```python
import torch

def _softmax(x, axis=-1):
    return torch.softmax(x, dim=axis)
def _gelu(x):
    return torch.nn.functional.gelu(x, approximate="tanh")
def _silu(x):
    return torch.nn.functional.silu(x)
def _sigmoid(x):
    return torch.sigmoid(x)
def _layernorm(x, axis=-1, eps=1e-5):
    m = x.mean(dim=axis, keepdim=True)
    v = x.var(dim=axis, keepdim=True, unbiased=False)
    return (x - m) / torch.sqrt(v + eps)
def _scatter_add(tgt, idx, src, axis=0):
    return tgt.clone().index_add_(axis, idx, src)
def _segment_sum(src, seg, n):
    out = torch.zeros((n,) + src.shape[1:], dtype=src.dtype)
    return out.index_add_(0, seg, src)
def _pad(x, pw):
    flat = tuple(v for pair in reversed(pw) for v in pair)
    return torch.nn.functional.pad(x, flat)

kernel_name = 'gated_mix__spectral_fnet__moe_arch_mod__prompt'

def setup_inputs():

    _w = (lambda a: (lambda t: t.to(torch.bfloat16) if t.is_floating_point() else t)(torch.as_tensor(a)))
    def _A_setup():
        B, S, D = 1, 2048, 512
        ns = torch.arange(S)[:, None] * torch.arange(S)[None, :]
        nd = torch.arange(D)[:, None] * torch.arange(D)[None, :]
        Ws_re = torch.cos(-2.0 * torch.pi * ns / S).to(float)
        Ws_im = torch.sin(-2.0 * torch.pi * ns / S).to(float)
        Wd_re = torch.cos(-2.0 * torch.pi * nd / D).to(float)
        Wd_im = torch.sin(-2.0 * torch.pi * nd / D).to(float)
        return {
            "x": _w((lambda *s: torch.randn(*s, dtype=torch.bfloat16) * 0.05)(B, S, D)),
            "dft_seq_re": _w(Ws_re),
            "dft_seq_im": _w(Ws_im),
            "dft_hid_re": _w(Wd_re),
            "dft_hid_im": _w(Wd_im),
        }
    _A_in = _A_setup()

    def _B_setup():
        B, S, D, F, C = 1, 2048, 512, 1792, 1
        return {
            "x": _w((lambda *s: torch.randn(*s, dtype=torch.bfloat16) * 0.05)(B, S, D)),
            "w_r": _w((lambda *s: torch.randn(*s, dtype=torch.bfloat16) * 1.6)(D)),
            "w_gate": _w((lambda *s: torch.randn(*s, dtype=torch.bfloat16) * 1.6)(D, F)),
            "w_up": _w((lambda *s: torch.randn(*s, dtype=torch.bfloat16) * 1.6)(D, F)),
            "w_down": _w((lambda *s: torch.randn(*s, dtype=torch.bfloat16) * 1.6)(F, D)),
        }
    _B_in = _B_setup()

    return {
        "A_x": _A_in["x"],
        "A_dft_seq_re": _A_in["dft_seq_re"],
        "A_dft_seq_im": _A_in["dft_seq_im"],
        "A_dft_hid_re": _A_in["dft_hid_re"],
        "A_dft_hid_im": _A_in["dft_hid_im"],
        "B_x": _B_in["x"],
        "B_w_r": _B_in["w_r"],
        "B_w_gate": _B_in["w_gate"],
        "B_w_up": _B_in["w_up"],
        "B_w_down": _B_in["w_down"],
        "gate_w": _w((lambda *s: torch.randn(*s, dtype=torch.bfloat16) * 0.05)(512) * 16.0),
    }

def reference(A_x, A_dft_seq_re, A_dft_seq_im, A_dft_hid_re, A_dft_hid_im, B_x, B_w_r, B_w_gate, B_w_up, B_w_down, gate_w):
    def _A_ref(x, dft_seq_re, dft_seq_im, dft_hid_re, dft_hid_im):
        a = torch.einsum("bsd,ed->bse", x, dft_hid_re)
        b = torch.einsum("bsd,ed->bse", x, dft_hid_im)
        y = torch.einsum("ts,bse->bte", dft_seq_re, a) - torch.einsum("ts,bse->bte", dft_seq_im, b)
        return y

    def _B_ref(x, w_r, w_gate, w_up, w_down):
        B, S, D = x.shape
        C = 1
        r = x @ w_r
        idx = torch.argsort(-r, axis=-1)[:, :C]
        idx_e = (lambda x, n, axis: torch.repeat_interleave(x, n, dim=axis))(idx.reshape(B, C, 1), D, axis=2)
        x_sel = (lambda x, i, axis: torch.take_along_dim(x, i, dim=axis))(x, idx_e, axis=1)
        g = _silu(x_sel @ w_gate)
        u = x_sel @ w_up
        y = (g * u) @ w_down
        r_sel = _sigmoid((lambda x, i, axis: torch.take_along_dim(x, i, dim=axis))(r, idx, axis=1))
        y = y * r_sel.reshape(B, C, 1)
        b_off = (torch.arange(B) * S).reshape(B, 1)
        flat_idx = (idx + b_off).reshape(B * C)
        zero = (x * 0.0).reshape(B * S, D)
        upd = _scatter_add(zero, flat_idx, y.reshape(B * C, D), axis=0)
        return x + upd.reshape(B, S, D)

    x = A_x
    g = _sigmoid((x * gate_w).sum(-1, keepdims=True))
    a = _A_ref(x, A_dft_seq_re, A_dft_seq_im, A_dft_hid_re, A_dft_hid_im)
    b = _B_ref(x, B_w_r, B_w_gate, B_w_up, B_w_down)
    return g * a + (1 - g) * b
```

```asm
; @launch grid=(256,1,1) block=(512,1,1) lds=100864
.amdgcn_target "amdgcn-amd-amdhsa--gfx950"
.text
.globl gated_mix__spectral_fnet__moe_arch_mod__prompt_kernel
.p2align 8
.type gated_mix__spectral_fnet__moe_arch_mod__prompt_kernel,@function
gated_mix__spectral_fnet__moe_arch_mod__prompt_kernel:
    s_cmp_ge_u32 s2, 256
    s_cbranch_scc1 L_end
    s_load_dwordx2 s[4:5], s[0:1], 0
    s_load_dwordx16 s[16:31], s[0:1], 48
    v_lshrrev_b32 v1, 6, v0
    v_and_b32 v0, 63, v0
    v_readfirstlane_b32 s3, v1
    v_and_b32 v2, 15, v0
    v_lshrrev_b32 v3, 4, v0
    s_and_b32 s56, s2, 7
    s_lshr_b32 s57, s2, 3
    s_mov_b32 s88, 400000
    s_mov_b32 s92, 0
    s_cmp_ge_u32 s57, 16
    s_cbranch_scc1 L_p2
    s_cmp_lt_u32 s57, 8
    s_cbranch_scc1 L_f0
    s_sub_u32 s58, s57, 8
    v_lshlrev_b32 v4, 19, v3
    v_lshl_add_u32 v4, v2, 3, v4
    v_add_u32 v5, 8192, v4
    s_lshl_b32 s12, s3, 14
    s_lshl_b32 s61, s56, 10
    s_add_u32 s12, s12, s61
    s_lshl_b32 s61, s58, 7
    s_add_u32 s12, s12, s61
    s_add_u32 s13, s12, 131072
    s_add_u32 s14, s12, 262144
    s_add_u32 s15, s12, 393216
    s_waitcnt lgkmcnt(0)
    s_load_dword s59, s[30:31], 0
    s_mov_b32 s32, s4
    s_mov_b32 s33, s5
    s_mov_b32 s34, 0x200000
    s_mov_b32 s35, 0x20000
    s_mov_b32 s36, s30
    s_mov_b32 s37, s31
    s_mov_b32 s38, 0x400000
    s_mov_b32 s39, 0x20000
    buffer_load_dwordx2 v[8:9], v4, s[32:35], s12 offen
    buffer_load_dwordx2 v[10:11], v5, s[32:35], s12 offen
    buffer_load_dwordx2 v[12:13], v4, s[32:35], s13 offen
    buffer_load_dwordx2 v[14:15], v5, s[32:35], s13 offen
    buffer_load_dwordx2 v[16:17], v4, s[32:35], s14 offen
    buffer_load_dwordx2 v[18:19], v5, s[32:35], s14 offen
    buffer_load_dwordx2 v[20:21], v4, s[32:35], s15 offen
    buffer_load_dwordx2 v[22:23], v5, s[32:35], s15 offen
    v_mov_b32 v112, 0x200000
    buffer_load_dword v113, v112, s[36:39], 0 offen
    s_add_u32 s12, s12, 0x200000
    s_add_u32 s13, s13, 0x200000
    s_add_u32 s14, s14, 0x200000
    s_add_u32 s15, s15, 0x200000
    v_lshlrev_b32 v119, 2, v3
    v_add_u32 v116, 0, v119
    v_mul_u32_u24 v116, v116, v2
    v_cvt_f32_u32 v116, v116
    v_mul_f32 v116, 0x3d800000, v116
    v_cos_f32 v117, v116
    v_sin_f32 v118, v116
    s_nop 0
    v_cvt_pk_bf16_f32 v40, v117, v118
    v_cvt_pk_bf16_f32 v44, -v118, v117
    v_add_u32 v116, 1, v119
    v_mul_u32_u24 v116, v116, v2
    v_cvt_f32_u32 v116, v116
    v_mul_f32 v116, 0x3d800000, v116
    v_cos_f32 v117, v116
    v_sin_f32 v118, v116
    s_nop 0
    v_cvt_pk_bf16_f32 v41, v117, v118
    v_cvt_pk_bf16_f32 v45, -v118, v117
    v_add_u32 v116, 2, v119
    v_mul_u32_u24 v116, v116, v2
    v_cvt_f32_u32 v116, v116
    v_mul_f32 v116, 0x3d800000, v116
    v_cos_f32 v117, v116
    v_sin_f32 v118, v116
    s_nop 0
    v_cvt_pk_bf16_f32 v42, v117, v118
    v_cvt_pk_bf16_f32 v46, -v118, v117
    v_add_u32 v116, 3, v119
    v_mul_u32_u24 v116, v116, v2
    v_cvt_f32_u32 v116, v116
    v_mul_f32 v116, 0x3d800000, v116
    v_cos_f32 v117, v116
    v_sin_f32 v118, v116
    s_nop 0
    v_cvt_pk_bf16_f32 v43, v117, v118
    v_cvt_pk_bf16_f32 v47, -v118, v117
    v_lshlrev_b32 v119, 2, v3
    s_lshl_b32 s60, s3, 1
    s_add_u32 s61, s60, 1
    v_add_u32 v116, 0, v119
    v_mul_u32_u24 v116, s60, v116
    v_cvt_f32_u32 v116, v116
    v_mul_f32 v116, 0x3b800000, v116
    v_cos_f32 v48, v116
    v_sin_f32 v56, v116
    v_add_u32 v116, 1, v119
    v_mul_u32_u24 v116, s60, v116
    v_cvt_f32_u32 v116, v116
    v_mul_f32 v116, 0x3b800000, v116
    v_cos_f32 v49, v116
    v_sin_f32 v57, v116
    v_add_u32 v116, 2, v119
    v_mul_u32_u24 v116, s60, v116
    v_cvt_f32_u32 v116, v116
    v_mul_f32 v116, 0x3b800000, v116
    v_cos_f32 v50, v116
    v_sin_f32 v58, v116
    v_add_u32 v116, 3, v119
    v_mul_u32_u24 v116, s60, v116
    v_cvt_f32_u32 v116, v116
    v_mul_f32 v116, 0x3b800000, v116
    v_cos_f32 v51, v116
    v_sin_f32 v59, v116
    v_add_u32 v116, 0, v119
    v_mul_u32_u24 v116, s61, v116
    v_cvt_f32_u32 v116, v116
    v_mul_f32 v116, 0x3b800000, v116
    v_cos_f32 v52, v116
    v_sin_f32 v60, v116
    v_add_u32 v116, 1, v119
    v_mul_u32_u24 v116, s61, v116
    v_cvt_f32_u32 v116, v116
    v_mul_f32 v116, 0x3b800000, v116
    v_cos_f32 v53, v116
    v_sin_f32 v61, v116
    v_add_u32 v116, 2, v119
    v_mul_u32_u24 v116, s61, v116
    v_cvt_f32_u32 v116, v116
    v_mul_f32 v116, 0x3b800000, v116
    v_cos_f32 v54, v116
    v_sin_f32 v62, v116
    v_add_u32 v116, 3, v119
    v_mul_u32_u24 v116, s61, v116
    v_cvt_f32_u32 v116, v116
    v_mul_f32 v116, 0x3b800000, v116
    v_cos_f32 v55, v116
    v_sin_f32 v63, v116
    v_bfe_u32 v116, v2, 1, 2
    s_lshr_b32 s60, s3, 1
    v_xor_b32 v116, s60, v116
    v_lshlrev_b32 v116, 4, v116
    v_lshl_add_u32 v116, v2, 6, v116
    v_lshl_add_u32 v116, v3, 13, v116
    s_and_b32 s60, s3, 1
    s_lshl_b32 s60, s60, 3
    v_add_u32 v6, s60, v116
    v_xor_b32 v7, 32, v6
    v_and_b32 v116, 1, v2
    v_lshrrev_b32 v117, 2, v2
    v_lshlrev_b32 v118, 1, v116
    v_xor_b32 v117, v117, v118
    v_xor_b32 v117, v117, v3
    v_lshrrev_b32 v118, 1, v2
    v_lshl_add_u32 v118, v116, 4, v118
    v_lshlrev_b32 v118, 6, v118
    v_lshl_add_u32 v118, v117, 4, v118
    s_lshl_b32 s60, s3, 12
    v_add_u32 v114, s60, v118
    v_mov_b32 v115, 0x00010001
    s_waitcnt lgkmcnt(0)
    s_add_u32 s59, s59, 0x9e3779b9
    s_and_b32 s89, s59, 0x00010001
    s_waitcnt vmcnt(2)
    v_mov_b32 v24, v8
    v_mov_b32 v25, v12
    v_mov_b32 v26, v16
    v_mov_b32 v27, v20
    v_mov_b32 v28, v9
    v_mov_b32 v29, v13
    v_mov_b32 v30, v17
    v_mov_b32 v31, v21
    s_waitcnt vmcnt(1)
    v_mov_b32 v32, v10
    v_mov_b32 v33, v14
    v_mov_b32 v34, v18
    v_mov_b32 v35, v22
    v_mov_b32 v36, v11
    v_mov_b32 v37, v15
    v_mov_b32 v38, v19
    v_mov_b32 v39, v23
    v_mfma_f32_16x16x32_bf16 v[64:67], v[40:43], v[24:27], 0
    v_mfma_f32_16x16x32_bf16 v[68:71], v[44:47], v[24:27], 0
    v_mfma_f32_16x16x32_bf16 v[72:75], v[40:43], v[28:31], 0
    v_mfma_f32_16x16x32_bf16 v[76:79], v[44:47], v[28:31], 0
    v_mfma_f32_16x16x32_bf16 v[80:83], v[40:43], v[32:35], 0
    v_mfma_f32_16x16x32_bf16 v[84:87], v[44:47], v[32:35], 0
    v_mfma_f32_16x16x32_bf16 v[88:91], v[40:43], v[36:39], 0
    v_mfma_f32_16x16x32_bf16 v[92:95], v[44:47], v[36:39], 0
    s_nop 0
    v_mul_f32 v116, v64, v48
    v_mul_f32 v120, v68, v48
    v_mul_f32 v117, v65, v49
    v_mul_f32 v121, v69, v49
    v_mul_f32 v118, v66, v50
    v_mul_f32 v122, v70, v50
    v_mul_f32 v119, v67, v51
    v_mul_f32 v123, v71, v51
    v_fmac_f32 v116, v68, v56
    v_fma_f32 v120, -v64, v56, v120
    v_fmac_f32 v117, v69, v57
    v_fma_f32 v121, -v65, v57, v121
    v_fmac_f32 v118, v70, v58
    v_fma_f32 v122, -v66, v58, v122
    v_fmac_f32 v119, v71, v59
    v_fma_f32 v123, -v67, v59, v123
    v_cvt_pk_bf16_f32 v96, v116, v120
    v_cvt_pk_bf16_f32 v98, v117, v121
    v_cvt_pk_bf16_f32 v100, v118, v122
    v_cvt_pk_bf16_f32 v102, v119, v123
    v_mul_f32 v116, v80, v52
    v_mul_f32 v120, v84, v52
    v_mul_f32 v117, v81, v53
    v_mul_f32 v121, v85, v53
    v_mul_f32 v118, v82, v54
    v_mul_f32 v122, v86, v54
    v_mul_f32 v119, v83, v55
    v_mul_f32 v123, v87, v55
    v_fmac_f32 v116, v84, v60
    v_fma_f32 v120, -v80, v60, v120
    v_fmac_f32 v117, v85, v61
    v_fma_f32 v121, -v81, v61, v121
    v_fmac_f32 v118, v86, v62
    v_fma_f32 v122, -v82, v62, v122
    v_fmac_f32 v119, v87, v63
    v_fma_f32 v123, -v83, v63, v123
    v_cvt_pk_bf16_f32 v97, v116, v120
    v_cvt_pk_bf16_f32 v99, v117, v121
    v_cvt_pk_bf16_f32 v101, v118, v122
    v_cvt_pk_bf16_f32 v103, v119, v123
    ds_write_b64 v6, v[96:97] offset:0
    ds_write_b64 v6, v[98:99] offset:2048
    ds_write_b64 v6, v[100:101] offset:4096
    ds_write_b64 v6, v[102:103] offset:6144
    v_mul_f32 v116, v72, v48
    v_mul_f32 v120, v76, v48
    v_mul_f32 v117, v73, v49
    v_mul_f32 v121, v77, v49
    v_mul_f32 v118, v74, v50
    v_mul_f32 v122, v78, v50
    v_mul_f32 v119, v75, v51
    v_mul_f32 v123, v79, v51
    v_fmac_f32 v116, v76, v56
    v_fma_f32 v120, -v72, v56, v120
    v_fmac_f32 v117, v77, v57
    v_fma_f32 v121, -v73, v57, v121
    v_fmac_f32 v118, v78, v58
    v_fma_f32 v122, -v74, v58, v122
    v_fmac_f32 v119, v79, v59
    v_fma_f32 v123, -v75, v59, v123
    v_cvt_pk_bf16_f32 v104, v116, v120
    v_cvt_pk_bf16_f32 v106, v117, v121
    v_cvt_pk_bf16_f32 v108, v118, v122
    v_cvt_pk_bf16_f32 v110, v119, v123
    v_mul_f32 v116, v88, v52
    v_mul_f32 v120, v92, v52
    v_mul_f32 v117, v89, v53
    v_mul_f32 v121, v93, v53
    v_mul_f32 v118, v90, v54
    v_mul_f32 v122, v94, v54
    v_mul_f32 v119, v91, v55
    v_mul_f32 v123, v95, v55
    v_fmac_f32 v116, v92, v60
    v_fma_f32 v120, -v88, v60, v120
    v_fmac_f32 v117, v93, v61
    v_fma_f32 v121, -v89, v61, v121
    v_fmac_f32 v118, v94, v62
    v_fma_f32 v122, -v90, v62, v122
    v_fmac_f32 v119, v95, v63
    v_fma_f32 v123, -v91, v63, v123
    v_cvt_pk_bf16_f32 v105, v116, v120
    v_cvt_pk_bf16_f32 v107, v117, v121
    v_cvt_pk_bf16_f32 v109, v118, v122
    v_cvt_pk_bf16_f32 v111, v119, v123
    ds_write_b64 v7, v[104:105] offset:1024
    ds_write_b64 v7, v[106:107] offset:3072
    ds_write_b64 v7, v[108:109] offset:5120
    ds_write_b64 v7, v[110:111] offset:7168
    s_waitcnt lgkmcnt(0)
    s_barrier
    ds_read_b128 v[8:11], v114 offset:0
    ds_read_b128 v[12:15], v114 offset:512
    ds_read_b128 v[16:19], v114 offset:2048
    ds_read_b128 v[20:23], v114 offset:2560
    s_waitcnt lgkmcnt(3)
    v_mfma_f32_16x16x32_bf16 v[64:67], v[40:43], v[8:11], 0
    v_mfma_f32_16x16x32_bf16 v[68:71], v[44:47], v[8:11], 0
    s_waitcnt lgkmcnt(2)
    v_mfma_f32_16x16x32_bf16 v[72:75], v[40:43], v[12:15], 0
    v_mfma_f32_16x16x32_bf16 v[76:79], v[44:47], v[12:15], 0
    s_waitcnt lgkmcnt(1)
    v_mfma_f32_16x16x32_bf16 v[80:83], v[40:43], v[16:19], 0
    v_mfma_f32_16x16x32_bf16 v[84:87], v[44:47], v[16:19], 0
    s_waitcnt lgkmcnt(0)
    v_mfma_f32_16x16x32_bf16 v[88:91], v[40:43], v[20:23], 0
    v_mfma_f32_16x16x32_bf16 v[92:95], v[44:47], v[20:23], 0
    v_cvt_pk_bf16_f32 v96, v64, v68
    s_nop 0
    v_cvt_pk_bf16_f32 v97, v72, v76
    v_bfi_b32 v96, v115, s89, v96
    v_bfi_b32 v97, v115, s89, v97
    buffer_store_dwordx2 v[96:97], v4, s[36:39], s12 offen sc1
    v_cvt_pk_bf16_f32 v98, v65, v69
    v_cvt_pk_bf16_f32 v99, v73, v77
    v_bfi_b32 v98, v115, s89, v98
    v_bfi_b32 v99, v115, s89, v99
    buffer_store_dwordx2 v[98:99], v4, s[36:39], s13 offen sc1
    v_cvt_pk_bf16_f32 v100, v66, v70
    v_cvt_pk_bf16_f32 v101, v74, v78
    v_bfi_b32 v100, v115, s89, v100
    v_bfi_b32 v101, v115, s89, v101
    buffer_store_dwordx2 v[100:101], v4, s[36:39], s14 offen sc1
    v_cvt_pk_bf16_f32 v102, v67, v71
    v_cvt_pk_bf16_f32 v103, v75, v79
    v_bfi_b32 v102, v115, s89, v102
    v_bfi_b32 v103, v115, s89, v103
    buffer_store_dwordx2 v[102:103], v4, s[36:39], s15 offen sc1
    v_cvt_pk_bf16_f32 v104, v80, v84
    v_cvt_pk_bf16_f32 v105, v88, v92
    v_bfi_b32 v104, v115, s89, v104
    v_bfi_b32 v105, v115, s89, v105
    buffer_store_dwordx2 v[104:105], v5, s[36:39], s12 offen sc1
    v_cvt_pk_bf16_f32 v106, v81, v85
    v_cvt_pk_bf16_f32 v107, v89, v93
    v_bfi_b32 v106, v115, s89, v106
    v_bfi_b32 v107, v115, s89, v107
    buffer_store_dwordx2 v[106:107], v5, s[36:39], s13 offen sc1
    v_cvt_pk_bf16_f32 v108, v82, v86
    v_cvt_pk_bf16_f32 v109, v90, v94
    v_bfi_b32 v108, v115, s89, v108
    v_bfi_b32 v109, v115, s89, v109
    buffer_store_dwordx2 v[108:109], v5, s[36:39], s14 offen sc1
    v_cvt_pk_bf16_f32 v110, v83, v87
    v_cvt_pk_bf16_f32 v111, v91, v95
    v_bfi_b32 v110, v115, s89, v110
    v_bfi_b32 v111, v115, s89, v111
    buffer_store_dwordx2 v[110:111], v5, s[36:39], s15 offen sc1
    s_barrier
    s_cmp_lg_u32 s3, 0
    s_cbranch_scc1 L_p1b
    s_lshl3_add_u32 s60, s58, s56
    s_lshl_b32 s60, s60, 2
    s_add_u32 s60, s60, 0x4000
    v_lshlrev_b32 v116, 8, v0
    v_mov_b32 v117, s59
    buffer_store_dword v117, v116, s[36:39], s60 offen sc1
L_p1b:
    s_cmp_eq_u32 s58, 0
    s_cbranch_scc1 L_fin
    s_endpgm
L_fin:
    s_add_u32 s10, s56, 56
    s_cmp_lg_u32 s3, 0
    s_cbranch_scc1 L_fin1
    s_lshl_b32 s60, s10, 11
    s_add_u32 s60, s60, 0x40000
    v_lshlrev_b32 v166, 3, v0
    v_mov_b32 v167, 1024
L_pk1:
    v_mov_b32 v160, 0
    v_mov_b32 v161, 0
    v_mov_b32 v162, 0
    v_mov_b32 v163, 0
    v_mov_b32 v164, 0
    v_mov_b32 v165, 0
    buffer_atomic_or_x2 v[160:161], v166, s[36:39], s60 offen sc0 sc1
    buffer_atomic_or_x2 v[162:163], v166, s[36:39], s60 offen offset:512 sc0 sc1
    s_mov_b64 exec, 1
    buffer_atomic_or_x2 v[164:165], v167, s[36:39], s60 offen sc0 sc1
    s_mov_b64 exec, -2
    v_mov_b32 v165, s59
    s_mov_b64 exec, -1
    s_waitcnt vmcnt(0)
    v_xor_b32 v161, s59, v161
    v_xor_b32 v163, s59, v163
    v_xor_b32 v165, s59, v165
    v_or3_b32 v161, v161, v163, v165
    v_cmp_ne_u32 vcc, 0, v161
    v_max3_u32 v160, v160, v162, v164
    s_nop 0
    s_cbranch_vccz L_pk1_ok
    s_sleep 1
    s_sub_u32 s88, s88, 1
    s_cbranch_scc0 L_pk1
    s_mov_b32 s88, 0
L_pk1_ok:
    v_max_u32_dpp v160, v160, v160 row_ror:8 row_mask:0xf bank_mask:0xf
    s_nop 1
    v_max_u32_dpp v160, v160, v160 row_ror:4 row_mask:0xf bank_mask:0xf
    s_nop 1
    v_max_u32_dpp v160, v160, v160 row_ror:2 row_mask:0xf bank_mask:0xf
    s_nop 1
    v_max_u32_dpp v160, v160, v160 row_ror:1 row_mask:0xf bank_mask:0xf
    s_nop 0
    v_readlane_b32 s95, v160, 0
    v_readlane_b32 s60, v160, 16
    v_readlane_b32 s61, v160, 32
    v_readlane_b32 s62, v160, 48
    s_max_u32 s95, s95, s60
    s_max_u32 s61, s61, s62
    s_max_u32 s95, s95, s61
    s_and_b32 s95, s95, 2047
    v_mov_b32 v160, 40964
    v_mov_b32 v161, s95
    ds_write_b32 v160, v161
    s_waitcnt lgkmcnt(0)
L_fin1:
    s_barrier
    v_mov_b32 v160, 40964
    ds_read_b32 v161, v160
    s_waitcnt lgkmcnt(0)
    v_readfirstlane_b32 s95, v161
    s_mov_b32 s92, 1
    s_and_b32 s60, s95, 255
    s_sub_u32 s61, 2048, s95
    s_cmp_gt_u32 s60, 128
    s_cselect_b32 s94, 1, 0
    s_cselect_b32 s60, s61, s95
    s_and_b32 s58, s60, 255
    s_lshr_b32 s93, s60, 8
    s_branch L_p2fin
L_f0:
    s_cmp_lt_u32 s56, 4
    s_cbranch_scc1 L_f
    s_cmp_lt_u32 s57, 6
    s_cbranch_scc1 L_f
    s_cmp_lg_u32 s2, 52
    s_cbranch_scc1 L_end
    s_mov_b32 s58, 128
    s_branch L_p2b
L_f:
    s_lshl3_add_u32 s60, s56, s57
    s_mul_i32 s62, s56, 6
    s_add_u32 s62, s62, 8
    s_add_u32 s62, s62, s57
    s_cmp_lt_u32 s56, 4
    s_cselect_b32 s58, s60, s62
    s_mov_b32 s10, s58
    v_lshrrev_b32 v8, 2, v0
    v_mul_u32_u24 v4, 3584, v8
    v_lshrrev_b32 v8, 2, v8
    v_and_b32 v8, 2, v8
    v_and_b32 v9, 3, v0
    v_xor_b32 v8, v8, v9
    v_lshl_add_u32 v4, v8, 4, v4
    v_lshrrev_b32 v8, 3, v0
    v_and_b32 v9, 2, v8
    v_and_b32 v10, 7, v0
    v_xor_b32 v9, v9, v10
    v_lshlrev_b32 v9, 4, v9
    v_lshl_add_u32 v5, v8, 10, v9
    v_xor_b32 v6, 64, v5
    s_and_b32 s60, s3, 3
    s_mul_i32 s12, s60, 458752
    s_lshl_b32 s61, s58, 6
    s_add_u32 s12, s12, s61
    s_lshl_b32 s13, s58, 15
    s_lshl_b32 s61, s3, 7
    s_add_u32 s13, s13, s61
    s_lshl_b32 s14, s3, 13
    s_lshl_b32 s15, s3, 12
    s_add_u32 s15, s15, 65536
    s_waitcnt lgkmcnt(0)
    s_load_dword s59, s[30:31], 0
    s_mov_b32 s32, s4
    s_mov_b32 s33, s5
    s_mov_b32 s34, 0x200000
    s_mov_b32 s35, 0x20000
    s_mov_b32 s36, s30
    s_mov_b32 s37, s31
    s_mov_b32 s38, 0x400000
    s_mov_b32 s39, 0x20000
    s_cmp_lt_u32 s3, 4
    s_cselect_b32 s44, s18, s20
    s_cselect_b32 s45, s19, s21
    s_mov_b32 s46, 0x1c0000
    s_mov_b32 s47, 0x20000
    s_mov_b32 s52, s22
    s_mov_b32 s53, s23
    s_mov_b32 s54, 0x1c0000
    s_mov_b32 s55, 0x20000
    s_add_u32 m0, s14, 0
    s_nop 0
    buffer_load_dwordx4 v4, s[44:47], s12 offen lds
    s_add_u32 s12, s12, 57344
    s_add_u32 m0, s14, 1024
    s_nop 0
    buffer_load_dwordx4 v4, s[44:47], s12 offen lds
    s_add_u32 s12, s12, 57344
    s_add_u32 m0, s14, 2048
    s_nop 0
    buffer_load_dwordx4 v4, s[44:47], s12 offen lds
    s_add_u32 s12, s12, 57344
    s_add_u32 m0, s14, 3072
    s_nop 0
    buffer_load_dwordx4 v4, s[44:47], s12 offen lds
    s_add_u32 s12, s12, 57344
    s_add_u32 m0, s14, 4096
    s_nop 0
    buffer_load_dwordx4 v4, s[44:47], s12 offen lds
    s_add_u32 s12, s12, 57344
    s_add_u32 m0, s14, 5120
    s_nop 0
    buffer_load_dwordx4 v4, s[44:47], s12 offen lds
    s_add_u32 s12, s12, 57344
    s_add_u32 m0, s14, 6144
    s_nop 0
    buffer_load_dwordx4 v4, s[44:47], s12 offen lds
    s_add_u32 s12, s12, 57344
    s_add_u32 m0, s14, 7168
    s_nop 0
    buffer_load_dwordx4 v4, s[44:47], s12 offen lds
    s_add_u32 m0, s15, 0
    s_nop 0
    buffer_load_dwordx4 v5, s[52:55], s13 offen lds
    s_add_u32 s13, s13, 8192
    s_add_u32 m0, s15, 1024
    s_nop 0
    buffer_load_dwordx4 v6, s[52:55], s13 offen lds
    s_add_u32 s13, s13, 8192
    s_add_u32 m0, s15, 2048
    s_nop 0
    buffer_load_dwordx4 v5, s[52:55], s13 offen lds
    s_add_u32 s13, s13, 8192
    s_add_u32 m0, s15, 3072
    s_nop 0
    buffer_load_dwordx4 v6, s[52:55], s13 offen lds
    v_lshrrev_b32 v8, 2, v2
    v_lshl_add_u32 v9, v3, 3, v8
    v_and_b32 v10, 3, v0
    v_lshlrev_b32 v10, 3, v10
    v_and_b32 v11, 1, v3
    v_lshl_add_u32 v7, v9, 6, v10
    v_lshl_add_u32 v7, v11, 5, v7
    v_add_u32 v7, s14, v7
    v_xor_b32 v12, 32, v7
    v_lshrrev_b32 v8, 1, v8
    v_lshl_add_u32 v8, v11, 1, v8
    v_lshl_add_u32 v13, v9, 7, v10
    v_lshl_add_u32 v13, v8, 5, v13
    v_add_u32 v13, s15, v13
    s_and_b32 s60, s3, 3
    s_lshl_b32 s60, s60, 8
    s_add_u32 s60, s60, 98304
    v_lshlrev_b32 v14, 4, v3
    v_add_u32 v15, s60, v14
    s_lshl_b32 s60, s3, 7
    s_add_u32 s60, s60, 99328
    v_add_u32 v104, s60, v14
    v_and_b32 v105, 31, v0
    s_lshl_b32 s60, s3, 6
    s_add_u32 s60, s60, 100352
    v_lshl_add_u32 v106, v105, 1, s60
    v_add_u32 v107, s60, v14
    v_lshlrev_b32 v105, 2, v105
    v_add_u32 v105, 99328, v105
    v_lshl_add_u32 v108, v2, 6, v14
    v_lshlrev_b32 v109, 4, v0
    s_waitcnt lgkmcnt(0)
    s_add_u32 s59, s59, 0x9e3779b9
    s_and_b32 s89, s59, 0x00010001
    v_mov_b32 v121, s59
    v_mov_b32 v123, s59
    s_mul_i32 s12, s3, 14336
    s_lshl_b32 s61, s58, 8
    s_add_u32 s12, s12, s61
    s_add_u32 s12, s12, 0x10000
    s_waitcnt vmcnt(10)
    ds_read_b64_tr_b16 v[16:17], v7 offset:0
    ds_read_b64_tr_b16 v[18:19], v7 offset:256
    ds_read_b64_tr_b16 v[20:21], v12 offset:0
    ds_read_b64_tr_b16 v[22:23], v12 offset:256
    s_waitcnt vmcnt(8)
    ds_read_b64_tr_b16 v[24:25], v7 offset:2048
    ds_read_b64_tr_b16 v[26:27], v7 offset:2304
    ds_read_b64_tr_b16 v[28:29], v12 offset:2048
    ds_read_b64_tr_b16 v[30:31], v12 offset:2304
    s_waitcnt vmcnt(6)
    ds_read_b64_tr_b16 v[32:33], v7 offset:4096
    ds_read_b64_tr_b16 v[34:35], v7 offset:4352
    ds_read_b64_tr_b16 v[36:37], v12 offset:4096
    ds_read_b64_tr_b16 v[38:39], v12 offset:4352
    s_waitcnt vmcnt(4)
    ds_read_b64_tr_b16 v[40:41], v7 offset:6144
    ds_read_b64_tr_b16 v[42:43], v7 offset:6400
    ds_read_b64_tr_b16 v[44:45], v12 offset:6144
    ds_read_b64_tr_b16 v[46:47], v12 offset:6400
    s_waitcnt vmcnt(0)
    v_xor_b32 v8, 0, v13
    ds_read_b64_tr_b16 v[48:49], v8 offset:0
    ds_read_b64_tr_b16 v[50:51], v8 offset:512
    v_xor_b32 v8, 32, v13
    ds_read_b64_tr_b16 v[52:53], v8 offset:0
    ds_read_b64_tr_b16 v[54:55], v8 offset:512
    v_xor_b32 v8, 64, v13
    ds_read_b64_tr_b16 v[56:57], v8 offset:0
    ds_read_b64_tr_b16 v[58:59], v8 offset:512
    v_xor_b32 v8, 96, v13
    ds_read_b64_tr_b16 v[60:61], v8 offset:0
    ds_read_b64_tr_b16 v[62:63], v8 offset:512
    s_cmp_lg_u32 s3, 0
    s_cbranch_scc1 L_f2
    s_lshl_b32 s60, s10, 11
    s_add_u32 s60, s60, 0x40000
    v_lshlrev_b32 v166, 3, v0
    v_mov_b32 v167, 1024
L_pk2:
    v_mov_b32 v160, 0
    v_mov_b32 v161, 0
    v_mov_b32 v162, 0
    v_mov_b32 v163, 0
    v_mov_b32 v164, 0
    v_mov_b32 v165, 0
    buffer_atomic_or_x2 v[160:161], v166, s[36:39], s60 offen sc0 sc1
    buffer_atomic_or_x2 v[162:163], v166, s[36:39], s60 offen offset:512 sc0 sc1
    s_mov_b64 exec, 1
    buffer_atomic_or_x2 v[164:165], v167, s[36:39], s60 offen sc0 sc1
    s_mov_b64 exec, -2
    v_mov_b32 v165, s59
    s_mov_b64 exec, -1
    s_waitcnt vmcnt(0)
    v_xor_b32 v161, s59, v161
    v_xor_b32 v163, s59, v163
    v_xor_b32 v165, s59, v165
    v_or3_b32 v161, v161, v163, v165
    v_cmp_ne_u32 vcc, 0, v161
    v_max3_u32 v160, v160, v162, v164
    s_nop 0
    s_cbranch_vccz L_pk2_ok
    s_sleep 1
    s_sub_u32 s88, s88, 1
    s_cbranch_scc0 L_pk2
    s_mov_b32 s88, 0
L_pk2_ok:
    v_max_u32_dpp v160, v160, v160 row_ror:8 row_mask:0xf bank_mask:0xf
    s_nop 1
    v_max_u32_dpp v160, v160, v160 row_ror:4 row_mask:0xf bank_mask:0xf
    s_nop 1
    v_max_u32_dpp v160, v160, v160 row_ror:2 row_mask:0xf bank_mask:0xf
    s_nop 1
    v_max_u32_dpp v160, v160, v160 row_ror:1 row_mask:0xf bank_mask:0xf
    s_nop 0
    v_readlane_b32 s95, v160, 0
    v_readlane_b32 s60, v160, 16
    v_readlane_b32 s61, v160, 32
    v_readlane_b32 s62, v160, 48
    s_max_u32 s95, s95, s60
    s_max_u32 s61, s61, s62
    s_max_u32 s95, s95, s61
    s_and_b32 s95, s95, 2047
    s_lshl_b32 s60, s95, 10
    s_mov_b32 m0, 98304
    s_nop 0
    buffer_load_dwordx4 v109, s[32:35], s60 offen lds
    s_waitcnt vmcnt(0)
L_f2:
    s_waitcnt lgkmcnt(0)
    s_barrier
    ds_read_b128 v[64:67], v15 offset:0
    ds_read_b128 v[68:71], v15 offset:64
    ds_read_b128 v[72:75], v15 offset:128
    ds_read_b128 v[76:79], v15 offset:192
    s_waitcnt lgkmcnt(3)
    v_mfma_f32_16x16x32_bf16 v[80:83], v[16:19], v[64:67], 0
    v_mfma_f32_16x16x32_bf16 v[84:87], v[20:23], v[64:67], 0
    s_waitcnt lgkmcnt(2)
    v_mfma_f32_16x16x32_bf16 v[80:83], v[24:27], v[68:71], v[80:83]
    v_mfma_f32_16x16x32_bf16 v[84:87], v[28:31], v[68:71], v[84:87]
    s_waitcnt lgkmcnt(1)
    v_mfma_f32_16x16x32_bf16 v[80:83], v[32:35], v[72:75], v[80:83]
    v_mfma_f32_16x16x32_bf16 v[84:87], v[36:39], v[72:75], v[84:87]
    s_waitcnt lgkmcnt(0)
    v_mfma_f32_16x16x32_bf16 v[80:83], v[40:43], v[76:79], v[80:83]
    v_mfma_f32_16x16x32_bf16 v[84:87], v[44:47], v[76:79], v[84:87]
    s_mov_b32 exec_lo, 0x00010001
    s_mov_b32 exec_hi, 0x00010001
    s_nop 4
    ds_write_b128 v104, v[80:83] offset:0
    ds_write_b128 v104, v[84:87] offset:64
    s_mov_b64 exec, -1
    s_waitcnt lgkmcnt(0)
    s_barrier
    ds_read2_b32 v[64:65], v105 offset0:0 offset1:32
    ds_read2_b32 v[66:67], v105 offset0:64 offset1:96
    ds_read2_b32 v[68:69], v105 offset0:128 offset1:160
    ds_read2_b32 v[70:71], v105 offset0:192 offset1:224
    s_waitcnt lgkmcnt(0)
    v_add_f32 v64, v64, v65
    v_add_f32 v66, v66, v67
    v_add_f32 v68, v68, v69
    v_add_f32 v70, v70, v71
    v_add_f32 v64, v64, v66
    v_add_f32 v68, v68, v70
    v_mul_f32 v65, 0xbfb8aa3b, v64
    v_exp_f32 v65, v65
    s_nop 0
    v_add_f32 v65, 1.0, v65
    v_rcp_f32 v65, v65
    v_mul_f32 v64, v64, v68
    v_mul_f32 v64, v64, v65
    v_cvt_pk_bf16_f32 v64, v64, v64
    ds_write_b16 v106, v64
    s_waitcnt lgkmcnt(0)
    ds_read_b128 v[72:75], v107
    s_waitcnt lgkmcnt(0)
    v_mfma_f32_16x16x32_bf16 v[88:91], v[48:51], v[72:75], 0
    v_mfma_f32_16x16x32_bf16 v[92:95], v[52:55], v[72:75], 0
    v_mfma_f32_16x16x32_bf16 v[96:99], v[56:59], v[72:75], 0
    v_mfma_f32_16x16x32_bf16 v[100:103], v[60:63], v[72:75], 0
    s_mov_b32 exec_lo, 0x10001
    s_mov_b32 exec_hi, 0x10001
    s_nop 2
    v_cvt_pk_bf16_f32 v120, v88, v89
    v_cvt_pk_bf16_f32 v122, v90, v91
    s_mov_b32 exec_lo, 0x20002
    s_mov_b32 exec_hi, 0x20002
    v_cvt_pk_bf16_f32 v120, v92, v93
    v_cvt_pk_bf16_f32 v122, v94, v95
    s_mov_b32 exec_lo, 0x40004
    s_mov_b32 exec_hi, 0x40004
    v_cvt_pk_bf16_f32 v120, v96, v97
    v_cvt_pk_bf16_f32 v122, v98, v99
    s_mov_b32 exec_lo, 0x80008
    s_mov_b32 exec_hi, 0x80008
    v_cvt_pk_bf16_f32 v120, v100, v101
    v_cvt_pk_bf16_f32 v122, v102, v103
    s_mov_b32 exec_lo, 0x000f000f
    s_mov_b32 exec_hi, 0x000f000f
    buffer_store_dwordx4 v[120:123], v108, s[36:39], s12 offen sc1
    s_endpgm
L_p2:
    s_sub_u32 s58, s57, 16
    s_lshl3_add_u32 s58, s58, s56
L_p2b:
    s_and_b32 s10, s58, 63
    s_waitcnt lgkmcnt(0)
    s_load_dword s59, s[30:31], 0
    s_mov_b32 s32, s4
    s_mov_b32 s33, s5
    s_mov_b32 s34, 0x200000
    s_mov_b32 s35, 0x20000
    s_mov_b32 s36, s30
    s_mov_b32 s37, s31
    s_mov_b32 s38, 0x400000
    s_mov_b32 s39, 0x20000
L_p2fin:
    v_lshlrev_b32 v4, 5, v2
    v_lshl_add_u32 v4, v3, 3, v4
    s_lshl_b32 s60, s3, 8
    s_add_u32 s90, s60, s58
    s_sub_u32 s91, 2048, s90
    s_and_b32 s91, s91, 2047
    s_lshl_b32 s12, s90, 10
    s_lshl_b32 s13, s91, 10
    s_mov_b32 s44, s16
    s_mov_b32 s45, s17
    s_mov_b32 s46, 0x400
    s_mov_b32 s47, 0x20000
    s_mov_b32 s48, s24
    s_mov_b32 s49, s25
    s_mov_b32 s50, 0x400
    s_mov_b32 s51, 0x20000
    s_mov_b32 s40, s26
    s_mov_b32 s41, s27
    s_mov_b32 s42, 0x200000
    s_mov_b32 s43, 0x20000
    buffer_load_dwordx2 v[8:9], v4, s[32:35], s12 offen offset:0
    buffer_load_dwordx2 v[10:11], v4, s[32:35], s12 offen offset:512
    buffer_load_dwordx2 v[12:13], v4, s[32:35], s13 offen offset:0
    buffer_load_dwordx2 v[14:15], v4, s[32:35], s13 offen offset:512
    buffer_load_dwordx2 v[16:17], v4, s[44:47], 0 offen offset:0
    buffer_load_dwordx2 v[18:19], v4, s[44:47], 0 offen offset:512
    buffer_load_dwordx2 v[20:21], v4, s[48:51], 0 offen offset:0
    buffer_load_dwordx2 v[22:23], v4, s[48:51], 0 offen offset:512
    v_mov_b32 v56, 0x200000
    v_mov_b32 v57, 0
    buffer_load_dword v58, v56, s[36:39], 0 offen
    buffer_load_dword v59, v57, s[40:43], 0 offen
    v_mov_b32 v160, 40960
    v_mov_b32 v161, 0
    ds_write_b32 v160, v161
    v_lshlrev_b32 v159, 2, v3
    v_add_u32 v156, 0, v159
    v_mul_u32_u24 v156, v156, v2
    v_cvt_f32_u32 v156, v156
    v_mul_f32 v156, 0x3d800000, v156
    v_cos_f32 v157, v156
    v_sin_f32 v158, v156
    s_nop 0
    v_cvt_pk_bf16_f32 v72, v157, v158
    v_cvt_pk_bf16_f32 v76, -v158, v157
    v_add_u32 v156, 1, v159
    v_mul_u32_u24 v156, v156, v2
    v_cvt_f32_u32 v156, v156
    v_mul_f32 v156, 0x3d800000, v156
    v_cos_f32 v157, v156
    v_sin_f32 v158, v156
    s_nop 0
    v_cvt_pk_bf16_f32 v73, v157, v158
    v_cvt_pk_bf16_f32 v77, -v158, v157
    v_add_u32 v156, 2, v159
    v_mul_u32_u24 v156, v156, v2
    v_cvt_f32_u32 v156, v156
    v_mul_f32 v156, 0x3d800000, v156
    v_cos_f32 v157, v156
    v_sin_f32 v158, v156
    s_nop 0
    v_cvt_pk_bf16_f32 v74, v157, v158
    v_cvt_pk_bf16_f32 v78, -v158, v157
    v_add_u32 v156, 3, v159
    v_mul_u32_u24 v156, v156, v2
    v_cvt_f32_u32 v156, v156
    v_mul_f32 v156, 0x3d800000, v156
    v_cos_f32 v157, v156
    v_sin_f32 v158, v156
    s_nop 0
    v_cvt_pk_bf16_f32 v75, v157, v158
    v_cvt_pk_bf16_f32 v79, -v158, v157
    v_mov_b32 v156, 0x80000000
    v_xor_b32 v80, v156, v72
    v_xor_b32 v84, v156, v76
    v_xor_b32 v81, v156, v73
    v_xor_b32 v85, v156, v77
    v_xor_b32 v82, v156, v74
    v_xor_b32 v86, v156, v78
    v_xor_b32 v83, v156, v75
    v_xor_b32 v87, v156, v79
    s_cmp_eq_u32 s92, 1
    s_cbranch_scc1 L_p2t
    s_waitcnt lgkmcnt(0)
    s_add_u32 s59, s59, 0x9e3779b9
    s_and_b32 s89, s59, 0x00010001
L_p2t:
    s_waitcnt lgkmcnt(0)
    s_barrier
    s_waitcnt vmcnt(2)
    v_dot2_f32_bf16 v24, v8, v16, 0
    v_dot2_f32_bf16 v25, v8, v20, 0
    v_dot2_f32_bf16 v26, v12, v16, 0
    v_dot2_f32_bf16 v27, v12, v20, 0
    v_dot2_f32_bf16 v24, v9, v17, v24
    v_dot2_f32_bf16 v25, v9, v21, v25
    v_dot2_f32_bf16 v26, v13, v17, v26
    v_dot2_f32_bf16 v27, v13, v21, v27
    v_dot2_f32_bf16 v24, v10, v18, v24
    v_dot2_f32_bf16 v25, v10, v22, v25
    v_dot2_f32_bf16 v26, v14, v18, v26
    v_dot2_f32_bf16 v27, v14, v22, v27
    v_dot2_f32_bf16 v24, v11, v19, v24
    v_dot2_f32_bf16 v25, v11, v23, v25
    v_dot2_f32_bf16 v26, v15, v19, v26
    v_dot2_f32_bf16 v27, v15, v23, v27
    s_nop 0
    v_permlane32_swap_b32 v24, v25
    s_nop 0
    v_permlane32_swap_b32 v26, v27
    v_add_f32 v24, v24, v25
    v_add_f32 v26, v26, v27
    s_nop 1
    v_permlane16_swap_b32 v24, v26
    v_add_f32 v24, v24, v26
    s_nop 1
    v_add_f32_dpp v24, v24, v24 row_ror:8 row_mask:0xf bank_mask:0xf
    s_nop 1
    v_add_f32_dpp v24, v24, v24 row_ror:4 row_mask:0xf bank_mask:0xf
    s_nop 1
    v_add_f32_dpp v24, v24, v24 row_ror:2 row_mask:0xf bank_mask:0xf
    s_nop 1
    v_add_f32_dpp v24, v24, v24 row_ror:1 row_mask:0xf bank_mask:0xf
    v_ashrrev_i32 v25, 31, v24
    v_or_b32 v25, 0x80000000, v25
    v_xor_b32 v25, v25, v24
    v_and_b32 v25, 0xfffff800, v25
    s_nop 0
    v_readlane_b32 s60, v25, 0
    v_readlane_b32 s61, v25, 16
    s_or_b32 s60, s60, s90
    s_or_b32 s61, s61, s91
    s_max_u32 s60, s60, s61
    v_mov_b32 v161, s60
    s_mov_b64 exec, 1
    ds_max_u32 v160, v161
    s_mov_b64 exec, -1
    v_mul_f32 v26, 0xbfb8aa3b, v24
    v_exp_f32 v26, v26
    s_nop 0
    v_add_f32 v26, 1.0, v26
    v_rcp_f32 v26, v26
    s_waitcnt lgkmcnt(0)
    s_barrier
    s_or_b32 s60, s3, s92
    s_cmp_lg_u32 s60, 0
    s_cbranch_scc1 L_p2k
    ds_read_b32 v162, v160
    s_lshl_b32 s60, s58, 3
    s_add_u32 s60, s60, 0x40000
    v_lshlrev_b32 v161, 11, v0
    v_mov_b32 v163, s59
    s_waitcnt lgkmcnt(0)
    buffer_store_dwordx2 v[162:163], v161, s[36:39], s60 offen sc1
L_p2k:
    v_readlane_b32 s8, v26, 0
    v_readlane_b32 s9, v26, 16
    v_readlane_b32 s6, v26, 32
    v_readlane_b32 s7, v26, 48
    s_nop 0
    v_sub_f32 v152, 1.0, s6
    v_lshlrev_b32 v136, 16, v8
    v_and_b32 v137, 0xffff0000, v8
    v_mul_f32 v136, v152, v136
    v_mul_f32 v137, v152, v137
    v_lshlrev_b32 v138, 16, v9
    v_and_b32 v139, 0xffff0000, v9
    v_mul_f32 v138, v152, v138
    v_mul_f32 v139, v152, v139
    v_lshlrev_b32 v140, 16, v10
    v_and_b32 v141, 0xffff0000, v10
    v_mul_f32 v140, v152, v140
    v_mul_f32 v141, v152, v141
    v_lshlrev_b32 v142, 16, v11
    v_and_b32 v143, 0xffff0000, v11
    v_mul_f32 v142, v152, v142
    v_mul_f32 v143, v152, v143
    v_sub_f32 v152, 1.0, s7
    v_lshlrev_b32 v144, 16, v12
    v_and_b32 v145, 0xffff0000, v12
    v_mul_f32 v144, v152, v144
    v_mul_f32 v145, v152, v145
    v_lshlrev_b32 v146, 16, v13
    v_and_b32 v147, 0xffff0000, v13
    v_mul_f32 v146, v152, v146
    v_mul_f32 v147, v152, v147
    v_lshlrev_b32 v148, 16, v14
    v_and_b32 v149, 0xffff0000, v14
    v_mul_f32 v148, v152, v148
    v_mul_f32 v149, v152, v149
    v_lshlrev_b32 v150, 16, v15
    v_and_b32 v151, 0xffff0000, v15
    v_mul_f32 v150, v152, v150
    v_mul_f32 v151, v152, v151
    v_lshrrev_b32 v152, 1, v2
    v_lshlrev_b32 v152, 8, v152
    v_add_u32 v152, s58, v152
    v_and_b32 v153, 1, v2
    v_lshlrev_b32 v153, 9, v153
    v_cmp_gt_u32 vcc, 2, v3
    v_sub_u32 v154, 2048, v153
    s_nop 0
    v_cndmask_b32 v153, v154, v153, vcc
    v_mov_b32 v154, -0.5
    v_mov_b32 v155, 0.5
    v_cndmask_b32 v154, v154, v155, vcc
    v_and_b32 v155, 1, v3
    v_lshlrev_b32 v155, 2, v155
    v_add_u32 v156, 0, v155
    v_mad_u32_u24 v156, v156, v152, v153
    v_and_b32 v156, 2047, v156
    v_cvt_f32_u32 v156, v156
    v_mul_f32 v156, 0x3a000000, v156
    v_cos_f32 v157, v156
    v_sin_f32 v158, v156
    v_mul_f32 v156, 0.5, v157
    v_mul_f32 v159, v154, v158
    v_cvt_pk_bf16_f32 v64, v156, v159
    v_mul_f32 v156, -0.5, v158
    v_mul_f32 v159, v154, v157
    v_cvt_pk_bf16_f32 v68, v156, v159
    v_add_u32 v156, 1, v155
    v_mad_u32_u24 v156, v156, v152, v153
    v_and_b32 v156, 2047, v156
    v_cvt_f32_u32 v156, v156
    v_mul_f32 v156, 0x3a000000, v156
    v_cos_f32 v157, v156
    v_sin_f32 v158, v156
    v_mul_f32 v156, 0.5, v157
    v_mul_f32 v159, v154, v158
    v_cvt_pk_bf16_f32 v65, v156, v159
    v_mul_f32 v156, -0.5, v158
    v_mul_f32 v159, v154, v157
    v_cvt_pk_bf16_f32 v69, v156, v159
    v_add_u32 v156, 2, v155
    v_mad_u32_u24 v156, v156, v152, v153
    v_and_b32 v156, 2047, v156
    v_cvt_f32_u32 v156, v156
    v_mul_f32 v156, 0x3a000000, v156
    v_cos_f32 v157, v156
    v_sin_f32 v158, v156
    v_mul_f32 v156, 0.5, v157
    v_mul_f32 v159, v154, v158
    v_cvt_pk_bf16_f32 v66, v156, v159
    v_mul_f32 v156, -0.5, v158
    v_mul_f32 v159, v154, v157
    v_cvt_pk_bf16_f32 v70, v156, v159
    v_add_u32 v156, 3, v155
    v_mad_u32_u24 v156, v156, v152, v153
    v_and_b32 v156, 2047, v156
    v_cvt_f32_u32 v156, v156
    v_mul_f32 v156, 0x3a000000, v156
    v_cos_f32 v157, v156
    v_sin_f32 v158, v156
    v_mul_f32 v156, 0.5, v157
    v_mul_f32 v159, v154, v158
    v_cvt_pk_bf16_f32 v67, v156, v159
    v_mul_f32 v156, -0.5, v158
    v_mul_f32 v159, v154, v157
    v_cvt_pk_bf16_f32 v71, v156, v159
    v_lshlrev_b32 v152, 3, v3
    v_add_u32 v153, 16, v2
    v_add_u32 v154, 0, v152
    v_mul_u32_u24 v155, v154, v2
    v_mul_u32_u24 v156, v154, v153
    v_cvt_f32_u32 v155, v155
    v_mul_f32 v154, 0x3b000000, v155
    v_cos_f32 v157, v154
    v_sin_f32 v158, v154
    v_mul_f32 v155, 0x3d000000, v155
    v_mul_f32 v104, s6, v157
    v_mul_f32 v108, s6, v158
    v_mul_f32 v120, s7, v157
    v_mul_f32 v124, s7, v158
    v_cos_f32 v157, v155
    v_sin_f32 v158, v155
    s_nop 0
    v_cvt_pk_bf16_f32 v88, v157, v158
    v_cvt_f32_u32 v156, v156
    v_mul_f32 v156, 0x3d000000, v156
    v_cos_f32 v157, v156
    v_sin_f32 v158, v156
    s_nop 0
    v_cvt_pk_bf16_f32 v92, v157, v158
    v_add_u32 v154, 2, v152
    v_mul_u32_u24 v155, v154, v2
    v_mul_u32_u24 v156, v154, v153
    v_cvt_f32_u32 v155, v155
    v_mul_f32 v154, 0x3b000000, v155
    v_cos_f32 v157, v154
    v_sin_f32 v158, v154
    v_mul_f32 v155, 0x3d000000, v155
    v_mul_f32 v105, s6, v157
    v_mul_f32 v109, s6, v158
    v_mul_f32 v121, s7, v157
    v_mul_f32 v125, s7, v158
    v_cos_f32 v157, v155
    v_sin_f32 v158, v155
    s_nop 0
    v_cvt_pk_bf16_f32 v89, v157, v158
    v_cvt_f32_u32 v156, v156
    v_mul_f32 v156, 0x3d000000, v156
    v_cos_f32 v157, v156
    v_sin_f32 v158, v156
    s_nop 0
    v_cvt_pk_bf16_f32 v93, v157, v158
    v_add_u32 v154, 4, v152
    v_mul_u32_u24 v155, v154, v2
    v_mul_u32_u24 v156, v154, v153
    v_cvt_f32_u32 v155, v155
    v_mul_f32 v154, 0x3b000000, v155
    v_cos_f32 v157, v154
    v_sin_f32 v158, v154
    v_mul_f32 v155, 0x3d000000, v155
    v_mul_f32 v106, s6, v157
    v_mul_f32 v110, s6, v158
    v_mul_f32 v122, s7, v157
    v_mul_f32 v126, s7, v158
    v_cos_f32 v157, v155
    v_sin_f32 v158, v155
    s_nop 0
    v_cvt_pk_bf16_f32 v90, v157, v158
    v_cvt_f32_u32 v156, v156
    v_mul_f32 v156, 0x3d000000, v156
    v_cos_f32 v157, v156
    v_sin_f32 v158, v156
    s_nop 0
    v_cvt_pk_bf16_f32 v94, v157, v158
    v_add_u32 v154, 6, v152
    v_mul_u32_u24 v155, v154, v2
    v_mul_u32_u24 v156, v154, v153
    v_cvt_f32_u32 v155, v155
    v_mul_f32 v154, 0x3b000000, v155
    v_cos_f32 v157, v154
    v_sin_f32 v158, v154
    v_mul_f32 v155, 0x3d000000, v155
    v_mul_f32 v107, s6, v157
    v_mul_f32 v111, s6, v158
    v_mul_f32 v123, s7, v157
    v_mul_f32 v127, s7, v158
    v_cos_f32 v157, v155
    v_sin_f32 v158, v155
    s_nop 0
    v_cvt_pk_bf16_f32 v91, v157, v158
    v_cvt_f32_u32 v156, v156
    v_mul_f32 v156, 0x3d000000, v156
    v_cos_f32 v157, v156
    v_sin_f32 v158, v156
    s_nop 0
    v_cvt_pk_bf16_f32 v95, v157, v158
    v_add_u32 v154, 1, v152
    v_mul_u32_u24 v155, v154, v2
    v_mul_u32_u24 v156, v154, v153
    v_cvt_f32_u32 v155, v155
    v_mul_f32 v154, 0x3b000000, v155
    v_cos_f32 v157, v154
    v_sin_f32 v158, v154
    v_mul_f32 v155, 0x3d000000, v155
    v_mul_f32 v112, s6, v157
    v_mul_f32 v116, s6, v158
    v_mul_f32 v128, s7, v157
    v_mul_f32 v132, s7, v158
    v_cos_f32 v157, v155
    v_sin_f32 v158, v155
    s_nop 0
    v_cvt_pk_bf16_f32 v96, v157, v158
    v_cvt_f32_u32 v156, v156
    v_mul_f32 v156, 0x3d000000, v156
    v_cos_f32 v157, v156
    v_sin_f32 v158, v156
    s_nop 0
    v_cvt_pk_bf16_f32 v100, v157, v158
    v_add_u32 v154, 3, v152
    v_mul_u32_u24 v155, v154, v2
    v_mul_u32_u24 v156, v154, v153
    v_cvt_f32_u32 v155, v155
    v_mul_f32 v154, 0x3b000000, v155
    v_cos_f32 v157, v154
    v_sin_f32 v158, v154
    v_mul_f32 v155, 0x3d000000, v155
    v_mul_f32 v113, s6, v157
    v_mul_f32 v117, s6, v158
    v_mul_f32 v129, s7, v157
    v_mul_f32 v133, s7, v158
    v_cos_f32 v157, v155
    v_sin_f32 v158, v155
    s_nop 0
    v_cvt_pk_bf16_f32 v97, v157, v158
    v_cvt_f32_u32 v156, v156
    v_mul_f32 v156, 0x3d000000, v156
    v_cos_f32 v157, v156
    v_sin_f32 v158, v156
    s_nop 0
    v_cvt_pk_bf16_f32 v101, v157, v158
    v_add_u32 v154, 5, v152
    v_mul_u32_u24 v155, v154, v2
    v_mul_u32_u24 v156, v154, v153
    v_cvt_f32_u32 v155, v155
    v_mul_f32 v154, 0x3b000000, v155
    v_cos_f32 v157, v154
    v_sin_f32 v158, v154
    v_mul_f32 v155, 0x3d000000, v155
    v_mul_f32 v114, s6, v157
    v_mul_f32 v118, s6, v158
    v_mul_f32 v130, s7, v157
    v_mul_f32 v134, s7, v158
    v_cos_f32 v157, v155
    v_sin_f32 v158, v155
    s_nop 0
    v_cvt_pk_bf16_f32 v98, v157, v158
    v_cvt_f32_u32 v156, v156
    v_mul_f32 v156, 0x3d000000, v156
    v_cos_f32 v157, v156
    v_sin_f32 v158, v156
    s_nop 0
    v_cvt_pk_bf16_f32 v102, v157, v158
    v_add_u32 v154, 7, v152
    v_mul_u32_u24 v155, v154, v2
    v_mul_u32_u24 v156, v154, v153
    v_cvt_f32_u32 v155, v155
    v_mul_f32 v154, 0x3b000000, v155
    v_cos_f32 v157, v154
    v_sin_f32 v158, v154
    v_mul_f32 v155, 0x3d000000, v155
    v_mul_f32 v115, s6, v157
    v_mul_f32 v119, s6, v158
    v_mul_f32 v131, s7, v157
    v_mul_f32 v135, s7, v158
    v_cos_f32 v157, v155
    v_sin_f32 v158, v155
    s_nop 0
    v_cvt_pk_bf16_f32 v99, v157, v158
    v_cvt_f32_u32 v156, v156
    v_mul_f32 v156, 0x3d000000, v156
    v_cos_f32 v157, v156
    v_sin_f32 v158, v156
    s_nop 0
    v_cvt_pk_bf16_f32 v103, v157, v158
    s_sub_u32 s61, 256, s58
    s_and_b32 s61, s61, 255
    s_lshl_b32 s61, s61, 13
    s_lshl_b32 s62, s58, 13
    v_mov_b32 v5, s61
    v_mov_b32 v152, s62
    v_cndmask_b32 v5, v5, v152, vcc
    v_lshl_add_u32 v5, v2, 3, v5
    v_and_b32 v152, 1, v3
    v_lshl_add_u32 v5, v152, 12, v5
    s_lshl_b32 s14, s3, 7
    s_add_u32 s14, s14, 0x200000
    v_lshrrev_b32 v152, 3, v2
    v_bfe_u32 v153, v2, 2, 1
    v_xor_b32 v153, v153, v152
    v_lshl_add_u32 v152, v153, 1, v152
    s_lshr_b32 s60, s3, 1
    v_xor_b32 v153, s60, v152
    v_lshlrev_b32 v153, 4, v153
    v_lshl_add_u32 v153, v2, 6, v153
    v_lshl_add_u32 v153, v3, 12, v153
    s_and_b32 s60, s3, 1
    s_lshl_b32 s60, s60, 3
    v_add_u32 v6, s60, v153
    v_xor_b32 v152, v152, v3
    v_lshlrev_b32 v152, 4, v152
    v_lshl_add_u32 v152, v2, 6, v152
    s_lshl_b32 s60, s3, 11
    v_add_u32 v7, s60, v152
    v_mov_b32 v159, 0x00010001
    s_cmp_lg_u32 s3, 0
    s_cbranch_scc1 L_p2c
    s_lshl_b32 s60, s10, 8
    s_add_u32 s60, s60, 0x4000
    v_lshlrev_b32 v161, 2, v0
L_pf:
    v_mov_b32 v162, 0
    buffer_atomic_or v162, v161, s[36:39], s60 offen sc0 sc1
    s_waitcnt vmcnt(0)
    v_cmp_ne_u32 vcc, s59, v162
    s_nop 0
    s_cbranch_vccz L_pf_ok
    s_sleep 1
    s_sub_u32 s88, s88, 1
    s_cbranch_scc0 L_pf
    s_mov_b32 s88, 0
L_pf_ok:
L_p2c:
    s_barrier
L_pl:
    buffer_load_dwordx2 v[8:9], v5, s[36:39], s14 offen offset:0 sc1
    buffer_load_dwordx2 v[10:11], v5, s[36:39], s14 offen offset:1024 sc1
    buffer_load_dwordx2 v[12:13], v5, s[36:39], s14 offen offset:2048 sc1
    buffer_load_dwordx2 v[14:15], v5, s[36:39], s14 offen offset:3072 sc1
    s_waitcnt vmcnt(0)
    v_xor_b32 v152, s89, v8
    v_bitop3_b32 v152, v9, s89, v152 bitop3:0xbe
    v_bitop3_b32 v152, v10, s89, v152 bitop3:0xbe
    v_bitop3_b32 v152, v11, s89, v152 bitop3:0xbe
    v_bitop3_b32 v152, v12, s89, v152 bitop3:0xbe
    v_bitop3_b32 v152, v13, s89, v152 bitop3:0xbe
    v_bitop3_b32 v152, v14, s89, v152 bitop3:0xbe
    v_bitop3_b32 v152, v15, s89, v152 bitop3:0xbe
    v_and_b32 v152, v159, v152
    v_cmp_ne_u32 vcc, 0, v152
    v_mov_b32 v16, v8
    v_mov_b32 v17, v10
    v_mov_b32 v18, v12
    v_mov_b32 v19, v14
    v_mov_b32 v20, v9
    v_mov_b32 v21, v11
    v_mov_b32 v22, v13
    v_mov_b32 v23, v15
    s_cbranch_vccz L_pl_ok
    s_sleep 1
    s_sub_u32 s88, s88, 1
    s_cbranch_scc0 L_pl
    s_mov_b32 s88, 0
L_pl_ok:
    v_mfma_f32_16x16x32_bf16 v[24:27], v[64:67], v[16:19], 0
    v_mfma_f32_16x16x32_bf16 v[28:31], v[68:71], v[16:19], 0
    v_mfma_f32_16x16x32_bf16 v[32:35], v[64:67], v[20:23], 0
    v_mfma_f32_16x16x32_bf16 v[36:39], v[68:71], v[20:23], 0
    s_nop 5
    v_cvt_pk_bf16_f32 v8, v24, v28
    s_nop 0
    v_cvt_pk_bf16_f32 v9, v32, v36
    ds_write_b64 v6, v[8:9] offset:0
    v_cvt_pk_bf16_f32 v10, v25, v29
    v_cvt_pk_bf16_f32 v11, v33, v37
    ds_write_b64 v6, v[10:11] offset:1024
    v_cvt_pk_bf16_f32 v12, v26, v30
    v_cvt_pk_bf16_f32 v13, v34, v38
    ds_write_b64 v6, v[12:13] offset:2048
    v_cvt_pk_bf16_f32 v14, v27, v31
    v_cvt_pk_bf16_f32 v15, v35, v39
    ds_write_b64 v6, v[14:15] offset:3072
    s_lshl_b32 s60, s92, 3
    s_or_b32 s60, s60, s3
    s_cmp_lg_u32 s60, 7
    s_cbranch_scc1 L_p2d
    s_lshl_b32 s60, s10, 11
    s_add_u32 s60, s60, 0x40000
    v_lshlrev_b32 v166, 3, v0
    v_mov_b32 v167, 1024
L_pk3:
    buffer_load_dwordx2 v[160:161], v166, s[36:39], s60 offen sc1
    buffer_load_dwordx2 v[162:163], v166, s[36:39], s60 offen offset:512 sc1
    buffer_load_dwordx2 v[164:165], v167, s[36:39], s60 offen sc1
    s_waitcnt vmcnt(0)
    v_xor_b32 v161, s59, v161
    v_xor_b32 v163, s59, v163
    v_xor_b32 v165, s59, v165
    v_or3_b32 v161, v161, v163, v165
    v_cmp_ne_u32 vcc, 0, v161
    v_max3_u32 v160, v160, v162, v164
    s_nop 0
    s_cbranch_vccz L_pk3_ok
    s_sleep 1
    s_sub_u32 s88, s88, 1
    s_cbranch_scc0 L_pk3
    s_mov_b32 s88, 0
L_pk3_ok:
    v_max_u32_dpp v160, v160, v160 row_ror:8 row_mask:0xf bank_mask:0xf
    s_nop 1
    v_max_u32_dpp v160, v160, v160 row_ror:4 row_mask:0xf bank_mask:0xf
    s_nop 1
    v_max_u32_dpp v160, v160, v160 row_ror:2 row_mask:0xf bank_mask:0xf
    s_nop 1
    v_max_u32_dpp v160, v160, v160 row_ror:1 row_mask:0xf bank_mask:0xf
    s_nop 0
    v_readlane_b32 s95, v160, 0
    v_readlane_b32 s60, v160, 16
    v_readlane_b32 s61, v160, 32
    v_readlane_b32 s62, v160, 48
    s_max_u32 s95, s95, s60
    s_max_u32 s61, s61, s62
    s_max_u32 s95, s95, s61
    s_and_b32 s95, s95, 2047
    v_mov_b32 v160, 40964
    v_mov_b32 v161, s95
    ds_write_b32 v160, v161
L_p2d:
    s_waitcnt lgkmcnt(0)
    s_barrier
    ds_read_b128 v[16:19], v7 offset:0
    ds_read_b128 v[20:23], v7 offset:1024
    v_mov_b32 v160, 40964
    ds_read_b32 v161, v160
    s_waitcnt lgkmcnt(0)
    v_mfma_f32_16x16x32_bf16 v[24:27], v[16:19], v[72:75], 0
    v_mfma_f32_16x16x32_bf16 v[28:31], v[16:19], v[76:79], 0
    v_mfma_f32_16x16x32_bf16 v[32:35], v[20:23], v[72:75], 0
    v_mfma_f32_16x16x32_bf16 v[36:39], v[20:23], v[76:79], 0
    v_mfma_f32_16x16x32_bf16 v[40:43], v[16:19], v[80:83], 0
    v_mfma_f32_16x16x32_bf16 v[44:47], v[16:19], v[84:87], 0
    v_mfma_f32_16x16x32_bf16 v[48:51], v[20:23], v[80:83], 0
    v_mfma_f32_16x16x32_bf16 v[52:55], v[20:23], v[84:87], 0
    v_readfirstlane_b32 s95, v161
    v_mul_f32 v152, v24, v104
    v_mul_f32 v164, v28, v104
    v_mul_f32 v153, v25, v105
    v_mul_f32 v165, v29, v105
    v_mul_f32 v154, v26, v106
    v_mul_f32 v166, v30, v106
    v_mul_f32 v155, v27, v107
    v_mul_f32 v167, v31, v107
    v_fmac_f32 v152, v28, v108
    v_fma_f32 v164, -v24, v108, v164
    v_fmac_f32 v153, v29, v109
    v_fma_f32 v165, -v25, v109, v165
    v_fmac_f32 v154, v30, v110
    v_fma_f32 v166, -v26, v110, v166
    v_fmac_f32 v155, v31, v111
    v_fma_f32 v167, -v27, v111, v167
    v_cvt_pk_bf16_f32 v168, v152, v164
    v_cvt_pk_bf16_f32 v169, v153, v165
    v_cvt_pk_bf16_f32 v170, v154, v166
    v_cvt_pk_bf16_f32 v171, v155, v167
    v_mul_f32 v152, v32, v112
    v_mul_f32 v164, v36, v112
    v_mul_f32 v153, v33, v113
    v_mul_f32 v165, v37, v113
    v_mul_f32 v154, v34, v114
    v_mul_f32 v166, v38, v114
    v_mul_f32 v155, v35, v115
    v_mul_f32 v167, v39, v115
    v_fmac_f32 v152, v36, v116
    v_fma_f32 v164, -v32, v116, v164
    v_fmac_f32 v153, v37, v117
    v_fma_f32 v165, -v33, v117, v165
    v_fmac_f32 v154, v38, v118
    v_fma_f32 v166, -v34, v118, v166
    v_fmac_f32 v155, v39, v119
    v_fma_f32 v167, -v35, v119, v167
    v_cvt_pk_bf16_f32 v172, v152, v164
    v_cvt_pk_bf16_f32 v173, v153, v165
    v_cvt_pk_bf16_f32 v174, v154, v166
    v_cvt_pk_bf16_f32 v175, v155, v167
    v_mfma_f32_16x16x32_bf16 v[136:139], v[168:171], v[88:91], v[136:139]
    v_mfma_f32_16x16x32_bf16 v[140:143], v[168:171], v[92:95], v[140:143]
    v_mfma_f32_16x16x32_bf16 v[136:139], v[172:175], v[96:99], v[136:139]
    v_mfma_f32_16x16x32_bf16 v[140:143], v[172:175], v[100:103], v[140:143]
    v_mul_f32 v152, v40, v120
    v_mul_f32 v164, v44, v120
    v_mul_f32 v153, v41, v121
    v_mul_f32 v165, v45, v121
    v_mul_f32 v154, v42, v122
    v_mul_f32 v166, v46, v122
    v_mul_f32 v155, v43, v123
    v_mul_f32 v167, v47, v123
    v_fmac_f32 v152, v44, v124
    v_fma_f32 v164, -v40, v124, v164
    v_fmac_f32 v153, v45, v125
    v_fma_f32 v165, -v41, v125, v165
    v_fmac_f32 v154, v46, v126
    v_fma_f32 v166, -v42, v126, v166
    v_fmac_f32 v155, v47, v127
    v_fma_f32 v167, -v43, v127, v167
    v_cvt_pk_bf16_f32 v176, v152, v164
    v_cvt_pk_bf16_f32 v177, v153, v165
    v_cvt_pk_bf16_f32 v178, v154, v166
    v_cvt_pk_bf16_f32 v179, v155, v167
    v_mul_f32 v152, v48, v128
    v_mul_f32 v164, v52, v128
    v_mul_f32 v153, v49, v129
    v_mul_f32 v165, v53, v129
    v_mul_f32 v154, v50, v130
    v_mul_f32 v166, v54, v130
    v_mul_f32 v155, v51, v131
    v_mul_f32 v167, v55, v131
    v_fmac_f32 v152, v52, v132
    v_fma_f32 v164, -v48, v132, v164
    v_fmac_f32 v153, v53, v133
    v_fma_f32 v165, -v49, v133, v165
    v_fmac_f32 v154, v54, v134
    v_fma_f32 v166, -v50, v134, v166
    v_fmac_f32 v155, v55, v135
    v_fma_f32 v167, -v51, v135, v167
    v_cvt_pk_bf16_f32 v180, v152, v164
    v_cvt_pk_bf16_f32 v181, v153, v165
    v_cvt_pk_bf16_f32 v182, v154, v166
    v_cvt_pk_bf16_f32 v183, v155, v167
    v_mfma_f32_16x16x32_bf16 v[144:147], v[176:179], v[88:91], v[144:147]
    v_mfma_f32_16x16x32_bf16 v[148:151], v[176:179], v[92:95], v[148:151]
    v_mfma_f32_16x16x32_bf16 v[144:147], v[180:183], v[96:99], v[144:147]
    v_mfma_f32_16x16x32_bf16 v[148:151], v[180:183], v[100:103], v[148:151]
    s_cmp_eq_u32 s92, 1
    s_cbranch_scc1 L_fin2
    v_cvt_pk_bf16_f32 v8, v136, v137
    v_cvt_pk_bf16_f32 v9, v138, v139
    v_cvt_pk_bf16_f32 v10, v140, v141
    v_cvt_pk_bf16_f32 v11, v142, v143
    s_cmp_eq_u32 s90, s95
    s_cbranch_scc1 L_sk4
    buffer_store_dwordx2 v[8:9], v4, s[40:43], s12 offen offset:0 sc1
    buffer_store_dwordx2 v[10:11], v4, s[40:43], s12 offen offset:512 sc1
L_sk4:
    v_cvt_pk_bf16_f32 v12, v144, v145
    v_cvt_pk_bf16_f32 v13, v146, v147
    v_cvt_pk_bf16_f32 v14, v148, v149
    v_cvt_pk_bf16_f32 v15, v150, v151
    s_cmp_eq_u32 s91, s95
    s_cbranch_scc1 L_sk5
    s_and_b32 s60, s58, 127
    s_cbranch_scc0 L_sk5
    buffer_store_dwordx2 v[12:13], v4, s[40:43], s13 offen offset:0 sc1
    buffer_store_dwordx2 v[14:15], v4, s[40:43], s13 offen offset:512 sc1
L_sk5:
    s_endpgm
L_fin2:
    s_cmp_eq_u32 s3, 7
    s_cbranch_scc1 L_fin3
    s_mul_i32 s60, s56, 14336
    s_lshl_b32 s61, s3, 11
    s_add_u32 s60, s60, s61
    s_add_u32 s60, s60, 0x10000
    v_lshlrev_b32 v160, 4, v0
L_pp:
    buffer_load_dwordx4 v[8:11], v160, s[36:39], s60 offen sc1
    buffer_load_dwordx4 v[12:15], v160, s[36:39], s60 offen offset:1024 sc1
    s_waitcnt vmcnt(0)
    v_xor_b32 v9, s59, v9
    v_bitop3_b32 v9, v11, s59, v9 bitop3:0xbe
    v_bitop3_b32 v9, v13, s59, v9 bitop3:0xbe
    v_bitop3_b32 v9, v15, s59, v9 bitop3:0xbe
    v_cmp_ne_u32 vcc, 0, v9
    s_nop 0
    s_cbranch_vccz L_pp_ok
    s_sleep 1
    s_sub_u32 s88, s88, 1
    s_cbranch_scc0 L_pp
    s_mov_b32 s88, 0
L_pp_ok:
    v_lshlrev_b32 v16, 16, v8
    v_lshlrev_b32 v20, 16, v12
    v_and_b32 v17, 0xffff0000, v8
    v_and_b32 v21, 0xffff0000, v12
    v_lshlrev_b32 v18, 16, v10
    v_lshlrev_b32 v22, 16, v14
    v_and_b32 v19, 0xffff0000, v10
    v_and_b32 v23, 0xffff0000, v14
    v_add_f32 v16, v16, v20
    v_add_f32 v17, v17, v21
    v_add_f32 v18, v18, v22
    v_add_f32 v19, v19, v23
    v_permlane32_swap_b32 v16, v17
    s_nop 0
    v_permlane32_swap_b32 v18, v19
    v_add_f32 v16, v16, v17
    v_add_f32 v18, v18, v19
    s_nop 1
    v_permlane16_swap_b32 v16, v18
    v_add_f32 v16, v16, v18
    v_and_b32 v20, 1, v3
    v_lshrrev_b32 v21, 1, v3
    v_lshl_add_u32 v20, v20, 1, v21
    v_lshl_add_u32 v20, v2, 2, v20
    s_lshl_b32 s60, s3, 8
    s_add_u32 s60, s60, 41216
    v_lshl_add_u32 v20, v20, 2, s60
    ds_write_b32 v20, v16
    s_waitcnt lgkmcnt(0)
L_fin3:
    s_barrier
    s_cmp_lg_u32 s3, s93
    s_cbranch_scc1 L_fin4
    v_and_b32 v20, 3, v2
    v_lshlrev_b32 v20, 6, v20
    v_lshl_add_u32 v20, v3, 4, v20
    ds_read_b128 v[24:27], v20 offset:41216
    ds_read_b128 v[28:31], v20 offset:41472
    ds_read_b128 v[32:35], v20 offset:41728
    ds_read_b128 v[36:39], v20 offset:41984
    ds_read_b128 v[40:43], v20 offset:42240
    ds_read_b128 v[44:47], v20 offset:42496
    ds_read_b128 v[48:51], v20 offset:42752
    s_lshr_b32 s60, s56, 2
    s_lshl1_add_u32 s60, s94, s60
    s_cmp_lg_u32 s60, 0
    s_cbranch_scc1 L_acc6
    v_mov_b32 v16, v136
    v_mov_b32 v17, v137
    v_mov_b32 v18, v138
    v_mov_b32 v19, v139
L_acc6:
    s_cmp_lg_u32 s60, 1
    s_cbranch_scc1 L_acc7
    v_mov_b32 v16, v140
    v_mov_b32 v17, v141
    v_mov_b32 v18, v142
    v_mov_b32 v19, v143
L_acc7:
    s_cmp_lg_u32 s60, 2
    s_cbranch_scc1 L_acc8
    v_mov_b32 v16, v144
    v_mov_b32 v17, v145
    v_mov_b32 v18, v146
    v_mov_b32 v19, v147
L_acc8:
    s_cmp_lg_u32 s60, 3
    s_cbranch_scc1 L_acc9
    v_mov_b32 v16, v148
    v_mov_b32 v17, v149
    v_mov_b32 v18, v150
    v_mov_b32 v19, v151
L_acc9:
    s_cmp_eq_u32 s94, 1
    s_cselect_b32 s6, s7, s6
    s_cselect_b32 s8, s9, s8
    v_sub_f32 v21, 1.0, s6
    v_mul_f32 v21, s8, v21
    s_waitcnt lgkmcnt(0)
    v_add_f32 v28, v28, v32
    v_add_f32 v29, v29, v33
    v_add_f32 v30, v30, v34
    v_add_f32 v31, v31, v35
    v_add_f32 v36, v36, v40
    v_add_f32 v37, v37, v41
    v_add_f32 v38, v38, v42
    v_add_f32 v39, v39, v43
    v_add_f32 v44, v44, v48
    v_add_f32 v45, v45, v49
    v_add_f32 v46, v46, v50
    v_add_f32 v47, v47, v51
    v_add_f32 v24, v24, v28
    v_add_f32 v36, v36, v44
    v_add_f32 v25, v25, v29
    v_add_f32 v37, v37, v45
    v_add_f32 v26, v26, v30
    v_add_f32 v38, v38, v46
    v_add_f32 v27, v27, v31
    v_add_f32 v39, v39, v47
    v_add_f32 v24, v24, v36
    v_add_f32 v25, v25, v37
    v_add_f32 v26, v26, v38
    v_add_f32 v27, v27, v39
    v_fmac_f32 v16, v21, v24
    v_fmac_f32 v17, v21, v25
    v_fmac_f32 v18, v21, v26
    v_fmac_f32 v19, v21, v27
    v_cvt_pk_bf16_f32 v16, v16, v17
    v_cvt_pk_bf16_f32 v17, v18, v19
    s_lshl_b32 s60, s95, 10
    s_lshr_b32 s61, s56, 2
    s_lshl_b32 s61, s61, 9
    s_add_u32 s60, s60, s61
    s_and_b32 s61, s56, 3
    s_lshl_b32 s61, s61, 2
    s_lshl_b32 exec_lo, 0x000f000f, s61
    s_mov_b32 exec_hi, exec_lo
    buffer_store_dwordx2 v[16:17], v4, s[40:43], s60 offen sc1
    s_cmp_lg_u32 s56, 0
    s_cbranch_scc1 L_fin4
    s_mov_b64 exec, 1
    v_mov_b32 v20, 0
    v_mov_b32 v21, s59
    buffer_store_dword v21, v20, s[36:39], 0 offen sc1
L_fin4:
    s_endpgm
L_end:
    s_endpgm
.section .rodata,"a"
.p2align 6
.amdhsa_kernel gated_mix__spectral_fnet__moe_arch_mod__prompt_kernel
  .amdhsa_next_free_vgpr 184
  .amdhsa_next_free_sgpr 96
  .amdhsa_accum_offset 184
  .amdhsa_group_segment_fixed_size 0
  .amdhsa_kernarg_size 112
  .amdhsa_user_sgpr_count 2
  .amdhsa_user_sgpr_kernarg_segment_ptr 1
  .amdhsa_system_sgpr_workgroup_id_x 1
.end_amdhsa_kernel
```

```asm
; @launch grid=(256,1,1) block=(512,1,1) lds=100352
.amdgcn_target "amdgcn-amd-amdhsa--gfx950"
.text
.globl gated_mix__spectral_fnet__moe_arch_mod__prompt_kernel
.p2align 8
.type gated_mix__spectral_fnet__moe_arch_mod__prompt_kernel,@function
gated_mix__spectral_fnet__moe_arch_mod__prompt_kernel:
    s_cmp_ge_u32 s2, 256
    s_cbranch_scc1 L_end
    s_load_dwordx2 s[4:5], s[0:1], 0
    s_load_dwordx16 s[16:31], s[0:1], 48
    s_getpc_b64 s[10:11]
L_pc:
    v_lshrrev_b32 v1, 6, v0
    s_lshr_b32 s57, s2, 3
    v_lshl_add_u32 v4, v0, 5, s57
    v_lshlrev_b32 v4, 7, v4
    v_cmp_gt_u32 vcc, L_tabend - L_pc, v4
    s_nop 0
    s_and_saveexec_b64 s[12:13], vcc
    s_cbranch_execz L_nocpf
    global_load_dword v249, v4, s[10:11]
L_nocpf:
    s_mov_b64 exec, s[12:13]
    v_and_b32 v0, 63, v0
    v_readfirstlane_b32 s3, v1
    v_and_b32 v2, 15, v0
    v_lshrrev_b32 v3, 4, v0
    s_add_u32 s10, s10, L_tab - L_pc
    s_addc_u32 s11, s11, 0
    s_and_b32 s56, s2, 7
    s_mov_b32 s90, 400000
    s_cmp_lt_u32 s57, 16
    s_cbranch_scc1 L_low
    s_sub_u32 s57, s57, 16
    s_lshl4_add_u32 s9, s56, s57
    s_lshl4_add_u32 s58, s57, s56
    s_sub_u32 s62, s58, 120
    s_cmp_lt_u32 s9, 8
    s_cselect_b32 s62, s58, s62
    s_cmp_lt_u32 s9, 16
    s_cselect_b32 s58, s62, s58
L_a:
    s_cmp_ge_u32 s3, 4
    s_cbranch_scc1 L_p1w
    s_lshl2_add_u32 s60, s57, s3
    s_lshl_b32 s60, s60, 5
    s_add_u32 s60, s60, s56
    s_lshl_b32 s12, s60, 10
    s_cmp_eq_u32 s58, 128
    s_cselect_b32 s12, 0x40000000, s12
    s_add_u32 s13, s12, 8192
    s_add_u32 s14, s12, 16384
    s_add_u32 s15, s12, 24576
    v_lshlrev_b32 v107, 4, v0
    s_waitcnt lgkmcnt(0)
    s_load_dword s59, s[30:31], 0
    s_mov_b32 s32, s4
    s_mov_b32 s33, s5
    s_mov_b32 s34, 0x200000
    s_mov_b32 s35, 0x20000
    s_mov_b32 s36, s30
    s_mov_b32 s37, s31
    s_mov_b32 s38, 0x400000
    s_mov_b32 s39, 0x20000
    buffer_load_dwordx4 v[8:11], v107, s[32:35], s12 offen
    buffer_load_dwordx4 v[12:15], v107, s[32:35], s13 offen
    buffer_load_dwordx4 v[16:19], v107, s[32:35], s14 offen
    buffer_load_dwordx4 v[20:23], v107, s[32:35], s15 offen
    s_mov_b32 s44, s16
    s_mov_b32 s45, s17
    s_mov_b32 s46, 0x400
    s_mov_b32 s47, 0x20000
    buffer_load_dwordx4 v[24:27], v107, s[44:47], 0 offen
    v_and_b32 v36, 1, v3
    v_lshrrev_b32 v108, 1, v3
    v_lshl_add_u32 v36, v36, 1, v108
    v_lshl_add_u32 v36, v36, 3, s60
    v_mov_b32 v108, 43008
    v_mov_b32 v109, 1
    s_mov_b32 s8, 0xfffff800
    s_branch L_a2c
L_p1w:
    v_lshlrev_b32 v107, 19, v3
    v_bfe_u32 v108, v0, 2, 2
    v_lshl_add_u32 v107, v108, 13, v107
    v_and_b32 v109, 3, v0
    v_lshl_add_u32 v107, v109, 4, v107
    s_sub_u32 s62, s3, 4
    s_lshl_b32 s12, s62, 15
    s_lshl_b32 s61, s56, 10
    s_add_u32 s12, s12, s61
    s_lshl_b32 s61, s57, 6
    s_add_u32 s12, s12, s61
    s_cmp_eq_u32 s58, 128
    s_cselect_b32 s12, 0x40000000, s12
    s_add_u32 s13, s12, 131072
    s_add_u32 s14, s12, 262144
    s_add_u32 s15, s12, 393216
    v_mov_b32 v96, 43008
    v_mov_b32 v98, 0
    v_mov_b32 v99, 0
    ds_write_b64 v96, v[98:99]
    s_waitcnt lgkmcnt(0)
    s_load_dword s59, s[30:31], 0
    s_mov_b32 s32, s4
    s_mov_b32 s33, s5
    s_mov_b32 s34, 0x200000
    s_mov_b32 s35, 0x20000
    s_mov_b32 s36, s30
    s_mov_b32 s37, s31
    s_mov_b32 s38, 0x400000
    s_mov_b32 s39, 0x20000
    v_lshlrev_b32 v96, 2, v3
    v_cvt_f32_u32 v96, v96
    v_cvt_f32_u32 v97, v2
    v_mul_f32 v97, 0x3d800000, v97
    v_mul_f32 v96, v96, v97
    v_cos_f32 v102, v96
    v_sin_f32 v103, v96
    v_add_f32 v96, v96, v97
    v_cvt_pk_bf16_f32 v40, v102, v103
    v_cvt_pk_bf16_f32 v44, -v103, v102
    v_cos_f32 v102, v96
    v_sin_f32 v103, v96
    v_add_f32 v96, v96, v97
    v_cvt_pk_bf16_f32 v41, v102, v103
    v_cvt_pk_bf16_f32 v45, -v103, v102
    v_cos_f32 v102, v96
    v_sin_f32 v103, v96
    v_add_f32 v96, v96, v97
    v_cvt_pk_bf16_f32 v42, v102, v103
    v_cvt_pk_bf16_f32 v46, -v103, v102
    v_cos_f32 v102, v96
    v_sin_f32 v103, v96
    s_nop 0
    v_cvt_pk_bf16_f32 v43, v102, v103
    v_cvt_pk_bf16_f32 v47, -v103, v102
    v_lshrrev_b32 v96, 1, v109
    v_mul_u32_u24 v96, 3, v96
    v_lshlrev_b32 v97, 1, v3
    v_and_b32 v97, 2, v97
    v_xor_b32 v96, v96, v97
    v_xor_b32 v96, s62, v96
    v_lshl_add_u32 v96, v96, 2, v108
    v_lshlrev_b32 v96, 2, v96
    v_lshl_add_u32 v96, v109, 8, v96
    v_lshl_add_u32 v96, v3, 12, v96
    v_and_b32 v97, 1, v109
    v_lshl_add_u32 v48, v97, 6, v96
    v_xor_b32 v49, 64, v48
    v_add_u32 v50, 128, v48
    v_add_u32 v51, 128, v49
L_a2c:
    s_xor_b32 s98, s3, 4
    v_lshl_add_u32 v96, v2, 4, s98
    v_sub_u32 v97, 256, v96
    s_cmp_lg_u32 s98, 0
    s_cbranch_scc1 L_a2d
    v_cmp_gt_u32 vcc, 8, v2
    v_subrev_u32 v98, 120, v96
    s_nop 0
    v_cndmask_b32 v96, v98, v96, vcc
    v_sub_u32 v97, 256, v96
    v_cmp_eq_u32 vcc, 0, v2
    v_mov_b32 v98, 128
    s_nop 0
    v_cndmask_b32 v97, v97, v98, vcc
L_a2d:
    v_lshlrev_b32 v98, 2, v3
    v_cvt_f32_u32 v98, v98
    v_cvt_f32_u32 v96, v96
    v_mul_f32 v96, 0x3b800000, v96
    v_mul_f32 v99, v98, v96
    v_cos_f32 v102, v99
    v_sin_f32 v103, v99
    v_add_f32 v99, v99, v96
    v_cvt_pk_bf16_f32 v112, v102, v103
    v_cvt_pk_bf16_f32 v116, -v103, v102
    v_cos_f32 v102, v99
    v_sin_f32 v103, v99
    v_add_f32 v99, v99, v96
    v_cvt_pk_bf16_f32 v113, v102, v103
    v_cvt_pk_bf16_f32 v117, -v103, v102
    v_cos_f32 v102, v99
    v_sin_f32 v103, v99
    v_add_f32 v99, v99, v96
    v_cvt_pk_bf16_f32 v114, v102, v103
    v_cvt_pk_bf16_f32 v118, -v103, v102
    v_cos_f32 v102, v99
    v_sin_f32 v103, v99
    s_nop 0
    v_cvt_pk_bf16_f32 v115, v102, v103
    v_cvt_pk_bf16_f32 v119, -v103, v102
    v_cvt_f32_u32 v97, v97
    v_mul_f32 v97, 0x3b800000, v97
    v_mul_f32 v99, v98, v97
    v_cos_f32 v102, v99
    v_sin_f32 v103, v99
    v_add_f32 v99, v99, v97
    v_cvt_pk_bf16_f32 v120, v102, v103
    v_cvt_pk_bf16_f32 v124, -v103, v102
    v_cos_f32 v102, v99
    v_sin_f32 v103, v99
    v_add_f32 v99, v99, v97
    v_cvt_pk_bf16_f32 v121, v102, v103
    v_cvt_pk_bf16_f32 v125, -v103, v102
    v_cos_f32 v102, v99
    v_sin_f32 v103, v99
    v_add_f32 v99, v99, v97
    v_cvt_pk_bf16_f32 v122, v102, v103
    v_cvt_pk_bf16_f32 v126, -v103, v102
    v_cos_f32 v102, v99
    v_sin_f32 v103, v99
    s_nop 0
    v_cvt_pk_bf16_f32 v123, v102, v103
    v_cvt_pk_bf16_f32 v127, -v103, v102
    s_cmp_lg_u32 s98, 0
    s_cbranch_scc1 L_a2e
    s_mov_b32 vcc_lo, 0x00ff00ff
    s_mov_b32 vcc_hi, 0x00ff00ff
    v_cndmask_b32_e64 v128, v112, 0, vcc
    v_cndmask_b32 v112, 0, v112, vcc
    v_cndmask_b32 v136, 0, v120, vcc
    v_cndmask_b32_e64 v120, v120, 0, vcc
    v_cndmask_b32_e64 v129, v113, 0, vcc
    v_cndmask_b32 v113, 0, v113, vcc
    v_cndmask_b32 v137, 0, v121, vcc
    v_cndmask_b32_e64 v121, v121, 0, vcc
    v_cndmask_b32_e64 v130, v114, 0, vcc
    v_cndmask_b32 v114, 0, v114, vcc
    v_cndmask_b32 v138, 0, v122, vcc
    v_cndmask_b32_e64 v122, v122, 0, vcc
    v_cndmask_b32_e64 v131, v115, 0, vcc
    v_cndmask_b32 v115, 0, v115, vcc
    v_cndmask_b32 v139, 0, v123, vcc
    v_cndmask_b32_e64 v123, v123, 0, vcc
    v_cndmask_b32_e64 v132, v116, 0, vcc
    v_cndmask_b32 v116, 0, v116, vcc
    v_cndmask_b32 v140, 0, v124, vcc
    v_cndmask_b32_e64 v124, v124, 0, vcc
    v_cndmask_b32_e64 v133, v117, 0, vcc
    v_cndmask_b32 v117, 0, v117, vcc
    v_cndmask_b32 v141, 0, v125, vcc
    v_cndmask_b32_e64 v125, v125, 0, vcc
    v_cndmask_b32_e64 v134, v118, 0, vcc
    v_cndmask_b32 v118, 0, v118, vcc
    v_cndmask_b32 v142, 0, v126, vcc
    v_cndmask_b32_e64 v126, v126, 0, vcc
    v_cndmask_b32_e64 v135, v119, 0, vcc
    v_cndmask_b32 v119, 0, v119, vcc
    v_cndmask_b32 v143, 0, v127, vcc
    v_cndmask_b32_e64 v127, v127, 0, vcc
L_a2e:
    s_sub_u32 s60, 16, s98
    s_cmp_eq_u32 s98, 0
    s_cselect_b32 s60, 8, s60
    v_bfe_u32 v96, v2, 2, 1
    v_xor_b32 v96, v96, v2
    v_lshrrev_b32 v97, 3, v2
    v_mul_u32_u24 v98, 3, v97
    v_xor_b32 v98, v98, v3
    v_lshlrev_b32 v98, 4, v98
    v_lshl_add_u32 v96, v96, 6, v98
    s_lshl_b32 s61, s98, 3
    s_and_b32 s61, s61, 32
    s_lshl_b32 s62, s98, 10
    s_or_b32 s61, s61, s62
    v_xor_b32 v60, s61, v96
    s_lshl_b32 s61, s60, 3
    s_and_b32 s61, s61, 32
    s_lshl_b32 s62, s60, 10
    s_or_b32 s61, s61, s62
    v_xor_b32 v61, s61, v96
    v_lshlrev_b32 v63, 16, v3
    v_lshl_add_u32 v63, v97, 14, v63
    v_and_b32 v96, 7, v2
    v_lshl_add_u32 v63, v96, 4, v63
    s_lshl_b32 s6, s98, 18
    s_lshl_b32 s61, s56, 11
    s_add_u32 s6, s6, s61
    s_lshl_b32 s61, s57, 7
    s_add_u32 s6, s6, s61
    s_add_u32 s6, s6, 0x200000
    s_add_u32 s7, s6, 32768
    s_waitcnt lgkmcnt(0)
    s_add_u32 s59, s59, 0x9e3779b9
    s_bitcmp1_b32 s59, 0
    s_cselect_b32 s91, 1, 0x10000
    s_xor_b32 s92, s91, 0x10001
    v_mov_b32 v104, s91
    v_mov_b32 v105, s92
    v_mov_b32 v106, 0x00010001
    v_lshlrev_b32 v4, 5, v2
    v_and_b32 v96, 1, v3
    v_lshl_add_u32 v4, v96, 9, v4
    v_lshrrev_b32 v96, 1, v3
    v_lshl_add_u32 v4, v96, 4, v4
    s_lshl_b32 s60, s3, 8
    s_add_u32 s93, s60, s58
    s_sub_u32 s94, 2048, s93
    s_and_b32 s94, s94, 2047
    s_mov_b32 s48, s24
    s_mov_b32 s49, s25
    s_mov_b32 s50, 0x400
    s_mov_b32 s51, 0x20000
    s_cmp_ge_u32 s3, 4
    s_cbranch_scc1 L_p1s
    s_lshl_b32 s60, s9, 3
    s_add_u32 s60, s60, 0x40000
    v_lshlrev_b32 v37, 11, v0
    v_mov_b32 v39, s59
    s_waitcnt vmcnt(1)
    s_barrier
    s_waitcnt vmcnt(0)
    v_dot2_f32_bf16 v32, v8, v24, 0
    v_dot2_f32_bf16 v33, v12, v24, 0
    v_dot2_f32_bf16 v34, v16, v24, 0
    v_dot2_f32_bf16 v35, v20, v24, 0
    v_dot2_f32_bf16 v32, v9, v25, v32
    v_dot2_f32_bf16 v33, v13, v25, v33
    v_dot2_f32_bf16 v34, v17, v25, v34
    v_dot2_f32_bf16 v35, v21, v25, v35
    v_dot2_f32_bf16 v32, v10, v26, v32
    v_dot2_f32_bf16 v33, v14, v26, v33
    v_dot2_f32_bf16 v34, v18, v26, v34
    v_dot2_f32_bf16 v35, v22, v26, v35
    v_dot2_f32_bf16 v32, v11, v27, v32
    v_dot2_f32_bf16 v33, v15, v27, v33
    v_dot2_f32_bf16 v34, v19, v27, v34
    v_dot2_f32_bf16 v35, v23, v27, v35
    s_nop 0
    v_permlane32_swap_b32 v32, v33
    s_nop 0
    v_permlane32_swap_b32 v34, v35
    v_add_f32 v32, v32, v33
    v_add_f32 v34, v34, v35
    s_nop 1
    v_permlane16_swap_b32 v32, v34
    v_add_f32 v32, v32, v34
    s_nop 1
    v_add_f32_dpp v32, v32, v32 row_ror:8 row_mask:0xf bank_mask:0xf
    s_nop 1
    v_add_f32_dpp v32, v32, v32 row_ror:4 row_mask:0xf bank_mask:0xf
    s_nop 1
    v_add_f32_dpp v32, v32, v32 row_ror:2 row_mask:0xf bank_mask:0xf
    s_nop 1
    v_add_f32_dpp v32, v32, v32 row_ror:1 row_mask:0xf bank_mask:0xf
    v_ashrrev_i32 v33, 31, v32
    v_or_b32 v33, 0x80000000, v33
    v_xor_b32 v33, v33, v32
    v_and_or_b32 v33, v33, s8, v36
    s_mov_b32 exec_lo, 0x10001
    s_mov_b32 exec_hi, 0x10001
    ds_max_u32 v108, v33
    s_mov_b64 exec, 1
    ds_add_rtn_u32 v34, v108, v109 offset:4
    s_mov_b64 exec, -1
    ds_read_b32 v38, v108
    s_waitcnt lgkmcnt(0)
    v_readfirstlane_b32 s61, v34
    s_nop 0
    s_cmp_lg_u32 s61, 3
    s_cbranch_scc1 L_b1a
    s_cmp_eq_u32 s58, 128
    s_cbranch_scc1 L_ack128
    buffer_store_dwordx2 v[38:39], v37, s[36:39], s60 offen sc1
    s_mov_b64 exec, -1
    s_branch L_b1a
L_ack128:
    s_mov_b64 exec, 1
    s_movk_i32 s60, 0x1000
    buffer_store_dword v39, v37, s[36:39], s60 offen sc1
    s_mov_b64 exec, -1
L_b1a:
    s_lshl_b32 s12, s93, 10
    s_lshl_b32 s13, s94, 10
    buffer_load_dwordx4 v[232:235], v4, s[32:35], s12 offen
    buffer_load_dwordx4 v[236:239], v4, s[32:35], s13 offen
    buffer_load_dwordx4 v[240:243], v4, s[48:51], 0 offen
    s_branch L_b1
L_p1s:
    s_barrier
    buffer_load_dwordx4 v[8:11], v107, s[32:35], s12 offen
    buffer_load_dwordx4 v[12:15], v107, s[32:35], s13 offen
    buffer_load_dwordx4 v[16:19], v107, s[32:35], s14 offen
    buffer_load_dwordx4 v[20:23], v107, s[32:35], s15 offen
    s_lshl_b32 s63, s98, 1
    s_lshl_b32 s60, s63, 10
    v_lshl_add_u32 v248, v0, 4, s60
    s_add_u32 m0, s60, 32768
    global_load_lds_dwordx4 v248, s[10:11] offset:0
    global_load_lds_dwordx4 v248, s[10:11] offset:1024
    s_and_b32 s63, s98, 1
    s_add_u32 s63, s63, 8
    s_lshl_b32 s60, s63, 10
    v_lshl_add_u32 v248, v0, 4, s60
    s_add_u32 m0, s60, 32768
    global_load_lds_dwordx4 v248, s[10:11] offset:0
    s_lshl_b32 s63, s98, 21
    s_and_b32 s63, s63, 0x200000
    v_mov_b32 v252, 0x3000
    buffer_load_dword v252, v252, s[36:39], s63 offen
    s_waitcnt vmcnt(4)
    v_pk_mov_b32 v[24:25], v[8:9], v[12:13] op_sel:[0,0]
    v_pk_mov_b32 v[26:27], v[16:17], v[20:21] op_sel:[0,0]
    v_pk_mov_b32 v[28:29], v[8:9], v[12:13] op_sel:[1,1]
    v_pk_mov_b32 v[30:31], v[16:17], v[20:21] op_sel:[1,1]
    v_mfma_f32_16x16x32_bf16 v[64:67], v[40:43], v[24:27], 0
    v_mfma_f32_16x16x32_bf16 v[68:71], v[44:47], v[24:27], 0
    v_pk_mov_b32 v[32:33], v[10:11], v[14:15] op_sel:[0,0]
    v_pk_mov_b32 v[34:35], v[18:19], v[22:23] op_sel:[0,0]
    v_mfma_f32_16x16x32_bf16 v[72:75], v[40:43], v[28:31], 0
    v_mfma_f32_16x16x32_bf16 v[76:79], v[44:47], v[28:31], 0
    v_pk_mov_b32 v[36:37], v[10:11], v[14:15] op_sel:[1,1]
    v_pk_mov_b32 v[38:39], v[18:19], v[22:23] op_sel:[1,1]
    v_mfma_f32_16x16x32_bf16 v[80:83], v[40:43], v[32:35], 0
    v_mfma_f32_16x16x32_bf16 v[84:87], v[44:47], v[32:35], 0
    v_mfma_f32_16x16x32_bf16 v[88:91], v[40:43], v[36:39], 0
    v_mfma_f32_16x16x32_bf16 v[92:95], v[44:47], v[36:39], 0
    v_cvt_pk_bf16_f32 v8, v64, v68
    v_cvt_pk_bf16_f32 v9, v65, v69
    ds_write2st64_b32 v48, v8, v9 offset0:0 offset1:4
    v_cvt_pk_bf16_f32 v10, v66, v70
    v_cvt_pk_bf16_f32 v11, v67, v71
    ds_write2st64_b32 v48, v10, v11 offset0:8 offset1:12
    v_cvt_pk_bf16_f32 v12, v72, v76
    v_cvt_pk_bf16_f32 v13, v73, v77
    ds_write2st64_b32 v49, v12, v13 offset0:0 offset1:4
    v_cvt_pk_bf16_f32 v14, v74, v78
    v_cvt_pk_bf16_f32 v15, v75, v79
    ds_write2st64_b32 v49, v14, v15 offset0:8 offset1:12
    v_cvt_pk_bf16_f32 v16, v80, v84
    v_cvt_pk_bf16_f32 v17, v81, v85
    ds_write2st64_b32 v50, v16, v17 offset0:0 offset1:4
    v_cvt_pk_bf16_f32 v18, v82, v86
    v_cvt_pk_bf16_f32 v19, v83, v87
    ds_write2st64_b32 v50, v18, v19 offset0:8 offset1:12
    v_cvt_pk_bf16_f32 v20, v88, v92
    v_cvt_pk_bf16_f32 v21, v89, v93
    ds_write2st64_b32 v51, v20, v21 offset0:0 offset1:4
    v_cvt_pk_bf16_f32 v22, v90, v94
    v_cvt_pk_bf16_f32 v23, v91, v95
    ds_write2st64_b32 v51, v22, v23 offset0:8 offset1:12
    s_lshl_b32 s12, s93, 10
    s_lshl_b32 s13, s94, 10
    buffer_load_dwordx4 v[232:235], v4, s[32:35], s12 offen
    buffer_load_dwordx4 v[236:239], v4, s[32:35], s13 offen
    buffer_load_dwordx4 v[240:243], v4, s[48:51], 0 offen
    s_waitcnt vmcnt(4) lgkmcnt(0)
L_b1:
    s_barrier
    s_cmp_eq_u32 s58, 128
    s_cbranch_scc1 L_nos2
    ds_read_b128 v[52:55], v60
    ds_read_b128 v[56:59], v61
    s_mov_b32 vcc_lo, 0x00ff00ff
    s_mov_b32 vcc_hi, 0x00ff00ff
    s_waitcnt lgkmcnt(1)
    v_mfma_f32_16x16x32_bf16 v[64:67], v[112:115], v[52:55], 0
    v_mfma_f32_16x16x32_bf16 v[68:71], v[116:119], v[52:55], 0
    s_waitcnt lgkmcnt(0)
    v_mfma_f32_16x16x32_bf16 v[72:75], v[120:123], v[56:59], 0
    v_mfma_f32_16x16x32_bf16 v[76:79], v[124:127], v[56:59], 0
    s_cmp_lg_u32 s98, 0
    s_cbranch_scc1 L_s2b
    v_mfma_f32_16x16x32_bf16 v[64:67], v[128:131], v[56:59], v[64:67]
    v_mfma_f32_16x16x32_bf16 v[68:71], v[132:135], v[56:59], v[68:71]
    v_mfma_f32_16x16x32_bf16 v[72:75], v[136:139], v[52:55], v[72:75]
    v_mfma_f32_16x16x32_bf16 v[76:79], v[140:143], v[52:55], v[76:79]
L_s2b:
    s_nop 5
    v_cvt_pk_bf16_f32 v96, v64, v68
    v_cvt_pk_bf16_f32 v97, v65, v69
    v_cvt_pk_bf16_f32 v98, v66, v70
    v_cvt_pk_bf16_f32 v99, v67, v71
    v_bitop3_b32 v96, v106, v104, v96 bitop3:0xca
    v_bitop3_b32 v97, v106, v104, v97 bitop3:0xca
    v_bitop3_b32 v98, v106, v104, v98 bitop3:0xca
    v_bitop3_b32 v99, v106, v104, v99 bitop3:0xca
    v_cvt_pk_bf16_f32 v100, v72, v76
    v_cvt_pk_bf16_f32 v101, v73, v77
    v_cvt_pk_bf16_f32 v102, v74, v78
    v_cvt_pk_bf16_f32 v103, v75, v79
    v_bitop3_b32 v100, v106, v105, v100 bitop3:0xca
    v_bitop3_b32 v101, v106, v105, v101 bitop3:0xca
    v_bitop3_b32 v102, v106, v105, v102 bitop3:0xca
    v_bitop3_b32 v103, v106, v105, v103 bitop3:0xca
    v_cndmask_b32_dpp v80, v97, v96, vcc row_ror:8 row_mask:0xf bank_mask:0xf
    v_cndmask_b32_dpp v81, v101, v100, vcc row_ror:8 row_mask:0xf bank_mask:0xf
    v_cndmask_b32_dpp v84, v99, v98, vcc row_ror:8 row_mask:0xf bank_mask:0xf
    v_cndmask_b32_dpp v85, v103, v102, vcc row_ror:8 row_mask:0xf bank_mask:0xf
    s_not_b64 vcc, vcc
    v_cndmask_b32_dpp v82, v96, v97, vcc row_ror:8 row_mask:0xf bank_mask:0xf
    v_cndmask_b32_dpp v83, v100, v101, vcc row_ror:8 row_mask:0xf bank_mask:0xf
    buffer_store_dwordx4 v[80:83], v63, s[36:39], s6 offen sc1
    v_cndmask_b32_dpp v86, v98, v99, vcc row_ror:8 row_mask:0xf bank_mask:0xf
    v_cndmask_b32_dpp v87, v102, v103, vcc row_ror:8 row_mask:0xf bank_mask:0xf
    buffer_store_dwordx4 v[84:87], v63, s[36:39], s7 offen sc1
L_nos2:
    s_mov_b32 s40, s26
    s_mov_b32 s41, s27
    s_mov_b32 s42, 0x200000
    s_mov_b32 s43, 0x20000
    v_mov_b32 v252, 0x0
    buffer_load_dword v252, v252, s[40:43], 0 offen
    s_mov_b32 s95, s9
    s_and_b32 s15, s95, 63
    s_lshl_b32 s15, s15, 11
    s_add_u32 s15, s15, 0x40000
    v_lshlrev_b32 v134, 3, v0
    s_cmp_lg_u32 s3, 7
    s_cbranch_scc1 L_a3
    v_mov_b32 v128, 0
    v_mov_b32 v129, 0
    v_mov_b32 v130, 0
    v_mov_b32 v131, 0
    buffer_atomic_or_x2 v[128:129], v134, s[36:39], s15 offen sc0 sc1
    buffer_atomic_or_x2 v[130:131], v134, s[36:39], s15 offen offset:512 sc0 sc1
L_a3:
    v_lshlrev_b32 v107, 4, v0
    ds_read_b128 v[152:155], v107 offset:32768
    ds_read_b128 v[156:159], v107 offset:33792
    ds_read_b128 v[200:203], v107 offset:34816
    ds_read_b128 v[204:207], v107 offset:35840
    ds_read_b128 v[208:211], v107 offset:36864
    ds_read_b128 v[212:215], v107 offset:37888
    ds_read_b128 v[168:171], v107 offset:38912
    ds_read_b128 v[172:175], v107 offset:39936
    ds_read_b128 v[176:179], v107 offset:40960
    ds_read_b128 v[180:183], v107 offset:41984
    v_lshrrev_b32 v96, 1, v2
    v_lshlrev_b32 v96, 8, v96
    v_add_u32 v96, s58, v96
    v_and_b32 v97, 1, v2
    v_lshlrev_b32 v98, 1, v3
    v_mul_u32_u24 v98, v98, v96
    v_cmp_eq_u32 vcc, 0, v97
    v_and_b32 v99, 2047, v98
    v_add_u32 v98, v98, v96
    v_cvt_f32_u32 v99, v99
    v_mul_f32 v99, 0x3a000000, v99
    v_cos_f32 v100, v99
    v_sin_f32 v101, v99
    v_mul_f32 v100, 0.5, v100
    v_mul_f32 v101, 0.5, v101
    v_cndmask_b32_e64 v102, -v101, v100, vcc
    v_cndmask_b32 v103, v100, v101, vcc
    v_cvt_pk_bf16_f32 v144, v102, v103
    v_cvt_pk_bf16_f32 v148, -v103, v102
    v_cndmask_b32 v102, v101, v100, vcc
    v_cndmask_b32_e64 v103, -v100, v101, vcc
    v_cvt_pk_bf16_f32 v145, v102, -v103
    v_cvt_pk_bf16_f32 v149, -v103, -v102
    s_and_b32 s60, s58, 127
    s_cbranch_scc1 L_a_a10
    v_add_f32 v100, v100, v100
    v_add_f32 v101, v101, v101
    v_cndmask_b32 v102, 0, v100, vcc
    v_sub_f32 v103, v100, v102
    v_cvt_pk_bf16_f32 v100, v102, v103
    v_cndmask_b32 v102, 0, v101, vcc
    v_sub_f32 v103, v101, v102
    v_cvt_pk_bf16_f32 v101, -v102, -v103
    s_cmp_eq_u32 s58, 0
    s_cselect_b32 s60, -1, 0
    s_cselect_b32 s61, 0, -1
    v_and_b32 v144, s60, v100
    v_and_b32 v148, s60, v101
    v_and_b32 v145, s61, v100
    v_and_b32 v149, s61, v101
L_a_a10:
    v_and_b32 v99, 2047, v98
    v_cvt_f32_u32 v99, v99
    v_mul_f32 v99, 0x3a000000, v99
    v_cos_f32 v100, v99
    v_sin_f32 v101, v99
    v_mul_f32 v100, 0.5, v100
    v_mul_f32 v101, 0.5, v101
    v_cndmask_b32_e64 v102, -v101, v100, vcc
    v_cndmask_b32 v103, v100, v101, vcc
    v_cvt_pk_bf16_f32 v146, v102, v103
    v_cvt_pk_bf16_f32 v150, -v103, v102
    v_cndmask_b32 v102, v101, v100, vcc
    v_cndmask_b32_e64 v103, -v100, v101, vcc
    v_cvt_pk_bf16_f32 v147, v102, -v103
    v_cvt_pk_bf16_f32 v151, -v103, -v102
    s_and_b32 s60, s58, 127
    s_cbranch_scc1 L_a_a11
    v_add_f32 v100, v100, v100
    v_add_f32 v101, v101, v101
    v_cndmask_b32 v102, 0, v100, vcc
    v_sub_f32 v103, v100, v102
    v_cvt_pk_bf16_f32 v100, v102, v103
    v_cndmask_b32 v102, 0, v101, vcc
    v_sub_f32 v103, v101, v102
    v_cvt_pk_bf16_f32 v101, -v102, -v103
    s_cmp_eq_u32 s58, 0
    s_cselect_b32 s60, -1, 0
    s_cselect_b32 s61, 0, -1
    v_and_b32 v146, s60, v100
    v_and_b32 v150, s60, v101
    v_and_b32 v147, s61, v100
    v_and_b32 v151, s61, v101
L_a_a11:
    v_lshlrev_b32 v5, 12, v3
    v_lshl_add_u32 v5, v2, 4, v5
    v_lshrrev_b32 v96, 2, v2
    v_xor_b32 v96, v96, v3
    v_and_b32 v96, 1, v96
    v_bfe_u32 v97, v2, 1, 1
    v_lshl_or_b32 v96, v96, 1, v97
    s_lshr_b32 s60, s3, 1
    v_xor_b32 v96, s60, v96
    v_lshlrev_b32 v96, 4, v96
    v_and_b32 v98, 7, v2
    v_lshl_add_u32 v96, v98, 6, v96
    v_lshl_add_u32 v96, v3, 12, v96
    v_lshrrev_b32 v98, 3, v2
    v_lshl_add_u32 v96, v98, 2, v96
    s_and_b32 s60, s3, 1
    s_lshl_b32 s60, s60, 3
    s_add_u32 s60, s60, 16384
    v_add_u32 v6, s60, v96
    v_xor_b32 v7, 48, v6
    v_bfe_u32 v96, v2, 2, 1
    v_xor_b32 v96, v96, v98
    v_lshl_or_b32 v96, v96, 1, v98
    v_xor_b32 v96, v96, v97
    v_xor_b32 v96, v96, v3
    v_lshlrev_b32 v96, 4, v96
    v_lshl_add_u32 v62, v2, 6, v96
    s_lshl_b32 s60, s3, 4
    s_and_b32 s60, s60, 32
    v_xor_b32 v62, s60, v62
    s_lshl_b32 s60, s3, 11
    s_add_u32 s60, s60, 16384
    v_add_u32 v62, s60, v62
    s_lshl_b32 s14, s9, 14
    s_lshl_b32 s60, s3, 8
    s_add_u32 s14, s14, s60
    s_add_u32 s14, s14, 0x200000
    v_mov_b32 v109, 43016
    s_waitcnt lgkmcnt(0)
    v_mov_b32 v96, 0x80000000
    v_xor_b32 v160, v96, v152
    v_xor_b32 v164, v96, v156
    v_xor_b32 v161, v96, v153
    v_xor_b32 v165, v96, v157
    v_xor_b32 v162, v96, v154
    v_xor_b32 v166, v96, v158
    v_xor_b32 v163, v96, v155
    v_xor_b32 v167, v96, v159
    s_cmp_lg_u32 s3, 7
    s_cbranch_scc1 L_a5
    s_branch L_pk1_w
L_pk1:
    v_mov_b32 v128, 0
    v_mov_b32 v129, 0
    v_mov_b32 v130, 0
    v_mov_b32 v131, 0
    buffer_atomic_or_x2 v[128:129], v134, s[36:39], s15 offen sc0 sc1
    buffer_atomic_or_x2 v[130:131], v134, s[36:39], s15 offen offset:512 sc0 sc1
L_pk1_w:
    s_waitcnt vmcnt(0)
    v_xor_b32 v129, s59, v129
    v_bitop3_b32 v129, v131, s59, v129 bitop3:0xbe
    v_cmp_ne_u32 vcc, 0, v129
    v_max_u32 v128, v128, v130
    s_nop 0
    s_cbranch_vccz L_pk1_ok
    s_sleep 1
    s_sub_u32 s90, s90, 1
    s_cbranch_scc0 L_pk1
    s_mov_b32 s90, 0
L_pk1_ok:
    v_max_u32_dpp v128, v128, v128 row_ror:8 row_mask:0xf bank_mask:0xf
    s_nop 1
    v_max_u32_dpp v128, v128, v128 row_ror:4 row_mask:0xf bank_mask:0xf
    s_nop 1
    v_max_u32_dpp v128, v128, v128 row_ror:2 row_mask:0xf bank_mask:0xf
    s_nop 1
    v_max_u32_dpp v128, v128, v128 row_ror:1 row_mask:0xf bank_mask:0xf
    s_nop 0
    v_readlane_b32 s97, v128, 0
    v_readlane_b32 s60, v128, 16
    v_readlane_b32 s61, v128, 32
    v_readlane_b32 s62, v128, 48
    s_max_u32 s97, s97, s60
    s_max_u32 s61, s61, s62
    s_max_u32 s97, s97, s61
    s_and_b32 s97, s97, 2047
    v_mov_b32 v110, s97
    ds_write_b32 v109, v110
    s_waitcnt lgkmcnt(0)
L_a5:
    s_waitcnt vmcnt(0)
    s_barrier
    buffer_load_dwordx4 v[8:11], v5, s[36:39], s14 offen offset:0 sc1
    buffer_load_dwordx4 v[12:15], v5, s[36:39], s14 offen offset:2048 sc1
    ds_read_b32 v109, v109
    v_dot2_f32_bf16 v110, v232, v240, 0
    v_dot2_f32_bf16 v111, v236, v240, 0
    v_dot2_f32_bf16 v110, v233, v241, v110
    v_dot2_f32_bf16 v111, v237, v241, v111
    v_dot2_f32_bf16 v110, v234, v242, v110
    v_dot2_f32_bf16 v111, v238, v242, v111
    v_dot2_f32_bf16 v110, v235, v243, v110
    v_dot2_f32_bf16 v111, v239, v243, v111
    v_permlane16_swap_b32 v232, v234
    v_permlane16_swap_b32 v233, v235
    v_permlane16_swap_b32 v236, v238
    v_permlane16_swap_b32 v237, v239
    v_permlane32_swap_b32 v110, v111
    v_add_f32 v110, v110, v111
    v_mov_b32 v111, v110
    s_nop 1
    v_permlane16_swap_b32 v110, v111
    v_add_f32 v110, v110, v111
    s_nop 1
    v_add_f32_dpp v110, v110, v110 row_ror:8 row_mask:0xf bank_mask:0xf
    v_lshlrev_b32 v216, 16, v232
    v_and_b32 v217, 0xffff0000, v232
    v_add_f32_dpp v110, v110, v110 row_ror:4 row_mask:0xf bank_mask:0xf
    v_lshlrev_b32 v218, 16, v233
    v_and_b32 v219, 0xffff0000, v233
    v_add_f32_dpp v110, v110, v110 row_ror:2 row_mask:0xf bank_mask:0xf
    v_lshlrev_b32 v220, 16, v234
    v_and_b32 v221, 0xffff0000, v234
    v_add_f32_dpp v110, v110, v110 row_ror:1 row_mask:0xf bank_mask:0xf
    v_lshlrev_b32 v222, 16, v235
    v_and_b32 v223, 0xffff0000, v235
    v_mul_f32 v110, 0xbfb8aa3b, v110
    v_lshlrev_b32 v224, 16, v236
    v_and_b32 v225, 0xffff0000, v236
    v_exp_f32 v110, v110
    v_lshlrev_b32 v226, 16, v237
    v_and_b32 v227, 0xffff0000, v237
    v_add_f32 v110, 1.0, v110
    v_lshlrev_b32 v228, 16, v238
    v_and_b32 v229, 0xffff0000, v238
    v_rcp_f32 v110, v110
    v_lshlrev_b32 v230, 16, v239
    v_and_b32 v231, 0xffff0000, v239
    v_mov_b32 v111, v110
    s_nop 1
    v_permlane32_swap_b32 v110, v111
    s_waitcnt lgkmcnt(0)
    v_readfirstlane_b32 s97, v109
    v_sub_f32 v96, 1.0, v110
    v_sub_f32 v97, 1.0, v111
    v_pk_mul_f32 v[184:185], v[200:201], v[110:111] op_sel:[0,0] op_sel_hi:[1,0]
    v_pk_mul_f32 v[186:187], v[202:203], v[110:111] op_sel:[0,0] op_sel_hi:[1,0]
    v_pk_mul_f32 v[188:189], v[204:205], v[110:111] op_sel:[0,0] op_sel_hi:[1,0]
    v_pk_mul_f32 v[190:191], v[206:207], v[110:111] op_sel:[0,0] op_sel_hi:[1,0]
    v_pk_mul_f32 v[192:193], v[208:209], v[110:111] op_sel:[0,0] op_sel_hi:[1,0]
    v_pk_mul_f32 v[194:195], v[210:211], v[110:111] op_sel:[0,0] op_sel_hi:[1,0]
    v_pk_mul_f32 v[196:197], v[212:213], v[110:111] op_sel:[0,0] op_sel_hi:[1,0]
    v_pk_mul_f32 v[198:199], v[214:215], v[110:111] op_sel:[0,0] op_sel_hi:[1,0]
    v_pk_mul_f32 v[200:201], v[200:201], v[110:111] op_sel:[0,1] op_sel_hi:[1,1]
    v_pk_mul_f32 v[202:203], v[202:203], v[110:111] op_sel:[0,1] op_sel_hi:[1,1]
    v_pk_mul_f32 v[204:205], v[204:205], v[110:111] op_sel:[0,1] op_sel_hi:[1,1]
    v_pk_mul_f32 v[206:207], v[206:207], v[110:111] op_sel:[0,1] op_sel_hi:[1,1]
    v_pk_mul_f32 v[208:209], v[208:209], v[110:111] op_sel:[0,1] op_sel_hi:[1,1]
    v_pk_mul_f32 v[210:211], v[210:211], v[110:111] op_sel:[0,1] op_sel_hi:[1,1]
    v_pk_mul_f32 v[212:213], v[212:213], v[110:111] op_sel:[0,1] op_sel_hi:[1,1]
    v_pk_mul_f32 v[214:215], v[214:215], v[110:111] op_sel:[0,1] op_sel_hi:[1,1]
    v_pk_mul_f32 v[216:217], v[216:217], v[96:97] op_sel:[0,0] op_sel_hi:[1,0]
    v_pk_mul_f32 v[218:219], v[218:219], v[96:97] op_sel:[0,0] op_sel_hi:[1,0]
    v_pk_mul_f32 v[220:221], v[220:221], v[96:97] op_sel:[0,0] op_sel_hi:[1,0]
    v_pk_mul_f32 v[222:223], v[222:223], v[96:97] op_sel:[0,0] op_sel_hi:[1,0]
    v_pk_mul_f32 v[224:225], v[224:225], v[96:97] op_sel:[0,1] op_sel_hi:[1,1]
    v_pk_mul_f32 v[226:227], v[226:227], v[96:97] op_sel:[0,1] op_sel_hi:[1,1]
    v_pk_mul_f32 v[228:229], v[228:229], v[96:97] op_sel:[0,1] op_sel_hi:[1,1]
    v_pk_mul_f32 v[230:231], v[230:231], v[96:97] op_sel:[0,1] op_sel_hi:[1,1]
    s_branch L_a_pw
L_a_pl:
    buffer_load_dwordx4 v[8:11], v5, s[36:39], s14 offen offset:0 sc1
    buffer_load_dwordx4 v[12:15], v5, s[36:39], s14 offen offset:2048 sc1
L_a_pw:
    s_waitcnt vmcnt(0)
    v_swap_b32 v10, v12
    v_swap_b32 v11, v13
    v_xor_b32 v96, v104, v8
    v_xor_b32 v97, v105, v9
    v_mfma_f32_16x16x32_bf16 v[64:67], v[144:147], v[8:11], 0
    v_bitop3_b32 v96, v10, v104, v96 bitop3:0xbe
    v_bitop3_b32 v97, v11, v105, v97 bitop3:0xbe
    v_mfma_f32_16x16x32_bf16 v[68:71], v[148:151], v[8:11], 0
    v_bitop3_b32 v96, v12, v104, v96 bitop3:0xbe
    v_bitop3_b32 v97, v13, v105, v97 bitop3:0xbe
    v_mfma_f32_16x16x32_bf16 v[72:75], v[144:147], v[12:15], 0
    v_bitop3_b32 v96, v14, v104, v96 bitop3:0xbe
    v_bitop3_b32 v97, v15, v105, v97 bitop3:0xbe
    v_mfma_f32_16x16x32_bf16 v[76:79], v[148:151], v[12:15], 0
    v_bitop3_b32 v96, v96, v97, v106 bitop3:0xa8
    v_cmp_ne_u32 vcc, 0, v96
    s_nop 0
    s_cbranch_vccz L_a_pl_ok
    s_sleep 1
    s_sub_u32 s90, s90, 1
    s_cbranch_scc0 L_a_pl
    s_mov_b32 s90, 0
L_a_pl_ok:
    v_cvt_pk_bf16_f32 v16, v64, v68
    v_cvt_pk_bf16_f32 v17, v65, v69
    ds_write2st64_b32 v6, v16, v17 offset0:0 offset1:4
    v_cvt_pk_bf16_f32 v18, v66, v70
    v_cvt_pk_bf16_f32 v19, v67, v71
    ds_write2st64_b32 v6, v18, v19 offset0:8 offset1:12
    v_cvt_pk_bf16_f32 v20, v72, v76
    v_cvt_pk_bf16_f32 v21, v73, v77
    ds_write2st64_b32 v7, v20, v21 offset0:2 offset1:6
    v_cvt_pk_bf16_f32 v22, v74, v78
    v_cvt_pk_bf16_f32 v23, v75, v79
    ds_write2st64_b32 v7, v22, v23 offset0:10 offset1:14
    s_waitcnt lgkmcnt(0)
    s_barrier
    ds_read_b128 v[16:19], v62 offset:0
    ds_read_b128 v[20:23], v62 offset:1024
    s_waitcnt lgkmcnt(1)
    v_mfma_f32_16x16x32_bf16 v[64:67], v[16:19], v[152:155], 0
    v_mfma_f32_16x16x32_bf16 v[68:71], v[16:19], v[156:159], 0
    s_waitcnt lgkmcnt(0)
    v_mfma_f32_16x16x32_bf16 v[72:75], v[20:23], v[152:155], 0
    v_mfma_f32_16x16x32_bf16 v[76:79], v[20:23], v[156:159], 0
    v_mfma_f32_16x16x32_bf16 v[80:83], v[16:19], v[160:163], 0
    s_nop 2
    v_pk_mul_f32 v[96:97], v[64:65], v[184:185]
    v_pk_mul_f32 v[100:101], v[68:69], v[184:185]
    v_mfma_f32_16x16x32_bf16 v[84:87], v[16:19], v[164:167], 0
    v_pk_mul_f32 v[98:99], v[66:67], v[186:187]
    v_pk_mul_f32 v[102:103], v[70:71], v[186:187]
    v_pk_fma_f32 v[96:97], v[68:69], v[188:189], v[96:97]
    v_pk_fma_f32 v[100:101], v[64:65], v[188:189], v[100:101] neg_lo:[1,0,0] neg_hi:[1,0,0]
    v_mfma_f32_16x16x32_bf16 v[88:91], v[20:23], v[160:163], 0
    v_pk_fma_f32 v[98:99], v[70:71], v[190:191], v[98:99]
    v_pk_fma_f32 v[102:103], v[66:67], v[190:191], v[102:103] neg_lo:[1,0,0] neg_hi:[1,0,0]
    v_cvt_pk_bf16_f32 v112, v96, v100
    v_cvt_pk_bf16_f32 v113, v97, v101
    v_mfma_f32_16x16x32_bf16 v[92:95], v[20:23], v[164:167], 0
    v_cvt_pk_bf16_f32 v114, v98, v102
    v_cvt_pk_bf16_f32 v115, v99, v103
    v_pk_mul_f32 v[96:97], v[72:73], v[192:193]
    v_pk_mul_f32 v[100:101], v[76:77], v[192:193]
    v_mfma_f32_16x16x32_bf16 v[232:235], v[112:115], v[168:171], v[216:219]
    v_pk_mul_f32 v[98:99], v[74:75], v[194:195]
    v_pk_mul_f32 v[102:103], v[78:79], v[194:195]
    v_pk_fma_f32 v[96:97], v[76:77], v[196:197], v[96:97]
    v_pk_fma_f32 v[100:101], v[72:73], v[196:197], v[100:101] neg_lo:[1,0,0] neg_hi:[1,0,0]
    v_mfma_f32_16x16x32_bf16 v[236:239], v[112:115], v[172:175], v[220:223]
    v_pk_fma_f32 v[98:99], v[78:79], v[198:199], v[98:99]
    v_pk_fma_f32 v[102:103], v[74:75], v[198:199], v[102:103] neg_lo:[1,0,0] neg_hi:[1,0,0]
    v_cvt_pk_bf16_f32 v116, v96, v100
    v_cvt_pk_bf16_f32 v117, v97, v101
    v_cvt_pk_bf16_f32 v118, v98, v102
    v_cvt_pk_bf16_f32 v119, v99, v103
    v_pk_mul_f32 v[96:97], v[80:81], v[200:201]
    v_pk_mul_f32 v[100:101], v[84:85], v[200:201]
    v_mfma_f32_16x16x32_bf16 v[232:235], v[116:119], v[176:179], v[232:235]
    v_pk_mul_f32 v[98:99], v[82:83], v[202:203]
    v_pk_mul_f32 v[102:103], v[86:87], v[202:203]
    v_pk_fma_f32 v[96:97], v[84:85], v[204:205], v[96:97]
    v_pk_fma_f32 v[100:101], v[80:81], v[204:205], v[100:101] neg_lo:[1,0,0] neg_hi:[1,0,0]
    v_mfma_f32_16x16x32_bf16 v[236:239], v[116:119], v[180:183], v[236:239]
    v_pk_fma_f32 v[98:99], v[86:87], v[206:207], v[98:99]
    v_pk_fma_f32 v[102:103], v[82:83], v[206:207], v[102:103] neg_lo:[1,0,0] neg_hi:[1,0,0]
    v_cvt_pk_bf16_f32 v120, v96, v100
    v_cvt_pk_bf16_f32 v121, v97, v101
    v_cvt_pk_bf16_f32 v122, v98, v102
    v_cvt_pk_bf16_f32 v123, v99, v103
    v_pk_mul_f32 v[96:97], v[88:89], v[208:209]
    v_pk_mul_f32 v[100:101], v[92:93], v[208:209]
    v_mfma_f32_16x16x32_bf16 v[240:243], v[120:123], v[168:171], v[224:227]
    v_pk_mul_f32 v[98:99], v[90:91], v[210:211]
    v_pk_mul_f32 v[102:103], v[94:95], v[210:211]
    v_pk_fma_f32 v[96:97], v[92:93], v[212:213], v[96:97]
    v_pk_fma_f32 v[100:101], v[88:89], v[212:213], v[100:101] neg_lo:[1,0,0] neg_hi:[1,0,0]
    v_mfma_f32_16x16x32_bf16 v[244:247], v[120:123], v[172:175], v[228:231]
    v_pk_fma_f32 v[98:99], v[94:95], v[214:215], v[98:99]
    v_pk_fma_f32 v[102:103], v[90:91], v[214:215], v[102:103] neg_lo:[1,0,0] neg_hi:[1,0,0]
    v_cvt_pk_bf16_f32 v124, v96, v100
    v_cvt_pk_bf16_f32 v125, v97, v101
    v_cvt_pk_bf16_f32 v126, v98, v102
    v_cvt_pk_bf16_f32 v127, v99, v103
    s_nop 1
    v_mfma_f32_16x16x32_bf16 v[240:243], v[124:127], v[176:179], v[240:243]
    v_mfma_f32_16x16x32_bf16 v[244:247], v[124:127], v[180:183], v[244:247]
    v_cvt_pk_bf16_f32 v8, v232, v233
    v_cvt_pk_bf16_f32 v9, v234, v235
    v_cvt_pk_bf16_f32 v10, v236, v237
    v_cvt_pk_bf16_f32 v11, v238, v239
    s_nop 0
    v_permlane16_swap_b32 v8, v10
    v_permlane16_swap_b32 v9, v11
    s_cmp_eq_u32 s93, s97
    s_cbranch_scc1 L_sk2
    buffer_store_dwordx4 v[8:11], v4, s[40:43], s12 offen sc1
L_sk2:
    v_cvt_pk_bf16_f32 v12, v240, v241
    v_cvt_pk_bf16_f32 v13, v242, v243
    v_cvt_pk_bf16_f32 v14, v244, v245
    v_cvt_pk_bf16_f32 v15, v246, v247
    s_nop 0
    v_permlane16_swap_b32 v12, v14
    v_permlane16_swap_b32 v13, v15
    s_cmp_eq_u32 s94, s97
    s_cbranch_scc1 L_sk3
    s_and_b32 s60, s58, 127
    s_cbranch_scc0 L_sk3
    buffer_store_dwordx4 v[12:15], v4, s[40:43], s13 offen sc1
L_sk3:
    s_endpgm
L_low:
    s_cmp_ge_u32 s57, 8
    s_cbranch_scc1 L_h
    s_cmp_lt_u32 s56, 4
    s_cbranch_scc1 L_f
    s_cmp_lt_u32 s57, 6
    s_cbranch_scc1 L_f
    s_cmp_eq_u32 s57, 7
    s_cbranch_scc1 L_fin
    s_cmp_lg_u32 s56, 4
    s_cbranch_scc1 L_end
    s_mov_b32 s58, 128
    s_mov_b32 s9, 0
    s_branch L_a
L_h:
    s_lshl_b32 s60, s56, 3
    s_mul_i32 s62, s56, 6
    s_add_u32 s62, s62, 8
    s_cmp_lt_u32 s56, 4
    s_cselect_b32 s60, s60, s62
    s_cselect_b32 s61, 16, 14
    s_cmp_ge_u32 s57, s61
    s_cbranch_scc1 L_end
    s_add_u32 s58, s60, s57
    s_sub_u32 s58, s58, 8
    s_waitcnt lgkmcnt(0)
    s_cmp_ge_u32 s3, 4
    s_cbranch_scc1 L_h2
    s_bitcmp1_b32 s58, 0
    s_cselect_b32 s44, s20, s18
    s_cselect_b32 s45, s21, s19
    s_cselect_b32 s60, 0, 256
    s_mov_b32 s46, 0x1c0000
    s_mov_b32 s47, 0x20000
    s_lshl_b32 s61, s3, 6
    s_add_u32 s60, s60, s61
    v_add_u32 v4, s60, v0
    v_mul_u32_u24 v4, 3584, v4
    s_lshr_b32 s60, s58, 1
    s_lshl_b32 s60, s60, 7
    buffer_load_dword v5, v4, s[44:47], s60 offen
    s_endpgm
L_h2:
    s_mov_b32 s52, s22
    s_mov_b32 s53, s23
    s_mov_b32 s54, 0x1c0000
    s_mov_b32 s55, 0x20000
    s_lshl_b32 s60, s58, 15
    s_and_b32 s61, s3, 3
    s_lshl_b32 s61, s61, 13
    s_add_u32 s60, s60, s61
    v_lshlrev_b32 v4, 7, v0
    buffer_load_dword v5, v4, s[52:55], s60 offen
    s_endpgm
L_f:
    s_lshl3_add_u32 s60, s56, s57
    s_mul_i32 s62, s56, 6
    s_add_u32 s62, s62, 8
    s_add_u32 s62, s62, s57
    s_cmp_lt_u32 s56, 4
    s_cselect_b32 s58, s60, s62
    s_mov_b32 s95, s58
    s_bitcmp1_b32 s58, 0
    s_cselect_b32 s98, 7, 0
    s_xor_b32 s98, s98, s3
    v_lshrrev_b32 v8, 2, v0
    v_mul_u32_u24 v4, 3584, v8
    v_lshrrev_b32 v8, 2, v8
    v_and_b32 v8, 2, v8
    v_and_b32 v9, 3, v0
    v_xor_b32 v8, v8, v9
    v_lshl_add_u32 v4, v8, 4, v4
    v_lshrrev_b32 v8, 3, v0
    v_and_b32 v9, 2, v8
    v_and_b32 v10, 7, v0
    v_xor_b32 v9, v9, v10
    v_lshlrev_b32 v9, 4, v9
    v_lshl_add_u32 v5, v8, 10, v9
    v_xor_b32 v6, 64, v5
    s_and_b32 s60, s98, 3
    s_mul_i32 s12, s60, 458752
    s_lshl_b32 s61, s58, 6
    s_add_u32 s12, s12, s61
    s_lshl_b32 s13, s58, 15
    s_lshl_b32 s61, s3, 7
    s_add_u32 s13, s13, s61
    s_lshl_b32 s14, s3, 13
    s_lshl_b32 s6, s3, 12
    s_add_u32 s6, s6, 65536
    s_waitcnt lgkmcnt(0)
    s_load_dword s59, s[30:31], 0
    s_mov_b32 s32, s4
    s_mov_b32 s33, s5
    s_mov_b32 s34, 0x200000
    s_mov_b32 s35, 0x20000
    s_mov_b32 s36, s30
    s_mov_b32 s37, s31
    s_mov_b32 s38, 0x400000
    s_mov_b32 s39, 0x20000
    s_cmp_lt_u32 s98, 4
    s_cselect_b32 s44, s18, s20
    s_cselect_b32 s45, s19, s21
    s_mov_b32 s46, 0x1c0000
    s_mov_b32 s47, 0x20000
    s_mov_b32 s52, s22
    s_mov_b32 s53, s23
    s_mov_b32 s54, 0x1c0000
    s_mov_b32 s55, 0x20000
    s_add_u32 m0, s14, 0
    s_nop 0
    buffer_load_dwordx4 v4, s[44:47], s12 offen lds
    s_add_u32 s12, s12, 57344
    s_add_u32 m0, s14, 1024
    s_nop 0
    buffer_load_dwordx4 v4, s[44:47], s12 offen lds
    s_add_u32 s12, s12, 57344
    s_add_u32 m0, s14, 2048
    s_nop 0
    buffer_load_dwordx4 v4, s[44:47], s12 offen lds
    s_add_u32 s12, s12, 57344
    s_add_u32 m0, s14, 3072
    s_nop 0
    buffer_load_dwordx4 v4, s[44:47], s12 offen lds
    s_add_u32 s12, s12, 57344
    s_add_u32 m0, s14, 4096
    s_nop 0
    buffer_load_dwordx4 v4, s[44:47], s12 offen lds
    s_add_u32 s12, s12, 57344
    s_add_u32 m0, s14, 5120
    s_nop 0
    buffer_load_dwordx4 v4, s[44:47], s12 offen lds
    s_add_u32 s12, s12, 57344
    s_add_u32 m0, s14, 6144
    s_nop 0
    buffer_load_dwordx4 v4, s[44:47], s12 offen lds
    s_add_u32 s12, s12, 57344
    s_add_u32 m0, s14, 7168
    s_nop 0
    buffer_load_dwordx4 v4, s[44:47], s12 offen lds
    s_add_u32 m0, s6, 0
    s_nop 0
    buffer_load_dwordx4 v5, s[52:55], s13 offen lds
    s_add_u32 s13, s13, 8192
    s_add_u32 m0, s6, 1024
    s_nop 0
    buffer_load_dwordx4 v6, s[52:55], s13 offen lds
    s_add_u32 s13, s13, 8192
    s_add_u32 m0, s6, 2048
    s_nop 0
    buffer_load_dwordx4 v5, s[52:55], s13 offen lds
    s_add_u32 s13, s13, 8192
    s_add_u32 m0, s6, 3072
    s_nop 0
    buffer_load_dwordx4 v6, s[52:55], s13 offen lds
    v_mov_b32 v252, 0x0
    buffer_load_dword v252, v252, s[32:35], 0 offen
    v_mov_b32 v253, 0x3000
    buffer_load_dword v253, v253, s[36:39], 0 offen
    v_lshrrev_b32 v8, 2, v2
    v_lshl_add_u32 v9, v3, 3, v8
    v_and_b32 v10, 3, v0
    v_lshlrev_b32 v10, 3, v10
    v_and_b32 v11, 1, v3
    v_lshl_add_u32 v7, v9, 6, v10
    v_lshl_add_u32 v7, v11, 5, v7
    v_add_u32 v7, s14, v7
    v_xor_b32 v12, 32, v7
    v_lshrrev_b32 v8, 1, v8
    v_lshl_add_u32 v8, v11, 1, v8
    v_lshl_add_u32 v13, v9, 7, v10
    v_lshl_add_u32 v13, v8, 5, v13
    v_add_u32 v13, s6, v13
    s_and_b32 s60, s98, 3
    s_lshl_b32 s60, s60, 8
    s_add_u32 s60, s60, 98304
    v_lshlrev_b32 v14, 4, v3
    v_add_u32 v15, s60, v14
    s_lshl_b32 s60, s98, 7
    s_add_u32 s60, s60, 99328
    v_add_u32 v107, s60, v14
    v_lshl_add_u32 v111, v3, 5, v10
    v_add_u32 v111, 99328, v111
    v_lshlrev_b32 v108, 3, v3
    v_lshl_add_u32 v108, v2, 5, v108
    v_lshlrev_b32 v109, 4, v0
    s_lshr_b32 s60, s3, 1
    s_mul_i32 s12, s60, 14336
    s_and_b32 s60, s3, 1
    s_lshl_b32 s60, s60, 7
    s_add_u32 s12, s12, s60
    s_lshl_b32 s61, s58, 8
    s_add_u32 s12, s12, s61
    s_add_u32 s12, s12, 0x10000
    s_and_b32 s15, s95, 63
    s_lshl_b32 s15, s15, 11
    s_add_u32 s15, s15, 0x40000
    v_lshlrev_b32 v134, 3, v0
    s_waitcnt lgkmcnt(0)
    s_add_u32 s59, s59, 0x9e3779b9
    s_bitcmp1_b32 s59, 0
    s_cselect_b32 s91, 1, 0x10000
    s_xor_b32 s92, s91, 0x10001
    v_mov_b32 v104, s91
    v_mov_b32 v105, s92
    v_mov_b32 v106, 0x00010001
    s_waitcnt vmcnt(12)
    ds_read_b64_tr_b16 v[16:17], v7 offset:0
    ds_read_b64_tr_b16 v[18:19], v7 offset:256
    ds_read_b64_tr_b16 v[20:21], v12 offset:0
    ds_read_b64_tr_b16 v[22:23], v12 offset:256
    s_waitcnt vmcnt(10)
    ds_read_b64_tr_b16 v[24:25], v7 offset:2048
    ds_read_b64_tr_b16 v[26:27], v7 offset:2304
    ds_read_b64_tr_b16 v[28:29], v12 offset:2048
    ds_read_b64_tr_b16 v[30:31], v12 offset:2304
    s_waitcnt vmcnt(8)
    ds_read_b64_tr_b16 v[32:33], v7 offset:4096
    ds_read_b64_tr_b16 v[34:35], v7 offset:4352
    ds_read_b64_tr_b16 v[36:37], v12 offset:4096
    ds_read_b64_tr_b16 v[38:39], v12 offset:4352
    s_waitcnt vmcnt(6)
    ds_read_b64_tr_b16 v[40:41], v7 offset:6144
    ds_read_b64_tr_b16 v[42:43], v7 offset:6400
    ds_read_b64_tr_b16 v[44:45], v12 offset:6144
    ds_read_b64_tr_b16 v[46:47], v12 offset:6400
    s_waitcnt vmcnt(2)
    v_xor_b32 v8, 0, v13
    ds_read_b64_tr_b16 v[48:49], v8 offset:0
    ds_read_b64_tr_b16 v[50:51], v8 offset:512
    v_xor_b32 v8, 32, v13
    ds_read_b64_tr_b16 v[52:53], v8 offset:0
    ds_read_b64_tr_b16 v[54:55], v8 offset:512
    v_xor_b32 v8, 64, v13
    ds_read_b64_tr_b16 v[56:57], v8 offset:0
    ds_read_b64_tr_b16 v[58:59], v8 offset:512
    v_xor_b32 v8, 96, v13
    ds_read_b64_tr_b16 v[60:61], v8 offset:0
    ds_read_b64_tr_b16 v[62:63], v8 offset:512
    s_cmp_lg_u32 s3, 0
    s_cbranch_scc1 L_f2
L_pk4:
    v_mov_b32 v128, 0
    v_mov_b32 v129, 0
    v_mov_b32 v130, 0
    v_mov_b32 v131, 0
    buffer_atomic_or_x2 v[128:129], v134, s[36:39], s15 offen sc0 sc1
    buffer_atomic_or_x2 v[130:131], v134, s[36:39], s15 offen offset:512 sc0 sc1
L_pk4_w:
    s_waitcnt vmcnt(0)
    v_xor_b32 v129, s59, v129
    v_bitop3_b32 v129, v131, s59, v129 bitop3:0xbe
    v_cmp_ne_u32 vcc, 0, v129
    v_max_u32 v128, v128, v130
    s_nop 0
    s_cbranch_vccz L_pk4_ok
    s_sleep 1
    s_sub_u32 s90, s90, 1
    s_cbranch_scc0 L_pk4
    s_mov_b32 s90, 0
L_pk4_ok:
    v_max_u32_dpp v128, v128, v128 row_ror:8 row_mask:0xf bank_mask:0xf
    s_nop 1
    v_max_u32_dpp v128, v128, v128 row_ror:4 row_mask:0xf bank_mask:0xf
    s_nop 1
    v_max_u32_dpp v128, v128, v128 row_ror:2 row_mask:0xf bank_mask:0xf
    s_nop 1
    v_max_u32_dpp v128, v128, v128 row_ror:1 row_mask:0xf bank_mask:0xf
    s_nop 0
    v_readlane_b32 s97, v128, 0
    v_readlane_b32 s60, v128, 16
    v_readlane_b32 s61, v128, 32
    v_readlane_b32 s62, v128, 48
    s_max_u32 s97, s97, s60
    s_max_u32 s61, s61, s62
    s_max_u32 s97, s97, s61
    s_and_b32 s97, s97, 2047
    s_lshl_b32 s60, s97, 10
    s_mov_b32 m0, 98304
    s_nop 0
    buffer_load_dwordx4 v109, s[32:35], s60 offen lds
    s_waitcnt vmcnt(0)
L_f2:
    s_waitcnt lgkmcnt(0)
    s_barrier
    ds_read_b128 v[64:67], v15 offset:0
    ds_read_b128 v[68:71], v15 offset:64
    ds_read_b128 v[72:75], v15 offset:128
    ds_read_b128 v[76:79], v15 offset:192
    s_waitcnt lgkmcnt(3)
    v_mfma_f32_16x16x32_bf16 v[80:83], v[16:19], v[64:67], 0
    v_mfma_f32_16x16x32_bf16 v[84:87], v[20:23], v[64:67], 0
    s_waitcnt lgkmcnt(2)
    v_mfma_f32_16x16x32_bf16 v[80:83], v[24:27], v[68:71], v[80:83]
    v_mfma_f32_16x16x32_bf16 v[84:87], v[28:31], v[68:71], v[84:87]
    s_waitcnt lgkmcnt(1)
    v_mfma_f32_16x16x32_bf16 v[80:83], v[32:35], v[72:75], v[80:83]
    v_mfma_f32_16x16x32_bf16 v[84:87], v[36:39], v[72:75], v[84:87]
    s_waitcnt lgkmcnt(0)
    v_mfma_f32_16x16x32_bf16 v[80:83], v[40:43], v[76:79], v[80:83]
    v_mfma_f32_16x16x32_bf16 v[84:87], v[44:47], v[76:79], v[84:87]
    s_mov_b32 exec_lo, 0x10001
    s_mov_b32 exec_hi, 0x10001
    s_nop 4
    ds_write_b128 v107, v[80:83] offset:0
    ds_write_b128 v107, v[84:87] offset:64
    s_mov_b64 exec, -1
    s_waitcnt lgkmcnt(0)
    s_barrier
    ds_read_b64 v[64:65], v111 offset:0
    ds_read_b64 v[66:67], v111 offset:128
    ds_read_b64 v[68:69], v111 offset:256
    ds_read_b64 v[70:71], v111 offset:384
    ds_read_b64 v[72:73], v111 offset:512
    ds_read_b64 v[74:75], v111 offset:640
    ds_read_b64 v[76:77], v111 offset:768
    ds_read_b64 v[78:79], v111 offset:896
    s_waitcnt lgkmcnt(4)
    v_pk_add_f32 v[64:65], v[64:65], v[66:67]
    v_pk_add_f32 v[68:69], v[68:69], v[70:71]
    v_pk_add_f32 v[64:65], v[64:65], v[68:69]
    v_mul_f32 v67, 0xbfb8aa3b, v65
    v_mul_f32 v66, 0xbfb8aa3b, v64
    v_exp_f32 v67, v67
    v_exp_f32 v66, v66
    v_add_f32 v67, 1.0, v67
    v_add_f32 v66, 1.0, v66
    v_rcp_f32 v67, v67
    v_rcp_f32 v66, v66
    s_nop 0
    v_pk_mul_f32 v[64:65], v[64:65], v[66:67]
    s_waitcnt lgkmcnt(0)
    v_pk_add_f32 v[72:73], v[72:73], v[74:75]
    v_pk_add_f32 v[76:77], v[76:77], v[78:79]
    v_pk_add_f32 v[72:73], v[72:73], v[76:77]
    v_pk_mul_f32 v[64:65], v[64:65], v[72:73]
    v_cvt_pk_bf16_f32 v64, v64, v65
    s_nop 1
    v_mov_b32_dpp v72, v64 quad_perm:[0,0,0,0] row_mask:0xf bank_mask:0xf
    v_mov_b32_dpp v73, v64 quad_perm:[1,1,1,1] row_mask:0xf bank_mask:0xf
    v_mov_b32_dpp v74, v64 quad_perm:[2,2,2,2] row_mask:0xf bank_mask:0xf
    v_mov_b32_dpp v75, v64 quad_perm:[3,3,3,3] row_mask:0xf bank_mask:0xf
    s_nop 1
    v_mfma_f32_16x16x32_bf16 v[88:91], v[48:51], v[72:75], 0
    v_mfma_f32_16x16x32_bf16 v[92:95], v[52:55], v[72:75], 0
    v_mfma_f32_16x16x32_bf16 v[96:99], v[56:59], v[72:75], 0
    v_mfma_f32_16x16x32_bf16 v[100:103], v[60:63], v[72:75], 0
    s_mov_b32 exec_lo, 0x10001
    s_mov_b32 exec_hi, 0x10001
    s_nop 2
    v_cvt_pk_bf16_f32 v120, v88, v89
    v_cvt_pk_bf16_f32 v121, v90, v91
    s_mov_b32 exec_lo, 0x20002
    s_mov_b32 exec_hi, 0x20002
    v_cvt_pk_bf16_f32 v120, v92, v93
    v_cvt_pk_bf16_f32 v121, v94, v95
    s_mov_b32 exec_lo, 0x40004
    s_mov_b32 exec_hi, 0x40004
    v_cvt_pk_bf16_f32 v120, v96, v97
    v_cvt_pk_bf16_f32 v121, v98, v99
    s_mov_b32 exec_lo, 0x80008
    s_mov_b32 exec_hi, 0x80008
    v_cvt_pk_bf16_f32 v120, v100, v101
    v_cvt_pk_bf16_f32 v121, v102, v103
    s_mov_b32 exec_lo, 0x000f000f
    s_mov_b32 exec_hi, 0x000f000f
    v_bitop3_b32 v120, v106, v104, v120 bitop3:0xca
    v_bitop3_b32 v121, v106, v105, v121 bitop3:0xca
    buffer_store_dwordx2 v[120:121], v108, s[36:39], s12 offen sc1
    s_endpgm
L_fin:
    v_lshlrev_b32 v4, 5, v2
    v_and_b32 v96, 1, v3
    v_lshl_add_u32 v4, v96, 9, v4
    v_lshrrev_b32 v96, 1, v3
    v_lshl_add_u32 v4, v96, 4, v4
    s_add_u32 s95, s56, 56
    s_waitcnt lgkmcnt(0)
    s_load_dword s59, s[30:31], 0
    s_mov_b32 s32, s4
    s_mov_b32 s33, s5
    s_mov_b32 s34, 0x200000
    s_mov_b32 s35, 0x20000
    s_mov_b32 s36, s30
    s_mov_b32 s37, s31
    s_mov_b32 s38, 0x400000
    s_mov_b32 s39, 0x20000
    s_mov_b32 s48, s24
    s_mov_b32 s49, s25
    s_mov_b32 s50, 0x400
    s_mov_b32 s51, 0x20000
    buffer_load_dwordx4 v[28:31], v4, s[48:51], 0 offen
    s_lshl_b32 s60, s3, 10
    v_lshl_add_u32 v248, v0, 4, s60
    s_add_u32 m0, s60, 32768
    global_load_lds_dwordx4 v248, s[10:11] offset:0
    s_and_b32 s63, s3, 1
    s_add_u32 s63, s63, 8
    s_lshl_b32 s60, s63, 10
    v_lshl_add_u32 v248, v0, 4, s60
    s_add_u32 m0, s60, 32768
    global_load_lds_dwordx4 v248, s[10:11] offset:0
    s_mov_b32 s40, s26
    s_mov_b32 s41, s27
    s_mov_b32 s42, 0x200000
    s_mov_b32 s43, 0x20000
    v_mov_b32 v252, 0x200000
    buffer_load_dword v252, v252, s[36:39], 0 offen
    v_mov_b32 v253, 0x3000
    buffer_load_dword v253, v253, s[36:39], 0 offen
    v_mov_b32 v254, 0x0
    buffer_load_dword v254, v254, s[40:43], 0 offen
    v_mov_b32 v255, 0x0
    buffer_load_dword v255, v255, s[32:35], 0 offen
    v_lshlrev_b32 v5, 12, v3
    v_lshl_add_u32 v5, v2, 4, v5
    v_lshrrev_b32 v96, 2, v2
    v_xor_b32 v96, v96, v3
    v_and_b32 v96, 1, v96
    v_bfe_u32 v97, v2, 1, 1
    v_lshl_or_b32 v96, v96, 1, v97
    s_lshr_b32 s60, s3, 1
    v_xor_b32 v96, s60, v96
    v_lshlrev_b32 v96, 4, v96
    v_and_b32 v98, 7, v2
    v_lshl_add_u32 v96, v98, 6, v96
    v_lshl_add_u32 v96, v3, 12, v96
    v_lshrrev_b32 v98, 3, v2
    v_lshl_add_u32 v96, v98, 2, v96
    s_and_b32 s60, s3, 1
    s_lshl_b32 s60, s60, 3
    s_add_u32 s60, s60, 16384
    v_add_u32 v6, s60, v96
    v_xor_b32 v7, 48, v6
    v_bfe_u32 v96, v2, 2, 1
    v_xor_b32 v96, v96, v98
    v_lshl_or_b32 v96, v96, 1, v98
    v_xor_b32 v96, v96, v97
    v_xor_b32 v96, v96, v3
    v_lshlrev_b32 v96, 4, v96
    v_lshl_add_u32 v62, v2, 6, v96
    s_and_b32 s15, s95, 63
    s_lshl_b32 s15, s15, 11
    s_add_u32 s15, s15, 0x40000
    v_lshlrev_b32 v134, 3, v0
    s_and_b32 s60, s56, 3
    s_mul_i32 s7, s60, 14336
    s_lshl_b32 s61, s3, 11
    s_add_u32 s7, s7, s61
    s_add_u32 s7, s7, 0xf800
    v_lshlrev_b32 v107, 4, v0
    v_and_b32 v108, 1, v3
    v_lshrrev_b32 v111, 1, v3
    v_lshl_add_u32 v108, v108, 1, v111
    v_lshl_add_u32 v108, v2, 3, v108
    s_lshl_b32 s60, s3, 9
    s_add_u32 s60, s60, 42752
    v_lshl_add_u32 v108, v108, 2, s60
    v_and_b32 v111, 7, v2
    v_lshlrev_b32 v111, 6, v111
    v_lshl_add_u32 v111, v3, 4, v111
    v_mov_b32 v109, 43016
    s_waitcnt lgkmcnt(0)
    s_add_u32 s59, s59, 0x9e3779b9
    s_bitcmp1_b32 s59, 0
    s_cselect_b32 s91, 1, 0x10000
    s_xor_b32 s92, s91, 0x10001
    s_cmp_lg_u32 s3, 0
    s_cbranch_scc1 L_fin0
    s_cmp_eq_u32 s56, 4
    s_cbranch_scc1 L_fin0
    s_and_b32 s60, s56, 3
    s_lshl_b32 s60, s60, 7
    v_mov_b32 v96, 0x1000
    v_mov_b32 v97, s59
    s_mov_b64 exec, 1
    buffer_store_dword v97, v96, s[36:39], s60 offen sc1
    s_mov_b64 exec, -1
L_fin0:
    v_mov_b32 v104, s91
    v_mov_b32 v105, s92
    v_mov_b32 v106, 0x00010001
    s_waitcnt vmcnt(0)
    s_barrier
    s_bfe_u32 s60, s56, 0x10001
    s_lshl_b32 s60, s60, 10
    v_add_u32 v110, s60, v107
    ds_read_b128 v[152:155], v107 offset:32768
    ds_read_b128 v[156:159], v107 offset:33792
    ds_read_b128 v[184:187], v107 offset:34816
    ds_read_b128 v[188:191], v107 offset:35840
    ds_read_b128 v[192:195], v107 offset:36864
    ds_read_b128 v[196:199], v107 offset:37888
    ds_read_b128 v[168:171], v110 offset:38912
    ds_read_b128 v[172:175], v110 offset:40960
    s_cmp_lg_u32 s3, 0
    s_cbranch_scc1 L_fin1a
L_pk5:
    v_mov_b32 v128, 0
    v_mov_b32 v129, 0
    v_mov_b32 v130, 0
    v_mov_b32 v131, 0
    buffer_atomic_or_x2 v[128:129], v134, s[36:39], s15 offen sc0 sc1
    buffer_atomic_or_x2 v[130:131], v134, s[36:39], s15 offen offset:512 sc0 sc1
L_pk5_w:
    s_waitcnt vmcnt(0)
    v_xor_b32 v129, s59, v129
    v_bitop3_b32 v129, v131, s59, v129 bitop3:0xbe
    v_cmp_ne_u32 vcc, 0, v129
    v_max_u32 v128, v128, v130
    s_nop 0
    s_cbranch_vccz L_pk5_ok
    s_sleep 1
    s_sub_u32 s90, s90, 1
    s_cbranch_scc0 L_pk5
    s_mov_b32 s90, 0
L_pk5_ok:
    v_max_u32_dpp v128, v128, v128 row_ror:8 row_mask:0xf bank_mask:0xf
    s_nop 1
    v_max_u32_dpp v128, v128, v128 row_ror:4 row_mask:0xf bank_mask:0xf
    s_nop 1
    v_max_u32_dpp v128, v128, v128 row_ror:2 row_mask:0xf bank_mask:0xf
    s_nop 1
    v_max_u32_dpp v128, v128, v128 row_ror:1 row_mask:0xf bank_mask:0xf
    s_nop 0
    v_readlane_b32 s97, v128, 0
    v_readlane_b32 s60, v128, 16
    v_readlane_b32 s61, v128, 32
    v_readlane_b32 s62, v128, 48
    s_max_u32 s97, s97, s60
    s_max_u32 s61, s61, s62
    s_max_u32 s97, s97, s61
    v_mov_b32 v110, s97
    ds_write_b32 v109, v110
    s_and_b32 s60, s97, 2047
    s_lshl_b32 s12, s60, 10
    buffer_load_dwordx4 v[40:43], v4, s[32:35], s12 offen
    s_branch L_fin1
L_fin1a:
    s_lshl3_add_u32 s60, s56, s3
    s_cmp_lg_u32 s60, 34
    s_cbranch_scc1 L_fin1
    v_lshlrev_b32 v128, 7, v0
    s_mov_b64 exec, 0xf
    s_movk_i32 s60, 0x1000
L_ack:
    buffer_load_dword v129, v128, s[36:39], s60 offen sc1
    s_waitcnt vmcnt(0)
    v_cmp_ne_u32 vcc, s59, v129
    s_nop 0
    s_cbranch_vccz L_ack_ok
    s_sleep 1
    s_sub_u32 s90, s90, 1
    s_cbranch_scc0 L_ack
    s_mov_b32 s90, 0
L_ack_ok:
    s_mov_b64 exec, -1
L_fin1:
    s_waitcnt lgkmcnt(0)
    s_barrier
    ds_read_b32 v110, v109
    s_waitcnt lgkmcnt(0)
    v_readfirstlane_b32 s8, v110
    s_nop 0
    s_and_b32 s97, s8, 2047
    s_and_b32 s60, s97, 255
    s_and_b32 s61, s97, 15
    s_and_b32 s62, s97, 7
    s_cselect_b32 s60, s61, s60
    s_cselect_b32 s61, 8, 128
    s_cmp_gt_u32 s60, s61
    s_cselect_b32 s96, 0x80000000, 0
    s_sub_u32 s61, 2048, s97
    s_cmp_lg_u32 s96, 0
    s_cselect_b32 s60, s61, s97
    s_and_b32 s58, s60, 255
    s_lshr_b32 s98, s60, 8
    s_lshr_b32 s60, s58, 4
    s_and_b32 s61, s58, 15
    s_lshl4_add_u32 s9, s61, s60
    s_add_u32 s62, s60, s61
    s_cmp_eq_u32 s61, 8
    s_cselect_b32 s9, s62, s9
    s_cmp_eq_u32 s58, 128
    s_cselect_b32 s9, 0, s9
    s_lshl_b32 s14, s9, 14
    s_lshl_b32 s60, s3, 8
    s_add_u32 s14, s14, s60
    s_add_u32 s14, s14, 0x200000
    buffer_load_dwordx4 v[8:11], v5, s[36:39], s14 offen offset:0 sc1
    buffer_load_dwordx4 v[12:15], v5, s[36:39], s14 offen offset:2048 sc1
    v_lshrrev_b32 v96, 1, v2
    v_lshlrev_b32 v96, 8, v96
    v_add_u32 v96, s58, v96
    v_and_b32 v97, 1, v2
    v_lshlrev_b32 v98, 1, v3
    v_mul_u32_u24 v98, v98, v96
    v_cmp_eq_u32 vcc, 0, v97
    v_and_b32 v99, 2047, v98
    v_add_u32 v98, v98, v96
    v_cvt_f32_u32 v99, v99
    v_mul_f32 v99, 0x3a000000, v99
    v_cos_f32 v100, v99
    v_sin_f32 v101, v99
    v_mul_f32 v100, 0.5, v100
    v_mul_f32 v101, 0.5, v101
    v_cndmask_b32_e64 v102, -v101, v100, vcc
    v_cndmask_b32 v103, v100, v101, vcc
    v_cvt_pk_bf16_f32 v144, v102, v103
    v_cvt_pk_bf16_f32 v148, -v103, v102
    v_cndmask_b32 v102, v101, v100, vcc
    v_cndmask_b32_e64 v103, -v100, v101, vcc
    v_cvt_pk_bf16_f32 v145, v102, -v103
    v_cvt_pk_bf16_f32 v149, -v103, -v102
    s_and_b32 s60, s58, 127
    s_cbranch_scc1 L_fin_a10
    v_add_f32 v100, v100, v100
    v_add_f32 v101, v101, v101
    v_cndmask_b32 v102, 0, v100, vcc
    v_sub_f32 v103, v100, v102
    v_cvt_pk_bf16_f32 v100, v102, v103
    v_cndmask_b32 v102, 0, v101, vcc
    v_sub_f32 v103, v101, v102
    v_cvt_pk_bf16_f32 v101, -v102, -v103
    s_cmp_eq_u32 s58, 0
    s_cselect_b32 s60, -1, 0
    s_cselect_b32 s61, 0, -1
    v_and_b32 v144, s60, v100
    v_and_b32 v148, s60, v101
    v_and_b32 v145, s61, v100
    v_and_b32 v149, s61, v101
L_fin_a10:
    v_and_b32 v99, 2047, v98
    v_cvt_f32_u32 v99, v99
    v_mul_f32 v99, 0x3a000000, v99
    v_cos_f32 v100, v99
    v_sin_f32 v101, v99
    v_mul_f32 v100, 0.5, v100
    v_mul_f32 v101, 0.5, v101
    v_cndmask_b32_e64 v102, -v101, v100, vcc
    v_cndmask_b32 v103, v100, v101, vcc
    v_cvt_pk_bf16_f32 v146, v102, v103
    v_cvt_pk_bf16_f32 v150, -v103, v102
    v_cndmask_b32 v102, v101, v100, vcc
    v_cndmask_b32_e64 v103, -v100, v101, vcc
    v_cvt_pk_bf16_f32 v147, v102, -v103
    v_cvt_pk_bf16_f32 v151, -v103, -v102
    s_and_b32 s60, s58, 127
    s_cbranch_scc1 L_fin_a11
    v_add_f32 v100, v100, v100
    v_add_f32 v101, v101, v101
    v_cndmask_b32 v102, 0, v100, vcc
    v_sub_f32 v103, v100, v102
    v_cvt_pk_bf16_f32 v100, v102, v103
    v_cndmask_b32 v102, 0, v101, vcc
    v_sub_f32 v103, v101, v102
    v_cvt_pk_bf16_f32 v101, -v102, -v103
    s_cmp_eq_u32 s58, 0
    s_cselect_b32 s60, -1, 0
    s_cselect_b32 s61, 0, -1
    v_and_b32 v146, s60, v100
    v_and_b32 v150, s60, v101
    v_and_b32 v147, s61, v100
    v_and_b32 v151, s61, v101
L_fin_a11:
    s_cmp_lg_u32 s3, 0
    s_cbranch_scc1 L_fin3
    s_lshl_b32 s60, s98, 4
    s_and_b32 s60, s60, 32
    v_xor_b32 v62, s60, v62
    s_lshl_b32 s60, s98, 11
    s_add_u32 s60, s60, 16384
    v_add_u32 v62, s60, v62
    v_xor_b32 v152, s96, v152
    v_xor_b32 v156, s96, v156
    v_xor_b32 v153, s96, v153
    v_xor_b32 v157, s96, v157
    v_xor_b32 v154, s96, v154
    v_xor_b32 v158, s96, v158
    v_xor_b32 v155, s96, v155
    v_xor_b32 v159, s96, v159
    s_ashr_i32 s60, s8, 31
    s_orn2_b32 s60, 0x80000000, s60
    s_xor_b32 s8, s8, s60
    s_waitcnt vmcnt(2)
    v_dot2_f32_bf16 v32, v40, v28, 0
    v_dot2_f32_bf16 v32, v41, v29, v32
    v_dot2_f32_bf16 v32, v42, v30, v32
    v_dot2_f32_bf16 v32, v43, v31, v32
    s_nop 2
    v_add_f32_dpp v32, v32, v32 row_ror:8 row_mask:0xf bank_mask:0xf
    s_nop 1
    v_add_f32_dpp v32, v32, v32 row_ror:4 row_mask:0xf bank_mask:0xf
    s_nop 1
    v_add_f32_dpp v32, v32, v32 row_ror:2 row_mask:0xf bank_mask:0xf
    s_nop 1
    v_add_f32_dpp v32, v32, v32 row_ror:1 row_mask:0xf bank_mask:0xf
    v_mov_b32 v33, v32
    s_nop 1
    v_permlane32_swap_b32 v32, v33
    v_add_f32 v32, v32, v33
    v_mov_b32 v33, v32
    s_nop 1
    v_permlane16_swap_b32 v32, v33
    v_add_f32 v32, v32, v33
    v_mov_b32 v33, s8
    v_mul_f32 v35, 0xbfb8aa3b, v33
    v_mul_f32 v34, 0xbfb8aa3b, v32
    v_exp_f32 v35, v35
    v_exp_f32 v34, v34
    v_add_f32 v35, 1.0, v35
    v_add_f32 v34, 1.0, v34
    v_rcp_f32 v35, v35
    v_rcp_f32 v34, v34
    v_permlane16_swap_b32 v40, v42
    v_permlane16_swap_b32 v41, v43
    s_bitcmp1_b32 s56, 1
    s_cbranch_scc0 L_fint
    v_mov_b32 v40, v42
    v_mov_b32 v41, v43
L_fint:
    v_sub_f32 v36, 1.0, v34
    v_lshlrev_b32 v216, 16, v40
    v_and_b32 v217, 0xffff0000, v40
    v_pk_mul_f32 v[216:217], v[216:217], v[36:37] op_sel_hi:[1,0]
    v_lshlrev_b32 v218, 16, v41
    v_and_b32 v219, 0xffff0000, v41
    v_pk_mul_f32 v[218:219], v[218:219], v[36:37] op_sel_hi:[1,0]
    v_mul_f32 v38, v35, v36
    v_pk_mul_f32 v[184:185], v[184:185], v[34:35] op_sel_hi:[1,0]
    v_pk_mul_f32 v[186:187], v[186:187], v[34:35] op_sel_hi:[1,0]
    v_pk_mul_f32 v[188:189], v[188:189], v[34:35] op_sel_hi:[1,0]
    v_pk_mul_f32 v[190:191], v[190:191], v[34:35] op_sel_hi:[1,0]
    v_pk_mul_f32 v[192:193], v[192:193], v[34:35] op_sel_hi:[1,0]
    v_pk_mul_f32 v[194:195], v[194:195], v[34:35] op_sel_hi:[1,0]
    v_pk_mul_f32 v[196:197], v[196:197], v[34:35] op_sel_hi:[1,0]
    v_pk_mul_f32 v[198:199], v[198:199], v[34:35] op_sel_hi:[1,0]
L_fin3:
    s_branch L_fin_pw
L_fin_pl:
    buffer_load_dwordx4 v[8:11], v5, s[36:39], s14 offen offset:0 sc1
    buffer_load_dwordx4 v[12:15], v5, s[36:39], s14 offen offset:2048 sc1
L_fin_pw:
    s_waitcnt vmcnt(0)
    v_swap_b32 v10, v12
    v_swap_b32 v11, v13
    v_xor_b32 v96, v104, v8
    v_xor_b32 v97, v105, v9
    v_mfma_f32_16x16x32_bf16 v[64:67], v[144:147], v[8:11], 0
    v_bitop3_b32 v96, v10, v104, v96 bitop3:0xbe
    v_bitop3_b32 v97, v11, v105, v97 bitop3:0xbe
    v_mfma_f32_16x16x32_bf16 v[68:71], v[148:151], v[8:11], 0
    v_bitop3_b32 v96, v12, v104, v96 bitop3:0xbe
    v_bitop3_b32 v97, v13, v105, v97 bitop3:0xbe
    v_mfma_f32_16x16x32_bf16 v[72:75], v[144:147], v[12:15], 0
    v_bitop3_b32 v96, v14, v104, v96 bitop3:0xbe
    v_bitop3_b32 v97, v15, v105, v97 bitop3:0xbe
    v_mfma_f32_16x16x32_bf16 v[76:79], v[148:151], v[12:15], 0
    v_bitop3_b32 v96, v96, v97, v106 bitop3:0xa8
    v_cmp_ne_u32 vcc, 0, v96
    s_nop 0
    s_cbranch_vccz L_fin_pl_ok
    s_sleep 1
    s_sub_u32 s90, s90, 1
    s_cbranch_scc0 L_fin_pl
    s_mov_b32 s90, 0
L_fin_pl_ok:
    v_cvt_pk_bf16_f32 v16, v64, v68
    v_cvt_pk_bf16_f32 v17, v65, v69
    ds_write2st64_b32 v6, v16, v17 offset0:0 offset1:4
    v_cvt_pk_bf16_f32 v18, v66, v70
    v_cvt_pk_bf16_f32 v19, v67, v71
    ds_write2st64_b32 v6, v18, v19 offset0:8 offset1:12
    v_cvt_pk_bf16_f32 v20, v72, v76
    v_cvt_pk_bf16_f32 v21, v73, v77
    ds_write2st64_b32 v7, v20, v21 offset0:2 offset1:6
    v_cvt_pk_bf16_f32 v22, v74, v78
    v_cvt_pk_bf16_f32 v23, v75, v79
    ds_write2st64_b32 v7, v22, v23 offset0:10 offset1:14
    s_waitcnt lgkmcnt(0)
    s_barrier
    s_cmp_lg_u32 s3, 0
    s_cbranch_scc1 L_pp
    ds_read_b128 v[16:19], v62 offset:0
    ds_read_b128 v[20:23], v62 offset:1024
    s_waitcnt lgkmcnt(1)
    v_mfma_f32_16x16x32_bf16 v[64:67], v[16:19], v[152:155], 0
    v_mfma_f32_16x16x32_bf16 v[68:71], v[16:19], v[156:159], 0
    s_waitcnt lgkmcnt(0)
    v_mfma_f32_16x16x32_bf16 v[72:75], v[20:23], v[152:155], 0
    v_mfma_f32_16x16x32_bf16 v[76:79], v[20:23], v[156:159], 0
    s_nop 3
    v_pk_mul_f32 v[96:97], v[64:65], v[184:185]
    v_pk_mul_f32 v[100:101], v[68:69], v[184:185]
    v_pk_mul_f32 v[98:99], v[66:67], v[186:187]
    v_pk_mul_f32 v[102:103], v[70:71], v[186:187]
    v_pk_fma_f32 v[96:97], v[68:69], v[188:189], v[96:97]
    v_pk_fma_f32 v[100:101], v[64:65], v[188:189], v[100:101] neg_lo:[1,0,0] neg_hi:[1,0,0]
    v_pk_fma_f32 v[98:99], v[70:71], v[190:191], v[98:99]
    v_pk_fma_f32 v[102:103], v[66:67], v[190:191], v[102:103] neg_lo:[1,0,0] neg_hi:[1,0,0]
    v_cvt_pk_bf16_f32 v112, v96, v100
    v_cvt_pk_bf16_f32 v113, v97, v101
    v_cvt_pk_bf16_f32 v114, v98, v102
    v_cvt_pk_bf16_f32 v115, v99, v103
    s_nop 1
    v_mfma_f32_16x16x32_bf16 v[232:235], v[112:115], v[168:171], v[216:219]
    v_pk_mul_f32 v[96:97], v[72:73], v[192:193]
    v_pk_mul_f32 v[100:101], v[76:77], v[192:193]
    v_pk_mul_f32 v[98:99], v[74:75], v[194:195]
    v_pk_mul_f32 v[102:103], v[78:79], v[194:195]
    v_pk_fma_f32 v[96:97], v[76:77], v[196:197], v[96:97]
    v_pk_fma_f32 v[100:101], v[72:73], v[196:197], v[100:101] neg_lo:[1,0,0] neg_hi:[1,0,0]
    v_pk_fma_f32 v[98:99], v[78:79], v[198:199], v[98:99]
    v_pk_fma_f32 v[102:103], v[74:75], v[198:199], v[102:103] neg_lo:[1,0,0] neg_hi:[1,0,0]
    v_cvt_pk_bf16_f32 v116, v96, v100
    v_cvt_pk_bf16_f32 v117, v97, v101
    v_cvt_pk_bf16_f32 v118, v98, v102
    v_cvt_pk_bf16_f32 v119, v99, v103
    s_nop 1
    v_mfma_f32_16x16x32_bf16 v[232:235], v[116:119], v[172:175], v[232:235]
    v_lshlrev_b32 v4, 5, v2
    v_lshl_add_u32 v4, v3, 3, v4
    s_bfe_u32 s61, s56, 0x10001
    s_lshl_b32 s61, s61, 9
    s_add_u32 s12, s12, s61
    s_branch L_fin5
L_pp:
    buffer_load_dwordx4 v[8:11], v107, s[36:39], s7 offen sc1
    buffer_load_dwordx4 v[12:15], v107, s[36:39], s7 offen offset:1024 sc1
    s_waitcnt vmcnt(0)
    v_xor_b32 v96, v104, v8
    v_xor_b32 v97, v105, v9
    v_bitop3_b32 v96, v10, v104, v96 bitop3:0xbe
    v_bitop3_b32 v97, v11, v105, v97 bitop3:0xbe
    v_bitop3_b32 v96, v12, v104, v96 bitop3:0xbe
    v_bitop3_b32 v97, v13, v105, v97 bitop3:0xbe
    v_bitop3_b32 v96, v14, v104, v96 bitop3:0xbe
    v_bitop3_b32 v97, v15, v105, v97 bitop3:0xbe
    v_bitop3_b32 v96, v96, v97, v106 bitop3:0xa8
    v_cmp_ne_u32 vcc, 0, v96
    v_lshlrev_b32 v16, 16, v8
    v_lshlrev_b32 v24, 16, v12
    v_and_b32 v17, 0xffff0000, v8
    v_and_b32 v25, 0xffff0000, v12
    v_lshlrev_b32 v18, 16, v9
    v_lshlrev_b32 v26, 16, v13
    v_and_b32 v19, 0xffff0000, v9
    v_and_b32 v27, 0xffff0000, v13
    v_lshlrev_b32 v20, 16, v10
    v_lshlrev_b32 v28, 16, v14
    v_and_b32 v21, 0xffff0000, v10
    v_and_b32 v29, 0xffff0000, v14
    v_lshlrev_b32 v22, 16, v11
    v_lshlrev_b32 v30, 16, v15
    v_and_b32 v23, 0xffff0000, v11
    v_and_b32 v31, 0xffff0000, v15
    s_cbranch_vccz L_pp_ok
    s_sleep 1
    s_sub_u32 s90, s90, 1
    s_cbranch_scc0 L_pp
    s_mov_b32 s90, 0
L_pp_ok:
    v_pk_add_f32 v[16:17], v[16:17], v[24:25]
    v_pk_add_f32 v[18:19], v[18:19], v[26:27]
    v_pk_add_f32 v[20:21], v[20:21], v[28:29]
    v_pk_add_f32 v[22:23], v[22:23], v[30:31]
    s_nop 0
    v_permlane32_swap_b32 v20, v21
    v_permlane32_swap_b32 v16, v17
    v_permlane32_swap_b32 v22, v23
    v_permlane32_swap_b32 v18, v19
    v_add_f32 v20, v20, v21
    v_add_f32 v16, v16, v17
    v_add_f32 v22, v22, v23
    v_add_f32 v18, v18, v19
    s_nop 0
    v_permlane16_swap_b32 v20, v22
    v_permlane16_swap_b32 v16, v18
    v_add_f32 v20, v20, v22
    v_add_f32 v16, v16, v18
    ds_write2_b32 v108, v16, v20 offset0:0 offset1:4
    s_waitcnt lgkmcnt(0)
L_fin5:
    s_barrier
    s_cmp_lg_u32 s3, 0
    s_cbranch_scc1 L_fin7
    ds_read_b128 v[64:67], v111 offset:43264
    ds_read_b128 v[68:71], v111 offset:43776
    ds_read_b128 v[72:75], v111 offset:44288
    ds_read_b128 v[76:79], v111 offset:44800
    ds_read_b128 v[80:83], v111 offset:45312
    ds_read_b128 v[84:87], v111 offset:45824
    ds_read_b128 v[88:91], v111 offset:46336
    s_and_b32 s61, s56, 1
    s_lshl_b32 s61, s61, 3
    s_waitcnt lgkmcnt(0)
    v_pk_add_f32 v[68:69], v[68:69], v[72:73]
    v_pk_add_f32 v[70:71], v[70:71], v[74:75]
    v_pk_add_f32 v[76:77], v[76:77], v[80:81]
    v_pk_add_f32 v[78:79], v[78:79], v[82:83]
    v_pk_add_f32 v[84:85], v[84:85], v[88:89]
    v_pk_add_f32 v[86:87], v[86:87], v[90:91]
    v_pk_add_f32 v[64:65], v[64:65], v[68:69]
    v_pk_add_f32 v[76:77], v[76:77], v[84:85]
    v_pk_add_f32 v[66:67], v[66:67], v[70:71]
    v_pk_add_f32 v[78:79], v[78:79], v[86:87]
    v_pk_add_f32 v[64:65], v[64:65], v[76:77]
    v_pk_add_f32 v[66:67], v[66:67], v[78:79]
    v_pk_fma_f32 v[64:65], v[64:65], v[38:39], v[232:233] op_sel_hi:[1,0,1]
    v_pk_fma_f32 v[66:67], v[66:67], v[38:39], v[234:235] op_sel_hi:[1,0,1]
    v_cvt_pk_bf16_f32 v16, v64, v65
    v_cvt_pk_bf16_f32 v17, v66, v67
    s_lshl_b32 exec_lo, 0x00ff00ff, s61
    s_mov_b32 exec_hi, exec_lo
    buffer_store_dwordx2 v[16:17], v4, s[40:43], s12 offen sc1
    s_cmp_lg_u32 s56, 4
    s_cbranch_scc1 L_fin7
    s_mov_b64 exec, 1
    v_mov_b32 v20, 0
    v_mov_b32 v21, s59
    buffer_store_dword v21, v20, s[36:39], 0 offen sc1
L_fin7:
    s_endpgm
L_end:
    s_endpgm
.p2align 7
.type L_tab,@object
L_tab:
.long 0x3f80, 0x3f80, 0x3f80, 0x3f80, 0x3f80, 0x3ec43f6d, 0x3f353f35, 0x3f6d3ec4
.long 0x3f80, 0x3f353f35, 0x3f800000, 0x3f35bf35, 0x3f80, 0x3f6d3ec4, 0x3f35bf35, 0xbec4bf6d
.long 0x3f80, 0x3f800000, 0xbf80, 0xbf800000, 0x3f80, 0x3f6dbec4, 0xbf35bf35, 0xbec43f6d
.long 0x3f80, 0x3f35bf35, 0xbf800000, 0x3f353f35, 0x3f80, 0x3ec4bf6d, 0xbf353f35, 0x3f6dbec4
.long 0x3f80, 0xbf80, 0x3f80, 0xbf80, 0x3f80, 0xbec4bf6d, 0x3f353f35, 0xbf6dbec4
.long 0x3f80, 0xbf35bf35, 0x3f800000, 0xbf353f35, 0x3f80, 0xbf6dbec4, 0x3f35bf35, 0x3ec43f6d
.long 0x3f80, 0xbf800000, 0xbf80, 0x3f800000, 0x3f80, 0xbf6d3ec4, 0xbf35bf35, 0x3ec4bf6d
.long 0x3f80, 0xbf353f35, 0xbf800000, 0xbf35bf35, 0x3f80, 0xbec43f6d, 0xbf353f35, 0xbf6d3ec4
.long 0x3f80, 0x3f80, 0x3f80, 0x3f80, 0x3f800000, 0x3f6dbec4, 0x3f35bf35, 0x3ec4bf6d
.long 0xbf80, 0xbf35bf35, 0xbf800000, 0xbf353f35, 0xbf800000, 0xbec43f6d, 0x3f353f35, 0x3f6dbec4
.long 0x3f80, 0x3f800000, 0xbf80, 0xbf800000, 0x3f800000, 0xbec4bf6d, 0xbf353f35, 0x3f6d3ec4
.long 0xbf80, 0xbf353f35, 0x3f800000, 0xbf35bf35, 0xbf800000, 0x3f6d3ec4, 0xbf35bf35, 0x3ec43f6d
.long 0x3f80, 0xbf80, 0x3f80, 0xbf80, 0x3f800000, 0xbf6d3ec4, 0x3f35bf35, 0xbec43f6d
.long 0xbf80, 0x3f353f35, 0xbf800000, 0x3f35bf35, 0xbf800000, 0x3ec4bf6d, 0x3f353f35, 0xbf6d3ec4
.long 0x3f80, 0xbf800000, 0xbf80, 0x3f800000, 0x3f800000, 0x3ec43f6d, 0xbf353f35, 0xbf6dbec4
.long 0xbf80, 0x3f35bf35, 0x3f800000, 0x3f353f35, 0xbf800000, 0xbf6dbec4, 0xbf35bf35, 0xbec4bf6d
.long 0x3f80, 0x3f80, 0x3f80, 0x3f80, 0xbf80, 0xbec4bf6d, 0xbf35bf35, 0xbf6dbec4
.long 0x3f80, 0x3f353f35, 0x3f800000, 0x3f35bf35, 0xbf80, 0xbf6dbec4, 0xbf353f35, 0x3ec43f6d
.long 0x3f80, 0x3f800000, 0xbf80, 0xbf800000, 0xbf80, 0xbf6d3ec4, 0x3f353f35, 0x3ec4bf6d
.long 0x3f80, 0x3f35bf35, 0xbf800000, 0x3f353f35, 0xbf80, 0xbec43f6d, 0x3f35bf35, 0xbf6d3ec4
.long 0x3f80, 0xbf80, 0x3f80, 0xbf80, 0xbf80, 0x3ec43f6d, 0xbf35bf35, 0x3f6d3ec4
.long 0x3f80, 0xbf35bf35, 0x3f800000, 0xbf353f35, 0xbf80, 0x3f6d3ec4, 0xbf353f35, 0xbec4bf6d
.long 0x3f80, 0xbf800000, 0xbf80, 0x3f800000, 0xbf80, 0x3f6dbec4, 0x3f353f35, 0xbec43f6d
.long 0x3f80, 0xbf353f35, 0xbf800000, 0xbf35bf35, 0xbf80, 0x3ec4bf6d, 0x3f35bf35, 0x3f6dbec4
.long 0x3f80, 0x3f80, 0x3f80, 0x3f80, 0xbf800000, 0xbf6d3ec4, 0xbf353f35, 0xbec43f6d
.long 0xbf80, 0xbf35bf35, 0xbf800000, 0xbf353f35, 0x3f800000, 0x3ec4bf6d, 0xbf35bf35, 0xbf6d3ec4
.long 0x3f80, 0x3f800000, 0xbf80, 0xbf800000, 0xbf800000, 0x3ec43f6d, 0x3f35bf35, 0xbf6dbec4
.long 0xbf80, 0xbf353f35, 0x3f800000, 0xbf35bf35, 0x3f800000, 0xbf6dbec4, 0x3f353f35, 0xbec4bf6d
.long 0x3f80, 0xbf80, 0x3f80, 0xbf80, 0xbf800000, 0x3f6dbec4, 0xbf353f35, 0x3ec4bf6d
.long 0xbf80, 0x3f353f35, 0xbf800000, 0x3f35bf35, 0x3f800000, 0xbec43f6d, 0xbf35bf35, 0x3f6dbec4
.long 0x3f80, 0xbf800000, 0xbf80, 0x3f800000, 0xbf800000, 0xbec4bf6d, 0x3f35bf35, 0x3f6d3ec4
.long 0xbf80, 0x3f35bf35, 0x3f800000, 0x3f353f35, 0x3f800000, 0x3f6d3ec4, 0x3f353f35, 0x3ec43f6d
.long 0x3f808000, 0x3f808000, 0x3f808000, 0x3f808000, 0x3f808000, 0x3f6dbec4, 0x3f35bf35, 0x3ec4bf6d
.long 0x3f808000, 0x3f35bf35, 0xbf80, 0xbf35bf35, 0x3f808000, 0x3ec4bf6d, 0xbf35bf35, 0xbf6d3ec4
.long 0x3f808000, 0xbf80, 0xbf808000, 0x3f80, 0x3f808000, 0xbec4bf6d, 0xbf353f35, 0x3f6d3ec4
.long 0x3f808000, 0xbf35bf35, 0x3f80, 0x3f35bf35, 0x3f808000, 0xbf6dbec4, 0x3f353f35, 0xbec4bf6d
.long 0x3f808000, 0xbf808000, 0x3f808000, 0xbf808000, 0x3f808000, 0xbf6d3ec4, 0x3f35bf35, 0xbec43f6d
.long 0x3f808000, 0xbf353f35, 0xbf80, 0x3f353f35, 0x3f808000, 0xbec43f6d, 0xbf35bf35, 0x3f6dbec4
.long 0x3f808000, 0x3f80, 0xbf808000, 0xbf80, 0x3f808000, 0x3ec43f6d, 0xbf353f35, 0xbf6dbec4
.long 0x3f808000, 0x3f353f35, 0x3f80, 0xbf353f35, 0x3f808000, 0x3f6d3ec4, 0x3f353f35, 0x3ec43f6d
.long 0x3f808000, 0x3f808000, 0x3f808000, 0x3f808000, 0xbf80, 0xbec4bf6d, 0xbf35bf35, 0xbf6dbec4
.long 0xbf808000, 0xbf353f35, 0x3f80, 0x3f353f35, 0x3f80, 0x3f6d3ec4, 0x3f35bf35, 0xbec4bf6d
.long 0x3f808000, 0xbf80, 0xbf808000, 0x3f80, 0xbf80, 0xbf6d3ec4, 0x3f353f35, 0x3ec4bf6d
.long 0xbf808000, 0x3f353f35, 0xbf80, 0xbf353f35, 0x3f80, 0x3ec4bf6d, 0xbf353f35, 0x3f6dbec4
.long 0x3f808000, 0xbf808000, 0x3f808000, 0xbf808000, 0xbf80, 0x3ec43f6d, 0xbf35bf35, 0x3f6d3ec4
.long 0xbf808000, 0x3f35bf35, 0x3f80, 0xbf35bf35, 0x3f80, 0xbf6dbec4, 0x3f35bf35, 0x3ec43f6d
.long 0x3f808000, 0x3f80, 0xbf808000, 0xbf80, 0xbf80, 0x3f6dbec4, 0x3f353f35, 0xbec43f6d
.long 0xbf808000, 0xbf35bf35, 0xbf80, 0x3f35bf35, 0x3f80, 0xbec43f6d, 0xbf353f35, 0xbf6d3ec4
.long 0x3f808000, 0x3f808000, 0x3f808000, 0x3f808000, 0xbf808000, 0xbf6d3ec4, 0xbf353f35, 0xbec43f6d
.long 0x3f808000, 0x3f35bf35, 0xbf80, 0xbf35bf35, 0xbf808000, 0xbec43f6d, 0x3f353f35, 0x3f6dbec4
.long 0x3f808000, 0xbf80, 0xbf808000, 0x3f80, 0xbf808000, 0x3ec43f6d, 0x3f35bf35, 0xbf6dbec4
.long 0x3f808000, 0xbf35bf35, 0x3f80, 0x3f35bf35, 0xbf808000, 0x3f6d3ec4, 0xbf35bf35, 0x3ec43f6d
.long 0x3f808000, 0xbf808000, 0x3f808000, 0xbf808000, 0xbf808000, 0x3f6dbec4, 0xbf353f35, 0x3ec4bf6d
.long 0x3f808000, 0xbf353f35, 0xbf80, 0x3f353f35, 0xbf808000, 0x3ec4bf6d, 0x3f353f35, 0xbf6d3ec4
.long 0x3f808000, 0x3f80, 0xbf808000, 0xbf80, 0xbf808000, 0xbec4bf6d, 0x3f35bf35, 0x3f6d3ec4
.long 0x3f808000, 0x3f353f35, 0x3f80, 0xbf353f35, 0xbf808000, 0xbf6dbec4, 0xbf35bf35, 0xbec4bf6d
.long 0x3f808000, 0x3f808000, 0x3f808000, 0x3f808000, 0x3f80, 0x3ec43f6d, 0x3f353f35, 0x3f6d3ec4
.long 0xbf808000, 0xbf353f35, 0x3f80, 0x3f353f35, 0xbf80, 0xbf6dbec4, 0xbf353f35, 0x3ec43f6d
.long 0x3f808000, 0xbf80, 0xbf808000, 0x3f80, 0x3f80, 0x3f6dbec4, 0xbf35bf35, 0xbec43f6d
.long 0xbf808000, 0x3f353f35, 0xbf80, 0xbf353f35, 0xbf80, 0xbec43f6d, 0x3f35bf35, 0xbf6d3ec4
.long 0x3f808000, 0xbf808000, 0x3f808000, 0xbf808000, 0x3f80, 0xbec4bf6d, 0x3f353f35, 0xbf6dbec4
.long 0xbf808000, 0x3f35bf35, 0x3f80, 0xbf35bf35, 0xbf80, 0x3f6d3ec4, 0xbf353f35, 0xbec4bf6d
.long 0x3f808000, 0x3f80, 0xbf808000, 0xbf80, 0x3f80, 0xbf6d3ec4, 0xbf35bf35, 0x3ec4bf6d
.long 0xbf808000, 0xbf35bf35, 0xbf80, 0x3f35bf35, 0xbf80, 0x3ec4bf6d, 0x3f35bf35, 0x3f6dbec4
.long 0x3f800000, 0x3f800000, 0x3f800000, 0x3f800000, 0x3f800000, 0x3f7fec43, 0x3f7fb10f, 0x3f7f4e6d
.long 0x3f800000, 0x3f7fb10f, 0x3f7ec46d, 0x3f7d3aac, 0x3f800000, 0x3f7f4e6d, 0x3f7d3aac, 0x3f79c79d
.long 0x3f800000, 0x3f7ec46d, 0x3f7b14be, 0x3f74fa0b, 0x3f800000, 0x3f7e1324, 0x3f7853f8, 0x3f6ed89e
.long 0x3f800000, 0x3f7d3aac, 0x3f74fa0b, 0x3f676bd8, 0x3f800000, 0x3f7c3b28, 0x3f710908, 0x3f5ebe05
.long 0x3f800000, 0x3f7b14be, 0x3f6c835e, 0x3f54db31, 0x3f800000, 0x3f79c79d, 0x3f676bd8, 0x3f49d112
.long 0x3f800000, 0x3f7853f8, 0x3f61c598, 0x3f3daef9, 0x3f800000, 0x3f76ba07, 0x3f5b941a, 0x3f3085bb
.long 0x3f800000, 0x3f74fa0b, 0x3f54db31, 0x3f226799, 0x3f800000, 0x3f731447, 0x3f4d9f02, 0x3f13682a
.long 0x3f800000, 0x3f710908, 0x3f45e403, 0x3f039c3d, 0x3f800000, 0x3f6ed89e, 0x3f3daef9, 0x3ee63375
.long 0x3f800000, 0x3f800000, 0x3f800000, 0x3f800000, 0x3f7ec46d, 0x3f7e1324, 0x3f7d3aac, 0x3f7c3b28
.long 0x3f7b14be, 0x3f7853f8, 0x3f74fa0b, 0x3f710908, 0x3f74fa0b, 0x3f6ed89e, 0x3f676bd8, 0x3f5ebe05
.long 0x3f6c835e, 0x3f61c598, 0x3f54db31, 0x3f45e403, 0x3f61c598, 0x3f514d3d, 0x3f3daef9, 0x3f273656
.long 0x3f54db31, 0x3f3daef9, 0x3f226799, 0x3f039c3d, 0x3f45e403, 0x3f273656, 0x3f039c3d, 0x3eb8442a
.long 0x3f3504f3, 0x3f0e39da, 0x3ec3ef15, 0x3e47c5c2, 0x3f226799, 0x3ee63375, 0x3e78cfcc, 0x3cc90ab0
.long 0x3f0e39da, 0x3eac7cd4, 0x3dc8bd36, 0xbe164083, 0x3ef15aea, 0x3e605c13, 0xbd48fb30, 0xbea09ae5
.long 0x3ec3ef15, 0x3dc8bd36, 0xbe47c5c2, 0xbef15aea, 0x3e94a031, 0xbcc90ab0, 0xbeac7cd4, 0xbf1d7fd1
.long 0x3e47c5c2, 0xbe164083, 0xbef15aea, 0xbf3daef9, 0x3dc8bd36, 0xbe888e93, 0xbf187fc0, 0xbf584853
.long 0x3f800000, 0x3f800000, 0x3f800000, 0x3f800000, 0x3f7b14be, 0x3f79c79d, 0x3f7853f8, 0x3f76ba07
.long 0x3f6c835e, 0x3f676bd8, 0x3f61c598, 0x3f5b941a, 0x3f54db31, 0x3f49d112, 0x3f3daef9, 0x3f3085bb
.long 0x3f3504f3, 0x3f226799, 0x3f0e39da, 0x3ef15aea, 0x3f0e39da, 0x3ee63375, 0x3eac7cd4, 0x3e605c13
.long 0x3ec3ef15, 0x3e78cfcc, 0x3dc8bd36, 0xbd48fb30, 0x3e47c5c2, 0x3cc90ab0, 0xbe164083, 0xbea09ae5
.long 0x0, 0xbe47c5c2, 0xbec3ef15, 0xbf0e39da, 0xbe47c5c2, 0xbecf7bca, 0xbf187fc0, 0xbf41d870
.long 0xbec3ef15, 0xbf187fc0, 0xbf45e403, 0xbf676bd8, 0xbf0e39da, 0xbf41d870, 0xbf676bd8, 0xbf7c3b28
.long 0xbf3504f3, 0xbf61c598, 0xbf7b14be, 0xbf7ec46d, 0xbf54db31, 0xbf76ba07, 0xbf7fb10f, 0xbf6ed89e
.long 0xbf6c835e, 0xbf7fb10f, 0xbf74fa0b, 0xbf4d9f02, 0xbf7b14be, 0xbf7c3b28, 0xbf5b941a, 0xbf1d7fd1
.long 0x3f800000, 0x3f800000, 0x3f800000, 0x3f800000, 0x3f74fa0b, 0x3f731447, 0x3f710908, 0x3f6ed89e
.long 0x3f54db31, 0x3f4d9f02, 0x3f45e403, 0x3f3daef9, 0x3f226799, 0x3f13682a, 0x3f039c3d, 0x3ee63375
.long 0x3ec3ef15, 0x3e94a031, 0x3e47c5c2, 0x3dc8bd36, 0x3dc8bd36, 0xbcc90ab0, 0xbe164083, 0xbe888e93
.long 0xbe47c5c2, 0xbeac7cd4, 0xbef15aea, 0xbf187fc0, 0xbef15aea, 0xbf1d7fd1, 0xbf3daef9, 0xbf584853
.long 0xbf3504f3, 0xbf54db31, 0xbf6c835e, 0xbf7b14be, 0xbf61c598, 0xbf76ba07, 0xbf7fb10f, 0xbf7c3b28
.long 0xbf7b14be, 0xbf7fb10f, 0xbf74fa0b, 0xbf5b941a, 0xbf7ec46d, 0xbf6ed89e, 0xbf4d9f02, 0xbf1d7fd1
.long 0xbf6c835e, 0xbf45e403, 0xbf0e39da, 0xbe94a031, 0xbf45e403, 0xbf08f59b, 0xbe78cfcc, 0x3d96a905
.long 0xbf0e39da, 0xbe78cfcc, 0x3dc8bd36, 0x3edae880, 0xbe94a031, 0x3d96a905, 0x3edae880, 0x3f396842
.long 0x0, 0x0, 0x0, 0x0, 0x0, 0x3cc90ab0, 0x3d48fb30, 0x3d96a905
.long 0x0, 0x3d48fb30, 0x3dc8bd36, 0x3e164083, 0x0, 0x3d96a905, 0x3e164083, 0x3e605c13
.long 0x0, 0x3dc8bd36, 0x3e47c5c2, 0x3e94a031, 0x0, 0x3dfab273, 0x3e78cfcc, 0x3eb8442a
.long 0x0, 0x3e164083, 0x3e94a031, 0x3edae880, 0x0, 0x3e2f10a2, 0x3eac7cd4, 0x3efc5d27
.long 0x0, 0x3e47c5c2, 0x3ec3ef15, 0x3f0e39da, 0x0, 0x3e605c13, 0x3edae880, 0x3f1d7fd1
.long 0x0, 0x3e78cfcc, 0x3ef15aea, 0x3f2beb4a, 0x0, 0x3e888e93, 0x3f039c3d, 0x3f396842
.long 0x0, 0x3e94a031, 0x3f0e39da, 0x3f45e403, 0x0, 0x3ea09ae5, 0x3f187fc0, 0x3f514d3d
.long 0x0, 0x3eac7cd4, 0x3f226799, 0x3f5b941a, 0x0, 0x3eb8442a, 0x3f2beb4a, 0x3f64aa59
.long 0x0, 0x0, 0x0, 0x0, 0x3dc8bd36, 0x3dfab273, 0x3e164083, 0x3e2f10a2
.long 0x3e47c5c2, 0x3e78cfcc, 0x3e94a031, 0x3eac7cd4, 0x3e94a031, 0x3eb8442a, 0x3edae880, 0x3efc5d27
.long 0x3ec3ef15, 0x3ef15aea, 0x3f0e39da, 0x3f226799, 0x3ef15aea, 0x3f13682a, 0x3f2beb4a, 0x3f41d870
.long 0x3f0e39da, 0x3f2beb4a, 0x3f45e403, 0x3f5b941a, 0x3f226799, 0x3f41d870, 0x3f5b941a, 0x3f6ed89e
.long 0x3f3504f3, 0x3f54db31, 0x3f6c835e, 0x3f7b14be, 0x3f45e403, 0x3f64aa59, 0x3f7853f8, 0x3f7fec43
.long 0x3f54db31, 0x3f710908, 0x3f7ec46d, 0x3f7d3aac, 0x3f61c598, 0x3f79c79d, 0x3f7fb10f, 0x3f731447
.long 0x3f6c835e, 0x3f7ec46d, 0x3f7b14be, 0x3f61c598, 0x3f74fa0b, 0x3f7fec43, 0x3f710908, 0x3f49d112
.long 0x3f7b14be, 0x3f7d3aac, 0x3f61c598, 0x3f2beb4a, 0x3f7ec46d, 0x3f76ba07, 0x3f4d9f02, 0x3f08f59b
.long 0x0, 0x0, 0x0, 0x0, 0x3e47c5c2, 0x3e605c13, 0x3e78cfcc, 0x3e888e93
.long 0x3ec3ef15, 0x3edae880, 0x3ef15aea, 0x3f039c3d, 0x3f0e39da, 0x3f1d7fd1, 0x3f2beb4a, 0x3f396842
.long 0x3f3504f3, 0x3f45e403, 0x3f54db31, 0x3f61c598, 0x3f54db31, 0x3f64aa59, 0x3f710908, 0x3f79c79d
.long 0x3f6c835e, 0x3f7853f8, 0x3f7ec46d, 0x3f7fb10f, 0x3f7b14be, 0x3f7fec43, 0x3f7d3aac, 0x3f731447
.long 0x3f800000, 0x3f7b14be, 0x3f6c835e, 0x3f54db31, 0x3f7b14be, 0x3f6a09a7, 0x3f4d9f02, 0x3f273656
.long 0x3f6c835e, 0x3f4d9f02, 0x3f226799, 0x3edae880, 0x3f54db31, 0x3f273656, 0x3edae880, 0x3e2f10a2
.long 0x3f3504f3, 0x3ef15aea, 0x3e47c5c2, 0xbdc8bd36, 0x3f0e39da, 0x3e888e93, 0xbd48fb30, 0xbeb8442a
.long 0x3ec3ef15, 0x3d48fb30, 0xbe94a031, 0xbf187fc0, 0x3e47c5c2, 0xbe2f10a2, 0xbf039c3d, 0xbf49d112
.long 0x0, 0x0, 0x0, 0x0, 0x3e94a031, 0x3ea09ae5, 0x3eac7cd4, 0x3eb8442a
.long 0x3f0e39da, 0x3f187fc0, 0x3f226799, 0x3f2beb4a, 0x3f45e403, 0x3f514d3d, 0x3f5b941a, 0x3f64aa59
.long 0x3f6c835e, 0x3f74fa0b, 0x3f7b14be, 0x3f7ec46d, 0x3f7ec46d, 0x3f7fec43, 0x3f7d3aac, 0x3f76ba07
.long 0x3f7b14be, 0x3f710908, 0x3f61c598, 0x3f4d9f02, 0x3f61c598, 0x3f49d112, 0x3f2beb4a, 0x3f08f59b
.long 0x3f3504f3, 0x3f0e39da, 0x3ec3ef15, 0x3e47c5c2, 0x3ef15aea, 0x3e888e93, 0x3d48fb30, 0xbe2f10a2
.long 0x3e47c5c2, 0xbd48fb30, 0xbe94a031, 0xbf039c3d, 0xbdc8bd36, 0xbeb8442a, 0xbf187fc0, 0xbf49d112
.long 0xbec3ef15, 0xbf226799, 0xbf54db31, 0xbf74fa0b, 0xbf226799, 0xbf584853, 0xbf7853f8, 0xbf7f4e6d
.long 0xbf54db31, 0xbf7853f8, 0xbf7ec46d, 0xbf676bd8, 0xbf74fa0b, 0xbf7f4e6d, 0xbf676bd8, 0xbf3085bb
.long 0x3f800000, 0x3f800000, 0x3f800000, 0x3f800000, 0x3f7ffb11, 0x3f7fd397, 0x3f7f84ab, 0x3f7f0e58
.long 0x3f7fec43, 0x3f7f4e6d, 0x3f7e1324, 0x3f7c3b28, 0x3f7fd397, 0x3f7e70b0, 0x3f7baccd, 0x3f778bc5
.long 0x3f7fb10f, 0x3f7d3aac, 0x3f7853f8, 0x3f710908, 0x3f7f84ab, 0x3f7baccd, 0x3f740bdd, 0x3f68bf3c
.long 0x3f7f4e6d, 0x3f79c79d, 0x3f6ed89e, 0x3f5ebe05, 0x3f7f0e58, 0x3f778bc5, 0x3f68bf3c, 0x3f531849
.long 0x3f7ec46d, 0x3f74fa0b, 0x3f61c598, 0x3f45e403, 0x3f7e70b0, 0x3f721352, 0x3f59f26a, 0x3f373a23
.long 0x3f7e1324, 0x3f6ed89e, 0x3f514d3d, 0x3f273656, 0x3f7dabcc, 0x3f6b4b0c, 0x3f47de65, 0x3f15f6d9
.long 0x3f7d3aac, 0x3f676bd8, 0x3f3daef9, 0x3f039c3d, 0x3f7cbfc9, 0x3f633c5a, 0x3f32c8c9, 0x3ee0924f
.long 0x3f7c3b28, 0x3f5ebe05, 0x3f273656, 0x3eb8442a, 0x3f7baccd, 0x3f59f26a, 0x3f1b02c6, 0x3e8e9a22
.long 0x3f800000, 0x3f800000, 0x3f800000, 0x3f800000, 0x3f7e70b0, 0x3f7dabcc, 0x3f7cbfc9, 0x3f7baccd
.long 0x3f79c79d, 0x3f76ba07, 0x3f731447, 0x3f6ed89e, 0x3f721352, 0x3f6b4b0c, 0x3f633c5a, 0x3f59f26a
.long 0x3f676bd8, 0x3f5b941a, 0x3f4d9f02, 0x3f3daef9, 0x3f59f26a, 0x3f47de65, 0x3f32c8c9, 0x3f1b02c6
.long 0x3f49d112, 0x3f3085bb, 0x3f13682a, 0x3ee63375, 0x3f373a23, 0x3f15f6d9, 0x3ee0924f, 0x3e8e9a22
.long 0x3f226799, 0x3ef15aea, 0x3e94a031, 0x3dc8bd36, 0x3f0b9a6b, 0x3eb263ef, 0x3e09cf86, 0xbdafb680
.long 0x3ee63375, 0x3e605c13, 0xbcc90ab0, 0xbe888e93, 0x3eb263ef, 0x3dafb680, 0xbe3b6ecf, 0xbee0924f
.long 0x3e78cfcc, 0xbd48fb30, 0xbeac7cd4, 0xbf187fc0, 0x3e09cf86, 0xbe3b6ecf, 0xbef6e0cb, 0xbf3b8f3b
.long 0x3cc90ab0, 0xbea09ae5, 0xbf1d7fd1, 0xbf584853, 0xbdafb680, 0xbee0924f, 0xbf3b8f3b, 0xbf6db293
.long 0x3f800000, 0x3f800000, 0x3f800000, 0x3f800000, 0x3f7a7302, 0x3f791298, 0x3f778bc5, 0x3f75dec6
.long 0x3f6a09a7, 0x3f64aa59, 0x3f5ebe05, 0x3f584853, 0x3f4f7a1f, 0x3f43e200, 0x3f373a23, 0x3f299415
.long 0x3f2beb4a, 0x3f187fc0, 0x3f039c3d, 0x3edae880, 0x3f00e7e4, 0x3ec9b953, 0x3e8e9a22, 0x3e22abb6
.long 0x3ea09ae5, 0x3e2f10a2, 0x3cc90ab0, 0xbdfab273, 0x3de1bc2e, 0xbd7b2b74, 0xbe6c9a7f, 0xbec9b953
.long 0xbdc8bd36, 0xbe94a031, 0xbef15aea, 0xbf226799, 0xbe9aa086, 0xbf00e7e4, 0xbf2e3bde, 0xbf531849
.long 0xbefc5d27, 0xbf3085bb, 0xbf584853, 0xbf731447, 0xbf299415, 0xbf5695e5, 0xbf740bdd, 0xbf7fd397
.long 0xbf4d9f02, 0xbf710908, 0xbf7fb10f, 0xbf7853f8, 0xbf68bf3c, 0xbf7e70b0, 0xbf7a7302, 0xbf5d2d53
.long 0xbf79c79d, 0xbf7e1324, 0xbf64aa59, 0xbf3085bb, 0xbf7ffb11, 0xbf6ff573, 0xbf3fc767, 0xbeebcbbb
.long 0x3f800000, 0x3f800000, 0x3f800000, 0x3f800000, 0x3f740bdd, 0x3f721352, 0x3f6ff573, 0x3f6db293
.long 0x3f514d3d, 0x3f49d112, 0x3f41d870, 0x3f396842, 0x3f1b02c6, 0x3f0b9a6b, 0x3ef6e0cb, 0x3ed53641
.long 0x3eac7cd4, 0x3e78cfcc, 0x3e164083, 0x3d48fb30, 0x3d16c32c, 0xbdafb680, 0xbe541501, 0xbea68f12
.long 0xbe888e93, 0xbecf7bca, 0xbf08f59b, 0xbf273656, 0xbf0b9a6b, 0xbf2e3bde, 0xbf4bbbf8, 0xbf633c5a
.long 0xbf45e403, 0xbf61c598, 0xbf74fa0b, 0xbf7ec46d, 0xbf6db293, 0xbf7cbfc9, 0xbf7f84ab, 0xbf75dec6
.long 0xbf7f4e6d, 0xbf7c3b28, 0xbf6a09a7, 0xbf49d112, 0xbf791298, 0xbf604621, 0xbf373a23, 0xbf00e7e4
.long 0xbf5b941a, 0xbf2beb4a, 0xbedae880, 0xbe164083, 0xbf299415, 0xbec9b953, 0xbdafb680, 0x3e6c9a7f
.long 0xbecf7bca, 0xbd96a905, 0x3e888e93, 0x3f13682a, 0xbde1bc2e, 0x3e827dc0, 0x3f15f6d9, 0x3f5695e5
.long 0x0, 0x0, 0x0, 0x0, 0x3c490e90, 0x3d16c32c, 0x3d7b2b74, 0x3dafb680
.long 0x3cc90ab0, 0x3d96a905, 0x3dfab273, 0x3e2f10a2, 0x3d16c32c, 0x3de1bc2e, 0x3e3b6ecf, 0x3e827dc0
.long 0x3d48fb30, 0x3e164083, 0x3e78cfcc, 0x3eac7cd4, 0x3d7b2b74, 0x3e3b6ecf, 0x3e9aa086, 0x3ed53641
.long 0x3d96a905, 0x3e605c13, 0x3eb8442a, 0x3efc5d27, 0x3dafb680, 0x3e827dc0, 0x3ed53641, 0x3f10d3cd
.long 0x3dc8bd36, 0x3e94a031, 0x3ef15aea, 0x3f226799, 0x3de1bc2e, 0x3ea68f12, 0x3f064b82, 0x3f32c8c9
.long 0x3dfab273, 0x3eb8442a, 0x3f13682a, 0x3f41d870, 0x3e09cf86, 0x3ec9b953, 0x3f1ff6cb, 0x3f4f7a1f
.long 0x3e164083, 0x3edae880, 0x3f2beb4a, 0x3f5b941a, 0x3e22abb6, 0x3eebcbbb, 0x3f373a23, 0x3f660f88
.long 0x3e2f10a2, 0x3efc5d27, 0x3f41d870, 0x3f6ed89e, 0x3e3b6ecf, 0x3f064b82, 0x3f4bbbf8, 0x3f75dec6
.long 0x0, 0x0, 0x0, 0x0, 0x3de1bc2e, 0x3e09cf86, 0x3e22abb6, 0x3e3b6ecf
.long 0x3e605c13, 0x3e888e93, 0x3ea09ae5, 0x3eb8442a, 0x3ea68f12, 0x3ec9b953, 0x3eebcbbb, 0x3f064b82
.long 0x3edae880, 0x3f039c3d, 0x3f187fc0, 0x3f2beb4a, 0x3f064b82, 0x3f1ff6cb, 0x3f373a23, 0x3f4bbbf8
.long 0x3f1d7fd1, 0x3f396842, 0x3f514d3d, 0x3f64aa59, 0x3f32c8c9, 0x3f4f7a1f, 0x3f660f88, 0x3f75dec6
.long 0x3f45e403, 0x3f61c598, 0x3f74fa0b, 0x3f7ec46d, 0x3f5695e5, 0x3f6ff573, 0x3f7dabcc, 0x3f7f0e58
.long 0x3f64aa59, 0x3f79c79d, 0x3f7fec43, 0x3f76ba07, 0x3f6ff573, 0x3f7f0e58, 0x3f7baccd, 0x3f660f88
.long 0x3f7853f8, 0x3f7fb10f, 0x3f710908, 0x3f4d9f02, 0x3f7dabcc, 0x3f7baccd, 0x3f604621, 0x3f2e3bde
.long 0x3f7fec43, 0x3f731447, 0x3f49d112, 0x3f08f59b, 0x3f7f0e58, 0x3f660f88, 0x3f2e3bde, 0x3ebe1d4a
.long 0x0, 0x0, 0x0, 0x0, 0x3e541501, 0x3e6c9a7f, 0x3e827dc0, 0x3e8e9a22
.long 0x3ecf7bca, 0x3ee63375, 0x3efc5d27, 0x3f08f59b, 0x3f15f6d9, 0x3f24d225, 0x3f32c8c9, 0x3f3fc767
.long 0x3f3daef9, 0x3f4d9f02, 0x3f5b941a, 0x3f676bd8, 0x3f5d2d53, 0x3f6b4b0c, 0x3f75dec6, 0x3f7cbfc9
.long 0x3f731447, 0x3f7c3b28, 0x3f7fec43, 0x3f7e1324, 0x3f7e70b0, 0x3f7f84ab, 0x3f791298, 0x3f6b4b0c
.long 0x3f7ec46d, 0x3f74fa0b, 0x3f61c598, 0x3f45e403, 0x3f740bdd, 0x3f5d2d53, 0x3f3b8f3b, 0x3f10d3cd
.long 0x3f5ebe05, 0x3f396842, 0x3f08f59b, 0x3ea09ae5, 0x3f3fc767, 0x3f0b9a6b, 0x3e9aa086, 0x3d16c32c
.long 0x3f187fc0, 0x3eac7cd4, 0x3d48fb30, 0xbe78cfcc, 0x3ed53641, 0x3de1bc2e, 0xbe541501, 0xbf00e7e4
.long 0x3e605c13, 0xbdfab273, 0xbee63375, 0xbf396842, 0x3c490e90, 0xbeb263ef, 0xbf299415, 0xbf633c5a
.long 0x0, 0x0, 0x0, 0x0, 0x3e9aa086, 0x3ea68f12, 0x3eb263ef, 0x3ebe1d4a
.long 0x3f13682a, 0x3f1d7fd1, 0x3f273656, 0x3f3085bb, 0x3f4bbbf8, 0x3f5695e5, 0x3f604621, 0x3f68bf3c
.long 0x3f710908, 0x3f7853f8, 0x3f7d3aac, 0x3f7fb10f, 0x3f7fd397, 0x3f7f0e58, 0x3f7a7302, 0x3f721352
.long 0x3f76ba07, 0x3f6a09a7, 0x3f584853, 0x3f41d870, 0x3f5695e5, 0x3f3b8f3b, 0x3f1b02c6, 0x3eebcbbb
.long 0x3f226799, 0x3ef15aea, 0x3e94a031, 0x3dc8bd36, 0x3ebe1d4a, 0x3e22abb6, 0xbd7b2b74, 0xbe8e9a22
.long 0x3d96a905, 0xbe2f10a2, 0xbecf7bca, 0xbf1d7fd1, 0xbe6c9a7f, 0xbef6e0cb, 0xbf32c8c9, 0xbf5d2d53
.long 0xbf039c3d, 0xbf3daef9, 0xbf676bd8, 0xbf7d3aac, 0xbf3fc767, 0xbf6b4b0c, 0xbf7f0e58, 0xbf791298
.long 0xbf6a09a7, 0xbf7f4e6d, 0xbf76ba07, 0xbf514d3d, 0xbf7e70b0, 0xbf778bc5, 0xbf4f7a1f, 0xbf0b9a6b
.long 0x3f80, 0x3f80, 0x3f80, 0x3f80, 0x3f80, 0x3ec43f6d, 0x3f353f35, 0x3f6d3ec4
.long 0x3f80, 0x3f353f35, 0x3f800000, 0x3f35bf35, 0x3f80, 0x3f6d3ec4, 0x3f35bf35, 0xbec4bf6d
.long 0x3f80, 0x3f800000, 0xbf80, 0xbf800000, 0x3f80, 0x3f6dbec4, 0xbf35bf35, 0xbec43f6d
.long 0x3f80, 0x3f35bf35, 0xbf800000, 0x3f353f35, 0x3f80, 0x3ec4bf6d, 0xbf353f35, 0x3f6dbec4
.long 0x3f80, 0xbf80, 0x3f80, 0xbf80, 0x3f80, 0xbec4bf6d, 0x3f353f35, 0xbf6dbec4
.long 0x3f80, 0xbf35bf35, 0x3f800000, 0xbf353f35, 0x3f80, 0xbf6dbec4, 0x3f35bf35, 0x3ec43f6d
.long 0x3f80, 0xbf800000, 0xbf80, 0x3f800000, 0x3f80, 0xbf6d3ec4, 0xbf35bf35, 0x3ec4bf6d
.long 0x3f80, 0xbf353f35, 0xbf800000, 0xbf35bf35, 0x3f80, 0xbec43f6d, 0xbf353f35, 0xbf6d3ec4
.long 0x3f80, 0x3f80, 0x3f80, 0x3f80, 0x3f800000, 0x3f6dbec4, 0x3f35bf35, 0x3ec4bf6d
.long 0xbf80, 0xbf35bf35, 0xbf800000, 0xbf353f35, 0xbf800000, 0xbec43f6d, 0x3f353f35, 0x3f6dbec4
.long 0x3f80, 0x3f800000, 0xbf80, 0xbf800000, 0x3f800000, 0xbec4bf6d, 0xbf353f35, 0x3f6d3ec4
.long 0xbf80, 0xbf353f35, 0x3f800000, 0xbf35bf35, 0xbf800000, 0x3f6d3ec4, 0xbf35bf35, 0x3ec43f6d
.long 0x3f80, 0xbf80, 0x3f80, 0xbf80, 0x3f800000, 0xbf6d3ec4, 0x3f35bf35, 0xbec43f6d
.long 0xbf80, 0x3f353f35, 0xbf800000, 0x3f35bf35, 0xbf800000, 0x3ec4bf6d, 0x3f353f35, 0xbf6d3ec4
.long 0x3f80, 0xbf800000, 0xbf80, 0x3f800000, 0x3f800000, 0x3ec43f6d, 0xbf353f35, 0xbf6dbec4
.long 0xbf80, 0x3f35bf35, 0x3f800000, 0x3f353f35, 0xbf800000, 0xbf6dbec4, 0xbf35bf35, 0xbec4bf6d
.long 0x3f80, 0x3f80, 0x3f80, 0x3f80, 0xbf80, 0xbec4bf6d, 0xbf35bf35, 0xbf6dbec4
.long 0x3f80, 0x3f353f35, 0x3f800000, 0x3f35bf35, 0xbf80, 0xbf6dbec4, 0xbf353f35, 0x3ec43f6d
.long 0x3f80, 0x3f800000, 0xbf80, 0xbf800000, 0xbf80, 0xbf6d3ec4, 0x3f353f35, 0x3ec4bf6d
.long 0x3f80, 0x3f35bf35, 0xbf800000, 0x3f353f35, 0xbf80, 0xbec43f6d, 0x3f35bf35, 0xbf6d3ec4
.long 0x3f80, 0xbf80, 0x3f80, 0xbf80, 0xbf80, 0x3ec43f6d, 0xbf35bf35, 0x3f6d3ec4
.long 0x3f80, 0xbf35bf35, 0x3f800000, 0xbf353f35, 0xbf80, 0x3f6d3ec4, 0xbf353f35, 0xbec4bf6d
.long 0x3f80, 0xbf800000, 0xbf80, 0x3f800000, 0xbf80, 0x3f6dbec4, 0x3f353f35, 0xbec43f6d
.long 0x3f80, 0xbf353f35, 0xbf800000, 0xbf35bf35, 0xbf80, 0x3ec4bf6d, 0x3f35bf35, 0x3f6dbec4
.long 0x3f80, 0x3f80, 0x3f80, 0x3f80, 0xbf800000, 0xbf6d3ec4, 0xbf353f35, 0xbec43f6d
.long 0xbf80, 0xbf35bf35, 0xbf800000, 0xbf353f35, 0x3f800000, 0x3ec4bf6d, 0xbf35bf35, 0xbf6d3ec4
.long 0x3f80, 0x3f800000, 0xbf80, 0xbf800000, 0xbf800000, 0x3ec43f6d, 0x3f35bf35, 0xbf6dbec4
.long 0xbf80, 0xbf353f35, 0x3f800000, 0xbf35bf35, 0x3f800000, 0xbf6dbec4, 0x3f353f35, 0xbec4bf6d
.long 0x3f80, 0xbf80, 0x3f80, 0xbf80, 0xbf800000, 0x3f6dbec4, 0xbf353f35, 0x3ec4bf6d
.long 0xbf80, 0x3f353f35, 0xbf800000, 0x3f35bf35, 0x3f800000, 0xbec43f6d, 0xbf35bf35, 0x3f6dbec4
.long 0x3f80, 0xbf800000, 0xbf80, 0x3f800000, 0xbf800000, 0xbec4bf6d, 0x3f35bf35, 0x3f6d3ec4
.long 0xbf80, 0x3f35bf35, 0x3f800000, 0x3f353f35, 0x3f800000, 0x3f6d3ec4, 0x3f353f35, 0x3ec43f6d
.long 0x3f80, 0x3f80, 0x3f80, 0x3f80, 0x3f80, 0x3ec43f6d, 0x3f353f35, 0x3f6d3ec4
.long 0x3f80, 0x3f353f35, 0x3f800000, 0x3f35bf35, 0x3f80, 0x3f6d3ec4, 0x3f35bf35, 0xbec4bf6d
.long 0x3f80, 0x3f800000, 0xbf80, 0xbf800000, 0x3f80, 0x3f6dbec4, 0xbf35bf35, 0xbec43f6d
.long 0x3f80, 0x3f35bf35, 0xbf800000, 0x3f353f35, 0x3f80, 0x3ec4bf6d, 0xbf353f35, 0x3f6dbec4
.long 0x3f80, 0xbf80, 0x3f80, 0xbf80, 0x3f80, 0xbec4bf6d, 0x3f353f35, 0xbf6dbec4
.long 0x3f80, 0xbf35bf35, 0x3f800000, 0xbf353f35, 0x3f80, 0xbf6dbec4, 0x3f35bf35, 0x3ec43f6d
.long 0x3f80, 0xbf800000, 0xbf80, 0x3f800000, 0x3f80, 0xbf6d3ec4, 0xbf35bf35, 0x3ec4bf6d
.long 0x3f80, 0xbf353f35, 0xbf800000, 0xbf35bf35, 0x3f80, 0xbec43f6d, 0xbf353f35, 0xbf6d3ec4
.long 0x3f80, 0x3f80, 0x3f80, 0x3f80, 0x3f800000, 0x3f6dbec4, 0x3f35bf35, 0x3ec4bf6d
.long 0xbf80, 0xbf35bf35, 0xbf800000, 0xbf353f35, 0xbf800000, 0xbec43f6d, 0x3f353f35, 0x3f6dbec4
.long 0x3f80, 0x3f800000, 0xbf80, 0xbf800000, 0x3f800000, 0xbec4bf6d, 0xbf353f35, 0x3f6d3ec4
.long 0xbf80, 0xbf353f35, 0x3f800000, 0xbf35bf35, 0xbf800000, 0x3f6d3ec4, 0xbf35bf35, 0x3ec43f6d
.long 0x3f80, 0xbf80, 0x3f80, 0xbf80, 0x3f800000, 0xbf6d3ec4, 0x3f35bf35, 0xbec43f6d
.long 0xbf80, 0x3f353f35, 0xbf800000, 0x3f35bf35, 0xbf800000, 0x3ec4bf6d, 0x3f353f35, 0xbf6d3ec4
.long 0x3f80, 0xbf800000, 0xbf80, 0x3f800000, 0x3f800000, 0x3ec43f6d, 0xbf353f35, 0xbf6dbec4
.long 0xbf80, 0x3f35bf35, 0x3f800000, 0x3f353f35, 0xbf800000, 0xbf6dbec4, 0xbf35bf35, 0xbec4bf6d
.long 0x3f80, 0x3f80, 0x3f80, 0x3f80, 0xbf80, 0xbec4bf6d, 0xbf35bf35, 0xbf6dbec4
.long 0x3f80, 0x3f353f35, 0x3f800000, 0x3f35bf35, 0xbf80, 0xbf6dbec4, 0xbf353f35, 0x3ec43f6d
.long 0x3f80, 0x3f800000, 0xbf80, 0xbf800000, 0xbf80, 0xbf6d3ec4, 0x3f353f35, 0x3ec4bf6d
.long 0x3f80, 0x3f35bf35, 0xbf800000, 0x3f353f35, 0xbf80, 0xbec43f6d, 0x3f35bf35, 0xbf6d3ec4
.long 0x3f80, 0xbf80, 0x3f80, 0xbf80, 0xbf80, 0x3ec43f6d, 0xbf35bf35, 0x3f6d3ec4
.long 0x3f80, 0xbf35bf35, 0x3f800000, 0xbf353f35, 0xbf80, 0x3f6d3ec4, 0xbf353f35, 0xbec4bf6d
.long 0x3f80, 0xbf800000, 0xbf80, 0x3f800000, 0xbf80, 0x3f6dbec4, 0x3f353f35, 0xbec43f6d
.long 0x3f80, 0xbf353f35, 0xbf800000, 0xbf35bf35, 0xbf80, 0x3ec4bf6d, 0x3f35bf35, 0x3f6dbec4
.long 0x3f80, 0x3f80, 0x3f80, 0x3f80, 0xbf800000, 0xbf6d3ec4, 0xbf353f35, 0xbec43f6d
.long 0xbf80, 0xbf35bf35, 0xbf800000, 0xbf353f35, 0x3f800000, 0x3ec4bf6d, 0xbf35bf35, 0xbf6d3ec4
.long 0x3f80, 0x3f800000, 0xbf80, 0xbf800000, 0xbf800000, 0x3ec43f6d, 0x3f35bf35, 0xbf6dbec4
.long 0xbf80, 0xbf353f35, 0x3f800000, 0xbf35bf35, 0x3f800000, 0xbf6dbec4, 0x3f353f35, 0xbec4bf6d
.long 0x3f80, 0xbf80, 0x3f80, 0xbf80, 0xbf800000, 0x3f6dbec4, 0xbf353f35, 0x3ec4bf6d
.long 0xbf80, 0x3f353f35, 0xbf800000, 0x3f35bf35, 0x3f800000, 0xbec43f6d, 0xbf35bf35, 0x3f6dbec4
.long 0x3f80, 0xbf800000, 0xbf80, 0x3f800000, 0xbf800000, 0xbec4bf6d, 0x3f35bf35, 0x3f6d3ec4
.long 0xbf80, 0x3f35bf35, 0x3f800000, 0x3f353f35, 0x3f800000, 0x3f6d3ec4, 0x3f353f35, 0x3ec43f6d
.long 0x3f80, 0x3f80, 0x3f80, 0x3f80, 0x3e483f7b, 0x3f0e3f55, 0x3f553f0e, 0x3f7b3e48
.long 0x3ec43f6d, 0x3f6d3ec4, 0x3f6dbec4, 0x3ec4bf6d, 0x3f0e3f55, 0x3f7bbe48, 0x3e48bf7b, 0xbf55bf0e
.long 0x3f353f35, 0x3f35bf35, 0xbf35bf35, 0xbf353f35, 0x3f553f0e, 0x3e48bf7b, 0xbf7b3e48, 0x3f0e3f55
.long 0x3f6d3ec4, 0xbec4bf6d, 0xbec43f6d, 0x3f6dbec4, 0x3f7b3e48, 0xbf55bf0e, 0x3f0e3f55, 0xbe48bf7b
.long 0x3f800000, 0xbf800000, 0x3f800000, 0xbf800000, 0x3f7bbe48, 0xbf553f0e, 0x3f0ebf55, 0xbe483f7b
.long 0x3f6dbec4, 0xbec43f6d, 0xbec4bf6d, 0x3f6d3ec4, 0x3f55bf0e, 0x3e483f7b, 0xbf7bbe48, 0x3f0ebf55
.long 0x3f35bf35, 0x3f353f35, 0xbf353f35, 0xbf35bf35, 0x3f0ebf55, 0x3f7b3e48, 0x3e483f7b, 0xbf553f0e
.long 0x3ec4bf6d, 0x3f6dbec4, 0x3f6d3ec4, 0x3ec43f6d, 0x3e48bf7b, 0x3f0ebf55, 0x3f55bf0e, 0x3f7bbe48
.long 0x3f80, 0x3f80, 0x3f80, 0x3f80, 0x3f7bbe48, 0x3f55bf0e, 0x3f0ebf55, 0x3e48bf7b
.long 0xbec4bf6d, 0xbf6dbec4, 0xbf6d3ec4, 0xbec43f6d, 0xbf553f0e, 0x3e483f7b, 0x3f7b3e48, 0x3f0ebf55
.long 0x3f353f35, 0x3f35bf35, 0xbf35bf35, 0xbf353f35, 0x3f0ebf55, 0xbf7bbe48, 0x3e483f7b, 0x3f55bf0e
.long 0xbf6dbec4, 0x3ec43f6d, 0x3ec4bf6d, 0xbf6d3ec4, 0xbe483f7b, 0x3f0ebf55, 0xbf553f0e, 0x3f7bbe48
.long 0x3f800000, 0xbf800000, 0x3f800000, 0xbf800000, 0xbe48bf7b, 0x3f0e3f55, 0xbf55bf0e, 0x3f7b3e48
.long 0xbf6d3ec4, 0x3ec4bf6d, 0x3ec43f6d, 0xbf6dbec4, 0x3f0e3f55, 0xbf7b3e48, 0x3e48bf7b, 0x3f553f0e
.long 0x3f35bf35, 0x3f353f35, 0xbf353f35, 0xbf35bf35, 0xbf55bf0e, 0x3e48bf7b, 0x3f7bbe48, 0x3f0e3f55
.long 0xbec43f6d, 0xbf6d3ec4, 0xbf6dbec4, 0xbec4bf6d, 0x3f7b3e48, 0x3f553f0e, 0x3f0e3f55, 0x3e483f7b
.long 0x3f80, 0x3f80, 0x3f80, 0x3f80, 0xbe48bf7b, 0xbf0ebf55, 0xbf55bf0e, 0xbf7bbe48
.long 0x3ec43f6d, 0x3f6d3ec4, 0x3f6dbec4, 0x3ec4bf6d, 0xbf0ebf55, 0xbf7b3e48, 0xbe483f7b, 0x3f553f0e
.long 0x3f353f35, 0x3f35bf35, 0xbf35bf35, 0xbf353f35, 0xbf55bf0e, 0xbe483f7b, 0x3f7bbe48, 0xbf0ebf55
.long 0x3f6d3ec4, 0xbec4bf6d, 0xbec43f6d, 0x3f6dbec4, 0xbf7bbe48, 0x3f553f0e, 0xbf0ebf55, 0x3e483f7b
.long 0x3f800000, 0xbf800000, 0x3f800000, 0xbf800000, 0xbf7b3e48, 0x3f55bf0e, 0xbf0e3f55, 0x3e48bf7b
.long 0x3f6dbec4, 0xbec43f6d, 0xbec4bf6d, 0x3f6d3ec4, 0xbf553f0e, 0xbe48bf7b, 0x3f7b3e48, 0xbf0e3f55
.long 0x3f35bf35, 0x3f353f35, 0xbf353f35, 0xbf35bf35, 0xbf0e3f55, 0xbf7bbe48, 0xbe48bf7b, 0x3f55bf0e
.long 0x3ec4bf6d, 0x3f6dbec4, 0x3f6d3ec4, 0x3ec43f6d, 0xbe483f7b, 0xbf0e3f55, 0xbf553f0e, 0xbf7b3e48
.long 0x3f80, 0x3f80, 0x3f80, 0x3f80, 0xbf7b3e48, 0xbf553f0e, 0xbf0e3f55, 0xbe483f7b
.long 0xbec4bf6d, 0xbf6dbec4, 0xbf6d3ec4, 0xbec43f6d, 0x3f55bf0e, 0xbe48bf7b, 0xbf7bbe48, 0xbf0e3f55
.long 0x3f353f35, 0x3f35bf35, 0xbf35bf35, 0xbf353f35, 0xbf0e3f55, 0x3f7b3e48, 0xbe48bf7b, 0xbf553f0e
.long 0xbf6dbec4, 0x3ec43f6d, 0x3ec4bf6d, 0xbf6d3ec4, 0x3e48bf7b, 0xbf0e3f55, 0x3f55bf0e, 0xbf7b3e48
.long 0x3f800000, 0xbf800000, 0x3f800000, 0xbf800000, 0x3e483f7b, 0xbf0ebf55, 0x3f553f0e, 0xbf7bbe48
.long 0xbf6d3ec4, 0x3ec4bf6d, 0x3ec43f6d, 0xbf6dbec4, 0xbf0ebf55, 0x3f7bbe48, 0xbe483f7b, 0xbf55bf0e
.long 0x3f35bf35, 0x3f353f35, 0xbf353f35, 0xbf35bf35, 0x3f553f0e, 0xbe483f7b, 0xbf7b3e48, 0xbf0ebf55
.long 0xbec43f6d, 0xbf6d3ec4, 0xbf6dbec4, 0xbec4bf6d, 0xbf7bbe48, 0xbf55bf0e, 0xbf0ebf55, 0xbe48bf7b
.long 0xbf80, 0xbf80, 0xbf80, 0xbf80, 0xbe48bf7b, 0xbf0ebf55, 0xbf55bf0e, 0xbf7bbe48
.long 0xbec4bf6d, 0xbf6dbec4, 0xbf6d3ec4, 0xbec43f6d, 0xbf0ebf55, 0xbf7b3e48, 0xbe483f7b, 0x3f553f0e
.long 0xbf35bf35, 0xbf353f35, 0x3f353f35, 0x3f35bf35, 0xbf55bf0e, 0xbe483f7b, 0x3f7bbe48, 0xbf0ebf55
.long 0xbf6dbec4, 0x3ec43f6d, 0x3ec4bf6d, 0xbf6d3ec4, 0xbf7bbe48, 0x3f553f0e, 0xbf0ebf55, 0x3e483f7b
.long 0xbf800000, 0x3f800000, 0xbf800000, 0x3f800000, 0xbf7b3e48, 0x3f55bf0e, 0xbf0e3f55, 0x3e48bf7b
.long 0xbf6d3ec4, 0x3ec4bf6d, 0x3ec43f6d, 0xbf6dbec4, 0xbf553f0e, 0xbe48bf7b, 0x3f7b3e48, 0xbf0e3f55
.long 0xbf353f35, 0xbf35bf35, 0x3f35bf35, 0x3f353f35, 0xbf0e3f55, 0xbf7bbe48, 0xbe48bf7b, 0x3f55bf0e
.long 0xbec43f6d, 0xbf6d3ec4, 0xbf6dbec4, 0xbec4bf6d, 0xbe483f7b, 0xbf0e3f55, 0xbf553f0e, 0xbf7b3e48
.long 0xbf80, 0xbf80, 0xbf80, 0xbf80, 0xbf7b3e48, 0xbf553f0e, 0xbf0e3f55, 0xbe483f7b
.long 0x3ec43f6d, 0x3f6d3ec4, 0x3f6dbec4, 0x3ec4bf6d, 0x3f55bf0e, 0xbe48bf7b, 0xbf7bbe48, 0xbf0e3f55
.long 0xbf35bf35, 0xbf353f35, 0x3f353f35, 0x3f35bf35, 0xbf0e3f55, 0x3f7b3e48, 0xbe48bf7b, 0xbf553f0e
.long 0x3f6d3ec4, 0xbec4bf6d, 0xbec43f6d, 0x3f6dbec4, 0x3e48bf7b, 0xbf0e3f55, 0x3f55bf0e, 0xbf7b3e48
.long 0xbf800000, 0x3f800000, 0xbf800000, 0x3f800000, 0x3e483f7b, 0xbf0ebf55, 0x3f553f0e, 0xbf7bbe48
.long 0x3f6dbec4, 0xbec43f6d, 0xbec4bf6d, 0x3f6d3ec4, 0xbf0ebf55, 0x3f7bbe48, 0xbe483f7b, 0xbf55bf0e
.long 0xbf353f35, 0xbf35bf35, 0x3f35bf35, 0x3f353f35, 0x3f553f0e, 0xbe483f7b, 0xbf7b3e48, 0xbf0ebf55
.long 0x3ec4bf6d, 0x3f6dbec4, 0x3f6d3ec4, 0x3ec43f6d, 0xbf7bbe48, 0xbf55bf0e, 0xbf0ebf55, 0xbe48bf7b
.long 0xbf80, 0xbf80, 0xbf80, 0xbf80, 0x3e483f7b, 0x3f0e3f55, 0x3f553f0e, 0x3f7b3e48
.long 0xbec4bf6d, 0xbf6dbec4, 0xbf6d3ec4, 0xbec43f6d, 0x3f0e3f55, 0x3f7bbe48, 0x3e48bf7b, 0xbf55bf0e
.long 0xbf35bf35, 0xbf353f35, 0x3f353f35, 0x3f35bf35, 0x3f553f0e, 0x3e48bf7b, 0xbf7b3e48, 0x3f0e3f55
.long 0xbf6dbec4, 0x3ec43f6d, 0x3ec4bf6d, 0xbf6d3ec4, 0x3f7b3e48, 0xbf55bf0e, 0x3f0e3f55, 0xbe48bf7b
.long 0xbf800000, 0x3f800000, 0xbf800000, 0x3f800000, 0x3f7bbe48, 0xbf553f0e, 0x3f0ebf55, 0xbe483f7b
.long 0xbf6d3ec4, 0x3ec4bf6d, 0x3ec43f6d, 0xbf6dbec4, 0x3f55bf0e, 0x3e483f7b, 0xbf7bbe48, 0x3f0ebf55
.long 0xbf353f35, 0xbf35bf35, 0x3f35bf35, 0x3f353f35, 0x3f0ebf55, 0x3f7b3e48, 0x3e483f7b, 0xbf553f0e
.long 0xbec43f6d, 0xbf6d3ec4, 0xbf6dbec4, 0xbec4bf6d, 0x3e48bf7b, 0x3f0ebf55, 0x3f55bf0e, 0x3f7bbe48
.long 0xbf80, 0xbf80, 0xbf80, 0xbf80, 0x3f7bbe48, 0x3f55bf0e, 0x3f0ebf55, 0x3e48bf7b
.long 0x3ec43f6d, 0x3f6d3ec4, 0x3f6dbec4, 0x3ec4bf6d, 0xbf553f0e, 0x3e483f7b, 0x3f7b3e48, 0x3f0ebf55
.long 0xbf35bf35, 0xbf353f35, 0x3f353f35, 0x3f35bf35, 0x3f0ebf55, 0xbf7bbe48, 0x3e483f7b, 0x3f55bf0e
.long 0x3f6d3ec4, 0xbec4bf6d, 0xbec43f6d, 0x3f6dbec4, 0xbe483f7b, 0x3f0ebf55, 0xbf553f0e, 0x3f7bbe48
.long 0xbf800000, 0x3f800000, 0xbf800000, 0x3f800000, 0xbe48bf7b, 0x3f0e3f55, 0xbf55bf0e, 0x3f7b3e48
.long 0x3f6dbec4, 0xbec43f6d, 0xbec4bf6d, 0x3f6d3ec4, 0x3f0e3f55, 0xbf7b3e48, 0x3e48bf7b, 0x3f553f0e
.long 0xbf353f35, 0xbf35bf35, 0x3f35bf35, 0x3f353f35, 0xbf55bf0e, 0x3e48bf7b, 0x3f7bbe48, 0x3f0e3f55
.long 0x3ec4bf6d, 0x3f6dbec4, 0x3f6d3ec4, 0x3ec43f6d, 0x3f7b3e48, 0x3f553f0e, 0x3f0e3f55, 0x3e483f7b
L_tabend:
.size L_tab, L_tabend - L_tab
.section .rodata,"a"
.p2align 6
.amdhsa_kernel gated_mix__spectral_fnet__moe_arch_mod__prompt_kernel
  .amdhsa_next_free_vgpr 256
  .amdhsa_next_free_sgpr 100
  .amdhsa_accum_offset 256
  .amdhsa_group_segment_fixed_size 0
  .amdhsa_kernarg_size 112
  .amdhsa_user_sgpr_count 2
  .amdhsa_user_sgpr_kernarg_segment_ptr 1
  .amdhsa_system_sgpr_workgroup_id_x 1
.end_amdhsa_kernel
```

```asm
; @launch grid=(256,1,1) block=(512,1,1) lds=101376
.amdgcn_target "amdgcn-amd-amdhsa--gfx950"
.text
.globl gated_mix__spectral_fnet__moe_arch_mod__prompt_kernel
.p2align 8
.type gated_mix__spectral_fnet__moe_arch_mod__prompt_kernel,@function
gated_mix__spectral_fnet__moe_arch_mod__prompt_kernel:
    s_cmp_ge_u32 s2, 256
    s_cbranch_scc1 L_end
    s_load_dwordx2 s[4:5], s[0:1], 0
    s_load_dwordx16 s[16:31], s[0:1], 48
    s_getpc_b64 s[10:11]
L_pc:
    v_lshrrev_b32 v1, 6, v0
    s_lshr_b32 s57, s2, 3
    v_lshl_add_u32 v4, v0, 5, s57
    v_lshlrev_b32 v4, 7, v4
    v_cmp_gt_u32 vcc, L_tabend - L_pc, v4
    s_nop 0
    s_and_saveexec_b64 s[12:13], vcc
    s_cbranch_execz L_nocpf
    global_load_dword v249, v4, s[10:11]
L_nocpf:
    s_mov_b64 exec, s[12:13]
    v_and_b32 v0, 63, v0
    v_readfirstlane_b32 s3, v1
    v_and_b32 v2, 15, v0
    v_lshrrev_b32 v3, 4, v0
    v_lshlrev_b32 v247, 4, v0
    s_add_u32 s10, s10, L_tab - L_pc
    s_addc_u32 s11, s11, 0
    s_and_b32 s56, s2, 7
    s_mov_b32 s90, 400000
    s_cmp_lt_u32 s57, 16
    s_cbranch_scc1 L_low
    s_sub_u32 s57, s57, 16
    s_lshl4_add_u32 s9, s56, s57
    s_lshl4_add_u32 s58, s57, s56
    s_sub_u32 s62, s58, 120
    s_cmp_lt_u32 s9, 8
    s_cselect_b32 s62, s58, s62
    s_cmp_lt_u32 s9, 16
    s_cselect_b32 s58, s62, s58
L_a:
    s_cmp_ge_u32 s3, 4
    s_cbranch_scc1 L_p1w
    s_lshl2_add_u32 s60, s57, s3
    s_lshl_b32 s60, s60, 5
    s_add_u32 s60, s60, s56
    s_lshl_b32 s12, s60, 10
    s_cmp_eq_u32 s58, 128
    s_cselect_b32 s12, 0x40000000, s12
    s_add_u32 s13, s12, 8192
    s_add_u32 s14, s12, 16384
    s_add_u32 s15, s12, 24576
    s_waitcnt lgkmcnt(0)
    s_load_dword s59, s[30:31], 0
    s_mov_b32 s32, s4
    s_mov_b32 s33, s5
    s_mov_b32 s34, 0x200000
    s_mov_b32 s35, 0x20000
    s_mov_b32 s36, s30
    s_mov_b32 s37, s31
    s_mov_b32 s38, 0x400000
    s_mov_b32 s39, 0x20000
    buffer_load_dwordx4 v[8:11], v247, s[32:35], s12 offen
    buffer_load_dwordx4 v[12:15], v247, s[32:35], s13 offen
    buffer_load_dwordx4 v[16:19], v247, s[32:35], s14 offen
    buffer_load_dwordx4 v[20:23], v247, s[32:35], s15 offen
    s_mov_b32 s44, s16
    s_mov_b32 s45, s17
    s_mov_b32 s46, 0x400
    s_mov_b32 s47, 0x20000
    buffer_load_dwordx4 v[24:27], v247, s[44:47], 0 offen
    v_and_b32 v36, 1, v3
    v_lshrrev_b32 v108, 1, v3
    v_lshl_add_u32 v36, v36, 1, v108
    v_lshl_add_u32 v36, v36, 3, s60
    v_mov_b32 v108, 43008
    v_mov_b32 v109, 1
    s_mov_b32 s8, 0xfffff800
    s_lshl3_add_u32 s15, s57, s56
    s_lshl_b32 s15, s15, 3
    s_add_u32 s15, s15, 0x40000
    v_lshlrev_b32 v37, 11, v0
    v_lshrrev_b32 v96, 1, v2
    v_lshlrev_b32 v96, 8, v96
    v_add_u32 v96, s58, v96
    v_and_b32 v97, 1, v2
    v_lshlrev_b32 v98, 1, v3
    v_mul_u32_u24 v98, v98, v96
    v_cmp_eq_u32 vcc, 0, v97
    v_and_b32 v99, 2047, v98
    v_add_u32 v98, v98, v96
    v_cvt_f32_u32 v99, v99
    v_mul_f32 v99, 0x3a000000, v99
    v_cos_f32 v100, v99
    v_sin_f32 v101, v99
    v_mul_f32 v100, 0.5, v100
    v_mul_f32 v101, 0.5, v101
    v_cndmask_b32_e64 v102, -v101, v100, vcc
    v_cndmask_b32 v103, v100, v101, vcc
    v_cvt_pk_bf16_f32 v144, v102, v103
    v_cvt_pk_bf16_f32 v148, -v103, v102
    v_cndmask_b32 v102, v101, v100, vcc
    v_cndmask_b32_e64 v103, -v100, v101, vcc
    v_cvt_pk_bf16_f32 v145, v102, -v103
    v_cvt_pk_bf16_f32 v149, -v103, -v102
    s_and_b32 s60, s58, 127
    s_cbranch_scc1 L_ar_a10
    v_add_f32 v100, v100, v100
    v_add_f32 v101, v101, v101
    v_cndmask_b32 v102, 0, v100, vcc
    v_sub_f32 v103, v100, v102
    v_cvt_pk_bf16_f32 v100, v102, v103
    v_cndmask_b32 v102, 0, v101, vcc
    v_sub_f32 v103, v101, v102
    v_cvt_pk_bf16_f32 v101, -v102, -v103
    s_cmp_eq_u32 s58, 0
    s_cselect_b32 s60, -1, 0
    s_cselect_b32 s61, 0, -1
    v_and_b32 v144, s60, v100
    v_and_b32 v148, s60, v101
    v_and_b32 v145, s61, v100
    v_and_b32 v149, s61, v101
L_ar_a10:
    v_and_b32 v99, 2047, v98
    v_cvt_f32_u32 v99, v99
    v_mul_f32 v99, 0x3a000000, v99
    v_cos_f32 v100, v99
    v_sin_f32 v101, v99
    v_mul_f32 v100, 0.5, v100
    v_mul_f32 v101, 0.5, v101
    v_cndmask_b32_e64 v102, -v101, v100, vcc
    v_cndmask_b32 v103, v100, v101, vcc
    v_cvt_pk_bf16_f32 v146, v102, v103
    v_cvt_pk_bf16_f32 v150, -v103, v102
    v_cndmask_b32 v102, v101, v100, vcc
    v_cndmask_b32_e64 v103, -v100, v101, vcc
    v_cvt_pk_bf16_f32 v147, v102, -v103
    v_cvt_pk_bf16_f32 v151, -v103, -v102
    s_and_b32 s60, s58, 127
    s_cbranch_scc1 L_ar_a11
    v_add_f32 v100, v100, v100
    v_add_f32 v101, v101, v101
    v_cndmask_b32 v102, 0, v100, vcc
    v_sub_f32 v103, v100, v102
    v_cvt_pk_bf16_f32 v100, v102, v103
    v_cndmask_b32 v102, 0, v101, vcc
    v_sub_f32 v103, v101, v102
    v_cvt_pk_bf16_f32 v101, -v102, -v103
    s_cmp_eq_u32 s58, 0
    s_cselect_b32 s60, -1, 0
    s_cselect_b32 s61, 0, -1
    v_and_b32 v146, s60, v100
    v_and_b32 v150, s60, v101
    v_and_b32 v147, s61, v100
    v_and_b32 v151, s61, v101
L_ar_a11:
    v_lshlrev_b32 v5, 12, v3
    v_lshl_add_u32 v5, v2, 4, v5
    v_lshrrev_b32 v96, 2, v2
    v_xor_b32 v96, v96, v3
    v_and_b32 v96, 1, v96
    v_bfe_u32 v97, v2, 1, 1
    v_lshl_or_b32 v96, v96, 1, v97
    s_lshr_b32 s60, s3, 1
    v_xor_b32 v96, s60, v96
    v_lshlrev_b32 v96, 4, v96
    v_and_b32 v98, 7, v2
    v_lshl_add_u32 v96, v98, 6, v96
    v_lshl_add_u32 v96, v3, 12, v96
    v_lshrrev_b32 v98, 3, v2
    v_lshl_add_u32 v96, v98, 2, v96
    s_and_b32 s60, s3, 1
    s_lshl_b32 s60, s60, 3
    s_add_u32 s60, s60, 16384
    v_add_u32 v6, s60, v96
    v_xor_b32 v7, 48, v6
    v_bfe_u32 v96, v2, 2, 1
    v_xor_b32 v96, v96, v98
    v_lshl_or_b32 v96, v96, 1, v98
    v_xor_b32 v96, v96, v97
    v_xor_b32 v96, v96, v3
    v_lshlrev_b32 v96, 4, v96
    v_lshl_add_u32 v62, v2, 6, v96
    s_lshl_b32 s60, s3, 4
    s_and_b32 s60, s60, 32
    v_xor_b32 v62, s60, v62
    s_lshl_b32 s60, s3, 11
    s_add_u32 s60, s60, 16384
    v_add_u32 v62, s60, v62
    s_lshl_b32 s14, s9, 14
    s_lshl_b32 s60, s3, 8
    s_add_u32 s14, s14, s60
    s_add_u32 s14, s14, 0x200000
    s_mov_b32 s40, s26
    s_mov_b32 s41, s27
    s_mov_b32 s42, 0x200000
    s_mov_b32 s43, 0x20000
    s_xor_b32 s98, s3, 4
    v_lshl_add_u32 v96, v2, 4, s98
    v_lshlrev_b32 v98, 2, v3
    v_cvt_f32_u32 v98, v98
    v_cvt_f32_u32 v96, v96
    v_mul_f32 v96, 0x3b800000, v96
    v_mul_f32 v99, v98, v96
    v_cos_f32 v102, v99
    v_sin_f32 v103, v99
    v_add_f32 v99, v99, v96
    v_cvt_pk_bf16_f32 v112, v102, v103
    v_cvt_pk_bf16_f32 v116, -v103, v102
    v_cos_f32 v102, v99
    v_sin_f32 v103, v99
    v_add_f32 v99, v99, v96
    v_cvt_pk_bf16_f32 v113, v102, v103
    v_cvt_pk_bf16_f32 v117, -v103, v102
    v_cos_f32 v102, v99
    v_sin_f32 v103, v99
    v_add_f32 v99, v99, v96
    v_cvt_pk_bf16_f32 v114, v102, v103
    v_cvt_pk_bf16_f32 v118, -v103, v102
    v_cos_f32 v102, v99
    v_sin_f32 v103, v99
    s_nop 0
    v_cvt_pk_bf16_f32 v115, v102, v103
    v_cvt_pk_bf16_f32 v119, -v103, v102
    v_mov_b32 v96, 0x80000000
    v_mov_b32 v97, 0x8000
    v_xor_b32 v120, v96, v112
    v_xor_b32 v124, v97, v116
    v_xor_b32 v121, v96, v113
    v_xor_b32 v125, v97, v117
    v_xor_b32 v122, v96, v114
    v_xor_b32 v126, v97, v118
    v_xor_b32 v123, v96, v115
    v_xor_b32 v127, v97, v119
    s_sub_u32 s60, 16, s98
    s_cmp_eq_u32 s98, 0
    s_cselect_b32 s60, 8, s60
    v_bfe_u32 v96, v2, 2, 1
    v_xor_b32 v96, v96, v2
    v_lshrrev_b32 v97, 3, v2
    v_mul_u32_u24 v98, 3, v97
    v_xor_b32 v98, v98, v3
    v_lshlrev_b32 v98, 4, v98
    v_lshl_add_u32 v96, v96, 6, v98
    s_lshl_b32 s61, s98, 3
    s_and_b32 s61, s61, 32
    s_lshl_b32 s62, s98, 10
    s_or_b32 s61, s61, s62
    v_xor_b32 v60, s61, v96
    s_lshl_b32 s61, s60, 3
    s_and_b32 s61, s61, 32
    s_lshl_b32 s62, s60, 10
    s_or_b32 s61, s61, s62
    v_xor_b32 v61, s61, v96
    v_lshlrev_b32 v63, 16, v3
    v_lshl_add_u32 v63, v97, 14, v63
    v_and_b32 v96, 7, v2
    v_lshl_add_u32 v63, v96, 4, v63
    s_lshl_b32 s6, s98, 18
    s_lshl_b32 s61, s56, 11
    s_add_u32 s6, s6, s61
    s_lshl_b32 s61, s57, 7
    s_add_u32 s6, s6, s61
    s_add_u32 s6, s6, 0x200000
    s_add_u32 s7, s6, 32768
    v_lshlrev_b32 v4, 5, v2
    v_and_b32 v96, 1, v3
    v_lshl_add_u32 v4, v96, 9, v4
    v_lshrrev_b32 v96, 1, v3
    v_lshl_add_u32 v4, v96, 4, v4
    s_lshl_b32 s60, s3, 8
    s_add_u32 s93, s60, s58
    s_sub_u32 s94, 2048, s93
    s_and_b32 s94, s94, 2047
    s_mov_b32 s48, s24
    s_mov_b32 s49, s25
    s_mov_b32 s50, 0x400
    s_mov_b32 s51, 0x20000
    s_waitcnt vmcnt(1)
    s_barrier
    s_waitcnt vmcnt(0)
    v_dot2_f32_bf16 v32, v8, v24, 0
    v_dot2_f32_bf16 v33, v12, v24, 0
    v_dot2_f32_bf16 v34, v16, v24, 0
    v_dot2_f32_bf16 v35, v20, v24, 0
    v_dot2_f32_bf16 v32, v9, v25, v32
    v_dot2_f32_bf16 v33, v13, v25, v33
    v_dot2_f32_bf16 v34, v17, v25, v34
    v_dot2_f32_bf16 v35, v21, v25, v35
    v_dot2_f32_bf16 v32, v10, v26, v32
    v_dot2_f32_bf16 v33, v14, v26, v33
    v_dot2_f32_bf16 v34, v18, v26, v34
    v_dot2_f32_bf16 v35, v22, v26, v35
    v_dot2_f32_bf16 v32, v11, v27, v32
    v_dot2_f32_bf16 v33, v15, v27, v33
    v_dot2_f32_bf16 v34, v19, v27, v34
    v_dot2_f32_bf16 v35, v23, v27, v35
    s_waitcnt lgkmcnt(0)
    s_add_u32 s59, s59, 0x9e3779b9
    s_bitcmp1_b32 s59, 0
    s_cselect_b32 s91, 1, 0x10000
    s_xor_b32 s92, s91, 0x10001
    v_permlane32_swap_b32 v32, v33
    v_permlane32_swap_b32 v34, v35
    v_add_f32 v32, v32, v33
    v_add_f32 v34, v34, v35
    s_nop 1
    v_permlane16_swap_b32 v32, v34
    v_add_f32 v32, v32, v34
    v_mov_b32 v39, s59
    s_nop 0
    v_add_f32_dpp v32, v32, v32 row_ror:8 row_mask:0xf bank_mask:0xf
    s_nop 1
    v_add_f32_dpp v32, v32, v32 row_ror:4 row_mask:0xf bank_mask:0xf
    s_nop 1
    v_add_f32_dpp v32, v32, v32 row_ror:2 row_mask:0xf bank_mask:0xf
    s_nop 1
    v_add_f32_dpp v32, v32, v32 row_ror:1 row_mask:0xf bank_mask:0xf
    v_ashrrev_i32 v33, 31, v32
    v_or_b32 v33, 0x80000000, v33
    v_xor_b32 v33, v33, v32
    v_and_or_b32 v33, v33, s8, v36
    s_mov_b32 exec_lo, 0x10001
    s_mov_b32 exec_hi, 0x10001
    ds_max_u32 v108, v33
    s_mov_b64 exec, 1
    ds_add_rtn_u32 v34, v108, v109 offset:4
    s_mov_b64 exec, -1
    ds_read_b32 v38, v108
    s_waitcnt lgkmcnt(0)
    v_readfirstlane_b32 s61, v34
    s_nop 0
    s_cmp_lg_u32 s61, 3
    s_cbranch_scc1 L_b1a
    s_cmp_eq_u32 s58, 128
    s_cbranch_scc1 L_b1a
    buffer_store_dwordx2 v[38:39], v37, s[36:39], s15 offen sc1
L_b1a:
    s_lshl_b32 s63, s3, 1
    s_lshl_b32 s60, s63, 10
    v_lshl_add_u32 v248, v0, 4, s60
    s_add_u32 m0, s60, 32768
    global_load_lds_dwordx4 v248, s[10:11] offset:0
    global_load_lds_dwordx4 v248, s[10:11] offset:1024
    s_and_b32 s63, s3, 1
    s_add_u32 s63, s63, 8
    s_lshl_b32 s60, s63, 10
    v_lshl_add_u32 v248, v0, 4, s60
    s_add_u32 m0, s60, 32768
    global_load_lds_dwordx4 v248, s[10:11] offset:0
    s_lshl_b32 s12, s93, 10
    s_lshl_b32 s13, s94, 10
    buffer_load_dwordx4 v[232:235], v4, s[32:35], s12 offen
    buffer_load_dwordx4 v[236:239], v4, s[32:35], s13 offen
    buffer_load_dwordx4 v[240:243], v4, s[48:51], 0 offen
    v_mov_b32 v104, s91
    v_mov_b32 v105, s92
    v_mov_b32 v106, 0x00010001
    s_branch L_b1
L_p1w:
    s_sub_u32 s96, s3, 4
    s_lshl_b32 s60, s56, 2
    s_mul_i32 s61, s56, 3
    s_add_u32 s61, s61, 4
    s_cmp_lt_u32 s56, 4
    s_cselect_b32 s60, s60, s61
    s_cselect_b32 s61, 16, 12
    s_cmp_ge_u32 s57, s61
    s_cselect_b32 s63, 8, s96
    s_lshr_b32 s61, s57, 2
    s_add_u32 s60, s60, s61
    s_lshl_b32 s6, s60, 7
    s_and_b32 s61, s57, 3
    s_mul_i32 s61, s61, 2
    s_add_u32 s61, s61, s96
    s_lshl_b32 s61, s61, 5
    s_add_u32 s61, s61, 256
    v_lshrrev_b32 v100, 1, v0
    v_add_u32 v100, s61, v100
    v_mul_u32_u24 v100, 3584, v100
    v_and_b32 v101, 1, v0
    v_lshl_add_u32 v100, v101, 6, v100
    s_waitcnt lgkmcnt(0)
    s_mov_b32 s52, s18
    s_mov_b32 s53, s19
    s_mov_b32 s54, 0x1c0000
    s_mov_b32 s55, 0x20000
    s_cmp_ge_u32 s63, 2
    s_cbranch_scc1 L_noapf
    buffer_load_dword v255, v100, s[52:55], s6 offen
L_noapf:
    s_waitcnt lgkmcnt(0)
    s_mov_b32 s32, s4
    s_mov_b32 s33, s5
    s_mov_b32 s34, 0x200000
    s_mov_b32 s35, 0x20000
    s_mov_b32 s36, s30
    s_mov_b32 s37, s31
    s_mov_b32 s38, 0x400000
    s_mov_b32 s39, 0x20000
    s_cmp_lg_u32 s3, 7
    s_cbranch_scc1 L_nomt
    v_mov_b32 v252, s16
    v_mov_b32 v253, s17
    v_writelane_b32 v252, s24, 1
    v_writelane_b32 v253, s25, 1
    v_writelane_b32 v252, s26, 2
    v_writelane_b32 v253, s27, 2
    s_add_u32 s63, s30, 0x3000
    v_writelane_b32 v252, s63, 3
    s_addc_u32 s63, s31, 0
    v_writelane_b32 v253, s63, 3
    s_add_u32 s63, s30, 0x203000
    v_writelane_b32 v252, s63, 4
    s_addc_u32 s63, s31, 0
    v_writelane_b32 v253, s63, 4
    s_mov_b64 exec, 0x1f
    global_load_dword v254, v[252:253], off
    s_mov_b64 exec, -1
L_nomt:
    v_lshlrev_b32 v107, 19, v3
    v_bfe_u32 v108, v0, 2, 2
    v_lshl_add_u32 v107, v108, 13, v107
    v_and_b32 v109, 3, v0
    v_lshl_add_u32 v107, v109, 4, v107
    v_mov_b32 v96, 43008
    v_mov_b32 v98, 0
    v_mov_b32 v99, 0
    ds_write_b64 v96, v[98:99]
    v_lshlrev_b32 v96, 2, v3
    v_cvt_f32_u32 v96, v96
    v_cvt_f32_u32 v97, v2
    v_mul_f32 v97, 0x3d800000, v97
    v_mul_f32 v96, v96, v97
    v_cos_f32 v102, v96
    v_sin_f32 v103, v96
    v_add_f32 v96, v96, v97
    v_cvt_pk_bf16_f32 v40, v102, v103
    v_cvt_pk_bf16_f32 v44, -v103, v102
    v_cos_f32 v102, v96
    v_sin_f32 v103, v96
    v_add_f32 v96, v96, v97
    v_cvt_pk_bf16_f32 v41, v102, v103
    v_cvt_pk_bf16_f32 v45, -v103, v102
    v_cos_f32 v102, v96
    v_sin_f32 v103, v96
    v_add_f32 v96, v96, v97
    v_cvt_pk_bf16_f32 v42, v102, v103
    v_cvt_pk_bf16_f32 v46, -v103, v102
    v_cos_f32 v102, v96
    v_sin_f32 v103, v96
    s_nop 0
    v_cvt_pk_bf16_f32 v43, v102, v103
    v_cvt_pk_bf16_f32 v47, -v103, v102
    v_lshrrev_b32 v96, 1, v109
    v_mul_u32_u24 v96, 3, v96
    v_lshlrev_b32 v97, 1, v3
    v_and_b32 v97, 2, v97
    v_xor_b32 v96, v96, v97
    v_xor_b32 v96, s96, v96
    v_lshl_add_u32 v96, v96, 2, v108
    v_lshlrev_b32 v96, 2, v96
    v_lshl_add_u32 v96, v109, 8, v96
    v_lshl_add_u32 v96, v3, 12, v96
    v_and_b32 v97, 1, v109
    v_lshl_add_u32 v48, v97, 6, v96
    v_xor_b32 v49, 64, v48
    v_add_u32 v50, 128, v48
    v_add_u32 v51, 128, v49
    v_lshlrev_b32 v5, 12, v3
    v_lshl_add_u32 v5, v2, 4, v5
    v_lshrrev_b32 v96, 2, v2
    v_xor_b32 v96, v96, v3
    v_and_b32 v96, 1, v96
    v_bfe_u32 v97, v2, 1, 1
    v_lshl_or_b32 v96, v96, 1, v97
    s_lshr_b32 s60, s3, 1
    v_xor_b32 v96, s60, v96
    v_lshlrev_b32 v96, 4, v96
    v_and_b32 v98, 7, v2
    v_lshl_add_u32 v96, v98, 6, v96
    v_lshl_add_u32 v96, v3, 12, v96
    v_lshrrev_b32 v98, 3, v2
    v_lshl_add_u32 v96, v98, 2, v96
    s_and_b32 s60, s3, 1
    s_lshl_b32 s60, s60, 3
    s_add_u32 s60, s60, 16384
    v_add_u32 v6, s60, v96
    v_xor_b32 v7, 48, v6
    v_bfe_u32 v96, v2, 2, 1
    v_xor_b32 v96, v96, v98
    v_lshl_or_b32 v96, v96, 1, v98
    v_xor_b32 v96, v96, v97
    v_xor_b32 v96, v96, v3
    v_lshlrev_b32 v96, 4, v96
    v_lshl_add_u32 v62, v2, 6, v96
    s_lshl_b32 s60, s3, 4
    s_and_b32 s60, s60, 32
    v_xor_b32 v62, s60, v62
    s_lshl_b32 s60, s3, 11
    s_add_u32 s60, s60, 16384
    v_add_u32 v62, s60, v62
    s_xor_b32 s98, s3, 4
    v_lshl_add_u32 v96, v2, 4, s98
    s_cmp_eq_u32 s98, 0
    s_cselect_b32 s60, 120, 0
    v_subrev_u32 v98, s60, v96
    v_cmp_gt_u32 vcc, 8, v2
    s_nop 1
    v_cndmask_b32 v96, v98, v96, vcc
    v_lshlrev_b32 v98, 2, v3
    v_cvt_f32_u32 v98, v98
    v_cvt_f32_u32 v96, v96
    v_mul_f32 v96, 0x3b800000, v96
    v_mul_f32 v99, v98, v96
    v_cos_f32 v102, v99
    v_sin_f32 v103, v99
    v_add_f32 v99, v99, v96
    v_cvt_pk_bf16_f32 v112, v102, v103
    v_cvt_pk_bf16_f32 v116, -v103, v102
    v_cos_f32 v102, v99
    v_sin_f32 v103, v99
    v_add_f32 v99, v99, v96
    v_cvt_pk_bf16_f32 v113, v102, v103
    v_cvt_pk_bf16_f32 v117, -v103, v102
    v_cos_f32 v102, v99
    v_sin_f32 v103, v99
    v_add_f32 v99, v99, v96
    v_cvt_pk_bf16_f32 v114, v102, v103
    v_cvt_pk_bf16_f32 v118, -v103, v102
    v_cos_f32 v102, v99
    v_sin_f32 v103, v99
    s_nop 0
    v_cvt_pk_bf16_f32 v115, v102, v103
    v_cvt_pk_bf16_f32 v119, -v103, v102
    v_mov_b32 v96, 0x80000000
    v_mov_b32 v97, 0x8000
    v_xor_b32 v120, v96, v112
    v_xor_b32 v124, v97, v116
    v_xor_b32 v121, v96, v113
    v_xor_b32 v125, v97, v117
    v_xor_b32 v122, v96, v114
    v_xor_b32 v126, v97, v118
    v_xor_b32 v123, v96, v115
    v_xor_b32 v127, v97, v119
    s_cmp_lg_u32 s98, 0
    s_cbranch_scc1 L_sp_e
    s_mov_b32 exec_lo, 0x10001
    s_mov_b32 exec_hi, 0x10001
    v_mov_b32 v121, 0xbf80
    v_mov_b32 v125, 0xbf800000
    v_mov_b32 v123, 0xbf80
    v_mov_b32 v127, 0xbf800000
    s_mov_b64 exec, -1
    v_cndmask_b32_e64 v128, v112, 0, vcc
    v_cndmask_b32 v112, 0, v112, vcc
    v_cndmask_b32 v136, 0, v120, vcc
    v_cndmask_b32_e64 v120, v120, 0, vcc
    v_cndmask_b32_e64 v129, v113, 0, vcc
    v_cndmask_b32 v113, 0, v113, vcc
    v_cndmask_b32 v137, 0, v121, vcc
    v_cndmask_b32_e64 v121, v121, 0, vcc
    v_cndmask_b32_e64 v130, v114, 0, vcc
    v_cndmask_b32 v114, 0, v114, vcc
    v_cndmask_b32 v138, 0, v122, vcc
    v_cndmask_b32_e64 v122, v122, 0, vcc
    v_cndmask_b32_e64 v131, v115, 0, vcc
    v_cndmask_b32 v115, 0, v115, vcc
    v_cndmask_b32 v139, 0, v123, vcc
    v_cndmask_b32_e64 v123, v123, 0, vcc
    v_cndmask_b32_e64 v132, v116, 0, vcc
    v_cndmask_b32 v116, 0, v116, vcc
    v_cndmask_b32 v140, 0, v124, vcc
    v_cndmask_b32_e64 v124, v124, 0, vcc
    v_cndmask_b32_e64 v133, v117, 0, vcc
    v_cndmask_b32 v117, 0, v117, vcc
    v_cndmask_b32 v141, 0, v125, vcc
    v_cndmask_b32_e64 v125, v125, 0, vcc
    v_cndmask_b32_e64 v134, v118, 0, vcc
    v_cndmask_b32 v118, 0, v118, vcc
    v_cndmask_b32 v142, 0, v126, vcc
    v_cndmask_b32_e64 v126, v126, 0, vcc
    v_cndmask_b32_e64 v135, v119, 0, vcc
    v_cndmask_b32 v119, 0, v119, vcc
    v_cndmask_b32 v143, 0, v127, vcc
    v_cndmask_b32_e64 v127, v127, 0, vcc
L_sp_e:
    s_sub_u32 s60, 16, s98
    s_cmp_eq_u32 s98, 0
    s_cselect_b32 s60, 8, s60
    v_bfe_u32 v96, v2, 2, 1
    v_xor_b32 v96, v96, v2
    v_lshrrev_b32 v97, 3, v2
    v_mul_u32_u24 v98, 3, v97
    v_xor_b32 v98, v98, v3
    v_lshlrev_b32 v98, 4, v98
    v_lshl_add_u32 v96, v96, 6, v98
    s_lshl_b32 s61, s98, 3
    s_and_b32 s61, s61, 32
    s_lshl_b32 s62, s98, 10
    s_or_b32 s61, s61, s62
    v_xor_b32 v60, s61, v96
    s_lshl_b32 s61, s60, 3
    s_and_b32 s61, s61, 32
    s_lshl_b32 s62, s60, 10
    s_or_b32 s61, s61, s62
    v_xor_b32 v61, s61, v96
    v_lshlrev_b32 v63, 16, v3
    v_lshl_add_u32 v63, v97, 14, v63
    v_and_b32 v96, 7, v2
    v_lshl_add_u32 v63, v96, 4, v63
    s_lshl_b32 s6, s98, 18
    s_lshl_b32 s61, s56, 11
    s_add_u32 s6, s6, s61
    s_lshl_b32 s61, s57, 7
    s_add_u32 s6, s6, s61
    s_add_u32 s6, s6, 0x200000
    s_add_u32 s7, s6, 32768
    v_lshlrev_b32 v4, 5, v2
    v_and_b32 v96, 1, v3
    v_lshl_add_u32 v4, v96, 9, v4
    v_lshrrev_b32 v96, 1, v3
    v_lshl_add_u32 v4, v96, 4, v4
    s_lshl_b32 s60, s3, 8
    s_add_u32 s93, s60, s58
    s_sub_u32 s94, 2048, s93
    s_and_b32 s94, s94, 2047
    s_mov_b32 s48, s24
    s_mov_b32 s49, s25
    s_mov_b32 s50, 0x400
    s_mov_b32 s51, 0x20000
    s_lshl_b32 s12, s96, 15
    s_lshl_b32 s61, s56, 10
    s_add_u32 s12, s12, s61
    s_lshl_b32 s61, s57, 6
    s_add_u32 s12, s12, s61
    s_cmp_eq_u32 s58, 128
    s_cselect_b32 s12, 0x40000000, s12
    s_add_u32 s13, s12, 131072
    s_add_u32 s14, s12, 262144
    s_add_u32 s15, s12, 393216
    s_waitcnt lgkmcnt(0)
    s_barrier
    buffer_load_dwordx4 v[8:11], v107, s[32:35], s12 offen
    buffer_load_dwordx4 v[12:15], v107, s[32:35], s13 offen
    buffer_load_dwordx4 v[16:19], v107, s[32:35], s14 offen
    buffer_load_dwordx4 v[20:23], v107, s[32:35], s15 offen
    s_load_dword s59, s[30:31], 0
    s_lshl_b32 s12, s93, 10
    s_lshl_b32 s13, s94, 10
    buffer_load_dwordx4 v[232:235], v4, s[32:35], s12 offen
    buffer_load_dwordx4 v[236:239], v4, s[32:35], s13 offen
    buffer_load_dwordx4 v[240:243], v4, s[48:51], 0 offen
    v_lshrrev_b32 v96, 1, v2
    v_lshlrev_b32 v96, 8, v96
    v_add_u32 v96, s58, v96
    v_and_b32 v97, 1, v2
    v_lshlrev_b32 v98, 1, v3
    v_mul_u32_u24 v98, v98, v96
    v_cmp_eq_u32 vcc, 0, v97
    v_and_b32 v99, 2047, v98
    v_add_u32 v98, v98, v96
    v_cvt_f32_u32 v99, v99
    v_mul_f32 v99, 0x3a000000, v99
    v_cos_f32 v100, v99
    v_sin_f32 v101, v99
    v_mul_f32 v100, 0.5, v100
    v_mul_f32 v101, 0.5, v101
    v_cndmask_b32_e64 v102, -v101, v100, vcc
    v_cndmask_b32 v103, v100, v101, vcc
    v_cvt_pk_bf16_f32 v144, v102, v103
    v_cvt_pk_bf16_f32 v148, -v103, v102
    v_cndmask_b32 v102, v101, v100, vcc
    v_cndmask_b32_e64 v103, -v100, v101, vcc
    v_cvt_pk_bf16_f32 v145, v102, -v103
    v_cvt_pk_bf16_f32 v149, -v103, -v102
    s_and_b32 s60, s58, 127
    s_cbranch_scc1 L_ap_a10
    v_add_f32 v100, v100, v100
    v_add_f32 v101, v101, v101
    v_cndmask_b32 v102, 0, v100, vcc
    v_sub_f32 v103, v100, v102
    v_cvt_pk_bf16_f32 v100, v102, v103
    v_cndmask_b32 v102, 0, v101, vcc
    v_sub_f32 v103, v101, v102
    v_cvt_pk_bf16_f32 v101, -v102, -v103
    s_cmp_eq_u32 s58, 0
    s_cselect_b32 s60, -1, 0
    s_cselect_b32 s61, 0, -1
    v_and_b32 v144, s60, v100
    v_and_b32 v148, s60, v101
    v_and_b32 v145, s61, v100
    v_and_b32 v149, s61, v101
L_ap_a10:
    v_and_b32 v99, 2047, v98
    v_cvt_f32_u32 v99, v99
    v_mul_f32 v99, 0x3a000000, v99
    v_cos_f32 v100, v99
    v_sin_f32 v101, v99
    v_mul_f32 v100, 0.5, v100
    v_mul_f32 v101, 0.5, v101
    v_cndmask_b32_e64 v102, -v101, v100, vcc
    v_cndmask_b32 v103, v100, v101, vcc
    v_cvt_pk_bf16_f32 v146, v102, v103
    v_cvt_pk_bf16_f32 v150, -v103, v102
    v_cndmask_b32 v102, v101, v100, vcc
    v_cndmask_b32_e64 v103, -v100, v101, vcc
    v_cvt_pk_bf16_f32 v147, v102, -v103
    v_cvt_pk_bf16_f32 v151, -v103, -v102
    s_and_b32 s60, s58, 127
    s_cbranch_scc1 L_ap_a11
    v_add_f32 v100, v100, v100
    v_add_f32 v101, v101, v101
    v_cndmask_b32 v102, 0, v100, vcc
    v_sub_f32 v103, v100, v102
    v_cvt_pk_bf16_f32 v100, v102, v103
    v_cndmask_b32 v102, 0, v101, vcc
    v_sub_f32 v103, v101, v102
    v_cvt_pk_bf16_f32 v101, -v102, -v103
    s_cmp_eq_u32 s58, 0
    s_cselect_b32 s60, -1, 0
    s_cselect_b32 s61, 0, -1
    v_and_b32 v146, s60, v100
    v_and_b32 v150, s60, v101
    v_and_b32 v147, s61, v100
    v_and_b32 v151, s61, v101
L_ap_a11:
    s_lshl_b32 s14, s9, 14
    s_lshl_b32 s60, s3, 8
    s_add_u32 s14, s14, s60
    s_add_u32 s14, s14, 0x200000
    s_mov_b32 s40, s26
    s_mov_b32 s41, s27
    s_mov_b32 s42, 0x200000
    s_mov_b32 s43, 0x20000
    s_lshr_b32 s15, s9, 2
    s_lshl_b32 s15, s15, 11
    s_add_u32 s15, s15, 0x50000
    s_waitcnt lgkmcnt(0)
    s_add_u32 s59, s59, 0x9e3779b9
    s_bitcmp1_b32 s59, 0
    s_cselect_b32 s91, 1, 0x10000
    s_xor_b32 s92, s91, 0x10001
    v_mov_b32 v104, s91
    v_mov_b32 v105, s92
    v_mov_b32 v106, 0x00010001
    s_not_b32 s63, s59
    v_mov_b32 v96, s63
    v_mov_b32 v97, s63
    v_mov_b32 v98, s63
    v_mov_b32 v99, s63
    ds_write_b128 v247, v[96:99] offset:44032
    s_waitcnt vmcnt(3)
    v_pk_mov_b32 v[24:25], v[8:9], v[12:13] op_sel:[0,0]
    v_pk_mov_b32 v[26:27], v[16:17], v[20:21] op_sel:[0,0]
    v_pk_mov_b32 v[28:29], v[8:9], v[12:13] op_sel:[1,1]
    v_pk_mov_b32 v[30:31], v[16:17], v[20:21] op_sel:[1,1]
    v_mfma_f32_16x16x32_bf16 v[64:67], v[40:43], v[24:27], 0
    v_mfma_f32_16x16x32_bf16 v[68:71], v[44:47], v[24:27], 0
    v_pk_mov_b32 v[32:33], v[10:11], v[14:15] op_sel:[0,0]
    v_pk_mov_b32 v[34:35], v[18:19], v[22:23] op_sel:[0,0]
    v_mfma_f32_16x16x32_bf16 v[72:75], v[40:43], v[28:31], 0
    v_mfma_f32_16x16x32_bf16 v[76:79], v[44:47], v[28:31], 0
    v_pk_mov_b32 v[36:37], v[10:11], v[14:15] op_sel:[1,1]
    v_pk_mov_b32 v[38:39], v[18:19], v[22:23] op_sel:[1,1]
    v_mfma_f32_16x16x32_bf16 v[80:83], v[40:43], v[32:35], 0
    v_mfma_f32_16x16x32_bf16 v[84:87], v[44:47], v[32:35], 0
    v_mfma_f32_16x16x32_bf16 v[88:91], v[40:43], v[36:39], 0
    v_cvt_pk_bf16_f32 v8, v64, v68
    v_cvt_pk_bf16_f32 v9, v65, v69
    v_mfma_f32_16x16x32_bf16 v[92:95], v[44:47], v[36:39], 0
    ds_write2st64_b32 v48, v8, v9 offset0:0 offset1:4
    v_cvt_pk_bf16_f32 v10, v66, v70
    v_cvt_pk_bf16_f32 v11, v67, v71
    ds_write2st64_b32 v48, v10, v11 offset0:8 offset1:12
    v_cvt_pk_bf16_f32 v12, v72, v76
    v_cvt_pk_bf16_f32 v13, v73, v77
    ds_write2st64_b32 v49, v12, v13 offset0:0 offset1:4
    v_cvt_pk_bf16_f32 v14, v74, v78
    v_cvt_pk_bf16_f32 v15, v75, v79
    ds_write2st64_b32 v49, v14, v15 offset0:8 offset1:12
    v_cvt_pk_bf16_f32 v16, v80, v84
    v_cvt_pk_bf16_f32 v17, v81, v85
    ds_write2st64_b32 v50, v16, v17 offset0:0 offset1:4
    v_cvt_pk_bf16_f32 v18, v82, v86
    v_cvt_pk_bf16_f32 v19, v83, v87
    ds_write2st64_b32 v50, v18, v19 offset0:8 offset1:12
    v_cvt_pk_bf16_f32 v20, v88, v92
    v_cvt_pk_bf16_f32 v21, v89, v93
    ds_write2st64_b32 v51, v20, v21 offset0:0 offset1:4
    v_cvt_pk_bf16_f32 v22, v90, v94
    v_cvt_pk_bf16_f32 v23, v91, v95
    ds_write2st64_b32 v51, v22, v23 offset0:8 offset1:12
    s_waitcnt lgkmcnt(0)
L_b1:
    s_barrier
    s_cmp_eq_u32 s58, 128
    s_cbranch_scc1 L_ack128
    ds_read_b128 v[52:55], v60
    ds_read_b128 v[56:59], v61
    s_mov_b32 m0, 44032
    s_cmp_lg_u32 s3, 7
    s_cbranch_scc1 L_kq1
    buffer_load_dwordx4 v247, s[36:39], s15 offen sc1 lds
L_kq1:
    s_mov_b32 vcc_lo, 0x00ff00ff
    s_mov_b32 vcc_hi, 0x00ff00ff
    s_waitcnt lgkmcnt(1)
    v_mfma_f32_16x16x32_bf16 v[64:67], v[112:115], v[52:55], 0
    v_mfma_f32_16x16x32_bf16 v[68:71], v[116:119], v[52:55], 0
    s_waitcnt lgkmcnt(0)
    v_mfma_f32_16x16x32_bf16 v[72:75], v[120:123], v[56:59], 0
    v_mfma_f32_16x16x32_bf16 v[76:79], v[124:127], v[56:59], 0
    s_cmp_lg_u32 s98, 0
    s_cbranch_scc1 L_s2b
    v_mfma_f32_16x16x32_bf16 v[64:67], v[128:131], v[56:59], v[64:67]
    v_mfma_f32_16x16x32_bf16 v[68:71], v[132:135], v[56:59], v[68:71]
    v_mfma_f32_16x16x32_bf16 v[72:75], v[136:139], v[52:55], v[72:75]
    v_mfma_f32_16x16x32_bf16 v[76:79], v[140:143], v[52:55], v[76:79]
L_s2b:
    s_nop 5
    v_cvt_pk_bf16_f32 v96, v64, v68
    v_cvt_pk_bf16_f32 v97, v65, v69
    v_cvt_pk_bf16_f32 v100, v72, v76
    v_cvt_pk_bf16_f32 v101, v73, v77
    v_bitop3_b32 v96, v106, v104, v96 bitop3:0xca
    v_bitop3_b32 v97, v106, v104, v97 bitop3:0xca
    v_bitop3_b32 v100, v106, v105, v100 bitop3:0xca
    v_bitop3_b32 v101, v106, v105, v101 bitop3:0xca
    v_cndmask_b32_dpp v80, v97, v96, vcc row_ror:8 row_mask:0xf bank_mask:0xf
    s_nop 0
    v_cndmask_b32_dpp v81, v101, v100, vcc row_ror:8 row_mask:0xf bank_mask:0xf
    s_not_b64 vcc, vcc
    v_cndmask_b32_dpp v82, v96, v97, vcc row_ror:8 row_mask:0xf bank_mask:0xf
    v_cndmask_b32_dpp v83, v100, v101, vcc row_ror:8 row_mask:0xf bank_mask:0xf
    buffer_store_dwordx4 v[80:83], v63, s[36:39], s6 offen sc1
    v_cvt_pk_bf16_f32 v98, v66, v70
    v_cvt_pk_bf16_f32 v99, v67, v71
    v_cvt_pk_bf16_f32 v102, v74, v78
    v_cvt_pk_bf16_f32 v103, v75, v79
    v_bitop3_b32 v98, v106, v104, v98 bitop3:0xca
    v_bitop3_b32 v99, v106, v104, v99 bitop3:0xca
    v_bitop3_b32 v102, v106, v105, v102 bitop3:0xca
    v_bitop3_b32 v103, v106, v105, v103 bitop3:0xca
    v_cndmask_b32_dpp v86, v98, v99, vcc row_ror:8 row_mask:0xf bank_mask:0xf
    s_nop 0
    v_cndmask_b32_dpp v87, v102, v103, vcc row_ror:8 row_mask:0xf bank_mask:0xf
    s_not_b64 vcc, vcc
    v_cndmask_b32_dpp v84, v99, v98, vcc row_ror:8 row_mask:0xf bank_mask:0xf
    v_cndmask_b32_dpp v85, v103, v102, vcc row_ror:8 row_mask:0xf bank_mask:0xf
    buffer_store_dwordx4 v[84:87], v63, s[36:39], s7 offen sc1
L_nos2:
    v_mov_b32 v109, 43016
    s_cmp_lg_u32 s3, 7
    s_cbranch_scc1 L_a5
L_kd:
    ds_read_b128 v[128:131], v247 offset:44032
    buffer_load_dwordx4 v247, s[36:39], s15 offen sc1 lds
    s_waitcnt lgkmcnt(0)
    v_xor_b32 v129, s59, v129
    v_bitop3_b32 v129, v131, s59, v129 bitop3:0xbe
    v_cmp_ne_u32 vcc, 0, v129
    v_max_u32 v128, v128, v130
    s_nop 0
    s_cbranch_vccz L_kd_ok
    s_sleep 2
    s_sub_u32 s90, s90, 1
    s_cbranch_scc0 L_kd
    s_mov_b32 s90, 0
L_kd_ok:
    v_max_u32_dpp v128, v128, v128 row_ror:8 row_mask:0xf bank_mask:0xf
    s_nop 1
    v_max_u32_dpp v128, v128, v128 row_ror:4 row_mask:0xf bank_mask:0xf
    s_nop 1
    v_max_u32_dpp v128, v128, v128 row_ror:2 row_mask:0xf bank_mask:0xf
    s_nop 1
    v_max_u32_dpp v128, v128, v128 row_ror:1 row_mask:0xf bank_mask:0xf
    s_nop 0
    v_readlane_b32 s97, v128, 0
    v_readlane_b32 s60, v128, 16
    v_readlane_b32 s61, v128, 32
    v_readlane_b32 s62, v128, 48
    s_max_u32 s97, s97, s60
    s_max_u32 s61, s61, s62
    s_max_u32 s97, s97, s61
    s_and_b32 s97, s97, 2047
    v_mov_b32 v110, s97
    ds_write_b32 v109, v110
    s_waitcnt lgkmcnt(0)
L_a5:
    s_cmp_ge_u32 s3, 4
    s_cbranch_scc1 L_a6
    s_waitcnt vmcnt(5)
    s_cmp_lg_u32 s58, 128
    s_cbranch_scc1 L_a6
    s_waitcnt vmcnt(0)
L_a6:
    s_barrier
    buffer_load_dwordx4 v[8:11], v5, s[36:39], s14 offen offset:0 sc1
    buffer_load_dwordx4 v[12:15], v5, s[36:39], s14 offen offset:2048 sc1
    ds_read_b32 v109, v109
    ds_read_b128 v[200:203], v247 offset:34816
    ds_read_b128 v[204:207], v247 offset:35840
    ds_read_b128 v[208:211], v247 offset:36864
    ds_read_b128 v[212:215], v247 offset:37888
    ds_read_b128 v[152:155], v247 offset:32768
    ds_read_b128 v[156:159], v247 offset:33792
    ds_read_b128 v[168:171], v247 offset:38912
    ds_read_b128 v[172:175], v247 offset:39936
    ds_read_b128 v[176:179], v247 offset:40960
    ds_read_b128 v[180:183], v247 offset:41984
    s_waitcnt vmcnt(4)
    s_cmp_lg_u32 s58, 128
    s_cbranch_scc1 L_a7
    s_waitcnt vmcnt(2)
L_a7:
    v_dot2_f32_bf16 v110, v232, v240, 0
    v_dot2_f32_bf16 v111, v236, v240, 0
    v_dot2_f32_bf16 v110, v233, v241, v110
    v_dot2_f32_bf16 v111, v237, v241, v111
    v_dot2_f32_bf16 v110, v234, v242, v110
    v_dot2_f32_bf16 v111, v238, v242, v111
    v_dot2_f32_bf16 v110, v235, v243, v110
    v_dot2_f32_bf16 v111, v239, v243, v111
    v_permlane16_swap_b32 v232, v234
    v_permlane16_swap_b32 v233, v235
    v_permlane16_swap_b32 v236, v238
    v_permlane16_swap_b32 v237, v239
    v_permlane32_swap_b32 v110, v111
    v_add_f32 v110, v110, v111
    v_mov_b32 v111, v110
    s_nop 1
    v_permlane16_swap_b32 v110, v111
    v_add_f32 v110, v110, v111
    s_nop 1
    v_add_f32_dpp v110, v110, v110 row_ror:8 row_mask:0xf bank_mask:0xf
    v_lshlrev_b32 v216, 16, v232
    v_and_b32 v217, 0xffff0000, v232
    v_add_f32_dpp v110, v110, v110 row_ror:4 row_mask:0xf bank_mask:0xf
    v_lshlrev_b32 v218, 16, v233
    v_and_b32 v219, 0xffff0000, v233
    v_add_f32_dpp v110, v110, v110 row_ror:2 row_mask:0xf bank_mask:0xf
    v_lshlrev_b32 v220, 16, v234
    v_and_b32 v221, 0xffff0000, v234
    v_add_f32_dpp v110, v110, v110 row_ror:1 row_mask:0xf bank_mask:0xf
    v_lshlrev_b32 v222, 16, v235
    v_and_b32 v223, 0xffff0000, v235
    v_mul_f32 v110, 0xbfb8aa3b, v110
    v_lshlrev_b32 v224, 16, v236
    v_and_b32 v225, 0xffff0000, v236
    v_exp_f32 v110, v110
    v_lshlrev_b32 v226, 16, v237
    v_and_b32 v227, 0xffff0000, v237
    v_add_f32 v110, 1.0, v110
    v_lshlrev_b32 v228, 16, v238
    v_and_b32 v229, 0xffff0000, v238
    v_rcp_f32 v110, v110
    v_lshlrev_b32 v230, 16, v239
    v_and_b32 v231, 0xffff0000, v239
    v_mov_b32 v111, v110
    s_nop 1
    v_permlane32_swap_b32 v110, v111
    s_waitcnt lgkmcnt(0)
    v_readfirstlane_b32 s97, v109
    v_sub_f32 v96, 1.0, v110
    v_sub_f32 v97, 1.0, v111
    v_pk_mul_f32 v[184:185], v[200:201], v[110:111] op_sel:[0,0] op_sel_hi:[1,0]
    v_pk_mul_f32 v[186:187], v[202:203], v[110:111] op_sel:[0,0] op_sel_hi:[1,0]
    v_pk_mul_f32 v[188:189], v[204:205], v[110:111] op_sel:[0,0] op_sel_hi:[1,0]
    v_pk_mul_f32 v[190:191], v[206:207], v[110:111] op_sel:[0,0] op_sel_hi:[1,0]
    v_pk_mul_f32 v[192:193], v[208:209], v[110:111] op_sel:[0,0] op_sel_hi:[1,0]
    v_pk_mul_f32 v[194:195], v[210:211], v[110:111] op_sel:[0,0] op_sel_hi:[1,0]
    v_pk_mul_f32 v[196:197], v[212:213], v[110:111] op_sel:[0,0] op_sel_hi:[1,0]
    v_pk_mul_f32 v[198:199], v[214:215], v[110:111] op_sel:[0,0] op_sel_hi:[1,0]
    v_pk_mul_f32 v[200:201], v[200:201], v[110:111] op_sel:[0,1] op_sel_hi:[1,1]
    v_pk_mul_f32 v[202:203], v[202:203], v[110:111] op_sel:[0,1] op_sel_hi:[1,1]
    v_pk_mul_f32 v[204:205], v[204:205], v[110:111] op_sel:[0,1] op_sel_hi:[1,1]
    v_pk_mul_f32 v[206:207], v[206:207], v[110:111] op_sel:[0,1] op_sel_hi:[1,1]
    v_pk_mul_f32 v[208:209], v[208:209], v[110:111] op_sel:[0,1] op_sel_hi:[1,1]
    v_pk_mul_f32 v[210:211], v[210:211], v[110:111] op_sel:[0,1] op_sel_hi:[1,1]
    v_pk_mul_f32 v[212:213], v[212:213], v[110:111] op_sel:[0,1] op_sel_hi:[1,1]
    v_pk_mul_f32 v[214:215], v[214:215], v[110:111] op_sel:[0,1] op_sel_hi:[1,1]
    v_pk_mul_f32 v[216:217], v[216:217], v[96:97] op_sel:[0,0] op_sel_hi:[1,0]
    v_pk_mul_f32 v[218:219], v[218:219], v[96:97] op_sel:[0,0] op_sel_hi:[1,0]
    v_pk_mul_f32 v[220:221], v[220:221], v[96:97] op_sel:[0,0] op_sel_hi:[1,0]
    v_pk_mul_f32 v[222:223], v[222:223], v[96:97] op_sel:[0,0] op_sel_hi:[1,0]
    v_pk_mul_f32 v[224:225], v[224:225], v[96:97] op_sel:[0,1] op_sel_hi:[1,1]
    v_pk_mul_f32 v[226:227], v[226:227], v[96:97] op_sel:[0,1] op_sel_hi:[1,1]
    v_pk_mul_f32 v[228:229], v[228:229], v[96:97] op_sel:[0,1] op_sel_hi:[1,1]
    v_pk_mul_f32 v[230:231], v[230:231], v[96:97] op_sel:[0,1] op_sel_hi:[1,1]
    v_mov_b32 v96, 0x80000000
    v_xor_b32 v160, v96, v152
    v_xor_b32 v164, v96, v156
    v_xor_b32 v161, v96, v153
    v_xor_b32 v165, v96, v157
    v_xor_b32 v162, v96, v154
    v_xor_b32 v166, v96, v158
    v_xor_b32 v163, v96, v155
    v_xor_b32 v167, v96, v159
    s_branch L_a_pw
L_a_pl:
    buffer_load_dwordx4 v[8:11], v5, s[36:39], s14 offen offset:0 sc1
    buffer_load_dwordx4 v[12:15], v5, s[36:39], s14 offen offset:2048 sc1
L_a_pw:
    s_waitcnt vmcnt(0)
    v_swap_b32 v10, v12
    v_swap_b32 v11, v13
    v_xor_b32 v96, v104, v8
    v_xor_b32 v97, v105, v9
    v_mfma_f32_16x16x32_bf16 v[64:67], v[144:147], v[8:11], 0
    v_bitop3_b32 v96, v10, v104, v96 bitop3:0xbe
    v_bitop3_b32 v97, v11, v105, v97 bitop3:0xbe
    v_mfma_f32_16x16x32_bf16 v[68:71], v[148:151], v[8:11], 0
    v_bitop3_b32 v96, v12, v104, v96 bitop3:0xbe
    v_bitop3_b32 v97, v13, v105, v97 bitop3:0xbe
    v_mfma_f32_16x16x32_bf16 v[72:75], v[144:147], v[12:15], 0
    v_bitop3_b32 v96, v14, v104, v96 bitop3:0xbe
    v_bitop3_b32 v97, v15, v105, v97 bitop3:0xbe
    v_mfma_f32_16x16x32_bf16 v[76:79], v[148:151], v[12:15], 0
    v_bitop3_b32 v96, v96, v97, v106 bitop3:0xa8
    v_cmp_ne_u32 vcc, 0, v96
    s_nop 0
    s_cbranch_vccz L_a_pl_ok
    s_sleep 1
    s_sub_u32 s90, s90, 1
    s_cbranch_scc0 L_a_pl
    s_mov_b32 s90, 0
L_a_pl_ok:
    v_cvt_pk_bf16_f32 v16, v64, v68
    v_cvt_pk_bf16_f32 v17, v65, v69
    ds_write2st64_b32 v6, v16, v17 offset0:0 offset1:4
    v_cvt_pk_bf16_f32 v18, v66, v70
    v_cvt_pk_bf16_f32 v19, v67, v71
    ds_write2st64_b32 v6, v18, v19 offset0:8 offset1:12
    v_cvt_pk_bf16_f32 v20, v72, v76
    v_cvt_pk_bf16_f32 v21, v73, v77
    ds_write2st64_b32 v7, v20, v21 offset0:2 offset1:6
    v_cvt_pk_bf16_f32 v22, v74, v78
    v_cvt_pk_bf16_f32 v23, v75, v79
    ds_write2st64_b32 v7, v22, v23 offset0:10 offset1:14
    s_waitcnt lgkmcnt(0)
    s_barrier
    ds_read_b128 v[16:19], v62 offset:0
    ds_read_b128 v[20:23], v62 offset:1024
    s_waitcnt lgkmcnt(1)
    v_mfma_f32_16x16x32_bf16 v[64:67], v[16:19], v[152:155], 0
    v_mfma_f32_16x16x32_bf16 v[68:71], v[16:19], v[156:159], 0
    s_waitcnt lgkmcnt(0)
    v_mfma_f32_16x16x32_bf16 v[72:75], v[20:23], v[152:155], 0
    v_mfma_f32_16x16x32_bf16 v[76:79], v[20:23], v[156:159], 0
    v_mfma_f32_16x16x32_bf16 v[80:83], v[16:19], v[160:163], 0
    s_nop 2
    v_pk_mul_f32 v[96:97], v[64:65], v[184:185]
    v_pk_mul_f32 v[100:101], v[68:69], v[184:185]
    v_mfma_f32_16x16x32_bf16 v[84:87], v[16:19], v[164:167], 0
    v_pk_mul_f32 v[98:99], v[66:67], v[186:187]
    v_pk_mul_f32 v[102:103], v[70:71], v[186:187]
    v_pk_fma_f32 v[96:97], v[68:69], v[188:189], v[96:97]
    v_pk_fma_f32 v[100:101], v[64:65], v[188:189], v[100:101] neg_lo:[1,0,0] neg_hi:[1,0,0]
    v_mfma_f32_16x16x32_bf16 v[88:91], v[20:23], v[160:163], 0
    v_pk_fma_f32 v[98:99], v[70:71], v[190:191], v[98:99]
    v_pk_fma_f32 v[102:103], v[66:67], v[190:191], v[102:103] neg_lo:[1,0,0] neg_hi:[1,0,0]
    v_cvt_pk_bf16_f32 v112, v96, v100
    v_cvt_pk_bf16_f32 v113, v97, v101
    v_mfma_f32_16x16x32_bf16 v[92:95], v[20:23], v[164:167], 0
    v_cvt_pk_bf16_f32 v114, v98, v102
    v_cvt_pk_bf16_f32 v115, v99, v103
    v_pk_mul_f32 v[96:97], v[72:73], v[192:193]
    v_pk_mul_f32 v[100:101], v[76:77], v[192:193]
    v_mfma_f32_16x16x32_bf16 v[232:235], v[112:115], v[168:171], v[216:219]
    v_pk_mul_f32 v[98:99], v[74:75], v[194:195]
    v_pk_mul_f32 v[102:103], v[78:79], v[194:195]
    v_pk_fma_f32 v[96:97], v[76:77], v[196:197], v[96:97]
    v_pk_fma_f32 v[100:101], v[72:73], v[196:197], v[100:101] neg_lo:[1,0,0] neg_hi:[1,0,0]
    v_mfma_f32_16x16x32_bf16 v[236:239], v[112:115], v[172:175], v[220:223]
    v_pk_fma_f32 v[98:99], v[78:79], v[198:199], v[98:99]
    v_pk_fma_f32 v[102:103], v[74:75], v[198:199], v[102:103] neg_lo:[1,0,0] neg_hi:[1,0,0]
    v_cvt_pk_bf16_f32 v116, v96, v100
    v_cvt_pk_bf16_f32 v117, v97, v101
    v_cvt_pk_bf16_f32 v118, v98, v102
    v_cvt_pk_bf16_f32 v119, v99, v103
    v_pk_mul_f32 v[96:97], v[80:81], v[200:201]
    v_pk_mul_f32 v[100:101], v[84:85], v[200:201]
    v_mfma_f32_16x16x32_bf16 v[232:235], v[116:119], v[176:179], v[232:235]
    v_pk_mul_f32 v[98:99], v[82:83], v[202:203]
    v_pk_mul_f32 v[102:103], v[86:87], v[202:203]
    v_pk_fma_f32 v[96:97], v[84:85], v[204:205], v[96:97]
    v_pk_fma_f32 v[100:101], v[80:81], v[204:205], v[100:101] neg_lo:[1,0,0] neg_hi:[1,0,0]
    v_mfma_f32_16x16x32_bf16 v[236:239], v[116:119], v[180:183], v[236:239]
    v_pk_fma_f32 v[98:99], v[86:87], v[206:207], v[98:99]
    v_pk_fma_f32 v[102:103], v[82:83], v[206:207], v[102:103] neg_lo:[1,0,0] neg_hi:[1,0,0]
    v_cvt_pk_bf16_f32 v120, v96, v100
    v_cvt_pk_bf16_f32 v121, v97, v101
    v_cvt_pk_bf16_f32 v122, v98, v102
    v_cvt_pk_bf16_f32 v123, v99, v103
    v_pk_mul_f32 v[96:97], v[88:89], v[208:209]
    v_pk_mul_f32 v[100:101], v[92:93], v[208:209]
    v_mfma_f32_16x16x32_bf16 v[240:243], v[120:123], v[168:171], v[224:227]
    v_pk_mul_f32 v[98:99], v[90:91], v[210:211]
    v_pk_mul_f32 v[102:103], v[94:95], v[210:211]
    v_pk_fma_f32 v[96:97], v[92:93], v[212:213], v[96:97]
    v_pk_fma_f32 v[100:101], v[88:89], v[212:213], v[100:101] neg_lo:[1,0,0] neg_hi:[1,0,0]
    v_mfma_f32_16x16x32_bf16 v[244:247], v[120:123], v[172:175], v[228:231]
    v_pk_fma_f32 v[98:99], v[94:95], v[214:215], v[98:99]
    v_pk_fma_f32 v[102:103], v[90:91], v[214:215], v[102:103] neg_lo:[1,0,0] neg_hi:[1,0,0]
    v_cvt_pk_bf16_f32 v124, v96, v100
    v_cvt_pk_bf16_f32 v125, v97, v101
    v_cvt_pk_bf16_f32 v126, v98, v102
    v_cvt_pk_bf16_f32 v127, v99, v103
    v_cvt_pk_bf16_f32 v8, v232, v233
    v_cvt_pk_bf16_f32 v9, v234, v235
    v_mfma_f32_16x16x32_bf16 v[240:243], v[124:127], v[176:179], v[240:243]
    v_cvt_pk_bf16_f32 v10, v236, v237
    v_cvt_pk_bf16_f32 v11, v238, v239
    v_mfma_f32_16x16x32_bf16 v[244:247], v[124:127], v[180:183], v[244:247]
    v_permlane16_swap_b32 v8, v10
    v_permlane16_swap_b32 v9, v11
    s_cmp_eq_u32 s93, s97
    s_nop 0
    s_cbranch_scc1 L_sk2
    buffer_store_dwordx4 v[8:11], v4, s[40:43], s12 offen sc1
L_sk2:
    v_cvt_pk_bf16_f32 v12, v240, v241
    v_cvt_pk_bf16_f32 v13, v242, v243
    s_nop 0
    v_cvt_pk_bf16_f32 v14, v244, v245
    v_cvt_pk_bf16_f32 v15, v246, v247
    s_nop 0
    v_permlane16_swap_b32 v12, v14
    v_permlane16_swap_b32 v13, v15
    s_cmp_eq_u32 s94, s97
    s_cbranch_scc1 L_sk3
    s_and_b32 s60, s58, 127
    s_cbranch_scc0 L_sk3
    buffer_store_dwordx4 v[12:15], v4, s[40:43], s13 offen sc1
L_sk3:
    s_endpgm
L_ack128:
    s_mov_b32 m0, 44032
    s_mov_b64 exec, 1
    v_mov_b32 v96, 0x1000
    v_mov_b32 v97, s59
    buffer_store_dword v97, v96, s[36:39], 0 offen sc1
    s_mov_b64 exec, -1
    s_branch L_nos2
L_low:
    s_lshl_b32 s60, s56, 3
    s_mul_i32 s62, s56, 6
    s_add_u32 s62, s62, 8
    s_cmp_lt_u32 s56, 4
    s_cselect_b32 s60, s60, s62
    s_cselect_b32 s61, 8, 6
    s_and_b32 s62, s57, 7
    s_add_u32 s58, s60, s62
    s_cmp_ge_u32 s62, s61
    s_cbranch_scc1 L_misc
    s_cmp_lt_u32 s57, 8
    s_cbranch_scc1 L_f
    v_lshrrev_b32 v4, 1, v0
    v_and_b32 v5, 1, v0
    v_lshlrev_b32 v5, 6, v5
    s_lshl_b32 s61, s3, 5
    v_add_u32 v4, s61, v4
    v_mul_u32_u24 v4, 3584, v4
    v_add_u32 v4, v4, v5
    s_lshr_b32 s60, s58, 1
    s_lshl_b32 s60, s60, 7
    s_bitcmp1_b32 s58, 0
    s_cselect_b32 s61, 917504, 0
    s_cselect_b32 s62, 458752, 0
    s_add_u32 s61, s61, s60
    s_add_u32 s62, s62, s60
    s_waitcnt lgkmcnt(0)
    s_mov_b32 s44, s18
    s_mov_b32 s45, s19
    s_mov_b32 s46, 0x1c0000
    s_mov_b32 s47, 0x20000
    s_mov_b32 s48, s20
    s_mov_b32 s49, s21
    s_mov_b32 s50, 0x1c0000
    s_mov_b32 s51, 0x20000
    buffer_load_dword v8, v4, s[48:51], s61 offen
    s_barrier
    s_cmp_ge_u32 s3, 4
    s_cbranch_scc1 L_end
    buffer_load_dword v10, v4, s[44:47], s62 offen
    s_endpgm
L_misc:
    s_cmp_eq_u32 s57, 7
    s_cbranch_scc1 L_fin
    s_cmp_eq_u32 s57, 14
    s_cbranch_scc1 L_fin
    s_cmp_eq_u32 s57, 15
    s_cbranch_scc1 L_w
    s_cmp_lg_u32 s56, 4
    s_cbranch_scc1 L_end
    s_mov_b32 s58, 128
    s_mov_b32 s9, 0
    s_mov_b32 s57, 15
    s_branch L_a
L_w:
    s_and_b32 s60, s56, 3
    s_lshl3_add_u32 s60, s60, s3
    s_lshl_b32 s61, s60, 12
    s_add_u32 s61, s61, 0x40000
    v_lshlrev_b32 v4, 6, v2
    v_lshl_add_u32 v4, v3, 11, v4
    v_lshlrev_b32 v6, 6, v0
    v_mov_b32 v5, 0
    s_waitcnt lgkmcnt(0)
    s_mov_b32 s36, s30
    s_mov_b32 s37, s31
    s_mov_b32 s38, 0x400000
    s_mov_b32 s39, 0x20000
    s_mov_b32 exec_hi, 0
    buffer_atomic_or v5, v4, s[36:39], s61 offen sc1
    s_cmp_lg_u32 s60, 0
    s_cbranch_scc1 L_end
    s_movk_i32 s61, 0x2000
    buffer_atomic_or v5, v6, s[36:39], s61 offen sc1
    s_endpgm
L_f:
    s_lshr_b32 s95, s58, 1
    s_xor_b32 s98, s3, 7
    v_lshrrev_b32 v8, 3, v0
    v_and_b32 v9, 2, v8
    v_and_b32 v10, 7, v0
    v_xor_b32 v9, v9, v10
    v_lshlrev_b32 v9, 4, v9
    v_lshl_add_u32 v5, v8, 10, v9
    v_xor_b32 v6, 64, v5
    s_lshl_b32 s13, s58, 15
    s_lshl_b32 s61, s3, 7
    s_add_u32 s13, s13, s61
    s_lshl_b32 s6, s3, 12
    s_add_u32 s6, s6, 65536
    s_waitcnt lgkmcnt(0)
    s_load_dword s59, s[30:31], 0
    s_mov_b32 s32, s4
    s_mov_b32 s33, s5
    s_mov_b32 s34, 0x200000
    s_mov_b32 s35, 0x20000
    s_mov_b32 s36, s30
    s_mov_b32 s37, s31
    s_mov_b32 s38, 0x400000
    s_mov_b32 s39, 0x20000
    s_mov_b32 s52, s22
    s_mov_b32 s53, s23
    s_mov_b32 s54, 0x1c0000
    s_mov_b32 s55, 0x20000
    s_waitcnt lgkmcnt(0)
    s_add_u32 s59, s59, 0x9e3779b9
    s_bitcmp1_b32 s59, 0
    s_cselect_b32 s91, 1, 0x10000
    s_xor_b32 s92, s91, 0x10001
    s_add_u32 m0, s6, 0
    s_nop 0
    buffer_load_dwordx4 v5, s[52:55], s13 offen lds
    s_add_u32 s13, s13, 8192
    s_add_u32 m0, s6, 1024
    s_nop 0
    buffer_load_dwordx4 v6, s[52:55], s13 offen lds
    s_add_u32 s13, s13, 8192
    s_add_u32 m0, s6, 2048
    s_nop 0
    buffer_load_dwordx4 v5, s[52:55], s13 offen lds
    s_add_u32 s13, s13, 8192
    s_add_u32 m0, s6, 3072
    s_nop 0
    buffer_load_dwordx4 v6, s[52:55], s13 offen lds
    s_cmp_lg_u32 s3, 0
    s_cbranch_scc1 L_nomf
    v_mov_b32 v252, s18
    v_mov_b32 v253, s19
    v_writelane_b32 v252, s20, 1
    v_writelane_b32 v253, s21, 1
    v_writelane_b32 v252, s4, 2
    v_writelane_b32 v253, s5, 2
    s_add_u32 s63, s30, 0x3000
    v_writelane_b32 v252, s63, 3
    s_addc_u32 s63, s31, 0
    v_writelane_b32 v253, s63, 3
    s_mov_b64 exec, 0xf
    global_load_dword v254, v[252:253], off
    s_mov_b64 exec, -1
L_nomf:
    s_cmp_lt_u32 s98, 4
    s_cselect_b32 s44, s18, s20
    s_cselect_b32 s45, s19, s21
    s_mov_b32 s46, 0x1c0000
    s_mov_b32 s47, 0x20000
    v_lshrrev_b32 v8, 2, v0
    v_mul_u32_u24 v4, 3584, v8
    v_lshrrev_b32 v8, 2, v8
    v_and_b32 v8, 2, v8
    v_and_b32 v9, 3, v0
    v_xor_b32 v8, v8, v9
    v_lshl_add_u32 v4, v8, 4, v4
    s_and_b32 s60, s98, 3
    s_mul_i32 s12, s60, 458752
    s_lshl_b32 s61, s58, 6
    s_add_u32 s12, s12, s61
    s_lshl_b32 s14, s3, 13
    v_lshrrev_b32 v8, 2, v2
    v_lshl_add_u32 v9, v3, 3, v8
    v_and_b32 v10, 3, v0
    v_lshlrev_b32 v10, 3, v10
    v_and_b32 v11, 1, v3
    v_lshl_add_u32 v7, v9, 6, v10
    v_lshl_add_u32 v7, v11, 5, v7
    v_add_u32 v7, s14, v7
    v_xor_b32 v12, 32, v7
    v_lshrrev_b32 v8, 1, v8
    v_lshl_add_u32 v8, v11, 1, v8
    v_lshl_add_u32 v112, v9, 7, v10
    v_lshl_add_u32 v112, v8, 5, v112
    v_add_u32 v112, s6, v112
    v_xor_b32 v113, 32, v112
    v_xor_b32 v114, 64, v112
    v_xor_b32 v115, 96, v112
    s_and_b32 s60, s98, 3
    s_lshl_b32 s60, s60, 8
    s_add_u32 s60, s60, 98304
    v_lshlrev_b32 v14, 4, v3
    v_add_u32 v15, s60, v14
    s_lshl_b32 s60, s98, 7
    s_add_u32 s60, s60, 99328
    v_add_u32 v107, s60, v14
    v_lshl_add_u32 v111, v3, 5, v10
    v_add_u32 v111, 99328, v111
    v_lshlrev_b32 v108, 3, v3
    v_lshl_add_u32 v108, v2, 5, v108
    s_mul_i32 s8, s3, 7168
    s_lshl_b32 s61, s58, 7
    s_add_u32 s8, s8, s61
    s_add_u32 s8, s8, 0x10000
    s_and_b32 s15, s95, 63
    s_lshl_b32 s15, s15, 11
    s_add_u32 s15, s15, 0x40000
    v_lshlrev_b32 v134, 3, v0
    v_lshlrev_b32 v133, 4, v0
    v_mov_b32 v104, s91
    v_mov_b32 v105, s92
    v_mov_b32 v106, 0x00010001
    s_lshl_b32 s7, s58, 2
    s_add_u32 s7, s7, 0x2000
    v_lshlrev_b32 v122, 8, v0
    v_mov_b32 v123, s59
    v_add_u32 v110, 65536, v247
    s_not_b32 s63, s59
    v_mov_b32 v128, s63
    v_mov_b32 v129, s63
    v_mov_b32 v130, s63
    v_mov_b32 v131, s63
    ds_write_b128 v110, v[128:131] offset:34816
    s_waitcnt vmcnt(0) lgkmcnt(0)
    s_barrier
    s_cmp_lg_u32 s3, 0
    s_cbranch_scc1 L_fq4
    s_mov_b32 m0, 100352
    s_nop 0
    buffer_load_dwordx4 v247, s[36:39], s15 offen sc1 lds
L_fq4:
    s_add_u32 m0, s14, 0
    s_nop 0
    buffer_load_dwordx4 v4, s[44:47], s12 offen lds
    s_add_u32 s12, s12, 57344
    s_add_u32 m0, s14, 1024
    s_nop 0
    buffer_load_dwordx4 v4, s[44:47], s12 offen lds
    s_add_u32 s12, s12, 57344
    s_add_u32 m0, s14, 2048
    s_nop 0
    buffer_load_dwordx4 v4, s[44:47], s12 offen lds
    s_add_u32 s12, s12, 57344
    s_add_u32 m0, s14, 3072
    s_nop 0
    buffer_load_dwordx4 v4, s[44:47], s12 offen lds
    s_add_u32 s12, s12, 57344
    s_cmp_lg_u32 s3, 0
    s_cbranch_scc1 L_fq5
    s_mov_b32 m0, 100352
    s_nop 0
    buffer_load_dwordx4 v247, s[36:39], s15 offen sc1 lds
L_fq5:
    s_add_u32 m0, s14, 4096
    s_nop 0
    buffer_load_dwordx4 v4, s[44:47], s12 offen lds
    s_add_u32 s12, s12, 57344
    s_add_u32 m0, s14, 5120
    s_nop 0
    buffer_load_dwordx4 v4, s[44:47], s12 offen lds
    s_add_u32 s12, s12, 57344
    s_add_u32 m0, s14, 6144
    s_nop 0
    buffer_load_dwordx4 v4, s[44:47], s12 offen lds
    s_add_u32 s12, s12, 57344
    s_add_u32 m0, s14, 7168
    s_nop 0
    buffer_load_dwordx4 v4, s[44:47], s12 offen lds
    ds_read_b64_tr_b16 v[48:49], v112 offset:0
    ds_read_b64_tr_b16 v[50:51], v112 offset:512
    ds_read_b64_tr_b16 v[52:53], v113 offset:0
    ds_read_b64_tr_b16 v[54:55], v113 offset:512
    ds_read_b64_tr_b16 v[56:57], v114 offset:0
    ds_read_b64_tr_b16 v[58:59], v114 offset:512
    ds_read_b64_tr_b16 v[60:61], v115 offset:0
    ds_read_b64_tr_b16 v[62:63], v115 offset:512
    s_cmp_lg_u32 s3, 0
    s_cbranch_scc1 L_fk1
    s_mov_b32 m0, 100352
L_fk:
    s_nop 0
    buffer_load_dwordx4 v247, s[36:39], s15 offen sc1 lds
    ds_read_b128 v[128:131], v110 offset:34816
    s_waitcnt lgkmcnt(0)
    v_xor_b32 v129, s59, v129
    v_bitop3_b32 v129, v131, s59, v129 bitop3:0xbe
    v_cmp_ne_u32 vcc, 0, v129
    v_max_u32 v128, v128, v130
    s_nop 0
    s_cbranch_vccz L_fk_ok
    s_sleep 2
    s_sub_u32 s90, s90, 1
    s_cbranch_scc0 L_fk
    s_mov_b32 s90, 0
L_fk_ok:
    v_max_u32_dpp v128, v128, v128 row_ror:8 row_mask:0xf bank_mask:0xf
    s_nop 1
    v_max_u32_dpp v128, v128, v128 row_ror:4 row_mask:0xf bank_mask:0xf
    s_nop 1
    v_max_u32_dpp v128, v128, v128 row_ror:2 row_mask:0xf bank_mask:0xf
    s_nop 1
    v_max_u32_dpp v128, v128, v128 row_ror:1 row_mask:0xf bank_mask:0xf
    s_nop 0
    v_readlane_b32 s97, v128, 0
    v_readlane_b32 s60, v128, 16
    v_readlane_b32 s61, v128, 32
    v_readlane_b32 s62, v128, 48
    s_max_u32 s97, s97, s60
    s_max_u32 s61, s61, s62
    s_max_u32 s97, s97, s61
    s_and_b32 s97, s97, 2047
    s_lshl_b32 s60, s97, 10
    s_mov_b32 m0, 98304
    s_nop 0
    buffer_load_dwordx4 v247, s[32:35], s60 offen lds
    s_waitcnt vmcnt(1)
    s_waitcnt vmcnt(14)
    ds_read_b64_tr_b16 v[16:17], v7 offset:0
    ds_read_b64_tr_b16 v[18:19], v7 offset:256
    ds_read_b64_tr_b16 v[20:21], v12 offset:0
    ds_read_b64_tr_b16 v[22:23], v12 offset:256
    s_waitcnt vmcnt(12)
    ds_read_b64_tr_b16 v[24:25], v7 offset:2048
    ds_read_b64_tr_b16 v[26:27], v7 offset:2304
    ds_read_b64_tr_b16 v[28:29], v12 offset:2048
    ds_read_b64_tr_b16 v[30:31], v12 offset:2304
    s_waitcnt vmcnt(10)
    ds_read_b64_tr_b16 v[32:33], v7 offset:4096
    ds_read_b64_tr_b16 v[34:35], v7 offset:4352
    ds_read_b64_tr_b16 v[36:37], v12 offset:4096
    ds_read_b64_tr_b16 v[38:39], v12 offset:4352
    s_waitcnt vmcnt(8)
    ds_read_b64_tr_b16 v[40:41], v7 offset:6144
    ds_read_b64_tr_b16 v[42:43], v7 offset:6400
    ds_read_b64_tr_b16 v[44:45], v12 offset:6144
    ds_read_b64_tr_b16 v[46:47], v12 offset:6400
    s_waitcnt vmcnt(0)
    s_branch L_f2
L_fk1:
    s_waitcnt vmcnt(6)
    ds_read_b64_tr_b16 v[16:17], v7 offset:0
    ds_read_b64_tr_b16 v[18:19], v7 offset:256
    ds_read_b64_tr_b16 v[20:21], v12 offset:0
    ds_read_b64_tr_b16 v[22:23], v12 offset:256
    s_waitcnt vmcnt(4)
    ds_read_b64_tr_b16 v[24:25], v7 offset:2048
    ds_read_b64_tr_b16 v[26:27], v7 offset:2304
    ds_read_b64_tr_b16 v[28:29], v12 offset:2048
    ds_read_b64_tr_b16 v[30:31], v12 offset:2304
    s_waitcnt vmcnt(2)
    ds_read_b64_tr_b16 v[32:33], v7 offset:4096
    ds_read_b64_tr_b16 v[34:35], v7 offset:4352
    ds_read_b64_tr_b16 v[36:37], v12 offset:4096
    ds_read_b64_tr_b16 v[38:39], v12 offset:4352
    s_waitcnt vmcnt(0)
    ds_read_b64_tr_b16 v[40:41], v7 offset:6144
    ds_read_b64_tr_b16 v[42:43], v7 offset:6400
    ds_read_b64_tr_b16 v[44:45], v12 offset:6144
    ds_read_b64_tr_b16 v[46:47], v12 offset:6400
L_f2:
    s_waitcnt lgkmcnt(0)
    s_barrier
    ds_read_b128 v[64:67], v15 offset:0
    ds_read_b128 v[68:71], v15 offset:64
    ds_read_b128 v[72:75], v15 offset:128
    ds_read_b128 v[76:79], v15 offset:192
    s_waitcnt lgkmcnt(3)
    v_mfma_f32_16x16x32_bf16 v[80:83], v[16:19], v[64:67], 0
    v_mfma_f32_16x16x32_bf16 v[84:87], v[20:23], v[64:67], 0
    s_waitcnt lgkmcnt(2)
    v_mfma_f32_16x16x32_bf16 v[80:83], v[24:27], v[68:71], v[80:83]
    v_mfma_f32_16x16x32_bf16 v[84:87], v[28:31], v[68:71], v[84:87]
    s_waitcnt lgkmcnt(1)
    v_mfma_f32_16x16x32_bf16 v[80:83], v[32:35], v[72:75], v[80:83]
    v_mfma_f32_16x16x32_bf16 v[84:87], v[36:39], v[72:75], v[84:87]
    s_waitcnt lgkmcnt(0)
    v_mfma_f32_16x16x32_bf16 v[80:83], v[40:43], v[76:79], v[80:83]
    v_mfma_f32_16x16x32_bf16 v[84:87], v[44:47], v[76:79], v[84:87]
    s_mov_b32 exec_lo, 0x10001
    s_mov_b32 exec_hi, 0x10001
    s_nop 4
    ds_write_b128 v107, v[80:83] offset:0
    ds_write_b128 v107, v[84:87] offset:64
    s_mov_b64 exec, -1
    s_waitcnt lgkmcnt(0)
    s_barrier
    ds_read_b64 v[64:65], v111 offset:0
    ds_read_b64 v[66:67], v111 offset:128
    ds_read_b64 v[68:69], v111 offset:256
    ds_read_b64 v[70:71], v111 offset:384
    ds_read_b64 v[72:73], v111 offset:512
    ds_read_b64 v[74:75], v111 offset:640
    ds_read_b64 v[76:77], v111 offset:768
    ds_read_b64 v[78:79], v111 offset:896
    s_cmp_lg_u32 s3, 7
    s_cbranch_scc1 L_fr6
    s_mov_b64 exec, 0xff
    buffer_store_dword v123, v122, s[36:39], s7 offen sc1
    s_mov_b64 exec, -1
L_fr6:
    s_waitcnt lgkmcnt(4)
    v_pk_add_f32 v[64:65], v[64:65], v[66:67]
    v_pk_add_f32 v[68:69], v[68:69], v[70:71]
    v_pk_add_f32 v[64:65], v[64:65], v[68:69]
    v_mul_f32 v67, 0xbfb8aa3b, v65
    v_mul_f32 v66, 0xbfb8aa3b, v64
    v_exp_f32 v67, v67
    v_exp_f32 v66, v66
    v_add_f32 v67, 1.0, v67
    v_add_f32 v66, 1.0, v66
    v_rcp_f32 v67, v67
    v_rcp_f32 v66, v66
    s_nop 0
    v_pk_mul_f32 v[64:65], v[64:65], v[66:67]
    s_waitcnt lgkmcnt(0)
    v_pk_add_f32 v[72:73], v[72:73], v[74:75]
    v_pk_add_f32 v[76:77], v[76:77], v[78:79]
    v_pk_add_f32 v[72:73], v[72:73], v[76:77]
    v_pk_mul_f32 v[64:65], v[64:65], v[72:73]
    v_cvt_pk_bf16_f32 v64, v64, v65
    s_nop 1
    v_mov_b32_dpp v72, v64 quad_perm:[0,0,0,0] row_mask:0xf bank_mask:0xf
    v_mov_b32_dpp v73, v64 quad_perm:[1,1,1,1] row_mask:0xf bank_mask:0xf
    v_mov_b32_dpp v74, v64 quad_perm:[2,2,2,2] row_mask:0xf bank_mask:0xf
    v_mov_b32_dpp v75, v64 quad_perm:[3,3,3,3] row_mask:0xf bank_mask:0xf
    s_nop 1
    v_mfma_f32_16x16x32_bf16 v[88:91], v[48:51], v[72:75], 0
    v_mfma_f32_16x16x32_bf16 v[92:95], v[52:55], v[72:75], 0
    v_mfma_f32_16x16x32_bf16 v[96:99], v[56:59], v[72:75], 0
    v_mfma_f32_16x16x32_bf16 v[100:103], v[60:63], v[72:75], 0
    s_mov_b32 exec_lo, 0x10001
    s_mov_b32 exec_hi, 0x10001
    s_nop 2
    v_cvt_pk_bf16_f32 v120, v88, v89
    v_cvt_pk_bf16_f32 v121, v90, v91
    s_mov_b32 exec_lo, 0x20002
    s_mov_b32 exec_hi, 0x20002
    v_cvt_pk_bf16_f32 v120, v92, v93
    v_cvt_pk_bf16_f32 v121, v94, v95
    s_mov_b32 exec_lo, 0x40004
    s_mov_b32 exec_hi, 0x40004
    v_cvt_pk_bf16_f32 v120, v96, v97
    v_cvt_pk_bf16_f32 v121, v98, v99
    s_mov_b32 exec_lo, 0x80008
    s_mov_b32 exec_hi, 0x80008
    v_cvt_pk_bf16_f32 v120, v100, v101
    v_cvt_pk_bf16_f32 v121, v102, v103
    s_mov_b32 exec_lo, 0x000f000f
    s_mov_b32 exec_hi, 0x000f000f
    v_bitop3_b32 v120, v106, v104, v120 bitop3:0xca
    v_bitop3_b32 v121, v106, v105, v121 bitop3:0xca
    buffer_store_dwordx2 v[120:121], v108, s[36:39], s8 offen sc1
    s_mov_b64 exec, -1
    s_endpgm
L_fin:
    v_lshlrev_b32 v4, 5, v2
    v_and_b32 v96, 1, v3
    v_lshl_add_u32 v4, v96, 9, v4
    v_lshrrev_b32 v96, 1, v3
    v_lshl_add_u32 v4, v96, 4, v4
    s_add_u32 s95, s56, 24
    s_lshr_b32 s99, s57, 1
    s_and_b32 s99, s99, 4
    s_add_u32 s99, s99, s56
    s_sub_u32 s99, s99, 4
    s_waitcnt lgkmcnt(0)
    s_load_dword s59, s[30:31], 0
    s_mov_b32 s32, s4
    s_mov_b32 s33, s5
    s_mov_b32 s34, 0x200000
    s_mov_b32 s35, 0x20000
    s_mov_b32 s36, s30
    s_mov_b32 s37, s31
    s_mov_b32 s38, 0x400000
    s_mov_b32 s39, 0x20000
    s_mov_b32 s48, s24
    s_mov_b32 s49, s25
    s_mov_b32 s50, 0x400
    s_mov_b32 s51, 0x20000
    buffer_load_dwordx4 v[28:31], v4, s[48:51], 0 offen
    s_lshl_b32 s60, s3, 10
    v_lshl_add_u32 v248, v0, 4, s60
    s_add_u32 m0, s60, 32768
    global_load_lds_dwordx4 v248, s[10:11] offset:0
    s_and_b32 s63, s3, 1
    s_add_u32 s63, s63, 8
    s_lshl_b32 s60, s63, 10
    v_lshl_add_u32 v248, v0, 4, s60
    s_add_u32 m0, s60, 32768
    global_load_lds_dwordx4 v248, s[10:11] offset:0
    s_mov_b32 s40, s26
    s_mov_b32 s41, s27
    s_mov_b32 s42, 0x200000
    s_mov_b32 s43, 0x20000
    v_mov_b32 v252, s4
    v_mov_b32 v253, s5
    v_writelane_b32 v252, s26, 1
    v_writelane_b32 v253, s27, 1
    s_add_u32 s63, s30, 0x3000
    v_writelane_b32 v252, s63, 2
    s_addc_u32 s63, s31, 0
    v_writelane_b32 v253, s63, 2
    s_add_u32 s63, s30, 0x203000
    v_writelane_b32 v252, s63, 3
    s_addc_u32 s63, s31, 0
    v_writelane_b32 v253, s63, 3
    s_mov_b64 exec, 0xf
    global_load_dword v254, v[252:253], off
    s_mov_b64 exec, -1
    v_lshlrev_b32 v5, 12, v3
    v_lshl_add_u32 v5, v2, 4, v5
    v_lshrrev_b32 v96, 2, v2
    v_xor_b32 v96, v96, v3
    v_and_b32 v96, 1, v96
    v_bfe_u32 v97, v2, 1, 1
    v_lshl_or_b32 v96, v96, 1, v97
    s_lshr_b32 s60, s3, 1
    v_xor_b32 v96, s60, v96
    v_lshlrev_b32 v96, 4, v96
    v_and_b32 v98, 7, v2
    v_lshl_add_u32 v96, v98, 6, v96
    v_lshl_add_u32 v96, v3, 12, v96
    v_lshrrev_b32 v98, 3, v2
    v_lshl_add_u32 v96, v98, 2, v96
    s_and_b32 s60, s3, 1
    s_lshl_b32 s60, s60, 3
    s_add_u32 s60, s60, 16384
    v_add_u32 v6, s60, v96
    v_xor_b32 v7, 48, v6
    v_bfe_u32 v96, v2, 2, 1
    v_xor_b32 v96, v96, v98
    v_lshl_or_b32 v96, v96, 1, v98
    v_xor_b32 v96, v96, v97
    v_xor_b32 v96, v96, v3
    v_lshlrev_b32 v96, 4, v96
    v_lshl_add_u32 v62, v2, 6, v96
    s_and_b32 s15, s95, 63
    s_lshl_b32 s15, s15, 11
    s_add_u32 s15, s15, 0x40000
    v_lshlrev_b32 v134, 3, v0
    v_lshlrev_b32 v133, 4, v0
    s_mul_i32 s7, s99, 7168
    s_lshl_b32 s61, s3, 10
    s_add_u32 s7, s7, s61
    s_add_u32 s7, s7, 0xfc00
    v_and_b32 v108, 1, v3
    v_lshrrev_b32 v111, 1, v3
    v_lshl_add_u32 v108, v108, 1, v111
    v_and_b32 v107, 7, v2
    v_lshl_add_u32 v108, v107, 3, v108
    s_lshl_b32 s60, s3, 8
    s_add_u32 s60, s60, 43008
    v_lshl_add_u32 v108, v108, 2, s60
    v_and_b32 v111, 3, v2
    v_lshlrev_b32 v111, 6, v111
    v_lshl_add_u32 v111, v3, 4, v111
    v_mov_b32 v109, 43016
    s_waitcnt lgkmcnt(0)
    s_add_u32 s59, s59, 0x9e3779b9
    s_bitcmp1_b32 s59, 0
    s_cselect_b32 s91, 1, 0x10000
    s_xor_b32 s92, s91, 0x10001
    s_cmp_lg_u32 s3, 0
    s_cbranch_scc1 L_fin0
    s_cmp_eq_u32 s99, 0
    s_cbranch_scc1 L_fin0
    s_lshl_b32 s60, s99, 7
    v_mov_b32 v96, 0x1000
    v_mov_b32 v97, s59
    s_mov_b64 exec, 1
    buffer_store_dword v97, v96, s[36:39], s60 offen sc1
    s_mov_b64 exec, -1
L_fin0:
    v_mov_b32 v104, s91
    v_mov_b32 v105, s92
    v_mov_b32 v106, 0x00010001
    s_waitcnt vmcnt(0)
    s_barrier
    s_lshr_b32 s60, s99, 2
    s_lshl_b32 s60, s60, 10
    v_add_u32 v110, s60, v247
    ds_read_b128 v[152:155], v247 offset:32768
    ds_read_b128 v[156:159], v247 offset:33792
    ds_read_b128 v[184:187], v247 offset:34816
    ds_read_b128 v[188:191], v247 offset:35840
    ds_read_b128 v[192:195], v247 offset:36864
    ds_read_b128 v[196:199], v247 offset:37888
    ds_read_b128 v[168:171], v110 offset:38912
    ds_read_b128 v[172:175], v110 offset:40960
    s_cmp_lg_u32 s3, 0
    s_cbranch_scc1 L_fin1a
    v_mov_b32 v80, 0
    v_mov_b32 v81, 0
    v_mov_b32 v82, 0
    v_mov_b32 v83, 0
    buffer_atomic_or_x2 v[80:81], v134, s[36:39], s15 offen sc0 sc1
    buffer_atomic_or_x2 v[82:83], v134, s[36:39], s15 offen offset:512 sc0 sc1
    s_sleep 4
    v_mov_b32 v84, 0
    v_mov_b32 v85, 0
    v_mov_b32 v86, 0
    v_mov_b32 v87, 0
    buffer_atomic_or_x2 v[84:85], v134, s[36:39], s15 offen sc0 sc1
    buffer_atomic_or_x2 v[86:87], v134, s[36:39], s15 offen offset:512 sc0 sc1
    s_sleep 4
    v_mov_b32 v88, 0
    v_mov_b32 v89, 0
    v_mov_b32 v90, 0
    v_mov_b32 v91, 0
    buffer_atomic_or_x2 v[88:89], v134, s[36:39], s15 offen sc0 sc1
    buffer_atomic_or_x2 v[90:91], v134, s[36:39], s15 offen offset:512 sc0 sc1
L_kp7:
    s_waitcnt vmcnt(4)
    v_xor_b32 v129, s59, v81
    v_bitop3_b32 v129, v83, s59, v129 bitop3:0xbe
    v_cmp_ne_u32 vcc, 0, v129
    s_nop 0
    s_cbranch_vccz L_kp7_d0
    v_mov_b32 v80, 0
    v_mov_b32 v81, 0
    v_mov_b32 v82, 0
    v_mov_b32 v83, 0
    buffer_atomic_or_x2 v[80:81], v134, s[36:39], s15 offen sc0 sc1
    buffer_atomic_or_x2 v[82:83], v134, s[36:39], s15 offen offset:512 sc0 sc1
    s_waitcnt vmcnt(4)
    v_xor_b32 v129, s59, v85
    v_bitop3_b32 v129, v87, s59, v129 bitop3:0xbe
    v_cmp_ne_u32 vcc, 0, v129
    s_nop 0
    s_cbranch_vccz L_kp7_d1
    v_mov_b32 v84, 0
    v_mov_b32 v85, 0
    v_mov_b32 v86, 0
    v_mov_b32 v87, 0
    buffer_atomic_or_x2 v[84:85], v134, s[36:39], s15 offen sc0 sc1
    buffer_atomic_or_x2 v[86:87], v134, s[36:39], s15 offen offset:512 sc0 sc1
    s_waitcnt vmcnt(4)
    v_xor_b32 v129, s59, v89
    v_bitop3_b32 v129, v91, s59, v129 bitop3:0xbe
    v_cmp_ne_u32 vcc, 0, v129
    s_nop 0
    s_cbranch_vccz L_kp7_d2
    v_mov_b32 v88, 0
    v_mov_b32 v89, 0
    v_mov_b32 v90, 0
    v_mov_b32 v91, 0
    buffer_atomic_or_x2 v[88:89], v134, s[36:39], s15 offen sc0 sc1
    buffer_atomic_or_x2 v[90:91], v134, s[36:39], s15 offen offset:512 sc0 sc1
    s_sub_u32 s90, s90, 1
    s_cbranch_scc0 L_kp7
    s_waitcnt vmcnt(0)
L_kp7_d0:
    v_max_u32 v128, v80, v82
    s_branch L_kp7_x
L_kp7_d1:
    v_max_u32 v128, v84, v86
    s_branch L_kp7_x
L_kp7_d2:
    v_max_u32 v128, v88, v90
L_kp7_x:
    s_nop 1
    v_max_u32_dpp v128, v128, v128 row_ror:8 row_mask:0xf bank_mask:0xf
    s_nop 1
    v_max_u32_dpp v128, v128, v128 row_ror:4 row_mask:0xf bank_mask:0xf
    s_nop 1
    v_max_u32_dpp v128, v128, v128 row_ror:2 row_mask:0xf bank_mask:0xf
    s_nop 1
    v_max_u32_dpp v128, v128, v128 row_ror:1 row_mask:0xf bank_mask:0xf
    s_nop 0
    v_readlane_b32 s97, v128, 0
    v_readlane_b32 s60, v128, 16
    v_readlane_b32 s61, v128, 32
    v_readlane_b32 s62, v128, 48
    s_max_u32 s97, s97, s60
    s_max_u32 s61, s61, s62
    s_max_u32 s97, s97, s61
    v_mov_b32 v110, s97
    ds_write_b32 v109, v110
    s_and_b32 s60, s97, 2047
    s_lshl_b32 s12, s60, 10
    buffer_load_dwordx4 v[40:43], v4, s[32:35], s12 offen
    s_branch L_fin1
L_fin1a:
    s_lshl3_add_u32 s60, s99, s3
    s_cmp_lg_u32 s60, 2
    s_cbranch_scc1 L_fin1
    v_lshlrev_b32 v128, 7, v0
    s_mov_b64 exec, 0xff
    s_movk_i32 s60, 0x1000
L_ack:
    buffer_load_dword v129, v128, s[36:39], s60 offen sc1
    s_waitcnt vmcnt(0)
    v_cmp_ne_u32 vcc, s59, v129
    s_nop 0
    s_cbranch_vccz L_ack_ok
    s_sleep 1
    s_sub_u32 s90, s90, 1
    s_cbranch_scc0 L_ack
    s_mov_b32 s90, 0
L_ack_ok:
    s_mov_b64 exec, -1
L_fin1:
    s_waitcnt lgkmcnt(0)
    s_barrier
    ds_read_b32 v110, v109
    s_waitcnt lgkmcnt(0)
    v_readfirstlane_b32 s8, v110
    s_nop 0
    s_and_b32 s97, s8, 2047
    s_and_b32 s60, s97, 255
    s_and_b32 s61, s97, 15
    s_and_b32 s62, s97, 7
    s_cselect_b32 s60, s61, s60
    s_cselect_b32 s61, 8, 128
    s_cmp_gt_u32 s60, s61
    s_cselect_b32 s96, 0x80000000, 0
    s_sub_u32 s61, 2048, s97
    s_cmp_lg_u32 s96, 0
    s_cselect_b32 s60, s61, s97
    s_and_b32 s58, s60, 255
    s_lshr_b32 s98, s60, 8
    s_lshr_b32 s60, s58, 4
    s_and_b32 s61, s58, 15
    s_lshl4_add_u32 s9, s61, s60
    s_add_u32 s62, s60, s61
    s_cmp_eq_u32 s61, 8
    s_cselect_b32 s9, s62, s9
    s_cmp_eq_u32 s58, 128
    s_cselect_b32 s9, 0, s9
    s_lshl_b32 s14, s9, 14
    s_lshl_b32 s60, s3, 8
    s_add_u32 s14, s14, s60
    s_add_u32 s14, s14, 0x200000
    v_lshrrev_b32 v96, 1, v2
    v_lshlrev_b32 v96, 8, v96
    v_add_u32 v96, s58, v96
    v_and_b32 v97, 1, v2
    v_lshlrev_b32 v98, 1, v3
    v_mul_u32_u24 v98, v98, v96
    v_cmp_eq_u32 vcc, 0, v97
    v_and_b32 v99, 2047, v98
    v_add_u32 v98, v98, v96
    v_cvt_f32_u32 v99, v99
    v_mul_f32 v99, 0x3a000000, v99
    v_cos_f32 v100, v99
    v_sin_f32 v101, v99
    v_mul_f32 v100, 0.5, v100
    v_mul_f32 v101, 0.5, v101
    v_cndmask_b32_e64 v102, -v101, v100, vcc
    v_cndmask_b32 v103, v100, v101, vcc
    v_cvt_pk_bf16_f32 v144, v102, v103
    v_cvt_pk_bf16_f32 v148, -v103, v102
    v_cndmask_b32 v102, v101, v100, vcc
    v_cndmask_b32_e64 v103, -v100, v101, vcc
    v_cvt_pk_bf16_f32 v145, v102, -v103
    v_cvt_pk_bf16_f32 v149, -v103, -v102
    s_and_b32 s60, s58, 127
    s_cbranch_scc1 L_fin_a10
    v_add_f32 v100, v100, v100
    v_add_f32 v101, v101, v101
    v_cndmask_b32 v102, 0, v100, vcc
    v_sub_f32 v103, v100, v102
    v_cvt_pk_bf16_f32 v100, v102, v103
    v_cndmask_b32 v102, 0, v101, vcc
    v_sub_f32 v103, v101, v102
    v_cvt_pk_bf16_f32 v101, -v102, -v103
    s_cmp_eq_u32 s58, 0
    s_cselect_b32 s60, -1, 0
    s_cselect_b32 s61, 0, -1
    v_and_b32 v144, s60, v100
    v_and_b32 v148, s60, v101
    v_and_b32 v145, s61, v100
    v_and_b32 v149, s61, v101
L_fin_a10:
    v_and_b32 v99, 2047, v98
    v_cvt_f32_u32 v99, v99
    v_mul_f32 v99, 0x3a000000, v99
    v_cos_f32 v100, v99
    v_sin_f32 v101, v99
    v_mul_f32 v100, 0.5, v100
    v_mul_f32 v101, 0.5, v101
    v_cndmask_b32_e64 v102, -v101, v100, vcc
    v_cndmask_b32 v103, v100, v101, vcc
    v_cvt_pk_bf16_f32 v146, v102, v103
    v_cvt_pk_bf16_f32 v150, -v103, v102
    v_cndmask_b32 v102, v101, v100, vcc
    v_cndmask_b32_e64 v103, -v100, v101, vcc
    v_cvt_pk_bf16_f32 v147, v102, -v103
    v_cvt_pk_bf16_f32 v151, -v103, -v102
    s_and_b32 s60, s58, 127
    s_cbranch_scc1 L_fin_a11
    v_add_f32 v100, v100, v100
    v_add_f32 v101, v101, v101
    v_cndmask_b32 v102, 0, v100, vcc
    v_sub_f32 v103, v100, v102
    v_cvt_pk_bf16_f32 v100, v102, v103
    v_cndmask_b32 v102, 0, v101, vcc
    v_sub_f32 v103, v101, v102
    v_cvt_pk_bf16_f32 v101, -v102, -v103
    s_cmp_eq_u32 s58, 0
    s_cselect_b32 s60, -1, 0
    s_cselect_b32 s61, 0, -1
    v_and_b32 v146, s60, v100
    v_and_b32 v150, s60, v101
    v_and_b32 v147, s61, v100
    v_and_b32 v151, s61, v101
L_fin_a11:
    s_cmp_lg_u32 s3, 0
    s_cbranch_scc1 L_fin3
    s_lshl_b32 s60, s98, 4
    s_and_b32 s60, s60, 32
    v_xor_b32 v62, s60, v62
    s_lshl_b32 s60, s98, 11
    s_add_u32 s60, s60, 16384
    v_add_u32 v62, s60, v62
    v_xor_b32 v152, s96, v152
    v_xor_b32 v156, s96, v156
    v_xor_b32 v153, s96, v153
    v_xor_b32 v157, s96, v157
    v_xor_b32 v154, s96, v154
    v_xor_b32 v158, s96, v158
    v_xor_b32 v155, s96, v155
    v_xor_b32 v159, s96, v159
    s_ashr_i32 s60, s8, 31
    s_orn2_b32 s60, 0x80000000, s60
    s_xor_b32 s8, s8, s60
    s_waitcnt vmcnt(0)
    v_dot2_f32_bf16 v32, v40, v28, 0
    v_dot2_f32_bf16 v32, v41, v29, v32
    v_dot2_f32_bf16 v32, v42, v30, v32
    v_dot2_f32_bf16 v32, v43, v31, v32
    s_nop 2
    v_add_f32_dpp v32, v32, v32 row_ror:8 row_mask:0xf bank_mask:0xf
    s_nop 1
    v_add_f32_dpp v32, v32, v32 row_ror:4 row_mask:0xf bank_mask:0xf
    s_nop 1
    v_add_f32_dpp v32, v32, v32 row_ror:2 row_mask:0xf bank_mask:0xf
    s_nop 1
    v_add_f32_dpp v32, v32, v32 row_ror:1 row_mask:0xf bank_mask:0xf
    v_mov_b32 v33, v32
    s_nop 1
    v_permlane32_swap_b32 v32, v33
    v_add_f32 v32, v32, v33
    v_mov_b32 v33, v32
    s_nop 1
    v_permlane16_swap_b32 v32, v33
    v_add_f32 v32, v32, v33
    v_mov_b32 v33, s8
    v_mul_f32 v35, 0xbfb8aa3b, v33
    v_mul_f32 v34, 0xbfb8aa3b, v32
    v_exp_f32 v35, v35
    v_exp_f32 v34, v34
    v_add_f32 v35, 1.0, v35
    v_add_f32 v34, 1.0, v34
    v_rcp_f32 v35, v35
    v_rcp_f32 v34, v34
    v_permlane16_swap_b32 v40, v42
    v_permlane16_swap_b32 v41, v43
    s_bitcmp1_b32 s99, 2
    s_cbranch_scc0 L_fint
    v_mov_b32 v40, v42
    v_mov_b32 v41, v43
L_fint:
    v_sub_f32 v36, 1.0, v34
    v_lshlrev_b32 v216, 16, v40
    v_and_b32 v217, 0xffff0000, v40
    v_pk_mul_f32 v[216:217], v[216:217], v[36:37] op_sel_hi:[1,0]
    v_lshlrev_b32 v218, 16, v41
    v_and_b32 v219, 0xffff0000, v41
    v_pk_mul_f32 v[218:219], v[218:219], v[36:37] op_sel_hi:[1,0]
    v_mul_f32 v38, v35, v36
    v_pk_mul_f32 v[184:185], v[184:185], v[34:35] op_sel_hi:[1,0]
    v_pk_mul_f32 v[186:187], v[186:187], v[34:35] op_sel_hi:[1,0]
    v_pk_mul_f32 v[188:189], v[188:189], v[34:35] op_sel_hi:[1,0]
    v_pk_mul_f32 v[190:191], v[190:191], v[34:35] op_sel_hi:[1,0]
    v_pk_mul_f32 v[192:193], v[192:193], v[34:35] op_sel_hi:[1,0]
    v_pk_mul_f32 v[194:195], v[194:195], v[34:35] op_sel_hi:[1,0]
    v_pk_mul_f32 v[196:197], v[196:197], v[34:35] op_sel_hi:[1,0]
    v_pk_mul_f32 v[198:199], v[198:199], v[34:35] op_sel_hi:[1,0]
L_fin3:
    s_barrier
    buffer_load_dwordx4 v[8:11], v5, s[36:39], s14 offen offset:0 sc1
    buffer_load_dwordx4 v[12:15], v5, s[36:39], s14 offen offset:2048 sc1
    s_branch L_fin_pw
L_fin_pl:
    buffer_load_dwordx4 v[8:11], v5, s[36:39], s14 offen offset:0 sc1
    buffer_load_dwordx4 v[12:15], v5, s[36:39], s14 offen offset:2048 sc1
L_fin_pw:
    s_waitcnt vmcnt(0)
    v_swap_b32 v10, v12
    v_swap_b32 v11, v13
    v_xor_b32 v96, v104, v8
    v_xor_b32 v97, v105, v9
    v_mfma_f32_16x16x32_bf16 v[64:67], v[144:147], v[8:11], 0
    v_bitop3_b32 v96, v10, v104, v96 bitop3:0xbe
    v_bitop3_b32 v97, v11, v105, v97 bitop3:0xbe
    v_mfma_f32_16x16x32_bf16 v[68:71], v[148:151], v[8:11], 0
    v_bitop3_b32 v96, v12, v104, v96 bitop3:0xbe
    v_bitop3_b32 v97, v13, v105, v97 bitop3:0xbe
    v_mfma_f32_16x16x32_bf16 v[72:75], v[144:147], v[12:15], 0
    v_bitop3_b32 v96, v14, v104, v96 bitop3:0xbe
    v_bitop3_b32 v97, v15, v105, v97 bitop3:0xbe
    v_mfma_f32_16x16x32_bf16 v[76:79], v[148:151], v[12:15], 0
    v_bitop3_b32 v96, v96, v97, v106 bitop3:0xa8
    v_cmp_ne_u32 vcc, 0, v96
    s_nop 0
    s_cbranch_vccz L_fin_pl_ok
    s_sleep 1
    s_sub_u32 s90, s90, 1
    s_cbranch_scc0 L_fin_pl
    s_mov_b32 s90, 0
L_fin_pl_ok:
    v_cvt_pk_bf16_f32 v16, v64, v68
    v_cvt_pk_bf16_f32 v17, v65, v69
    ds_write2st64_b32 v6, v16, v17 offset0:0 offset1:4
    v_cvt_pk_bf16_f32 v18, v66, v70
    v_cvt_pk_bf16_f32 v19, v67, v71
    ds_write2st64_b32 v6, v18, v19 offset0:8 offset1:12
    v_cvt_pk_bf16_f32 v20, v72, v76
    v_cvt_pk_bf16_f32 v21, v73, v77
    ds_write2st64_b32 v7, v20, v21 offset0:2 offset1:6
    v_cvt_pk_bf16_f32 v22, v74, v78
    v_cvt_pk_bf16_f32 v23, v75, v79
    ds_write2st64_b32 v7, v22, v23 offset0:10 offset1:14
    s_waitcnt lgkmcnt(0)
    s_barrier
    s_cmp_lg_u32 s3, 0
    s_cbranch_scc1 L_pp0
    ds_read_b128 v[16:19], v62 offset:0
    ds_read_b128 v[20:23], v62 offset:1024
    s_waitcnt lgkmcnt(1)
    v_mfma_f32_16x16x32_bf16 v[64:67], v[16:19], v[152:155], 0
    v_mfma_f32_16x16x32_bf16 v[68:71], v[16:19], v[156:159], 0
    s_waitcnt lgkmcnt(0)
    v_mfma_f32_16x16x32_bf16 v[72:75], v[20:23], v[152:155], 0
    v_mfma_f32_16x16x32_bf16 v[76:79], v[20:23], v[156:159], 0
    s_nop 3
    v_pk_mul_f32 v[96:97], v[64:65], v[184:185]
    v_pk_mul_f32 v[100:101], v[68:69], v[184:185]
    v_pk_mul_f32 v[98:99], v[66:67], v[186:187]
    v_pk_mul_f32 v[102:103], v[70:71], v[186:187]
    v_pk_fma_f32 v[96:97], v[68:69], v[188:189], v[96:97]
    v_pk_fma_f32 v[100:101], v[64:65], v[188:189], v[100:101] neg_lo:[1,0,0] neg_hi:[1,0,0]
    v_pk_fma_f32 v[98:99], v[70:71], v[190:191], v[98:99]
    v_pk_fma_f32 v[102:103], v[66:67], v[190:191], v[102:103] neg_lo:[1,0,0] neg_hi:[1,0,0]
    v_cvt_pk_bf16_f32 v112, v96, v100
    v_cvt_pk_bf16_f32 v113, v97, v101
    v_cvt_pk_bf16_f32 v114, v98, v102
    v_cvt_pk_bf16_f32 v115, v99, v103
    s_nop 1
    v_mfma_f32_16x16x32_bf16 v[232:235], v[112:115], v[168:171], v[216:219]
    v_pk_mul_f32 v[96:97], v[72:73], v[192:193]
    v_pk_mul_f32 v[100:101], v[76:77], v[192:193]
    v_pk_mul_f32 v[98:99], v[74:75], v[194:195]
    v_pk_mul_f32 v[102:103], v[78:79], v[194:195]
    v_pk_fma_f32 v[96:97], v[76:77], v[196:197], v[96:97]
    v_pk_fma_f32 v[100:101], v[72:73], v[196:197], v[100:101] neg_lo:[1,0,0] neg_hi:[1,0,0]
    v_pk_fma_f32 v[98:99], v[78:79], v[198:199], v[98:99]
    v_pk_fma_f32 v[102:103], v[74:75], v[198:199], v[102:103] neg_lo:[1,0,0] neg_hi:[1,0,0]
    v_cvt_pk_bf16_f32 v116, v96, v100
    v_cvt_pk_bf16_f32 v117, v97, v101
    v_cvt_pk_bf16_f32 v118, v98, v102
    v_cvt_pk_bf16_f32 v119, v99, v103
    s_nop 1
    v_mfma_f32_16x16x32_bf16 v[232:235], v[116:119], v[172:175], v[232:235]
    v_lshlrev_b32 v4, 5, v2
    v_lshl_add_u32 v4, v3, 3, v4
    s_lshr_b32 s61, s99, 2
    s_lshl_b32 s61, s61, 9
    s_add_u32 s12, s12, s61
    s_barrier
    s_branch L_fin5
L_pp0:
    s_cmp_lg_u32 s3, 1
    s_cbranch_scc1 L_pp1
    s_lshl_b32 s60, s99, 8
    s_add_u32 s60, s60, 0x2000
    v_lshlrev_b32 v128, 2, v0
    s_mov_b32 exec_hi, 0x00ffffff
    v_mov_b32 v129, 0
    buffer_atomic_or v129, v128, s[36:39], s60 offen sc0 sc1
    s_sleep 4
    v_mov_b32 v130, 0
    buffer_atomic_or v130, v128, s[36:39], s60 offen sc0 sc1
    s_sleep 4
    v_mov_b32 v131, 0
    buffer_atomic_or v131, v128, s[36:39], s60 offen sc0 sc1
L_fr:
    s_waitcnt vmcnt(2)
    v_cmp_ne_u32 vcc, s59, v129
    s_nop 0
    s_cbranch_vccz L_fr_d0
    v_mov_b32 v129, 0
    buffer_atomic_or v129, v128, s[36:39], s60 offen sc0 sc1
    s_waitcnt vmcnt(2)
    v_cmp_ne_u32 vcc, s59, v130
    s_nop 0
    s_cbranch_vccz L_fr_d1
    v_mov_b32 v130, 0
    buffer_atomic_or v130, v128, s[36:39], s60 offen sc0 sc1
    s_waitcnt vmcnt(2)
    v_cmp_ne_u32 vcc, s59, v131
    s_nop 0
    s_cbranch_vccz L_fr_d2
    v_mov_b32 v131, 0
    buffer_atomic_or v131, v128, s[36:39], s60 offen sc0 sc1
    s_sub_u32 s90, s90, 1
    s_cbranch_scc0 L_fr
    s_waitcnt vmcnt(0)
L_fr_d0:
    s_branch L_fr_x
L_fr_d1:
    s_branch L_fr_x
L_fr_d2:
L_fr_x:
    s_mov_b64 exec, -1
L_pp1:
    s_barrier
L_pp:
    buffer_load_dwordx4 v[8:11], v247, s[36:39], s7 offen sc1
    s_waitcnt vmcnt(0)
    v_xor_b32 v96, v104, v8
    v_xor_b32 v97, v105, v9
    v_bitop3_b32 v96, v10, v104, v96 bitop3:0xbe
    v_bitop3_b32 v97, v11, v105, v97 bitop3:0xbe
    v_bitop3_b32 v96, v96, v97, v106 bitop3:0xa8
    v_cmp_ne_u32 vcc, 0, v96
    v_lshlrev_b32 v16, 16, v8
    v_and_b32 v17, 0xffff0000, v8
    v_lshlrev_b32 v18, 16, v9
    v_and_b32 v19, 0xffff0000, v9
    v_lshlrev_b32 v20, 16, v10
    v_and_b32 v21, 0xffff0000, v10
    v_lshlrev_b32 v22, 16, v11
    v_and_b32 v23, 0xffff0000, v11
    s_cbranch_vccz L_pp_ok
    s_sleep 1
    s_sub_u32 s90, s90, 1
    s_cbranch_scc0 L_pp
    s_mov_b32 s90, 0
L_pp_ok:
    v_permlane32_swap_b32 v20, v21
    v_permlane32_swap_b32 v16, v17
    v_permlane32_swap_b32 v22, v23
    v_permlane32_swap_b32 v18, v19
    v_add_f32 v20, v20, v21
    v_add_f32 v16, v16, v17
    v_add_f32 v22, v22, v23
    v_add_f32 v18, v18, v19
    s_nop 0
    v_permlane16_swap_b32 v20, v22
    v_permlane16_swap_b32 v16, v18
    v_add_f32 v20, v20, v22
    v_add_f32 v16, v16, v18
    s_nop 1
    v_add_f32_dpp v16, v16, v16 row_ror:8 row_mask:0xf bank_mask:0xf
    v_add_f32_dpp v20, v20, v20 row_ror:8 row_mask:0xf bank_mask:0xf
    ds_write2_b32 v108, v16, v20 offset0:0 offset1:4
    s_waitcnt lgkmcnt(0)
L_fin5:
    s_barrier
    s_cmp_lg_u32 s3, 0
    s_cbranch_scc1 L_fin7
    ds_read_b128 v[64:67], v111 offset:43264
    ds_read_b128 v[68:71], v111 offset:43520
    ds_read_b128 v[72:75], v111 offset:43776
    ds_read_b128 v[76:79], v111 offset:44032
    ds_read_b128 v[80:83], v111 offset:44288
    ds_read_b128 v[84:87], v111 offset:44544
    ds_read_b128 v[88:91], v111 offset:44800
    s_and_b32 s61, s99, 3
    s_lshl_b32 s61, s61, 2
    s_waitcnt lgkmcnt(0)
    v_pk_add_f32 v[68:69], v[68:69], v[72:73]
    v_pk_add_f32 v[70:71], v[70:71], v[74:75]
    v_pk_add_f32 v[76:77], v[76:77], v[80:81]
    v_pk_add_f32 v[78:79], v[78:79], v[82:83]
    v_pk_add_f32 v[84:85], v[84:85], v[88:89]
    v_pk_add_f32 v[86:87], v[86:87], v[90:91]
    v_pk_add_f32 v[64:65], v[64:65], v[68:69]
    v_pk_add_f32 v[76:77], v[76:77], v[84:85]
    v_pk_add_f32 v[66:67], v[66:67], v[70:71]
    v_pk_add_f32 v[78:79], v[78:79], v[86:87]
    v_pk_add_f32 v[64:65], v[64:65], v[76:77]
    v_pk_add_f32 v[66:67], v[66:67], v[78:79]
    v_pk_fma_f32 v[64:65], v[64:65], v[38:39], v[232:233] op_sel_hi:[1,0,1]
    v_pk_fma_f32 v[66:67], v[66:67], v[38:39], v[234:235] op_sel_hi:[1,0,1]
    v_cvt_pk_bf16_f32 v16, v64, v65
    v_cvt_pk_bf16_f32 v17, v66, v67
    s_lshl_b32 exec_lo, 0x000f000f, s61
    s_mov_b32 exec_hi, exec_lo
    buffer_store_dwordx2 v[16:17], v4, s[40:43], s12 offen sc1
    s_cmp_lg_u32 s99, 0
    s_cbranch_scc1 L_fin7
    s_mov_b64 exec, 1
    v_mov_b32 v20, 0
    v_mov_b32 v21, s59
    buffer_store_dword v21, v20, s[36:39], 0 offen sc1
L_fin7:
    s_endpgm
L_end:
    s_endpgm
.p2align 7
.type L_tab,@object
L_tab:
.long 0x3f80, 0x3f80, 0x3f80, 0x3f80, 0x3f80, 0x3ec43f6d, 0x3f353f35, 0x3f6d3ec4
.long 0x3f80, 0x3f353f35, 0x3f800000, 0x3f35bf35, 0x3f80, 0x3f6d3ec4, 0x3f35bf35, 0xbec4bf6d
.long 0x3f80, 0x3f800000, 0xbf80, 0xbf800000, 0x3f80, 0x3f6dbec4, 0xbf35bf35, 0xbec43f6d
.long 0x3f80, 0x3f35bf35, 0xbf800000, 0x3f353f35, 0x3f80, 0x3ec4bf6d, 0xbf353f35, 0x3f6dbec4
.long 0x3f80, 0xbf80, 0x3f80, 0xbf80, 0x3f80, 0xbec4bf6d, 0x3f353f35, 0xbf6dbec4
.long 0x3f80, 0xbf35bf35, 0x3f800000, 0xbf353f35, 0x3f80, 0xbf6dbec4, 0x3f35bf35, 0x3ec43f6d
.long 0x3f80, 0xbf800000, 0xbf80, 0x3f800000, 0x3f80, 0xbf6d3ec4, 0xbf35bf35, 0x3ec4bf6d
.long 0x3f80, 0xbf353f35, 0xbf800000, 0xbf35bf35, 0x3f80, 0xbec43f6d, 0xbf353f35, 0xbf6d3ec4
.long 0x3f80, 0x3f80, 0x3f80, 0x3f80, 0x3f800000, 0x3f6dbec4, 0x3f35bf35, 0x3ec4bf6d
.long 0xbf80, 0xbf35bf35, 0xbf800000, 0xbf353f35, 0xbf800000, 0xbec43f6d, 0x3f353f35, 0x3f6dbec4
.long 0x3f80, 0x3f800000, 0xbf80, 0xbf800000, 0x3f800000, 0xbec4bf6d, 0xbf353f35, 0x3f6d3ec4
.long 0xbf80, 0xbf353f35, 0x3f800000, 0xbf35bf35, 0xbf800000, 0x3f6d3ec4, 0xbf35bf35, 0x3ec43f6d
.long 0x3f80, 0xbf80, 0x3f80, 0xbf80, 0x3f800000, 0xbf6d3ec4, 0x3f35bf35, 0xbec43f6d
.long 0xbf80, 0x3f353f35, 0xbf800000, 0x3f35bf35, 0xbf800000, 0x3ec4bf6d, 0x3f353f35, 0xbf6d3ec4
.long 0x3f80, 0xbf800000, 0xbf80, 0x3f800000, 0x3f800000, 0x3ec43f6d, 0xbf353f35, 0xbf6dbec4
.long 0xbf80, 0x3f35bf35, 0x3f800000, 0x3f353f35, 0xbf800000, 0xbf6dbec4, 0xbf35bf35, 0xbec4bf6d
.long 0x3f80, 0x3f80, 0x3f80, 0x3f80, 0xbf80, 0xbec4bf6d, 0xbf35bf35, 0xbf6dbec4
.long 0x3f80, 0x3f353f35, 0x3f800000, 0x3f35bf35, 0xbf80, 0xbf6dbec4, 0xbf353f35, 0x3ec43f6d
.long 0x3f80, 0x3f800000, 0xbf80, 0xbf800000, 0xbf80, 0xbf6d3ec4, 0x3f353f35, 0x3ec4bf6d
.long 0x3f80, 0x3f35bf35, 0xbf800000, 0x3f353f35, 0xbf80, 0xbec43f6d, 0x3f35bf35, 0xbf6d3ec4
.long 0x3f80, 0xbf80, 0x3f80, 0xbf80, 0xbf80, 0x3ec43f6d, 0xbf35bf35, 0x3f6d3ec4
.long 0x3f80, 0xbf35bf35, 0x3f800000, 0xbf353f35, 0xbf80, 0x3f6d3ec4, 0xbf353f35, 0xbec4bf6d
.long 0x3f80, 0xbf800000, 0xbf80, 0x3f800000, 0xbf80, 0x3f6dbec4, 0x3f353f35, 0xbec43f6d
.long 0x3f80, 0xbf353f35, 0xbf800000, 0xbf35bf35, 0xbf80, 0x3ec4bf6d, 0x3f35bf35, 0x3f6dbec4
.long 0x3f80, 0x3f80, 0x3f80, 0x3f80, 0xbf800000, 0xbf6d3ec4, 0xbf353f35, 0xbec43f6d
.long 0xbf80, 0xbf35bf35, 0xbf800000, 0xbf353f35, 0x3f800000, 0x3ec4bf6d, 0xbf35bf35, 0xbf6d3ec4
.long 0x3f80, 0x3f800000, 0xbf80, 0xbf800000, 0xbf800000, 0x3ec43f6d, 0x3f35bf35, 0xbf6dbec4
.long 0xbf80, 0xbf353f35, 0x3f800000, 0xbf35bf35, 0x3f800000, 0xbf6dbec4, 0x3f353f35, 0xbec4bf6d
.long 0x3f80, 0xbf80, 0x3f80, 0xbf80, 0xbf800000, 0x3f6dbec4, 0xbf353f35, 0x3ec4bf6d
.long 0xbf80, 0x3f353f35, 0xbf800000, 0x3f35bf35, 0x3f800000, 0xbec43f6d, 0xbf35bf35, 0x3f6dbec4
.long 0x3f80, 0xbf800000, 0xbf80, 0x3f800000, 0xbf800000, 0xbec4bf6d, 0x3f35bf35, 0x3f6d3ec4
.long 0xbf80, 0x3f35bf35, 0x3f800000, 0x3f353f35, 0x3f800000, 0x3f6d3ec4, 0x3f353f35, 0x3ec43f6d
.long 0x3f808000, 0x3f808000, 0x3f808000, 0x3f808000, 0x3f808000, 0x3f6dbec4, 0x3f35bf35, 0x3ec4bf6d
.long 0x3f808000, 0x3f35bf35, 0xbf80, 0xbf35bf35, 0x3f808000, 0x3ec4bf6d, 0xbf35bf35, 0xbf6d3ec4
.long 0x3f808000, 0xbf80, 0xbf808000, 0x3f80, 0x3f808000, 0xbec4bf6d, 0xbf353f35, 0x3f6d3ec4
.long 0x3f808000, 0xbf35bf35, 0x3f80, 0x3f35bf35, 0x3f808000, 0xbf6dbec4, 0x3f353f35, 0xbec4bf6d
.long 0x3f808000, 0xbf808000, 0x3f808000, 0xbf808000, 0x3f808000, 0xbf6d3ec4, 0x3f35bf35, 0xbec43f6d
.long 0x3f808000, 0xbf353f35, 0xbf80, 0x3f353f35, 0x3f808000, 0xbec43f6d, 0xbf35bf35, 0x3f6dbec4
.long 0x3f808000, 0x3f80, 0xbf808000, 0xbf80, 0x3f808000, 0x3ec43f6d, 0xbf353f35, 0xbf6dbec4
.long 0x3f808000, 0x3f353f35, 0x3f80, 0xbf353f35, 0x3f808000, 0x3f6d3ec4, 0x3f353f35, 0x3ec43f6d
.long 0x3f808000, 0x3f808000, 0x3f808000, 0x3f808000, 0xbf80, 0xbec4bf6d, 0xbf35bf35, 0xbf6dbec4
.long 0xbf808000, 0xbf353f35, 0x3f80, 0x3f353f35, 0x3f80, 0x3f6d3ec4, 0x3f35bf35, 0xbec4bf6d
.long 0x3f808000, 0xbf80, 0xbf808000, 0x3f80, 0xbf80, 0xbf6d3ec4, 0x3f353f35, 0x3ec4bf6d
.long 0xbf808000, 0x3f353f35, 0xbf80, 0xbf353f35, 0x3f80, 0x3ec4bf6d, 0xbf353f35, 0x3f6dbec4
.long 0x3f808000, 0xbf808000, 0x3f808000, 0xbf808000, 0xbf80, 0x3ec43f6d, 0xbf35bf35, 0x3f6d3ec4
.long 0xbf808000, 0x3f35bf35, 0x3f80, 0xbf35bf35, 0x3f80, 0xbf6dbec4, 0x3f35bf35, 0x3ec43f6d
.long 0x3f808000, 0x3f80, 0xbf808000, 0xbf80, 0xbf80, 0x3f6dbec4, 0x3f353f35, 0xbec43f6d
.long 0xbf808000, 0xbf35bf35, 0xbf80, 0x3f35bf35, 0x3f80, 0xbec43f6d, 0xbf353f35, 0xbf6d3ec4
.long 0x3f808000, 0x3f808000, 0x3f808000, 0x3f808000, 0xbf808000, 0xbf6d3ec4, 0xbf353f35, 0xbec43f6d
.long 0x3f808000, 0x3f35bf35, 0xbf80, 0xbf35bf35, 0xbf808000, 0xbec43f6d, 0x3f353f35, 0x3f6dbec4
.long 0x3f808000, 0xbf80, 0xbf808000, 0x3f80, 0xbf808000, 0x3ec43f6d, 0x3f35bf35, 0xbf6dbec4
.long 0x3f808000, 0xbf35bf35, 0x3f80, 0x3f35bf35, 0xbf808000, 0x3f6d3ec4, 0xbf35bf35, 0x3ec43f6d
.long 0x3f808000, 0xbf808000, 0x3f808000, 0xbf808000, 0xbf808000, 0x3f6dbec4, 0xbf353f35, 0x3ec4bf6d
.long 0x3f808000, 0xbf353f35, 0xbf80, 0x3f353f35, 0xbf808000, 0x3ec4bf6d, 0x3f353f35, 0xbf6d3ec4
.long 0x3f808000, 0x3f80, 0xbf808000, 0xbf80, 0xbf808000, 0xbec4bf6d, 0x3f35bf35, 0x3f6d3ec4
.long 0x3f808000, 0x3f353f35, 0x3f80, 0xbf353f35, 0xbf808000, 0xbf6dbec4, 0xbf35bf35, 0xbec4bf6d
.long 0x3f808000, 0x3f808000, 0x3f808000, 0x3f808000, 0x3f80, 0x3ec43f6d, 0x3f353f35, 0x3f6d3ec4
.long 0xbf808000, 0xbf353f35, 0x3f80, 0x3f353f35, 0xbf80, 0xbf6dbec4, 0xbf353f35, 0x3ec43f6d
.long 0x3f808000, 0xbf80, 0xbf808000, 0x3f80, 0x3f80, 0x3f6dbec4, 0xbf35bf35, 0xbec43f6d
.long 0xbf808000, 0x3f353f35, 0xbf80, 0xbf353f35, 0xbf80, 0xbec43f6d, 0x3f35bf35, 0xbf6d3ec4
.long 0x3f808000, 0xbf808000, 0x3f808000, 0xbf808000, 0x3f80, 0xbec4bf6d, 0x3f353f35, 0xbf6dbec4
.long 0xbf808000, 0x3f35bf35, 0x3f80, 0xbf35bf35, 0xbf80, 0x3f6d3ec4, 0xbf353f35, 0xbec4bf6d
.long 0x3f808000, 0x3f80, 0xbf808000, 0xbf80, 0x3f80, 0xbf6d3ec4, 0xbf35bf35, 0x3ec4bf6d
.long 0xbf808000, 0xbf35bf35, 0xbf80, 0x3f35bf35, 0xbf80, 0x3ec4bf6d, 0x3f35bf35, 0x3f6dbec4
.long 0x3f800000, 0x3f800000, 0x3f800000, 0x3f800000, 0x3f800000, 0x3f7fec43, 0x3f7fb10f, 0x3f7f4e6d
.long 0x3f800000, 0x3f7fb10f, 0x3f7ec46d, 0x3f7d3aac, 0x3f800000, 0x3f7f4e6d, 0x3f7d3aac, 0x3f79c79d
.long 0x3f800000, 0x3f7ec46d, 0x3f7b14be, 0x3f74fa0b, 0x3f800000, 0x3f7e1324, 0x3f7853f8, 0x3f6ed89e
.long 0x3f800000, 0x3f7d3aac, 0x3f74fa0b, 0x3f676bd8, 0x3f800000, 0x3f7c3b28, 0x3f710908, 0x3f5ebe05
.long 0x3f800000, 0x3f7b14be, 0x3f6c835e, 0x3f54db31, 0x3f800000, 0x3f79c79d, 0x3f676bd8, 0x3f49d112
.long 0x3f800000, 0x3f7853f8, 0x3f61c598, 0x3f3daef9, 0x3f800000, 0x3f76ba07, 0x3f5b941a, 0x3f3085bb
.long 0x3f800000, 0x3f74fa0b, 0x3f54db31, 0x3f226799, 0x3f800000, 0x3f731447, 0x3f4d9f02, 0x3f13682a
.long 0x3f800000, 0x3f710908, 0x3f45e403, 0x3f039c3d, 0x3f800000, 0x3f6ed89e, 0x3f3daef9, 0x3ee63375
.long 0x3f800000, 0x3f800000, 0x3f800000, 0x3f800000, 0x3f7ec46d, 0x3f7e1324, 0x3f7d3aac, 0x3f7c3b28
.long 0x3f7b14be, 0x3f7853f8, 0x3f74fa0b, 0x3f710908, 0x3f74fa0b, 0x3f6ed89e, 0x3f676bd8, 0x3f5ebe05
.long 0x3f6c835e, 0x3f61c598, 0x3f54db31, 0x3f45e403, 0x3f61c598, 0x3f514d3d, 0x3f3daef9, 0x3f273656
.long 0x3f54db31, 0x3f3daef9, 0x3f226799, 0x3f039c3d, 0x3f45e403, 0x3f273656, 0x3f039c3d, 0x3eb8442a
.long 0x3f3504f3, 0x3f0e39da, 0x3ec3ef15, 0x3e47c5c2, 0x3f226799, 0x3ee63375, 0x3e78cfcc, 0x3cc90ab0
.long 0x3f0e39da, 0x3eac7cd4, 0x3dc8bd36, 0xbe164083, 0x3ef15aea, 0x3e605c13, 0xbd48fb30, 0xbea09ae5
.long 0x3ec3ef15, 0x3dc8bd36, 0xbe47c5c2, 0xbef15aea, 0x3e94a031, 0xbcc90ab0, 0xbeac7cd4, 0xbf1d7fd1
.long 0x3e47c5c2, 0xbe164083, 0xbef15aea, 0xbf3daef9, 0x3dc8bd36, 0xbe888e93, 0xbf187fc0, 0xbf584853
.long 0x3f800000, 0x3f800000, 0x3f800000, 0x3f800000, 0x3f7b14be, 0x3f79c79d, 0x3f7853f8, 0x3f76ba07
.long 0x3f6c835e, 0x3f676bd8, 0x3f61c598, 0x3f5b941a, 0x3f54db31, 0x3f49d112, 0x3f3daef9, 0x3f3085bb
.long 0x3f3504f3, 0x3f226799, 0x3f0e39da, 0x3ef15aea, 0x3f0e39da, 0x3ee63375, 0x3eac7cd4, 0x3e605c13
.long 0x3ec3ef15, 0x3e78cfcc, 0x3dc8bd36, 0xbd48fb30, 0x3e47c5c2, 0x3cc90ab0, 0xbe164083, 0xbea09ae5
.long 0x0, 0xbe47c5c2, 0xbec3ef15, 0xbf0e39da, 0xbe47c5c2, 0xbecf7bca, 0xbf187fc0, 0xbf41d870
.long 0xbec3ef15, 0xbf187fc0, 0xbf45e403, 0xbf676bd8, 0xbf0e39da, 0xbf41d870, 0xbf676bd8, 0xbf7c3b28
.long 0xbf3504f3, 0xbf61c598, 0xbf7b14be, 0xbf7ec46d, 0xbf54db31, 0xbf76ba07, 0xbf7fb10f, 0xbf6ed89e
.long 0xbf6c835e, 0xbf7fb10f, 0xbf74fa0b, 0xbf4d9f02, 0xbf7b14be, 0xbf7c3b28, 0xbf5b941a, 0xbf1d7fd1
.long 0x3f800000, 0x3f800000, 0x3f800000, 0x3f800000, 0x3f74fa0b, 0x3f731447, 0x3f710908, 0x3f6ed89e
.long 0x3f54db31, 0x3f4d9f02, 0x3f45e403, 0x3f3daef9, 0x3f226799, 0x3f13682a, 0x3f039c3d, 0x3ee63375
.long 0x3ec3ef15, 0x3e94a031, 0x3e47c5c2, 0x3dc8bd36, 0x3dc8bd36, 0xbcc90ab0, 0xbe164083, 0xbe888e93
.long 0xbe47c5c2, 0xbeac7cd4, 0xbef15aea, 0xbf187fc0, 0xbef15aea, 0xbf1d7fd1, 0xbf3daef9, 0xbf584853
.long 0xbf3504f3, 0xbf54db31, 0xbf6c835e, 0xbf7b14be, 0xbf61c598, 0xbf76ba07, 0xbf7fb10f, 0xbf7c3b28
.long 0xbf7b14be, 0xbf7fb10f, 0xbf74fa0b, 0xbf5b941a, 0xbf7ec46d, 0xbf6ed89e, 0xbf4d9f02, 0xbf1d7fd1
.long 0xbf6c835e, 0xbf45e403, 0xbf0e39da, 0xbe94a031, 0xbf45e403, 0xbf08f59b, 0xbe78cfcc, 0x3d96a905
.long 0xbf0e39da, 0xbe78cfcc, 0x3dc8bd36, 0x3edae880, 0xbe94a031, 0x3d96a905, 0x3edae880, 0x3f396842
.long 0x0, 0x0, 0x0, 0x0, 0x0, 0x3cc90ab0, 0x3d48fb30, 0x3d96a905
.long 0x0, 0x3d48fb30, 0x3dc8bd36, 0x3e164083, 0x0, 0x3d96a905, 0x3e164083, 0x3e605c13
.long 0x0, 0x3dc8bd36, 0x3e47c5c2, 0x3e94a031, 0x0, 0x3dfab273, 0x3e78cfcc, 0x3eb8442a
.long 0x0, 0x3e164083, 0x3e94a031, 0x3edae880, 0x0, 0x3e2f10a2, 0x3eac7cd4, 0x3efc5d27
.long 0x0, 0x3e47c5c2, 0x3ec3ef15, 0x3f0e39da, 0x0, 0x3e605c13, 0x3edae880, 0x3f1d7fd1
.long 0x0, 0x3e78cfcc, 0x3ef15aea, 0x3f2beb4a, 0x0, 0x3e888e93, 0x3f039c3d, 0x3f396842
.long 0x0, 0x3e94a031, 0x3f0e39da, 0x3f45e403, 0x0, 0x3ea09ae5, 0x3f187fc0, 0x3f514d3d
.long 0x0, 0x3eac7cd4, 0x3f226799, 0x3f5b941a, 0x0, 0x3eb8442a, 0x3f2beb4a, 0x3f64aa59
.long 0x0, 0x0, 0x0, 0x0, 0x3dc8bd36, 0x3dfab273, 0x3e164083, 0x3e2f10a2
.long 0x3e47c5c2, 0x3e78cfcc, 0x3e94a031, 0x3eac7cd4, 0x3e94a031, 0x3eb8442a, 0x3edae880, 0x3efc5d27
.long 0x3ec3ef15, 0x3ef15aea, 0x3f0e39da, 0x3f226799, 0x3ef15aea, 0x3f13682a, 0x3f2beb4a, 0x3f41d870
.long 0x3f0e39da, 0x3f2beb4a, 0x3f45e403, 0x3f5b941a, 0x3f226799, 0x3f41d870, 0x3f5b941a, 0x3f6ed89e
.long 0x3f3504f3, 0x3f54db31, 0x3f6c835e, 0x3f7b14be, 0x3f45e403, 0x3f64aa59, 0x3f7853f8, 0x3f7fec43
.long 0x3f54db31, 0x3f710908, 0x3f7ec46d, 0x3f7d3aac, 0x3f61c598, 0x3f79c79d, 0x3f7fb10f, 0x3f731447
.long 0x3f6c835e, 0x3f7ec46d, 0x3f7b14be, 0x3f61c598, 0x3f74fa0b, 0x3f7fec43, 0x3f710908, 0x3f49d112
.long 0x3f7b14be, 0x3f7d3aac, 0x3f61c598, 0x3f2beb4a, 0x3f7ec46d, 0x3f76ba07, 0x3f4d9f02, 0x3f08f59b
.long 0x0, 0x0, 0x0, 0x0, 0x3e47c5c2, 0x3e605c13, 0x3e78cfcc, 0x3e888e93
.long 0x3ec3ef15, 0x3edae880, 0x3ef15aea, 0x3f039c3d, 0x3f0e39da, 0x3f1d7fd1, 0x3f2beb4a, 0x3f396842
.long 0x3f3504f3, 0x3f45e403, 0x3f54db31, 0x3f61c598, 0x3f54db31, 0x3f64aa59, 0x3f710908, 0x3f79c79d
.long 0x3f6c835e, 0x3f7853f8, 0x3f7ec46d, 0x3f7fb10f, 0x3f7b14be, 0x3f7fec43, 0x3f7d3aac, 0x3f731447
.long 0x3f800000, 0x3f7b14be, 0x3f6c835e, 0x3f54db31, 0x3f7b14be, 0x3f6a09a7, 0x3f4d9f02, 0x3f273656
.long 0x3f6c835e, 0x3f4d9f02, 0x3f226799, 0x3edae880, 0x3f54db31, 0x3f273656, 0x3edae880, 0x3e2f10a2
.long 0x3f3504f3, 0x3ef15aea, 0x3e47c5c2, 0xbdc8bd36, 0x3f0e39da, 0x3e888e93, 0xbd48fb30, 0xbeb8442a
.long 0x3ec3ef15, 0x3d48fb30, 0xbe94a031, 0xbf187fc0, 0x3e47c5c2, 0xbe2f10a2, 0xbf039c3d, 0xbf49d112
.long 0x0, 0x0, 0x0, 0x0, 0x3e94a031, 0x3ea09ae5, 0x3eac7cd4, 0x3eb8442a
.long 0x3f0e39da, 0x3f187fc0, 0x3f226799, 0x3f2beb4a, 0x3f45e403, 0x3f514d3d, 0x3f5b941a, 0x3f64aa59
.long 0x3f6c835e, 0x3f74fa0b, 0x3f7b14be, 0x3f7ec46d, 0x3f7ec46d, 0x3f7fec43, 0x3f7d3aac, 0x3f76ba07
.long 0x3f7b14be, 0x3f710908, 0x3f61c598, 0x3f4d9f02, 0x3f61c598, 0x3f49d112, 0x3f2beb4a, 0x3f08f59b
.long 0x3f3504f3, 0x3f0e39da, 0x3ec3ef15, 0x3e47c5c2, 0x3ef15aea, 0x3e888e93, 0x3d48fb30, 0xbe2f10a2
.long 0x3e47c5c2, 0xbd48fb30, 0xbe94a031, 0xbf039c3d, 0xbdc8bd36, 0xbeb8442a, 0xbf187fc0, 0xbf49d112
.long 0xbec3ef15, 0xbf226799, 0xbf54db31, 0xbf74fa0b, 0xbf226799, 0xbf584853, 0xbf7853f8, 0xbf7f4e6d
.long 0xbf54db31, 0xbf7853f8, 0xbf7ec46d, 0xbf676bd8, 0xbf74fa0b, 0xbf7f4e6d, 0xbf676bd8, 0xbf3085bb
.long 0x3f800000, 0x3f800000, 0x3f800000, 0x3f800000, 0x3f7ffb11, 0x3f7fd397, 0x3f7f84ab, 0x3f7f0e58
.long 0x3f7fec43, 0x3f7f4e6d, 0x3f7e1324, 0x3f7c3b28, 0x3f7fd397, 0x3f7e70b0, 0x3f7baccd, 0x3f778bc5
.long 0x3f7fb10f, 0x3f7d3aac, 0x3f7853f8, 0x3f710908, 0x3f7f84ab, 0x3f7baccd, 0x3f740bdd, 0x3f68bf3c
.long 0x3f7f4e6d, 0x3f79c79d, 0x3f6ed89e, 0x3f5ebe05, 0x3f7f0e58, 0x3f778bc5, 0x3f68bf3c, 0x3f531849
.long 0x3f7ec46d, 0x3f74fa0b, 0x3f61c598, 0x3f45e403, 0x3f7e70b0, 0x3f721352, 0x3f59f26a, 0x3f373a23
.long 0x3f7e1324, 0x3f6ed89e, 0x3f514d3d, 0x3f273656, 0x3f7dabcc, 0x3f6b4b0c, 0x3f47de65, 0x3f15f6d9
.long 0x3f7d3aac, 0x3f676bd8, 0x3f3daef9, 0x3f039c3d, 0x3f7cbfc9, 0x3f633c5a, 0x3f32c8c9, 0x3ee0924f
.long 0x3f7c3b28, 0x3f5ebe05, 0x3f273656, 0x3eb8442a, 0x3f7baccd, 0x3f59f26a, 0x3f1b02c6, 0x3e8e9a22
.long 0x3f800000, 0x3f800000, 0x3f800000, 0x3f800000, 0x3f7e70b0, 0x3f7dabcc, 0x3f7cbfc9, 0x3f7baccd
.long 0x3f79c79d, 0x3f76ba07, 0x3f731447, 0x3f6ed89e, 0x3f721352, 0x3f6b4b0c, 0x3f633c5a, 0x3f59f26a
.long 0x3f676bd8, 0x3f5b941a, 0x3f4d9f02, 0x3f3daef9, 0x3f59f26a, 0x3f47de65, 0x3f32c8c9, 0x3f1b02c6
.long 0x3f49d112, 0x3f3085bb, 0x3f13682a, 0x3ee63375, 0x3f373a23, 0x3f15f6d9, 0x3ee0924f, 0x3e8e9a22
.long 0x3f226799, 0x3ef15aea, 0x3e94a031, 0x3dc8bd36, 0x3f0b9a6b, 0x3eb263ef, 0x3e09cf86, 0xbdafb680
.long 0x3ee63375, 0x3e605c13, 0xbcc90ab0, 0xbe888e93, 0x3eb263ef, 0x3dafb680, 0xbe3b6ecf, 0xbee0924f
.long 0x3e78cfcc, 0xbd48fb30, 0xbeac7cd4, 0xbf187fc0, 0x3e09cf86, 0xbe3b6ecf, 0xbef6e0cb, 0xbf3b8f3b
.long 0x3cc90ab0, 0xbea09ae5, 0xbf1d7fd1, 0xbf584853, 0xbdafb680, 0xbee0924f, 0xbf3b8f3b, 0xbf6db293
.long 0x3f800000, 0x3f800000, 0x3f800000, 0x3f800000, 0x3f7a7302, 0x3f791298, 0x3f778bc5, 0x3f75dec6
.long 0x3f6a09a7, 0x3f64aa59, 0x3f5ebe05, 0x3f584853, 0x3f4f7a1f, 0x3f43e200, 0x3f373a23, 0x3f299415
.long 0x3f2beb4a, 0x3f187fc0, 0x3f039c3d, 0x3edae880, 0x3f00e7e4, 0x3ec9b953, 0x3e8e9a22, 0x3e22abb6
.long 0x3ea09ae5, 0x3e2f10a2, 0x3cc90ab0, 0xbdfab273, 0x3de1bc2e, 0xbd7b2b74, 0xbe6c9a7f, 0xbec9b953
.long 0xbdc8bd36, 0xbe94a031, 0xbef15aea, 0xbf226799, 0xbe9aa086, 0xbf00e7e4, 0xbf2e3bde, 0xbf531849
.long 0xbefc5d27, 0xbf3085bb, 0xbf584853, 0xbf731447, 0xbf299415, 0xbf5695e5, 0xbf740bdd, 0xbf7fd397
.long 0xbf4d9f02, 0xbf710908, 0xbf7fb10f, 0xbf7853f8, 0xbf68bf3c, 0xbf7e70b0, 0xbf7a7302, 0xbf5d2d53
.long 0xbf79c79d, 0xbf7e1324, 0xbf64aa59, 0xbf3085bb, 0xbf7ffb11, 0xbf6ff573, 0xbf3fc767, 0xbeebcbbb
.long 0x3f800000, 0x3f800000, 0x3f800000, 0x3f800000, 0x3f740bdd, 0x3f721352, 0x3f6ff573, 0x3f6db293
.long 0x3f514d3d, 0x3f49d112, 0x3f41d870, 0x3f396842, 0x3f1b02c6, 0x3f0b9a6b, 0x3ef6e0cb, 0x3ed53641
.long 0x3eac7cd4, 0x3e78cfcc, 0x3e164083, 0x3d48fb30, 0x3d16c32c, 0xbdafb680, 0xbe541501, 0xbea68f12
.long 0xbe888e93, 0xbecf7bca, 0xbf08f59b, 0xbf273656, 0xbf0b9a6b, 0xbf2e3bde, 0xbf4bbbf8, 0xbf633c5a
.long 0xbf45e403, 0xbf61c598, 0xbf74fa0b, 0xbf7ec46d, 0xbf6db293, 0xbf7cbfc9, 0xbf7f84ab, 0xbf75dec6
.long 0xbf7f4e6d, 0xbf7c3b28, 0xbf6a09a7, 0xbf49d112, 0xbf791298, 0xbf604621, 0xbf373a23, 0xbf00e7e4
.long 0xbf5b941a, 0xbf2beb4a, 0xbedae880, 0xbe164083, 0xbf299415, 0xbec9b953, 0xbdafb680, 0x3e6c9a7f
.long 0xbecf7bca, 0xbd96a905, 0x3e888e93, 0x3f13682a, 0xbde1bc2e, 0x3e827dc0, 0x3f15f6d9, 0x3f5695e5
.long 0x0, 0x0, 0x0, 0x0, 0x3c490e90, 0x3d16c32c, 0x3d7b2b74, 0x3dafb680
.long 0x3cc90ab0, 0x3d96a905, 0x3dfab273, 0x3e2f10a2, 0x3d16c32c, 0x3de1bc2e, 0x3e3b6ecf, 0x3e827dc0
.long 0x3d48fb30, 0x3e164083, 0x3e78cfcc, 0x3eac7cd4, 0x3d7b2b74, 0x3e3b6ecf, 0x3e9aa086, 0x3ed53641
.long 0x3d96a905, 0x3e605c13, 0x3eb8442a, 0x3efc5d27, 0x3dafb680, 0x3e827dc0, 0x3ed53641, 0x3f10d3cd
.long 0x3dc8bd36, 0x3e94a031, 0x3ef15aea, 0x3f226799, 0x3de1bc2e, 0x3ea68f12, 0x3f064b82, 0x3f32c8c9
.long 0x3dfab273, 0x3eb8442a, 0x3f13682a, 0x3f41d870, 0x3e09cf86, 0x3ec9b953, 0x3f1ff6cb, 0x3f4f7a1f
.long 0x3e164083, 0x3edae880, 0x3f2beb4a, 0x3f5b941a, 0x3e22abb6, 0x3eebcbbb, 0x3f373a23, 0x3f660f88
.long 0x3e2f10a2, 0x3efc5d27, 0x3f41d870, 0x3f6ed89e, 0x3e3b6ecf, 0x3f064b82, 0x3f4bbbf8, 0x3f75dec6
.long 0x0, 0x0, 0x0, 0x0, 0x3de1bc2e, 0x3e09cf86, 0x3e22abb6, 0x3e3b6ecf
.long 0x3e605c13, 0x3e888e93, 0x3ea09ae5, 0x3eb8442a, 0x3ea68f12, 0x3ec9b953, 0x3eebcbbb, 0x3f064b82
.long 0x3edae880, 0x3f039c3d, 0x3f187fc0, 0x3f2beb4a, 0x3f064b82, 0x3f1ff6cb, 0x3f373a23, 0x3f4bbbf8
.long 0x3f1d7fd1, 0x3f396842, 0x3f514d3d, 0x3f64aa59, 0x3f32c8c9, 0x3f4f7a1f, 0x3f660f88, 0x3f75dec6
.long 0x3f45e403, 0x3f61c598, 0x3f74fa0b, 0x3f7ec46d, 0x3f5695e5, 0x3f6ff573, 0x3f7dabcc, 0x3f7f0e58
.long 0x3f64aa59, 0x3f79c79d, 0x3f7fec43, 0x3f76ba07, 0x3f6ff573, 0x3f7f0e58, 0x3f7baccd, 0x3f660f88
.long 0x3f7853f8, 0x3f7fb10f, 0x3f710908, 0x3f4d9f02, 0x3f7dabcc, 0x3f7baccd, 0x3f604621, 0x3f2e3bde
.long 0x3f7fec43, 0x3f731447, 0x3f49d112, 0x3f08f59b, 0x3f7f0e58, 0x3f660f88, 0x3f2e3bde, 0x3ebe1d4a
.long 0x0, 0x0, 0x0, 0x0, 0x3e541501, 0x3e6c9a7f, 0x3e827dc0, 0x3e8e9a22
.long 0x3ecf7bca, 0x3ee63375, 0x3efc5d27, 0x3f08f59b, 0x3f15f6d9, 0x3f24d225, 0x3f32c8c9, 0x3f3fc767
.long 0x3f3daef9, 0x3f4d9f02, 0x3f5b941a, 0x3f676bd8, 0x3f5d2d53, 0x3f6b4b0c, 0x3f75dec6, 0x3f7cbfc9
.long 0x3f731447, 0x3f7c3b28, 0x3f7fec43, 0x3f7e1324, 0x3f7e70b0, 0x3f7f84ab, 0x3f791298, 0x3f6b4b0c
.long 0x3f7ec46d, 0x3f74fa0b, 0x3f61c598, 0x3f45e403, 0x3f740bdd, 0x3f5d2d53, 0x3f3b8f3b, 0x3f10d3cd
.long 0x3f5ebe05, 0x3f396842, 0x3f08f59b, 0x3ea09ae5, 0x3f3fc767, 0x3f0b9a6b, 0x3e9aa086, 0x3d16c32c
.long 0x3f187fc0, 0x3eac7cd4, 0x3d48fb30, 0xbe78cfcc, 0x3ed53641, 0x3de1bc2e, 0xbe541501, 0xbf00e7e4
.long 0x3e605c13, 0xbdfab273, 0xbee63375, 0xbf396842, 0x3c490e90, 0xbeb263ef, 0xbf299415, 0xbf633c5a
.long 0x0, 0x0, 0x0, 0x0, 0x3e9aa086, 0x3ea68f12, 0x3eb263ef, 0x3ebe1d4a
.long 0x3f13682a, 0x3f1d7fd1, 0x3f273656, 0x3f3085bb, 0x3f4bbbf8, 0x3f5695e5, 0x3f604621, 0x3f68bf3c
.long 0x3f710908, 0x3f7853f8, 0x3f7d3aac, 0x3f7fb10f, 0x3f7fd397, 0x3f7f0e58, 0x3f7a7302, 0x3f721352
.long 0x3f76ba07, 0x3f6a09a7, 0x3f584853, 0x3f41d870, 0x3f5695e5, 0x3f3b8f3b, 0x3f1b02c6, 0x3eebcbbb
.long 0x3f226799, 0x3ef15aea, 0x3e94a031, 0x3dc8bd36, 0x3ebe1d4a, 0x3e22abb6, 0xbd7b2b74, 0xbe8e9a22
.long 0x3d96a905, 0xbe2f10a2, 0xbecf7bca, 0xbf1d7fd1, 0xbe6c9a7f, 0xbef6e0cb, 0xbf32c8c9, 0xbf5d2d53
.long 0xbf039c3d, 0xbf3daef9, 0xbf676bd8, 0xbf7d3aac, 0xbf3fc767, 0xbf6b4b0c, 0xbf7f0e58, 0xbf791298
.long 0xbf6a09a7, 0xbf7f4e6d, 0xbf76ba07, 0xbf514d3d, 0xbf7e70b0, 0xbf778bc5, 0xbf4f7a1f, 0xbf0b9a6b
.long 0x3f80, 0x3f80, 0x3f80, 0x3f80, 0x3f80, 0x3ec43f6d, 0x3f353f35, 0x3f6d3ec4
.long 0x3f80, 0x3f353f35, 0x3f800000, 0x3f35bf35, 0x3f80, 0x3f6d3ec4, 0x3f35bf35, 0xbec4bf6d
.long 0x3f80, 0x3f800000, 0xbf80, 0xbf800000, 0x3f80, 0x3f6dbec4, 0xbf35bf35, 0xbec43f6d
.long 0x3f80, 0x3f35bf35, 0xbf800000, 0x3f353f35, 0x3f80, 0x3ec4bf6d, 0xbf353f35, 0x3f6dbec4
.long 0x3f80, 0xbf80, 0x3f80, 0xbf80, 0x3f80, 0xbec4bf6d, 0x3f353f35, 0xbf6dbec4
.long 0x3f80, 0xbf35bf35, 0x3f800000, 0xbf353f35, 0x3f80, 0xbf6dbec4, 0x3f35bf35, 0x3ec43f6d
.long 0x3f80, 0xbf800000, 0xbf80, 0x3f800000, 0x3f80, 0xbf6d3ec4, 0xbf35bf35, 0x3ec4bf6d
.long 0x3f80, 0xbf353f35, 0xbf800000, 0xbf35bf35, 0x3f80, 0xbec43f6d, 0xbf353f35, 0xbf6d3ec4
.long 0x3f80, 0x3f80, 0x3f80, 0x3f80, 0x3f800000, 0x3f6dbec4, 0x3f35bf35, 0x3ec4bf6d
.long 0xbf80, 0xbf35bf35, 0xbf800000, 0xbf353f35, 0xbf800000, 0xbec43f6d, 0x3f353f35, 0x3f6dbec4
.long 0x3f80, 0x3f800000, 0xbf80, 0xbf800000, 0x3f800000, 0xbec4bf6d, 0xbf353f35, 0x3f6d3ec4
.long 0xbf80, 0xbf353f35, 0x3f800000, 0xbf35bf35, 0xbf800000, 0x3f6d3ec4, 0xbf35bf35, 0x3ec43f6d
.long 0x3f80, 0xbf80, 0x3f80, 0xbf80, 0x3f800000, 0xbf6d3ec4, 0x3f35bf35, 0xbec43f6d
.long 0xbf80, 0x3f353f35, 0xbf800000, 0x3f35bf35, 0xbf800000, 0x3ec4bf6d, 0x3f353f35, 0xbf6d3ec4
.long 0x3f80, 0xbf800000, 0xbf80, 0x3f800000, 0x3f800000, 0x3ec43f6d, 0xbf353f35, 0xbf6dbec4
.long 0xbf80, 0x3f35bf35, 0x3f800000, 0x3f353f35, 0xbf800000, 0xbf6dbec4, 0xbf35bf35, 0xbec4bf6d
.long 0x3f80, 0x3f80, 0x3f80, 0x3f80, 0xbf80, 0xbec4bf6d, 0xbf35bf35, 0xbf6dbec4
.long 0x3f80, 0x3f353f35, 0x3f800000, 0x3f35bf35, 0xbf80, 0xbf6dbec4, 0xbf353f35, 0x3ec43f6d
.long 0x3f80, 0x3f800000, 0xbf80, 0xbf800000, 0xbf80, 0xbf6d3ec4, 0x3f353f35, 0x3ec4bf6d
.long 0x3f80, 0x3f35bf35, 0xbf800000, 0x3f353f35, 0xbf80, 0xbec43f6d, 0x3f35bf35, 0xbf6d3ec4
.long 0x3f80, 0xbf80, 0x3f80, 0xbf80, 0xbf80, 0x3ec43f6d, 0xbf35bf35, 0x3f6d3ec4
.long 0x3f80, 0xbf35bf35, 0x3f800000, 0xbf353f35, 0xbf80, 0x3f6d3ec4, 0xbf353f35, 0xbec4bf6d
.long 0x3f80, 0xbf800000, 0xbf80, 0x3f800000, 0xbf80, 0x3f6dbec4, 0x3f353f35, 0xbec43f6d
.long 0x3f80, 0xbf353f35, 0xbf800000, 0xbf35bf35, 0xbf80, 0x3ec4bf6d, 0x3f35bf35, 0x3f6dbec4
.long 0x3f80, 0x3f80, 0x3f80, 0x3f80, 0xbf800000, 0xbf6d3ec4, 0xbf353f35, 0xbec43f6d
.long 0xbf80, 0xbf35bf35, 0xbf800000, 0xbf353f35, 0x3f800000, 0x3ec4bf6d, 0xbf35bf35, 0xbf6d3ec4
.long 0x3f80, 0x3f800000, 0xbf80, 0xbf800000, 0xbf800000, 0x3ec43f6d, 0x3f35bf35, 0xbf6dbec4
.long 0xbf80, 0xbf353f35, 0x3f800000, 0xbf35bf35, 0x3f800000, 0xbf6dbec4, 0x3f353f35, 0xbec4bf6d
.long 0x3f80, 0xbf80, 0x3f80, 0xbf80, 0xbf800000, 0x3f6dbec4, 0xbf353f35, 0x3ec4bf6d
.long 0xbf80, 0x3f353f35, 0xbf800000, 0x3f35bf35, 0x3f800000, 0xbec43f6d, 0xbf35bf35, 0x3f6dbec4
.long 0x3f80, 0xbf800000, 0xbf80, 0x3f800000, 0xbf800000, 0xbec4bf6d, 0x3f35bf35, 0x3f6d3ec4
.long 0xbf80, 0x3f35bf35, 0x3f800000, 0x3f353f35, 0x3f800000, 0x3f6d3ec4, 0x3f353f35, 0x3ec43f6d
.long 0x3f80, 0x3f80, 0x3f80, 0x3f80, 0x3f80, 0x3ec43f6d, 0x3f353f35, 0x3f6d3ec4
.long 0x3f80, 0x3f353f35, 0x3f800000, 0x3f35bf35, 0x3f80, 0x3f6d3ec4, 0x3f35bf35, 0xbec4bf6d
.long 0x3f80, 0x3f800000, 0xbf80, 0xbf800000, 0x3f80, 0x3f6dbec4, 0xbf35bf35, 0xbec43f6d
.long 0x3f80, 0x3f35bf35, 0xbf800000, 0x3f353f35, 0x3f80, 0x3ec4bf6d, 0xbf353f35, 0x3f6dbec4
.long 0x3f80, 0xbf80, 0x3f80, 0xbf80, 0x3f80, 0xbec4bf6d, 0x3f353f35, 0xbf6dbec4
.long 0x3f80, 0xbf35bf35, 0x3f800000, 0xbf353f35, 0x3f80, 0xbf6dbec4, 0x3f35bf35, 0x3ec43f6d
.long 0x3f80, 0xbf800000, 0xbf80, 0x3f800000, 0x3f80, 0xbf6d3ec4, 0xbf35bf35, 0x3ec4bf6d
.long 0x3f80, 0xbf353f35, 0xbf800000, 0xbf35bf35, 0x3f80, 0xbec43f6d, 0xbf353f35, 0xbf6d3ec4
.long 0x3f80, 0x3f80, 0x3f80, 0x3f80, 0x3f800000, 0x3f6dbec4, 0x3f35bf35, 0x3ec4bf6d
.long 0xbf80, 0xbf35bf35, 0xbf800000, 0xbf353f35, 0xbf800000, 0xbec43f6d, 0x3f353f35, 0x3f6dbec4
.long 0x3f80, 0x3f800000, 0xbf80, 0xbf800000, 0x3f800000, 0xbec4bf6d, 0xbf353f35, 0x3f6d3ec4
.long 0xbf80, 0xbf353f35, 0x3f800000, 0xbf35bf35, 0xbf800000, 0x3f6d3ec4, 0xbf35bf35, 0x3ec43f6d
.long 0x3f80, 0xbf80, 0x3f80, 0xbf80, 0x3f800000, 0xbf6d3ec4, 0x3f35bf35, 0xbec43f6d
.long 0xbf80, 0x3f353f35, 0xbf800000, 0x3f35bf35, 0xbf800000, 0x3ec4bf6d, 0x3f353f35, 0xbf6d3ec4
.long 0x3f80, 0xbf800000, 0xbf80, 0x3f800000, 0x3f800000, 0x3ec43f6d, 0xbf353f35, 0xbf6dbec4
.long 0xbf80, 0x3f35bf35, 0x3f800000, 0x3f353f35, 0xbf800000, 0xbf6dbec4, 0xbf35bf35, 0xbec4bf6d
.long 0x3f80, 0x3f80, 0x3f80, 0x3f80, 0xbf80, 0xbec4bf6d, 0xbf35bf35, 0xbf6dbec4
.long 0x3f80, 0x3f353f35, 0x3f800000, 0x3f35bf35, 0xbf80, 0xbf6dbec4, 0xbf353f35, 0x3ec43f6d
.long 0x3f80, 0x3f800000, 0xbf80, 0xbf800000, 0xbf80, 0xbf6d3ec4, 0x3f353f35, 0x3ec4bf6d
.long 0x3f80, 0x3f35bf35, 0xbf800000, 0x3f353f35, 0xbf80, 0xbec43f6d, 0x3f35bf35, 0xbf6d3ec4
.long 0x3f80, 0xbf80, 0x3f80, 0xbf80, 0xbf80, 0x3ec43f6d, 0xbf35bf35, 0x3f6d3ec4
.long 0x3f80, 0xbf35bf35, 0x3f800000, 0xbf353f35, 0xbf80, 0x3f6d3ec4, 0xbf353f35, 0xbec4bf6d
.long 0x3f80, 0xbf800000, 0xbf80, 0x3f800000, 0xbf80, 0x3f6dbec4, 0x3f353f35, 0xbec43f6d
.long 0x3f80, 0xbf353f35, 0xbf800000, 0xbf35bf35, 0xbf80, 0x3ec4bf6d, 0x3f35bf35, 0x3f6dbec4
.long 0x3f80, 0x3f80, 0x3f80, 0x3f80, 0xbf800000, 0xbf6d3ec4, 0xbf353f35, 0xbec43f6d
.long 0xbf80, 0xbf35bf35, 0xbf800000, 0xbf353f35, 0x3f800000, 0x3ec4bf6d, 0xbf35bf35, 0xbf6d3ec4
.long 0x3f80, 0x3f800000, 0xbf80, 0xbf800000, 0xbf800000, 0x3ec43f6d, 0x3f35bf35, 0xbf6dbec4
.long 0xbf80, 0xbf353f35, 0x3f800000, 0xbf35bf35, 0x3f800000, 0xbf6dbec4, 0x3f353f35, 0xbec4bf6d
.long 0x3f80, 0xbf80, 0x3f80, 0xbf80, 0xbf800000, 0x3f6dbec4, 0xbf353f35, 0x3ec4bf6d
.long 0xbf80, 0x3f353f35, 0xbf800000, 0x3f35bf35, 0x3f800000, 0xbec43f6d, 0xbf35bf35, 0x3f6dbec4
.long 0x3f80, 0xbf800000, 0xbf80, 0x3f800000, 0xbf800000, 0xbec4bf6d, 0x3f35bf35, 0x3f6d3ec4
.long 0xbf80, 0x3f35bf35, 0x3f800000, 0x3f353f35, 0x3f800000, 0x3f6d3ec4, 0x3f353f35, 0x3ec43f6d
.long 0x3f80, 0x3f80, 0x3f80, 0x3f80, 0x3e483f7b, 0x3f0e3f55, 0x3f553f0e, 0x3f7b3e48
.long 0x3ec43f6d, 0x3f6d3ec4, 0x3f6dbec4, 0x3ec4bf6d, 0x3f0e3f55, 0x3f7bbe48, 0x3e48bf7b, 0xbf55bf0e
.long 0x3f353f35, 0x3f35bf35, 0xbf35bf35, 0xbf353f35, 0x3f553f0e, 0x3e48bf7b, 0xbf7b3e48, 0x3f0e3f55
.long 0x3f6d3ec4, 0xbec4bf6d, 0xbec43f6d, 0x3f6dbec4, 0x3f7b3e48, 0xbf55bf0e, 0x3f0e3f55, 0xbe48bf7b
.long 0x3f800000, 0xbf800000, 0x3f800000, 0xbf800000, 0x3f7bbe48, 0xbf553f0e, 0x3f0ebf55, 0xbe483f7b
.long 0x3f6dbec4, 0xbec43f6d, 0xbec4bf6d, 0x3f6d3ec4, 0x3f55bf0e, 0x3e483f7b, 0xbf7bbe48, 0x3f0ebf55
.long 0x3f35bf35, 0x3f353f35, 0xbf353f35, 0xbf35bf35, 0x3f0ebf55, 0x3f7b3e48, 0x3e483f7b, 0xbf553f0e
.long 0x3ec4bf6d, 0x3f6dbec4, 0x3f6d3ec4, 0x3ec43f6d, 0x3e48bf7b, 0x3f0ebf55, 0x3f55bf0e, 0x3f7bbe48
.long 0x3f80, 0x3f80, 0x3f80, 0x3f80, 0x3f7bbe48, 0x3f55bf0e, 0x3f0ebf55, 0x3e48bf7b
.long 0xbec4bf6d, 0xbf6dbec4, 0xbf6d3ec4, 0xbec43f6d, 0xbf553f0e, 0x3e483f7b, 0x3f7b3e48, 0x3f0ebf55
.long 0x3f353f35, 0x3f35bf35, 0xbf35bf35, 0xbf353f35, 0x3f0ebf55, 0xbf7bbe48, 0x3e483f7b, 0x3f55bf0e
.long 0xbf6dbec4, 0x3ec43f6d, 0x3ec4bf6d, 0xbf6d3ec4, 0xbe483f7b, 0x3f0ebf55, 0xbf553f0e, 0x3f7bbe48
.long 0x3f800000, 0xbf800000, 0x3f800000, 0xbf800000, 0xbe48bf7b, 0x3f0e3f55, 0xbf55bf0e, 0x3f7b3e48
.long 0xbf6d3ec4, 0x3ec4bf6d, 0x3ec43f6d, 0xbf6dbec4, 0x3f0e3f55, 0xbf7b3e48, 0x3e48bf7b, 0x3f553f0e
.long 0x3f35bf35, 0x3f353f35, 0xbf353f35, 0xbf35bf35, 0xbf55bf0e, 0x3e48bf7b, 0x3f7bbe48, 0x3f0e3f55
.long 0xbec43f6d, 0xbf6d3ec4, 0xbf6dbec4, 0xbec4bf6d, 0x3f7b3e48, 0x3f553f0e, 0x3f0e3f55, 0x3e483f7b
.long 0x3f80, 0x3f80, 0x3f80, 0x3f80, 0xbe48bf7b, 0xbf0ebf55, 0xbf55bf0e, 0xbf7bbe48
.long 0x3ec43f6d, 0x3f6d3ec4, 0x3f6dbec4, 0x3ec4bf6d, 0xbf0ebf55, 0xbf7b3e48, 0xbe483f7b, 0x3f553f0e
.long 0x3f353f35, 0x3f35bf35, 0xbf35bf35, 0xbf353f35, 0xbf55bf0e, 0xbe483f7b, 0x3f7bbe48, 0xbf0ebf55
.long 0x3f6d3ec4, 0xbec4bf6d, 0xbec43f6d, 0x3f6dbec4, 0xbf7bbe48, 0x3f553f0e, 0xbf0ebf55, 0x3e483f7b
.long 0x3f800000, 0xbf800000, 0x3f800000, 0xbf800000, 0xbf7b3e48, 0x3f55bf0e, 0xbf0e3f55, 0x3e48bf7b
.long 0x3f6dbec4, 0xbec43f6d, 0xbec4bf6d, 0x3f6d3ec4, 0xbf553f0e, 0xbe48bf7b, 0x3f7b3e48, 0xbf0e3f55
.long 0x3f35bf35, 0x3f353f35, 0xbf353f35, 0xbf35bf35, 0xbf0e3f55, 0xbf7bbe48, 0xbe48bf7b, 0x3f55bf0e
.long 0x3ec4bf6d, 0x3f6dbec4, 0x3f6d3ec4, 0x3ec43f6d, 0xbe483f7b, 0xbf0e3f55, 0xbf553f0e, 0xbf7b3e48
.long 0x3f80, 0x3f80, 0x3f80, 0x3f80, 0xbf7b3e48, 0xbf553f0e, 0xbf0e3f55, 0xbe483f7b
.long 0xbec4bf6d, 0xbf6dbec4, 0xbf6d3ec4, 0xbec43f6d, 0x3f55bf0e, 0xbe48bf7b, 0xbf7bbe48, 0xbf0e3f55
.long 0x3f353f35, 0x3f35bf35, 0xbf35bf35, 0xbf353f35, 0xbf0e3f55, 0x3f7b3e48, 0xbe48bf7b, 0xbf553f0e
.long 0xbf6dbec4, 0x3ec43f6d, 0x3ec4bf6d, 0xbf6d3ec4, 0x3e48bf7b, 0xbf0e3f55, 0x3f55bf0e, 0xbf7b3e48
.long 0x3f800000, 0xbf800000, 0x3f800000, 0xbf800000, 0x3e483f7b, 0xbf0ebf55, 0x3f553f0e, 0xbf7bbe48
.long 0xbf6d3ec4, 0x3ec4bf6d, 0x3ec43f6d, 0xbf6dbec4, 0xbf0ebf55, 0x3f7bbe48, 0xbe483f7b, 0xbf55bf0e
.long 0x3f35bf35, 0x3f353f35, 0xbf353f35, 0xbf35bf35, 0x3f553f0e, 0xbe483f7b, 0xbf7b3e48, 0xbf0ebf55
.long 0xbec43f6d, 0xbf6d3ec4, 0xbf6dbec4, 0xbec4bf6d, 0xbf7bbe48, 0xbf55bf0e, 0xbf0ebf55, 0xbe48bf7b
.long 0xbf80, 0xbf80, 0xbf80, 0xbf80, 0xbe48bf7b, 0xbf0ebf55, 0xbf55bf0e, 0xbf7bbe48
.long 0xbec4bf6d, 0xbf6dbec4, 0xbf6d3ec4, 0xbec43f6d, 0xbf0ebf55, 0xbf7b3e48, 0xbe483f7b, 0x3f553f0e
.long 0xbf35bf35, 0xbf353f35, 0x3f353f35, 0x3f35bf35, 0xbf55bf0e, 0xbe483f7b, 0x3f7bbe48, 0xbf0ebf55
.long 0xbf6dbec4, 0x3ec43f6d, 0x3ec4bf6d, 0xbf6d3ec4, 0xbf7bbe48, 0x3f553f0e, 0xbf0ebf55, 0x3e483f7b
.long 0xbf800000, 0x3f800000, 0xbf800000, 0x3f800000, 0xbf7b3e48, 0x3f55bf0e, 0xbf0e3f55, 0x3e48bf7b
.long 0xbf6d3ec4, 0x3ec4bf6d, 0x3ec43f6d, 0xbf6dbec4, 0xbf553f0e, 0xbe48bf7b, 0x3f7b3e48, 0xbf0e3f55
.long 0xbf353f35, 0xbf35bf35, 0x3f35bf35, 0x3f353f35, 0xbf0e3f55, 0xbf7bbe48, 0xbe48bf7b, 0x3f55bf0e
.long 0xbec43f6d, 0xbf6d3ec4, 0xbf6dbec4, 0xbec4bf6d, 0xbe483f7b, 0xbf0e3f55, 0xbf553f0e, 0xbf7b3e48
.long 0xbf80, 0xbf80, 0xbf80, 0xbf80, 0xbf7b3e48, 0xbf553f0e, 0xbf0e3f55, 0xbe483f7b
.long 0x3ec43f6d, 0x3f6d3ec4, 0x3f6dbec4, 0x3ec4bf6d, 0x3f55bf0e, 0xbe48bf7b, 0xbf7bbe48, 0xbf0e3f55
.long 0xbf35bf35, 0xbf353f35, 0x3f353f35, 0x3f35bf35, 0xbf0e3f55, 0x3f7b3e48, 0xbe48bf7b, 0xbf553f0e
.long 0x3f6d3ec4, 0xbec4bf6d, 0xbec43f6d, 0x3f6dbec4, 0x3e48bf7b, 0xbf0e3f55, 0x3f55bf0e, 0xbf7b3e48
.long 0xbf800000, 0x3f800000, 0xbf800000, 0x3f800000, 0x3e483f7b, 0xbf0ebf55, 0x3f553f0e, 0xbf7bbe48
.long 0x3f6dbec4, 0xbec43f6d, 0xbec4bf6d, 0x3f6d3ec4, 0xbf0ebf55, 0x3f7bbe48, 0xbe483f7b, 0xbf55bf0e
.long 0xbf353f35, 0xbf35bf35, 0x3f35bf35, 0x3f353f35, 0x3f553f0e, 0xbe483f7b, 0xbf7b3e48, 0xbf0ebf55
.long 0x3ec4bf6d, 0x3f6dbec4, 0x3f6d3ec4, 0x3ec43f6d, 0xbf7bbe48, 0xbf55bf0e, 0xbf0ebf55, 0xbe48bf7b
.long 0xbf80, 0xbf80, 0xbf80, 0xbf80, 0x3e483f7b, 0x3f0e3f55, 0x3f553f0e, 0x3f7b3e48
.long 0xbec4bf6d, 0xbf6dbec4, 0xbf6d3ec4, 0xbec43f6d, 0x3f0e3f55, 0x3f7bbe48, 0x3e48bf7b, 0xbf55bf0e
.long 0xbf35bf35, 0xbf353f35, 0x3f353f35, 0x3f35bf35, 0x3f553f0e, 0x3e48bf7b, 0xbf7b3e48, 0x3f0e3f55
.long 0xbf6dbec4, 0x3ec43f6d, 0x3ec4bf6d, 0xbf6d3ec4, 0x3f7b3e48, 0xbf55bf0e, 0x3f0e3f55, 0xbe48bf7b
.long 0xbf800000, 0x3f800000, 0xbf800000, 0x3f800000, 0x3f7bbe48, 0xbf553f0e, 0x3f0ebf55, 0xbe483f7b
.long 0xbf6d3ec4, 0x3ec4bf6d, 0x3ec43f6d, 0xbf6dbec4, 0x3f55bf0e, 0x3e483f7b, 0xbf7bbe48, 0x3f0ebf55
.long 0xbf353f35, 0xbf35bf35, 0x3f35bf35, 0x3f353f35, 0x3f0ebf55, 0x3f7b3e48, 0x3e483f7b, 0xbf553f0e
.long 0xbec43f6d, 0xbf6d3ec4, 0xbf6dbec4, 0xbec4bf6d, 0x3e48bf7b, 0x3f0ebf55, 0x3f55bf0e, 0x3f7bbe48
.long 0xbf80, 0xbf80, 0xbf80, 0xbf80, 0x3f7bbe48, 0x3f55bf0e, 0x3f0ebf55, 0x3e48bf7b
.long 0x3ec43f6d, 0x3f6d3ec4, 0x3f6dbec4, 0x3ec4bf6d, 0xbf553f0e, 0x3e483f7b, 0x3f7b3e48, 0x3f0ebf55
.long 0xbf35bf35, 0xbf353f35, 0x3f353f35, 0x3f35bf35, 0x3f0ebf55, 0xbf7bbe48, 0x3e483f7b, 0x3f55bf0e
.long 0x3f6d3ec4, 0xbec4bf6d, 0xbec43f6d, 0x3f6dbec4, 0xbe483f7b, 0x3f0ebf55, 0xbf553f0e, 0x3f7bbe48
.long 0xbf800000, 0x3f800000, 0xbf800000, 0x3f800000, 0xbe48bf7b, 0x3f0e3f55, 0xbf55bf0e, 0x3f7b3e48
.long 0x3f6dbec4, 0xbec43f6d, 0xbec4bf6d, 0x3f6d3ec4, 0x3f0e3f55, 0xbf7b3e48, 0x3e48bf7b, 0x3f553f0e
.long 0xbf353f35, 0xbf35bf35, 0x3f35bf35, 0x3f353f35, 0xbf55bf0e, 0x3e48bf7b, 0x3f7bbe48, 0x3f0e3f55
.long 0x3ec4bf6d, 0x3f6dbec4, 0x3f6d3ec4, 0x3ec43f6d, 0x3f7b3e48, 0x3f553f0e, 0x3f0e3f55, 0x3e483f7b
L_tabend:
.size L_tab, L_tabend - L_tab
.section .rodata,"a"
.p2align 6
.amdhsa_kernel gated_mix__spectral_fnet__moe_arch_mod__prompt_kernel
  .amdhsa_next_free_vgpr 256
  .amdhsa_next_free_sgpr 102
  .amdhsa_accum_offset 256
  .amdhsa_group_segment_fixed_size 0
  .amdhsa_kernarg_size 112
  .amdhsa_user_sgpr_count 2
  .amdhsa_user_sgpr_kernarg_segment_ptr 1
  .amdhsa_system_sgpr_workgroup_id_x 1
.end_amdhsa_kernel
```

```asm
; @launch grid=(256,1,1) block=(512,1,1) lds=100352
.amdgcn_target "amdgcn-amd-amdhsa--gfx950"
.text
.globl gated_mix__spectral_fnet__moe_arch_mod__prompt_kernel
.p2align 8
.type gated_mix__spectral_fnet__moe_arch_mod__prompt_kernel,@function
gated_mix__spectral_fnet__moe_arch_mod__prompt_kernel:
    s_cmp_ge_u32 s2, 256
    s_cbranch_scc1 L_end
    s_load_dwordx2 s[4:5], s[0:1], 0
    s_load_dwordx16 s[16:31], s[0:1], 48
    s_getpc_b64 s[10:11]
L_pc:
    v_lshrrev_b32 v1, 6, v0
    s_lshr_b32 s57, s2, 3
    v_lshl_add_u32 v4, v0, 5, s57
    v_lshlrev_b32 v4, 7, v4
    v_cmp_gt_u32 vcc, L_tabend - L_pc, v4
    s_nop 0
    s_and_saveexec_b64 s[12:13], vcc
    s_cbranch_execz L_nocpf
    global_load_dword v249, v4, s[10:11]
L_nocpf:
    s_mov_b64 exec, s[12:13]
    v_and_b32 v0, 63, v0
    v_readfirstlane_b32 s3, v1
    v_and_b32 v2, 15, v0
    v_lshrrev_b32 v3, 4, v0
    v_lshlrev_b32 v247, 4, v0
    v_lshlrev_b32 v246, 3, v0
    s_add_u32 s10, s10, L_tab - L_pc
    s_addc_u32 s11, s11, 0
    s_and_b32 s56, s2, 7
    s_mov_b32 s90, 400000
    s_cmp_lt_u32 s57, 16
    s_cbranch_scc1 L_low
    s_sub_u32 s57, s57, 16
    s_lshl4_add_u32 s9, s56, s57
    s_lshl4_add_u32 s58, s57, s56
    s_sub_u32 s62, s58, 120
    s_cmp_lt_u32 s9, 8
    s_cselect_b32 s62, s58, s62
    s_cmp_lt_u32 s9, 16
    s_cselect_b32 s58, s62, s58
L_a:
    s_cmp_ge_u32 s3, 4
    s_cbranch_scc1 L_p1w
    s_lshl2_add_u32 s60, s57, s3
    s_lshl_b32 s60, s60, 5
    s_add_u32 s60, s60, s56
    s_lshl_b32 s12, s60, 10
    s_cmp_eq_u32 s58, 128
    s_cselect_b32 s12, 0x40000000, s12
    s_add_u32 s13, s12, 8192
    s_add_u32 s14, s12, 16384
    s_add_u32 s15, s12, 24576
    s_waitcnt lgkmcnt(0)
    s_load_dword s59, s[30:31], 0
    s_mov_b32 s32, s4
    s_mov_b32 s33, s5
    s_mov_b32 s34, 0x200000
    s_mov_b32 s35, 0x20000
    s_mov_b32 s36, s30
    s_mov_b32 s37, s31
    s_mov_b32 s38, 0x400000
    s_mov_b32 s39, 0x20000
    buffer_load_dwordx4 v[8:11], v247, s[32:35], s12 offen
    buffer_load_dwordx4 v[12:15], v247, s[32:35], s13 offen
    buffer_load_dwordx4 v[16:19], v247, s[32:35], s14 offen
    buffer_load_dwordx4 v[20:23], v247, s[32:35], s15 offen
    s_mov_b32 s44, s16
    s_mov_b32 s45, s17
    s_mov_b32 s46, 0x400
    s_mov_b32 s47, 0x20000
    buffer_load_dwordx4 v[24:27], v247, s[44:47], 0 offen
    v_and_b32 v36, 1, v3
    v_lshrrev_b32 v108, 1, v3
    v_lshl_add_u32 v36, v36, 1, v108
    v_lshl_add_u32 v36, v36, 3, s60
    v_mov_b32 v108, 43008
    v_mov_b32 v109, 1
    s_mov_b32 s8, 0xfffff800
    s_lshl3_add_u32 s15, s57, s56
    s_lshl_b32 s15, s15, 3
    s_add_u32 s15, s15, 0x40000
    v_lshlrev_b32 v37, 11, v0
    s_waitcnt vmcnt(1)
    s_barrier
    s_waitcnt vmcnt(0)
    v_dot2_f32_bf16 v32, v8, v24, 0
    v_dot2_f32_bf16 v33, v12, v24, 0
    v_dot2_f32_bf16 v34, v16, v24, 0
    v_dot2_f32_bf16 v35, v20, v24, 0
    v_dot2_f32_bf16 v32, v9, v25, v32
    v_dot2_f32_bf16 v33, v13, v25, v33
    v_dot2_f32_bf16 v34, v17, v25, v34
    v_dot2_f32_bf16 v35, v21, v25, v35
    v_dot2_f32_bf16 v32, v10, v26, v32
    v_dot2_f32_bf16 v33, v14, v26, v33
    v_dot2_f32_bf16 v34, v18, v26, v34
    v_dot2_f32_bf16 v35, v22, v26, v35
    v_dot2_f32_bf16 v32, v11, v27, v32
    v_dot2_f32_bf16 v33, v15, v27, v33
    v_dot2_f32_bf16 v34, v19, v27, v34
    v_dot2_f32_bf16 v35, v23, v27, v35
    s_waitcnt lgkmcnt(0)
    s_add_u32 s59, s59, 0x9e3779b9
    s_bitcmp1_b32 s59, 0
    s_cselect_b32 s91, 1, 0x10000
    s_xor_b32 s92, s91, 0x10001
    v_permlane32_swap_b32 v32, v33
    v_permlane32_swap_b32 v34, v35
    v_add_f32 v32, v32, v33
    v_add_f32 v34, v34, v35
    s_nop 1
    v_permlane16_swap_b32 v32, v34
    v_add_f32 v32, v32, v34
    v_mov_b32 v39, s59
    s_nop 0
    v_add_f32_dpp v32, v32, v32 row_ror:8 row_mask:0xf bank_mask:0xf
    s_nop 1
    v_add_f32_dpp v32, v32, v32 row_ror:4 row_mask:0xf bank_mask:0xf
    s_nop 1
    v_add_f32_dpp v32, v32, v32 row_ror:2 row_mask:0xf bank_mask:0xf
    s_nop 1
    v_add_f32_dpp v32, v32, v32 row_ror:1 row_mask:0xf bank_mask:0xf
    v_ashrrev_i32 v33, 31, v32
    v_or_b32 v33, 0x80000000, v33
    v_xor_b32 v33, v33, v32
    v_and_or_b32 v33, v33, s8, v36
    s_mov_b32 exec_lo, 0x10001
    s_mov_b32 exec_hi, 0x10001
    ds_max_u32 v108, v33
    s_mov_b64 exec, 1
    ds_add_rtn_u32 v34, v108, v109 offset:4
    s_mov_b64 exec, -1
    ds_read_b32 v38, v108
    s_waitcnt lgkmcnt(0)
    v_readfirstlane_b32 s61, v34
    s_nop 0
    s_cmp_lg_u32 s61, 3
    s_cbranch_scc1 L_b1a
    s_cmp_eq_u32 s58, 128
    s_cbranch_scc1 L_b1a
    s_mov_b64 exec, 0xffffffff
    buffer_store_dwordx2 v[38:39], v37, s[36:39], s15 offen sc1
    s_mov_b64 exec, -1
L_b1a:
    s_lshl_b32 s63, s3, 1
    s_lshl_b32 s60, s63, 10
    v_lshl_add_u32 v248, v0, 4, s60
    s_add_u32 m0, s60, 32768
    global_load_lds_dwordx4 v248, s[10:11] offset:0
    global_load_lds_dwordx4 v248, s[10:11] offset:1024
    s_and_b32 s63, s3, 1
    s_add_u32 s63, s63, 8
    s_lshl_b32 s60, s63, 10
    v_lshl_add_u32 v248, v0, 4, s60
    s_add_u32 m0, s60, 32768
    global_load_lds_dwordx4 v248, s[10:11] offset:0
    s_xor_b32 s98, s3, 4
    v_lshl_add_u32 v96, v2, 4, s98
    v_lshlrev_b32 v98, 2, v3
    v_cvt_f32_u32 v98, v98
    v_cvt_f32_u32 v96, v96
    v_mul_f32 v96, 0x3b800000, v96
    v_mul_f32 v99, v98, v96
    v_cos_f32 v102, v99
    v_sin_f32 v103, v99
    v_add_f32 v99, v99, v96
    v_cvt_pk_bf16_f32 v112, v102, v103
    v_cvt_pk_bf16_f32 v116, -v103, v102
    v_cos_f32 v102, v99
    v_sin_f32 v103, v99
    v_add_f32 v99, v99, v96
    v_cvt_pk_bf16_f32 v113, v102, v103
    v_cvt_pk_bf16_f32 v117, -v103, v102
    v_cos_f32 v102, v99
    v_sin_f32 v103, v99
    v_add_f32 v99, v99, v96
    v_cvt_pk_bf16_f32 v114, v102, v103
    v_cvt_pk_bf16_f32 v118, -v103, v102
    v_cos_f32 v102, v99
    v_sin_f32 v103, v99
    s_nop 0
    v_cvt_pk_bf16_f32 v115, v102, v103
    v_cvt_pk_bf16_f32 v119, -v103, v102
    v_mov_b32 v96, 0x80000000
    v_mov_b32 v97, 0x8000
    v_xor_b32 v120, v96, v112
    v_xor_b32 v124, v97, v116
    v_xor_b32 v121, v96, v113
    v_xor_b32 v125, v97, v117
    v_xor_b32 v122, v96, v114
    v_xor_b32 v126, v97, v118
    v_xor_b32 v123, v96, v115
    v_xor_b32 v127, v97, v119
    s_sub_u32 s60, 16, s98
    s_cmp_eq_u32 s98, 0
    s_cselect_b32 s60, 8, s60
    v_bfe_u32 v96, v2, 2, 1
    v_xor_b32 v96, v96, v2
    v_lshrrev_b32 v97, 3, v2
    v_mul_u32_u24 v98, 3, v97
    v_xor_b32 v98, v98, v3
    v_lshlrev_b32 v98, 4, v98
    v_lshl_add_u32 v96, v96, 6, v98
    s_lshl_b32 s61, s98, 3
    s_and_b32 s61, s61, 32
    s_lshl_b32 s62, s98, 10
    s_or_b32 s61, s61, s62
    v_xor_b32 v60, s61, v96
    s_lshl_b32 s61, s60, 3
    s_and_b32 s61, s61, 32
    s_lshl_b32 s62, s60, 10
    s_or_b32 s61, s61, s62
    v_xor_b32 v61, s61, v96
    v_lshlrev_b32 v63, 16, v3
    v_lshl_add_u32 v63, v97, 14, v63
    v_and_b32 v96, 7, v2
    v_lshl_add_u32 v63, v96, 4, v63
    s_lshl_b32 s6, s98, 18
    s_lshl_b32 s61, s56, 11
    s_add_u32 s6, s6, s61
    s_lshl_b32 s61, s57, 7
    s_add_u32 s6, s6, s61
    s_add_u32 s6, s6, 0x200000
    s_add_u32 s7, s6, 32768
    v_lshlrev_b32 v4, 5, v2
    v_and_b32 v96, 1, v3
    v_lshl_add_u32 v4, v96, 9, v4
    v_lshrrev_b32 v96, 1, v3
    v_lshl_add_u32 v4, v96, 4, v4
    s_lshl_b32 s60, s3, 8
    s_add_u32 s93, s60, s58
    s_sub_u32 s94, 2048, s93
    s_and_b32 s94, s94, 2047
    s_mov_b32 s48, s24
    s_mov_b32 s49, s25
    s_mov_b32 s50, 0x400
    s_mov_b32 s51, 0x20000
    s_lshl_b32 s12, s93, 10
    s_lshl_b32 s13, s94, 10
    buffer_load_dwordx4 v[232:235], v4, s[32:35], s12 offen
    buffer_load_dwordx4 v[236:239], v4, s[32:35], s13 offen
    buffer_load_dwordx4 v[240:243], v4, s[48:51], 0 offen
    v_lshrrev_b32 v96, 1, v2
    v_lshlrev_b32 v96, 8, v96
    v_add_u32 v96, s58, v96
    v_and_b32 v97, 1, v2
    v_lshlrev_b32 v98, 1, v3
    v_mul_u32_u24 v98, v98, v96
    v_cmp_eq_u32 vcc, 0, v97
    v_and_b32 v99, 2047, v98
    v_add_u32 v98, v98, v96
    v_cvt_f32_u32 v99, v99
    v_mul_f32 v99, 0x3a000000, v99
    v_cos_f32 v100, v99
    v_sin_f32 v101, v99
    v_mul_f32 v100, 0.5, v100
    v_mul_f32 v101, 0.5, v101
    v_cndmask_b32_e64 v102, -v101, v100, vcc
    v_cndmask_b32 v103, v100, v101, vcc
    v_cvt_pk_bf16_f32 v144, v102, v103
    v_cvt_pk_bf16_f32 v148, -v103, v102
    v_cndmask_b32 v102, v101, v100, vcc
    v_cndmask_b32_e64 v103, -v100, v101, vcc
    v_cvt_pk_bf16_f32 v145, v102, -v103
    v_cvt_pk_bf16_f32 v149, -v103, -v102
    s_and_b32 s60, s58, 127
    s_cbranch_scc1 L_ar_a10
    v_add_f32 v100, v100, v100
    v_add_f32 v101, v101, v101
    v_cndmask_b32 v102, 0, v100, vcc
    v_sub_f32 v103, v100, v102
    v_cvt_pk_bf16_f32 v100, v102, v103
    v_cndmask_b32 v102, 0, v101, vcc
    v_sub_f32 v103, v101, v102
    v_cvt_pk_bf16_f32 v101, -v102, -v103
    s_cmp_eq_u32 s58, 0
    s_cselect_b32 s60, -1, 0
    s_cselect_b32 s61, 0, -1
    v_and_b32 v144, s60, v100
    v_and_b32 v148, s60, v101
    v_and_b32 v145, s61, v100
    v_and_b32 v149, s61, v101
L_ar_a10:
    v_and_b32 v99, 2047, v98
    v_cvt_f32_u32 v99, v99
    v_mul_f32 v99, 0x3a000000, v99
    v_cos_f32 v100, v99
    v_sin_f32 v101, v99
    v_mul_f32 v100, 0.5, v100
    v_mul_f32 v101, 0.5, v101
    v_cndmask_b32_e64 v102, -v101, v100, vcc
    v_cndmask_b32 v103, v100, v101, vcc
    v_cvt_pk_bf16_f32 v146, v102, v103
    v_cvt_pk_bf16_f32 v150, -v103, v102
    v_cndmask_b32 v102, v101, v100, vcc
    v_cndmask_b32_e64 v103, -v100, v101, vcc
    v_cvt_pk_bf16_f32 v147, v102, -v103
    v_cvt_pk_bf16_f32 v151, -v103, -v102
    s_and_b32 s60, s58, 127
    s_cbranch_scc1 L_ar_a11
    v_add_f32 v100, v100, v100
    v_add_f32 v101, v101, v101
    v_cndmask_b32 v102, 0, v100, vcc
    v_sub_f32 v103, v100, v102
    v_cvt_pk_bf16_f32 v100, v102, v103
    v_cndmask_b32 v102, 0, v101, vcc
    v_sub_f32 v103, v101, v102
    v_cvt_pk_bf16_f32 v101, -v102, -v103
    s_cmp_eq_u32 s58, 0
    s_cselect_b32 s60, -1, 0
    s_cselect_b32 s61, 0, -1
    v_and_b32 v146, s60, v100
    v_and_b32 v150, s60, v101
    v_and_b32 v147, s61, v100
    v_and_b32 v151, s61, v101
L_ar_a11:
    v_lshlrev_b32 v5, 12, v3
    v_lshl_add_u32 v5, v2, 4, v5
    v_lshrrev_b32 v96, 2, v2
    v_xor_b32 v96, v96, v3
    v_and_b32 v96, 1, v96
    v_bfe_u32 v97, v2, 1, 1
    v_lshl_or_b32 v96, v96, 1, v97
    s_lshr_b32 s60, s3, 1
    v_xor_b32 v96, s60, v96
    v_lshlrev_b32 v96, 4, v96
    v_and_b32 v98, 7, v2
    v_lshl_add_u32 v96, v98, 6, v96
    v_lshl_add_u32 v96, v3, 12, v96
    v_lshrrev_b32 v98, 3, v2
    v_lshl_add_u32 v96, v98, 2, v96
    s_and_b32 s60, s3, 1
    s_lshl_b32 s60, s60, 3
    s_add_u32 s60, s60, 16384
    v_add_u32 v6, s60, v96
    v_xor_b32 v7, 48, v6
    v_bfe_u32 v96, v2, 2, 1
    v_xor_b32 v96, v96, v98
    v_lshl_or_b32 v96, v96, 1, v98
    v_xor_b32 v96, v96, v97
    v_xor_b32 v96, v96, v3
    v_lshlrev_b32 v96, 4, v96
    v_lshl_add_u32 v62, v2, 6, v96
    s_lshl_b32 s60, s3, 4
    s_and_b32 s60, s60, 32
    v_xor_b32 v62, s60, v62
    s_lshl_b32 s60, s3, 11
    s_add_u32 s60, s60, 16384
    v_add_u32 v62, s60, v62
    s_lshl_b32 s14, s9, 14
    s_lshl_b32 s60, s3, 8
    s_add_u32 s14, s14, s60
    s_add_u32 s14, s14, 0x200000
    s_mov_b32 s40, s26
    s_mov_b32 s41, s27
    s_mov_b32 s42, 0x200000
    s_mov_b32 s43, 0x20000
    v_mov_b32 v104, s91
    v_mov_b32 v105, s92
    v_mov_b32 v106, 0x00010001
    s_branch L_b1
L_p1w:
    s_sub_u32 s96, s3, 4
    s_lshl_b32 s60, s56, 2
    s_mul_i32 s61, s56, 3
    s_add_u32 s61, s61, 4
    s_cmp_lt_u32 s56, 4
    s_cselect_b32 s60, s60, s61
    s_cselect_b32 s61, 16, 12
    s_cmp_ge_u32 s57, s61
    s_cselect_b32 s63, 8, s96
    s_lshr_b32 s61, s57, 2
    s_add_u32 s60, s60, s61
    s_lshl_b32 s6, s60, 7
    s_and_b32 s61, s57, 3
    s_mul_i32 s61, s61, 2
    s_add_u32 s61, s61, s96
    s_lshl_b32 s61, s61, 5
    s_add_u32 s61, s61, 256
    v_lshrrev_b32 v100, 1, v0
    v_add_u32 v100, s61, v100
    v_mul_u32_u24 v100, 3584, v100
    v_and_b32 v101, 1, v0
    v_lshl_add_u32 v100, v101, 6, v100
    s_waitcnt lgkmcnt(0)
    s_mov_b32 s52, s18
    s_mov_b32 s53, s19
    s_mov_b32 s54, 0x1c0000
    s_mov_b32 s55, 0x20000
    s_cmp_ge_u32 s63, 2
    s_cbranch_scc1 L_noapf
    buffer_load_dword v255, v100, s[52:55], s6 offen
L_noapf:
    s_waitcnt lgkmcnt(0)
    s_mov_b32 s32, s4
    s_mov_b32 s33, s5
    s_mov_b32 s34, 0x200000
    s_mov_b32 s35, 0x20000
    s_mov_b32 s36, s30
    s_mov_b32 s37, s31
    s_mov_b32 s38, 0x400000
    s_mov_b32 s39, 0x20000
    s_cmp_lg_u32 s3, 7
    s_cbranch_scc1 L_nomt
    v_mov_b32 v252, s16
    v_mov_b32 v253, s17
    v_writelane_b32 v252, s24, 1
    v_writelane_b32 v253, s25, 1
    v_writelane_b32 v252, s26, 2
    v_writelane_b32 v253, s27, 2
    s_add_u32 s63, s30, 0x3000
    v_writelane_b32 v252, s63, 3
    s_addc_u32 s63, s31, 0
    v_writelane_b32 v253, s63, 3
    s_add_u32 s63, s30, 0x203000
    v_writelane_b32 v252, s63, 4
    s_addc_u32 s63, s31, 0
    v_writelane_b32 v253, s63, 4
    s_mov_b64 exec, 0x1f
    global_load_dword v254, v[252:253], off
    s_mov_b64 exec, -1
L_nomt:
    v_lshlrev_b32 v107, 19, v3
    v_bfe_u32 v108, v0, 2, 2
    v_lshl_add_u32 v107, v108, 13, v107
    v_and_b32 v109, 3, v0
    v_lshl_add_u32 v107, v109, 4, v107
    v_mov_b32 v96, 43008
    v_mov_b32 v98, 0
    v_mov_b32 v99, 0
    ds_write_b64 v96, v[98:99]
    v_lshlrev_b32 v96, 2, v3
    v_cvt_f32_u32 v96, v96
    v_cvt_f32_u32 v97, v2
    v_mul_f32 v97, 0x3d800000, v97
    v_mul_f32 v96, v96, v97
    v_cos_f32 v102, v96
    v_sin_f32 v103, v96
    v_add_f32 v96, v96, v97
    v_cvt_pk_bf16_f32 v40, v102, v103
    v_cvt_pk_bf16_f32 v44, -v103, v102
    v_cos_f32 v102, v96
    v_sin_f32 v103, v96
    v_add_f32 v96, v96, v97
    v_cvt_pk_bf16_f32 v41, v102, v103
    v_cvt_pk_bf16_f32 v45, -v103, v102
    v_cos_f32 v102, v96
    v_sin_f32 v103, v96
    v_add_f32 v96, v96, v97
    v_cvt_pk_bf16_f32 v42, v102, v103
    v_cvt_pk_bf16_f32 v46, -v103, v102
    v_cos_f32 v102, v96
    v_sin_f32 v103, v96
    s_nop 0
    v_cvt_pk_bf16_f32 v43, v102, v103
    v_cvt_pk_bf16_f32 v47, -v103, v102
    v_lshrrev_b32 v96, 1, v109
    v_mul_u32_u24 v96, 3, v96
    v_lshlrev_b32 v97, 1, v3
    v_and_b32 v97, 2, v97
    v_xor_b32 v96, v96, v97
    v_xor_b32 v96, s96, v96
    v_lshl_add_u32 v96, v96, 2, v108
    v_lshlrev_b32 v96, 2, v96
    v_lshl_add_u32 v96, v109, 8, v96
    v_lshl_add_u32 v96, v3, 12, v96
    v_and_b32 v97, 1, v109
    v_lshl_add_u32 v48, v97, 6, v96
    v_xor_b32 v49, 64, v48
    v_add_u32 v50, 128, v48
    v_add_u32 v51, 128, v49
    v_lshlrev_b32 v5, 12, v3
    v_lshl_add_u32 v5, v2, 4, v5
    v_lshrrev_b32 v96, 2, v2
    v_xor_b32 v96, v96, v3
    v_and_b32 v96, 1, v96
    v_bfe_u32 v97, v2, 1, 1
    v_lshl_or_b32 v96, v96, 1, v97
    s_lshr_b32 s60, s3, 1
    v_xor_b32 v96, s60, v96
    v_lshlrev_b32 v96, 4, v96
    v_and_b32 v98, 7, v2
    v_lshl_add_u32 v96, v98, 6, v96
    v_lshl_add_u32 v96, v3, 12, v96
    v_lshrrev_b32 v98, 3, v2
    v_lshl_add_u32 v96, v98, 2, v96
    s_and_b32 s60, s3, 1
    s_lshl_b32 s60, s60, 3
    s_add_u32 s60, s60, 16384
    v_add_u32 v6, s60, v96
    v_xor_b32 v7, 48, v6
    v_bfe_u32 v96, v2, 2, 1
    v_xor_b32 v96, v96, v98
    v_lshl_or_b32 v96, v96, 1, v98
    v_xor_b32 v96, v96, v97
    v_xor_b32 v96, v96, v3
    v_lshlrev_b32 v96, 4, v96
    v_lshl_add_u32 v62, v2, 6, v96
    s_lshl_b32 s60, s3, 4
    s_and_b32 s60, s60, 32
    v_xor_b32 v62, s60, v62
    s_lshl_b32 s60, s3, 11
    s_add_u32 s60, s60, 16384
    v_add_u32 v62, s60, v62
    s_xor_b32 s98, s3, 4
    v_lshl_add_u32 v96, v2, 4, s98
    s_cmp_eq_u32 s98, 0
    s_cselect_b32 s60, 120, 0
    v_subrev_u32 v98, s60, v96
    v_cmp_gt_u32 vcc, 8, v2
    s_nop 1
    v_cndmask_b32 v96, v98, v96, vcc
    v_lshlrev_b32 v98, 2, v3
    v_cvt_f32_u32 v98, v98
    v_cvt_f32_u32 v96, v96
    v_mul_f32 v96, 0x3b800000, v96
    v_mul_f32 v99, v98, v96
    v_cos_f32 v102, v99
    v_sin_f32 v103, v99
    v_add_f32 v99, v99, v96
    v_cvt_pk_bf16_f32 v112, v102, v103
    v_cvt_pk_bf16_f32 v116, -v103, v102
    v_cos_f32 v102, v99
    v_sin_f32 v103, v99
    v_add_f32 v99, v99, v96
    v_cvt_pk_bf16_f32 v113, v102, v103
    v_cvt_pk_bf16_f32 v117, -v103, v102
    v_cos_f32 v102, v99
    v_sin_f32 v103, v99
    v_add_f32 v99, v99, v96
    v_cvt_pk_bf16_f32 v114, v102, v103
    v_cvt_pk_bf16_f32 v118, -v103, v102
    v_cos_f32 v102, v99
    v_sin_f32 v103, v99
    s_nop 0
    v_cvt_pk_bf16_f32 v115, v102, v103
    v_cvt_pk_bf16_f32 v119, -v103, v102
    v_mov_b32 v96, 0x80000000
    v_mov_b32 v97, 0x8000
    v_xor_b32 v120, v96, v112
    v_xor_b32 v124, v97, v116
    v_xor_b32 v121, v96, v113
    v_xor_b32 v125, v97, v117
    v_xor_b32 v122, v96, v114
    v_xor_b32 v126, v97, v118
    v_xor_b32 v123, v96, v115
    v_xor_b32 v127, v97, v119
    s_cmp_lg_u32 s98, 0
    s_cbranch_scc1 L_sp_e
    s_mov_b32 exec_lo, 0x10001
    s_mov_b32 exec_hi, 0x10001
    v_mov_b32 v121, 0xbf80
    v_mov_b32 v125, 0xbf800000
    v_mov_b32 v123, 0xbf80
    v_mov_b32 v127, 0xbf800000
    s_mov_b64 exec, -1
    v_cndmask_b32_e64 v128, v112, 0, vcc
    v_cndmask_b32 v112, 0, v112, vcc
    v_cndmask_b32 v136, 0, v120, vcc
    v_cndmask_b32_e64 v120, v120, 0, vcc
    v_cndmask_b32_e64 v129, v113, 0, vcc
    v_cndmask_b32 v113, 0, v113, vcc
    v_cndmask_b32 v137, 0, v121, vcc
    v_cndmask_b32_e64 v121, v121, 0, vcc
    v_cndmask_b32_e64 v130, v114, 0, vcc
    v_cndmask_b32 v114, 0, v114, vcc
    v_cndmask_b32 v138, 0, v122, vcc
    v_cndmask_b32_e64 v122, v122, 0, vcc
    v_cndmask_b32_e64 v131, v115, 0, vcc
    v_cndmask_b32 v115, 0, v115, vcc
    v_cndmask_b32 v139, 0, v123, vcc
    v_cndmask_b32_e64 v123, v123, 0, vcc
    v_cndmask_b32_e64 v132, v116, 0, vcc
    v_cndmask_b32 v116, 0, v116, vcc
    v_cndmask_b32 v140, 0, v124, vcc
    v_cndmask_b32_e64 v124, v124, 0, vcc
    v_cndmask_b32_e64 v133, v117, 0, vcc
    v_cndmask_b32 v117, 0, v117, vcc
    v_cndmask_b32 v141, 0, v125, vcc
    v_cndmask_b32_e64 v125, v125, 0, vcc
    v_cndmask_b32_e64 v134, v118, 0, vcc
    v_cndmask_b32 v118, 0, v118, vcc
    v_cndmask_b32 v142, 0, v126, vcc
    v_cndmask_b32_e64 v126, v126, 0, vcc
    v_cndmask_b32_e64 v135, v119, 0, vcc
    v_cndmask_b32 v119, 0, v119, vcc
    v_cndmask_b32 v143, 0, v127, vcc
    v_cndmask_b32_e64 v127, v127, 0, vcc
L_sp_e:
    s_sub_u32 s60, 16, s98
    s_cmp_eq_u32 s98, 0
    s_cselect_b32 s60, 8, s60
    v_bfe_u32 v96, v2, 2, 1
    v_xor_b32 v96, v96, v2
    v_lshrrev_b32 v97, 3, v2
    v_mul_u32_u24 v98, 3, v97
    v_xor_b32 v98, v98, v3
    v_lshlrev_b32 v98, 4, v98
    v_lshl_add_u32 v96, v96, 6, v98
    s_lshl_b32 s61, s98, 3
    s_and_b32 s61, s61, 32
    s_lshl_b32 s62, s98, 10
    s_or_b32 s61, s61, s62
    v_xor_b32 v60, s61, v96
    s_lshl_b32 s61, s60, 3
    s_and_b32 s61, s61, 32
    s_lshl_b32 s62, s60, 10
    s_or_b32 s61, s61, s62
    v_xor_b32 v61, s61, v96
    v_lshlrev_b32 v63, 16, v3
    v_lshl_add_u32 v63, v97, 14, v63
    v_and_b32 v96, 7, v2
    v_lshl_add_u32 v63, v96, 4, v63
    s_lshl_b32 s6, s98, 18
    s_lshl_b32 s61, s56, 11
    s_add_u32 s6, s6, s61
    s_lshl_b32 s61, s57, 7
    s_add_u32 s6, s6, s61
    s_add_u32 s6, s6, 0x200000
    s_add_u32 s7, s6, 32768
    v_lshlrev_b32 v4, 5, v2
    v_and_b32 v96, 1, v3
    v_lshl_add_u32 v4, v96, 9, v4
    v_lshrrev_b32 v96, 1, v3
    v_lshl_add_u32 v4, v96, 4, v4
    s_lshl_b32 s60, s3, 8
    s_add_u32 s93, s60, s58
    s_sub_u32 s94, 2048, s93
    s_and_b32 s94, s94, 2047
    s_mov_b32 s48, s24
    s_mov_b32 s49, s25
    s_mov_b32 s50, 0x400
    s_mov_b32 s51, 0x20000
    s_lshl_b32 s12, s96, 15
    s_lshl_b32 s61, s56, 10
    s_add_u32 s12, s12, s61
    s_lshl_b32 s61, s57, 6
    s_add_u32 s12, s12, s61
    s_cmp_eq_u32 s58, 128
    s_cselect_b32 s12, 0x40000000, s12
    s_add_u32 s13, s12, 131072
    s_add_u32 s14, s12, 262144
    s_add_u32 s15, s12, 393216
    s_waitcnt lgkmcnt(0)
    s_barrier
    buffer_load_dwordx4 v[8:11], v107, s[32:35], s12 offen
    buffer_load_dwordx4 v[12:15], v107, s[32:35], s13 offen
    buffer_load_dwordx4 v[16:19], v107, s[32:35], s14 offen
    buffer_load_dwordx4 v[20:23], v107, s[32:35], s15 offen
    s_load_dword s59, s[30:31], 0
    s_lshl_b32 s12, s93, 10
    s_lshl_b32 s13, s94, 10
    buffer_load_dwordx4 v[232:235], v4, s[32:35], s12 offen
    buffer_load_dwordx4 v[236:239], v4, s[32:35], s13 offen
    buffer_load_dwordx4 v[240:243], v4, s[48:51], 0 offen
    v_lshrrev_b32 v96, 1, v2
    v_lshlrev_b32 v96, 8, v96
    v_add_u32 v96, s58, v96
    v_and_b32 v97, 1, v2
    v_lshlrev_b32 v98, 1, v3
    v_mul_u32_u24 v98, v98, v96
    v_cmp_eq_u32 vcc, 0, v97
    v_and_b32 v99, 2047, v98
    v_add_u32 v98, v98, v96
    v_cvt_f32_u32 v99, v99
    v_mul_f32 v99, 0x3a000000, v99
    v_cos_f32 v100, v99
    v_sin_f32 v101, v99
    v_mul_f32 v100, 0.5, v100
    v_mul_f32 v101, 0.5, v101
    v_cndmask_b32_e64 v102, -v101, v100, vcc
    v_cndmask_b32 v103, v100, v101, vcc
    v_cvt_pk_bf16_f32 v144, v102, v103
    v_cvt_pk_bf16_f32 v148, -v103, v102
    v_cndmask_b32 v102, v101, v100, vcc
    v_cndmask_b32_e64 v103, -v100, v101, vcc
    v_cvt_pk_bf16_f32 v145, v102, -v103
    v_cvt_pk_bf16_f32 v149, -v103, -v102
    s_and_b32 s60, s58, 127
    s_cbranch_scc1 L_ap_a10
    v_add_f32 v100, v100, v100
    v_add_f32 v101, v101, v101
    v_cndmask_b32 v102, 0, v100, vcc
    v_sub_f32 v103, v100, v102
    v_cvt_pk_bf16_f32 v100, v102, v103
    v_cndmask_b32 v102, 0, v101, vcc
    v_sub_f32 v103, v101, v102
    v_cvt_pk_bf16_f32 v101, -v102, -v103
    s_cmp_eq_u32 s58, 0
    s_cselect_b32 s60, -1, 0
    s_cselect_b32 s61, 0, -1
    v_and_b32 v144, s60, v100
    v_and_b32 v148, s60, v101
    v_and_b32 v145, s61, v100
    v_and_b32 v149, s61, v101
L_ap_a10:
    v_and_b32 v99, 2047, v98
    v_cvt_f32_u32 v99, v99
    v_mul_f32 v99, 0x3a000000, v99
    v_cos_f32 v100, v99
    v_sin_f32 v101, v99
    v_mul_f32 v100, 0.5, v100
    v_mul_f32 v101, 0.5, v101
    v_cndmask_b32_e64 v102, -v101, v100, vcc
    v_cndmask_b32 v103, v100, v101, vcc
    v_cvt_pk_bf16_f32 v146, v102, v103
    v_cvt_pk_bf16_f32 v150, -v103, v102
    v_cndmask_b32 v102, v101, v100, vcc
    v_cndmask_b32_e64 v103, -v100, v101, vcc
    v_cvt_pk_bf16_f32 v147, v102, -v103
    v_cvt_pk_bf16_f32 v151, -v103, -v102
    s_and_b32 s60, s58, 127
    s_cbranch_scc1 L_ap_a11
    v_add_f32 v100, v100, v100
    v_add_f32 v101, v101, v101
    v_cndmask_b32 v102, 0, v100, vcc
    v_sub_f32 v103, v100, v102
    v_cvt_pk_bf16_f32 v100, v102, v103
    v_cndmask_b32 v102, 0, v101, vcc
    v_sub_f32 v103, v101, v102
    v_cvt_pk_bf16_f32 v101, -v102, -v103
    s_cmp_eq_u32 s58, 0
    s_cselect_b32 s60, -1, 0
    s_cselect_b32 s61, 0, -1
    v_and_b32 v146, s60, v100
    v_and_b32 v150, s60, v101
    v_and_b32 v147, s61, v100
    v_and_b32 v151, s61, v101
L_ap_a11:
    s_lshl_b32 s14, s9, 14
    s_lshl_b32 s60, s3, 8
    s_add_u32 s14, s14, s60
    s_add_u32 s14, s14, 0x200000
    s_mov_b32 s40, s26
    s_mov_b32 s41, s27
    s_mov_b32 s42, 0x200000
    s_mov_b32 s43, 0x20000
    s_lshr_b32 s15, s9, 2
    s_add_u32 s15, s15, 32
    s_and_b32 s15, s15, 31
    s_lshl_b32 s15, s15, 11
    s_add_u32 s15, s15, 0x40000
    s_waitcnt lgkmcnt(0)
    s_add_u32 s59, s59, 0x9e3779b9
    s_bitcmp1_b32 s59, 0
    s_cselect_b32 s91, 1, 0x10000
    s_xor_b32 s92, s91, 0x10001
    v_mov_b32 v104, s91
    v_mov_b32 v105, s92
    v_mov_b32 v106, 0x00010001
    v_mov_b32 v184, 0
    v_mov_b32 v185, 0
    v_mov_b32 v186, 0
    v_mov_b32 v187, 0
    s_waitcnt vmcnt(3)
    v_pk_mov_b32 v[24:25], v[8:9], v[12:13] op_sel:[0,0]
    v_pk_mov_b32 v[26:27], v[16:17], v[20:21] op_sel:[0,0]
    v_pk_mov_b32 v[28:29], v[8:9], v[12:13] op_sel:[1,1]
    v_pk_mov_b32 v[30:31], v[16:17], v[20:21] op_sel:[1,1]
    v_mfma_f32_16x16x32_bf16 v[64:67], v[40:43], v[24:27], 0
    v_mfma_f32_16x16x32_bf16 v[68:71], v[44:47], v[24:27], 0
    v_pk_mov_b32 v[32:33], v[10:11], v[14:15] op_sel:[0,0]
    v_pk_mov_b32 v[34:35], v[18:19], v[22:23] op_sel:[0,0]
    v_mfma_f32_16x16x32_bf16 v[72:75], v[40:43], v[28:31], 0
    v_mfma_f32_16x16x32_bf16 v[76:79], v[44:47], v[28:31], 0
    v_pk_mov_b32 v[36:37], v[10:11], v[14:15] op_sel:[1,1]
    v_pk_mov_b32 v[38:39], v[18:19], v[22:23] op_sel:[1,1]
    v_mfma_f32_16x16x32_bf16 v[80:83], v[40:43], v[32:35], 0
    v_mfma_f32_16x16x32_bf16 v[84:87], v[44:47], v[32:35], 0
    v_mfma_f32_16x16x32_bf16 v[88:91], v[40:43], v[36:39], 0
    v_cvt_pk_bf16_f32 v8, v64, v68
    v_cvt_pk_bf16_f32 v9, v65, v69
    v_mfma_f32_16x16x32_bf16 v[92:95], v[44:47], v[36:39], 0
    ds_write2st64_b32 v48, v8, v9 offset0:0 offset1:4
    v_cvt_pk_bf16_f32 v10, v66, v70
    v_cvt_pk_bf16_f32 v11, v67, v71
    ds_write2st64_b32 v48, v10, v11 offset0:8 offset1:12
    v_cvt_pk_bf16_f32 v12, v72, v76
    v_cvt_pk_bf16_f32 v13, v73, v77
    ds_write2st64_b32 v49, v12, v13 offset0:0 offset1:4
    v_cvt_pk_bf16_f32 v14, v74, v78
    v_cvt_pk_bf16_f32 v15, v75, v79
    ds_write2st64_b32 v49, v14, v15 offset0:8 offset1:12
    v_cvt_pk_bf16_f32 v16, v80, v84
    v_cvt_pk_bf16_f32 v17, v81, v85
    ds_write2st64_b32 v50, v16, v17 offset0:0 offset1:4
    v_cvt_pk_bf16_f32 v18, v82, v86
    v_cvt_pk_bf16_f32 v19, v83, v87
    ds_write2st64_b32 v50, v18, v19 offset0:8 offset1:12
    v_cvt_pk_bf16_f32 v20, v88, v92
    v_cvt_pk_bf16_f32 v21, v89, v93
    ds_write2st64_b32 v51, v20, v21 offset0:0 offset1:4
    v_cvt_pk_bf16_f32 v22, v90, v94
    v_cvt_pk_bf16_f32 v23, v91, v95
    ds_write2st64_b32 v51, v22, v23 offset0:8 offset1:12
    s_waitcnt lgkmcnt(0)
L_b1:
    s_barrier
    s_cmp_eq_u32 s58, 128
    s_cbranch_scc1 L_ack128
    ds_read_b128 v[52:55], v60
    ds_read_b128 v[56:59], v61
    s_mov_b32 vcc_lo, 0x00ff00ff
    s_mov_b32 vcc_hi, 0x00ff00ff
    s_waitcnt lgkmcnt(1)
    v_mfma_f32_16x16x32_bf16 v[64:67], v[112:115], v[52:55], 0
    v_mfma_f32_16x16x32_bf16 v[68:71], v[116:119], v[52:55], 0
    s_waitcnt lgkmcnt(0)
    v_mfma_f32_16x16x32_bf16 v[72:75], v[120:123], v[56:59], 0
    v_mfma_f32_16x16x32_bf16 v[76:79], v[124:127], v[56:59], 0
    s_cmp_lg_u32 s98, 0
    s_cbranch_scc1 L_s2b
    v_mfma_f32_16x16x32_bf16 v[64:67], v[128:131], v[56:59], v[64:67]
    v_mfma_f32_16x16x32_bf16 v[68:71], v[132:135], v[56:59], v[68:71]
    v_mfma_f32_16x16x32_bf16 v[72:75], v[136:139], v[52:55], v[72:75]
    v_mfma_f32_16x16x32_bf16 v[76:79], v[140:143], v[52:55], v[76:79]
L_s2b:
    s_nop 5
    v_cvt_pk_bf16_f32 v96, v64, v68
    v_cvt_pk_bf16_f32 v97, v65, v69
    v_cvt_pk_bf16_f32 v100, v72, v76
    v_cvt_pk_bf16_f32 v101, v73, v77
    v_bitop3_b32 v96, v106, v104, v96 bitop3:0xca
    v_bitop3_b32 v97, v106, v104, v97 bitop3:0xca
    v_bitop3_b32 v100, v106, v105, v100 bitop3:0xca
    v_bitop3_b32 v101, v106, v105, v101 bitop3:0xca
    v_cndmask_b32_dpp v80, v97, v96, vcc row_ror:8 row_mask:0xf bank_mask:0xf
    s_nop 0
    v_cndmask_b32_dpp v81, v101, v100, vcc row_ror:8 row_mask:0xf bank_mask:0xf
    s_not_b64 vcc, vcc
    v_cndmask_b32_dpp v82, v96, v97, vcc row_ror:8 row_mask:0xf bank_mask:0xf
    v_cndmask_b32_dpp v83, v100, v101, vcc row_ror:8 row_mask:0xf bank_mask:0xf
    buffer_store_dwordx4 v[80:83], v63, s[36:39], s6 offen sc1
    v_cvt_pk_bf16_f32 v98, v66, v70
    v_cvt_pk_bf16_f32 v99, v67, v71
    v_cvt_pk_bf16_f32 v102, v74, v78
    v_cvt_pk_bf16_f32 v103, v75, v79
    v_bitop3_b32 v98, v106, v104, v98 bitop3:0xca
    v_bitop3_b32 v99, v106, v104, v99 bitop3:0xca
    v_bitop3_b32 v102, v106, v105, v102 bitop3:0xca
    v_bitop3_b32 v103, v106, v105, v103 bitop3:0xca
    v_cndmask_b32_dpp v86, v98, v99, vcc row_ror:8 row_mask:0xf bank_mask:0xf
    s_nop 0
    v_cndmask_b32_dpp v87, v102, v103, vcc row_ror:8 row_mask:0xf bank_mask:0xf
    s_not_b64 vcc, vcc
    v_cndmask_b32_dpp v84, v99, v98, vcc row_ror:8 row_mask:0xf bank_mask:0xf
    v_cndmask_b32_dpp v85, v103, v102, vcc row_ror:8 row_mask:0xf bank_mask:0xf
    buffer_store_dwordx4 v[84:87], v63, s[36:39], s7 offen sc1
L_nos2:
    v_mov_b32 v109, 43016
    s_cmp_lg_u32 s3, 7
    s_cbranch_scc1 L_a5
    s_waitcnt vmcnt(0)
L_kd:
    buffer_load_dwordx4 v[128:131], v247, s[36:39], s15 offen sc1
    s_waitcnt vmcnt(0)
    v_xor_b32 v129, s59, v129
    v_bitop3_b32 v129, v131, s59, v129 bitop3:0xbe
    v_cmp_ne_u32 vcc, 0, v129
    v_max_u32 v128, v128, v130
    s_nop 0
    s_cbranch_vccz L_kd_ok
    s_sleep 2
    s_sub_u32 s90, s90, 1
    s_cbranch_scc0 L_kd
    s_mov_b32 s90, 0
L_kd_ok:
    v_max_u32_dpp v128, v128, v128 row_ror:8 row_mask:0xf bank_mask:0xf
    s_nop 1
    v_max_u32_dpp v128, v128, v128 row_ror:4 row_mask:0xf bank_mask:0xf
    s_nop 1
    v_max_u32_dpp v128, v128, v128 row_ror:2 row_mask:0xf bank_mask:0xf
    s_nop 1
    v_max_u32_dpp v128, v128, v128 row_ror:1 row_mask:0xf bank_mask:0xf
    s_nop 0
    v_readlane_b32 s97, v128, 0
    v_readlane_b32 s60, v128, 16
    v_readlane_b32 s61, v128, 32
    v_readlane_b32 s62, v128, 48
    s_max_u32 s97, s97, s60
    s_max_u32 s61, s61, s62
    s_max_u32 s97, s97, s61
    s_and_b32 s97, s97, 2047
    v_mov_b32 v110, s97
    ds_write_b32 v109, v110
    s_waitcnt lgkmcnt(0)
L_a5:
    s_cmp_ge_u32 s3, 4
    s_cbranch_scc1 L_a6
    s_waitcnt vmcnt(5)
    s_cmp_lg_u32 s58, 128
    s_cbranch_scc1 L_a6
    s_waitcnt vmcnt(0)
L_a6:
    s_barrier
    buffer_load_dwordx4 v[8:11], v5, s[36:39], s14 offen offset:0 sc1
    buffer_load_dwordx4 v[12:15], v5, s[36:39], s14 offen offset:2048 sc1
    ds_read_b32 v109, v109
    ds_read_b128 v[200:203], v247 offset:34816
    ds_read_b128 v[204:207], v247 offset:35840
    ds_read_b128 v[208:211], v247 offset:36864
    ds_read_b128 v[212:215], v247 offset:37888
    ds_read_b128 v[152:155], v247 offset:32768
    ds_read_b128 v[156:159], v247 offset:33792
    ds_read_b128 v[168:171], v247 offset:38912
    ds_read_b128 v[172:175], v247 offset:39936
    ds_read_b128 v[176:179], v247 offset:40960
    ds_read_b128 v[180:183], v247 offset:41984
    s_waitcnt vmcnt(4)
    s_cmp_lg_u32 s58, 128
    s_cbranch_scc1 L_a7
    s_waitcnt vmcnt(2)
L_a7:
    v_dot2_f32_bf16 v110, v232, v240, 0
    v_dot2_f32_bf16 v111, v236, v240, 0
    v_dot2_f32_bf16 v110, v233, v241, v110
    v_dot2_f32_bf16 v111, v237, v241, v111
    v_dot2_f32_bf16 v110, v234, v242, v110
    v_dot2_f32_bf16 v111, v238, v242, v111
    v_dot2_f32_bf16 v110, v235, v243, v110
    v_dot2_f32_bf16 v111, v239, v243, v111
    v_permlane16_swap_b32 v232, v234
    v_permlane16_swap_b32 v233, v235
    v_permlane16_swap_b32 v236, v238
    v_permlane16_swap_b32 v237, v239
    v_permlane32_swap_b32 v110, v111
    v_add_f32 v110, v110, v111
    v_mov_b32 v111, v110
    s_nop 1
    v_permlane16_swap_b32 v110, v111
    v_add_f32 v110, v110, v111
    s_nop 1
    v_add_f32_dpp v110, v110, v110 row_ror:8 row_mask:0xf bank_mask:0xf
    v_lshlrev_b32 v216, 16, v232
    v_and_b32 v217, 0xffff0000, v232
    v_add_f32_dpp v110, v110, v110 row_ror:4 row_mask:0xf bank_mask:0xf
    v_lshlrev_b32 v218, 16, v233
    v_and_b32 v219, 0xffff0000, v233
    v_add_f32_dpp v110, v110, v110 row_ror:2 row_mask:0xf bank_mask:0xf
    v_lshlrev_b32 v220, 16, v234
    v_and_b32 v221, 0xffff0000, v234
    v_add_f32_dpp v110, v110, v110 row_ror:1 row_mask:0xf bank_mask:0xf
    v_lshlrev_b32 v222, 16, v235
    v_and_b32 v223, 0xffff0000, v235
    v_mul_f32 v110, 0xbfb8aa3b, v110
    v_lshlrev_b32 v224, 16, v236
    v_and_b32 v225, 0xffff0000, v236
    v_exp_f32 v110, v110
    v_lshlrev_b32 v226, 16, v237
    v_and_b32 v227, 0xffff0000, v237
    v_add_f32 v110, 1.0, v110
    v_lshlrev_b32 v228, 16, v238
    v_and_b32 v229, 0xffff0000, v238
    v_rcp_f32 v110, v110
    v_lshlrev_b32 v230, 16, v239
    v_and_b32 v231, 0xffff0000, v239
    v_mov_b32 v111, v110
    s_nop 1
    v_permlane32_swap_b32 v110, v111
    s_waitcnt lgkmcnt(0)
    v_readfirstlane_b32 s97, v109
    v_sub_f32 v96, 1.0, v110
    v_sub_f32 v97, 1.0, v111
    v_pk_mul_f32 v[184:185], v[200:201], v[110:111] op_sel:[0,0] op_sel_hi:[1,0]
    v_pk_mul_f32 v[186:187], v[202:203], v[110:111] op_sel:[0,0] op_sel_hi:[1,0]
    v_pk_mul_f32 v[188:189], v[204:205], v[110:111] op_sel:[0,0] op_sel_hi:[1,0]
    v_pk_mul_f32 v[190:191], v[206:207], v[110:111] op_sel:[0,0] op_sel_hi:[1,0]
    v_pk_mul_f32 v[192:193], v[208:209], v[110:111] op_sel:[0,0] op_sel_hi:[1,0]
    v_pk_mul_f32 v[194:195], v[210:211], v[110:111] op_sel:[0,0] op_sel_hi:[1,0]
    v_pk_mul_f32 v[196:197], v[212:213], v[110:111] op_sel:[0,0] op_sel_hi:[1,0]
    v_pk_mul_f32 v[198:199], v[214:215], v[110:111] op_sel:[0,0] op_sel_hi:[1,0]
    v_pk_mul_f32 v[200:201], v[200:201], v[110:111] op_sel:[0,1] op_sel_hi:[1,1]
    v_pk_mul_f32 v[202:203], v[202:203], v[110:111] op_sel:[0,1] op_sel_hi:[1,1]
    v_pk_mul_f32 v[204:205], v[204:205], v[110:111] op_sel:[0,1] op_sel_hi:[1,1]
    v_pk_mul_f32 v[206:207], v[206:207], v[110:111] op_sel:[0,1] op_sel_hi:[1,1]
    v_pk_mul_f32 v[208:209], v[208:209], v[110:111] op_sel:[0,1] op_sel_hi:[1,1]
    v_pk_mul_f32 v[210:211], v[210:211], v[110:111] op_sel:[0,1] op_sel_hi:[1,1]
    v_pk_mul_f32 v[212:213], v[212:213], v[110:111] op_sel:[0,1] op_sel_hi:[1,1]
    v_pk_mul_f32 v[214:215], v[214:215], v[110:111] op_sel:[0,1] op_sel_hi:[1,1]
    v_pk_mul_f32 v[216:217], v[216:217], v[96:97] op_sel:[0,0] op_sel_hi:[1,0]
    v_pk_mul_f32 v[218:219], v[218:219], v[96:97] op_sel:[0,0] op_sel_hi:[1,0]
    v_pk_mul_f32 v[220:221], v[220:221], v[96:97] op_sel:[0,0] op_sel_hi:[1,0]
    v_pk_mul_f32 v[222:223], v[222:223], v[96:97] op_sel:[0,0] op_sel_hi:[1,0]
    v_pk_mul_f32 v[224:225], v[224:225], v[96:97] op_sel:[0,1] op_sel_hi:[1,1]
    v_pk_mul_f32 v[226:227], v[226:227], v[96:97] op_sel:[0,1] op_sel_hi:[1,1]
    v_pk_mul_f32 v[228:229], v[228:229], v[96:97] op_sel:[0,1] op_sel_hi:[1,1]
    v_pk_mul_f32 v[230:231], v[230:231], v[96:97] op_sel:[0,1] op_sel_hi:[1,1]
    v_mov_b32 v96, 0x80000000
    v_xor_b32 v160, v96, v152
    v_xor_b32 v164, v96, v156
    v_xor_b32 v161, v96, v153
    v_xor_b32 v165, v96, v157
    v_xor_b32 v162, v96, v154
    v_xor_b32 v166, v96, v158
    v_xor_b32 v163, v96, v155
    v_xor_b32 v167, v96, v159
    s_branch L_a_pw
L_a_pl:
    buffer_load_dwordx4 v[8:11], v5, s[36:39], s14 offen offset:0 sc1
    buffer_load_dwordx4 v[12:15], v5, s[36:39], s14 offen offset:2048 sc1
L_a_pw:
    s_waitcnt vmcnt(0)
    v_swap_b32 v10, v12
    v_swap_b32 v11, v13
    v_xor_b32 v96, v104, v8
    v_xor_b32 v97, v105, v9
    v_mfma_f32_16x16x32_bf16 v[64:67], v[144:147], v[8:11], 0
    v_bitop3_b32 v96, v10, v104, v96 bitop3:0xbe
    v_bitop3_b32 v97, v11, v105, v97 bitop3:0xbe
    v_mfma_f32_16x16x32_bf16 v[68:71], v[148:151], v[8:11], 0
    v_bitop3_b32 v96, v12, v104, v96 bitop3:0xbe
    v_bitop3_b32 v97, v13, v105, v97 bitop3:0xbe
    v_mfma_f32_16x16x32_bf16 v[72:75], v[144:147], v[12:15], 0
    v_bitop3_b32 v96, v14, v104, v96 bitop3:0xbe
    v_bitop3_b32 v97, v15, v105, v97 bitop3:0xbe
    v_mfma_f32_16x16x32_bf16 v[76:79], v[148:151], v[12:15], 0
    v_bitop3_b32 v96, v96, v97, v106 bitop3:0xa8
    v_cmp_ne_u32 vcc, 0, v96
    s_nop 0
    s_cbranch_vccz L_a_pl_ok
    s_sleep 1
    s_sub_u32 s90, s90, 1
    s_cbranch_scc0 L_a_pl
    s_mov_b32 s90, 0
L_a_pl_ok:
    v_cvt_pk_bf16_f32 v16, v64, v68
    v_cvt_pk_bf16_f32 v17, v65, v69
    ds_write2st64_b32 v6, v16, v17 offset0:0 offset1:4
    v_cvt_pk_bf16_f32 v18, v66, v70
    v_cvt_pk_bf16_f32 v19, v67, v71
    ds_write2st64_b32 v6, v18, v19 offset0:8 offset1:12
    v_cvt_pk_bf16_f32 v20, v72, v76
    v_cvt_pk_bf16_f32 v21, v73, v77
    ds_write2st64_b32 v7, v20, v21 offset0:2 offset1:6
    v_cvt_pk_bf16_f32 v22, v74, v78
    v_cvt_pk_bf16_f32 v23, v75, v79
    ds_write2st64_b32 v7, v22, v23 offset0:10 offset1:14
    s_waitcnt lgkmcnt(0)
    s_barrier
    ds_read_b128 v[16:19], v62 offset:0
    ds_read_b128 v[20:23], v62 offset:1024
    s_waitcnt lgkmcnt(1)
    v_mfma_f32_16x16x32_bf16 v[64:67], v[16:19], v[152:155], 0
    v_mfma_f32_16x16x32_bf16 v[68:71], v[16:19], v[156:159], 0
    s_waitcnt lgkmcnt(0)
    v_mfma_f32_16x16x32_bf16 v[72:75], v[20:23], v[152:155], 0
    v_mfma_f32_16x16x32_bf16 v[76:79], v[20:23], v[156:159], 0
    v_mfma_f32_16x16x32_bf16 v[80:83], v[16:19], v[160:163], 0
    s_nop 2
    v_pk_mul_f32 v[96:97], v[64:65], v[184:185]
    v_pk_mul_f32 v[100:101], v[68:69], v[184:185]
    v_mfma_f32_16x16x32_bf16 v[84:87], v[16:19], v[164:167], 0
    v_pk_mul_f32 v[98:99], v[66:67], v[186:187]
    v_pk_mul_f32 v[102:103], v[70:71], v[186:187]
    v_pk_fma_f32 v[96:97], v[68:69], v[188:189], v[96:97]
    v_pk_fma_f32 v[100:101], v[64:65], v[188:189], v[100:101] neg_lo:[1,0,0] neg_hi:[1,0,0]
    v_mfma_f32_16x16x32_bf16 v[88:91], v[20:23], v[160:163], 0
    v_pk_fma_f32 v[98:99], v[70:71], v[190:191], v[98:99]
    v_pk_fma_f32 v[102:103], v[66:67], v[190:191], v[102:103] neg_lo:[1,0,0] neg_hi:[1,0,0]
    v_cvt_pk_bf16_f32 v112, v96, v100
    v_cvt_pk_bf16_f32 v113, v97, v101
    v_mfma_f32_16x16x32_bf16 v[92:95], v[20:23], v[164:167], 0
    v_cvt_pk_bf16_f32 v114, v98, v102
    v_cvt_pk_bf16_f32 v115, v99, v103
    v_pk_mul_f32 v[96:97], v[72:73], v[192:193]
    v_pk_mul_f32 v[100:101], v[76:77], v[192:193]
    v_mfma_f32_16x16x32_bf16 v[232:235], v[112:115], v[168:171], v[216:219]
    v_pk_mul_f32 v[98:99], v[74:75], v[194:195]
    v_pk_mul_f32 v[102:103], v[78:79], v[194:195]
    v_pk_fma_f32 v[96:97], v[76:77], v[196:197], v[96:97]
    v_pk_fma_f32 v[100:101], v[72:73], v[196:197], v[100:101] neg_lo:[1,0,0] neg_hi:[1,0,0]
    v_mfma_f32_16x16x32_bf16 v[236:239], v[112:115], v[172:175], v[220:223]
    v_pk_fma_f32 v[98:99], v[78:79], v[198:199], v[98:99]
    v_pk_fma_f32 v[102:103], v[74:75], v[198:199], v[102:103] neg_lo:[1,0,0] neg_hi:[1,0,0]
    v_cvt_pk_bf16_f32 v116, v96, v100
    v_cvt_pk_bf16_f32 v117, v97, v101
    v_cvt_pk_bf16_f32 v118, v98, v102
    v_cvt_pk_bf16_f32 v119, v99, v103
    v_pk_mul_f32 v[96:97], v[80:81], v[200:201]
    v_pk_mul_f32 v[100:101], v[84:85], v[200:201]
    v_mfma_f32_16x16x32_bf16 v[232:235], v[116:119], v[176:179], v[232:235]
    v_pk_mul_f32 v[98:99], v[82:83], v[202:203]
    v_pk_mul_f32 v[102:103], v[86:87], v[202:203]
    v_pk_fma_f32 v[96:97], v[84:85], v[204:205], v[96:97]
    v_pk_fma_f32 v[100:101], v[80:81], v[204:205], v[100:101] neg_lo:[1,0,0] neg_hi:[1,0,0]
    v_mfma_f32_16x16x32_bf16 v[236:239], v[116:119], v[180:183], v[236:239]
    v_pk_fma_f32 v[98:99], v[86:87], v[206:207], v[98:99]
    v_pk_fma_f32 v[102:103], v[82:83], v[206:207], v[102:103] neg_lo:[1,0,0] neg_hi:[1,0,0]
    v_cvt_pk_bf16_f32 v120, v96, v100
    v_cvt_pk_bf16_f32 v121, v97, v101
    v_cvt_pk_bf16_f32 v122, v98, v102
    v_cvt_pk_bf16_f32 v123, v99, v103
    v_pk_mul_f32 v[96:97], v[88:89], v[208:209]
    v_pk_mul_f32 v[100:101], v[92:93], v[208:209]
    v_mfma_f32_16x16x32_bf16 v[240:243], v[120:123], v[168:171], v[224:227]
    v_pk_mul_f32 v[98:99], v[90:91], v[210:211]
    v_pk_mul_f32 v[102:103], v[94:95], v[210:211]
    v_pk_fma_f32 v[96:97], v[92:93], v[212:213], v[96:97]
    v_pk_fma_f32 v[100:101], v[88:89], v[212:213], v[100:101] neg_lo:[1,0,0] neg_hi:[1,0,0]
    v_mfma_f32_16x16x32_bf16 v[244:247], v[120:123], v[172:175], v[228:231]
    v_pk_fma_f32 v[98:99], v[94:95], v[214:215], v[98:99]
    v_pk_fma_f32 v[102:103], v[90:91], v[214:215], v[102:103] neg_lo:[1,0,0] neg_hi:[1,0,0]
    v_cvt_pk_bf16_f32 v124, v96, v100
    v_cvt_pk_bf16_f32 v125, v97, v101
    v_cvt_pk_bf16_f32 v126, v98, v102
    v_cvt_pk_bf16_f32 v127, v99, v103
    v_cvt_pk_bf16_f32 v8, v232, v233
    v_cvt_pk_bf16_f32 v9, v234, v235
    v_mfma_f32_16x16x32_bf16 v[240:243], v[124:127], v[176:179], v[240:243]
    v_cvt_pk_bf16_f32 v10, v236, v237
    v_cvt_pk_bf16_f32 v11, v238, v239
    v_mfma_f32_16x16x32_bf16 v[244:247], v[124:127], v[180:183], v[244:247]
    v_permlane16_swap_b32 v8, v10
    v_permlane16_swap_b32 v9, v11
    s_cmp_eq_u32 s93, s97
    s_nop 0
    s_cbranch_scc1 L_sk1
    buffer_store_dwordx4 v[8:11], v4, s[40:43], s12 offen sc1
L_sk1:
    v_cvt_pk_bf16_f32 v12, v240, v241
    v_cvt_pk_bf16_f32 v13, v242, v243
    s_nop 0
    v_cvt_pk_bf16_f32 v14, v244, v245
    v_cvt_pk_bf16_f32 v15, v246, v247
    s_nop 0
    v_permlane16_swap_b32 v12, v14
    v_permlane16_swap_b32 v13, v15
    s_cmp_eq_u32 s94, s97
    s_cbranch_scc1 L_sk2
    s_and_b32 s60, s58, 127
    s_cbranch_scc0 L_sk2
    buffer_store_dwordx4 v[12:15], v4, s[40:43], s13 offen sc1
L_sk2:
    s_endpgm
L_ack128:
    s_mov_b64 exec, 1
    v_mov_b32 v96, 0x1000
    v_mov_b32 v97, s59
    buffer_store_dword v97, v96, s[36:39], 0 offen sc1
    s_mov_b64 exec, -1
    s_branch L_nos2
L_low:
    s_lshl_b32 s60, s56, 3
    s_mul_i32 s62, s56, 6
    s_add_u32 s62, s62, 8
    s_cmp_lt_u32 s56, 4
    s_cselect_b32 s60, s60, s62
    s_cselect_b32 s61, 8, 6
    s_and_b32 s62, s57, 7
    s_add_u32 s58, s60, s62
    s_cmp_ge_u32 s62, s61
    s_cbranch_scc1 L_misc
    s_cmp_lt_u32 s57, 8
    s_cbranch_scc1 L_f
    v_lshrrev_b32 v4, 1, v0
    v_and_b32 v5, 1, v0
    v_lshlrev_b32 v5, 6, v5
    s_lshl_b32 s61, s3, 5
    v_add_u32 v4, s61, v4
    v_mul_u32_u24 v4, 3584, v4
    v_add_u32 v4, v4, v5
    s_lshr_b32 s60, s58, 1
    s_lshl_b32 s60, s60, 7
    s_bitcmp1_b32 s58, 0
    s_cselect_b32 s61, 917504, 0
    s_cselect_b32 s62, 458752, 0
    s_add_u32 s61, s61, s60
    s_add_u32 s62, s62, s60
    s_waitcnt lgkmcnt(0)
    s_mov_b32 s44, s18
    s_mov_b32 s45, s19
    s_mov_b32 s46, 0x1c0000
    s_mov_b32 s47, 0x20000
    s_mov_b32 s48, s20
    s_mov_b32 s49, s21
    s_mov_b32 s50, 0x1c0000
    s_mov_b32 s51, 0x20000
    buffer_load_dword v8, v4, s[48:51], s61 offen
    s_barrier
    s_cmp_ge_u32 s3, 4
    s_cbranch_scc1 L_end
    buffer_load_dword v10, v4, s[44:47], s62 offen
    s_endpgm
L_misc:
    s_cmp_eq_u32 s57, 7
    s_cbranch_scc1 L_fin
    s_cmp_eq_u32 s57, 14
    s_cbranch_scc1 L_fin
    s_cmp_eq_u32 s57, 15
    s_cbranch_scc1 L_w
    s_cmp_lg_u32 s56, 4
    s_cbranch_scc1 L_end
    s_mov_b32 s58, 128
    s_mov_b32 s9, 0
    s_mov_b32 s57, 15
    s_branch L_a
L_w:
    s_and_b32 s60, s56, 3
    s_lshl3_add_u32 s60, s60, s3
    s_lshl_b32 s61, s60, 12
    s_add_u32 s61, s61, 0x40000
    v_lshlrev_b32 v4, 6, v2
    v_lshl_add_u32 v4, v3, 11, v4
    v_lshlrev_b32 v6, 6, v0
    v_mov_b32 v5, 0
    s_waitcnt lgkmcnt(0)
    s_mov_b32 s36, s30
    s_mov_b32 s37, s31
    s_mov_b32 s38, 0x400000
    s_mov_b32 s39, 0x20000
    s_mov_b32 exec_hi, 0
    buffer_atomic_or v5, v4, s[36:39], s61 offen sc1
    s_cmp_lg_u32 s60, 0
    s_cbranch_scc1 L_end
    s_movk_i32 s61, 0x2000
    buffer_atomic_or v5, v6, s[36:39], s61 offen sc1
    s_endpgm
L_f:
    s_lshr_b32 s95, s58, 1
    s_xor_b32 s98, s3, 7
    v_lshrrev_b32 v8, 3, v0
    v_and_b32 v9, 2, v8
    v_and_b32 v10, 7, v0
    v_xor_b32 v9, v9, v10
    v_lshlrev_b32 v9, 4, v9
    v_lshl_add_u32 v5, v8, 10, v9
    v_xor_b32 v6, 64, v5
    s_lshl_b32 s13, s58, 15
    s_lshl_b32 s61, s3, 7
    s_add_u32 s13, s13, s61
    s_lshl_b32 s6, s3, 12
    s_add_u32 s6, s6, 65536
    s_waitcnt lgkmcnt(0)
    s_load_dword s59, s[30:31], 0
    s_mov_b32 s32, s4
    s_mov_b32 s33, s5
    s_mov_b32 s34, 0x200000
    s_mov_b32 s35, 0x20000
    s_mov_b32 s36, s30
    s_mov_b32 s37, s31
    s_mov_b32 s38, 0x400000
    s_mov_b32 s39, 0x20000
    s_mov_b32 s52, s22
    s_mov_b32 s53, s23
    s_mov_b32 s54, 0x1c0000
    s_mov_b32 s55, 0x20000
    s_waitcnt lgkmcnt(0)
    s_add_u32 s59, s59, 0x9e3779b9
    s_bitcmp1_b32 s59, 0
    s_cselect_b32 s91, 1, 0x10000
    s_xor_b32 s92, s91, 0x10001
    s_add_u32 m0, s6, 0
    s_nop 0
    buffer_load_dwordx4 v5, s[52:55], s13 offen lds
    s_add_u32 s13, s13, 8192
    s_add_u32 m0, s6, 1024
    s_nop 0
    buffer_load_dwordx4 v6, s[52:55], s13 offen lds
    s_add_u32 s13, s13, 8192
    s_add_u32 m0, s6, 2048
    s_nop 0
    buffer_load_dwordx4 v5, s[52:55], s13 offen lds
    s_add_u32 s13, s13, 8192
    s_add_u32 m0, s6, 3072
    s_nop 0
    buffer_load_dwordx4 v6, s[52:55], s13 offen lds
    s_cmp_lg_u32 s3, 0
    s_cbranch_scc1 L_nomf
    v_mov_b32 v252, s18
    v_mov_b32 v253, s19
    v_writelane_b32 v252, s20, 1
    v_writelane_b32 v253, s21, 1
    v_writelane_b32 v252, s4, 2
    v_writelane_b32 v253, s5, 2
    s_add_u32 s63, s30, 0x3000
    v_writelane_b32 v252, s63, 3
    s_addc_u32 s63, s31, 0
    v_writelane_b32 v253, s63, 3
    s_mov_b64 exec, 0xf
    global_load_dword v254, v[252:253], off
    s_mov_b64 exec, -1
L_nomf:
    s_cmp_lt_u32 s98, 4
    s_cselect_b32 s44, s18, s20
    s_cselect_b32 s45, s19, s21
    s_mov_b32 s46, 0x1c0000
    s_mov_b32 s47, 0x20000
    v_lshrrev_b32 v8, 2, v0
    v_mul_u32_u24 v4, 3584, v8
    v_lshrrev_b32 v8, 2, v8
    v_and_b32 v8, 2, v8
    v_and_b32 v9, 3, v0
    v_xor_b32 v8, v8, v9
    v_lshl_add_u32 v4, v8, 4, v4
    s_and_b32 s60, s98, 3
    s_mul_i32 s12, s60, 458752
    s_lshl_b32 s61, s58, 6
    s_add_u32 s12, s12, s61
    s_lshl_b32 s14, s3, 13
    v_lshrrev_b32 v8, 2, v2
    v_lshl_add_u32 v9, v3, 3, v8
    v_and_b32 v10, 3, v0
    v_lshlrev_b32 v10, 3, v10
    v_and_b32 v11, 1, v3
    v_lshl_add_u32 v7, v9, 6, v10
    v_lshl_add_u32 v7, v11, 5, v7
    v_add_u32 v7, s14, v7
    v_xor_b32 v12, 32, v7
    v_lshrrev_b32 v8, 1, v8
    v_lshl_add_u32 v8, v11, 1, v8
    v_lshl_add_u32 v112, v9, 7, v10
    v_lshl_add_u32 v112, v8, 5, v112
    v_add_u32 v112, s6, v112
    v_xor_b32 v113, 32, v112
    v_xor_b32 v114, 64, v112
    v_xor_b32 v115, 96, v112
    s_and_b32 s60, s98, 3
    s_lshl_b32 s60, s60, 8
    s_add_u32 s60, s60, 98304
    v_lshlrev_b32 v14, 4, v3
    v_add_u32 v15, s60, v14
    s_lshl_b32 s60, s98, 7
    s_add_u32 s60, s60, 99328
    v_add_u32 v107, s60, v14
    v_lshl_add_u32 v111, v3, 5, v10
    v_add_u32 v111, 99328, v111
    v_lshlrev_b32 v108, 3, v3
    v_lshl_add_u32 v108, v2, 5, v108
    s_mul_i32 s8, s3, 7168
    s_lshl_b32 s61, s58, 7
    s_add_u32 s8, s8, s61
    s_add_u32 s8, s8, 0x10000
    s_and_b32 s15, s95, 31
    s_lshl_b32 s15, s15, 11
    s_add_u32 s15, s15, 0x40000
    v_lshlrev_b32 v134, 3, v0
    v_lshlrev_b32 v133, 4, v0
    v_mov_b32 v104, s91
    v_mov_b32 v105, s92
    v_mov_b32 v106, 0x00010001
    s_lshl_b32 s7, s58, 2
    s_add_u32 s7, s7, 0x2000
    v_lshlrev_b32 v122, 8, v0
    v_mov_b32 v123, s59
    s_waitcnt vmcnt(0)
    s_cmp_lg_u32 s3, 0
    s_cbranch_scc1 L_f1
    s_barrier
    s_add_u32 m0, s14, 0
    s_nop 0
    buffer_load_dwordx4 v4, s[44:47], s12 offen lds
    s_add_u32 s12, s12, 57344
    s_add_u32 m0, s14, 1024
    s_nop 0
    buffer_load_dwordx4 v4, s[44:47], s12 offen lds
    s_add_u32 s12, s12, 57344
    s_add_u32 m0, s14, 2048
    s_nop 0
    buffer_load_dwordx4 v4, s[44:47], s12 offen lds
    s_add_u32 s12, s12, 57344
    s_add_u32 m0, s14, 3072
    s_nop 0
    buffer_load_dwordx4 v4, s[44:47], s12 offen lds
    s_add_u32 s12, s12, 57344
    s_add_u32 m0, s14, 4096
    s_nop 0
    buffer_load_dwordx4 v4, s[44:47], s12 offen lds
    s_add_u32 s12, s12, 57344
    s_add_u32 m0, s14, 5120
    s_nop 0
    buffer_load_dwordx4 v4, s[44:47], s12 offen lds
    s_add_u32 s12, s12, 57344
    s_add_u32 m0, s14, 6144
    s_nop 0
    buffer_load_dwordx4 v4, s[44:47], s12 offen lds
    s_add_u32 s12, s12, 57344
    s_add_u32 m0, s14, 7168
    s_nop 0
    buffer_load_dwordx4 v4, s[44:47], s12 offen lds
    buffer_load_dwordx4 v[128:131], v247, s[36:39], s15 offen sc1
    ds_read_b64_tr_b16 v[48:49], v112 offset:0
    ds_read_b64_tr_b16 v[50:51], v112 offset:512
    ds_read_b64_tr_b16 v[52:53], v113 offset:0
    ds_read_b64_tr_b16 v[54:55], v113 offset:512
    ds_read_b64_tr_b16 v[56:57], v114 offset:0
    ds_read_b64_tr_b16 v[58:59], v114 offset:512
    ds_read_b64_tr_b16 v[60:61], v115 offset:0
    ds_read_b64_tr_b16 v[62:63], v115 offset:512
    s_waitcnt vmcnt(0)
    v_xor_b32 v129, s59, v129
    v_bitop3_b32 v129, v131, s59, v129 bitop3:0xbe
    v_cmp_ne_u32 vcc, 0, v129
    v_max_u32 v128, v128, v130
    s_cbranch_vccnz L_f1b
    s_nop 0
    v_max_u32_dpp v128, v128, v128 row_ror:8 row_mask:0xf bank_mask:0xf
    s_nop 1
    v_max_u32_dpp v128, v128, v128 row_ror:4 row_mask:0xf bank_mask:0xf
    s_nop 1
    v_max_u32_dpp v128, v128, v128 row_ror:2 row_mask:0xf bank_mask:0xf
    s_nop 1
    v_max_u32_dpp v128, v128, v128 row_ror:1 row_mask:0xf bank_mask:0xf
    s_nop 0
    v_readlane_b32 s97, v128, 0
    v_readlane_b32 s60, v128, 16
    v_readlane_b32 s61, v128, 32
    v_readlane_b32 s62, v128, 48
    s_max_u32 s97, s97, s60
    s_max_u32 s61, s61, s62
    s_max_u32 s97, s97, s61
    s_and_b32 s97, s97, 2047
    s_lshl_b32 s60, s97, 10
    s_mov_b32 m0, 98304
    s_nop 0
    buffer_load_dwordx4 v247, s[32:35], s60 offen lds
    s_waitcnt vmcnt(1)
    s_waitcnt vmcnt(14)
    ds_read_b64_tr_b16 v[16:17], v7 offset:0
    ds_read_b64_tr_b16 v[18:19], v7 offset:256
    ds_read_b64_tr_b16 v[20:21], v12 offset:0
    ds_read_b64_tr_b16 v[22:23], v12 offset:256
    s_waitcnt vmcnt(12)
    ds_read_b64_tr_b16 v[24:25], v7 offset:2048
    ds_read_b64_tr_b16 v[26:27], v7 offset:2304
    ds_read_b64_tr_b16 v[28:29], v12 offset:2048
    ds_read_b64_tr_b16 v[30:31], v12 offset:2304
    s_waitcnt vmcnt(10)
    ds_read_b64_tr_b16 v[32:33], v7 offset:4096
    ds_read_b64_tr_b16 v[34:35], v7 offset:4352
    ds_read_b64_tr_b16 v[36:37], v12 offset:4096
    ds_read_b64_tr_b16 v[38:39], v12 offset:4352
    s_waitcnt vmcnt(8)
    ds_read_b64_tr_b16 v[40:41], v7 offset:6144
    ds_read_b64_tr_b16 v[42:43], v7 offset:6400
    ds_read_b64_tr_b16 v[44:45], v12 offset:6144
    ds_read_b64_tr_b16 v[46:47], v12 offset:6400
    s_waitcnt vmcnt(0)
    s_branch L_f2
L_f1b:
L_pk3:
    buffer_load_dwordx4 v[128:131], v133, s[36:39], s15 offen sc1
L_pk3_w:
    s_waitcnt vmcnt(0)
    v_xor_b32 v129, s59, v129
    v_bitop3_b32 v129, v131, s59, v129 bitop3:0xbe
    v_cmp_ne_u32 vcc, 0, v129
    v_max_u32 v128, v128, v130
    s_nop 0
    s_cbranch_vccz L_pk3_ok
    s_sleep 1
    s_sub_u32 s90, s90, 1
    s_cbranch_scc0 L_pk3
    s_mov_b32 s90, 0
L_pk3_ok:
    v_max_u32_dpp v128, v128, v128 row_ror:8 row_mask:0xf bank_mask:0xf
    s_nop 1
    v_max_u32_dpp v128, v128, v128 row_ror:4 row_mask:0xf bank_mask:0xf
    s_nop 1
    v_max_u32_dpp v128, v128, v128 row_ror:2 row_mask:0xf bank_mask:0xf
    s_nop 1
    v_max_u32_dpp v128, v128, v128 row_ror:1 row_mask:0xf bank_mask:0xf
    s_nop 0
    v_readlane_b32 s97, v128, 0
    v_readlane_b32 s60, v128, 16
    v_readlane_b32 s61, v128, 32
    v_readlane_b32 s62, v128, 48
    s_max_u32 s97, s97, s60
    s_max_u32 s61, s61, s62
    s_max_u32 s97, s97, s61
    s_and_b32 s97, s97, 2047
    s_lshl_b32 s60, s97, 10
    s_mov_b32 m0, 98304
    s_nop 0
    buffer_load_dwordx4 v247, s[32:35], s60 offen lds
    s_waitcnt vmcnt(1)
    s_waitcnt vmcnt(14)
    ds_read_b64_tr_b16 v[16:17], v7 offset:0
    ds_read_b64_tr_b16 v[18:19], v7 offset:256
    ds_read_b64_tr_b16 v[20:21], v12 offset:0
    ds_read_b64_tr_b16 v[22:23], v12 offset:256
    s_waitcnt vmcnt(12)
    ds_read_b64_tr_b16 v[24:25], v7 offset:2048
    ds_read_b64_tr_b16 v[26:27], v7 offset:2304
    ds_read_b64_tr_b16 v[28:29], v12 offset:2048
    ds_read_b64_tr_b16 v[30:31], v12 offset:2304
    s_waitcnt vmcnt(10)
    ds_read_b64_tr_b16 v[32:33], v7 offset:4096
    ds_read_b64_tr_b16 v[34:35], v7 offset:4352
    ds_read_b64_tr_b16 v[36:37], v12 offset:4096
    ds_read_b64_tr_b16 v[38:39], v12 offset:4352
    s_waitcnt vmcnt(8)
    ds_read_b64_tr_b16 v[40:41], v7 offset:6144
    ds_read_b64_tr_b16 v[42:43], v7 offset:6400
    ds_read_b64_tr_b16 v[44:45], v12 offset:6144
    ds_read_b64_tr_b16 v[46:47], v12 offset:6400
    s_waitcnt vmcnt(0)
    s_branch L_f2
L_f1:
    s_barrier
    s_add_u32 m0, s14, 0
    s_nop 0
    buffer_load_dwordx4 v4, s[44:47], s12 offen lds
    s_add_u32 s12, s12, 57344
    s_add_u32 m0, s14, 1024
    s_nop 0
    buffer_load_dwordx4 v4, s[44:47], s12 offen lds
    s_add_u32 s12, s12, 57344
    s_add_u32 m0, s14, 2048
    s_nop 0
    buffer_load_dwordx4 v4, s[44:47], s12 offen lds
    s_add_u32 s12, s12, 57344
    s_add_u32 m0, s14, 3072
    s_nop 0
    buffer_load_dwordx4 v4, s[44:47], s12 offen lds
    s_add_u32 s12, s12, 57344
    s_add_u32 m0, s14, 4096
    s_nop 0
    buffer_load_dwordx4 v4, s[44:47], s12 offen lds
    s_add_u32 s12, s12, 57344
    s_add_u32 m0, s14, 5120
    s_nop 0
    buffer_load_dwordx4 v4, s[44:47], s12 offen lds
    s_add_u32 s12, s12, 57344
    s_add_u32 m0, s14, 6144
    s_nop 0
    buffer_load_dwordx4 v4, s[44:47], s12 offen lds
    s_add_u32 s12, s12, 57344
    s_add_u32 m0, s14, 7168
    s_nop 0
    buffer_load_dwordx4 v4, s[44:47], s12 offen lds
    ds_read_b64_tr_b16 v[48:49], v112 offset:0
    ds_read_b64_tr_b16 v[50:51], v112 offset:512
    ds_read_b64_tr_b16 v[52:53], v113 offset:0
    ds_read_b64_tr_b16 v[54:55], v113 offset:512
    ds_read_b64_tr_b16 v[56:57], v114 offset:0
    ds_read_b64_tr_b16 v[58:59], v114 offset:512
    ds_read_b64_tr_b16 v[60:61], v115 offset:0
    ds_read_b64_tr_b16 v[62:63], v115 offset:512
    s_waitcnt vmcnt(6)
    ds_read_b64_tr_b16 v[16:17], v7 offset:0
    ds_read_b64_tr_b16 v[18:19], v7 offset:256
    ds_read_b64_tr_b16 v[20:21], v12 offset:0
    ds_read_b64_tr_b16 v[22:23], v12 offset:256
    s_waitcnt vmcnt(4)
    ds_read_b64_tr_b16 v[24:25], v7 offset:2048
    ds_read_b64_tr_b16 v[26:27], v7 offset:2304
    ds_read_b64_tr_b16 v[28:29], v12 offset:2048
    ds_read_b64_tr_b16 v[30:31], v12 offset:2304
    s_waitcnt vmcnt(2)
    ds_read_b64_tr_b16 v[32:33], v7 offset:4096
    ds_read_b64_tr_b16 v[34:35], v7 offset:4352
    ds_read_b64_tr_b16 v[36:37], v12 offset:4096
    ds_read_b64_tr_b16 v[38:39], v12 offset:4352
    s_waitcnt vmcnt(0)
    ds_read_b64_tr_b16 v[40:41], v7 offset:6144
    ds_read_b64_tr_b16 v[42:43], v7 offset:6400
    ds_read_b64_tr_b16 v[44:45], v12 offset:6144
    ds_read_b64_tr_b16 v[46:47], v12 offset:6400
L_f2:
    s_waitcnt lgkmcnt(0)
    s_barrier
    ds_read_b128 v[64:67], v15 offset:0
    ds_read_b128 v[68:71], v15 offset:64
    ds_read_b128 v[72:75], v15 offset:128
    ds_read_b128 v[76:79], v15 offset:192
    s_waitcnt lgkmcnt(3)
    v_mfma_f32_16x16x32_bf16 v[80:83], v[16:19], v[64:67], 0
    v_mfma_f32_16x16x32_bf16 v[84:87], v[20:23], v[64:67], 0
    s_waitcnt lgkmcnt(2)
    v_mfma_f32_16x16x32_bf16 v[80:83], v[24:27], v[68:71], v[80:83]
    v_mfma_f32_16x16x32_bf16 v[84:87], v[28:31], v[68:71], v[84:87]
    s_waitcnt lgkmcnt(1)
    v_mfma_f32_16x16x32_bf16 v[80:83], v[32:35], v[72:75], v[80:83]
    v_mfma_f32_16x16x32_bf16 v[84:87], v[36:39], v[72:75], v[84:87]
    s_waitcnt lgkmcnt(0)
    v_mfma_f32_16x16x32_bf16 v[80:83], v[40:43], v[76:79], v[80:83]
    v_mfma_f32_16x16x32_bf16 v[84:87], v[44:47], v[76:79], v[84:87]
    s_mov_b32 exec_lo, 0x10001
    s_mov_b32 exec_hi, 0x10001
    s_nop 4
    ds_write_b128 v107, v[80:83] offset:0
    ds_write_b128 v107, v[84:87] offset:64
    s_mov_b64 exec, -1
    s_waitcnt lgkmcnt(0)
    s_barrier
    ds_read_b64 v[64:65], v111 offset:0
    ds_read_b64 v[66:67], v111 offset:128
    ds_read_b64 v[68:69], v111 offset:256
    ds_read_b64 v[70:71], v111 offset:384
    ds_read_b64 v[72:73], v111 offset:512
    ds_read_b64 v[74:75], v111 offset:640
    ds_read_b64 v[76:77], v111 offset:768
    ds_read_b64 v[78:79], v111 offset:896
    s_waitcnt lgkmcnt(4)
    v_pk_add_f32 v[64:65], v[64:65], v[66:67]
    v_pk_add_f32 v[68:69], v[68:69], v[70:71]
    v_pk_add_f32 v[64:65], v[64:65], v[68:69]
    v_mul_f32 v67, 0xbfb8aa3b, v65
    v_mul_f32 v66, 0xbfb8aa3b, v64
    v_exp_f32 v67, v67
    v_exp_f32 v66, v66
    v_add_f32 v67, 1.0, v67
    v_add_f32 v66, 1.0, v66
    v_rcp_f32 v67, v67
    v_rcp_f32 v66, v66
    s_nop 0
    v_pk_mul_f32 v[64:65], v[64:65], v[66:67]
    s_waitcnt lgkmcnt(0)
    v_pk_add_f32 v[72:73], v[72:73], v[74:75]
    v_pk_add_f32 v[76:77], v[76:77], v[78:79]
    v_pk_add_f32 v[72:73], v[72:73], v[76:77]
    v_pk_mul_f32 v[64:65], v[64:65], v[72:73]
    v_cvt_pk_bf16_f32 v64, v64, v65
    s_nop 1
    v_mov_b32_dpp v72, v64 quad_perm:[0,0,0,0] row_mask:0xf bank_mask:0xf
    v_mov_b32_dpp v73, v64 quad_perm:[1,1,1,1] row_mask:0xf bank_mask:0xf
    v_mov_b32_dpp v74, v64 quad_perm:[2,2,2,2] row_mask:0xf bank_mask:0xf
    v_mov_b32_dpp v75, v64 quad_perm:[3,3,3,3] row_mask:0xf bank_mask:0xf
    s_nop 1
    v_mfma_f32_16x16x32_bf16 v[88:91], v[48:51], v[72:75], 0
    v_mfma_f32_16x16x32_bf16 v[92:95], v[52:55], v[72:75], 0
    v_mfma_f32_16x16x32_bf16 v[96:99], v[56:59], v[72:75], 0
    v_mfma_f32_16x16x32_bf16 v[100:103], v[60:63], v[72:75], 0
    s_mov_b32 exec_lo, 0x10001
    s_mov_b32 exec_hi, 0x10001
    s_nop 2
    v_cvt_pk_bf16_f32 v120, v88, v89
    v_cvt_pk_bf16_f32 v121, v90, v91
    s_mov_b32 exec_lo, 0x20002
    s_mov_b32 exec_hi, 0x20002
    v_cvt_pk_bf16_f32 v120, v92, v93
    v_cvt_pk_bf16_f32 v121, v94, v95
    s_mov_b32 exec_lo, 0x40004
    s_mov_b32 exec_hi, 0x40004
    v_cvt_pk_bf16_f32 v120, v96, v97
    v_cvt_pk_bf16_f32 v121, v98, v99
    s_mov_b32 exec_lo, 0x80008
    s_mov_b32 exec_hi, 0x80008
    v_cvt_pk_bf16_f32 v120, v100, v101
    v_cvt_pk_bf16_f32 v121, v102, v103
    s_mov_b32 exec_lo, 0x000f000f
    s_mov_b32 exec_hi, 0x000f000f
    v_bitop3_b32 v120, v106, v104, v120 bitop3:0xca
    v_bitop3_b32 v121, v106, v105, v121 bitop3:0xca
    buffer_store_dwordx2 v[120:121], v108, s[36:39], s8 offen sc1
    s_mov_b64 exec, -1
    s_endpgm
L_fin:
    v_lshlrev_b32 v4, 5, v2
    v_and_b32 v96, 1, v3
    v_lshl_add_u32 v4, v96, 9, v4
    v_lshrrev_b32 v96, 1, v3
    v_lshl_add_u32 v4, v96, 4, v4
    s_add_u32 s95, s56, 24
    s_lshr_b32 s99, s57, 1
    s_and_b32 s99, s99, 4
    s_add_u32 s99, s99, s56
    s_sub_u32 s99, s99, 4
    s_waitcnt lgkmcnt(0)
    s_load_dword s59, s[30:31], 0
    s_mov_b32 s32, s4
    s_mov_b32 s33, s5
    s_mov_b32 s34, 0x200000
    s_mov_b32 s35, 0x20000
    s_mov_b32 s36, s30
    s_mov_b32 s37, s31
    s_mov_b32 s38, 0x400000
    s_mov_b32 s39, 0x20000
    s_mov_b32 s48, s24
    s_mov_b32 s49, s25
    s_mov_b32 s50, 0x400
    s_mov_b32 s51, 0x20000
    buffer_load_dwordx4 v[28:31], v4, s[48:51], 0 offen
    s_lshl_b32 s60, s3, 10
    v_lshl_add_u32 v248, v0, 4, s60
    s_add_u32 m0, s60, 32768
    global_load_lds_dwordx4 v248, s[10:11] offset:0
    s_and_b32 s63, s3, 1
    s_add_u32 s63, s63, 8
    s_lshl_b32 s60, s63, 10
    v_lshl_add_u32 v248, v0, 4, s60
    s_add_u32 m0, s60, 32768
    global_load_lds_dwordx4 v248, s[10:11] offset:0
    s_mov_b32 s40, s26
    s_mov_b32 s41, s27
    s_mov_b32 s42, 0x200000
    s_mov_b32 s43, 0x20000
    v_mov_b32 v252, s4
    v_mov_b32 v253, s5
    v_writelane_b32 v252, s26, 1
    v_writelane_b32 v253, s27, 1
    s_add_u32 s63, s30, 0x3000
    v_writelane_b32 v252, s63, 2
    s_addc_u32 s63, s31, 0
    v_writelane_b32 v253, s63, 2
    s_add_u32 s63, s30, 0x203000
    v_writelane_b32 v252, s63, 3
    s_addc_u32 s63, s31, 0
    v_writelane_b32 v253, s63, 3
    s_mov_b64 exec, 0xf
    global_load_dword v254, v[252:253], off
    s_mov_b64 exec, -1
    v_lshlrev_b32 v5, 12, v3
    v_lshl_add_u32 v5, v2, 4, v5
    v_lshrrev_b32 v96, 2, v2
    v_xor_b32 v96, v96, v3
    v_and_b32 v96, 1, v96
    v_bfe_u32 v97, v2, 1, 1
    v_lshl_or_b32 v96, v96, 1, v97
    s_lshr_b32 s60, s3, 1
    v_xor_b32 v96, s60, v96
    v_lshlrev_b32 v96, 4, v96
    v_and_b32 v98, 7, v2
    v_lshl_add_u32 v96, v98, 6, v96
    v_lshl_add_u32 v96, v3, 12, v96
    v_lshrrev_b32 v98, 3, v2
    v_lshl_add_u32 v96, v98, 2, v96
    s_and_b32 s60, s3, 1
    s_lshl_b32 s60, s60, 3
    s_add_u32 s60, s60, 16384
    v_add_u32 v6, s60, v96
    v_xor_b32 v7, 48, v6
    v_bfe_u32 v96, v2, 2, 1
    v_xor_b32 v96, v96, v98
    v_lshl_or_b32 v96, v96, 1, v98
    v_xor_b32 v96, v96, v97
    v_xor_b32 v96, v96, v3
    v_lshlrev_b32 v96, 4, v96
    v_lshl_add_u32 v62, v2, 6, v96
    s_and_b32 s15, s95, 31
    s_lshl_b32 s15, s15, 11
    s_add_u32 s15, s15, 0x40000
    v_lshlrev_b32 v134, 3, v0
    v_lshlrev_b32 v133, 4, v0
    s_mul_i32 s7, s99, 7168
    s_lshl_b32 s61, s3, 10
    s_add_u32 s7, s7, s61
    s_add_u32 s7, s7, 0xfc00
    v_and_b32 v108, 1, v3
    v_lshrrev_b32 v111, 1, v3
    v_lshl_add_u32 v108, v108, 1, v111
    v_and_b32 v107, 7, v2
    v_lshl_add_u32 v108, v2, 2, v108
    s_lshl_b32 s60, s3, 8
    s_add_u32 s60, s60, 43008
    v_lshl_add_u32 v108, v108, 2, s60
    v_and_b32 v111, 3, v2
    v_lshlrev_b32 v111, 6, v111
    v_lshl_add_u32 v111, v3, 4, v111
    v_mov_b32 v109, 43016
    s_waitcnt lgkmcnt(0)
    s_add_u32 s59, s59, 0x9e3779b9
    s_bitcmp1_b32 s59, 0
    s_cselect_b32 s91, 1, 0x10000
    s_xor_b32 s92, s91, 0x10001
    s_cmp_lg_u32 s3, 0
    s_cbranch_scc1 L_fin0
    s_cmp_eq_u32 s99, 0
    s_cbranch_scc1 L_fin0
    s_lshl_b32 s60, s99, 7
    v_mov_b32 v96, 0x1000
    v_mov_b32 v97, s59
    s_mov_b64 exec, 1
    buffer_store_dword v97, v96, s[36:39], s60 offen sc1
    s_mov_b64 exec, -1
L_fin0:
    v_mov_b32 v104, s91
    v_mov_b32 v105, s92
    v_mov_b32 v106, 0x00010001
    s_waitcnt vmcnt(0)
    s_barrier
    s_lshr_b32 s60, s99, 2
    s_lshl_b32 s60, s60, 10
    v_add_u32 v110, s60, v247
    ds_read_b128 v[152:155], v247 offset:32768
    ds_read_b128 v[156:159], v247 offset:33792
    ds_read_b128 v[184:187], v247 offset:34816
    ds_read_b128 v[188:191], v247 offset:35840
    ds_read_b128 v[192:195], v247 offset:36864
    ds_read_b128 v[196:199], v247 offset:37888
    ds_read_b128 v[168:171], v110 offset:38912
    ds_read_b128 v[172:175], v110 offset:40960
    s_cmp_lg_u32 s3, 0
    s_cbranch_scc1 L_fin1a
    v_mov_b32 v80, 0
    v_mov_b32 v81, 0
    v_mov_b32 v82, 0
    v_mov_b32 v83, 0
    buffer_atomic_or_x2 v[80:81], v134, s[36:39], s15 offen sc0 sc1
    buffer_atomic_or_x2 v[82:83], v134, s[36:39], s15 offen offset:512 sc0 sc1
    s_sleep 4
    v_mov_b32 v84, 0
    v_mov_b32 v85, 0
    v_mov_b32 v86, 0
    v_mov_b32 v87, 0
    buffer_atomic_or_x2 v[84:85], v134, s[36:39], s15 offen sc0 sc1
    buffer_atomic_or_x2 v[86:87], v134, s[36:39], s15 offen offset:512 sc0 sc1
    s_sleep 4
    v_mov_b32 v88, 0
    v_mov_b32 v89, 0
    v_mov_b32 v90, 0
    v_mov_b32 v91, 0
    buffer_atomic_or_x2 v[88:89], v134, s[36:39], s15 offen sc0 sc1
    buffer_atomic_or_x2 v[90:91], v134, s[36:39], s15 offen offset:512 sc0 sc1
L_kp4:
    s_waitcnt vmcnt(4)
    v_xor_b32 v129, s59, v81
    v_bitop3_b32 v129, v83, s59, v129 bitop3:0xbe
    v_cmp_ne_u32 vcc, 0, v129
    s_nop 0
    s_cbranch_vccz L_kp4_d0
    v_mov_b32 v80, 0
    v_mov_b32 v81, 0
    v_mov_b32 v82, 0
    v_mov_b32 v83, 0
    buffer_atomic_or_x2 v[80:81], v134, s[36:39], s15 offen sc0 sc1
    buffer_atomic_or_x2 v[82:83], v134, s[36:39], s15 offen offset:512 sc0 sc1
    s_waitcnt vmcnt(4)
    v_xor_b32 v129, s59, v85
    v_bitop3_b32 v129, v87, s59, v129 bitop3:0xbe
    v_cmp_ne_u32 vcc, 0, v129
    s_nop 0
    s_cbranch_vccz L_kp4_d1
    v_mov_b32 v84, 0
    v_mov_b32 v85, 0
    v_mov_b32 v86, 0
    v_mov_b32 v87, 0
    buffer_atomic_or_x2 v[84:85], v134, s[36:39], s15 offen sc0 sc1
    buffer_atomic_or_x2 v[86:87], v134, s[36:39], s15 offen offset:512 sc0 sc1
    s_waitcnt vmcnt(4)
    v_xor_b32 v129, s59, v89
    v_bitop3_b32 v129, v91, s59, v129 bitop3:0xbe
    v_cmp_ne_u32 vcc, 0, v129
    s_nop 0
    s_cbranch_vccz L_kp4_d2
    v_mov_b32 v88, 0
    v_mov_b32 v89, 0
    v_mov_b32 v90, 0
    v_mov_b32 v91, 0
    buffer_atomic_or_x2 v[88:89], v134, s[36:39], s15 offen sc0 sc1
    buffer_atomic_or_x2 v[90:91], v134, s[36:39], s15 offen offset:512 sc0 sc1
    s_sub_u32 s90, s90, 1
    s_cbranch_scc0 L_kp4
    s_waitcnt vmcnt(0)
L_kp4_d0:
    v_max_u32 v128, v80, v82
    s_branch L_kp4_x
L_kp4_d1:
    v_max_u32 v128, v84, v86
    s_branch L_kp4_x
L_kp4_d2:
    v_max_u32 v128, v88, v90
L_kp4_x:
    s_nop 1
    v_max_u32_dpp v128, v128, v128 row_ror:8 row_mask:0xf bank_mask:0xf
    s_nop 1
    v_max_u32_dpp v128, v128, v128 row_ror:4 row_mask:0xf bank_mask:0xf
    s_nop 1
    v_max_u32_dpp v128, v128, v128 row_ror:2 row_mask:0xf bank_mask:0xf
    s_nop 1
    v_max_u32_dpp v128, v128, v128 row_ror:1 row_mask:0xf bank_mask:0xf
    s_nop 0
    v_readlane_b32 s97, v128, 0
    v_readlane_b32 s60, v128, 16
    v_readlane_b32 s61, v128, 32
    v_readlane_b32 s62, v128, 48
    s_max_u32 s97, s97, s60
    s_max_u32 s61, s61, s62
    s_max_u32 s97, s97, s61
    v_mov_b32 v110, s97
    ds_write_b32 v109, v110
    s_and_b32 s60, s97, 2047
    s_lshl_b32 s12, s60, 10
    buffer_load_dwordx4 v[40:43], v4, s[32:35], s12 offen
    s_branch L_fin1
L_fin1a:
    s_lshl3_add_u32 s60, s99, s3
    s_cmp_lg_u32 s60, 2
    s_cbranch_scc1 L_fin1
    v_lshlrev_b32 v128, 7, v0
    s_mov_b64 exec, 0xff
    s_movk_i32 s60, 0x1000
L_ack:
    buffer_load_dword v129, v128, s[36:39], s60 offen sc1
    s_waitcnt vmcnt(0)
    v_cmp_ne_u32 vcc, s59, v129
    s_nop 0
    s_cbranch_vccz L_ack_ok
    s_sleep 1
    s_sub_u32 s90, s90, 1
    s_cbranch_scc0 L_ack
    s_mov_b32 s90, 0
L_ack_ok:
    s_mov_b64 exec, -1
L_fin1:
    s_waitcnt lgkmcnt(0)
    s_barrier
    ds_read_b32 v110, v109
    s_waitcnt lgkmcnt(0)
    v_readfirstlane_b32 s8, v110
    s_nop 0
    s_and_b32 s97, s8, 2047
    s_and_b32 s60, s97, 255
    s_and_b32 s61, s97, 15
    s_and_b32 s62, s97, 7
    s_cselect_b32 s60, s61, s60
    s_cselect_b32 s61, 8, 128
    s_cmp_gt_u32 s60, s61
    s_cselect_b32 s96, 0x80000000, 0
    s_sub_u32 s61, 2048, s97
    s_cmp_lg_u32 s96, 0
    s_cselect_b32 s60, s61, s97
    s_and_b32 s58, s60, 255
    s_lshr_b32 s98, s60, 8
    s_lshr_b32 s60, s58, 4
    s_and_b32 s61, s58, 15
    s_lshl4_add_u32 s9, s61, s60
    s_add_u32 s62, s60, s61
    s_cmp_eq_u32 s61, 8
    s_cselect_b32 s9, s62, s9
    s_cmp_eq_u32 s58, 128
    s_cselect_b32 s9, 0, s9
    s_lshl_b32 s14, s9, 14
    s_lshl_b32 s60, s3, 8
    s_add_u32 s14, s14, s60
    s_add_u32 s14, s14, 0x200000
    v_lshrrev_b32 v96, 1, v2
    v_lshlrev_b32 v96, 8, v96
    v_add_u32 v96, s58, v96
    v_and_b32 v97, 1, v2
    v_lshlrev_b32 v98, 1, v3
    v_mul_u32_u24 v98, v98, v96
    v_cmp_eq_u32 vcc, 0, v97
    v_and_b32 v99, 2047, v98
    v_add_u32 v98, v98, v96
    v_cvt_f32_u32 v99, v99
    v_mul_f32 v99, 0x3a000000, v99
    v_cos_f32 v100, v99
    v_sin_f32 v101, v99
    v_mul_f32 v100, 0.5, v100
    v_mul_f32 v101, 0.5, v101
    v_cndmask_b32_e64 v102, -v101, v100, vcc
    v_cndmask_b32 v103, v100, v101, vcc
    v_cvt_pk_bf16_f32 v144, v102, v103
    v_cvt_pk_bf16_f32 v148, -v103, v102
    v_cndmask_b32 v102, v101, v100, vcc
    v_cndmask_b32_e64 v103, -v100, v101, vcc
    v_cvt_pk_bf16_f32 v145, v102, -v103
    v_cvt_pk_bf16_f32 v149, -v103, -v102
    s_and_b32 s60, s58, 127
    s_cbranch_scc1 L_fin_a10
    v_add_f32 v100, v100, v100
    v_add_f32 v101, v101, v101
    v_cndmask_b32 v102, 0, v100, vcc
    v_sub_f32 v103, v100, v102
    v_cvt_pk_bf16_f32 v100, v102, v103
    v_cndmask_b32 v102, 0, v101, vcc
    v_sub_f32 v103, v101, v102
    v_cvt_pk_bf16_f32 v101, -v102, -v103
    s_cmp_eq_u32 s58, 0
    s_cselect_b32 s60, -1, 0
    s_cselect_b32 s61, 0, -1
    v_and_b32 v144, s60, v100
    v_and_b32 v148, s60, v101
    v_and_b32 v145, s61, v100
    v_and_b32 v149, s61, v101
L_fin_a10:
    v_and_b32 v99, 2047, v98
    v_cvt_f32_u32 v99, v99
    v_mul_f32 v99, 0x3a000000, v99
    v_cos_f32 v100, v99
    v_sin_f32 v101, v99
    v_mul_f32 v100, 0.5, v100
    v_mul_f32 v101, 0.5, v101
    v_cndmask_b32_e64 v102, -v101, v100, vcc
    v_cndmask_b32 v103, v100, v101, vcc
    v_cvt_pk_bf16_f32 v146, v102, v103
    v_cvt_pk_bf16_f32 v150, -v103, v102
    v_cndmask_b32 v102, v101, v100, vcc
    v_cndmask_b32_e64 v103, -v100, v101, vcc
    v_cvt_pk_bf16_f32 v147, v102, -v103
    v_cvt_pk_bf16_f32 v151, -v103, -v102
    s_and_b32 s60, s58, 127
    s_cbranch_scc1 L_fin_a11
    v_add_f32 v100, v100, v100
    v_add_f32 v101, v101, v101
    v_cndmask_b32 v102, 0, v100, vcc
    v_sub_f32 v103, v100, v102
    v_cvt_pk_bf16_f32 v100, v102, v103
    v_cndmask_b32 v102, 0, v101, vcc
    v_sub_f32 v103, v101, v102
    v_cvt_pk_bf16_f32 v101, -v102, -v103
    s_cmp_eq_u32 s58, 0
    s_cselect_b32 s60, -1, 0
    s_cselect_b32 s61, 0, -1
    v_and_b32 v146, s60, v100
    v_and_b32 v150, s60, v101
    v_and_b32 v147, s61, v100
    v_and_b32 v151, s61, v101
L_fin_a11:
    s_cmp_lg_u32 s3, 0
    s_cbranch_scc1 L_fin3
    s_lshl_b32 s60, s98, 4
    s_and_b32 s60, s60, 32
    v_xor_b32 v62, s60, v62
    s_lshl_b32 s60, s98, 11
    s_add_u32 s60, s60, 16384
    v_add_u32 v62, s60, v62
    v_xor_b32 v152, s96, v152
    v_xor_b32 v156, s96, v156
    v_xor_b32 v153, s96, v153
    v_xor_b32 v157, s96, v157
    v_xor_b32 v154, s96, v154
    v_xor_b32 v158, s96, v158
    v_xor_b32 v155, s96, v155
    v_xor_b32 v159, s96, v159
    s_ashr_i32 s60, s8, 31
    s_orn2_b32 s60, 0x80000000, s60
    s_xor_b32 s8, s8, s60
    s_waitcnt vmcnt(0)
    v_dot2_f32_bf16 v32, v40, v28, 0
    v_dot2_f32_bf16 v32, v41, v29, v32
    v_dot2_f32_bf16 v32, v42, v30, v32
    v_dot2_f32_bf16 v32, v43, v31, v32
    s_nop 2
    v_add_f32_dpp v32, v32, v32 row_ror:8 row_mask:0xf bank_mask:0xf
    s_nop 1
    v_add_f32_dpp v32, v32, v32 row_ror:4 row_mask:0xf bank_mask:0xf
    s_nop 1
    v_add_f32_dpp v32, v32, v32 row_ror:2 row_mask:0xf bank_mask:0xf
    s_nop 1
    v_add_f32_dpp v32, v32, v32 row_ror:1 row_mask:0xf bank_mask:0xf
    v_mov_b32 v33, v32
    s_nop 1
    v_permlane32_swap_b32 v32, v33
    v_add_f32 v32, v32, v33
    v_mov_b32 v33, v32
    s_nop 1
    v_permlane16_swap_b32 v32, v33
    v_add_f32 v32, v32, v33
    v_mov_b32 v33, s8
    v_mul_f32 v35, 0xbfb8aa3b, v33
    v_mul_f32 v34, 0xbfb8aa3b, v32
    v_exp_f32 v35, v35
    v_exp_f32 v34, v34
    v_add_f32 v35, 1.0, v35
    v_add_f32 v34, 1.0, v34
    v_rcp_f32 v35, v35
    v_rcp_f32 v34, v34
    v_permlane16_swap_b32 v40, v42
    v_permlane16_swap_b32 v41, v43
    s_bitcmp1_b32 s99, 2
    s_cbranch_scc0 L_fint
    v_mov_b32 v40, v42
    v_mov_b32 v41, v43
L_fint:
    v_sub_f32 v36, 1.0, v34
    v_lshlrev_b32 v216, 16, v40
    v_and_b32 v217, 0xffff0000, v40
    v_pk_mul_f32 v[216:217], v[216:217], v[36:37] op_sel_hi:[1,0]
    v_lshlrev_b32 v218, 16, v41
    v_and_b32 v219, 0xffff0000, v41
    v_pk_mul_f32 v[218:219], v[218:219], v[36:37] op_sel_hi:[1,0]
    v_mul_f32 v38, v35, v36
    v_pk_mul_f32 v[184:185], v[184:185], v[34:35] op_sel_hi:[1,0]
    v_pk_mul_f32 v[186:187], v[186:187], v[34:35] op_sel_hi:[1,0]
    v_pk_mul_f32 v[188:189], v[188:189], v[34:35] op_sel_hi:[1,0]
    v_pk_mul_f32 v[190:191], v[190:191], v[34:35] op_sel_hi:[1,0]
    v_pk_mul_f32 v[192:193], v[192:193], v[34:35] op_sel_hi:[1,0]
    v_pk_mul_f32 v[194:195], v[194:195], v[34:35] op_sel_hi:[1,0]
    v_pk_mul_f32 v[196:197], v[196:197], v[34:35] op_sel_hi:[1,0]
    v_pk_mul_f32 v[198:199], v[198:199], v[34:35] op_sel_hi:[1,0]
L_fin3:
    buffer_load_dwordx4 v[8:11], v5, s[36:39], s14 offen offset:0 sc1
    buffer_load_dwordx4 v[12:15], v5, s[36:39], s14 offen offset:2048 sc1
    s_branch L_fin_pw
L_fin_pl:
    buffer_load_dwordx4 v[8:11], v5, s[36:39], s14 offen offset:0 sc1
    buffer_load_dwordx4 v[12:15], v5, s[36:39], s14 offen offset:2048 sc1
L_fin_pw:
    s_waitcnt vmcnt(0)
    v_swap_b32 v10, v12
    v_swap_b32 v11, v13
    v_xor_b32 v96, v104, v8
    v_xor_b32 v97, v105, v9
    v_mfma_f32_16x16x32_bf16 v[64:67], v[144:147], v[8:11], 0
    v_bitop3_b32 v96, v10, v104, v96 bitop3:0xbe
    v_bitop3_b32 v97, v11, v105, v97 bitop3:0xbe
    v_mfma_f32_16x16x32_bf16 v[68:71], v[148:151], v[8:11], 0
    v_bitop3_b32 v96, v12, v104, v96 bitop3:0xbe
    v_bitop3_b32 v97, v13, v105, v97 bitop3:0xbe
    v_mfma_f32_16x16x32_bf16 v[72:75], v[144:147], v[12:15], 0
    v_bitop3_b32 v96, v14, v104, v96 bitop3:0xbe
    v_bitop3_b32 v97, v15, v105, v97 bitop3:0xbe
    v_mfma_f32_16x16x32_bf16 v[76:79], v[148:151], v[12:15], 0
    v_bitop3_b32 v96, v96, v97, v106 bitop3:0xa8
    v_cmp_ne_u32 vcc, 0, v96
    s_nop 0
    s_cbranch_vccz L_fin_pl_ok
    s_sleep 1
    s_sub_u32 s90, s90, 1
    s_cbranch_scc0 L_fin_pl
    s_mov_b32 s90, 0
L_fin_pl_ok:
    v_cvt_pk_bf16_f32 v16, v64, v68
    v_cvt_pk_bf16_f32 v17, v65, v69
    ds_write2st64_b32 v6, v16, v17 offset0:0 offset1:4
    v_cvt_pk_bf16_f32 v18, v66, v70
    v_cvt_pk_bf16_f32 v19, v67, v71
    ds_write2st64_b32 v6, v18, v19 offset0:8 offset1:12
    v_cvt_pk_bf16_f32 v20, v72, v76
    v_cvt_pk_bf16_f32 v21, v73, v77
    ds_write2st64_b32 v7, v20, v21 offset0:2 offset1:6
    v_cvt_pk_bf16_f32 v22, v74, v78
    v_cvt_pk_bf16_f32 v23, v75, v79
    ds_write2st64_b32 v7, v22, v23 offset0:10 offset1:14
    s_waitcnt lgkmcnt(0)
    s_barrier
    s_cmp_lg_u32 s3, 0
    s_cbranch_scc1 L_pp0
    ds_read_b128 v[16:19], v62 offset:0
    ds_read_b128 v[20:23], v62 offset:1024
    s_waitcnt lgkmcnt(1)
    v_mfma_f32_16x16x32_bf16 v[64:67], v[16:19], v[152:155], 0
    v_mfma_f32_16x16x32_bf16 v[68:71], v[16:19], v[156:159], 0
    s_waitcnt lgkmcnt(0)
    v_mfma_f32_16x16x32_bf16 v[72:75], v[20:23], v[152:155], 0
    v_mfma_f32_16x16x32_bf16 v[76:79], v[20:23], v[156:159], 0
    s_nop 3
    v_pk_mul_f32 v[96:97], v[64:65], v[184:185]
    v_pk_mul_f32 v[100:101], v[68:69], v[184:185]
    v_pk_mul_f32 v[98:99], v[66:67], v[186:187]
    v_pk_mul_f32 v[102:103], v[70:71], v[186:187]
    v_pk_fma_f32 v[96:97], v[68:69], v[188:189], v[96:97]
    v_pk_fma_f32 v[100:101], v[64:65], v[188:189], v[100:101] neg_lo:[1,0,0] neg_hi:[1,0,0]
    v_pk_fma_f32 v[98:99], v[70:71], v[190:191], v[98:99]
    v_pk_fma_f32 v[102:103], v[66:67], v[190:191], v[102:103] neg_lo:[1,0,0] neg_hi:[1,0,0]
    v_cvt_pk_bf16_f32 v112, v96, v100
    v_cvt_pk_bf16_f32 v113, v97, v101
    v_cvt_pk_bf16_f32 v114, v98, v102
    v_cvt_pk_bf16_f32 v115, v99, v103
    s_nop 1
    v_mfma_f32_16x16x32_bf16 v[232:235], v[112:115], v[168:171], v[216:219]
    v_pk_mul_f32 v[96:97], v[72:73], v[192:193]
    v_pk_mul_f32 v[100:101], v[76:77], v[192:193]
    v_pk_mul_f32 v[98:99], v[74:75], v[194:195]
    v_pk_mul_f32 v[102:103], v[78:79], v[194:195]
    v_pk_fma_f32 v[96:97], v[76:77], v[196:197], v[96:97]
    v_pk_fma_f32 v[100:101], v[72:73], v[196:197], v[100:101] neg_lo:[1,0,0] neg_hi:[1,0,0]
    v_pk_fma_f32 v[98:99], v[78:79], v[198:199], v[98:99]
    v_pk_fma_f32 v[102:103], v[74:75], v[198:199], v[102:103] neg_lo:[1,0,0] neg_hi:[1,0,0]
    v_cvt_pk_bf16_f32 v116, v96, v100
    v_cvt_pk_bf16_f32 v117, v97, v101
    v_cvt_pk_bf16_f32 v118, v98, v102
    v_cvt_pk_bf16_f32 v119, v99, v103
    s_nop 1
    v_mfma_f32_16x16x32_bf16 v[232:235], v[116:119], v[172:175], v[232:235]
    v_lshlrev_b32 v4, 5, v2
    v_lshl_add_u32 v4, v3, 3, v4
    s_lshr_b32 s61, s99, 2
    s_lshl_b32 s61, s61, 9
    s_add_u32 s12, s12, s61
    s_branch L_fin5
L_pp0:
    v_mov_b32 v8, 0
    v_mov_b32 v9, 0
    v_mov_b32 v10, 0
    v_mov_b32 v11, 0
    buffer_atomic_or_x2 v[8:9], v246, s[36:39], s7 offen offset:0 sc0 sc1
    buffer_atomic_or_x2 v[10:11], v246, s[36:39], s7 offen offset:512 sc0 sc1
    s_sleep 4
    v_mov_b32 v12, 0
    v_mov_b32 v13, 0
    v_mov_b32 v14, 0
    v_mov_b32 v15, 0
    buffer_atomic_or_x2 v[12:13], v246, s[36:39], s7 offen offset:0 sc0 sc1
    buffer_atomic_or_x2 v[14:15], v246, s[36:39], s7 offen offset:512 sc0 sc1
    s_sleep 4
    v_mov_b32 v16, 0
    v_mov_b32 v17, 0
    v_mov_b32 v18, 0
    v_mov_b32 v19, 0
    buffer_atomic_or_x2 v[16:17], v246, s[36:39], s7 offen offset:0 sc0 sc1
    buffer_atomic_or_x2 v[18:19], v246, s[36:39], s7 offen offset:512 sc0 sc1
L_pa:
    s_waitcnt vmcnt(4)
    v_xor_b32 v96, v104, v8
    v_xor_b32 v97, v105, v9
    v_bitop3_b32 v96, v10, v104, v96 bitop3:0xbe
    v_bitop3_b32 v97, v11, v105, v97 bitop3:0xbe
    v_bitop3_b32 v96, v96, v97, v106 bitop3:0xa8
    v_cmp_ne_u32 vcc, 0, v96
    s_nop 0
    s_cbranch_vccz L_pa_d0
    v_mov_b32 v8, 0
    v_mov_b32 v9, 0
    v_mov_b32 v10, 0
    v_mov_b32 v11, 0
    buffer_atomic_or_x2 v[8:9], v246, s[36:39], s7 offen offset:0 sc0 sc1
    buffer_atomic_or_x2 v[10:11], v246, s[36:39], s7 offen offset:512 sc0 sc1
    s_waitcnt vmcnt(4)
    v_xor_b32 v96, v104, v12
    v_xor_b32 v97, v105, v13
    v_bitop3_b32 v96, v14, v104, v96 bitop3:0xbe
    v_bitop3_b32 v97, v15, v105, v97 bitop3:0xbe
    v_bitop3_b32 v96, v96, v97, v106 bitop3:0xa8
    v_cmp_ne_u32 vcc, 0, v96
    s_nop 0
    s_cbranch_vccz L_pa_d1
    v_mov_b32 v12, 0
    v_mov_b32 v13, 0
    v_mov_b32 v14, 0
    v_mov_b32 v15, 0
    buffer_atomic_or_x2 v[12:13], v246, s[36:39], s7 offen offset:0 sc0 sc1
    buffer_atomic_or_x2 v[14:15], v246, s[36:39], s7 offen offset:512 sc0 sc1
    s_waitcnt vmcnt(4)
    v_xor_b32 v96, v104, v16
    v_xor_b32 v97, v105, v17
    v_bitop3_b32 v96, v18, v104, v96 bitop3:0xbe
    v_bitop3_b32 v97, v19, v105, v97 bitop3:0xbe
    v_bitop3_b32 v96, v96, v97, v106 bitop3:0xa8
    v_cmp_ne_u32 vcc, 0, v96
    s_nop 0
    s_cbranch_vccz L_pa_d2
    v_mov_b32 v16, 0
    v_mov_b32 v17, 0
    v_mov_b32 v18, 0
    v_mov_b32 v19, 0
    buffer_atomic_or_x2 v[16:17], v246, s[36:39], s7 offen offset:0 sc0 sc1
    buffer_atomic_or_x2 v[18:19], v246, s[36:39], s7 offen offset:512 sc0 sc1
    s_sub_u32 s90, s90, 1
    s_cbranch_scc0 L_pa
    s_waitcnt vmcnt(0)
L_pa_d0:
    v_lshlrev_b32 v32, 16, v8
    v_and_b32 v33, 0xffff0000, v8
    v_lshlrev_b32 v34, 16, v9
    v_and_b32 v35, 0xffff0000, v9
    v_lshlrev_b32 v36, 16, v10
    v_and_b32 v37, 0xffff0000, v10
    v_lshlrev_b32 v38, 16, v11
    v_and_b32 v39, 0xffff0000, v11
    s_branch L_pa_x
L_pa_d1:
    v_lshlrev_b32 v32, 16, v12
    v_and_b32 v33, 0xffff0000, v12
    v_lshlrev_b32 v34, 16, v13
    v_and_b32 v35, 0xffff0000, v13
    v_lshlrev_b32 v36, 16, v14
    v_and_b32 v37, 0xffff0000, v14
    v_lshlrev_b32 v38, 16, v15
    v_and_b32 v39, 0xffff0000, v15
    s_branch L_pa_x
L_pa_d2:
    v_lshlrev_b32 v32, 16, v16
    v_and_b32 v33, 0xffff0000, v16
    v_lshlrev_b32 v34, 16, v17
    v_and_b32 v35, 0xffff0000, v17
    v_lshlrev_b32 v36, 16, v18
    v_and_b32 v37, 0xffff0000, v18
    v_lshlrev_b32 v38, 16, v19
    v_and_b32 v39, 0xffff0000, v19
L_pa_x:
    v_pk_add_f32 v[32:33], v[32:33], v[36:37]
    v_pk_add_f32 v[34:35], v[34:35], v[38:39]
    s_nop 0
    v_permlane32_swap_b32 v32, v33
    v_permlane32_swap_b32 v34, v35
    v_add_f32 v32, v32, v33
    v_add_f32 v34, v34, v35
    s_nop 1
    v_permlane16_swap_b32 v32, v34
    v_add_f32 v32, v32, v34
    ds_write_b32 v108, v32
    s_waitcnt lgkmcnt(0)
L_fin5:
    s_barrier
    s_cmp_lg_u32 s3, 0
    s_cbranch_scc1 L_fin7
    ds_read_b128 v[64:67], v111 offset:43264
    ds_read_b128 v[68:71], v111 offset:43520
    ds_read_b128 v[72:75], v111 offset:43776
    ds_read_b128 v[76:79], v111 offset:44032
    ds_read_b128 v[80:83], v111 offset:44288
    ds_read_b128 v[84:87], v111 offset:44544
    ds_read_b128 v[88:91], v111 offset:44800
    s_and_b32 s61, s99, 3
    s_lshl_b32 s61, s61, 2
    s_waitcnt lgkmcnt(0)
    v_pk_add_f32 v[68:69], v[68:69], v[72:73]
    v_pk_add_f32 v[70:71], v[70:71], v[74:75]
    v_pk_add_f32 v[76:77], v[76:77], v[80:81]
    v_pk_add_f32 v[78:79], v[78:79], v[82:83]
    v_pk_add_f32 v[84:85], v[84:85], v[88:89]
    v_pk_add_f32 v[86:87], v[86:87], v[90:91]
    v_pk_add_f32 v[64:65], v[64:65], v[68:69]
    v_pk_add_f32 v[76:77], v[76:77], v[84:85]
    v_pk_add_f32 v[66:67], v[66:67], v[70:71]
    v_pk_add_f32 v[78:79], v[78:79], v[86:87]
    v_pk_add_f32 v[64:65], v[64:65], v[76:77]
    v_pk_add_f32 v[66:67], v[66:67], v[78:79]
    v_pk_fma_f32 v[64:65], v[64:65], v[38:39], v[232:233] op_sel_hi:[1,0,1]
    v_pk_fma_f32 v[66:67], v[66:67], v[38:39], v[234:235] op_sel_hi:[1,0,1]
    v_cvt_pk_bf16_f32 v16, v64, v65
    v_cvt_pk_bf16_f32 v17, v66, v67
    s_lshl_b32 exec_lo, 0x000f000f, s61
    s_mov_b32 exec_hi, exec_lo
    buffer_store_dwordx2 v[16:17], v4, s[40:43], s12 offen sc1
    s_cmp_lg_u32 s99, 0
    s_cbranch_scc1 L_fin7
    s_mov_b64 exec, 1
    v_mov_b32 v20, 0
    v_mov_b32 v21, s59
    buffer_store_dword v21, v20, s[36:39], 0 offen sc1
L_fin7:
    s_endpgm
L_end:
    s_endpgm
.p2align 7
.type L_tab,@object
L_tab:
.long 0x3f80, 0x3f80, 0x3f80, 0x3f80, 0x3f80, 0x3ec43f6d, 0x3f353f35, 0x3f6d3ec4
.long 0x3f80, 0x3f353f35, 0x3f800000, 0x3f35bf35, 0x3f80, 0x3f6d3ec4, 0x3f35bf35, 0xbec4bf6d
.long 0x3f80, 0x3f800000, 0xbf80, 0xbf800000, 0x3f80, 0x3f6dbec4, 0xbf35bf35, 0xbec43f6d
.long 0x3f80, 0x3f35bf35, 0xbf800000, 0x3f353f35, 0x3f80, 0x3ec4bf6d, 0xbf353f35, 0x3f6dbec4
.long 0x3f80, 0xbf80, 0x3f80, 0xbf80, 0x3f80, 0xbec4bf6d, 0x3f353f35, 0xbf6dbec4
.long 0x3f80, 0xbf35bf35, 0x3f800000, 0xbf353f35, 0x3f80, 0xbf6dbec4, 0x3f35bf35, 0x3ec43f6d
.long 0x3f80, 0xbf800000, 0xbf80, 0x3f800000, 0x3f80, 0xbf6d3ec4, 0xbf35bf35, 0x3ec4bf6d
.long 0x3f80, 0xbf353f35, 0xbf800000, 0xbf35bf35, 0x3f80, 0xbec43f6d, 0xbf353f35, 0xbf6d3ec4
.long 0x3f80, 0x3f80, 0x3f80, 0x3f80, 0x3f800000, 0x3f6dbec4, 0x3f35bf35, 0x3ec4bf6d
.long 0xbf80, 0xbf35bf35, 0xbf800000, 0xbf353f35, 0xbf800000, 0xbec43f6d, 0x3f353f35, 0x3f6dbec4
.long 0x3f80, 0x3f800000, 0xbf80, 0xbf800000, 0x3f800000, 0xbec4bf6d, 0xbf353f35, 0x3f6d3ec4
.long 0xbf80, 0xbf353f35, 0x3f800000, 0xbf35bf35, 0xbf800000, 0x3f6d3ec4, 0xbf35bf35, 0x3ec43f6d
.long 0x3f80, 0xbf80, 0x3f80, 0xbf80, 0x3f800000, 0xbf6d3ec4, 0x3f35bf35, 0xbec43f6d
.long 0xbf80, 0x3f353f35, 0xbf800000, 0x3f35bf35, 0xbf800000, 0x3ec4bf6d, 0x3f353f35, 0xbf6d3ec4
.long 0x3f80, 0xbf800000, 0xbf80, 0x3f800000, 0x3f800000, 0x3ec43f6d, 0xbf353f35, 0xbf6dbec4
.long 0xbf80, 0x3f35bf35, 0x3f800000, 0x3f353f35, 0xbf800000, 0xbf6dbec4, 0xbf35bf35, 0xbec4bf6d
.long 0x3f80, 0x3f80, 0x3f80, 0x3f80, 0xbf80, 0xbec4bf6d, 0xbf35bf35, 0xbf6dbec4
.long 0x3f80, 0x3f353f35, 0x3f800000, 0x3f35bf35, 0xbf80, 0xbf6dbec4, 0xbf353f35, 0x3ec43f6d
.long 0x3f80, 0x3f800000, 0xbf80, 0xbf800000, 0xbf80, 0xbf6d3ec4, 0x3f353f35, 0x3ec4bf6d
.long 0x3f80, 0x3f35bf35, 0xbf800000, 0x3f353f35, 0xbf80, 0xbec43f6d, 0x3f35bf35, 0xbf6d3ec4
.long 0x3f80, 0xbf80, 0x3f80, 0xbf80, 0xbf80, 0x3ec43f6d, 0xbf35bf35, 0x3f6d3ec4
.long 0x3f80, 0xbf35bf35, 0x3f800000, 0xbf353f35, 0xbf80, 0x3f6d3ec4, 0xbf353f35, 0xbec4bf6d
.long 0x3f80, 0xbf800000, 0xbf80, 0x3f800000, 0xbf80, 0x3f6dbec4, 0x3f353f35, 0xbec43f6d
.long 0x3f80, 0xbf353f35, 0xbf800000, 0xbf35bf35, 0xbf80, 0x3ec4bf6d, 0x3f35bf35, 0x3f6dbec4
.long 0x3f80, 0x3f80, 0x3f80, 0x3f80, 0xbf800000, 0xbf6d3ec4, 0xbf353f35, 0xbec43f6d
.long 0xbf80, 0xbf35bf35, 0xbf800000, 0xbf353f35, 0x3f800000, 0x3ec4bf6d, 0xbf35bf35, 0xbf6d3ec4
.long 0x3f80, 0x3f800000, 0xbf80, 0xbf800000, 0xbf800000, 0x3ec43f6d, 0x3f35bf35, 0xbf6dbec4
.long 0xbf80, 0xbf353f35, 0x3f800000, 0xbf35bf35, 0x3f800000, 0xbf6dbec4, 0x3f353f35, 0xbec4bf6d
.long 0x3f80, 0xbf80, 0x3f80, 0xbf80, 0xbf800000, 0x3f6dbec4, 0xbf353f35, 0x3ec4bf6d
.long 0xbf80, 0x3f353f35, 0xbf800000, 0x3f35bf35, 0x3f800000, 0xbec43f6d, 0xbf35bf35, 0x3f6dbec4
.long 0x3f80, 0xbf800000, 0xbf80, 0x3f800000, 0xbf800000, 0xbec4bf6d, 0x3f35bf35, 0x3f6d3ec4
.long 0xbf80, 0x3f35bf35, 0x3f800000, 0x3f353f35, 0x3f800000, 0x3f6d3ec4, 0x3f353f35, 0x3ec43f6d
.long 0x3f808000, 0x3f808000, 0x3f808000, 0x3f808000, 0x3f808000, 0x3f6dbec4, 0x3f35bf35, 0x3ec4bf6d
.long 0x3f808000, 0x3f35bf35, 0xbf80, 0xbf35bf35, 0x3f808000, 0x3ec4bf6d, 0xbf35bf35, 0xbf6d3ec4
.long 0x3f808000, 0xbf80, 0xbf808000, 0x3f80, 0x3f808000, 0xbec4bf6d, 0xbf353f35, 0x3f6d3ec4
.long 0x3f808000, 0xbf35bf35, 0x3f80, 0x3f35bf35, 0x3f808000, 0xbf6dbec4, 0x3f353f35, 0xbec4bf6d
.long 0x3f808000, 0xbf808000, 0x3f808000, 0xbf808000, 0x3f808000, 0xbf6d3ec4, 0x3f35bf35, 0xbec43f6d
.long 0x3f808000, 0xbf353f35, 0xbf80, 0x3f353f35, 0x3f808000, 0xbec43f6d, 0xbf35bf35, 0x3f6dbec4
.long 0x3f808000, 0x3f80, 0xbf808000, 0xbf80, 0x3f808000, 0x3ec43f6d, 0xbf353f35, 0xbf6dbec4
.long 0x3f808000, 0x3f353f35, 0x3f80, 0xbf353f35, 0x3f808000, 0x3f6d3ec4, 0x3f353f35, 0x3ec43f6d
.long 0x3f808000, 0x3f808000, 0x3f808000, 0x3f808000, 0xbf80, 0xbec4bf6d, 0xbf35bf35, 0xbf6dbec4
.long 0xbf808000, 0xbf353f35, 0x3f80, 0x3f353f35, 0x3f80, 0x3f6d3ec4, 0x3f35bf35, 0xbec4bf6d
.long 0x3f808000, 0xbf80, 0xbf808000, 0x3f80, 0xbf80, 0xbf6d3ec4, 0x3f353f35, 0x3ec4bf6d
.long 0xbf808000, 0x3f353f35, 0xbf80, 0xbf353f35, 0x3f80, 0x3ec4bf6d, 0xbf353f35, 0x3f6dbec4
.long 0x3f808000, 0xbf808000, 0x3f808000, 0xbf808000, 0xbf80, 0x3ec43f6d, 0xbf35bf35, 0x3f6d3ec4
.long 0xbf808000, 0x3f35bf35, 0x3f80, 0xbf35bf35, 0x3f80, 0xbf6dbec4, 0x3f35bf35, 0x3ec43f6d
.long 0x3f808000, 0x3f80, 0xbf808000, 0xbf80, 0xbf80, 0x3f6dbec4, 0x3f353f35, 0xbec43f6d
.long 0xbf808000, 0xbf35bf35, 0xbf80, 0x3f35bf35, 0x3f80, 0xbec43f6d, 0xbf353f35, 0xbf6d3ec4
.long 0x3f808000, 0x3f808000, 0x3f808000, 0x3f808000, 0xbf808000, 0xbf6d3ec4, 0xbf353f35, 0xbec43f6d
.long 0x3f808000, 0x3f35bf35, 0xbf80, 0xbf35bf35, 0xbf808000, 0xbec43f6d, 0x3f353f35, 0x3f6dbec4
.long 0x3f808000, 0xbf80, 0xbf808000, 0x3f80, 0xbf808000, 0x3ec43f6d, 0x3f35bf35, 0xbf6dbec4
.long 0x3f808000, 0xbf35bf35, 0x3f80, 0x3f35bf35, 0xbf808000, 0x3f6d3ec4, 0xbf35bf35, 0x3ec43f6d
.long 0x3f808000, 0xbf808000, 0x3f808000, 0xbf808000, 0xbf808000, 0x3f6dbec4, 0xbf353f35, 0x3ec4bf6d
.long 0x3f808000, 0xbf353f35, 0xbf80, 0x3f353f35, 0xbf808000, 0x3ec4bf6d, 0x3f353f35, 0xbf6d3ec4
.long 0x3f808000, 0x3f80, 0xbf808000, 0xbf80, 0xbf808000, 0xbec4bf6d, 0x3f35bf35, 0x3f6d3ec4
.long 0x3f808000, 0x3f353f35, 0x3f80, 0xbf353f35, 0xbf808000, 0xbf6dbec4, 0xbf35bf35, 0xbec4bf6d
.long 0x3f808000, 0x3f808000, 0x3f808000, 0x3f808000, 0x3f80, 0x3ec43f6d, 0x3f353f35, 0x3f6d3ec4
.long 0xbf808000, 0xbf353f35, 0x3f80, 0x3f353f35, 0xbf80, 0xbf6dbec4, 0xbf353f35, 0x3ec43f6d
.long 0x3f808000, 0xbf80, 0xbf808000, 0x3f80, 0x3f80, 0x3f6dbec4, 0xbf35bf35, 0xbec43f6d
.long 0xbf808000, 0x3f353f35, 0xbf80, 0xbf353f35, 0xbf80, 0xbec43f6d, 0x3f35bf35, 0xbf6d3ec4
.long 0x3f808000, 0xbf808000, 0x3f808000, 0xbf808000, 0x3f80, 0xbec4bf6d, 0x3f353f35, 0xbf6dbec4
.long 0xbf808000, 0x3f35bf35, 0x3f80, 0xbf35bf35, 0xbf80, 0x3f6d3ec4, 0xbf353f35, 0xbec4bf6d
.long 0x3f808000, 0x3f80, 0xbf808000, 0xbf80, 0x3f80, 0xbf6d3ec4, 0xbf35bf35, 0x3ec4bf6d
.long 0xbf808000, 0xbf35bf35, 0xbf80, 0x3f35bf35, 0xbf80, 0x3ec4bf6d, 0x3f35bf35, 0x3f6dbec4
.long 0x3f800000, 0x3f800000, 0x3f800000, 0x3f800000, 0x3f800000, 0x3f7fec43, 0x3f7fb10f, 0x3f7f4e6d
.long 0x3f800000, 0x3f7fb10f, 0x3f7ec46d, 0x3f7d3aac, 0x3f800000, 0x3f7f4e6d, 0x3f7d3aac, 0x3f79c79d
.long 0x3f800000, 0x3f7ec46d, 0x3f7b14be, 0x3f74fa0b, 0x3f800000, 0x3f7e1324, 0x3f7853f8, 0x3f6ed89e
.long 0x3f800000, 0x3f7d3aac, 0x3f74fa0b, 0x3f676bd8, 0x3f800000, 0x3f7c3b28, 0x3f710908, 0x3f5ebe05
.long 0x3f800000, 0x3f7b14be, 0x3f6c835e, 0x3f54db31, 0x3f800000, 0x3f79c79d, 0x3f676bd8, 0x3f49d112
.long 0x3f800000, 0x3f7853f8, 0x3f61c598, 0x3f3daef9, 0x3f800000, 0x3f76ba07, 0x3f5b941a, 0x3f3085bb
.long 0x3f800000, 0x3f74fa0b, 0x3f54db31, 0x3f226799, 0x3f800000, 0x3f731447, 0x3f4d9f02, 0x3f13682a
.long 0x3f800000, 0x3f710908, 0x3f45e403, 0x3f039c3d, 0x3f800000, 0x3f6ed89e, 0x3f3daef9, 0x3ee63375
.long 0x3f800000, 0x3f800000, 0x3f800000, 0x3f800000, 0x3f7ec46d, 0x3f7e1324, 0x3f7d3aac, 0x3f7c3b28
.long 0x3f7b14be, 0x3f7853f8, 0x3f74fa0b, 0x3f710908, 0x3f74fa0b, 0x3f6ed89e, 0x3f676bd8, 0x3f5ebe05
.long 0x3f6c835e, 0x3f61c598, 0x3f54db31, 0x3f45e403, 0x3f61c598, 0x3f514d3d, 0x3f3daef9, 0x3f273656
.long 0x3f54db31, 0x3f3daef9, 0x3f226799, 0x3f039c3d, 0x3f45e403, 0x3f273656, 0x3f039c3d, 0x3eb8442a
.long 0x3f3504f3, 0x3f0e39da, 0x3ec3ef15, 0x3e47c5c2, 0x3f226799, 0x3ee63375, 0x3e78cfcc, 0x3cc90ab0
.long 0x3f0e39da, 0x3eac7cd4, 0x3dc8bd36, 0xbe164083, 0x3ef15aea, 0x3e605c13, 0xbd48fb30, 0xbea09ae5
.long 0x3ec3ef15, 0x3dc8bd36, 0xbe47c5c2, 0xbef15aea, 0x3e94a031, 0xbcc90ab0, 0xbeac7cd4, 0xbf1d7fd1
.long 0x3e47c5c2, 0xbe164083, 0xbef15aea, 0xbf3daef9, 0x3dc8bd36, 0xbe888e93, 0xbf187fc0, 0xbf584853
.long 0x3f800000, 0x3f800000, 0x3f800000, 0x3f800000, 0x3f7b14be, 0x3f79c79d, 0x3f7853f8, 0x3f76ba07
.long 0x3f6c835e, 0x3f676bd8, 0x3f61c598, 0x3f5b941a, 0x3f54db31, 0x3f49d112, 0x3f3daef9, 0x3f3085bb
.long 0x3f3504f3, 0x3f226799, 0x3f0e39da, 0x3ef15aea, 0x3f0e39da, 0x3ee63375, 0x3eac7cd4, 0x3e605c13
.long 0x3ec3ef15, 0x3e78cfcc, 0x3dc8bd36, 0xbd48fb30, 0x3e47c5c2, 0x3cc90ab0, 0xbe164083, 0xbea09ae5
.long 0x0, 0xbe47c5c2, 0xbec3ef15, 0xbf0e39da, 0xbe47c5c2, 0xbecf7bca, 0xbf187fc0, 0xbf41d870
.long 0xbec3ef15, 0xbf187fc0, 0xbf45e403, 0xbf676bd8, 0xbf0e39da, 0xbf41d870, 0xbf676bd8, 0xbf7c3b28
.long 0xbf3504f3, 0xbf61c598, 0xbf7b14be, 0xbf7ec46d, 0xbf54db31, 0xbf76ba07, 0xbf7fb10f, 0xbf6ed89e
.long 0xbf6c835e, 0xbf7fb10f, 0xbf74fa0b, 0xbf4d9f02, 0xbf7b14be, 0xbf7c3b28, 0xbf5b941a, 0xbf1d7fd1
.long 0x3f800000, 0x3f800000, 0x3f800000, 0x3f800000, 0x3f74fa0b, 0x3f731447, 0x3f710908, 0x3f6ed89e
.long 0x3f54db31, 0x3f4d9f02, 0x3f45e403, 0x3f3daef9, 0x3f226799, 0x3f13682a, 0x3f039c3d, 0x3ee63375
.long 0x3ec3ef15, 0x3e94a031, 0x3e47c5c2, 0x3dc8bd36, 0x3dc8bd36, 0xbcc90ab0, 0xbe164083, 0xbe888e93
.long 0xbe47c5c2, 0xbeac7cd4, 0xbef15aea, 0xbf187fc0, 0xbef15aea, 0xbf1d7fd1, 0xbf3daef9, 0xbf584853
.long 0xbf3504f3, 0xbf54db31, 0xbf6c835e, 0xbf7b14be, 0xbf61c598, 0xbf76ba07, 0xbf7fb10f, 0xbf7c3b28
.long 0xbf7b14be, 0xbf7fb10f, 0xbf74fa0b, 0xbf5b941a, 0xbf7ec46d, 0xbf6ed89e, 0xbf4d9f02, 0xbf1d7fd1
.long 0xbf6c835e, 0xbf45e403, 0xbf0e39da, 0xbe94a031, 0xbf45e403, 0xbf08f59b, 0xbe78cfcc, 0x3d96a905
.long 0xbf0e39da, 0xbe78cfcc, 0x3dc8bd36, 0x3edae880, 0xbe94a031, 0x3d96a905, 0x3edae880, 0x3f396842
.long 0x0, 0x0, 0x0, 0x0, 0x0, 0x3cc90ab0, 0x3d48fb30, 0x3d96a905
.long 0x0, 0x3d48fb30, 0x3dc8bd36, 0x3e164083, 0x0, 0x3d96a905, 0x3e164083, 0x3e605c13
.long 0x0, 0x3dc8bd36, 0x3e47c5c2, 0x3e94a031, 0x0, 0x3dfab273, 0x3e78cfcc, 0x3eb8442a
.long 0x0, 0x3e164083, 0x3e94a031, 0x3edae880, 0x0, 0x3e2f10a2, 0x3eac7cd4, 0x3efc5d27
.long 0x0, 0x3e47c5c2, 0x3ec3ef15, 0x3f0e39da, 0x0, 0x3e605c13, 0x3edae880, 0x3f1d7fd1
.long 0x0, 0x3e78cfcc, 0x3ef15aea, 0x3f2beb4a, 0x0, 0x3e888e93, 0x3f039c3d, 0x3f396842
.long 0x0, 0x3e94a031, 0x3f0e39da, 0x3f45e403, 0x0, 0x3ea09ae5, 0x3f187fc0, 0x3f514d3d
.long 0x0, 0x3eac7cd4, 0x3f226799, 0x3f5b941a, 0x0, 0x3eb8442a, 0x3f2beb4a, 0x3f64aa59
.long 0x0, 0x0, 0x0, 0x0, 0x3dc8bd36, 0x3dfab273, 0x3e164083, 0x3e2f10a2
.long 0x3e47c5c2, 0x3e78cfcc, 0x3e94a031, 0x3eac7cd4, 0x3e94a031, 0x3eb8442a, 0x3edae880, 0x3efc5d27
.long 0x3ec3ef15, 0x3ef15aea, 0x3f0e39da, 0x3f226799, 0x3ef15aea, 0x3f13682a, 0x3f2beb4a, 0x3f41d870
.long 0x3f0e39da, 0x3f2beb4a, 0x3f45e403, 0x3f5b941a, 0x3f226799, 0x3f41d870, 0x3f5b941a, 0x3f6ed89e
.long 0x3f3504f3, 0x3f54db31, 0x3f6c835e, 0x3f7b14be, 0x3f45e403, 0x3f64aa59, 0x3f7853f8, 0x3f7fec43
.long 0x3f54db31, 0x3f710908, 0x3f7ec46d, 0x3f7d3aac, 0x3f61c598, 0x3f79c79d, 0x3f7fb10f, 0x3f731447
.long 0x3f6c835e, 0x3f7ec46d, 0x3f7b14be, 0x3f61c598, 0x3f74fa0b, 0x3f7fec43, 0x3f710908, 0x3f49d112
.long 0x3f7b14be, 0x3f7d3aac, 0x3f61c598, 0x3f2beb4a, 0x3f7ec46d, 0x3f76ba07, 0x3f4d9f02, 0x3f08f59b
.long 0x0, 0x0, 0x0, 0x0, 0x3e47c5c2, 0x3e605c13, 0x3e78cfcc, 0x3e888e93
.long 0x3ec3ef15, 0x3edae880, 0x3ef15aea, 0x3f039c3d, 0x3f0e39da, 0x3f1d7fd1, 0x3f2beb4a, 0x3f396842
.long 0x3f3504f3, 0x3f45e403, 0x3f54db31, 0x3f61c598, 0x3f54db31, 0x3f64aa59, 0x3f710908, 0x3f79c79d
.long 0x3f6c835e, 0x3f7853f8, 0x3f7ec46d, 0x3f7fb10f, 0x3f7b14be, 0x3f7fec43, 0x3f7d3aac, 0x3f731447
.long 0x3f800000, 0x3f7b14be, 0x3f6c835e, 0x3f54db31, 0x3f7b14be, 0x3f6a09a7, 0x3f4d9f02, 0x3f273656
.long 0x3f6c835e, 0x3f4d9f02, 0x3f226799, 0x3edae880, 0x3f54db31, 0x3f273656, 0x3edae880, 0x3e2f10a2
.long 0x3f3504f3, 0x3ef15aea, 0x3e47c5c2, 0xbdc8bd36, 0x3f0e39da, 0x3e888e93, 0xbd48fb30, 0xbeb8442a
.long 0x3ec3ef15, 0x3d48fb30, 0xbe94a031, 0xbf187fc0, 0x3e47c5c2, 0xbe2f10a2, 0xbf039c3d, 0xbf49d112
.long 0x0, 0x0, 0x0, 0x0, 0x3e94a031, 0x3ea09ae5, 0x3eac7cd4, 0x3eb8442a
.long 0x3f0e39da, 0x3f187fc0, 0x3f226799, 0x3f2beb4a, 0x3f45e403, 0x3f514d3d, 0x3f5b941a, 0x3f64aa59
.long 0x3f6c835e, 0x3f74fa0b, 0x3f7b14be, 0x3f7ec46d, 0x3f7ec46d, 0x3f7fec43, 0x3f7d3aac, 0x3f76ba07
.long 0x3f7b14be, 0x3f710908, 0x3f61c598, 0x3f4d9f02, 0x3f61c598, 0x3f49d112, 0x3f2beb4a, 0x3f08f59b
.long 0x3f3504f3, 0x3f0e39da, 0x3ec3ef15, 0x3e47c5c2, 0x3ef15aea, 0x3e888e93, 0x3d48fb30, 0xbe2f10a2
.long 0x3e47c5c2, 0xbd48fb30, 0xbe94a031, 0xbf039c3d, 0xbdc8bd36, 0xbeb8442a, 0xbf187fc0, 0xbf49d112
.long 0xbec3ef15, 0xbf226799, 0xbf54db31, 0xbf74fa0b, 0xbf226799, 0xbf584853, 0xbf7853f8, 0xbf7f4e6d
.long 0xbf54db31, 0xbf7853f8, 0xbf7ec46d, 0xbf676bd8, 0xbf74fa0b, 0xbf7f4e6d, 0xbf676bd8, 0xbf3085bb
.long 0x3f800000, 0x3f800000, 0x3f800000, 0x3f800000, 0x3f7ffb11, 0x3f7fd397, 0x3f7f84ab, 0x3f7f0e58
.long 0x3f7fec43, 0x3f7f4e6d, 0x3f7e1324, 0x3f7c3b28, 0x3f7fd397, 0x3f7e70b0, 0x3f7baccd, 0x3f778bc5
.long 0x3f7fb10f, 0x3f7d3aac, 0x3f7853f8, 0x3f710908, 0x3f7f84ab, 0x3f7baccd, 0x3f740bdd, 0x3f68bf3c
.long 0x3f7f4e6d, 0x3f79c79d, 0x3f6ed89e, 0x3f5ebe05, 0x3f7f0e58, 0x3f778bc5, 0x3f68bf3c, 0x3f531849
.long 0x3f7ec46d, 0x3f74fa0b, 0x3f61c598, 0x3f45e403, 0x3f7e70b0, 0x3f721352, 0x3f59f26a, 0x3f373a23
.long 0x3f7e1324, 0x3f6ed89e, 0x3f514d3d, 0x3f273656, 0x3f7dabcc, 0x3f6b4b0c, 0x3f47de65, 0x3f15f6d9
.long 0x3f7d3aac, 0x3f676bd8, 0x3f3daef9, 0x3f039c3d, 0x3f7cbfc9, 0x3f633c5a, 0x3f32c8c9, 0x3ee0924f
.long 0x3f7c3b28, 0x3f5ebe05, 0x3f273656, 0x3eb8442a, 0x3f7baccd, 0x3f59f26a, 0x3f1b02c6, 0x3e8e9a22
.long 0x3f800000, 0x3f800000, 0x3f800000, 0x3f800000, 0x3f7e70b0, 0x3f7dabcc, 0x3f7cbfc9, 0x3f7baccd
.long 0x3f79c79d, 0x3f76ba07, 0x3f731447, 0x3f6ed89e, 0x3f721352, 0x3f6b4b0c, 0x3f633c5a, 0x3f59f26a
.long 0x3f676bd8, 0x3f5b941a, 0x3f4d9f02, 0x3f3daef9, 0x3f59f26a, 0x3f47de65, 0x3f32c8c9, 0x3f1b02c6
.long 0x3f49d112, 0x3f3085bb, 0x3f13682a, 0x3ee63375, 0x3f373a23, 0x3f15f6d9, 0x3ee0924f, 0x3e8e9a22
.long 0x3f226799, 0x3ef15aea, 0x3e94a031, 0x3dc8bd36, 0x3f0b9a6b, 0x3eb263ef, 0x3e09cf86, 0xbdafb680
.long 0x3ee63375, 0x3e605c13, 0xbcc90ab0, 0xbe888e93, 0x3eb263ef, 0x3dafb680, 0xbe3b6ecf, 0xbee0924f
.long 0x3e78cfcc, 0xbd48fb30, 0xbeac7cd4, 0xbf187fc0, 0x3e09cf86, 0xbe3b6ecf, 0xbef6e0cb, 0xbf3b8f3b
.long 0x3cc90ab0, 0xbea09ae5, 0xbf1d7fd1, 0xbf584853, 0xbdafb680, 0xbee0924f, 0xbf3b8f3b, 0xbf6db293
.long 0x3f800000, 0x3f800000, 0x3f800000, 0x3f800000, 0x3f7a7302, 0x3f791298, 0x3f778bc5, 0x3f75dec6
.long 0x3f6a09a7, 0x3f64aa59, 0x3f5ebe05, 0x3f584853, 0x3f4f7a1f, 0x3f43e200, 0x3f373a23, 0x3f299415
.long 0x3f2beb4a, 0x3f187fc0, 0x3f039c3d, 0x3edae880, 0x3f00e7e4, 0x3ec9b953, 0x3e8e9a22, 0x3e22abb6
.long 0x3ea09ae5, 0x3e2f10a2, 0x3cc90ab0, 0xbdfab273, 0x3de1bc2e, 0xbd7b2b74, 0xbe6c9a7f, 0xbec9b953
.long 0xbdc8bd36, 0xbe94a031, 0xbef15aea, 0xbf226799, 0xbe9aa086, 0xbf00e7e4, 0xbf2e3bde, 0xbf531849
.long 0xbefc5d27, 0xbf3085bb, 0xbf584853, 0xbf731447, 0xbf299415, 0xbf5695e5, 0xbf740bdd, 0xbf7fd397
.long 0xbf4d9f02, 0xbf710908, 0xbf7fb10f, 0xbf7853f8, 0xbf68bf3c, 0xbf7e70b0, 0xbf7a7302, 0xbf5d2d53
.long 0xbf79c79d, 0xbf7e1324, 0xbf64aa59, 0xbf3085bb, 0xbf7ffb11, 0xbf6ff573, 0xbf3fc767, 0xbeebcbbb
.long 0x3f800000, 0x3f800000, 0x3f800000, 0x3f800000, 0x3f740bdd, 0x3f721352, 0x3f6ff573, 0x3f6db293
.long 0x3f514d3d, 0x3f49d112, 0x3f41d870, 0x3f396842, 0x3f1b02c6, 0x3f0b9a6b, 0x3ef6e0cb, 0x3ed53641
.long 0x3eac7cd4, 0x3e78cfcc, 0x3e164083, 0x3d48fb30, 0x3d16c32c, 0xbdafb680, 0xbe541501, 0xbea68f12
.long 0xbe888e93, 0xbecf7bca, 0xbf08f59b, 0xbf273656, 0xbf0b9a6b, 0xbf2e3bde, 0xbf4bbbf8, 0xbf633c5a
.long 0xbf45e403, 0xbf61c598, 0xbf74fa0b, 0xbf7ec46d, 0xbf6db293, 0xbf7cbfc9, 0xbf7f84ab, 0xbf75dec6
.long 0xbf7f4e6d, 0xbf7c3b28, 0xbf6a09a7, 0xbf49d112, 0xbf791298, 0xbf604621, 0xbf373a23, 0xbf00e7e4
.long 0xbf5b941a, 0xbf2beb4a, 0xbedae880, 0xbe164083, 0xbf299415, 0xbec9b953, 0xbdafb680, 0x3e6c9a7f
.long 0xbecf7bca, 0xbd96a905, 0x3e888e93, 0x3f13682a, 0xbde1bc2e, 0x3e827dc0, 0x3f15f6d9, 0x3f5695e5
.long 0x0, 0x0, 0x0, 0x0, 0x3c490e90, 0x3d16c32c, 0x3d7b2b74, 0x3dafb680
.long 0x3cc90ab0, 0x3d96a905, 0x3dfab273, 0x3e2f10a2, 0x3d16c32c, 0x3de1bc2e, 0x3e3b6ecf, 0x3e827dc0
.long 0x3d48fb30, 0x3e164083, 0x3e78cfcc, 0x3eac7cd4, 0x3d7b2b74, 0x3e3b6ecf, 0x3e9aa086, 0x3ed53641
.long 0x3d96a905, 0x3e605c13, 0x3eb8442a, 0x3efc5d27, 0x3dafb680, 0x3e827dc0, 0x3ed53641, 0x3f10d3cd
.long 0x3dc8bd36, 0x3e94a031, 0x3ef15aea, 0x3f226799, 0x3de1bc2e, 0x3ea68f12, 0x3f064b82, 0x3f32c8c9
.long 0x3dfab273, 0x3eb8442a, 0x3f13682a, 0x3f41d870, 0x3e09cf86, 0x3ec9b953, 0x3f1ff6cb, 0x3f4f7a1f
.long 0x3e164083, 0x3edae880, 0x3f2beb4a, 0x3f5b941a, 0x3e22abb6, 0x3eebcbbb, 0x3f373a23, 0x3f660f88
.long 0x3e2f10a2, 0x3efc5d27, 0x3f41d870, 0x3f6ed89e, 0x3e3b6ecf, 0x3f064b82, 0x3f4bbbf8, 0x3f75dec6
.long 0x0, 0x0, 0x0, 0x0, 0x3de1bc2e, 0x3e09cf86, 0x3e22abb6, 0x3e3b6ecf
.long 0x3e605c13, 0x3e888e93, 0x3ea09ae5, 0x3eb8442a, 0x3ea68f12, 0x3ec9b953, 0x3eebcbbb, 0x3f064b82
.long 0x3edae880, 0x3f039c3d, 0x3f187fc0, 0x3f2beb4a, 0x3f064b82, 0x3f1ff6cb, 0x3f373a23, 0x3f4bbbf8
.long 0x3f1d7fd1, 0x3f396842, 0x3f514d3d, 0x3f64aa59, 0x3f32c8c9, 0x3f4f7a1f, 0x3f660f88, 0x3f75dec6
.long 0x3f45e403, 0x3f61c598, 0x3f74fa0b, 0x3f7ec46d, 0x3f5695e5, 0x3f6ff573, 0x3f7dabcc, 0x3f7f0e58
.long 0x3f64aa59, 0x3f79c79d, 0x3f7fec43, 0x3f76ba07, 0x3f6ff573, 0x3f7f0e58, 0x3f7baccd, 0x3f660f88
.long 0x3f7853f8, 0x3f7fb10f, 0x3f710908, 0x3f4d9f02, 0x3f7dabcc, 0x3f7baccd, 0x3f604621, 0x3f2e3bde
.long 0x3f7fec43, 0x3f731447, 0x3f49d112, 0x3f08f59b, 0x3f7f0e58, 0x3f660f88, 0x3f2e3bde, 0x3ebe1d4a
.long 0x0, 0x0, 0x0, 0x0, 0x3e541501, 0x3e6c9a7f, 0x3e827dc0, 0x3e8e9a22
.long 0x3ecf7bca, 0x3ee63375, 0x3efc5d27, 0x3f08f59b, 0x3f15f6d9, 0x3f24d225, 0x3f32c8c9, 0x3f3fc767
.long 0x3f3daef9, 0x3f4d9f02, 0x3f5b941a, 0x3f676bd8, 0x3f5d2d53, 0x3f6b4b0c, 0x3f75dec6, 0x3f7cbfc9
.long 0x3f731447, 0x3f7c3b28, 0x3f7fec43, 0x3f7e1324, 0x3f7e70b0, 0x3f7f84ab, 0x3f791298, 0x3f6b4b0c
.long 0x3f7ec46d, 0x3f74fa0b, 0x3f61c598, 0x3f45e403, 0x3f740bdd, 0x3f5d2d53, 0x3f3b8f3b, 0x3f10d3cd
.long 0x3f5ebe05, 0x3f396842, 0x3f08f59b, 0x3ea09ae5, 0x3f3fc767, 0x3f0b9a6b, 0x3e9aa086, 0x3d16c32c
.long 0x3f187fc0, 0x3eac7cd4, 0x3d48fb30, 0xbe78cfcc, 0x3ed53641, 0x3de1bc2e, 0xbe541501, 0xbf00e7e4
.long 0x3e605c13, 0xbdfab273, 0xbee63375, 0xbf396842, 0x3c490e90, 0xbeb263ef, 0xbf299415, 0xbf633c5a
.long 0x0, 0x0, 0x0, 0x0, 0x3e9aa086, 0x3ea68f12, 0x3eb263ef, 0x3ebe1d4a
.long 0x3f13682a, 0x3f1d7fd1, 0x3f273656, 0x3f3085bb, 0x3f4bbbf8, 0x3f5695e5, 0x3f604621, 0x3f68bf3c
.long 0x3f710908, 0x3f7853f8, 0x3f7d3aac, 0x3f7fb10f, 0x3f7fd397, 0x3f7f0e58, 0x3f7a7302, 0x3f721352
.long 0x3f76ba07, 0x3f6a09a7, 0x3f584853, 0x3f41d870, 0x3f5695e5, 0x3f3b8f3b, 0x3f1b02c6, 0x3eebcbbb
.long 0x3f226799, 0x3ef15aea, 0x3e94a031, 0x3dc8bd36, 0x3ebe1d4a, 0x3e22abb6, 0xbd7b2b74, 0xbe8e9a22
.long 0x3d96a905, 0xbe2f10a2, 0xbecf7bca, 0xbf1d7fd1, 0xbe6c9a7f, 0xbef6e0cb, 0xbf32c8c9, 0xbf5d2d53
.long 0xbf039c3d, 0xbf3daef9, 0xbf676bd8, 0xbf7d3aac, 0xbf3fc767, 0xbf6b4b0c, 0xbf7f0e58, 0xbf791298
.long 0xbf6a09a7, 0xbf7f4e6d, 0xbf76ba07, 0xbf514d3d, 0xbf7e70b0, 0xbf778bc5, 0xbf4f7a1f, 0xbf0b9a6b
.long 0x3f80, 0x3f80, 0x3f80, 0x3f80, 0x3f80, 0x3ec43f6d, 0x3f353f35, 0x3f6d3ec4
.long 0x3f80, 0x3f353f35, 0x3f800000, 0x3f35bf35, 0x3f80, 0x3f6d3ec4, 0x3f35bf35, 0xbec4bf6d
.long 0x3f80, 0x3f800000, 0xbf80, 0xbf800000, 0x3f80, 0x3f6dbec4, 0xbf35bf35, 0xbec43f6d
.long 0x3f80, 0x3f35bf35, 0xbf800000, 0x3f353f35, 0x3f80, 0x3ec4bf6d, 0xbf353f35, 0x3f6dbec4
.long 0x3f80, 0xbf80, 0x3f80, 0xbf80, 0x3f80, 0xbec4bf6d, 0x3f353f35, 0xbf6dbec4
.long 0x3f80, 0xbf35bf35, 0x3f800000, 0xbf353f35, 0x3f80, 0xbf6dbec4, 0x3f35bf35, 0x3ec43f6d
.long 0x3f80, 0xbf800000, 0xbf80, 0x3f800000, 0x3f80, 0xbf6d3ec4, 0xbf35bf35, 0x3ec4bf6d
.long 0x3f80, 0xbf353f35, 0xbf800000, 0xbf35bf35, 0x3f80, 0xbec43f6d, 0xbf353f35, 0xbf6d3ec4
.long 0x3f80, 0x3f80, 0x3f80, 0x3f80, 0x3f800000, 0x3f6dbec4, 0x3f35bf35, 0x3ec4bf6d
.long 0xbf80, 0xbf35bf35, 0xbf800000, 0xbf353f35, 0xbf800000, 0xbec43f6d, 0x3f353f35, 0x3f6dbec4
.long 0x3f80, 0x3f800000, 0xbf80, 0xbf800000, 0x3f800000, 0xbec4bf6d, 0xbf353f35, 0x3f6d3ec4
.long 0xbf80, 0xbf353f35, 0x3f800000, 0xbf35bf35, 0xbf800000, 0x3f6d3ec4, 0xbf35bf35, 0x3ec43f6d
.long 0x3f80, 0xbf80, 0x3f80, 0xbf80, 0x3f800000, 0xbf6d3ec4, 0x3f35bf35, 0xbec43f6d
.long 0xbf80, 0x3f353f35, 0xbf800000, 0x3f35bf35, 0xbf800000, 0x3ec4bf6d, 0x3f353f35, 0xbf6d3ec4
.long 0x3f80, 0xbf800000, 0xbf80, 0x3f800000, 0x3f800000, 0x3ec43f6d, 0xbf353f35, 0xbf6dbec4
.long 0xbf80, 0x3f35bf35, 0x3f800000, 0x3f353f35, 0xbf800000, 0xbf6dbec4, 0xbf35bf35, 0xbec4bf6d
.long 0x3f80, 0x3f80, 0x3f80, 0x3f80, 0xbf80, 0xbec4bf6d, 0xbf35bf35, 0xbf6dbec4
.long 0x3f80, 0x3f353f35, 0x3f800000, 0x3f35bf35, 0xbf80, 0xbf6dbec4, 0xbf353f35, 0x3ec43f6d
.long 0x3f80, 0x3f800000, 0xbf80, 0xbf800000, 0xbf80, 0xbf6d3ec4, 0x3f353f35, 0x3ec4bf6d
.long 0x3f80, 0x3f35bf35, 0xbf800000, 0x3f353f35, 0xbf80, 0xbec43f6d, 0x3f35bf35, 0xbf6d3ec4
.long 0x3f80, 0xbf80, 0x3f80, 0xbf80, 0xbf80, 0x3ec43f6d, 0xbf35bf35, 0x3f6d3ec4
.long 0x3f80, 0xbf35bf35, 0x3f800000, 0xbf353f35, 0xbf80, 0x3f6d3ec4, 0xbf353f35, 0xbec4bf6d
.long 0x3f80, 0xbf800000, 0xbf80, 0x3f800000, 0xbf80, 0x3f6dbec4, 0x3f353f35, 0xbec43f6d
.long 0x3f80, 0xbf353f35, 0xbf800000, 0xbf35bf35, 0xbf80, 0x3ec4bf6d, 0x3f35bf35, 0x3f6dbec4
.long 0x3f80, 0x3f80, 0x3f80, 0x3f80, 0xbf800000, 0xbf6d3ec4, 0xbf353f35, 0xbec43f6d
.long 0xbf80, 0xbf35bf35, 0xbf800000, 0xbf353f35, 0x3f800000, 0x3ec4bf6d, 0xbf35bf35, 0xbf6d3ec4
.long 0x3f80, 0x3f800000, 0xbf80, 0xbf800000, 0xbf800000, 0x3ec43f6d, 0x3f35bf35, 0xbf6dbec4
.long 0xbf80, 0xbf353f35, 0x3f800000, 0xbf35bf35, 0x3f800000, 0xbf6dbec4, 0x3f353f35, 0xbec4bf6d
.long 0x3f80, 0xbf80, 0x3f80, 0xbf80, 0xbf800000, 0x3f6dbec4, 0xbf353f35, 0x3ec4bf6d
.long 0xbf80, 0x3f353f35, 0xbf800000, 0x3f35bf35, 0x3f800000, 0xbec43f6d, 0xbf35bf35, 0x3f6dbec4
.long 0x3f80, 0xbf800000, 0xbf80, 0x3f800000, 0xbf800000, 0xbec4bf6d, 0x3f35bf35, 0x3f6d3ec4
.long 0xbf80, 0x3f35bf35, 0x3f800000, 0x3f353f35, 0x3f800000, 0x3f6d3ec4, 0x3f353f35, 0x3ec43f6d
.long 0x3f80, 0x3f80, 0x3f80, 0x3f80, 0x3f80, 0x3ec43f6d, 0x3f353f35, 0x3f6d3ec4
.long 0x3f80, 0x3f353f35, 0x3f800000, 0x3f35bf35, 0x3f80, 0x3f6d3ec4, 0x3f35bf35, 0xbec4bf6d
.long 0x3f80, 0x3f800000, 0xbf80, 0xbf800000, 0x3f80, 0x3f6dbec4, 0xbf35bf35, 0xbec43f6d
.long 0x3f80, 0x3f35bf35, 0xbf800000, 0x3f353f35, 0x3f80, 0x3ec4bf6d, 0xbf353f35, 0x3f6dbec4
.long 0x3f80, 0xbf80, 0x3f80, 0xbf80, 0x3f80, 0xbec4bf6d, 0x3f353f35, 0xbf6dbec4
.long 0x3f80, 0xbf35bf35, 0x3f800000, 0xbf353f35, 0x3f80, 0xbf6dbec4, 0x3f35bf35, 0x3ec43f6d
.long 0x3f80, 0xbf800000, 0xbf80, 0x3f800000, 0x3f80, 0xbf6d3ec4, 0xbf35bf35, 0x3ec4bf6d
.long 0x3f80, 0xbf353f35, 0xbf800000, 0xbf35bf35, 0x3f80, 0xbec43f6d, 0xbf353f35, 0xbf6d3ec4
.long 0x3f80, 0x3f80, 0x3f80, 0x3f80, 0x3f800000, 0x3f6dbec4, 0x3f35bf35, 0x3ec4bf6d
.long 0xbf80, 0xbf35bf35, 0xbf800000, 0xbf353f35, 0xbf800000, 0xbec43f6d, 0x3f353f35, 0x3f6dbec4
.long 0x3f80, 0x3f800000, 0xbf80, 0xbf800000, 0x3f800000, 0xbec4bf6d, 0xbf353f35, 0x3f6d3ec4
.long 0xbf80, 0xbf353f35, 0x3f800000, 0xbf35bf35, 0xbf800000, 0x3f6d3ec4, 0xbf35bf35, 0x3ec43f6d
.long 0x3f80, 0xbf80, 0x3f80, 0xbf80, 0x3f800000, 0xbf6d3ec4, 0x3f35bf35, 0xbec43f6d
.long 0xbf80, 0x3f353f35, 0xbf800000, 0x3f35bf35, 0xbf800000, 0x3ec4bf6d, 0x3f353f35, 0xbf6d3ec4
.long 0x3f80, 0xbf800000, 0xbf80, 0x3f800000, 0x3f800000, 0x3ec43f6d, 0xbf353f35, 0xbf6dbec4
.long 0xbf80, 0x3f35bf35, 0x3f800000, 0x3f353f35, 0xbf800000, 0xbf6dbec4, 0xbf35bf35, 0xbec4bf6d
.long 0x3f80, 0x3f80, 0x3f80, 0x3f80, 0xbf80, 0xbec4bf6d, 0xbf35bf35, 0xbf6dbec4
.long 0x3f80, 0x3f353f35, 0x3f800000, 0x3f35bf35, 0xbf80, 0xbf6dbec4, 0xbf353f35, 0x3ec43f6d
.long 0x3f80, 0x3f800000, 0xbf80, 0xbf800000, 0xbf80, 0xbf6d3ec4, 0x3f353f35, 0x3ec4bf6d
.long 0x3f80, 0x3f35bf35, 0xbf800000, 0x3f353f35, 0xbf80, 0xbec43f6d, 0x3f35bf35, 0xbf6d3ec4
.long 0x3f80, 0xbf80, 0x3f80, 0xbf80, 0xbf80, 0x3ec43f6d, 0xbf35bf35, 0x3f6d3ec4
.long 0x3f80, 0xbf35bf35, 0x3f800000, 0xbf353f35, 0xbf80, 0x3f6d3ec4, 0xbf353f35, 0xbec4bf6d
.long 0x3f80, 0xbf800000, 0xbf80, 0x3f800000, 0xbf80, 0x3f6dbec4, 0x3f353f35, 0xbec43f6d
.long 0x3f80, 0xbf353f35, 0xbf800000, 0xbf35bf35, 0xbf80, 0x3ec4bf6d, 0x3f35bf35, 0x3f6dbec4
.long 0x3f80, 0x3f80, 0x3f80, 0x3f80, 0xbf800000, 0xbf6d3ec4, 0xbf353f35, 0xbec43f6d
.long 0xbf80, 0xbf35bf35, 0xbf800000, 0xbf353f35, 0x3f800000, 0x3ec4bf6d, 0xbf35bf35, 0xbf6d3ec4
.long 0x3f80, 0x3f800000, 0xbf80, 0xbf800000, 0xbf800000, 0x3ec43f6d, 0x3f35bf35, 0xbf6dbec4
.long 0xbf80, 0xbf353f35, 0x3f800000, 0xbf35bf35, 0x3f800000, 0xbf6dbec4, 0x3f353f35, 0xbec4bf6d
.long 0x3f80, 0xbf80, 0x3f80, 0xbf80, 0xbf800000, 0x3f6dbec4, 0xbf353f35, 0x3ec4bf6d
.long 0xbf80, 0x3f353f35, 0xbf800000, 0x3f35bf35, 0x3f800000, 0xbec43f6d, 0xbf35bf35, 0x3f6dbec4
.long 0x3f80, 0xbf800000, 0xbf80, 0x3f800000, 0xbf800000, 0xbec4bf6d, 0x3f35bf35, 0x3f6d3ec4
.long 0xbf80, 0x3f35bf35, 0x3f800000, 0x3f353f35, 0x3f800000, 0x3f6d3ec4, 0x3f353f35, 0x3ec43f6d
.long 0x3f80, 0x3f80, 0x3f80, 0x3f80, 0x3e483f7b, 0x3f0e3f55, 0x3f553f0e, 0x3f7b3e48
.long 0x3ec43f6d, 0x3f6d3ec4, 0x3f6dbec4, 0x3ec4bf6d, 0x3f0e3f55, 0x3f7bbe48, 0x3e48bf7b, 0xbf55bf0e
.long 0x3f353f35, 0x3f35bf35, 0xbf35bf35, 0xbf353f35, 0x3f553f0e, 0x3e48bf7b, 0xbf7b3e48, 0x3f0e3f55
.long 0x3f6d3ec4, 0xbec4bf6d, 0xbec43f6d, 0x3f6dbec4, 0x3f7b3e48, 0xbf55bf0e, 0x3f0e3f55, 0xbe48bf7b
.long 0x3f800000, 0xbf800000, 0x3f800000, 0xbf800000, 0x3f7bbe48, 0xbf553f0e, 0x3f0ebf55, 0xbe483f7b
.long 0x3f6dbec4, 0xbec43f6d, 0xbec4bf6d, 0x3f6d3ec4, 0x3f55bf0e, 0x3e483f7b, 0xbf7bbe48, 0x3f0ebf55
.long 0x3f35bf35, 0x3f353f35, 0xbf353f35, 0xbf35bf35, 0x3f0ebf55, 0x3f7b3e48, 0x3e483f7b, 0xbf553f0e
.long 0x3ec4bf6d, 0x3f6dbec4, 0x3f6d3ec4, 0x3ec43f6d, 0x3e48bf7b, 0x3f0ebf55, 0x3f55bf0e, 0x3f7bbe48
.long 0x3f80, 0x3f80, 0x3f80, 0x3f80, 0x3f7bbe48, 0x3f55bf0e, 0x3f0ebf55, 0x3e48bf7b
.long 0xbec4bf6d, 0xbf6dbec4, 0xbf6d3ec4, 0xbec43f6d, 0xbf553f0e, 0x3e483f7b, 0x3f7b3e48, 0x3f0ebf55
.long 0x3f353f35, 0x3f35bf35, 0xbf35bf35, 0xbf353f35, 0x3f0ebf55, 0xbf7bbe48, 0x3e483f7b, 0x3f55bf0e
.long 0xbf6dbec4, 0x3ec43f6d, 0x3ec4bf6d, 0xbf6d3ec4, 0xbe483f7b, 0x3f0ebf55, 0xbf553f0e, 0x3f7bbe48
.long 0x3f800000, 0xbf800000, 0x3f800000, 0xbf800000, 0xbe48bf7b, 0x3f0e3f55, 0xbf55bf0e, 0x3f7b3e48
.long 0xbf6d3ec4, 0x3ec4bf6d, 0x3ec43f6d, 0xbf6dbec4, 0x3f0e3f55, 0xbf7b3e48, 0x3e48bf7b, 0x3f553f0e
.long 0x3f35bf35, 0x3f353f35, 0xbf353f35, 0xbf35bf35, 0xbf55bf0e, 0x3e48bf7b, 0x3f7bbe48, 0x3f0e3f55
.long 0xbec43f6d, 0xbf6d3ec4, 0xbf6dbec4, 0xbec4bf6d, 0x3f7b3e48, 0x3f553f0e, 0x3f0e3f55, 0x3e483f7b
.long 0x3f80, 0x3f80, 0x3f80, 0x3f80, 0xbe48bf7b, 0xbf0ebf55, 0xbf55bf0e, 0xbf7bbe48
.long 0x3ec43f6d, 0x3f6d3ec4, 0x3f6dbec4, 0x3ec4bf6d, 0xbf0ebf55, 0xbf7b3e48, 0xbe483f7b, 0x3f553f0e
.long 0x3f353f35, 0x3f35bf35, 0xbf35bf35, 0xbf353f35, 0xbf55bf0e, 0xbe483f7b, 0x3f7bbe48, 0xbf0ebf55
.long 0x3f6d3ec4, 0xbec4bf6d, 0xbec43f6d, 0x3f6dbec4, 0xbf7bbe48, 0x3f553f0e, 0xbf0ebf55, 0x3e483f7b
.long 0x3f800000, 0xbf800000, 0x3f800000, 0xbf800000, 0xbf7b3e48, 0x3f55bf0e, 0xbf0e3f55, 0x3e48bf7b
.long 0x3f6dbec4, 0xbec43f6d, 0xbec4bf6d, 0x3f6d3ec4, 0xbf553f0e, 0xbe48bf7b, 0x3f7b3e48, 0xbf0e3f55
.long 0x3f35bf35, 0x3f353f35, 0xbf353f35, 0xbf35bf35, 0xbf0e3f55, 0xbf7bbe48, 0xbe48bf7b, 0x3f55bf0e
.long 0x3ec4bf6d, 0x3f6dbec4, 0x3f6d3ec4, 0x3ec43f6d, 0xbe483f7b, 0xbf0e3f55, 0xbf553f0e, 0xbf7b3e48
.long 0x3f80, 0x3f80, 0x3f80, 0x3f80, 0xbf7b3e48, 0xbf553f0e, 0xbf0e3f55, 0xbe483f7b
.long 0xbec4bf6d, 0xbf6dbec4, 0xbf6d3ec4, 0xbec43f6d, 0x3f55bf0e, 0xbe48bf7b, 0xbf7bbe48, 0xbf0e3f55
.long 0x3f353f35, 0x3f35bf35, 0xbf35bf35, 0xbf353f35, 0xbf0e3f55, 0x3f7b3e48, 0xbe48bf7b, 0xbf553f0e
.long 0xbf6dbec4, 0x3ec43f6d, 0x3ec4bf6d, 0xbf6d3ec4, 0x3e48bf7b, 0xbf0e3f55, 0x3f55bf0e, 0xbf7b3e48
.long 0x3f800000, 0xbf800000, 0x3f800000, 0xbf800000, 0x3e483f7b, 0xbf0ebf55, 0x3f553f0e, 0xbf7bbe48
.long 0xbf6d3ec4, 0x3ec4bf6d, 0x3ec43f6d, 0xbf6dbec4, 0xbf0ebf55, 0x3f7bbe48, 0xbe483f7b, 0xbf55bf0e
.long 0x3f35bf35, 0x3f353f35, 0xbf353f35, 0xbf35bf35, 0x3f553f0e, 0xbe483f7b, 0xbf7b3e48, 0xbf0ebf55
.long 0xbec43f6d, 0xbf6d3ec4, 0xbf6dbec4, 0xbec4bf6d, 0xbf7bbe48, 0xbf55bf0e, 0xbf0ebf55, 0xbe48bf7b
.long 0xbf80, 0xbf80, 0xbf80, 0xbf80, 0xbe48bf7b, 0xbf0ebf55, 0xbf55bf0e, 0xbf7bbe48
.long 0xbec4bf6d, 0xbf6dbec4, 0xbf6d3ec4, 0xbec43f6d, 0xbf0ebf55, 0xbf7b3e48, 0xbe483f7b, 0x3f553f0e
.long 0xbf35bf35, 0xbf353f35, 0x3f353f35, 0x3f35bf35, 0xbf55bf0e, 0xbe483f7b, 0x3f7bbe48, 0xbf0ebf55
.long 0xbf6dbec4, 0x3ec43f6d, 0x3ec4bf6d, 0xbf6d3ec4, 0xbf7bbe48, 0x3f553f0e, 0xbf0ebf55, 0x3e483f7b
.long 0xbf800000, 0x3f800000, 0xbf800000, 0x3f800000, 0xbf7b3e48, 0x3f55bf0e, 0xbf0e3f55, 0x3e48bf7b
.long 0xbf6d3ec4, 0x3ec4bf6d, 0x3ec43f6d, 0xbf6dbec4, 0xbf553f0e, 0xbe48bf7b, 0x3f7b3e48, 0xbf0e3f55
.long 0xbf353f35, 0xbf35bf35, 0x3f35bf35, 0x3f353f35, 0xbf0e3f55, 0xbf7bbe48, 0xbe48bf7b, 0x3f55bf0e
.long 0xbec43f6d, 0xbf6d3ec4, 0xbf6dbec4, 0xbec4bf6d, 0xbe483f7b, 0xbf0e3f55, 0xbf553f0e, 0xbf7b3e48
.long 0xbf80, 0xbf80, 0xbf80, 0xbf80, 0xbf7b3e48, 0xbf553f0e, 0xbf0e3f55, 0xbe483f7b
.long 0x3ec43f6d, 0x3f6d3ec4, 0x3f6dbec4, 0x3ec4bf6d, 0x3f55bf0e, 0xbe48bf7b, 0xbf7bbe48, 0xbf0e3f55
.long 0xbf35bf35, 0xbf353f35, 0x3f353f35, 0x3f35bf35, 0xbf0e3f55, 0x3f7b3e48, 0xbe48bf7b, 0xbf553f0e
.long 0x3f6d3ec4, 0xbec4bf6d, 0xbec43f6d, 0x3f6dbec4, 0x3e48bf7b, 0xbf0e3f55, 0x3f55bf0e, 0xbf7b3e48
.long 0xbf800000, 0x3f800000, 0xbf800000, 0x3f800000, 0x3e483f7b, 0xbf0ebf55, 0x3f553f0e, 0xbf7bbe48
.long 0x3f6dbec4, 0xbec43f6d, 0xbec4bf6d, 0x3f6d3ec4, 0xbf0ebf55, 0x3f7bbe48, 0xbe483f7b, 0xbf55bf0e
.long 0xbf353f35, 0xbf35bf35, 0x3f35bf35, 0x3f353f35, 0x3f553f0e, 0xbe483f7b, 0xbf7b3e48, 0xbf0ebf55
.long 0x3ec4bf6d, 0x3f6dbec4, 0x3f6d3ec4, 0x3ec43f6d, 0xbf7bbe48, 0xbf55bf0e, 0xbf0ebf55, 0xbe48bf7b
.long 0xbf80, 0xbf80, 0xbf80, 0xbf80, 0x3e483f7b, 0x3f0e3f55, 0x3f553f0e, 0x3f7b3e48
.long 0xbec4bf6d, 0xbf6dbec4, 0xbf6d3ec4, 0xbec43f6d, 0x3f0e3f55, 0x3f7bbe48, 0x3e48bf7b, 0xbf55bf0e
.long 0xbf35bf35, 0xbf353f35, 0x3f353f35, 0x3f35bf35, 0x3f553f0e, 0x3e48bf7b, 0xbf7b3e48, 0x3f0e3f55
.long 0xbf6dbec4, 0x3ec43f6d, 0x3ec4bf6d, 0xbf6d3ec4, 0x3f7b3e48, 0xbf55bf0e, 0x3f0e3f55, 0xbe48bf7b
.long 0xbf800000, 0x3f800000, 0xbf800000, 0x3f800000, 0x3f7bbe48, 0xbf553f0e, 0x3f0ebf55, 0xbe483f7b
.long 0xbf6d3ec4, 0x3ec4bf6d, 0x3ec43f6d, 0xbf6dbec4, 0x3f55bf0e, 0x3e483f7b, 0xbf7bbe48, 0x3f0ebf55
.long 0xbf353f35, 0xbf35bf35, 0x3f35bf35, 0x3f353f35, 0x3f0ebf55, 0x3f7b3e48, 0x3e483f7b, 0xbf553f0e
.long 0xbec43f6d, 0xbf6d3ec4, 0xbf6dbec4, 0xbec4bf6d, 0x3e48bf7b, 0x3f0ebf55, 0x3f55bf0e, 0x3f7bbe48
.long 0xbf80, 0xbf80, 0xbf80, 0xbf80, 0x3f7bbe48, 0x3f55bf0e, 0x3f0ebf55, 0x3e48bf7b
.long 0x3ec43f6d, 0x3f6d3ec4, 0x3f6dbec4, 0x3ec4bf6d, 0xbf553f0e, 0x3e483f7b, 0x3f7b3e48, 0x3f0ebf55
.long 0xbf35bf35, 0xbf353f35, 0x3f353f35, 0x3f35bf35, 0x3f0ebf55, 0xbf7bbe48, 0x3e483f7b, 0x3f55bf0e
.long 0x3f6d3ec4, 0xbec4bf6d, 0xbec43f6d, 0x3f6dbec4, 0xbe483f7b, 0x3f0ebf55, 0xbf553f0e, 0x3f7bbe48
.long 0xbf800000, 0x3f800000, 0xbf800000, 0x3f800000, 0xbe48bf7b, 0x3f0e3f55, 0xbf55bf0e, 0x3f7b3e48
.long 0x3f6dbec4, 0xbec43f6d, 0xbec4bf6d, 0x3f6d3ec4, 0x3f0e3f55, 0xbf7b3e48, 0x3e48bf7b, 0x3f553f0e
.long 0xbf353f35, 0xbf35bf35, 0x3f35bf35, 0x3f353f35, 0xbf55bf0e, 0x3e48bf7b, 0x3f7bbe48, 0x3f0e3f55
.long 0x3ec4bf6d, 0x3f6dbec4, 0x3f6d3ec4, 0x3ec43f6d, 0x3f7b3e48, 0x3f553f0e, 0x3f0e3f55, 0x3e483f7b
L_tabend:
.size L_tab, L_tabend - L_tab
.section .rodata,"a"
.p2align 6
.amdhsa_kernel gated_mix__spectral_fnet__moe_arch_mod__prompt_kernel
  .amdhsa_next_free_vgpr 256
  .amdhsa_next_free_sgpr 102
  .amdhsa_accum_offset 256
  .amdhsa_group_segment_fixed_size 0
  .amdhsa_kernarg_size 112
  .amdhsa_user_sgpr_count 2
  .amdhsa_user_sgpr_kernarg_segment_ptr 1
  .amdhsa_system_sgpr_workgroup_id_x 1
.end_amdhsa_kernel
```

```asm
; @launch grid=(256,1,1) block=(512,1,1) lds=100352
.amdgcn_target "amdgcn-amd-amdhsa--gfx950"
.text
.globl gated_mix__spectral_fnet__moe_arch_mod__prompt_kernel
.p2align 8
.type gated_mix__spectral_fnet__moe_arch_mod__prompt_kernel,@function
gated_mix__spectral_fnet__moe_arch_mod__prompt_kernel:
    s_cmp_ge_u32 s2, 256
    s_cbranch_scc1 L_end
    s_load_dwordx2 s[4:5], s[0:1], 0
    s_load_dwordx16 s[16:31], s[0:1], 48
    s_getpc_b64 s[10:11]
L_pc:
    v_lshrrev_b32 v1, 6, v0
    s_lshr_b32 s57, s2, 3
    v_lshl_add_u32 v4, v0, 5, s57
    v_lshlrev_b32 v4, 7, v4
    v_cmp_gt_u32 vcc, L_tabend - L_pc, v4
    s_nop 0
    s_and_saveexec_b64 s[12:13], vcc
    s_cbranch_execz L_nocpf
    global_load_dword v249, v4, s[10:11]
L_nocpf:
    s_mov_b64 exec, s[12:13]
    v_and_b32 v0, 63, v0
    v_readfirstlane_b32 s3, v1
    v_and_b32 v2, 15, v0
    v_lshrrev_b32 v3, 4, v0
    v_lshlrev_b32 v247, 4, v0
    v_lshlrev_b32 v246, 3, v0
    s_add_u32 s10, s10, L_tab - L_pc
    s_addc_u32 s11, s11, 0
    s_and_b32 s56, s2, 7
    s_mov_b32 s90, 400000
    s_cmp_lt_u32 s57, 16
    s_cbranch_scc1 L_low
    s_sub_u32 s57, s57, 16
    s_lshl4_add_u32 s9, s56, s57
    s_lshl4_add_u32 s58, s57, s56
    s_sub_u32 s62, s58, 120
    s_cmp_lt_u32 s9, 8
    s_cselect_b32 s62, s58, s62
    s_cmp_lt_u32 s9, 16
    s_cselect_b32 s58, s62, s58
L_a:
    s_cmp_ge_u32 s3, 4
    s_cbranch_scc1 L_p1w
    s_lshl2_add_u32 s60, s57, s3
    s_lshl_b32 s60, s60, 5
    s_add_u32 s60, s60, s56
    s_lshl_b32 s12, s60, 10
    s_cmp_eq_u32 s58, 128
    s_cselect_b32 s12, 0x40000000, s12
    s_add_u32 s13, s12, 8192
    s_add_u32 s14, s12, 16384
    s_add_u32 s15, s12, 24576
    s_waitcnt lgkmcnt(0)
    s_load_dword s59, s[30:31], 0
    s_mov_b32 s32, s4
    s_mov_b32 s33, s5
    s_mov_b32 s34, 0x200000
    s_mov_b32 s35, 0x20000
    s_mov_b32 s36, s30
    s_mov_b32 s37, s31
    s_mov_b32 s38, 0x400000
    s_mov_b32 s39, 0x20000
    buffer_load_dwordx4 v[8:11], v247, s[32:35], s12 offen
    buffer_load_dwordx4 v[12:15], v247, s[32:35], s13 offen
    buffer_load_dwordx4 v[16:19], v247, s[32:35], s14 offen
    buffer_load_dwordx4 v[20:23], v247, s[32:35], s15 offen
    s_mov_b32 s44, s16
    s_mov_b32 s45, s17
    s_mov_b32 s46, 0x400
    s_mov_b32 s47, 0x20000
    buffer_load_dwordx4 v[24:27], v247, s[44:47], 0 offen
    v_and_b32 v36, 1, v3
    v_lshrrev_b32 v108, 1, v3
    v_lshl_add_u32 v36, v36, 1, v108
    v_lshl_add_u32 v36, v36, 3, s60
    v_mov_b32 v108, 43008
    v_mov_b32 v109, 1
    s_mov_b32 s8, 0xfffff800
    s_lshl3_add_u32 s15, s57, s56
    s_lshl_b32 s15, s15, 3
    s_add_u32 s15, s15, 0x40000
    v_lshlrev_b32 v37, 11, v0
    s_xor_b32 s98, s3, 4
    v_lshl_add_u32 v96, v2, 4, s98
    v_lshlrev_b32 v98, 2, v3
    v_cvt_f32_u32 v98, v98
    v_cvt_f32_u32 v96, v96
    v_mul_f32 v96, 0x3b800000, v96
    v_mul_f32 v99, v98, v96
    v_cos_f32 v102, v99
    v_sin_f32 v103, v99
    v_add_f32 v99, v99, v96
    v_cvt_pk_bf16_f32 v112, v102, v103
    v_cvt_pk_bf16_f32 v116, -v103, v102
    v_cos_f32 v102, v99
    v_sin_f32 v103, v99
    v_add_f32 v99, v99, v96
    v_cvt_pk_bf16_f32 v113, v102, v103
    v_cvt_pk_bf16_f32 v117, -v103, v102
    v_cos_f32 v102, v99
    v_sin_f32 v103, v99
    v_add_f32 v99, v99, v96
    v_cvt_pk_bf16_f32 v114, v102, v103
    v_cvt_pk_bf16_f32 v118, -v103, v102
    v_cos_f32 v102, v99
    v_sin_f32 v103, v99
    s_nop 0
    v_cvt_pk_bf16_f32 v115, v102, v103
    v_cvt_pk_bf16_f32 v119, -v103, v102
    v_mov_b32 v96, 0x80000000
    v_mov_b32 v97, 0x8000
    v_xor_b32 v120, v96, v112
    v_xor_b32 v124, v97, v116
    v_xor_b32 v121, v96, v113
    v_xor_b32 v125, v97, v117
    v_xor_b32 v122, v96, v114
    v_xor_b32 v126, v97, v118
    v_xor_b32 v123, v96, v115
    v_xor_b32 v127, v97, v119
    s_sub_u32 s60, 16, s98
    s_cmp_eq_u32 s98, 0
    s_cselect_b32 s60, 8, s60
    v_bfe_u32 v96, v2, 2, 1
    v_xor_b32 v96, v96, v2
    v_lshrrev_b32 v97, 3, v2
    v_mul_u32_u24 v98, 3, v97
    v_xor_b32 v98, v98, v3
    v_lshlrev_b32 v98, 4, v98
    v_lshl_add_u32 v96, v96, 6, v98
    s_lshl_b32 s61, s98, 3
    s_and_b32 s61, s61, 32
    s_lshl_b32 s62, s98, 10
    s_or_b32 s61, s61, s62
    v_xor_b32 v60, s61, v96
    s_lshl_b32 s61, s60, 3
    s_and_b32 s61, s61, 32
    s_lshl_b32 s62, s60, 10
    s_or_b32 s61, s61, s62
    v_xor_b32 v61, s61, v96
    v_lshlrev_b32 v63, 16, v3
    v_lshl_add_u32 v63, v97, 14, v63
    v_and_b32 v96, 7, v2
    v_lshl_add_u32 v63, v96, 4, v63
    s_lshl_b32 s6, s98, 18
    s_lshl_b32 s61, s56, 11
    s_add_u32 s6, s6, s61
    s_lshl_b32 s61, s57, 7
    s_add_u32 s6, s6, s61
    s_add_u32 s6, s6, 0x200000
    s_add_u32 s7, s6, 32768
    v_lshlrev_b32 v4, 5, v2
    v_and_b32 v96, 1, v3
    v_lshl_add_u32 v4, v96, 9, v4
    v_lshrrev_b32 v96, 1, v3
    v_lshl_add_u32 v4, v96, 4, v4
    s_lshl_b32 s60, s3, 8
    s_add_u32 s93, s60, s58
    s_sub_u32 s94, 2048, s93
    s_and_b32 s94, s94, 2047
    s_mov_b32 s48, s24
    s_mov_b32 s49, s25
    s_mov_b32 s50, 0x400
    s_mov_b32 s51, 0x20000
    s_waitcnt vmcnt(1)
    s_barrier
    s_waitcnt vmcnt(0)
    v_dot2_f32_bf16 v32, v8, v24, 0
    v_dot2_f32_bf16 v33, v12, v24, 0
    v_dot2_f32_bf16 v34, v16, v24, 0
    v_dot2_f32_bf16 v35, v20, v24, 0
    v_dot2_f32_bf16 v32, v9, v25, v32
    v_dot2_f32_bf16 v33, v13, v25, v33
    v_dot2_f32_bf16 v34, v17, v25, v34
    v_dot2_f32_bf16 v35, v21, v25, v35
    v_dot2_f32_bf16 v32, v10, v26, v32
    v_dot2_f32_bf16 v33, v14, v26, v33
    v_dot2_f32_bf16 v34, v18, v26, v34
    v_dot2_f32_bf16 v35, v22, v26, v35
    v_dot2_f32_bf16 v32, v11, v27, v32
    v_dot2_f32_bf16 v33, v15, v27, v33
    v_dot2_f32_bf16 v34, v19, v27, v34
    v_dot2_f32_bf16 v35, v23, v27, v35
    s_waitcnt lgkmcnt(0)
    s_add_u32 s59, s59, 0x9e3779b9
    s_bitcmp1_b32 s59, 0
    s_cselect_b32 s91, 1, 0x10000
    s_xor_b32 s92, s91, 0x10001
    v_permlane32_swap_b32 v32, v33
    v_permlane32_swap_b32 v34, v35
    v_add_f32 v32, v32, v33
    v_add_f32 v34, v34, v35
    s_nop 1
    v_permlane16_swap_b32 v32, v34
    v_add_f32 v32, v32, v34
    v_mov_b32 v39, s59
    s_nop 0
    v_add_f32_dpp v32, v32, v32 row_ror:8 row_mask:0xf bank_mask:0xf
    s_nop 1
    v_add_f32_dpp v32, v32, v32 row_ror:4 row_mask:0xf bank_mask:0xf
    s_nop 1
    v_add_f32_dpp v32, v32, v32 row_ror:2 row_mask:0xf bank_mask:0xf
    s_nop 1
    v_add_f32_dpp v32, v32, v32 row_ror:1 row_mask:0xf bank_mask:0xf
    v_ashrrev_i32 v33, 31, v32
    v_or_b32 v33, 0x80000000, v33
    v_xor_b32 v33, v33, v32
    v_and_or_b32 v33, v33, s8, v36
    s_mov_b32 exec_lo, 0x10001
    s_mov_b32 exec_hi, 0x10001
    ds_max_u32 v108, v33
    s_mov_b64 exec, -1
    s_waitcnt lgkmcnt(0)
    s_barrier
    s_cmp_lg_u32 s3, 0
    s_cbranch_scc1 L_b1a
    ds_read_b32 v38, v108
    s_waitcnt lgkmcnt(0)
    s_cmp_eq_u32 s58, 128
    s_cbranch_scc1 L_b1a
    s_mov_b64 exec, 0xffffffff
    buffer_store_dwordx2 v[38:39], v37, s[36:39], s15 offen sc1
    s_mov_b64 exec, -1
L_b1a:
    s_lshl_b32 s63, s3, 1
    s_lshl_b32 s60, s63, 10
    v_lshl_add_u32 v248, v0, 4, s60
    s_add_u32 m0, s60, 32768
    global_load_lds_dwordx4 v248, s[10:11] offset:0
    global_load_lds_dwordx4 v248, s[10:11] offset:1024
    s_and_b32 s63, s3, 1
    s_add_u32 s63, s63, 8
    s_lshl_b32 s60, s63, 10
    v_lshl_add_u32 v248, v0, 4, s60
    s_add_u32 m0, s60, 32768
    global_load_lds_dwordx4 v248, s[10:11] offset:0
    s_lshl_b32 s12, s93, 10
    s_lshl_b32 s13, s94, 10
    buffer_load_dwordx4 v[232:235], v4, s[32:35], s12 offen
    buffer_load_dwordx4 v[236:239], v4, s[32:35], s13 offen
    buffer_load_dwordx4 v[240:243], v4, s[48:51], 0 offen
    v_mov_b32 v104, s91
    v_mov_b32 v105, s92
    v_mov_b32 v106, 0x00010001
    s_branch L_b1
L_p1w:
    s_sub_u32 s96, s3, 4
    s_lshl_b32 s60, s56, 2
    s_mul_i32 s61, s56, 3
    s_add_u32 s61, s61, 4
    s_cmp_lt_u32 s56, 4
    s_cselect_b32 s60, s60, s61
    s_cselect_b32 s61, 16, 12
    s_cmp_ge_u32 s57, s61
    s_cselect_b32 s63, 8, s96
    s_lshr_b32 s61, s57, 2
    s_add_u32 s60, s60, s61
    s_lshl_b32 s6, s60, 7
    s_and_b32 s61, s57, 3
    s_mul_i32 s61, s61, 2
    s_add_u32 s61, s61, s96
    s_lshl_b32 s61, s61, 5
    s_add_u32 s61, s61, 256
    v_lshrrev_b32 v100, 1, v0
    v_add_u32 v100, s61, v100
    v_mul_u32_u24 v100, 3584, v100
    v_and_b32 v101, 1, v0
    v_lshl_add_u32 v100, v101, 6, v100
    s_waitcnt lgkmcnt(0)
    s_mov_b32 s52, s18
    s_mov_b32 s53, s19
    s_mov_b32 s54, 0x1c0000
    s_mov_b32 s55, 0x20000
    s_cmp_ge_u32 s63, 2
    s_cbranch_scc1 L_noapf
    buffer_load_dword v255, v100, s[52:55], s6 offen
L_noapf:
    s_waitcnt lgkmcnt(0)
    s_mov_b32 s32, s4
    s_mov_b32 s33, s5
    s_mov_b32 s34, 0x200000
    s_mov_b32 s35, 0x20000
    s_mov_b32 s36, s30
    s_mov_b32 s37, s31
    s_mov_b32 s38, 0x400000
    s_mov_b32 s39, 0x20000
    s_cmp_lg_u32 s3, 7
    s_cbranch_scc1 L_nomt
    v_mov_b32 v252, s16
    v_mov_b32 v253, s17
    v_writelane_b32 v252, s24, 1
    v_writelane_b32 v253, s25, 1
    v_writelane_b32 v252, s26, 2
    v_writelane_b32 v253, s27, 2
    s_add_u32 s63, s30, 0x3000
    v_writelane_b32 v252, s63, 3
    s_addc_u32 s63, s31, 0
    v_writelane_b32 v253, s63, 3
    s_add_u32 s63, s30, 0x203000
    v_writelane_b32 v252, s63, 4
    s_addc_u32 s63, s31, 0
    v_writelane_b32 v253, s63, 4
    s_mov_b64 exec, 0x1f
    global_load_dword v254, v[252:253], off
    s_mov_b64 exec, -1
L_nomt:
    v_lshlrev_b32 v107, 19, v3
    v_bfe_u32 v108, v0, 2, 2
    v_lshl_add_u32 v107, v108, 13, v107
    v_and_b32 v109, 3, v0
    v_lshl_add_u32 v107, v109, 4, v107
    v_mov_b32 v96, 43008
    v_mov_b32 v98, 0
    v_mov_b32 v99, 0
    ds_write_b64 v96, v[98:99]
    v_lshlrev_b32 v96, 2, v3
    v_cvt_f32_u32 v96, v96
    v_cvt_f32_u32 v97, v2
    v_mul_f32 v97, 0x3d800000, v97
    v_mul_f32 v96, v96, v97
    v_cos_f32 v102, v96
    v_sin_f32 v103, v96
    v_add_f32 v96, v96, v97
    v_cvt_pk_bf16_f32 v40, v102, v103
    v_cvt_pk_bf16_f32 v44, -v103, v102
    v_cos_f32 v102, v96
    v_sin_f32 v103, v96
    v_add_f32 v96, v96, v97
    v_cvt_pk_bf16_f32 v41, v102, v103
    v_cvt_pk_bf16_f32 v45, -v103, v102
    v_cos_f32 v102, v96
    v_sin_f32 v103, v96
    v_add_f32 v96, v96, v97
    v_cvt_pk_bf16_f32 v42, v102, v103
    v_cvt_pk_bf16_f32 v46, -v103, v102
    v_cos_f32 v102, v96
    v_sin_f32 v103, v96
    s_nop 0
    v_cvt_pk_bf16_f32 v43, v102, v103
    v_cvt_pk_bf16_f32 v47, -v103, v102
    v_lshrrev_b32 v96, 1, v109
    v_mul_u32_u24 v96, 3, v96
    v_lshlrev_b32 v97, 1, v3
    v_and_b32 v97, 2, v97
    v_xor_b32 v96, v96, v97
    v_xor_b32 v96, s96, v96
    v_lshl_add_u32 v96, v96, 2, v108
    v_lshlrev_b32 v96, 2, v96
    v_lshl_add_u32 v96, v109, 8, v96
    v_lshl_add_u32 v96, v3, 12, v96
    v_and_b32 v97, 1, v109
    v_lshl_add_u32 v48, v97, 6, v96
    v_xor_b32 v49, 64, v48
    v_add_u32 v50, 128, v48
    v_add_u32 v51, 128, v49
    s_xor_b32 s98, s3, 4
    v_lshl_add_u32 v96, v2, 4, s98
    s_cmp_eq_u32 s98, 0
    s_cselect_b32 s60, 120, 0
    v_subrev_u32 v98, s60, v96
    v_cmp_gt_u32 vcc, 8, v2
    s_nop 1
    v_cndmask_b32 v96, v98, v96, vcc
    v_lshlrev_b32 v98, 2, v3
    v_cvt_f32_u32 v98, v98
    v_cvt_f32_u32 v96, v96
    v_mul_f32 v96, 0x3b800000, v96
    v_mul_f32 v99, v98, v96
    v_cos_f32 v102, v99
    v_sin_f32 v103, v99
    v_add_f32 v99, v99, v96
    v_cvt_pk_bf16_f32 v112, v102, v103
    v_cvt_pk_bf16_f32 v116, -v103, v102
    v_cos_f32 v102, v99
    v_sin_f32 v103, v99
    v_add_f32 v99, v99, v96
    v_cvt_pk_bf16_f32 v113, v102, v103
    v_cvt_pk_bf16_f32 v117, -v103, v102
    v_cos_f32 v102, v99
    v_sin_f32 v103, v99
    v_add_f32 v99, v99, v96
    v_cvt_pk_bf16_f32 v114, v102, v103
    v_cvt_pk_bf16_f32 v118, -v103, v102
    v_cos_f32 v102, v99
    v_sin_f32 v103, v99
    s_nop 0
    v_cvt_pk_bf16_f32 v115, v102, v103
    v_cvt_pk_bf16_f32 v119, -v103, v102
    v_mov_b32 v96, 0x80000000
    v_mov_b32 v97, 0x8000
    v_xor_b32 v120, v96, v112
    v_xor_b32 v124, v97, v116
    v_xor_b32 v121, v96, v113
    v_xor_b32 v125, v97, v117
    v_xor_b32 v122, v96, v114
    v_xor_b32 v126, v97, v118
    v_xor_b32 v123, v96, v115
    v_xor_b32 v127, v97, v119
    s_cmp_lg_u32 s98, 0
    s_cbranch_scc1 L_sp_e
    s_mov_b32 exec_lo, 0x10001
    s_mov_b32 exec_hi, 0x10001
    v_mov_b32 v121, 0xbf80
    v_mov_b32 v125, 0xbf800000
    v_mov_b32 v123, 0xbf80
    v_mov_b32 v127, 0xbf800000
    s_mov_b64 exec, -1
    v_cndmask_b32_e64 v128, v112, 0, vcc
    v_cndmask_b32 v112, 0, v112, vcc
    v_cndmask_b32 v136, 0, v120, vcc
    v_cndmask_b32_e64 v120, v120, 0, vcc
    v_cndmask_b32_e64 v129, v113, 0, vcc
    v_cndmask_b32 v113, 0, v113, vcc
    v_cndmask_b32 v137, 0, v121, vcc
    v_cndmask_b32_e64 v121, v121, 0, vcc
    v_cndmask_b32_e64 v130, v114, 0, vcc
    v_cndmask_b32 v114, 0, v114, vcc
    v_cndmask_b32 v138, 0, v122, vcc
    v_cndmask_b32_e64 v122, v122, 0, vcc
    v_cndmask_b32_e64 v131, v115, 0, vcc
    v_cndmask_b32 v115, 0, v115, vcc
    v_cndmask_b32 v139, 0, v123, vcc
    v_cndmask_b32_e64 v123, v123, 0, vcc
    v_cndmask_b32_e64 v132, v116, 0, vcc
    v_cndmask_b32 v116, 0, v116, vcc
    v_cndmask_b32 v140, 0, v124, vcc
    v_cndmask_b32_e64 v124, v124, 0, vcc
    v_cndmask_b32_e64 v133, v117, 0, vcc
    v_cndmask_b32 v117, 0, v117, vcc
    v_cndmask_b32 v141, 0, v125, vcc
    v_cndmask_b32_e64 v125, v125, 0, vcc
    v_cndmask_b32_e64 v134, v118, 0, vcc
    v_cndmask_b32 v118, 0, v118, vcc
    v_cndmask_b32 v142, 0, v126, vcc
    v_cndmask_b32_e64 v126, v126, 0, vcc
    v_cndmask_b32_e64 v135, v119, 0, vcc
    v_cndmask_b32 v119, 0, v119, vcc
    v_cndmask_b32 v143, 0, v127, vcc
    v_cndmask_b32_e64 v127, v127, 0, vcc
L_sp_e:
    s_sub_u32 s60, 16, s98
    s_cmp_eq_u32 s98, 0
    s_cselect_b32 s60, 8, s60
    v_bfe_u32 v96, v2, 2, 1
    v_xor_b32 v96, v96, v2
    v_lshrrev_b32 v97, 3, v2
    v_mul_u32_u24 v98, 3, v97
    v_xor_b32 v98, v98, v3
    v_lshlrev_b32 v98, 4, v98
    v_lshl_add_u32 v96, v96, 6, v98
    s_lshl_b32 s61, s98, 3
    s_and_b32 s61, s61, 32
    s_lshl_b32 s62, s98, 10
    s_or_b32 s61, s61, s62
    v_xor_b32 v60, s61, v96
    s_lshl_b32 s61, s60, 3
    s_and_b32 s61, s61, 32
    s_lshl_b32 s62, s60, 10
    s_or_b32 s61, s61, s62
    v_xor_b32 v61, s61, v96
    v_lshlrev_b32 v63, 16, v3
    v_lshl_add_u32 v63, v97, 14, v63
    v_and_b32 v96, 7, v2
    v_lshl_add_u32 v63, v96, 4, v63
    s_lshl_b32 s6, s98, 18
    s_lshl_b32 s61, s56, 11
    s_add_u32 s6, s6, s61
    s_lshl_b32 s61, s57, 7
    s_add_u32 s6, s6, s61
    s_add_u32 s6, s6, 0x200000
    s_add_u32 s7, s6, 32768
    v_lshlrev_b32 v4, 5, v2
    v_and_b32 v96, 1, v3
    v_lshl_add_u32 v4, v96, 9, v4
    v_lshrrev_b32 v96, 1, v3
    v_lshl_add_u32 v4, v96, 4, v4
    s_lshl_b32 s60, s3, 8
    s_add_u32 s93, s60, s58
    s_sub_u32 s94, 2048, s93
    s_and_b32 s94, s94, 2047
    s_mov_b32 s48, s24
    s_mov_b32 s49, s25
    s_mov_b32 s50, 0x400
    s_mov_b32 s51, 0x20000
    s_lshl_b32 s12, s96, 15
    s_lshl_b32 s61, s56, 10
    s_add_u32 s12, s12, s61
    s_lshl_b32 s61, s57, 6
    s_add_u32 s12, s12, s61
    s_cmp_eq_u32 s58, 128
    s_cselect_b32 s12, 0x40000000, s12
    s_add_u32 s13, s12, 131072
    s_add_u32 s14, s12, 262144
    s_add_u32 s15, s12, 393216
    s_waitcnt lgkmcnt(0)
    s_barrier
    buffer_load_dwordx4 v[8:11], v107, s[32:35], s12 offen
    buffer_load_dwordx4 v[12:15], v107, s[32:35], s13 offen
    buffer_load_dwordx4 v[16:19], v107, s[32:35], s14 offen
    buffer_load_dwordx4 v[20:23], v107, s[32:35], s15 offen
    s_load_dword s59, s[30:31], 0
    s_lshl_b32 s12, s93, 10
    s_lshl_b32 s13, s94, 10
    buffer_load_dwordx4 v[232:235], v4, s[32:35], s12 offen
    buffer_load_dwordx4 v[236:239], v4, s[32:35], s13 offen
    buffer_load_dwordx4 v[240:243], v4, s[48:51], 0 offen
    s_lshr_b32 s15, s9, 2
    s_add_u32 s15, s15, 32
    s_and_b32 s15, s15, 31
    s_lshl_b32 s15, s15, 11
    s_add_u32 s15, s15, 0x40000
    s_waitcnt lgkmcnt(0)
    s_add_u32 s59, s59, 0x9e3779b9
    s_bitcmp1_b32 s59, 0
    s_cselect_b32 s91, 1, 0x10000
    s_xor_b32 s92, s91, 0x10001
    v_mov_b32 v104, s91
    v_mov_b32 v105, s92
    v_mov_b32 v106, 0x00010001
    v_mov_b32 v184, 0
    v_mov_b32 v185, 0
    v_mov_b32 v186, 0
    v_mov_b32 v187, 0
    s_barrier
    s_waitcnt vmcnt(3)
    v_pk_mov_b32 v[24:25], v[8:9], v[12:13] op_sel:[0,0]
    v_pk_mov_b32 v[26:27], v[16:17], v[20:21] op_sel:[0,0]
    v_pk_mov_b32 v[28:29], v[8:9], v[12:13] op_sel:[1,1]
    v_pk_mov_b32 v[30:31], v[16:17], v[20:21] op_sel:[1,1]
    v_mfma_f32_16x16x32_bf16 v[64:67], v[40:43], v[24:27], 0
    v_mfma_f32_16x16x32_bf16 v[68:71], v[44:47], v[24:27], 0
    v_pk_mov_b32 v[32:33], v[10:11], v[14:15] op_sel:[0,0]
    v_pk_mov_b32 v[34:35], v[18:19], v[22:23] op_sel:[0,0]
    v_mfma_f32_16x16x32_bf16 v[72:75], v[40:43], v[28:31], 0
    v_mfma_f32_16x16x32_bf16 v[76:79], v[44:47], v[28:31], 0
    v_pk_mov_b32 v[36:37], v[10:11], v[14:15] op_sel:[1,1]
    v_pk_mov_b32 v[38:39], v[18:19], v[22:23] op_sel:[1,1]
    v_mfma_f32_16x16x32_bf16 v[80:83], v[40:43], v[32:35], 0
    v_mfma_f32_16x16x32_bf16 v[84:87], v[44:47], v[32:35], 0
    v_mfma_f32_16x16x32_bf16 v[88:91], v[40:43], v[36:39], 0
    v_cvt_pk_bf16_f32 v8, v64, v68
    v_cvt_pk_bf16_f32 v9, v65, v69
    v_mfma_f32_16x16x32_bf16 v[92:95], v[44:47], v[36:39], 0
    ds_write2st64_b32 v48, v8, v9 offset0:0 offset1:4
    v_cvt_pk_bf16_f32 v10, v66, v70
    v_cvt_pk_bf16_f32 v11, v67, v71
    ds_write2st64_b32 v48, v10, v11 offset0:8 offset1:12
    v_cvt_pk_bf16_f32 v12, v72, v76
    v_cvt_pk_bf16_f32 v13, v73, v77
    ds_write2st64_b32 v49, v12, v13 offset0:0 offset1:4
    v_cvt_pk_bf16_f32 v14, v74, v78
    v_cvt_pk_bf16_f32 v15, v75, v79
    ds_write2st64_b32 v49, v14, v15 offset0:8 offset1:12
    v_cvt_pk_bf16_f32 v16, v80, v84
    v_cvt_pk_bf16_f32 v17, v81, v85
    ds_write2st64_b32 v50, v16, v17 offset0:0 offset1:4
    v_cvt_pk_bf16_f32 v18, v82, v86
    v_cvt_pk_bf16_f32 v19, v83, v87
    ds_write2st64_b32 v50, v18, v19 offset0:8 offset1:12
    v_cvt_pk_bf16_f32 v20, v88, v92
    v_cvt_pk_bf16_f32 v21, v89, v93
    ds_write2st64_b32 v51, v20, v21 offset0:0 offset1:4
    v_cvt_pk_bf16_f32 v22, v90, v94
    v_cvt_pk_bf16_f32 v23, v91, v95
    ds_write2st64_b32 v51, v22, v23 offset0:8 offset1:12
    s_waitcnt lgkmcnt(0)
L_b1:
    s_barrier
    s_cmp_eq_u32 s58, 128
    s_cbranch_scc1 L_ack128
    ds_read_b128 v[52:55], v60
    ds_read_b128 v[56:59], v61
    s_mov_b32 vcc_lo, 0x00ff00ff
    s_mov_b32 vcc_hi, 0x00ff00ff
    s_waitcnt lgkmcnt(1)
    v_mfma_f32_16x16x32_bf16 v[64:67], v[112:115], v[52:55], 0
    v_mfma_f32_16x16x32_bf16 v[68:71], v[116:119], v[52:55], 0
    s_waitcnt lgkmcnt(0)
    v_mfma_f32_16x16x32_bf16 v[72:75], v[120:123], v[56:59], 0
    v_mfma_f32_16x16x32_bf16 v[76:79], v[124:127], v[56:59], 0
    s_cmp_lg_u32 s98, 0
    s_cbranch_scc1 L_s2b
    v_mfma_f32_16x16x32_bf16 v[64:67], v[128:131], v[56:59], v[64:67]
    v_mfma_f32_16x16x32_bf16 v[68:71], v[132:135], v[56:59], v[68:71]
    v_mfma_f32_16x16x32_bf16 v[72:75], v[136:139], v[52:55], v[72:75]
    v_mfma_f32_16x16x32_bf16 v[76:79], v[140:143], v[52:55], v[76:79]
L_s2b:
    s_nop 5
    v_cvt_pk_bf16_f32 v96, v64, v68
    v_cvt_pk_bf16_f32 v97, v65, v69
    v_cvt_pk_bf16_f32 v100, v72, v76
    v_cvt_pk_bf16_f32 v101, v73, v77
    v_bitop3_b32 v96, v106, v104, v96 bitop3:0xca
    v_bitop3_b32 v97, v106, v104, v97 bitop3:0xca
    v_bitop3_b32 v100, v106, v105, v100 bitop3:0xca
    v_bitop3_b32 v101, v106, v105, v101 bitop3:0xca
    v_cndmask_b32_dpp v80, v97, v96, vcc row_ror:8 row_mask:0xf bank_mask:0xf
    s_nop 0
    v_cndmask_b32_dpp v81, v101, v100, vcc row_ror:8 row_mask:0xf bank_mask:0xf
    s_not_b64 vcc, vcc
    v_cndmask_b32_dpp v82, v96, v97, vcc row_ror:8 row_mask:0xf bank_mask:0xf
    v_cndmask_b32_dpp v83, v100, v101, vcc row_ror:8 row_mask:0xf bank_mask:0xf
    buffer_store_dwordx4 v[80:83], v63, s[36:39], s6 offen sc1
    v_cvt_pk_bf16_f32 v98, v66, v70
    v_cvt_pk_bf16_f32 v99, v67, v71
    v_cvt_pk_bf16_f32 v102, v74, v78
    v_cvt_pk_bf16_f32 v103, v75, v79
    v_bitop3_b32 v98, v106, v104, v98 bitop3:0xca
    v_bitop3_b32 v99, v106, v104, v99 bitop3:0xca
    v_bitop3_b32 v102, v106, v105, v102 bitop3:0xca
    v_bitop3_b32 v103, v106, v105, v103 bitop3:0xca
    v_cndmask_b32_dpp v86, v98, v99, vcc row_ror:8 row_mask:0xf bank_mask:0xf
    s_nop 0
    v_cndmask_b32_dpp v87, v102, v103, vcc row_ror:8 row_mask:0xf bank_mask:0xf
    s_not_b64 vcc, vcc
    v_cndmask_b32_dpp v84, v99, v98, vcc row_ror:8 row_mask:0xf bank_mask:0xf
    v_cndmask_b32_dpp v85, v103, v102, vcc row_ror:8 row_mask:0xf bank_mask:0xf
    buffer_store_dwordx4 v[84:87], v63, s[36:39], s7 offen sc1
L_nos2:
    v_lshrrev_b32 v96, 1, v2
    v_lshlrev_b32 v96, 8, v96
    v_add_u32 v96, s58, v96
    v_and_b32 v97, 1, v2
    v_lshlrev_b32 v98, 1, v3
    v_mul_u32_u24 v98, v98, v96
    v_cmp_eq_u32 vcc, 0, v97
    v_and_b32 v99, 2047, v98
    v_add_u32 v98, v98, v96
    v_cvt_f32_u32 v99, v99
    v_mul_f32 v99, 0x3a000000, v99
    v_cos_f32 v100, v99
    v_sin_f32 v101, v99
    v_mul_f32 v100, 0.5, v100
    v_mul_f32 v101, 0.5, v101
    v_cndmask_b32_e64 v102, -v101, v100, vcc
    v_cndmask_b32 v103, v100, v101, vcc
    v_cvt_pk_bf16_f32 v144, v102, v103
    v_cvt_pk_bf16_f32 v148, -v103, v102
    v_cndmask_b32 v102, v101, v100, vcc
    v_cndmask_b32_e64 v103, -v100, v101, vcc
    v_cvt_pk_bf16_f32 v145, v102, -v103
    v_cvt_pk_bf16_f32 v149, -v103, -v102
    s_and_b32 s60, s58, 127
    s_cbranch_scc1 L_ac_a10
    v_add_f32 v100, v100, v100
    v_add_f32 v101, v101, v101
    v_cndmask_b32 v102, 0, v100, vcc
    v_sub_f32 v103, v100, v102
    v_cvt_pk_bf16_f32 v100, v102, v103
    v_cndmask_b32 v102, 0, v101, vcc
    v_sub_f32 v103, v101, v102
    v_cvt_pk_bf16_f32 v101, -v102, -v103
    s_cmp_eq_u32 s58, 0
    s_cselect_b32 s60, -1, 0
    s_cselect_b32 s61, 0, -1
    v_and_b32 v144, s60, v100
    v_and_b32 v148, s60, v101
    v_and_b32 v145, s61, v100
    v_and_b32 v149, s61, v101
L_ac_a10:
    v_and_b32 v99, 2047, v98
    v_cvt_f32_u32 v99, v99
    v_mul_f32 v99, 0x3a000000, v99
    v_cos_f32 v100, v99
    v_sin_f32 v101, v99
    v_mul_f32 v100, 0.5, v100
    v_mul_f32 v101, 0.5, v101
    v_cndmask_b32_e64 v102, -v101, v100, vcc
    v_cndmask_b32 v103, v100, v101, vcc
    v_cvt_pk_bf16_f32 v146, v102, v103
    v_cvt_pk_bf16_f32 v150, -v103, v102
    v_cndmask_b32 v102, v101, v100, vcc
    v_cndmask_b32_e64 v103, -v100, v101, vcc
    v_cvt_pk_bf16_f32 v147, v102, -v103
    v_cvt_pk_bf16_f32 v151, -v103, -v102
    s_and_b32 s60, s58, 127
    s_cbranch_scc1 L_ac_a11
    v_add_f32 v100, v100, v100
    v_add_f32 v101, v101, v101
    v_cndmask_b32 v102, 0, v100, vcc
    v_sub_f32 v103, v100, v102
    v_cvt_pk_bf16_f32 v100, v102, v103
    v_cndmask_b32 v102, 0, v101, vcc
    v_sub_f32 v103, v101, v102
    v_cvt_pk_bf16_f32 v101, -v102, -v103
    s_cmp_eq_u32 s58, 0
    s_cselect_b32 s60, -1, 0
    s_cselect_b32 s61, 0, -1
    v_and_b32 v146, s60, v100
    v_and_b32 v150, s60, v101
    v_and_b32 v147, s61, v100
    v_and_b32 v151, s61, v101
L_ac_a11:
    v_lshlrev_b32 v5, 12, v3
    v_lshl_add_u32 v5, v2, 4, v5
    v_lshrrev_b32 v96, 2, v2
    v_xor_b32 v96, v96, v3
    v_and_b32 v96, 1, v96
    v_bfe_u32 v97, v2, 1, 1
    v_lshl_or_b32 v96, v96, 1, v97
    s_lshr_b32 s60, s3, 1
    v_xor_b32 v96, s60, v96
    v_lshlrev_b32 v96, 4, v96
    v_and_b32 v98, 7, v2
    v_lshl_add_u32 v96, v98, 6, v96
    v_lshl_add_u32 v96, v3, 12, v96
    v_lshrrev_b32 v98, 3, v2
    v_lshl_add_u32 v96, v98, 2, v96
    s_and_b32 s60, s3, 1
    s_lshl_b32 s60, s60, 3
    s_add_u32 s60, s60, 16384
    v_add_u32 v6, s60, v96
    v_xor_b32 v7, 48, v6
    v_bfe_u32 v96, v2, 2, 1
    v_xor_b32 v96, v96, v98
    v_lshl_or_b32 v96, v96, 1, v98
    v_xor_b32 v96, v96, v97
    v_xor_b32 v96, v96, v3
    v_lshlrev_b32 v96, 4, v96
    v_lshl_add_u32 v62, v2, 6, v96
    s_lshl_b32 s60, s3, 4
    s_and_b32 s60, s60, 32
    v_xor_b32 v62, s60, v62
    s_lshl_b32 s60, s3, 11
    s_add_u32 s60, s60, 16384
    v_add_u32 v62, s60, v62
    s_lshl_b32 s14, s9, 14
    s_lshl_b32 s60, s3, 8
    s_add_u32 s14, s14, s60
    s_add_u32 s14, s14, 0x200000
    s_mov_b32 s40, s26
    s_mov_b32 s41, s27
    s_mov_b32 s42, 0x200000
    s_mov_b32 s43, 0x20000
    s_waitcnt vmcnt(2)
    s_cmp_lg_u32 s58, 128
    s_cbranch_scc1 L_a7
    s_waitcnt vmcnt(0)
L_a7:
    v_dot2_f32_bf16 v110, v232, v240, 0
    v_dot2_f32_bf16 v111, v236, v240, 0
    v_dot2_f32_bf16 v110, v233, v241, v110
    v_dot2_f32_bf16 v111, v237, v241, v111
    v_dot2_f32_bf16 v110, v234, v242, v110
    v_dot2_f32_bf16 v111, v238, v242, v111
    v_dot2_f32_bf16 v110, v235, v243, v110
    v_dot2_f32_bf16 v111, v239, v243, v111
    v_permlane16_swap_b32 v232, v234
    v_permlane16_swap_b32 v233, v235
    v_permlane16_swap_b32 v236, v238
    v_permlane16_swap_b32 v237, v239
    v_permlane32_swap_b32 v110, v111
    v_add_f32 v110, v110, v111
    v_mov_b32 v111, v110
    s_nop 1
    v_permlane16_swap_b32 v110, v111
    v_add_f32 v110, v110, v111
    s_nop 1
    v_add_f32_dpp v110, v110, v110 row_ror:8 row_mask:0xf bank_mask:0xf
    v_lshlrev_b32 v216, 16, v232
    v_and_b32 v217, 0xffff0000, v232
    v_add_f32_dpp v110, v110, v110 row_ror:4 row_mask:0xf bank_mask:0xf
    v_lshlrev_b32 v218, 16, v233
    v_and_b32 v219, 0xffff0000, v233
    v_add_f32_dpp v110, v110, v110 row_ror:2 row_mask:0xf bank_mask:0xf
    v_lshlrev_b32 v220, 16, v234
    v_and_b32 v221, 0xffff0000, v234
    v_add_f32_dpp v110, v110, v110 row_ror:1 row_mask:0xf bank_mask:0xf
    v_lshlrev_b32 v222, 16, v235
    v_and_b32 v223, 0xffff0000, v235
    v_mul_f32 v110, 0xbfb8aa3b, v110
    v_lshlrev_b32 v224, 16, v236
    v_and_b32 v225, 0xffff0000, v236
    v_exp_f32 v110, v110
    v_lshlrev_b32 v226, 16, v237
    v_and_b32 v227, 0xffff0000, v237
    v_add_f32 v110, 1.0, v110
    v_lshlrev_b32 v228, 16, v238
    v_and_b32 v229, 0xffff0000, v238
    v_rcp_f32 v110, v110
    v_lshlrev_b32 v230, 16, v239
    v_and_b32 v231, 0xffff0000, v239
    v_mov_b32 v111, v110
    s_nop 1
    v_permlane32_swap_b32 v110, v111
    v_sub_f32 v96, 1.0, v110
    v_sub_f32 v97, 1.0, v111
    v_pk_mul_f32 v[216:217], v[216:217], v[96:97] op_sel:[0,0] op_sel_hi:[1,0]
    v_pk_mul_f32 v[218:219], v[218:219], v[96:97] op_sel:[0,0] op_sel_hi:[1,0]
    v_pk_mul_f32 v[220:221], v[220:221], v[96:97] op_sel:[0,0] op_sel_hi:[1,0]
    v_pk_mul_f32 v[222:223], v[222:223], v[96:97] op_sel:[0,0] op_sel_hi:[1,0]
    v_pk_mul_f32 v[224:225], v[224:225], v[96:97] op_sel:[0,1] op_sel_hi:[1,1]
    v_pk_mul_f32 v[226:227], v[226:227], v[96:97] op_sel:[0,1] op_sel_hi:[1,1]
    v_pk_mul_f32 v[228:229], v[228:229], v[96:97] op_sel:[0,1] op_sel_hi:[1,1]
    v_pk_mul_f32 v[230:231], v[230:231], v[96:97] op_sel:[0,1] op_sel_hi:[1,1]
    v_mov_b32 v109, 43016
    s_cmp_lg_u32 s3, 7
    s_cbranch_scc1 L_a5
    s_waitcnt vmcnt(0)
L_kd:
    buffer_load_dwordx4 v[128:131], v247, s[36:39], s15 offen sc1
    s_waitcnt vmcnt(0)
    v_xor_b32 v129, s59, v129
    v_bitop3_b32 v129, v131, s59, v129 bitop3:0xbe
    v_cmp_ne_u32 vcc, 0, v129
    v_max_u32 v128, v128, v130
    s_nop 0
    s_cbranch_vccz L_kd_ok
    s_sleep 2
    s_sub_u32 s90, s90, 1
    s_cbranch_scc0 L_kd
    s_mov_b32 s90, 0
L_kd_ok:
    v_max_u32_dpp v128, v128, v128 row_ror:8 row_mask:0xf bank_mask:0xf
    s_nop 1
    v_max_u32_dpp v128, v128, v128 row_ror:4 row_mask:0xf bank_mask:0xf
    s_nop 1
    v_max_u32_dpp v128, v128, v128 row_ror:2 row_mask:0xf bank_mask:0xf
    s_nop 1
    v_max_u32_dpp v128, v128, v128 row_ror:1 row_mask:0xf bank_mask:0xf
    s_nop 0
    v_readlane_b32 s97, v128, 0
    v_readlane_b32 s60, v128, 16
    v_readlane_b32 s61, v128, 32
    v_readlane_b32 s62, v128, 48
    s_max_u32 s97, s97, s60
    s_max_u32 s61, s61, s62
    s_max_u32 s97, s97, s61
    s_and_b32 s97, s97, 2047
    v_mov_b32 v108, s97
    ds_write_b32 v109, v108
    s_waitcnt lgkmcnt(0)
L_a5:
    s_barrier
    buffer_load_dwordx4 v[8:11], v5, s[36:39], s14 offen offset:0 sc1
    buffer_load_dwordx4 v[12:15], v5, s[36:39], s14 offen offset:2048 sc1
    ds_read_b32 v109, v109
    ds_read_b128 v[200:203], v247 offset:34816
    ds_read_b128 v[204:207], v247 offset:35840
    ds_read_b128 v[208:211], v247 offset:36864
    ds_read_b128 v[212:215], v247 offset:37888
    ds_read_b128 v[152:155], v247 offset:32768
    ds_read_b128 v[156:159], v247 offset:33792
    ds_read_b128 v[168:171], v247 offset:38912
    ds_read_b128 v[172:175], v247 offset:39936
    ds_read_b128 v[176:179], v247 offset:40960
    ds_read_b128 v[180:183], v247 offset:41984
    s_waitcnt lgkmcnt(0)
    v_readfirstlane_b32 s97, v109
    v_pk_mul_f32 v[184:185], v[200:201], v[110:111] op_sel:[0,0] op_sel_hi:[1,0]
    v_pk_mul_f32 v[186:187], v[202:203], v[110:111] op_sel:[0,0] op_sel_hi:[1,0]
    v_pk_mul_f32 v[188:189], v[204:205], v[110:111] op_sel:[0,0] op_sel_hi:[1,0]
    v_pk_mul_f32 v[190:191], v[206:207], v[110:111] op_sel:[0,0] op_sel_hi:[1,0]
    v_pk_mul_f32 v[192:193], v[208:209], v[110:111] op_sel:[0,0] op_sel_hi:[1,0]
    v_pk_mul_f32 v[194:195], v[210:211], v[110:111] op_sel:[0,0] op_sel_hi:[1,0]
    v_pk_mul_f32 v[196:197], v[212:213], v[110:111] op_sel:[0,0] op_sel_hi:[1,0]
    v_pk_mul_f32 v[198:199], v[214:215], v[110:111] op_sel:[0,0] op_sel_hi:[1,0]
    v_pk_mul_f32 v[200:201], v[200:201], v[110:111] op_sel:[0,1] op_sel_hi:[1,1]
    v_pk_mul_f32 v[202:203], v[202:203], v[110:111] op_sel:[0,1] op_sel_hi:[1,1]
    v_pk_mul_f32 v[204:205], v[204:205], v[110:111] op_sel:[0,1] op_sel_hi:[1,1]
    v_pk_mul_f32 v[206:207], v[206:207], v[110:111] op_sel:[0,1] op_sel_hi:[1,1]
    v_pk_mul_f32 v[208:209], v[208:209], v[110:111] op_sel:[0,1] op_sel_hi:[1,1]
    v_pk_mul_f32 v[210:211], v[210:211], v[110:111] op_sel:[0,1] op_sel_hi:[1,1]
    v_pk_mul_f32 v[212:213], v[212:213], v[110:111] op_sel:[0,1] op_sel_hi:[1,1]
    v_pk_mul_f32 v[214:215], v[214:215], v[110:111] op_sel:[0,1] op_sel_hi:[1,1]
    v_mov_b32 v96, 0x80000000
    v_xor_b32 v160, v96, v152
    v_xor_b32 v164, v96, v156
    v_xor_b32 v161, v96, v153
    v_xor_b32 v165, v96, v157
    v_xor_b32 v162, v96, v154
    v_xor_b32 v166, v96, v158
    v_xor_b32 v163, v96, v155
    v_xor_b32 v167, v96, v159
    s_branch L_a_pw
L_a_pl:
    buffer_load_dwordx4 v[8:11], v5, s[36:39], s14 offen offset:0 sc1
    buffer_load_dwordx4 v[12:15], v5, s[36:39], s14 offen offset:2048 sc1
L_a_pw:
    s_waitcnt vmcnt(0)
    v_swap_b32 v10, v12
    v_swap_b32 v11, v13
    v_xor_b32 v96, v104, v8
    v_xor_b32 v97, v105, v9
    v_mfma_f32_16x16x32_bf16 v[64:67], v[144:147], v[8:11], 0
    v_bitop3_b32 v96, v10, v104, v96 bitop3:0xbe
    v_bitop3_b32 v97, v11, v105, v97 bitop3:0xbe
    v_mfma_f32_16x16x32_bf16 v[68:71], v[148:151], v[8:11], 0
    v_bitop3_b32 v96, v12, v104, v96 bitop3:0xbe
    v_bitop3_b32 v97, v13, v105, v97 bitop3:0xbe
    v_mfma_f32_16x16x32_bf16 v[72:75], v[144:147], v[12:15], 0
    v_bitop3_b32 v96, v14, v104, v96 bitop3:0xbe
    v_bitop3_b32 v97, v15, v105, v97 bitop3:0xbe
    v_mfma_f32_16x16x32_bf16 v[76:79], v[148:151], v[12:15], 0
    v_bitop3_b32 v96, v96, v97, v106 bitop3:0xa8
    v_cmp_ne_u32 vcc, 0, v96
    s_nop 0
    s_cbranch_vccz L_a_pl_ok
    s_sleep 1
    s_sub_u32 s90, s90, 1
    s_cbranch_scc0 L_a_pl
    s_mov_b32 s90, 0
L_a_pl_ok:
    v_cvt_pk_bf16_f32 v16, v64, v68
    v_cvt_pk_bf16_f32 v17, v65, v69
    ds_write2st64_b32 v6, v16, v17 offset0:0 offset1:4
    v_cvt_pk_bf16_f32 v18, v66, v70
    v_cvt_pk_bf16_f32 v19, v67, v71
    ds_write2st64_b32 v6, v18, v19 offset0:8 offset1:12
    v_cvt_pk_bf16_f32 v20, v72, v76
    v_cvt_pk_bf16_f32 v21, v73, v77
    ds_write2st64_b32 v7, v20, v21 offset0:2 offset1:6
    v_cvt_pk_bf16_f32 v22, v74, v78
    v_cvt_pk_bf16_f32 v23, v75, v79
    ds_write2st64_b32 v7, v22, v23 offset0:10 offset1:14
    s_waitcnt lgkmcnt(0)
    s_barrier
    ds_read_b128 v[16:19], v62 offset:0
    ds_read_b128 v[20:23], v62 offset:1024
    s_waitcnt lgkmcnt(1)
    v_mfma_f32_16x16x32_bf16 v[64:67], v[16:19], v[152:155], 0
    v_mfma_f32_16x16x32_bf16 v[68:71], v[16:19], v[156:159], 0
    s_waitcnt lgkmcnt(0)
    v_mfma_f32_16x16x32_bf16 v[72:75], v[20:23], v[152:155], 0
    v_mfma_f32_16x16x32_bf16 v[76:79], v[20:23], v[156:159], 0
    v_mfma_f32_16x16x32_bf16 v[80:83], v[16:19], v[160:163], 0
    s_nop 2
    v_pk_mul_f32 v[96:97], v[64:65], v[184:185]
    v_pk_mul_f32 v[100:101], v[68:69], v[184:185]
    v_mfma_f32_16x16x32_bf16 v[84:87], v[16:19], v[164:167], 0
    v_pk_mul_f32 v[98:99], v[66:67], v[186:187]
    v_pk_mul_f32 v[102:103], v[70:71], v[186:187]
    v_pk_fma_f32 v[96:97], v[68:69], v[188:189], v[96:97]
    v_pk_fma_f32 v[100:101], v[64:65], v[188:189], v[100:101] neg_lo:[1,0,0] neg_hi:[1,0,0]
    v_mfma_f32_16x16x32_bf16 v[88:91], v[20:23], v[160:163], 0
    v_pk_fma_f32 v[98:99], v[70:71], v[190:191], v[98:99]
    v_pk_fma_f32 v[102:103], v[66:67], v[190:191], v[102:103] neg_lo:[1,0,0] neg_hi:[1,0,0]
    v_cvt_pk_bf16_f32 v112, v96, v100
    v_cvt_pk_bf16_f32 v113, v97, v101
    v_mfma_f32_16x16x32_bf16 v[92:95], v[20:23], v[164:167], 0
    v_cvt_pk_bf16_f32 v114, v98, v102
    v_cvt_pk_bf16_f32 v115, v99, v103
    v_pk_mul_f32 v[96:97], v[72:73], v[192:193]
    v_pk_mul_f32 v[100:101], v[76:77], v[192:193]
    v_mfma_f32_16x16x32_bf16 v[232:235], v[112:115], v[168:171], v[216:219]
    v_pk_mul_f32 v[98:99], v[74:75], v[194:195]
    v_pk_mul_f32 v[102:103], v[78:79], v[194:195]
    v_pk_fma_f32 v[96:97], v[76:77], v[196:197], v[96:97]
    v_pk_fma_f32 v[100:101], v[72:73], v[196:197], v[100:101] neg_lo:[1,0,0] neg_hi:[1,0,0]
    v_mfma_f32_16x16x32_bf16 v[236:239], v[112:115], v[172:175], v[220:223]
    v_pk_fma_f32 v[98:99], v[78:79], v[198:199], v[98:99]
    v_pk_fma_f32 v[102:103], v[74:75], v[198:199], v[102:103] neg_lo:[1,0,0] neg_hi:[1,0,0]
    v_cvt_pk_bf16_f32 v116, v96, v100
    v_cvt_pk_bf16_f32 v117, v97, v101
    v_cvt_pk_bf16_f32 v118, v98, v102
    v_cvt_pk_bf16_f32 v119, v99, v103
    v_pk_mul_f32 v[96:97], v[80:81], v[200:201]
    v_pk_mul_f32 v[100:101], v[84:85], v[200:201]
    v_mfma_f32_16x16x32_bf16 v[232:235], v[116:119], v[176:179], v[232:235]
    v_pk_mul_f32 v[98:99], v[82:83], v[202:203]
    v_pk_mul_f32 v[102:103], v[86:87], v[202:203]
    v_pk_fma_f32 v[96:97], v[84:85], v[204:205], v[96:97]
    v_pk_fma_f32 v[100:101], v[80:81], v[204:205], v[100:101] neg_lo:[1,0,0] neg_hi:[1,0,0]
    v_mfma_f32_16x16x32_bf16 v[236:239], v[116:119], v[180:183], v[236:239]
    v_pk_fma_f32 v[98:99], v[86:87], v[206:207], v[98:99]
    v_pk_fma_f32 v[102:103], v[82:83], v[206:207], v[102:103] neg_lo:[1,0,0] neg_hi:[1,0,0]
    v_cvt_pk_bf16_f32 v120, v96, v100
    v_cvt_pk_bf16_f32 v121, v97, v101
    v_cvt_pk_bf16_f32 v122, v98, v102
    v_cvt_pk_bf16_f32 v123, v99, v103
    v_pk_mul_f32 v[96:97], v[88:89], v[208:209]
    v_pk_mul_f32 v[100:101], v[92:93], v[208:209]
    v_mfma_f32_16x16x32_bf16 v[240:243], v[120:123], v[168:171], v[224:227]
    v_pk_mul_f32 v[98:99], v[90:91], v[210:211]
    v_pk_mul_f32 v[102:103], v[94:95], v[210:211]
    v_pk_fma_f32 v[96:97], v[92:93], v[212:213], v[96:97]
    v_pk_fma_f32 v[100:101], v[88:89], v[212:213], v[100:101] neg_lo:[1,0,0] neg_hi:[1,0,0]
    v_mfma_f32_16x16x32_bf16 v[244:247], v[120:123], v[172:175], v[228:231]
    v_pk_fma_f32 v[98:99], v[94:95], v[214:215], v[98:99]
    v_pk_fma_f32 v[102:103], v[90:91], v[214:215], v[102:103] neg_lo:[1,0,0] neg_hi:[1,0,0]
    v_cvt_pk_bf16_f32 v124, v96, v100
    v_cvt_pk_bf16_f32 v125, v97, v101
    v_cvt_pk_bf16_f32 v126, v98, v102
    v_cvt_pk_bf16_f32 v127, v99, v103
    v_cvt_pk_bf16_f32 v8, v232, v233
    v_cvt_pk_bf16_f32 v9, v234, v235
    v_mfma_f32_16x16x32_bf16 v[240:243], v[124:127], v[176:179], v[240:243]
    v_cvt_pk_bf16_f32 v10, v236, v237
    v_cvt_pk_bf16_f32 v11, v238, v239
    v_mfma_f32_16x16x32_bf16 v[244:247], v[124:127], v[180:183], v[244:247]
    v_permlane16_swap_b32 v8, v10
    v_permlane16_swap_b32 v9, v11
    s_cmp_eq_u32 s93, s97
    s_nop 0
    s_cbranch_scc1 L_sk1
    buffer_store_dwordx4 v[8:11], v4, s[40:43], s12 offen sc1
L_sk1:
    v_cvt_pk_bf16_f32 v12, v240, v241
    v_cvt_pk_bf16_f32 v13, v242, v243
    s_nop 0
    v_cvt_pk_bf16_f32 v14, v244, v245
    v_cvt_pk_bf16_f32 v15, v246, v247
    s_nop 0
    v_permlane16_swap_b32 v12, v14
    v_permlane16_swap_b32 v13, v15
    s_cmp_eq_u32 s94, s97
    s_cbranch_scc1 L_sk2
    s_and_b32 s60, s58, 127
    s_cbranch_scc0 L_sk2
    buffer_store_dwordx4 v[12:15], v4, s[40:43], s13 offen sc1
L_sk2:
    s_endpgm
L_ack128:
    s_mov_b64 exec, 1
    v_mov_b32 v96, 0x1000
    v_mov_b32 v97, s59
    buffer_store_dword v97, v96, s[36:39], 0 offen sc1
    s_mov_b64 exec, -1
    s_branch L_nos2
L_low:
    s_lshl_b32 s60, s56, 3
    s_mul_i32 s62, s56, 6
    s_add_u32 s62, s62, 8
    s_cmp_lt_u32 s56, 4
    s_cselect_b32 s60, s60, s62
    s_cselect_b32 s61, 8, 6
    s_and_b32 s62, s57, 7
    s_add_u32 s58, s60, s62
    s_cmp_ge_u32 s62, s61
    s_cbranch_scc1 L_misc
    s_cmp_lt_u32 s57, 8
    s_cbranch_scc1 L_f
    v_lshrrev_b32 v4, 1, v0
    v_and_b32 v5, 1, v0
    v_lshlrev_b32 v5, 6, v5
    s_lshl_b32 s61, s3, 5
    v_add_u32 v4, s61, v4
    v_mul_u32_u24 v4, 3584, v4
    v_add_u32 v4, v4, v5
    s_lshr_b32 s60, s58, 1
    s_lshl_b32 s60, s60, 7
    s_bitcmp1_b32 s58, 0
    s_cselect_b32 s61, 917504, 0
    s_cselect_b32 s62, 458752, 0
    s_add_u32 s61, s61, s60
    s_add_u32 s62, s62, s60
    s_waitcnt lgkmcnt(0)
    s_mov_b32 s44, s18
    s_mov_b32 s45, s19
    s_mov_b32 s46, 0x1c0000
    s_mov_b32 s47, 0x20000
    s_mov_b32 s48, s20
    s_mov_b32 s49, s21
    s_mov_b32 s50, 0x1c0000
    s_mov_b32 s51, 0x20000
    buffer_load_dword v8, v4, s[48:51], s61 offen
    s_barrier
    s_cmp_ge_u32 s3, 4
    s_cbranch_scc1 L_end
    buffer_load_dword v10, v4, s[44:47], s62 offen
    s_endpgm
L_misc:
    s_cmp_eq_u32 s57, 7
    s_cbranch_scc1 L_fin
    s_cmp_eq_u32 s57, 14
    s_cbranch_scc1 L_fin
    s_cmp_eq_u32 s57, 15
    s_cbranch_scc1 L_w
    s_cmp_lg_u32 s56, 4
    s_cbranch_scc1 L_end
    s_mov_b32 s58, 128
    s_mov_b32 s9, 0
    s_mov_b32 s57, 15
    s_branch L_a
L_w:
    s_endpgm
    s_and_b32 s60, s56, 3
    s_lshl3_add_u32 s60, s60, s3
    s_lshl_b32 s61, s60, 12
    s_add_u32 s61, s61, 0x40000
    v_lshlrev_b32 v4, 6, v2
    v_lshl_add_u32 v4, v3, 11, v4
    v_lshlrev_b32 v6, 6, v0
    v_mov_b32 v5, 0
    s_waitcnt lgkmcnt(0)
    s_mov_b32 s36, s30
    s_mov_b32 s37, s31
    s_mov_b32 s38, 0x400000
    s_mov_b32 s39, 0x20000
    s_mov_b32 exec_hi, 0
    buffer_atomic_or v5, v4, s[36:39], s61 offen sc1
    s_cmp_lg_u32 s60, 0
    s_cbranch_scc1 L_end
    s_movk_i32 s61, 0x2000
    buffer_atomic_or v5, v6, s[36:39], s61 offen sc1
    s_endpgm
L_f:
    s_lshr_b32 s95, s58, 1
    s_xor_b32 s98, s3, 7
    v_lshrrev_b32 v8, 3, v0
    v_and_b32 v9, 2, v8
    v_and_b32 v10, 7, v0
    v_xor_b32 v9, v9, v10
    v_lshlrev_b32 v9, 4, v9
    v_lshl_add_u32 v5, v8, 10, v9
    v_xor_b32 v6, 64, v5
    s_lshl_b32 s13, s58, 15
    s_lshl_b32 s61, s3, 7
    s_add_u32 s13, s13, s61
    s_lshl_b32 s6, s3, 12
    s_add_u32 s6, s6, 65536
    s_waitcnt lgkmcnt(0)
    s_load_dword s59, s[30:31], 0
    s_mov_b32 s32, s4
    s_mov_b32 s33, s5
    s_mov_b32 s34, 0x200000
    s_mov_b32 s35, 0x20000
    s_mov_b32 s36, s30
    s_mov_b32 s37, s31
    s_mov_b32 s38, 0x400000
    s_mov_b32 s39, 0x20000
    s_mov_b32 s52, s22
    s_mov_b32 s53, s23
    s_mov_b32 s54, 0x1c0000
    s_mov_b32 s55, 0x20000
    s_waitcnt lgkmcnt(0)
    s_add_u32 s59, s59, 0x9e3779b9
    s_bitcmp1_b32 s59, 0
    s_cselect_b32 s91, 1, 0x10000
    s_xor_b32 s92, s91, 0x10001
    s_add_u32 m0, s6, 0
    s_nop 0
    buffer_load_dwordx4 v5, s[52:55], s13 offen lds
    s_add_u32 s13, s13, 8192
    s_add_u32 m0, s6, 1024
    s_nop 0
    buffer_load_dwordx4 v6, s[52:55], s13 offen lds
    s_add_u32 s13, s13, 8192
    s_add_u32 m0, s6, 2048
    s_nop 0
    buffer_load_dwordx4 v5, s[52:55], s13 offen lds
    s_add_u32 s13, s13, 8192
    s_add_u32 m0, s6, 3072
    s_nop 0
    buffer_load_dwordx4 v6, s[52:55], s13 offen lds
    s_cmp_lt_u32 s98, 4
    s_cselect_b32 s44, s18, s20
    s_cselect_b32 s45, s19, s21
    s_mov_b32 s46, 0x1c0000
    s_mov_b32 s47, 0x20000
    v_lshrrev_b32 v8, 2, v0
    v_mul_u32_u24 v4, 3584, v8
    v_lshrrev_b32 v8, 2, v8
    v_and_b32 v8, 2, v8
    v_and_b32 v9, 3, v0
    v_xor_b32 v8, v8, v9
    v_lshl_add_u32 v4, v8, 4, v4
    s_and_b32 s60, s98, 3
    s_mul_i32 s12, s60, 458752
    s_lshl_b32 s61, s58, 6
    s_add_u32 s12, s12, s61
    s_lshl_b32 s14, s3, 13
    v_lshrrev_b32 v8, 2, v2
    v_lshl_add_u32 v9, v3, 3, v8
    v_and_b32 v10, 3, v0
    v_lshlrev_b32 v10, 3, v10
    v_and_b32 v11, 1, v3
    v_lshl_add_u32 v7, v9, 6, v10
    v_lshl_add_u32 v7, v11, 5, v7
    v_add_u32 v7, s14, v7
    v_xor_b32 v12, 32, v7
    v_lshrrev_b32 v8, 1, v8
    v_lshl_add_u32 v8, v11, 1, v8
    v_lshl_add_u32 v112, v9, 7, v10
    v_lshl_add_u32 v112, v8, 5, v112
    v_add_u32 v112, s6, v112
    v_xor_b32 v113, 32, v112
    v_xor_b32 v114, 64, v112
    v_xor_b32 v115, 96, v112
    s_and_b32 s60, s98, 3
    s_lshl_b32 s60, s60, 8
    s_add_u32 s60, s60, 98304
    v_lshlrev_b32 v14, 4, v3
    v_add_u32 v15, s60, v14
    s_lshl_b32 s60, s98, 7
    s_add_u32 s60, s60, 99328
    v_add_u32 v107, s60, v14
    v_lshl_add_u32 v111, v3, 5, v10
    v_add_u32 v111, 99328, v111
    v_lshlrev_b32 v108, 3, v3
    v_lshl_add_u32 v108, v2, 5, v108
    s_mul_i32 s8, s3, 7168
    s_lshl_b32 s61, s58, 7
    s_add_u32 s8, s8, s61
    s_add_u32 s8, s8, 0x10000
    s_and_b32 s15, s95, 31
    s_lshl_b32 s15, s15, 11
    s_add_u32 s15, s15, 0x40000
    v_lshlrev_b32 v134, 3, v0
    v_lshlrev_b32 v133, 4, v0
    v_mov_b32 v104, s91
    v_mov_b32 v105, s92
    v_mov_b32 v106, 0x00010001
    s_lshl_b32 s7, s58, 2
    s_add_u32 s7, s7, 0x2000
    v_lshlrev_b32 v122, 8, v0
    v_mov_b32 v123, s59
    s_cmp_lg_u32 s3, 2
    s_cbranch_scc1 L_f1
    s_waitcnt vmcnt(0)
    s_barrier
    s_add_u32 m0, s14, 0
    s_nop 0
    buffer_load_dwordx4 v4, s[44:47], s12 offen lds
    s_add_u32 s12, s12, 57344
    s_add_u32 m0, s14, 1024
    s_nop 0
    buffer_load_dwordx4 v4, s[44:47], s12 offen lds
    s_add_u32 s12, s12, 57344
    s_add_u32 m0, s14, 2048
    s_nop 0
    buffer_load_dwordx4 v4, s[44:47], s12 offen lds
    s_add_u32 s12, s12, 57344
    s_add_u32 m0, s14, 3072
    s_nop 0
    buffer_load_dwordx4 v4, s[44:47], s12 offen lds
    s_add_u32 s12, s12, 57344
    s_add_u32 m0, s14, 4096
    s_nop 0
    buffer_load_dwordx4 v4, s[44:47], s12 offen lds
    s_add_u32 s12, s12, 57344
    s_add_u32 m0, s14, 5120
    s_nop 0
    buffer_load_dwordx4 v4, s[44:47], s12 offen lds
    s_add_u32 s12, s12, 57344
    s_add_u32 m0, s14, 6144
    s_nop 0
    buffer_load_dwordx4 v4, s[44:47], s12 offen lds
    s_add_u32 s12, s12, 57344
    s_add_u32 m0, s14, 7168
    s_nop 0
    buffer_load_dwordx4 v4, s[44:47], s12 offen lds
    s_waitcnt vmcnt(4)
    buffer_load_dwordx4 v[128:131], v247, s[36:39], s15 offen sc1
    ds_read_b64_tr_b16 v[48:49], v112 offset:0
    ds_read_b64_tr_b16 v[50:51], v112 offset:512
    ds_read_b64_tr_b16 v[52:53], v113 offset:0
    ds_read_b64_tr_b16 v[54:55], v113 offset:512
    ds_read_b64_tr_b16 v[56:57], v114 offset:0
    ds_read_b64_tr_b16 v[58:59], v114 offset:512
    ds_read_b64_tr_b16 v[60:61], v115 offset:0
    ds_read_b64_tr_b16 v[62:63], v115 offset:512
    s_waitcnt vmcnt(0)
    v_xor_b32 v129, s59, v129
    v_bitop3_b32 v129, v131, s59, v129 bitop3:0xbe
    v_cmp_ne_u32 vcc, 0, v129
    v_max_u32 v128, v128, v130
    s_cbranch_vccnz L_f1b
    s_nop 0
    v_max_u32_dpp v128, v128, v128 row_ror:8 row_mask:0xf bank_mask:0xf
    s_nop 1
    v_max_u32_dpp v128, v128, v128 row_ror:4 row_mask:0xf bank_mask:0xf
    s_nop 1
    v_max_u32_dpp v128, v128, v128 row_ror:2 row_mask:0xf bank_mask:0xf
    s_nop 1
    v_max_u32_dpp v128, v128, v128 row_ror:1 row_mask:0xf bank_mask:0xf
    s_nop 0
    v_readlane_b32 s97, v128, 0
    v_readlane_b32 s60, v128, 16
    v_readlane_b32 s61, v128, 32
    v_readlane_b32 s62, v128, 48
    s_max_u32 s97, s97, s60
    s_max_u32 s61, s61, s62
    s_max_u32 s97, s97, s61
    s_and_b32 s97, s97, 2047
    s_lshl_b32 s60, s97, 10
    s_mov_b32 m0, 98304
    s_nop 0
    buffer_load_dwordx4 v247, s[32:35], s60 offen lds
    s_waitcnt vmcnt(1)
    s_waitcnt vmcnt(14)
    ds_read_b64_tr_b16 v[16:17], v7 offset:0
    ds_read_b64_tr_b16 v[18:19], v7 offset:256
    ds_read_b64_tr_b16 v[20:21], v12 offset:0
    ds_read_b64_tr_b16 v[22:23], v12 offset:256
    s_waitcnt vmcnt(12)
    ds_read_b64_tr_b16 v[24:25], v7 offset:2048
    ds_read_b64_tr_b16 v[26:27], v7 offset:2304
    ds_read_b64_tr_b16 v[28:29], v12 offset:2048
    ds_read_b64_tr_b16 v[30:31], v12 offset:2304
    s_waitcnt vmcnt(10)
    ds_read_b64_tr_b16 v[32:33], v7 offset:4096
    ds_read_b64_tr_b16 v[34:35], v7 offset:4352
    ds_read_b64_tr_b16 v[36:37], v12 offset:4096
    ds_read_b64_tr_b16 v[38:39], v12 offset:4352
    s_waitcnt vmcnt(8)
    ds_read_b64_tr_b16 v[40:41], v7 offset:6144
    ds_read_b64_tr_b16 v[42:43], v7 offset:6400
    ds_read_b64_tr_b16 v[44:45], v12 offset:6144
    ds_read_b64_tr_b16 v[46:47], v12 offset:6400
    s_waitcnt vmcnt(0)
    s_branch L_f2
L_f1b:
L_pk3:
    buffer_load_dwordx4 v[128:131], v133, s[36:39], s15 offen sc1
L_pk3_w:
    s_waitcnt vmcnt(0)
    v_xor_b32 v129, s59, v129
    v_bitop3_b32 v129, v131, s59, v129 bitop3:0xbe
    v_cmp_ne_u32 vcc, 0, v129
    v_max_u32 v128, v128, v130
    s_nop 0
    s_cbranch_vccz L_pk3_ok
    s_sleep 1
    s_sub_u32 s90, s90, 1
    s_cbranch_scc0 L_pk3
    s_mov_b32 s90, 0
L_pk3_ok:
    v_max_u32_dpp v128, v128, v128 row_ror:8 row_mask:0xf bank_mask:0xf
    s_nop 1
    v_max_u32_dpp v128, v128, v128 row_ror:4 row_mask:0xf bank_mask:0xf
    s_nop 1
    v_max_u32_dpp v128, v128, v128 row_ror:2 row_mask:0xf bank_mask:0xf
    s_nop 1
    v_max_u32_dpp v128, v128, v128 row_ror:1 row_mask:0xf bank_mask:0xf
    s_nop 0
    v_readlane_b32 s97, v128, 0
    v_readlane_b32 s60, v128, 16
    v_readlane_b32 s61, v128, 32
    v_readlane_b32 s62, v128, 48
    s_max_u32 s97, s97, s60
    s_max_u32 s61, s61, s62
    s_max_u32 s97, s97, s61
    s_and_b32 s97, s97, 2047
    s_lshl_b32 s60, s97, 10
    s_mov_b32 m0, 98304
    s_nop 0
    buffer_load_dwordx4 v247, s[32:35], s60 offen lds
    s_waitcnt vmcnt(1)
    s_waitcnt vmcnt(14)
    ds_read_b64_tr_b16 v[16:17], v7 offset:0
    ds_read_b64_tr_b16 v[18:19], v7 offset:256
    ds_read_b64_tr_b16 v[20:21], v12 offset:0
    ds_read_b64_tr_b16 v[22:23], v12 offset:256
    s_waitcnt vmcnt(12)
    ds_read_b64_tr_b16 v[24:25], v7 offset:2048
    ds_read_b64_tr_b16 v[26:27], v7 offset:2304
    ds_read_b64_tr_b16 v[28:29], v12 offset:2048
    ds_read_b64_tr_b16 v[30:31], v12 offset:2304
    s_waitcnt vmcnt(10)
    ds_read_b64_tr_b16 v[32:33], v7 offset:4096
    ds_read_b64_tr_b16 v[34:35], v7 offset:4352
    ds_read_b64_tr_b16 v[36:37], v12 offset:4096
    ds_read_b64_tr_b16 v[38:39], v12 offset:4352
    s_waitcnt vmcnt(8)
    ds_read_b64_tr_b16 v[40:41], v7 offset:6144
    ds_read_b64_tr_b16 v[42:43], v7 offset:6400
    ds_read_b64_tr_b16 v[44:45], v12 offset:6144
    ds_read_b64_tr_b16 v[46:47], v12 offset:6400
    s_waitcnt vmcnt(0)
    s_branch L_f2
L_f1:
    s_waitcnt vmcnt(0)
    s_barrier
    s_add_u32 m0, s14, 0
    s_nop 0
    buffer_load_dwordx4 v4, s[44:47], s12 offen lds
    s_add_u32 s12, s12, 57344
    s_add_u32 m0, s14, 1024
    s_nop 0
    buffer_load_dwordx4 v4, s[44:47], s12 offen lds
    s_add_u32 s12, s12, 57344
    s_add_u32 m0, s14, 2048
    s_nop 0
    buffer_load_dwordx4 v4, s[44:47], s12 offen lds
    s_add_u32 s12, s12, 57344
    s_add_u32 m0, s14, 3072
    s_nop 0
    buffer_load_dwordx4 v4, s[44:47], s12 offen lds
    s_add_u32 s12, s12, 57344
    s_add_u32 m0, s14, 4096
    s_nop 0
    buffer_load_dwordx4 v4, s[44:47], s12 offen lds
    s_add_u32 s12, s12, 57344
    s_add_u32 m0, s14, 5120
    s_nop 0
    buffer_load_dwordx4 v4, s[44:47], s12 offen lds
    s_add_u32 s12, s12, 57344
    s_add_u32 m0, s14, 6144
    s_nop 0
    buffer_load_dwordx4 v4, s[44:47], s12 offen lds
    s_add_u32 s12, s12, 57344
    s_add_u32 m0, s14, 7168
    s_nop 0
    buffer_load_dwordx4 v4, s[44:47], s12 offen lds
    ds_read_b64_tr_b16 v[48:49], v112 offset:0
    ds_read_b64_tr_b16 v[50:51], v112 offset:512
    ds_read_b64_tr_b16 v[52:53], v113 offset:0
    ds_read_b64_tr_b16 v[54:55], v113 offset:512
    ds_read_b64_tr_b16 v[56:57], v114 offset:0
    ds_read_b64_tr_b16 v[58:59], v114 offset:512
    ds_read_b64_tr_b16 v[60:61], v115 offset:0
    ds_read_b64_tr_b16 v[62:63], v115 offset:512
    s_waitcnt vmcnt(6)
    ds_read_b64_tr_b16 v[16:17], v7 offset:0
    ds_read_b64_tr_b16 v[18:19], v7 offset:256
    ds_read_b64_tr_b16 v[20:21], v12 offset:0
    ds_read_b64_tr_b16 v[22:23], v12 offset:256
    s_waitcnt vmcnt(4)
    ds_read_b64_tr_b16 v[24:25], v7 offset:2048
    ds_read_b64_tr_b16 v[26:27], v7 offset:2304
    ds_read_b64_tr_b16 v[28:29], v12 offset:2048
    ds_read_b64_tr_b16 v[30:31], v12 offset:2304
    s_waitcnt vmcnt(2)
    ds_read_b64_tr_b16 v[32:33], v7 offset:4096
    ds_read_b64_tr_b16 v[34:35], v7 offset:4352
    ds_read_b64_tr_b16 v[36:37], v12 offset:4096
    ds_read_b64_tr_b16 v[38:39], v12 offset:4352
    s_waitcnt vmcnt(0)
    ds_read_b64_tr_b16 v[40:41], v7 offset:6144
    ds_read_b64_tr_b16 v[42:43], v7 offset:6400
    ds_read_b64_tr_b16 v[44:45], v12 offset:6144
    ds_read_b64_tr_b16 v[46:47], v12 offset:6400
L_f2:
    s_waitcnt lgkmcnt(0)
    s_barrier
    ds_read_b128 v[64:67], v15 offset:0
    ds_read_b128 v[68:71], v15 offset:64
    ds_read_b128 v[72:75], v15 offset:128
    ds_read_b128 v[76:79], v15 offset:192
    s_waitcnt lgkmcnt(3)
    v_mfma_f32_16x16x32_bf16 v[80:83], v[16:19], v[64:67], 0
    v_mfma_f32_16x16x32_bf16 v[84:87], v[20:23], v[64:67], 0
    s_waitcnt lgkmcnt(2)
    v_mfma_f32_16x16x32_bf16 v[80:83], v[24:27], v[68:71], v[80:83]
    v_mfma_f32_16x16x32_bf16 v[84:87], v[28:31], v[68:71], v[84:87]
    s_waitcnt lgkmcnt(1)
    v_mfma_f32_16x16x32_bf16 v[80:83], v[32:35], v[72:75], v[80:83]
    v_mfma_f32_16x16x32_bf16 v[84:87], v[36:39], v[72:75], v[84:87]
    s_waitcnt lgkmcnt(0)
    v_mfma_f32_16x16x32_bf16 v[80:83], v[40:43], v[76:79], v[80:83]
    v_mfma_f32_16x16x32_bf16 v[84:87], v[44:47], v[76:79], v[84:87]
    s_mov_b32 exec_lo, 0x10001
    s_mov_b32 exec_hi, 0x10001
    s_nop 4
    ds_write_b128 v107, v[80:83] offset:0
    ds_write_b128 v107, v[84:87] offset:64
    s_mov_b64 exec, -1
    s_waitcnt lgkmcnt(0)
    s_barrier
    ds_read_b64 v[64:65], v111 offset:0
    ds_read_b64 v[66:67], v111 offset:128
    ds_read_b64 v[68:69], v111 offset:256
    ds_read_b64 v[70:71], v111 offset:384
    ds_read_b64 v[72:73], v111 offset:512
    ds_read_b64 v[74:75], v111 offset:640
    ds_read_b64 v[76:77], v111 offset:768
    ds_read_b64 v[78:79], v111 offset:896
    s_waitcnt lgkmcnt(4)
    v_pk_add_f32 v[64:65], v[64:65], v[66:67]
    v_pk_add_f32 v[68:69], v[68:69], v[70:71]
    v_pk_add_f32 v[64:65], v[64:65], v[68:69]
    v_mul_f32 v67, 0xbfb8aa3b, v65
    v_mul_f32 v66, 0xbfb8aa3b, v64
    v_exp_f32 v67, v67
    v_exp_f32 v66, v66
    v_add_f32 v67, 1.0, v67
    v_add_f32 v66, 1.0, v66
    v_rcp_f32 v67, v67
    v_rcp_f32 v66, v66
    s_nop 0
    v_pk_mul_f32 v[64:65], v[64:65], v[66:67]
    s_waitcnt lgkmcnt(0)
    v_pk_add_f32 v[72:73], v[72:73], v[74:75]
    v_pk_add_f32 v[76:77], v[76:77], v[78:79]
    v_pk_add_f32 v[72:73], v[72:73], v[76:77]
    v_pk_mul_f32 v[64:65], v[64:65], v[72:73]
    v_cvt_pk_bf16_f32 v64, v64, v65
    s_nop 1
    v_mov_b32_dpp v72, v64 quad_perm:[0,0,0,0] row_mask:0xf bank_mask:0xf
    v_mov_b32_dpp v73, v64 quad_perm:[1,1,1,1] row_mask:0xf bank_mask:0xf
    v_mov_b32_dpp v74, v64 quad_perm:[2,2,2,2] row_mask:0xf bank_mask:0xf
    v_mov_b32_dpp v75, v64 quad_perm:[3,3,3,3] row_mask:0xf bank_mask:0xf
    s_nop 1
    v_mfma_f32_16x16x32_bf16 v[88:91], v[48:51], v[72:75], 0
    v_mfma_f32_16x16x32_bf16 v[92:95], v[52:55], v[72:75], 0
    v_mfma_f32_16x16x32_bf16 v[96:99], v[56:59], v[72:75], 0
    v_mfma_f32_16x16x32_bf16 v[100:103], v[60:63], v[72:75], 0
    s_mov_b32 exec_lo, 0x10001
    s_mov_b32 exec_hi, 0x10001
    s_nop 2
    v_cvt_pk_bf16_f32 v120, v88, v89
    v_cvt_pk_bf16_f32 v121, v90, v91
    s_mov_b32 exec_lo, 0x20002
    s_mov_b32 exec_hi, 0x20002
    v_cvt_pk_bf16_f32 v120, v92, v93
    v_cvt_pk_bf16_f32 v121, v94, v95
    s_mov_b32 exec_lo, 0x40004
    s_mov_b32 exec_hi, 0x40004
    v_cvt_pk_bf16_f32 v120, v96, v97
    v_cvt_pk_bf16_f32 v121, v98, v99
    s_mov_b32 exec_lo, 0x80008
    s_mov_b32 exec_hi, 0x80008
    v_cvt_pk_bf16_f32 v120, v100, v101
    v_cvt_pk_bf16_f32 v121, v102, v103
    s_mov_b32 exec_lo, 0x000f000f
    s_mov_b32 exec_hi, 0x000f000f
    v_bitop3_b32 v120, v106, v104, v120 bitop3:0xca
    v_bitop3_b32 v121, v106, v105, v121 bitop3:0xca
    buffer_store_dwordx2 v[120:121], v108, s[36:39], s8 offen sc1
    s_mov_b64 exec, -1
    s_endpgm
L_fin:
    v_lshlrev_b32 v4, 5, v2
    v_and_b32 v96, 1, v3
    v_lshl_add_u32 v4, v96, 9, v4
    v_lshrrev_b32 v96, 1, v3
    v_lshl_add_u32 v4, v96, 4, v4
    s_add_u32 s95, s56, 24
    s_lshr_b32 s99, s57, 1
    s_and_b32 s99, s99, 4
    s_add_u32 s99, s99, s56
    s_sub_u32 s99, s99, 4
    s_waitcnt lgkmcnt(0)
    s_load_dword s59, s[30:31], 0
    s_mov_b32 s32, s4
    s_mov_b32 s33, s5
    s_mov_b32 s34, 0x200000
    s_mov_b32 s35, 0x20000
    s_mov_b32 s36, s30
    s_mov_b32 s37, s31
    s_mov_b32 s38, 0x400000
    s_mov_b32 s39, 0x20000
    s_mov_b32 s48, s24
    s_mov_b32 s49, s25
    s_mov_b32 s50, 0x400
    s_mov_b32 s51, 0x20000
    buffer_load_dwordx4 v[28:31], v4, s[48:51], 0 offen
    s_lshl_b32 s60, s3, 10
    v_lshl_add_u32 v248, v0, 4, s60
    s_add_u32 m0, s60, 32768
    global_load_lds_dwordx4 v248, s[10:11] offset:0
    s_and_b32 s63, s3, 1
    s_add_u32 s63, s63, 8
    s_lshl_b32 s60, s63, 10
    v_lshl_add_u32 v248, v0, 4, s60
    s_add_u32 m0, s60, 32768
    global_load_lds_dwordx4 v248, s[10:11] offset:0
    s_mov_b32 s40, s26
    s_mov_b32 s41, s27
    s_mov_b32 s42, 0x200000
    s_mov_b32 s43, 0x20000
    v_mov_b32 v252, s4
    v_mov_b32 v253, s5
    v_writelane_b32 v252, s26, 1
    v_writelane_b32 v253, s27, 1
    s_add_u32 s63, s30, 0x3000
    v_writelane_b32 v252, s63, 2
    s_addc_u32 s63, s31, 0
    v_writelane_b32 v253, s63, 2
    s_add_u32 s63, s30, 0x203000
    v_writelane_b32 v252, s63, 3
    s_addc_u32 s63, s31, 0
    v_writelane_b32 v253, s63, 3
    s_mov_b64 exec, 0xf
    global_load_dword v254, v[252:253], off
    s_mov_b64 exec, -1
    v_lshlrev_b32 v5, 12, v3
    v_lshl_add_u32 v5, v2, 4, v5
    v_lshrrev_b32 v96, 2, v2
    v_xor_b32 v96, v96, v3
    v_and_b32 v96, 1, v96
    v_bfe_u32 v97, v2, 1, 1
    v_lshl_or_b32 v96, v96, 1, v97
    s_lshr_b32 s60, s3, 1
    v_xor_b32 v96, s60, v96
    v_lshlrev_b32 v96, 4, v96
    v_and_b32 v98, 7, v2
    v_lshl_add_u32 v96, v98, 6, v96
    v_lshl_add_u32 v96, v3, 12, v96
    v_lshrrev_b32 v98, 3, v2
    v_lshl_add_u32 v96, v98, 2, v96
    s_and_b32 s60, s3, 1
    s_lshl_b32 s60, s60, 3
    s_add_u32 s60, s60, 16384
    v_add_u32 v6, s60, v96
    v_xor_b32 v7, 48, v6
    v_bfe_u32 v96, v2, 2, 1
    v_xor_b32 v96, v96, v98
    v_lshl_or_b32 v96, v96, 1, v98
    v_xor_b32 v96, v96, v97
    v_xor_b32 v96, v96, v3
    v_lshlrev_b32 v96, 4, v96
    v_lshl_add_u32 v62, v2, 6, v96
    s_and_b32 s15, s95, 31
    s_lshl_b32 s15, s15, 11
    s_add_u32 s15, s15, 0x40000
    v_lshlrev_b32 v134, 3, v0
    v_lshlrev_b32 v133, 4, v0
    s_mul_i32 s7, s99, 7168
    s_lshl_b32 s61, s3, 10
    s_add_u32 s7, s7, s61
    s_add_u32 s7, s7, 0xfc00
    v_and_b32 v108, 1, v3
    v_lshrrev_b32 v111, 1, v3
    v_lshl_add_u32 v108, v108, 1, v111
    v_and_b32 v107, 7, v2
    v_lshl_add_u32 v108, v2, 2, v108
    s_lshl_b32 s60, s3, 8
    s_add_u32 s60, s60, 43008
    v_lshl_add_u32 v108, v108, 2, s60
    v_and_b32 v111, 3, v2
    v_lshlrev_b32 v111, 6, v111
    v_lshl_add_u32 v111, v3, 4, v111
    v_mov_b32 v109, 43016
    s_waitcnt lgkmcnt(0)
    s_add_u32 s59, s59, 0x9e3779b9
    s_bitcmp1_b32 s59, 0
    s_cselect_b32 s91, 1, 0x10000
    s_xor_b32 s92, s91, 0x10001
    s_cmp_lg_u32 s3, 0
    s_cbranch_scc1 L_fin0
    s_cmp_eq_u32 s99, 0
    s_cbranch_scc1 L_fin0
    s_lshl_b32 s60, s99, 7
    v_mov_b32 v96, 0x1000
    v_mov_b32 v97, s59
    s_mov_b64 exec, 1
    buffer_store_dword v97, v96, s[36:39], s60 offen sc1
    s_mov_b64 exec, -1
L_fin0:
    v_mov_b32 v104, s91
    v_mov_b32 v105, s92
    v_mov_b32 v106, 0x00010001
    s_waitcnt vmcnt(0)
    s_barrier
    s_lshr_b32 s60, s99, 2
    s_lshl_b32 s60, s60, 10
    v_add_u32 v110, s60, v247
    ds_read_b128 v[152:155], v247 offset:32768
    ds_read_b128 v[156:159], v247 offset:33792
    ds_read_b128 v[184:187], v247 offset:34816
    ds_read_b128 v[188:191], v247 offset:35840
    ds_read_b128 v[192:195], v247 offset:36864
    ds_read_b128 v[196:199], v247 offset:37888
    ds_read_b128 v[168:171], v110 offset:38912
    ds_read_b128 v[172:175], v110 offset:40960
    s_cmp_lg_u32 s3, 0
    s_cbranch_scc1 L_fin1a
    v_mov_b32 v80, 0
    v_mov_b32 v81, 0
    v_mov_b32 v82, 0
    v_mov_b32 v83, 0
    buffer_atomic_or_x2 v[80:81], v134, s[36:39], s15 offen sc0 sc1
    buffer_atomic_or_x2 v[82:83], v134, s[36:39], s15 offen offset:512 sc0 sc1
    s_sleep 4
    v_mov_b32 v84, 0
    v_mov_b32 v85, 0
    v_mov_b32 v86, 0
    v_mov_b32 v87, 0
    buffer_atomic_or_x2 v[84:85], v134, s[36:39], s15 offen sc0 sc1
    buffer_atomic_or_x2 v[86:87], v134, s[36:39], s15 offen offset:512 sc0 sc1
    s_sleep 4
    v_mov_b32 v88, 0
    v_mov_b32 v89, 0
    v_mov_b32 v90, 0
    v_mov_b32 v91, 0
    buffer_atomic_or_x2 v[88:89], v134, s[36:39], s15 offen sc0 sc1
    buffer_atomic_or_x2 v[90:91], v134, s[36:39], s15 offen offset:512 sc0 sc1
L_kp4:
    s_waitcnt vmcnt(4)
    v_xor_b32 v129, s59, v81
    v_bitop3_b32 v129, v83, s59, v129 bitop3:0xbe
    v_cmp_ne_u32 vcc, 0, v129
    s_nop 0
    s_cbranch_vccz L_kp4_d0
    v_mov_b32 v80, 0
    v_mov_b32 v81, 0
    v_mov_b32 v82, 0
    v_mov_b32 v83, 0
    buffer_atomic_or_x2 v[80:81], v134, s[36:39], s15 offen sc0 sc1
    buffer_atomic_or_x2 v[82:83], v134, s[36:39], s15 offen offset:512 sc0 sc1
    s_waitcnt vmcnt(4)
    v_xor_b32 v129, s59, v85
    v_bitop3_b32 v129, v87, s59, v129 bitop3:0xbe
    v_cmp_ne_u32 vcc, 0, v129
    s_nop 0
    s_cbranch_vccz L_kp4_d1
    v_mov_b32 v84, 0
    v_mov_b32 v85, 0
    v_mov_b32 v86, 0
    v_mov_b32 v87, 0
    buffer_atomic_or_x2 v[84:85], v134, s[36:39], s15 offen sc0 sc1
    buffer_atomic_or_x2 v[86:87], v134, s[36:39], s15 offen offset:512 sc0 sc1
    s_waitcnt vmcnt(4)
    v_xor_b32 v129, s59, v89
    v_bitop3_b32 v129, v91, s59, v129 bitop3:0xbe
    v_cmp_ne_u32 vcc, 0, v129
    s_nop 0
    s_cbranch_vccz L_kp4_d2
    v_mov_b32 v88, 0
    v_mov_b32 v89, 0
    v_mov_b32 v90, 0
    v_mov_b32 v91, 0
    buffer_atomic_or_x2 v[88:89], v134, s[36:39], s15 offen sc0 sc1
    buffer_atomic_or_x2 v[90:91], v134, s[36:39], s15 offen offset:512 sc0 sc1
    s_sub_u32 s90, s90, 1
    s_cbranch_scc0 L_kp4
    s_waitcnt vmcnt(0)
L_kp4_d0:
    v_max_u32 v128, v80, v82
    s_branch L_kp4_x
L_kp4_d1:
    v_max_u32 v128, v84, v86
    s_branch L_kp4_x
L_kp4_d2:
    v_max_u32 v128, v88, v90
L_kp4_x:
    s_nop 1
    v_max_u32_dpp v128, v128, v128 row_ror:8 row_mask:0xf bank_mask:0xf
    s_nop 1
    v_max_u32_dpp v128, v128, v128 row_ror:4 row_mask:0xf bank_mask:0xf
    s_nop 1
    v_max_u32_dpp v128, v128, v128 row_ror:2 row_mask:0xf bank_mask:0xf
    s_nop 1
    v_max_u32_dpp v128, v128, v128 row_ror:1 row_mask:0xf bank_mask:0xf
    s_nop 0
    v_readlane_b32 s97, v128, 0
    v_readlane_b32 s60, v128, 16
    v_readlane_b32 s61, v128, 32
    v_readlane_b32 s62, v128, 48
    s_max_u32 s97, s97, s60
    s_max_u32 s61, s61, s62
    s_max_u32 s97, s97, s61
    v_mov_b32 v110, s97
    ds_write_b32 v109, v110
    s_and_b32 s60, s97, 2047
    s_lshl_b32 s12, s60, 10
    buffer_load_dwordx4 v[40:43], v4, s[32:35], s12 offen
    s_branch L_fin1
L_fin1a:
    s_lshl3_add_u32 s60, s99, s3
    s_cmp_lg_u32 s60, 2
    s_cbranch_scc1 L_fin1
    v_lshlrev_b32 v128, 7, v0
    s_mov_b64 exec, 0xff
    s_movk_i32 s60, 0x1000
L_ack:
    buffer_load_dword v129, v128, s[36:39], s60 offen sc1
    s_waitcnt vmcnt(0)
    v_cmp_ne_u32 vcc, s59, v129
    s_nop 0
    s_cbranch_vccz L_ack_ok
    s_sleep 1
    s_sub_u32 s90, s90, 1
    s_cbranch_scc0 L_ack
    s_mov_b32 s90, 0
L_ack_ok:
    s_mov_b64 exec, -1
L_fin1:
    s_waitcnt lgkmcnt(0)
    s_barrier
    ds_read_b32 v110, v109
    s_waitcnt lgkmcnt(0)
    v_readfirstlane_b32 s8, v110
    s_nop 0
    s_and_b32 s97, s8, 2047
    s_and_b32 s60, s97, 255
    s_and_b32 s61, s97, 15
    s_and_b32 s62, s97, 7
    s_cselect_b32 s60, s61, s60
    s_cselect_b32 s61, 8, 128
    s_cmp_gt_u32 s60, s61
    s_cselect_b32 s96, 0x80000000, 0
    s_sub_u32 s61, 2048, s97
    s_cmp_lg_u32 s96, 0
    s_cselect_b32 s60, s61, s97
    s_and_b32 s58, s60, 255
    s_lshr_b32 s98, s60, 8
    s_lshr_b32 s60, s58, 4
    s_and_b32 s61, s58, 15
    s_lshl4_add_u32 s9, s61, s60
    s_add_u32 s62, s60, s61
    s_cmp_eq_u32 s61, 8
    s_cselect_b32 s9, s62, s9
    s_cmp_eq_u32 s58, 128
    s_cselect_b32 s9, 0, s9
    s_lshl_b32 s14, s9, 14
    s_lshl_b32 s60, s3, 8
    s_add_u32 s14, s14, s60
    s_add_u32 s14, s14, 0x200000
    v_lshrrev_b32 v96, 1, v2
    v_lshlrev_b32 v96, 8, v96
    v_add_u32 v96, s58, v96
    v_and_b32 v97, 1, v2
    v_lshlrev_b32 v98, 1, v3
    v_mul_u32_u24 v98, v98, v96
    v_cmp_eq_u32 vcc, 0, v97
    v_and_b32 v99, 2047, v98
    v_add_u32 v98, v98, v96
    v_cvt_f32_u32 v99, v99
    v_mul_f32 v99, 0x3a000000, v99
    v_cos_f32 v100, v99
    v_sin_f32 v101, v99
    v_mul_f32 v100, 0.5, v100
    v_mul_f32 v101, 0.5, v101
    v_cndmask_b32_e64 v102, -v101, v100, vcc
    v_cndmask_b32 v103, v100, v101, vcc
    v_cvt_pk_bf16_f32 v144, v102, v103
    v_cvt_pk_bf16_f32 v148, -v103, v102
    v_cndmask_b32 v102, v101, v100, vcc
    v_cndmask_b32_e64 v103, -v100, v101, vcc
    v_cvt_pk_bf16_f32 v145, v102, -v103
    v_cvt_pk_bf16_f32 v149, -v103, -v102
    s_and_b32 s60, s58, 127
    s_cbranch_scc1 L_fin_a10
    v_add_f32 v100, v100, v100
    v_add_f32 v101, v101, v101
    v_cndmask_b32 v102, 0, v100, vcc
    v_sub_f32 v103, v100, v102
    v_cvt_pk_bf16_f32 v100, v102, v103
    v_cndmask_b32 v102, 0, v101, vcc
    v_sub_f32 v103, v101, v102
    v_cvt_pk_bf16_f32 v101, -v102, -v103
    s_cmp_eq_u32 s58, 0
    s_cselect_b32 s60, -1, 0
    s_cselect_b32 s61, 0, -1
    v_and_b32 v144, s60, v100
    v_and_b32 v148, s60, v101
    v_and_b32 v145, s61, v100
    v_and_b32 v149, s61, v101
L_fin_a10:
    v_and_b32 v99, 2047, v98
    v_cvt_f32_u32 v99, v99
    v_mul_f32 v99, 0x3a000000, v99
    v_cos_f32 v100, v99
    v_sin_f32 v101, v99
    v_mul_f32 v100, 0.5, v100
    v_mul_f32 v101, 0.5, v101
    v_cndmask_b32_e64 v102, -v101, v100, vcc
    v_cndmask_b32 v103, v100, v101, vcc
    v_cvt_pk_bf16_f32 v146, v102, v103
    v_cvt_pk_bf16_f32 v150, -v103, v102
    v_cndmask_b32 v102, v101, v100, vcc
    v_cndmask_b32_e64 v103, -v100, v101, vcc
    v_cvt_pk_bf16_f32 v147, v102, -v103
    v_cvt_pk_bf16_f32 v151, -v103, -v102
    s_and_b32 s60, s58, 127
    s_cbranch_scc1 L_fin_a11
    v_add_f32 v100, v100, v100
    v_add_f32 v101, v101, v101
    v_cndmask_b32 v102, 0, v100, vcc
    v_sub_f32 v103, v100, v102
    v_cvt_pk_bf16_f32 v100, v102, v103
    v_cndmask_b32 v102, 0, v101, vcc
    v_sub_f32 v103, v101, v102
    v_cvt_pk_bf16_f32 v101, -v102, -v103
    s_cmp_eq_u32 s58, 0
    s_cselect_b32 s60, -1, 0
    s_cselect_b32 s61, 0, -1
    v_and_b32 v146, s60, v100
    v_and_b32 v150, s60, v101
    v_and_b32 v147, s61, v100
    v_and_b32 v151, s61, v101
L_fin_a11:
    s_cmp_lg_u32 s3, 0
    s_cbranch_scc1 L_fin3
    s_lshl_b32 s60, s98, 4
    s_and_b32 s60, s60, 32
    v_xor_b32 v62, s60, v62
    s_lshl_b32 s60, s98, 11
    s_add_u32 s60, s60, 16384
    v_add_u32 v62, s60, v62
    v_xor_b32 v152, s96, v152
    v_xor_b32 v156, s96, v156
    v_xor_b32 v153, s96, v153
    v_xor_b32 v157, s96, v157
    v_xor_b32 v154, s96, v154
    v_xor_b32 v158, s96, v158
    v_xor_b32 v155, s96, v155
    v_xor_b32 v159, s96, v159
    s_ashr_i32 s60, s8, 31
    s_orn2_b32 s60, 0x80000000, s60
    s_xor_b32 s8, s8, s60
    s_waitcnt vmcnt(0)
    v_dot2_f32_bf16 v32, v40, v28, 0
    v_dot2_f32_bf16 v32, v41, v29, v32
    v_dot2_f32_bf16 v32, v42, v30, v32
    v_dot2_f32_bf16 v32, v43, v31, v32
    s_nop 2
    v_add_f32_dpp v32, v32, v32 row_ror:8 row_mask:0xf bank_mask:0xf
    s_nop 1
    v_add_f32_dpp v32, v32, v32 row_ror:4 row_mask:0xf bank_mask:0xf
    s_nop 1
    v_add_f32_dpp v32, v32, v32 row_ror:2 row_mask:0xf bank_mask:0xf
    s_nop 1
    v_add_f32_dpp v32, v32, v32 row_ror:1 row_mask:0xf bank_mask:0xf
    v_mov_b32 v33, v32
    s_nop 1
    v_permlane32_swap_b32 v32, v33
    v_add_f32 v32, v32, v33
    v_mov_b32 v33, v32
    s_nop 1
    v_permlane16_swap_b32 v32, v33
    v_add_f32 v32, v32, v33
    v_mov_b32 v33, s8
    v_mul_f32 v35, 0xbfb8aa3b, v33
    v_mul_f32 v34, 0xbfb8aa3b, v32
    v_exp_f32 v35, v35
    v_exp_f32 v34, v34
    v_add_f32 v35, 1.0, v35
    v_add_f32 v34, 1.0, v34
    v_rcp_f32 v35, v35
    v_rcp_f32 v34, v34
    v_permlane16_swap_b32 v40, v42
    v_permlane16_swap_b32 v41, v43
    s_bitcmp1_b32 s99, 2
    s_cbranch_scc0 L_fint
    v_mov_b32 v40, v42
    v_mov_b32 v41, v43
L_fint:
    v_sub_f32 v36, 1.0, v34
    v_lshlrev_b32 v216, 16, v40
    v_and_b32 v217, 0xffff0000, v40
    v_pk_mul_f32 v[216:217], v[216:217], v[36:37] op_sel_hi:[1,0]
    v_lshlrev_b32 v218, 16, v41
    v_and_b32 v219, 0xffff0000, v41
    v_pk_mul_f32 v[218:219], v[218:219], v[36:37] op_sel_hi:[1,0]
    v_mul_f32 v38, v35, v36
    v_pk_mul_f32 v[184:185], v[184:185], v[34:35] op_sel_hi:[1,0]
    v_pk_mul_f32 v[186:187], v[186:187], v[34:35] op_sel_hi:[1,0]
    v_pk_mul_f32 v[188:189], v[188:189], v[34:35] op_sel_hi:[1,0]
    v_pk_mul_f32 v[190:191], v[190:191], v[34:35] op_sel_hi:[1,0]
    v_pk_mul_f32 v[192:193], v[192:193], v[34:35] op_sel_hi:[1,0]
    v_pk_mul_f32 v[194:195], v[194:195], v[34:35] op_sel_hi:[1,0]
    v_pk_mul_f32 v[196:197], v[196:197], v[34:35] op_sel_hi:[1,0]
    v_pk_mul_f32 v[198:199], v[198:199], v[34:35] op_sel_hi:[1,0]
L_fin3:
    buffer_load_dwordx4 v[8:11], v5, s[36:39], s14 offen offset:0 sc1
    buffer_load_dwordx4 v[12:15], v5, s[36:39], s14 offen offset:2048 sc1
    s_branch L_fin_pw
L_fin_pl:
    buffer_load_dwordx4 v[8:11], v5, s[36:39], s14 offen offset:0 sc1
    buffer_load_dwordx4 v[12:15], v5, s[36:39], s14 offen offset:2048 sc1
L_fin_pw:
    s_waitcnt vmcnt(0)
    v_swap_b32 v10, v12
    v_swap_b32 v11, v13
    v_xor_b32 v96, v104, v8
    v_xor_b32 v97, v105, v9
    v_mfma_f32_16x16x32_bf16 v[64:67], v[144:147], v[8:11], 0
    v_bitop3_b32 v96, v10, v104, v96 bitop3:0xbe
    v_bitop3_b32 v97, v11, v105, v97 bitop3:0xbe
    v_mfma_f32_16x16x32_bf16 v[68:71], v[148:151], v[8:11], 0
    v_bitop3_b32 v96, v12, v104, v96 bitop3:0xbe
    v_bitop3_b32 v97, v13, v105, v97 bitop3:0xbe
    v_mfma_f32_16x16x32_bf16 v[72:75], v[144:147], v[12:15], 0
    v_bitop3_b32 v96, v14, v104, v96 bitop3:0xbe
    v_bitop3_b32 v97, v15, v105, v97 bitop3:0xbe
    v_mfma_f32_16x16x32_bf16 v[76:79], v[148:151], v[12:15], 0
    v_bitop3_b32 v96, v96, v97, v106 bitop3:0xa8
    v_cmp_ne_u32 vcc, 0, v96
    s_nop 0
    s_cbranch_vccz L_fin_pl_ok
    s_sleep 1
    s_sub_u32 s90, s90, 1
    s_cbranch_scc0 L_fin_pl
    s_mov_b32 s90, 0
L_fin_pl_ok:
    v_cvt_pk_bf16_f32 v16, v64, v68
    v_cvt_pk_bf16_f32 v17, v65, v69
    ds_write2st64_b32 v6, v16, v17 offset0:0 offset1:4
    v_cvt_pk_bf16_f32 v18, v66, v70
    v_cvt_pk_bf16_f32 v19, v67, v71
    ds_write2st64_b32 v6, v18, v19 offset0:8 offset1:12
    v_cvt_pk_bf16_f32 v20, v72, v76
    v_cvt_pk_bf16_f32 v21, v73, v77
    ds_write2st64_b32 v7, v20, v21 offset0:2 offset1:6
    v_cvt_pk_bf16_f32 v22, v74, v78
    v_cvt_pk_bf16_f32 v23, v75, v79
    ds_write2st64_b32 v7, v22, v23 offset0:10 offset1:14
    s_waitcnt lgkmcnt(0)
    s_barrier
    s_cmp_lg_u32 s3, 0
    s_cbranch_scc1 L_pp0
    ds_read_b128 v[16:19], v62 offset:0
    ds_read_b128 v[20:23], v62 offset:1024
    s_waitcnt lgkmcnt(1)
    v_mfma_f32_16x16x32_bf16 v[64:67], v[16:19], v[152:155], 0
    v_mfma_f32_16x16x32_bf16 v[68:71], v[16:19], v[156:159], 0
    s_waitcnt lgkmcnt(0)
    v_mfma_f32_16x16x32_bf16 v[72:75], v[20:23], v[152:155], 0
    v_mfma_f32_16x16x32_bf16 v[76:79], v[20:23], v[156:159], 0
    s_nop 3
    v_pk_mul_f32 v[96:97], v[64:65], v[184:185]
    v_pk_mul_f32 v[100:101], v[68:69], v[184:185]
    v_pk_mul_f32 v[98:99], v[66:67], v[186:187]
    v_pk_mul_f32 v[102:103], v[70:71], v[186:187]
    v_pk_fma_f32 v[96:97], v[68:69], v[188:189], v[96:97]
    v_pk_fma_f32 v[100:101], v[64:65], v[188:189], v[100:101] neg_lo:[1,0,0] neg_hi:[1,0,0]
    v_pk_fma_f32 v[98:99], v[70:71], v[190:191], v[98:99]
    v_pk_fma_f32 v[102:103], v[66:67], v[190:191], v[102:103] neg_lo:[1,0,0] neg_hi:[1,0,0]
    v_cvt_pk_bf16_f32 v112, v96, v100
    v_cvt_pk_bf16_f32 v113, v97, v101
    v_cvt_pk_bf16_f32 v114, v98, v102
    v_cvt_pk_bf16_f32 v115, v99, v103
    s_nop 1
    v_mfma_f32_16x16x32_bf16 v[232:235], v[112:115], v[168:171], v[216:219]
    v_pk_mul_f32 v[96:97], v[72:73], v[192:193]
    v_pk_mul_f32 v[100:101], v[76:77], v[192:193]
    v_pk_mul_f32 v[98:99], v[74:75], v[194:195]
    v_pk_mul_f32 v[102:103], v[78:79], v[194:195]
    v_pk_fma_f32 v[96:97], v[76:77], v[196:197], v[96:97]
    v_pk_fma_f32 v[100:101], v[72:73], v[196:197], v[100:101] neg_lo:[1,0,0] neg_hi:[1,0,0]
    v_pk_fma_f32 v[98:99], v[78:79], v[198:199], v[98:99]
    v_pk_fma_f32 v[102:103], v[74:75], v[198:199], v[102:103] neg_lo:[1,0,0] neg_hi:[1,0,0]
    v_cvt_pk_bf16_f32 v116, v96, v100
    v_cvt_pk_bf16_f32 v117, v97, v101
    v_cvt_pk_bf16_f32 v118, v98, v102
    v_cvt_pk_bf16_f32 v119, v99, v103
    s_nop 1
    v_mfma_f32_16x16x32_bf16 v[232:235], v[116:119], v[172:175], v[232:235]
    v_lshlrev_b32 v4, 5, v2
    v_lshl_add_u32 v4, v3, 3, v4
    s_lshr_b32 s61, s99, 2
    s_lshl_b32 s61, s61, 9
    s_add_u32 s12, s12, s61
    s_branch L_fin5
L_pp0:
    v_mov_b32 v8, 0
    v_mov_b32 v9, 0
    v_mov_b32 v10, 0
    v_mov_b32 v11, 0
    buffer_atomic_or_x2 v[8:9], v246, s[36:39], s7 offen offset:0 sc0 sc1
    buffer_atomic_or_x2 v[10:11], v246, s[36:39], s7 offen offset:512 sc0 sc1
    s_sleep 4
    v_mov_b32 v12, 0
    v_mov_b32 v13, 0
    v_mov_b32 v14, 0
    v_mov_b32 v15, 0
    buffer_atomic_or_x2 v[12:13], v246, s[36:39], s7 offen offset:0 sc0 sc1
    buffer_atomic_or_x2 v[14:15], v246, s[36:39], s7 offen offset:512 sc0 sc1
    s_sleep 4
    v_mov_b32 v16, 0
    v_mov_b32 v17, 0
    v_mov_b32 v18, 0
    v_mov_b32 v19, 0
    buffer_atomic_or_x2 v[16:17], v246, s[36:39], s7 offen offset:0 sc0 sc1
    buffer_atomic_or_x2 v[18:19], v246, s[36:39], s7 offen offset:512 sc0 sc1
L_pa:
    s_waitcnt vmcnt(4)
    v_xor_b32 v96, v104, v8
    v_xor_b32 v97, v105, v9
    v_bitop3_b32 v96, v10, v104, v96 bitop3:0xbe
    v_bitop3_b32 v97, v11, v105, v97 bitop3:0xbe
    v_bitop3_b32 v96, v96, v97, v106 bitop3:0xa8
    v_cmp_ne_u32 vcc, 0, v96
    s_nop 0
    s_cbranch_vccz L_pa_d0
    v_mov_b32 v8, 0
    v_mov_b32 v9, 0
    v_mov_b32 v10, 0
    v_mov_b32 v11, 0
    buffer_atomic_or_x2 v[8:9], v246, s[36:39], s7 offen offset:0 sc0 sc1
    buffer_atomic_or_x2 v[10:11], v246, s[36:39], s7 offen offset:512 sc0 sc1
    s_waitcnt vmcnt(4)
    v_xor_b32 v96, v104, v12
    v_xor_b32 v97, v105, v13
    v_bitop3_b32 v96, v14, v104, v96 bitop3:0xbe
    v_bitop3_b32 v97, v15, v105, v97 bitop3:0xbe
    v_bitop3_b32 v96, v96, v97, v106 bitop3:0xa8
    v_cmp_ne_u32 vcc, 0, v96
    s_nop 0
    s_cbranch_vccz L_pa_d1
    v_mov_b32 v12, 0
    v_mov_b32 v13, 0
    v_mov_b32 v14, 0
    v_mov_b32 v15, 0
    buffer_atomic_or_x2 v[12:13], v246, s[36:39], s7 offen offset:0 sc0 sc1
    buffer_atomic_or_x2 v[14:15], v246, s[36:39], s7 offen offset:512 sc0 sc1
    s_waitcnt vmcnt(4)
    v_xor_b32 v96, v104, v16
    v_xor_b32 v97, v105, v17
    v_bitop3_b32 v96, v18, v104, v96 bitop3:0xbe
    v_bitop3_b32 v97, v19, v105, v97 bitop3:0xbe
    v_bitop3_b32 v96, v96, v97, v106 bitop3:0xa8
    v_cmp_ne_u32 vcc, 0, v96
    s_nop 0
    s_cbranch_vccz L_pa_d2
    v_mov_b32 v16, 0
    v_mov_b32 v17, 0
    v_mov_b32 v18, 0
    v_mov_b32 v19, 0
    buffer_atomic_or_x2 v[16:17], v246, s[36:39], s7 offen offset:0 sc0 sc1
    buffer_atomic_or_x2 v[18:19], v246, s[36:39], s7 offen offset:512 sc0 sc1
    s_sub_u32 s90, s90, 1
    s_cbranch_scc0 L_pa
    s_waitcnt vmcnt(0)
L_pa_d0:
    v_lshlrev_b32 v32, 16, v8
    v_and_b32 v33, 0xffff0000, v8
    v_lshlrev_b32 v34, 16, v9
    v_and_b32 v35, 0xffff0000, v9
    v_lshlrev_b32 v36, 16, v10
    v_and_b32 v37, 0xffff0000, v10
    v_lshlrev_b32 v38, 16, v11
    v_and_b32 v39, 0xffff0000, v11
    s_branch L_pa_x
L_pa_d1:
    v_lshlrev_b32 v32, 16, v12
    v_and_b32 v33, 0xffff0000, v12
    v_lshlrev_b32 v34, 16, v13
    v_and_b32 v35, 0xffff0000, v13
    v_lshlrev_b32 v36, 16, v14
    v_and_b32 v37, 0xffff0000, v14
    v_lshlrev_b32 v38, 16, v15
    v_and_b32 v39, 0xffff0000, v15
    s_branch L_pa_x
L_pa_d2:
    v_lshlrev_b32 v32, 16, v16
    v_and_b32 v33, 0xffff0000, v16
    v_lshlrev_b32 v34, 16, v17
    v_and_b32 v35, 0xffff0000, v17
    v_lshlrev_b32 v36, 16, v18
    v_and_b32 v37, 0xffff0000, v18
    v_lshlrev_b32 v38, 16, v19
    v_and_b32 v39, 0xffff0000, v19
L_pa_x:
    v_pk_add_f32 v[32:33], v[32:33], v[36:37]
    v_pk_add_f32 v[34:35], v[34:35], v[38:39]
    s_nop 0
    v_permlane32_swap_b32 v32, v33
    v_permlane32_swap_b32 v34, v35
    v_add_f32 v32, v32, v33
    v_add_f32 v34, v34, v35
    s_nop 1
    v_permlane16_swap_b32 v32, v34
    v_add_f32 v32, v32, v34
    ds_write_b32 v108, v32
    s_waitcnt lgkmcnt(0)
L_fin5:
    s_barrier
    s_cmp_lg_u32 s3, 0
    s_cbranch_scc1 L_fin7
    ds_read_b128 v[64:67], v111 offset:43264
    ds_read_b128 v[68:71], v111 offset:43520
    ds_read_b128 v[72:75], v111 offset:43776
    ds_read_b128 v[76:79], v111 offset:44032
    ds_read_b128 v[80:83], v111 offset:44288
    ds_read_b128 v[84:87], v111 offset:44544
    ds_read_b128 v[88:91], v111 offset:44800
    s_and_b32 s61, s99, 3
    s_lshl_b32 s61, s61, 2
    s_waitcnt lgkmcnt(0)
    v_pk_add_f32 v[68:69], v[68:69], v[72:73]
    v_pk_add_f32 v[70:71], v[70:71], v[74:75]
    v_pk_add_f32 v[76:77], v[76:77], v[80:81]
    v_pk_add_f32 v[78:79], v[78:79], v[82:83]
    v_pk_add_f32 v[84:85], v[84:85], v[88:89]
    v_pk_add_f32 v[86:87], v[86:87], v[90:91]
    v_pk_add_f32 v[64:65], v[64:65], v[68:69]
    v_pk_add_f32 v[76:77], v[76:77], v[84:85]
    v_pk_add_f32 v[66:67], v[66:67], v[70:71]
    v_pk_add_f32 v[78:79], v[78:79], v[86:87]
    v_pk_add_f32 v[64:65], v[64:65], v[76:77]
    v_pk_add_f32 v[66:67], v[66:67], v[78:79]
    v_pk_fma_f32 v[64:65], v[64:65], v[38:39], v[232:233] op_sel_hi:[1,0,1]
    v_pk_fma_f32 v[66:67], v[66:67], v[38:39], v[234:235] op_sel_hi:[1,0,1]
    v_cvt_pk_bf16_f32 v16, v64, v65
    v_cvt_pk_bf16_f32 v17, v66, v67
    s_lshl_b32 exec_lo, 0x000f000f, s61
    s_mov_b32 exec_hi, exec_lo
    buffer_store_dwordx2 v[16:17], v4, s[40:43], s12 offen sc1
    s_cmp_lg_u32 s99, 0
    s_cbranch_scc1 L_fin7
    s_mov_b64 exec, 1
    v_mov_b32 v20, 0
    v_mov_b32 v21, s59
    buffer_store_dword v21, v20, s[36:39], 0 offen sc1
L_fin7:
    s_endpgm
L_end:
    s_endpgm
.p2align 7
.type L_tab,@object
L_tab:
.long 0x3f80, 0x3f80, 0x3f80, 0x3f80, 0x3f80, 0x3ec43f6d, 0x3f353f35, 0x3f6d3ec4
.long 0x3f80, 0x3f353f35, 0x3f800000, 0x3f35bf35, 0x3f80, 0x3f6d3ec4, 0x3f35bf35, 0xbec4bf6d
.long 0x3f80, 0x3f800000, 0xbf80, 0xbf800000, 0x3f80, 0x3f6dbec4, 0xbf35bf35, 0xbec43f6d
.long 0x3f80, 0x3f35bf35, 0xbf800000, 0x3f353f35, 0x3f80, 0x3ec4bf6d, 0xbf353f35, 0x3f6dbec4
.long 0x3f80, 0xbf80, 0x3f80, 0xbf80, 0x3f80, 0xbec4bf6d, 0x3f353f35, 0xbf6dbec4
.long 0x3f80, 0xbf35bf35, 0x3f800000, 0xbf353f35, 0x3f80, 0xbf6dbec4, 0x3f35bf35, 0x3ec43f6d
.long 0x3f80, 0xbf800000, 0xbf80, 0x3f800000, 0x3f80, 0xbf6d3ec4, 0xbf35bf35, 0x3ec4bf6d
.long 0x3f80, 0xbf353f35, 0xbf800000, 0xbf35bf35, 0x3f80, 0xbec43f6d, 0xbf353f35, 0xbf6d3ec4
.long 0x3f80, 0x3f80, 0x3f80, 0x3f80, 0x3f800000, 0x3f6dbec4, 0x3f35bf35, 0x3ec4bf6d
.long 0xbf80, 0xbf35bf35, 0xbf800000, 0xbf353f35, 0xbf800000, 0xbec43f6d, 0x3f353f35, 0x3f6dbec4
.long 0x3f80, 0x3f800000, 0xbf80, 0xbf800000, 0x3f800000, 0xbec4bf6d, 0xbf353f35, 0x3f6d3ec4
.long 0xbf80, 0xbf353f35, 0x3f800000, 0xbf35bf35, 0xbf800000, 0x3f6d3ec4, 0xbf35bf35, 0x3ec43f6d
.long 0x3f80, 0xbf80, 0x3f80, 0xbf80, 0x3f800000, 0xbf6d3ec4, 0x3f35bf35, 0xbec43f6d
.long 0xbf80, 0x3f353f35, 0xbf800000, 0x3f35bf35, 0xbf800000, 0x3ec4bf6d, 0x3f353f35, 0xbf6d3ec4
.long 0x3f80, 0xbf800000, 0xbf80, 0x3f800000, 0x3f800000, 0x3ec43f6d, 0xbf353f35, 0xbf6dbec4
.long 0xbf80, 0x3f35bf35, 0x3f800000, 0x3f353f35, 0xbf800000, 0xbf6dbec4, 0xbf35bf35, 0xbec4bf6d
.long 0x3f80, 0x3f80, 0x3f80, 0x3f80, 0xbf80, 0xbec4bf6d, 0xbf35bf35, 0xbf6dbec4
.long 0x3f80, 0x3f353f35, 0x3f800000, 0x3f35bf35, 0xbf80, 0xbf6dbec4, 0xbf353f35, 0x3ec43f6d
.long 0x3f80, 0x3f800000, 0xbf80, 0xbf800000, 0xbf80, 0xbf6d3ec4, 0x3f353f35, 0x3ec4bf6d
.long 0x3f80, 0x3f35bf35, 0xbf800000, 0x3f353f35, 0xbf80, 0xbec43f6d, 0x3f35bf35, 0xbf6d3ec4
.long 0x3f80, 0xbf80, 0x3f80, 0xbf80, 0xbf80, 0x3ec43f6d, 0xbf35bf35, 0x3f6d3ec4
.long 0x3f80, 0xbf35bf35, 0x3f800000, 0xbf353f35, 0xbf80, 0x3f6d3ec4, 0xbf353f35, 0xbec4bf6d
.long 0x3f80, 0xbf800000, 0xbf80, 0x3f800000, 0xbf80, 0x3f6dbec4, 0x3f353f35, 0xbec43f6d
.long 0x3f80, 0xbf353f35, 0xbf800000, 0xbf35bf35, 0xbf80, 0x3ec4bf6d, 0x3f35bf35, 0x3f6dbec4
.long 0x3f80, 0x3f80, 0x3f80, 0x3f80, 0xbf800000, 0xbf6d3ec4, 0xbf353f35, 0xbec43f6d
.long 0xbf80, 0xbf35bf35, 0xbf800000, 0xbf353f35, 0x3f800000, 0x3ec4bf6d, 0xbf35bf35, 0xbf6d3ec4
.long 0x3f80, 0x3f800000, 0xbf80, 0xbf800000, 0xbf800000, 0x3ec43f6d, 0x3f35bf35, 0xbf6dbec4
.long 0xbf80, 0xbf353f35, 0x3f800000, 0xbf35bf35, 0x3f800000, 0xbf6dbec4, 0x3f353f35, 0xbec4bf6d
.long 0x3f80, 0xbf80, 0x3f80, 0xbf80, 0xbf800000, 0x3f6dbec4, 0xbf353f35, 0x3ec4bf6d
.long 0xbf80, 0x3f353f35, 0xbf800000, 0x3f35bf35, 0x3f800000, 0xbec43f6d, 0xbf35bf35, 0x3f6dbec4
.long 0x3f80, 0xbf800000, 0xbf80, 0x3f800000, 0xbf800000, 0xbec4bf6d, 0x3f35bf35, 0x3f6d3ec4
.long 0xbf80, 0x3f35bf35, 0x3f800000, 0x3f353f35, 0x3f800000, 0x3f6d3ec4, 0x3f353f35, 0x3ec43f6d
.long 0x3f808000, 0x3f808000, 0x3f808000, 0x3f808000, 0x3f808000, 0x3f6dbec4, 0x3f35bf35, 0x3ec4bf6d
.long 0x3f808000, 0x3f35bf35, 0xbf80, 0xbf35bf35, 0x3f808000, 0x3ec4bf6d, 0xbf35bf35, 0xbf6d3ec4
.long 0x3f808000, 0xbf80, 0xbf808000, 0x3f80, 0x3f808000, 0xbec4bf6d, 0xbf353f35, 0x3f6d3ec4
.long 0x3f808000, 0xbf35bf35, 0x3f80, 0x3f35bf35, 0x3f808000, 0xbf6dbec4, 0x3f353f35, 0xbec4bf6d
.long 0x3f808000, 0xbf808000, 0x3f808000, 0xbf808000, 0x3f808000, 0xbf6d3ec4, 0x3f35bf35, 0xbec43f6d
.long 0x3f808000, 0xbf353f35, 0xbf80, 0x3f353f35, 0x3f808000, 0xbec43f6d, 0xbf35bf35, 0x3f6dbec4
.long 0x3f808000, 0x3f80, 0xbf808000, 0xbf80, 0x3f808000, 0x3ec43f6d, 0xbf353f35, 0xbf6dbec4
.long 0x3f808000, 0x3f353f35, 0x3f80, 0xbf353f35, 0x3f808000, 0x3f6d3ec4, 0x3f353f35, 0x3ec43f6d
.long 0x3f808000, 0x3f808000, 0x3f808000, 0x3f808000, 0xbf80, 0xbec4bf6d, 0xbf35bf35, 0xbf6dbec4
.long 0xbf808000, 0xbf353f35, 0x3f80, 0x3f353f35, 0x3f80, 0x3f6d3ec4, 0x3f35bf35, 0xbec4bf6d
.long 0x3f808000, 0xbf80, 0xbf808000, 0x3f80, 0xbf80, 0xbf6d3ec4, 0x3f353f35, 0x3ec4bf6d
.long 0xbf808000, 0x3f353f35, 0xbf80, 0xbf353f35, 0x3f80, 0x3ec4bf6d, 0xbf353f35, 0x3f6dbec4
.long 0x3f808000, 0xbf808000, 0x3f808000, 0xbf808000, 0xbf80, 0x3ec43f6d, 0xbf35bf35, 0x3f6d3ec4
.long 0xbf808000, 0x3f35bf35, 0x3f80, 0xbf35bf35, 0x3f80, 0xbf6dbec4, 0x3f35bf35, 0x3ec43f6d
.long 0x3f808000, 0x3f80, 0xbf808000, 0xbf80, 0xbf80, 0x3f6dbec4, 0x3f353f35, 0xbec43f6d
.long 0xbf808000, 0xbf35bf35, 0xbf80, 0x3f35bf35, 0x3f80, 0xbec43f6d, 0xbf353f35, 0xbf6d3ec4
.long 0x3f808000, 0x3f808000, 0x3f808000, 0x3f808000, 0xbf808000, 0xbf6d3ec4, 0xbf353f35, 0xbec43f6d
.long 0x3f808000, 0x3f35bf35, 0xbf80, 0xbf35bf35, 0xbf808000, 0xbec43f6d, 0x3f353f35, 0x3f6dbec4
.long 0x3f808000, 0xbf80, 0xbf808000, 0x3f80, 0xbf808000, 0x3ec43f6d, 0x3f35bf35, 0xbf6dbec4
.long 0x3f808000, 0xbf35bf35, 0x3f80, 0x3f35bf35, 0xbf808000, 0x3f6d3ec4, 0xbf35bf35, 0x3ec43f6d
.long 0x3f808000, 0xbf808000, 0x3f808000, 0xbf808000, 0xbf808000, 0x3f6dbec4, 0xbf353f35, 0x3ec4bf6d
.long 0x3f808000, 0xbf353f35, 0xbf80, 0x3f353f35, 0xbf808000, 0x3ec4bf6d, 0x3f353f35, 0xbf6d3ec4
.long 0x3f808000, 0x3f80, 0xbf808000, 0xbf80, 0xbf808000, 0xbec4bf6d, 0x3f35bf35, 0x3f6d3ec4
.long 0x3f808000, 0x3f353f35, 0x3f80, 0xbf353f35, 0xbf808000, 0xbf6dbec4, 0xbf35bf35, 0xbec4bf6d
.long 0x3f808000, 0x3f808000, 0x3f808000, 0x3f808000, 0x3f80, 0x3ec43f6d, 0x3f353f35, 0x3f6d3ec4
.long 0xbf808000, 0xbf353f35, 0x3f80, 0x3f353f35, 0xbf80, 0xbf6dbec4, 0xbf353f35, 0x3ec43f6d
.long 0x3f808000, 0xbf80, 0xbf808000, 0x3f80, 0x3f80, 0x3f6dbec4, 0xbf35bf35, 0xbec43f6d
.long 0xbf808000, 0x3f353f35, 0xbf80, 0xbf353f35, 0xbf80, 0xbec43f6d, 0x3f35bf35, 0xbf6d3ec4
.long 0x3f808000, 0xbf808000, 0x3f808000, 0xbf808000, 0x3f80, 0xbec4bf6d, 0x3f353f35, 0xbf6dbec4
.long 0xbf808000, 0x3f35bf35, 0x3f80, 0xbf35bf35, 0xbf80, 0x3f6d3ec4, 0xbf353f35, 0xbec4bf6d
.long 0x3f808000, 0x3f80, 0xbf808000, 0xbf80, 0x3f80, 0xbf6d3ec4, 0xbf35bf35, 0x3ec4bf6d
.long 0xbf808000, 0xbf35bf35, 0xbf80, 0x3f35bf35, 0xbf80, 0x3ec4bf6d, 0x3f35bf35, 0x3f6dbec4
.long 0x3f800000, 0x3f800000, 0x3f800000, 0x3f800000, 0x3f800000, 0x3f7fec43, 0x3f7fb10f, 0x3f7f4e6d
.long 0x3f800000, 0x3f7fb10f, 0x3f7ec46d, 0x3f7d3aac, 0x3f800000, 0x3f7f4e6d, 0x3f7d3aac, 0x3f79c79d
.long 0x3f800000, 0x3f7ec46d, 0x3f7b14be, 0x3f74fa0b, 0x3f800000, 0x3f7e1324, 0x3f7853f8, 0x3f6ed89e
.long 0x3f800000, 0x3f7d3aac, 0x3f74fa0b, 0x3f676bd8, 0x3f800000, 0x3f7c3b28, 0x3f710908, 0x3f5ebe05
.long 0x3f800000, 0x3f7b14be, 0x3f6c835e, 0x3f54db31, 0x3f800000, 0x3f79c79d, 0x3f676bd8, 0x3f49d112
.long 0x3f800000, 0x3f7853f8, 0x3f61c598, 0x3f3daef9, 0x3f800000, 0x3f76ba07, 0x3f5b941a, 0x3f3085bb
.long 0x3f800000, 0x3f74fa0b, 0x3f54db31, 0x3f226799, 0x3f800000, 0x3f731447, 0x3f4d9f02, 0x3f13682a
.long 0x3f800000, 0x3f710908, 0x3f45e403, 0x3f039c3d, 0x3f800000, 0x3f6ed89e, 0x3f3daef9, 0x3ee63375
.long 0x3f800000, 0x3f800000, 0x3f800000, 0x3f800000, 0x3f7ec46d, 0x3f7e1324, 0x3f7d3aac, 0x3f7c3b28
.long 0x3f7b14be, 0x3f7853f8, 0x3f74fa0b, 0x3f710908, 0x3f74fa0b, 0x3f6ed89e, 0x3f676bd8, 0x3f5ebe05
.long 0x3f6c835e, 0x3f61c598, 0x3f54db31, 0x3f45e403, 0x3f61c598, 0x3f514d3d, 0x3f3daef9, 0x3f273656
.long 0x3f54db31, 0x3f3daef9, 0x3f226799, 0x3f039c3d, 0x3f45e403, 0x3f273656, 0x3f039c3d, 0x3eb8442a
.long 0x3f3504f3, 0x3f0e39da, 0x3ec3ef15, 0x3e47c5c2, 0x3f226799, 0x3ee63375, 0x3e78cfcc, 0x3cc90ab0
.long 0x3f0e39da, 0x3eac7cd4, 0x3dc8bd36, 0xbe164083, 0x3ef15aea, 0x3e605c13, 0xbd48fb30, 0xbea09ae5
.long 0x3ec3ef15, 0x3dc8bd36, 0xbe47c5c2, 0xbef15aea, 0x3e94a031, 0xbcc90ab0, 0xbeac7cd4, 0xbf1d7fd1
.long 0x3e47c5c2, 0xbe164083, 0xbef15aea, 0xbf3daef9, 0x3dc8bd36, 0xbe888e93, 0xbf187fc0, 0xbf584853
.long 0x3f800000, 0x3f800000, 0x3f800000, 0x3f800000, 0x3f7b14be, 0x3f79c79d, 0x3f7853f8, 0x3f76ba07
.long 0x3f6c835e, 0x3f676bd8, 0x3f61c598, 0x3f5b941a, 0x3f54db31, 0x3f49d112, 0x3f3daef9, 0x3f3085bb
.long 0x3f3504f3, 0x3f226799, 0x3f0e39da, 0x3ef15aea, 0x3f0e39da, 0x3ee63375, 0x3eac7cd4, 0x3e605c13
.long 0x3ec3ef15, 0x3e78cfcc, 0x3dc8bd36, 0xbd48fb30, 0x3e47c5c2, 0x3cc90ab0, 0xbe164083, 0xbea09ae5
.long 0x0, 0xbe47c5c2, 0xbec3ef15, 0xbf0e39da, 0xbe47c5c2, 0xbecf7bca, 0xbf187fc0, 0xbf41d870
.long 0xbec3ef15, 0xbf187fc0, 0xbf45e403, 0xbf676bd8, 0xbf0e39da, 0xbf41d870, 0xbf676bd8, 0xbf7c3b28
.long 0xbf3504f3, 0xbf61c598, 0xbf7b14be, 0xbf7ec46d, 0xbf54db31, 0xbf76ba07, 0xbf7fb10f, 0xbf6ed89e
.long 0xbf6c835e, 0xbf7fb10f, 0xbf74fa0b, 0xbf4d9f02, 0xbf7b14be, 0xbf7c3b28, 0xbf5b941a, 0xbf1d7fd1
.long 0x3f800000, 0x3f800000, 0x3f800000, 0x3f800000, 0x3f74fa0b, 0x3f731447, 0x3f710908, 0x3f6ed89e
.long 0x3f54db31, 0x3f4d9f02, 0x3f45e403, 0x3f3daef9, 0x3f226799, 0x3f13682a, 0x3f039c3d, 0x3ee63375
.long 0x3ec3ef15, 0x3e94a031, 0x3e47c5c2, 0x3dc8bd36, 0x3dc8bd36, 0xbcc90ab0, 0xbe164083, 0xbe888e93
.long 0xbe47c5c2, 0xbeac7cd4, 0xbef15aea, 0xbf187fc0, 0xbef15aea, 0xbf1d7fd1, 0xbf3daef9, 0xbf584853
.long 0xbf3504f3, 0xbf54db31, 0xbf6c835e, 0xbf7b14be, 0xbf61c598, 0xbf76ba07, 0xbf7fb10f, 0xbf7c3b28
.long 0xbf7b14be, 0xbf7fb10f, 0xbf74fa0b, 0xbf5b941a, 0xbf7ec46d, 0xbf6ed89e, 0xbf4d9f02, 0xbf1d7fd1
.long 0xbf6c835e, 0xbf45e403, 0xbf0e39da, 0xbe94a031, 0xbf45e403, 0xbf08f59b, 0xbe78cfcc, 0x3d96a905
.long 0xbf0e39da, 0xbe78cfcc, 0x3dc8bd36, 0x3edae880, 0xbe94a031, 0x3d96a905, 0x3edae880, 0x3f396842
.long 0x0, 0x0, 0x0, 0x0, 0x0, 0x3cc90ab0, 0x3d48fb30, 0x3d96a905
.long 0x0, 0x3d48fb30, 0x3dc8bd36, 0x3e164083, 0x0, 0x3d96a905, 0x3e164083, 0x3e605c13
.long 0x0, 0x3dc8bd36, 0x3e47c5c2, 0x3e94a031, 0x0, 0x3dfab273, 0x3e78cfcc, 0x3eb8442a
.long 0x0, 0x3e164083, 0x3e94a031, 0x3edae880, 0x0, 0x3e2f10a2, 0x3eac7cd4, 0x3efc5d27
.long 0x0, 0x3e47c5c2, 0x3ec3ef15, 0x3f0e39da, 0x0, 0x3e605c13, 0x3edae880, 0x3f1d7fd1
.long 0x0, 0x3e78cfcc, 0x3ef15aea, 0x3f2beb4a, 0x0, 0x3e888e93, 0x3f039c3d, 0x3f396842
.long 0x0, 0x3e94a031, 0x3f0e39da, 0x3f45e403, 0x0, 0x3ea09ae5, 0x3f187fc0, 0x3f514d3d
.long 0x0, 0x3eac7cd4, 0x3f226799, 0x3f5b941a, 0x0, 0x3eb8442a, 0x3f2beb4a, 0x3f64aa59
.long 0x0, 0x0, 0x0, 0x0, 0x3dc8bd36, 0x3dfab273, 0x3e164083, 0x3e2f10a2
.long 0x3e47c5c2, 0x3e78cfcc, 0x3e94a031, 0x3eac7cd4, 0x3e94a031, 0x3eb8442a, 0x3edae880, 0x3efc5d27
.long 0x3ec3ef15, 0x3ef15aea, 0x3f0e39da, 0x3f226799, 0x3ef15aea, 0x3f13682a, 0x3f2beb4a, 0x3f41d870
.long 0x3f0e39da, 0x3f2beb4a, 0x3f45e403, 0x3f5b941a, 0x3f226799, 0x3f41d870, 0x3f5b941a, 0x3f6ed89e
.long 0x3f3504f3, 0x3f54db31, 0x3f6c835e, 0x3f7b14be, 0x3f45e403, 0x3f64aa59, 0x3f7853f8, 0x3f7fec43
.long 0x3f54db31, 0x3f710908, 0x3f7ec46d, 0x3f7d3aac, 0x3f61c598, 0x3f79c79d, 0x3f7fb10f, 0x3f731447
.long 0x3f6c835e, 0x3f7ec46d, 0x3f7b14be, 0x3f61c598, 0x3f74fa0b, 0x3f7fec43, 0x3f710908, 0x3f49d112
.long 0x3f7b14be, 0x3f7d3aac, 0x3f61c598, 0x3f2beb4a, 0x3f7ec46d, 0x3f76ba07, 0x3f4d9f02, 0x3f08f59b
.long 0x0, 0x0, 0x0, 0x0, 0x3e47c5c2, 0x3e605c13, 0x3e78cfcc, 0x3e888e93
.long 0x3ec3ef15, 0x3edae880, 0x3ef15aea, 0x3f039c3d, 0x3f0e39da, 0x3f1d7fd1, 0x3f2beb4a, 0x3f396842
.long 0x3f3504f3, 0x3f45e403, 0x3f54db31, 0x3f61c598, 0x3f54db31, 0x3f64aa59, 0x3f710908, 0x3f79c79d
.long 0x3f6c835e, 0x3f7853f8, 0x3f7ec46d, 0x3f7fb10f, 0x3f7b14be, 0x3f7fec43, 0x3f7d3aac, 0x3f731447
.long 0x3f800000, 0x3f7b14be, 0x3f6c835e, 0x3f54db31, 0x3f7b14be, 0x3f6a09a7, 0x3f4d9f02, 0x3f273656
.long 0x3f6c835e, 0x3f4d9f02, 0x3f226799, 0x3edae880, 0x3f54db31, 0x3f273656, 0x3edae880, 0x3e2f10a2
.long 0x3f3504f3, 0x3ef15aea, 0x3e47c5c2, 0xbdc8bd36, 0x3f0e39da, 0x3e888e93, 0xbd48fb30, 0xbeb8442a
.long 0x3ec3ef15, 0x3d48fb30, 0xbe94a031, 0xbf187fc0, 0x3e47c5c2, 0xbe2f10a2, 0xbf039c3d, 0xbf49d112
.long 0x0, 0x0, 0x0, 0x0, 0x3e94a031, 0x3ea09ae5, 0x3eac7cd4, 0x3eb8442a
.long 0x3f0e39da, 0x3f187fc0, 0x3f226799, 0x3f2beb4a, 0x3f45e403, 0x3f514d3d, 0x3f5b941a, 0x3f64aa59
.long 0x3f6c835e, 0x3f74fa0b, 0x3f7b14be, 0x3f7ec46d, 0x3f7ec46d, 0x3f7fec43, 0x3f7d3aac, 0x3f76ba07
.long 0x3f7b14be, 0x3f710908, 0x3f61c598, 0x3f4d9f02, 0x3f61c598, 0x3f49d112, 0x3f2beb4a, 0x3f08f59b
.long 0x3f3504f3, 0x3f0e39da, 0x3ec3ef15, 0x3e47c5c2, 0x3ef15aea, 0x3e888e93, 0x3d48fb30, 0xbe2f10a2
.long 0x3e47c5c2, 0xbd48fb30, 0xbe94a031, 0xbf039c3d, 0xbdc8bd36, 0xbeb8442a, 0xbf187fc0, 0xbf49d112
.long 0xbec3ef15, 0xbf226799, 0xbf54db31, 0xbf74fa0b, 0xbf226799, 0xbf584853, 0xbf7853f8, 0xbf7f4e6d
.long 0xbf54db31, 0xbf7853f8, 0xbf7ec46d, 0xbf676bd8, 0xbf74fa0b, 0xbf7f4e6d, 0xbf676bd8, 0xbf3085bb
.long 0x3f800000, 0x3f800000, 0x3f800000, 0x3f800000, 0x3f7ffb11, 0x3f7fd397, 0x3f7f84ab, 0x3f7f0e58
.long 0x3f7fec43, 0x3f7f4e6d, 0x3f7e1324, 0x3f7c3b28, 0x3f7fd397, 0x3f7e70b0, 0x3f7baccd, 0x3f778bc5
.long 0x3f7fb10f, 0x3f7d3aac, 0x3f7853f8, 0x3f710908, 0x3f7f84ab, 0x3f7baccd, 0x3f740bdd, 0x3f68bf3c
.long 0x3f7f4e6d, 0x3f79c79d, 0x3f6ed89e, 0x3f5ebe05, 0x3f7f0e58, 0x3f778bc5, 0x3f68bf3c, 0x3f531849
.long 0x3f7ec46d, 0x3f74fa0b, 0x3f61c598, 0x3f45e403, 0x3f7e70b0, 0x3f721352, 0x3f59f26a, 0x3f373a23
.long 0x3f7e1324, 0x3f6ed89e, 0x3f514d3d, 0x3f273656, 0x3f7dabcc, 0x3f6b4b0c, 0x3f47de65, 0x3f15f6d9
.long 0x3f7d3aac, 0x3f676bd8, 0x3f3daef9, 0x3f039c3d, 0x3f7cbfc9, 0x3f633c5a, 0x3f32c8c9, 0x3ee0924f
.long 0x3f7c3b28, 0x3f5ebe05, 0x3f273656, 0x3eb8442a, 0x3f7baccd, 0x3f59f26a, 0x3f1b02c6, 0x3e8e9a22
.long 0x3f800000, 0x3f800000, 0x3f800000, 0x3f800000, 0x3f7e70b0, 0x3f7dabcc, 0x3f7cbfc9, 0x3f7baccd
.long 0x3f79c79d, 0x3f76ba07, 0x3f731447, 0x3f6ed89e, 0x3f721352, 0x3f6b4b0c, 0x3f633c5a, 0x3f59f26a
.long 0x3f676bd8, 0x3f5b941a, 0x3f4d9f02, 0x3f3daef9, 0x3f59f26a, 0x3f47de65, 0x3f32c8c9, 0x3f1b02c6
.long 0x3f49d112, 0x3f3085bb, 0x3f13682a, 0x3ee63375, 0x3f373a23, 0x3f15f6d9, 0x3ee0924f, 0x3e8e9a22
.long 0x3f226799, 0x3ef15aea, 0x3e94a031, 0x3dc8bd36, 0x3f0b9a6b, 0x3eb263ef, 0x3e09cf86, 0xbdafb680
.long 0x3ee63375, 0x3e605c13, 0xbcc90ab0, 0xbe888e93, 0x3eb263ef, 0x3dafb680, 0xbe3b6ecf, 0xbee0924f
.long 0x3e78cfcc, 0xbd48fb30, 0xbeac7cd4, 0xbf187fc0, 0x3e09cf86, 0xbe3b6ecf, 0xbef6e0cb, 0xbf3b8f3b
.long 0x3cc90ab0, 0xbea09ae5, 0xbf1d7fd1, 0xbf584853, 0xbdafb680, 0xbee0924f, 0xbf3b8f3b, 0xbf6db293
.long 0x3f800000, 0x3f800000, 0x3f800000, 0x3f800000, 0x3f7a7302, 0x3f791298, 0x3f778bc5, 0x3f75dec6
.long 0x3f6a09a7, 0x3f64aa59, 0x3f5ebe05, 0x3f584853, 0x3f4f7a1f, 0x3f43e200, 0x3f373a23, 0x3f299415
.long 0x3f2beb4a, 0x3f187fc0, 0x3f039c3d, 0x3edae880, 0x3f00e7e4, 0x3ec9b953, 0x3e8e9a22, 0x3e22abb6
.long 0x3ea09ae5, 0x3e2f10a2, 0x3cc90ab0, 0xbdfab273, 0x3de1bc2e, 0xbd7b2b74, 0xbe6c9a7f, 0xbec9b953
.long 0xbdc8bd36, 0xbe94a031, 0xbef15aea, 0xbf226799, 0xbe9aa086, 0xbf00e7e4, 0xbf2e3bde, 0xbf531849
.long 0xbefc5d27, 0xbf3085bb, 0xbf584853, 0xbf731447, 0xbf299415, 0xbf5695e5, 0xbf740bdd, 0xbf7fd397
.long 0xbf4d9f02, 0xbf710908, 0xbf7fb10f, 0xbf7853f8, 0xbf68bf3c, 0xbf7e70b0, 0xbf7a7302, 0xbf5d2d53
.long 0xbf79c79d, 0xbf7e1324, 0xbf64aa59, 0xbf3085bb, 0xbf7ffb11, 0xbf6ff573, 0xbf3fc767, 0xbeebcbbb
.long 0x3f800000, 0x3f800000, 0x3f800000, 0x3f800000, 0x3f740bdd, 0x3f721352, 0x3f6ff573, 0x3f6db293
.long 0x3f514d3d, 0x3f49d112, 0x3f41d870, 0x3f396842, 0x3f1b02c6, 0x3f0b9a6b, 0x3ef6e0cb, 0x3ed53641
.long 0x3eac7cd4, 0x3e78cfcc, 0x3e164083, 0x3d48fb30, 0x3d16c32c, 0xbdafb680, 0xbe541501, 0xbea68f12
.long 0xbe888e93, 0xbecf7bca, 0xbf08f59b, 0xbf273656, 0xbf0b9a6b, 0xbf2e3bde, 0xbf4bbbf8, 0xbf633c5a
.long 0xbf45e403, 0xbf61c598, 0xbf74fa0b, 0xbf7ec46d, 0xbf6db293, 0xbf7cbfc9, 0xbf7f84ab, 0xbf75dec6
.long 0xbf7f4e6d, 0xbf7c3b28, 0xbf6a09a7, 0xbf49d112, 0xbf791298, 0xbf604621, 0xbf373a23, 0xbf00e7e4
.long 0xbf5b941a, 0xbf2beb4a, 0xbedae880, 0xbe164083, 0xbf299415, 0xbec9b953, 0xbdafb680, 0x3e6c9a7f
.long 0xbecf7bca, 0xbd96a905, 0x3e888e93, 0x3f13682a, 0xbde1bc2e, 0x3e827dc0, 0x3f15f6d9, 0x3f5695e5
.long 0x0, 0x0, 0x0, 0x0, 0x3c490e90, 0x3d16c32c, 0x3d7b2b74, 0x3dafb680
.long 0x3cc90ab0, 0x3d96a905, 0x3dfab273, 0x3e2f10a2, 0x3d16c32c, 0x3de1bc2e, 0x3e3b6ecf, 0x3e827dc0
.long 0x3d48fb30, 0x3e164083, 0x3e78cfcc, 0x3eac7cd4, 0x3d7b2b74, 0x3e3b6ecf, 0x3e9aa086, 0x3ed53641
.long 0x3d96a905, 0x3e605c13, 0x3eb8442a, 0x3efc5d27, 0x3dafb680, 0x3e827dc0, 0x3ed53641, 0x3f10d3cd
.long 0x3dc8bd36, 0x3e94a031, 0x3ef15aea, 0x3f226799, 0x3de1bc2e, 0x3ea68f12, 0x3f064b82, 0x3f32c8c9
.long 0x3dfab273, 0x3eb8442a, 0x3f13682a, 0x3f41d870, 0x3e09cf86, 0x3ec9b953, 0x3f1ff6cb, 0x3f4f7a1f
.long 0x3e164083, 0x3edae880, 0x3f2beb4a, 0x3f5b941a, 0x3e22abb6, 0x3eebcbbb, 0x3f373a23, 0x3f660f88
.long 0x3e2f10a2, 0x3efc5d27, 0x3f41d870, 0x3f6ed89e, 0x3e3b6ecf, 0x3f064b82, 0x3f4bbbf8, 0x3f75dec6
.long 0x0, 0x0, 0x0, 0x0, 0x3de1bc2e, 0x3e09cf86, 0x3e22abb6, 0x3e3b6ecf
.long 0x3e605c13, 0x3e888e93, 0x3ea09ae5, 0x3eb8442a, 0x3ea68f12, 0x3ec9b953, 0x3eebcbbb, 0x3f064b82
.long 0x3edae880, 0x3f039c3d, 0x3f187fc0, 0x3f2beb4a, 0x3f064b82, 0x3f1ff6cb, 0x3f373a23, 0x3f4bbbf8
.long 0x3f1d7fd1, 0x3f396842, 0x3f514d3d, 0x3f64aa59, 0x3f32c8c9, 0x3f4f7a1f, 0x3f660f88, 0x3f75dec6
.long 0x3f45e403, 0x3f61c598, 0x3f74fa0b, 0x3f7ec46d, 0x3f5695e5, 0x3f6ff573, 0x3f7dabcc, 0x3f7f0e58
.long 0x3f64aa59, 0x3f79c79d, 0x3f7fec43, 0x3f76ba07, 0x3f6ff573, 0x3f7f0e58, 0x3f7baccd, 0x3f660f88
.long 0x3f7853f8, 0x3f7fb10f, 0x3f710908, 0x3f4d9f02, 0x3f7dabcc, 0x3f7baccd, 0x3f604621, 0x3f2e3bde
.long 0x3f7fec43, 0x3f731447, 0x3f49d112, 0x3f08f59b, 0x3f7f0e58, 0x3f660f88, 0x3f2e3bde, 0x3ebe1d4a
.long 0x0, 0x0, 0x0, 0x0, 0x3e541501, 0x3e6c9a7f, 0x3e827dc0, 0x3e8e9a22
.long 0x3ecf7bca, 0x3ee63375, 0x3efc5d27, 0x3f08f59b, 0x3f15f6d9, 0x3f24d225, 0x3f32c8c9, 0x3f3fc767
.long 0x3f3daef9, 0x3f4d9f02, 0x3f5b941a, 0x3f676bd8, 0x3f5d2d53, 0x3f6b4b0c, 0x3f75dec6, 0x3f7cbfc9
.long 0x3f731447, 0x3f7c3b28, 0x3f7fec43, 0x3f7e1324, 0x3f7e70b0, 0x3f7f84ab, 0x3f791298, 0x3f6b4b0c
.long 0x3f7ec46d, 0x3f74fa0b, 0x3f61c598, 0x3f45e403, 0x3f740bdd, 0x3f5d2d53, 0x3f3b8f3b, 0x3f10d3cd
.long 0x3f5ebe05, 0x3f396842, 0x3f08f59b, 0x3ea09ae5, 0x3f3fc767, 0x3f0b9a6b, 0x3e9aa086, 0x3d16c32c
.long 0x3f187fc0, 0x3eac7cd4, 0x3d48fb30, 0xbe78cfcc, 0x3ed53641, 0x3de1bc2e, 0xbe541501, 0xbf00e7e4
.long 0x3e605c13, 0xbdfab273, 0xbee63375, 0xbf396842, 0x3c490e90, 0xbeb263ef, 0xbf299415, 0xbf633c5a
.long 0x0, 0x0, 0x0, 0x0, 0x3e9aa086, 0x3ea68f12, 0x3eb263ef, 0x3ebe1d4a
.long 0x3f13682a, 0x3f1d7fd1, 0x3f273656, 0x3f3085bb, 0x3f4bbbf8, 0x3f5695e5, 0x3f604621, 0x3f68bf3c
.long 0x3f710908, 0x3f7853f8, 0x3f7d3aac, 0x3f7fb10f, 0x3f7fd397, 0x3f7f0e58, 0x3f7a7302, 0x3f721352
.long 0x3f76ba07, 0x3f6a09a7, 0x3f584853, 0x3f41d870, 0x3f5695e5, 0x3f3b8f3b, 0x3f1b02c6, 0x3eebcbbb
.long 0x3f226799, 0x3ef15aea, 0x3e94a031, 0x3dc8bd36, 0x3ebe1d4a, 0x3e22abb6, 0xbd7b2b74, 0xbe8e9a22
.long 0x3d96a905, 0xbe2f10a2, 0xbecf7bca, 0xbf1d7fd1, 0xbe6c9a7f, 0xbef6e0cb, 0xbf32c8c9, 0xbf5d2d53
.long 0xbf039c3d, 0xbf3daef9, 0xbf676bd8, 0xbf7d3aac, 0xbf3fc767, 0xbf6b4b0c, 0xbf7f0e58, 0xbf791298
.long 0xbf6a09a7, 0xbf7f4e6d, 0xbf76ba07, 0xbf514d3d, 0xbf7e70b0, 0xbf778bc5, 0xbf4f7a1f, 0xbf0b9a6b
.long 0x3f80, 0x3f80, 0x3f80, 0x3f80, 0x3f80, 0x3ec43f6d, 0x3f353f35, 0x3f6d3ec4
.long 0x3f80, 0x3f353f35, 0x3f800000, 0x3f35bf35, 0x3f80, 0x3f6d3ec4, 0x3f35bf35, 0xbec4bf6d
.long 0x3f80, 0x3f800000, 0xbf80, 0xbf800000, 0x3f80, 0x3f6dbec4, 0xbf35bf35, 0xbec43f6d
.long 0x3f80, 0x3f35bf35, 0xbf800000, 0x3f353f35, 0x3f80, 0x3ec4bf6d, 0xbf353f35, 0x3f6dbec4
.long 0x3f80, 0xbf80, 0x3f80, 0xbf80, 0x3f80, 0xbec4bf6d, 0x3f353f35, 0xbf6dbec4
.long 0x3f80, 0xbf35bf35, 0x3f800000, 0xbf353f35, 0x3f80, 0xbf6dbec4, 0x3f35bf35, 0x3ec43f6d
.long 0x3f80, 0xbf800000, 0xbf80, 0x3f800000, 0x3f80, 0xbf6d3ec4, 0xbf35bf35, 0x3ec4bf6d
.long 0x3f80, 0xbf353f35, 0xbf800000, 0xbf35bf35, 0x3f80, 0xbec43f6d, 0xbf353f35, 0xbf6d3ec4
.long 0x3f80, 0x3f80, 0x3f80, 0x3f80, 0x3f800000, 0x3f6dbec4, 0x3f35bf35, 0x3ec4bf6d
.long 0xbf80, 0xbf35bf35, 0xbf800000, 0xbf353f35, 0xbf800000, 0xbec43f6d, 0x3f353f35, 0x3f6dbec4
.long 0x3f80, 0x3f800000, 0xbf80, 0xbf800000, 0x3f800000, 0xbec4bf6d, 0xbf353f35, 0x3f6d3ec4
.long 0xbf80, 0xbf353f35, 0x3f800000, 0xbf35bf35, 0xbf800000, 0x3f6d3ec4, 0xbf35bf35, 0x3ec43f6d
.long 0x3f80, 0xbf80, 0x3f80, 0xbf80, 0x3f800000, 0xbf6d3ec4, 0x3f35bf35, 0xbec43f6d
.long 0xbf80, 0x3f353f35, 0xbf800000, 0x3f35bf35, 0xbf800000, 0x3ec4bf6d, 0x3f353f35, 0xbf6d3ec4
.long 0x3f80, 0xbf800000, 0xbf80, 0x3f800000, 0x3f800000, 0x3ec43f6d, 0xbf353f35, 0xbf6dbec4
.long 0xbf80, 0x3f35bf35, 0x3f800000, 0x3f353f35, 0xbf800000, 0xbf6dbec4, 0xbf35bf35, 0xbec4bf6d
.long 0x3f80, 0x3f80, 0x3f80, 0x3f80, 0xbf80, 0xbec4bf6d, 0xbf35bf35, 0xbf6dbec4
.long 0x3f80, 0x3f353f35, 0x3f800000, 0x3f35bf35, 0xbf80, 0xbf6dbec4, 0xbf353f35, 0x3ec43f6d
.long 0x3f80, 0x3f800000, 0xbf80, 0xbf800000, 0xbf80, 0xbf6d3ec4, 0x3f353f35, 0x3ec4bf6d
.long 0x3f80, 0x3f35bf35, 0xbf800000, 0x3f353f35, 0xbf80, 0xbec43f6d, 0x3f35bf35, 0xbf6d3ec4
.long 0x3f80, 0xbf80, 0x3f80, 0xbf80, 0xbf80, 0x3ec43f6d, 0xbf35bf35, 0x3f6d3ec4
.long 0x3f80, 0xbf35bf35, 0x3f800000, 0xbf353f35, 0xbf80, 0x3f6d3ec4, 0xbf353f35, 0xbec4bf6d
.long 0x3f80, 0xbf800000, 0xbf80, 0x3f800000, 0xbf80, 0x3f6dbec4, 0x3f353f35, 0xbec43f6d
.long 0x3f80, 0xbf353f35, 0xbf800000, 0xbf35bf35, 0xbf80, 0x3ec4bf6d, 0x3f35bf35, 0x3f6dbec4
.long 0x3f80, 0x3f80, 0x3f80, 0x3f80, 0xbf800000, 0xbf6d3ec4, 0xbf353f35, 0xbec43f6d
.long 0xbf80, 0xbf35bf35, 0xbf800000, 0xbf353f35, 0x3f800000, 0x3ec4bf6d, 0xbf35bf35, 0xbf6d3ec4
.long 0x3f80, 0x3f800000, 0xbf80, 0xbf800000, 0xbf800000, 0x3ec43f6d, 0x3f35bf35, 0xbf6dbec4
.long 0xbf80, 0xbf353f35, 0x3f800000, 0xbf35bf35, 0x3f800000, 0xbf6dbec4, 0x3f353f35, 0xbec4bf6d
.long 0x3f80, 0xbf80, 0x3f80, 0xbf80, 0xbf800000, 0x3f6dbec4, 0xbf353f35, 0x3ec4bf6d
.long 0xbf80, 0x3f353f35, 0xbf800000, 0x3f35bf35, 0x3f800000, 0xbec43f6d, 0xbf35bf35, 0x3f6dbec4
.long 0x3f80, 0xbf800000, 0xbf80, 0x3f800000, 0xbf800000, 0xbec4bf6d, 0x3f35bf35, 0x3f6d3ec4
.long 0xbf80, 0x3f35bf35, 0x3f800000, 0x3f353f35, 0x3f800000, 0x3f6d3ec4, 0x3f353f35, 0x3ec43f6d
.long 0x3f80, 0x3f80, 0x3f80, 0x3f80, 0x3f80, 0x3ec43f6d, 0x3f353f35, 0x3f6d3ec4
.long 0x3f80, 0x3f353f35, 0x3f800000, 0x3f35bf35, 0x3f80, 0x3f6d3ec4, 0x3f35bf35, 0xbec4bf6d
.long 0x3f80, 0x3f800000, 0xbf80, 0xbf800000, 0x3f80, 0x3f6dbec4, 0xbf35bf35, 0xbec43f6d
.long 0x3f80, 0x3f35bf35, 0xbf800000, 0x3f353f35, 0x3f80, 0x3ec4bf6d, 0xbf353f35, 0x3f6dbec4
.long 0x3f80, 0xbf80, 0x3f80, 0xbf80, 0x3f80, 0xbec4bf6d, 0x3f353f35, 0xbf6dbec4
.long 0x3f80, 0xbf35bf35, 0x3f800000, 0xbf353f35, 0x3f80, 0xbf6dbec4, 0x3f35bf35, 0x3ec43f6d
.long 0x3f80, 0xbf800000, 0xbf80, 0x3f800000, 0x3f80, 0xbf6d3ec4, 0xbf35bf35, 0x3ec4bf6d
.long 0x3f80, 0xbf353f35, 0xbf800000, 0xbf35bf35, 0x3f80, 0xbec43f6d, 0xbf353f35, 0xbf6d3ec4
.long 0x3f80, 0x3f80, 0x3f80, 0x3f80, 0x3f800000, 0x3f6dbec4, 0x3f35bf35, 0x3ec4bf6d
.long 0xbf80, 0xbf35bf35, 0xbf800000, 0xbf353f35, 0xbf800000, 0xbec43f6d, 0x3f353f35, 0x3f6dbec4
.long 0x3f80, 0x3f800000, 0xbf80, 0xbf800000, 0x3f800000, 0xbec4bf6d, 0xbf353f35, 0x3f6d3ec4
.long 0xbf80, 0xbf353f35, 0x3f800000, 0xbf35bf35, 0xbf800000, 0x3f6d3ec4, 0xbf35bf35, 0x3ec43f6d
.long 0x3f80, 0xbf80, 0x3f80, 0xbf80, 0x3f800000, 0xbf6d3ec4, 0x3f35bf35, 0xbec43f6d
.long 0xbf80, 0x3f353f35, 0xbf800000, 0x3f35bf35, 0xbf800000, 0x3ec4bf6d, 0x3f353f35, 0xbf6d3ec4
.long 0x3f80, 0xbf800000, 0xbf80, 0x3f800000, 0x3f800000, 0x3ec43f6d, 0xbf353f35, 0xbf6dbec4
.long 0xbf80, 0x3f35bf35, 0x3f800000, 0x3f353f35, 0xbf800000, 0xbf6dbec4, 0xbf35bf35, 0xbec4bf6d
.long 0x3f80, 0x3f80, 0x3f80, 0x3f80, 0xbf80, 0xbec4bf6d, 0xbf35bf35, 0xbf6dbec4
.long 0x3f80, 0x3f353f35, 0x3f800000, 0x3f35bf35, 0xbf80, 0xbf6dbec4, 0xbf353f35, 0x3ec43f6d
.long 0x3f80, 0x3f800000, 0xbf80, 0xbf800000, 0xbf80, 0xbf6d3ec4, 0x3f353f35, 0x3ec4bf6d
.long 0x3f80, 0x3f35bf35, 0xbf800000, 0x3f353f35, 0xbf80, 0xbec43f6d, 0x3f35bf35, 0xbf6d3ec4
.long 0x3f80, 0xbf80, 0x3f80, 0xbf80, 0xbf80, 0x3ec43f6d, 0xbf35bf35, 0x3f6d3ec4
.long 0x3f80, 0xbf35bf35, 0x3f800000, 0xbf353f35, 0xbf80, 0x3f6d3ec4, 0xbf353f35, 0xbec4bf6d
.long 0x3f80, 0xbf800000, 0xbf80, 0x3f800000, 0xbf80, 0x3f6dbec4, 0x3f353f35, 0xbec43f6d
.long 0x3f80, 0xbf353f35, 0xbf800000, 0xbf35bf35, 0xbf80, 0x3ec4bf6d, 0x3f35bf35, 0x3f6dbec4
.long 0x3f80, 0x3f80, 0x3f80, 0x3f80, 0xbf800000, 0xbf6d3ec4, 0xbf353f35, 0xbec43f6d
.long 0xbf80, 0xbf35bf35, 0xbf800000, 0xbf353f35, 0x3f800000, 0x3ec4bf6d, 0xbf35bf35, 0xbf6d3ec4
.long 0x3f80, 0x3f800000, 0xbf80, 0xbf800000, 0xbf800000, 0x3ec43f6d, 0x3f35bf35, 0xbf6dbec4
.long 0xbf80, 0xbf353f35, 0x3f800000, 0xbf35bf35, 0x3f800000, 0xbf6dbec4, 0x3f353f35, 0xbec4bf6d
.long 0x3f80, 0xbf80, 0x3f80, 0xbf80, 0xbf800000, 0x3f6dbec4, 0xbf353f35, 0x3ec4bf6d
.long 0xbf80, 0x3f353f35, 0xbf800000, 0x3f35bf35, 0x3f800000, 0xbec43f6d, 0xbf35bf35, 0x3f6dbec4
.long 0x3f80, 0xbf800000, 0xbf80, 0x3f800000, 0xbf800000, 0xbec4bf6d, 0x3f35bf35, 0x3f6d3ec4
.long 0xbf80, 0x3f35bf35, 0x3f800000, 0x3f353f35, 0x3f800000, 0x3f6d3ec4, 0x3f353f35, 0x3ec43f6d
.long 0x3f80, 0x3f80, 0x3f80, 0x3f80, 0x3e483f7b, 0x3f0e3f55, 0x3f553f0e, 0x3f7b3e48
.long 0x3ec43f6d, 0x3f6d3ec4, 0x3f6dbec4, 0x3ec4bf6d, 0x3f0e3f55, 0x3f7bbe48, 0x3e48bf7b, 0xbf55bf0e
.long 0x3f353f35, 0x3f35bf35, 0xbf35bf35, 0xbf353f35, 0x3f553f0e, 0x3e48bf7b, 0xbf7b3e48, 0x3f0e3f55
.long 0x3f6d3ec4, 0xbec4bf6d, 0xbec43f6d, 0x3f6dbec4, 0x3f7b3e48, 0xbf55bf0e, 0x3f0e3f55, 0xbe48bf7b
.long 0x3f800000, 0xbf800000, 0x3f800000, 0xbf800000, 0x3f7bbe48, 0xbf553f0e, 0x3f0ebf55, 0xbe483f7b
.long 0x3f6dbec4, 0xbec43f6d, 0xbec4bf6d, 0x3f6d3ec4, 0x3f55bf0e, 0x3e483f7b, 0xbf7bbe48, 0x3f0ebf55
.long 0x3f35bf35, 0x3f353f35, 0xbf353f35, 0xbf35bf35, 0x3f0ebf55, 0x3f7b3e48, 0x3e483f7b, 0xbf553f0e
.long 0x3ec4bf6d, 0x3f6dbec4, 0x3f6d3ec4, 0x3ec43f6d, 0x3e48bf7b, 0x3f0ebf55, 0x3f55bf0e, 0x3f7bbe48
.long 0x3f80, 0x3f80, 0x3f80, 0x3f80, 0x3f7bbe48, 0x3f55bf0e, 0x3f0ebf55, 0x3e48bf7b
.long 0xbec4bf6d, 0xbf6dbec4, 0xbf6d3ec4, 0xbec43f6d, 0xbf553f0e, 0x3e483f7b, 0x3f7b3e48, 0x3f0ebf55
.long 0x3f353f35, 0x3f35bf35, 0xbf35bf35, 0xbf353f35, 0x3f0ebf55, 0xbf7bbe48, 0x3e483f7b, 0x3f55bf0e
.long 0xbf6dbec4, 0x3ec43f6d, 0x3ec4bf6d, 0xbf6d3ec4, 0xbe483f7b, 0x3f0ebf55, 0xbf553f0e, 0x3f7bbe48
.long 0x3f800000, 0xbf800000, 0x3f800000, 0xbf800000, 0xbe48bf7b, 0x3f0e3f55, 0xbf55bf0e, 0x3f7b3e48
.long 0xbf6d3ec4, 0x3ec4bf6d, 0x3ec43f6d, 0xbf6dbec4, 0x3f0e3f55, 0xbf7b3e48, 0x3e48bf7b, 0x3f553f0e
.long 0x3f35bf35, 0x3f353f35, 0xbf353f35, 0xbf35bf35, 0xbf55bf0e, 0x3e48bf7b, 0x3f7bbe48, 0x3f0e3f55
.long 0xbec43f6d, 0xbf6d3ec4, 0xbf6dbec4, 0xbec4bf6d, 0x3f7b3e48, 0x3f553f0e, 0x3f0e3f55, 0x3e483f7b
.long 0x3f80, 0x3f80, 0x3f80, 0x3f80, 0xbe48bf7b, 0xbf0ebf55, 0xbf55bf0e, 0xbf7bbe48
.long 0x3ec43f6d, 0x3f6d3ec4, 0x3f6dbec4, 0x3ec4bf6d, 0xbf0ebf55, 0xbf7b3e48, 0xbe483f7b, 0x3f553f0e
.long 0x3f353f35, 0x3f35bf35, 0xbf35bf35, 0xbf353f35, 0xbf55bf0e, 0xbe483f7b, 0x3f7bbe48, 0xbf0ebf55
.long 0x3f6d3ec4, 0xbec4bf6d, 0xbec43f6d, 0x3f6dbec4, 0xbf7bbe48, 0x3f553f0e, 0xbf0ebf55, 0x3e483f7b
.long 0x3f800000, 0xbf800000, 0x3f800000, 0xbf800000, 0xbf7b3e48, 0x3f55bf0e, 0xbf0e3f55, 0x3e48bf7b
.long 0x3f6dbec4, 0xbec43f6d, 0xbec4bf6d, 0x3f6d3ec4, 0xbf553f0e, 0xbe48bf7b, 0x3f7b3e48, 0xbf0e3f55
.long 0x3f35bf35, 0x3f353f35, 0xbf353f35, 0xbf35bf35, 0xbf0e3f55, 0xbf7bbe48, 0xbe48bf7b, 0x3f55bf0e
.long 0x3ec4bf6d, 0x3f6dbec4, 0x3f6d3ec4, 0x3ec43f6d, 0xbe483f7b, 0xbf0e3f55, 0xbf553f0e, 0xbf7b3e48
.long 0x3f80, 0x3f80, 0x3f80, 0x3f80, 0xbf7b3e48, 0xbf553f0e, 0xbf0e3f55, 0xbe483f7b
.long 0xbec4bf6d, 0xbf6dbec4, 0xbf6d3ec4, 0xbec43f6d, 0x3f55bf0e, 0xbe48bf7b, 0xbf7bbe48, 0xbf0e3f55
.long 0x3f353f35, 0x3f35bf35, 0xbf35bf35, 0xbf353f35, 0xbf0e3f55, 0x3f7b3e48, 0xbe48bf7b, 0xbf553f0e
.long 0xbf6dbec4, 0x3ec43f6d, 0x3ec4bf6d, 0xbf6d3ec4, 0x3e48bf7b, 0xbf0e3f55, 0x3f55bf0e, 0xbf7b3e48
.long 0x3f800000, 0xbf800000, 0x3f800000, 0xbf800000, 0x3e483f7b, 0xbf0ebf55, 0x3f553f0e, 0xbf7bbe48
.long 0xbf6d3ec4, 0x3ec4bf6d, 0x3ec43f6d, 0xbf6dbec4, 0xbf0ebf55, 0x3f7bbe48, 0xbe483f7b, 0xbf55bf0e
.long 0x3f35bf35, 0x3f353f35, 0xbf353f35, 0xbf35bf35, 0x3f553f0e, 0xbe483f7b, 0xbf7b3e48, 0xbf0ebf55
.long 0xbec43f6d, 0xbf6d3ec4, 0xbf6dbec4, 0xbec4bf6d, 0xbf7bbe48, 0xbf55bf0e, 0xbf0ebf55, 0xbe48bf7b
.long 0xbf80, 0xbf80, 0xbf80, 0xbf80, 0xbe48bf7b, 0xbf0ebf55, 0xbf55bf0e, 0xbf7bbe48
.long 0xbec4bf6d, 0xbf6dbec4, 0xbf6d3ec4, 0xbec43f6d, 0xbf0ebf55, 0xbf7b3e48, 0xbe483f7b, 0x3f553f0e
.long 0xbf35bf35, 0xbf353f35, 0x3f353f35, 0x3f35bf35, 0xbf55bf0e, 0xbe483f7b, 0x3f7bbe48, 0xbf0ebf55
.long 0xbf6dbec4, 0x3ec43f6d, 0x3ec4bf6d, 0xbf6d3ec4, 0xbf7bbe48, 0x3f553f0e, 0xbf0ebf55, 0x3e483f7b
.long 0xbf800000, 0x3f800000, 0xbf800000, 0x3f800000, 0xbf7b3e48, 0x3f55bf0e, 0xbf0e3f55, 0x3e48bf7b
.long 0xbf6d3ec4, 0x3ec4bf6d, 0x3ec43f6d, 0xbf6dbec4, 0xbf553f0e, 0xbe48bf7b, 0x3f7b3e48, 0xbf0e3f55
.long 0xbf353f35, 0xbf35bf35, 0x3f35bf35, 0x3f353f35, 0xbf0e3f55, 0xbf7bbe48, 0xbe48bf7b, 0x3f55bf0e
.long 0xbec43f6d, 0xbf6d3ec4, 0xbf6dbec4, 0xbec4bf6d, 0xbe483f7b, 0xbf0e3f55, 0xbf553f0e, 0xbf7b3e48
.long 0xbf80, 0xbf80, 0xbf80, 0xbf80, 0xbf7b3e48, 0xbf553f0e, 0xbf0e3f55, 0xbe483f7b
.long 0x3ec43f6d, 0x3f6d3ec4, 0x3f6dbec4, 0x3ec4bf6d, 0x3f55bf0e, 0xbe48bf7b, 0xbf7bbe48, 0xbf0e3f55
.long 0xbf35bf35, 0xbf353f35, 0x3f353f35, 0x3f35bf35, 0xbf0e3f55, 0x3f7b3e48, 0xbe48bf7b, 0xbf553f0e
.long 0x3f6d3ec4, 0xbec4bf6d, 0xbec43f6d, 0x3f6dbec4, 0x3e48bf7b, 0xbf0e3f55, 0x3f55bf0e, 0xbf7b3e48
.long 0xbf800000, 0x3f800000, 0xbf800000, 0x3f800000, 0x3e483f7b, 0xbf0ebf55, 0x3f553f0e, 0xbf7bbe48
.long 0x3f6dbec4, 0xbec43f6d, 0xbec4bf6d, 0x3f6d3ec4, 0xbf0ebf55, 0x3f7bbe48, 0xbe483f7b, 0xbf55bf0e
.long 0xbf353f35, 0xbf35bf35, 0x3f35bf35, 0x3f353f35, 0x3f553f0e, 0xbe483f7b, 0xbf7b3e48, 0xbf0ebf55
.long 0x3ec4bf6d, 0x3f6dbec4, 0x3f6d3ec4, 0x3ec43f6d, 0xbf7bbe48, 0xbf55bf0e, 0xbf0ebf55, 0xbe48bf7b
.long 0xbf80, 0xbf80, 0xbf80, 0xbf80, 0x3e483f7b, 0x3f0e3f55, 0x3f553f0e, 0x3f7b3e48
.long 0xbec4bf6d, 0xbf6dbec4, 0xbf6d3ec4, 0xbec43f6d, 0x3f0e3f55, 0x3f7bbe48, 0x3e48bf7b, 0xbf55bf0e
.long 0xbf35bf35, 0xbf353f35, 0x3f353f35, 0x3f35bf35, 0x3f553f0e, 0x3e48bf7b, 0xbf7b3e48, 0x3f0e3f55
.long 0xbf6dbec4, 0x3ec43f6d, 0x3ec4bf6d, 0xbf6d3ec4, 0x3f7b3e48, 0xbf55bf0e, 0x3f0e3f55, 0xbe48bf7b
.long 0xbf800000, 0x3f800000, 0xbf800000, 0x3f800000, 0x3f7bbe48, 0xbf553f0e, 0x3f0ebf55, 0xbe483f7b
.long 0xbf6d3ec4, 0x3ec4bf6d, 0x3ec43f6d, 0xbf6dbec4, 0x3f55bf0e, 0x3e483f7b, 0xbf7bbe48, 0x3f0ebf55
.long 0xbf353f35, 0xbf35bf35, 0x3f35bf35, 0x3f353f35, 0x3f0ebf55, 0x3f7b3e48, 0x3e483f7b, 0xbf553f0e
.long 0xbec43f6d, 0xbf6d3ec4, 0xbf6dbec4, 0xbec4bf6d, 0x3e48bf7b, 0x3f0ebf55, 0x3f55bf0e, 0x3f7bbe48
.long 0xbf80, 0xbf80, 0xbf80, 0xbf80, 0x3f7bbe48, 0x3f55bf0e, 0x3f0ebf55, 0x3e48bf7b
.long 0x3ec43f6d, 0x3f6d3ec4, 0x3f6dbec4, 0x3ec4bf6d, 0xbf553f0e, 0x3e483f7b, 0x3f7b3e48, 0x3f0ebf55
.long 0xbf35bf35, 0xbf353f35, 0x3f353f35, 0x3f35bf35, 0x3f0ebf55, 0xbf7bbe48, 0x3e483f7b, 0x3f55bf0e
.long 0x3f6d3ec4, 0xbec4bf6d, 0xbec43f6d, 0x3f6dbec4, 0xbe483f7b, 0x3f0ebf55, 0xbf553f0e, 0x3f7bbe48
.long 0xbf800000, 0x3f800000, 0xbf800000, 0x3f800000, 0xbe48bf7b, 0x3f0e3f55, 0xbf55bf0e, 0x3f7b3e48
.long 0x3f6dbec4, 0xbec43f6d, 0xbec4bf6d, 0x3f6d3ec4, 0x3f0e3f55, 0xbf7b3e48, 0x3e48bf7b, 0x3f553f0e
.long 0xbf353f35, 0xbf35bf35, 0x3f35bf35, 0x3f353f35, 0xbf55bf0e, 0x3e48bf7b, 0x3f7bbe48, 0x3f0e3f55
.long 0x3ec4bf6d, 0x3f6dbec4, 0x3f6d3ec4, 0x3ec43f6d, 0x3f7b3e48, 0x3f553f0e, 0x3f0e3f55, 0x3e483f7b
L_tabend:
.size L_tab, L_tabend - L_tab
.section .rodata,"a"
.p2align 6
.amdhsa_kernel gated_mix__spectral_fnet__moe_arch_mod__prompt_kernel
  .amdhsa_next_free_vgpr 256
  .amdhsa_next_free_sgpr 102
  .amdhsa_accum_offset 256
  .amdhsa_group_segment_fixed_size 0
  .amdhsa_kernarg_size 112
  .amdhsa_user_sgpr_count 2
  .amdhsa_user_sgpr_kernarg_segment_ptr 1
  .amdhsa_system_sgpr_workgroup_id_x 1
.end_amdhsa_kernel
```

```asm
; @launch grid=(256,1,1) block=(512,1,1) lds=100352
.amdgcn_target "amdgcn-amd-amdhsa--gfx950"
.text
.globl gated_mix__spectral_fnet__moe_arch_mod__prompt_kernel
.p2align 8
.type gated_mix__spectral_fnet__moe_arch_mod__prompt_kernel,@function
gated_mix__spectral_fnet__moe_arch_mod__prompt_kernel:
    s_cmp_ge_u32 s2, 256
    s_cbranch_scc1 L_end
    s_load_dwordx2 s[4:5], s[0:1], 0
    s_load_dwordx16 s[16:31], s[0:1], 48
    s_getpc_b64 s[10:11]
L_pc:
    v_lshrrev_b32 v1, 6, v0
    s_lshr_b32 s57, s2, 3
    v_lshl_add_u32 v4, v0, 5, s57
    v_lshlrev_b32 v4, 7, v4
    v_cmp_gt_u32 vcc, L_tabend - L_pc, v4
    s_nop 0
    s_and_saveexec_b64 s[12:13], vcc
    s_cbranch_execz L_nocpf
    global_load_dword v249, v4, s[10:11]
L_nocpf:
    s_mov_b64 exec, s[12:13]
    v_and_b32 v0, 63, v0
    v_readfirstlane_b32 s3, v1
    v_and_b32 v2, 15, v0
    v_lshrrev_b32 v3, 4, v0
    v_lshlrev_b32 v247, 4, v0
    v_lshlrev_b32 v246, 3, v0
    s_add_u32 s10, s10, L_tab - L_pc
    s_addc_u32 s11, s11, 0
    s_and_b32 s56, s2, 7
    s_mov_b32 s90, 400000
    s_cmp_lt_u32 s57, 16
    s_cbranch_scc1 L_low
    s_sub_u32 s57, s57, 16
    s_lshl4_add_u32 s9, s56, s57
    s_lshl4_add_u32 s58, s57, s56
    s_sub_u32 s62, s58, 120
    s_cmp_lt_u32 s9, 8
    s_cselect_b32 s62, s58, s62
    s_cmp_lt_u32 s9, 16
    s_cselect_b32 s58, s62, s58
L_a:
    s_cmp_ge_u32 s3, 4
    s_cbranch_scc1 L_p1w
    s_lshl2_add_u32 s60, s57, s3
    s_lshl_b32 s60, s60, 5
    s_add_u32 s60, s60, s56
    s_lshl_b32 s12, s60, 10
    s_cmp_eq_u32 s58, 128
    s_cselect_b32 s12, 0x40000000, s12
    s_add_u32 s13, s12, 8192
    s_add_u32 s14, s12, 16384
    s_add_u32 s15, s12, 24576
    s_waitcnt lgkmcnt(0)
    s_load_dword s59, s[30:31], 0
    s_mov_b32 s32, s4
    s_mov_b32 s33, s5
    s_mov_b32 s34, 0x200000
    s_mov_b32 s35, 0x20000
    s_mov_b32 s36, s30
    s_mov_b32 s37, s31
    s_mov_b32 s38, 0x400000
    s_mov_b32 s39, 0x20000
    buffer_load_dwordx4 v[8:11], v247, s[32:35], s12 offen
    buffer_load_dwordx4 v[12:15], v247, s[32:35], s13 offen
    buffer_load_dwordx4 v[16:19], v247, s[32:35], s14 offen
    buffer_load_dwordx4 v[20:23], v247, s[32:35], s15 offen
    s_mov_b32 s44, s16
    s_mov_b32 s45, s17
    s_mov_b32 s46, 0x400
    s_mov_b32 s47, 0x20000
    buffer_load_dwordx4 v[24:27], v247, s[44:47], 0 offen
    v_and_b32 v36, 1, v3
    v_lshrrev_b32 v108, 1, v3
    v_lshl_add_u32 v36, v36, 1, v108
    v_lshl_add_u32 v36, v36, 3, s60
    v_mov_b32 v108, 43008
    v_mov_b32 v109, 1
    s_mov_b32 s8, 0xfffff800
    s_lshl3_add_u32 s15, s57, s56
    s_lshl_b32 s15, s15, 3
    s_add_u32 s15, s15, 0x40000
    v_lshlrev_b32 v37, 11, v0
    s_xor_b32 s98, s3, 4
    v_lshl_add_u32 v96, v2, 4, s98
    v_lshlrev_b32 v98, 2, v3
    v_cvt_f32_u32 v98, v98
    v_cvt_f32_u32 v96, v96
    v_mul_f32 v96, 0x3b800000, v96
    v_mul_f32 v99, v98, v96
    v_cos_f32 v102, v99
    v_sin_f32 v103, v99
    v_add_f32 v99, v99, v96
    v_cvt_pk_bf16_f32 v112, v102, v103
    v_cvt_pk_bf16_f32 v116, -v103, v102
    v_cos_f32 v102, v99
    v_sin_f32 v103, v99
    v_add_f32 v99, v99, v96
    v_cvt_pk_bf16_f32 v113, v102, v103
    v_cvt_pk_bf16_f32 v117, -v103, v102
    v_cos_f32 v102, v99
    v_sin_f32 v103, v99
    v_add_f32 v99, v99, v96
    v_cvt_pk_bf16_f32 v114, v102, v103
    v_cvt_pk_bf16_f32 v118, -v103, v102
    v_cos_f32 v102, v99
    v_sin_f32 v103, v99
    s_nop 0
    v_cvt_pk_bf16_f32 v115, v102, v103
    v_cvt_pk_bf16_f32 v119, -v103, v102
    v_mov_b32 v96, 0x80000000
    v_mov_b32 v97, 0x8000
    v_xor_b32 v120, v96, v112
    v_xor_b32 v124, v97, v116
    v_xor_b32 v121, v96, v113
    v_xor_b32 v125, v97, v117
    v_xor_b32 v122, v96, v114
    v_xor_b32 v126, v97, v118
    v_xor_b32 v123, v96, v115
    v_xor_b32 v127, v97, v119
    s_sub_u32 s60, 16, s98
    s_cmp_eq_u32 s98, 0
    s_cselect_b32 s60, 8, s60
    v_bfe_u32 v96, v2, 2, 1
    v_xor_b32 v96, v96, v2
    v_lshrrev_b32 v97, 3, v2
    v_mul_u32_u24 v98, 3, v97
    v_xor_b32 v98, v98, v3
    v_lshlrev_b32 v98, 4, v98
    v_lshl_add_u32 v96, v96, 6, v98
    s_lshl_b32 s61, s98, 3
    s_and_b32 s61, s61, 32
    s_lshl_b32 s62, s98, 10
    s_or_b32 s61, s61, s62
    v_xor_b32 v60, s61, v96
    s_lshl_b32 s61, s60, 3
    s_and_b32 s61, s61, 32
    s_lshl_b32 s62, s60, 10
    s_or_b32 s61, s61, s62
    v_xor_b32 v61, s61, v96
    v_lshlrev_b32 v63, 16, v3
    v_lshl_add_u32 v63, v97, 14, v63
    v_and_b32 v96, 7, v2
    v_lshl_add_u32 v63, v96, 4, v63
    s_lshl_b32 s6, s98, 18
    s_lshl_b32 s61, s56, 11
    s_add_u32 s6, s6, s61
    s_lshl_b32 s61, s57, 7
    s_add_u32 s6, s6, s61
    s_add_u32 s6, s6, 0x200000
    s_add_u32 s7, s6, 32768
    v_lshlrev_b32 v4, 5, v2
    v_and_b32 v96, 1, v3
    v_lshl_add_u32 v4, v96, 9, v4
    v_lshrrev_b32 v96, 1, v3
    v_lshl_add_u32 v4, v96, 4, v4
    s_lshl_b32 s60, s3, 8
    s_add_u32 s93, s60, s58
    s_sub_u32 s94, 2048, s93
    s_and_b32 s94, s94, 2047
    s_mov_b32 s48, s24
    s_mov_b32 s49, s25
    s_mov_b32 s50, 0x400
    s_mov_b32 s51, 0x20000
    s_waitcnt vmcnt(1)
    s_barrier
    s_waitcnt vmcnt(0)
    v_dot2_f32_bf16 v32, v8, v24, 0
    v_dot2_f32_bf16 v33, v12, v24, 0
    v_dot2_f32_bf16 v34, v16, v24, 0
    v_dot2_f32_bf16 v35, v20, v24, 0
    v_dot2_f32_bf16 v32, v9, v25, v32
    v_dot2_f32_bf16 v33, v13, v25, v33
    v_dot2_f32_bf16 v34, v17, v25, v34
    v_dot2_f32_bf16 v35, v21, v25, v35
    v_dot2_f32_bf16 v32, v10, v26, v32
    v_dot2_f32_bf16 v33, v14, v26, v33
    v_dot2_f32_bf16 v34, v18, v26, v34
    v_dot2_f32_bf16 v35, v22, v26, v35
    v_dot2_f32_bf16 v32, v11, v27, v32
    v_dot2_f32_bf16 v33, v15, v27, v33
    v_dot2_f32_bf16 v34, v19, v27, v34
    v_dot2_f32_bf16 v35, v23, v27, v35
    s_waitcnt lgkmcnt(0)
    s_add_u32 s59, s59, 0x9e3779b9
    s_bitcmp1_b32 s59, 0
    s_cselect_b32 s91, 1, 0x10000
    s_xor_b32 s92, s91, 0x10001
    v_permlane32_swap_b32 v32, v33
    v_permlane32_swap_b32 v34, v35
    v_add_f32 v32, v32, v33
    v_add_f32 v34, v34, v35
    s_nop 1
    v_permlane16_swap_b32 v32, v34
    v_add_f32 v32, v32, v34
    v_mov_b32 v39, s59
    s_nop 0
    v_add_f32_dpp v32, v32, v32 row_ror:8 row_mask:0xf bank_mask:0xf
    s_nop 1
    v_add_f32_dpp v32, v32, v32 row_ror:4 row_mask:0xf bank_mask:0xf
    s_nop 1
    v_add_f32_dpp v32, v32, v32 row_ror:2 row_mask:0xf bank_mask:0xf
    s_nop 1
    v_add_f32_dpp v32, v32, v32 row_ror:1 row_mask:0xf bank_mask:0xf
    v_ashrrev_i32 v33, 31, v32
    v_or_b32 v33, 0x80000000, v33
    v_xor_b32 v33, v33, v32
    v_and_or_b32 v33, v33, s8, v36
    s_mov_b32 exec_lo, 0x10001
    s_mov_b32 exec_hi, 0x10001
    ds_max_u32 v108, v33
    s_mov_b64 exec, -1
    s_waitcnt lgkmcnt(0)
    s_barrier
    s_cmp_lg_u32 s3, 0
    s_cbranch_scc1 L_b1a
    ds_read_b32 v38, v108
    s_waitcnt lgkmcnt(0)
    s_cmp_eq_u32 s58, 128
    s_cbranch_scc1 L_b1a
    s_mov_b64 exec, 0xffffffff
    buffer_store_dwordx2 v[38:39], v37, s[36:39], s15 offen sc1
    s_mov_b64 exec, -1
L_b1a:
    s_lshl_b32 s63, s3, 1
    s_lshl_b32 s60, s63, 10
    v_lshl_add_u32 v248, v0, 4, s60
    s_add_u32 m0, s60, 32768
    global_load_lds_dwordx4 v248, s[10:11] offset:0
    global_load_lds_dwordx4 v248, s[10:11] offset:1024
    s_and_b32 s63, s3, 1
    s_add_u32 s63, s63, 8
    s_lshl_b32 s60, s63, 10
    v_lshl_add_u32 v248, v0, 4, s60
    s_add_u32 m0, s60, 32768
    global_load_lds_dwordx4 v248, s[10:11] offset:0
    s_lshl_b32 s12, s93, 10
    s_lshl_b32 s13, s94, 10
    buffer_load_dwordx4 v[232:235], v4, s[32:35], s12 offen
    buffer_load_dwordx4 v[236:239], v4, s[32:35], s13 offen
    buffer_load_dwordx4 v[240:243], v4, s[48:51], 0 offen
    v_mov_b32 v104, s91
    v_mov_b32 v105, s92
    v_mov_b32 v106, 0x00010001
    s_branch L_b1
L_p1w:
    s_sub_u32 s96, s3, 4
    s_lshl_b32 s60, s56, 2
    s_mul_i32 s61, s56, 3
    s_add_u32 s61, s61, 4
    s_cmp_lt_u32 s56, 4
    s_cselect_b32 s60, s60, s61
    s_cselect_b32 s61, 16, 12
    s_cmp_ge_u32 s57, s61
    s_cselect_b32 s63, 8, s96
    s_lshr_b32 s61, s57, 2
    s_add_u32 s60, s60, s61
    s_lshl_b32 s6, s60, 7
    s_and_b32 s61, s57, 3
    s_mul_i32 s61, s61, 2
    s_add_u32 s61, s61, s96
    s_lshl_b32 s61, s61, 5
    s_add_u32 s61, s61, 256
    v_lshrrev_b32 v100, 1, v0
    v_add_u32 v100, s61, v100
    v_mul_u32_u24 v100, 3584, v100
    v_and_b32 v101, 1, v0
    v_lshl_add_u32 v100, v101, 6, v100
    s_waitcnt lgkmcnt(0)
    s_mov_b32 s52, s18
    s_mov_b32 s53, s19
    s_mov_b32 s54, 0x1c0000
    s_mov_b32 s55, 0x20000
    s_cmp_ge_u32 s63, 2
    s_cbranch_scc1 L_noapf
    buffer_load_dword v255, v100, s[52:55], s6 offen
L_noapf:
    s_waitcnt lgkmcnt(0)
    s_mov_b32 s32, s4
    s_mov_b32 s33, s5
    s_mov_b32 s34, 0x200000
    s_mov_b32 s35, 0x20000
    s_mov_b32 s36, s30
    s_mov_b32 s37, s31
    s_mov_b32 s38, 0x400000
    s_mov_b32 s39, 0x20000
    s_cmp_lg_u32 s3, 7
    s_cbranch_scc1 L_nomt
    v_mov_b32 v252, s16
    v_mov_b32 v253, s17
    v_writelane_b32 v252, s24, 1
    v_writelane_b32 v253, s25, 1
    v_writelane_b32 v252, s26, 2
    v_writelane_b32 v253, s27, 2
    s_add_u32 s63, s30, 0x3000
    v_writelane_b32 v252, s63, 3
    s_addc_u32 s63, s31, 0
    v_writelane_b32 v253, s63, 3
    s_add_u32 s63, s30, 0x203000
    v_writelane_b32 v252, s63, 4
    s_addc_u32 s63, s31, 0
    v_writelane_b32 v253, s63, 4
    s_mov_b64 exec, 0x1f
    global_load_dword v254, v[252:253], off
    s_mov_b64 exec, -1
L_nomt:
    v_lshlrev_b32 v107, 19, v3
    v_bfe_u32 v108, v0, 2, 2
    v_lshl_add_u32 v107, v108, 13, v107
    v_and_b32 v109, 3, v0
    v_lshl_add_u32 v107, v109, 4, v107
    v_mov_b32 v96, 43008
    v_mov_b32 v98, 0
    v_mov_b32 v99, 0
    ds_write_b64 v96, v[98:99]
    v_lshlrev_b32 v96, 2, v3
    v_cvt_f32_u32 v96, v96
    v_cvt_f32_u32 v97, v2
    v_mul_f32 v97, 0x3d800000, v97
    v_mul_f32 v96, v96, v97
    v_cos_f32 v102, v96
    v_sin_f32 v103, v96
    v_add_f32 v96, v96, v97
    v_cvt_pk_bf16_f32 v40, v102, v103
    v_cvt_pk_bf16_f32 v44, -v103, v102
    v_cos_f32 v102, v96
    v_sin_f32 v103, v96
    v_add_f32 v96, v96, v97
    v_cvt_pk_bf16_f32 v41, v102, v103
    v_cvt_pk_bf16_f32 v45, -v103, v102
    v_cos_f32 v102, v96
    v_sin_f32 v103, v96
    v_add_f32 v96, v96, v97
    v_cvt_pk_bf16_f32 v42, v102, v103
    v_cvt_pk_bf16_f32 v46, -v103, v102
    v_cos_f32 v102, v96
    v_sin_f32 v103, v96
    s_nop 0
    v_cvt_pk_bf16_f32 v43, v102, v103
    v_cvt_pk_bf16_f32 v47, -v103, v102
    v_lshrrev_b32 v96, 1, v109
    v_mul_u32_u24 v96, 3, v96
    v_lshlrev_b32 v97, 1, v3
    v_and_b32 v97, 2, v97
    v_xor_b32 v96, v96, v97
    v_xor_b32 v96, s96, v96
    v_lshl_add_u32 v96, v96, 2, v108
    v_lshlrev_b32 v96, 2, v96
    v_lshl_add_u32 v96, v109, 8, v96
    v_lshl_add_u32 v96, v3, 12, v96
    v_and_b32 v97, 1, v109
    v_lshl_add_u32 v48, v97, 6, v96
    v_xor_b32 v49, 64, v48
    v_add_u32 v50, 128, v48
    v_add_u32 v51, 128, v49
    s_xor_b32 s98, s3, 4
    v_lshl_add_u32 v96, v2, 4, s98
    s_cmp_eq_u32 s98, 0
    s_cselect_b32 s60, 120, 0
    v_subrev_u32 v98, s60, v96
    v_cmp_gt_u32 vcc, 8, v2
    s_nop 1
    v_cndmask_b32 v96, v98, v96, vcc
    v_lshlrev_b32 v98, 2, v3
    v_cvt_f32_u32 v98, v98
    v_cvt_f32_u32 v96, v96
    v_mul_f32 v96, 0x3b800000, v96
    v_mul_f32 v99, v98, v96
    v_cos_f32 v102, v99
    v_sin_f32 v103, v99
    v_add_f32 v99, v99, v96
    v_cvt_pk_bf16_f32 v112, v102, v103
    v_cvt_pk_bf16_f32 v116, -v103, v102
    v_cos_f32 v102, v99
    v_sin_f32 v103, v99
    v_add_f32 v99, v99, v96
    v_cvt_pk_bf16_f32 v113, v102, v103
    v_cvt_pk_bf16_f32 v117, -v103, v102
    v_cos_f32 v102, v99
    v_sin_f32 v103, v99
    v_add_f32 v99, v99, v96
    v_cvt_pk_bf16_f32 v114, v102, v103
    v_cvt_pk_bf16_f32 v118, -v103, v102
    v_cos_f32 v102, v99
    v_sin_f32 v103, v99
    s_nop 0
    v_cvt_pk_bf16_f32 v115, v102, v103
    v_cvt_pk_bf16_f32 v119, -v103, v102
    v_mov_b32 v96, 0x80000000
    v_mov_b32 v97, 0x8000
    v_xor_b32 v120, v96, v112
    v_xor_b32 v124, v97, v116
    v_xor_b32 v121, v96, v113
    v_xor_b32 v125, v97, v117
    v_xor_b32 v122, v96, v114
    v_xor_b32 v126, v97, v118
    v_xor_b32 v123, v96, v115
    v_xor_b32 v127, v97, v119
    s_cmp_lg_u32 s98, 0
    s_cbranch_scc1 L_sp_e
    s_mov_b32 exec_lo, 0x10001
    s_mov_b32 exec_hi, 0x10001
    v_mov_b32 v121, 0xbf80
    v_mov_b32 v125, 0xbf800000
    v_mov_b32 v123, 0xbf80
    v_mov_b32 v127, 0xbf800000
    s_mov_b64 exec, -1
    v_cndmask_b32_e64 v128, v112, 0, vcc
    v_cndmask_b32 v112, 0, v112, vcc
    v_cndmask_b32 v136, 0, v120, vcc
    v_cndmask_b32_e64 v120, v120, 0, vcc
    v_cndmask_b32_e64 v129, v113, 0, vcc
    v_cndmask_b32 v113, 0, v113, vcc
    v_cndmask_b32 v137, 0, v121, vcc
    v_cndmask_b32_e64 v121, v121, 0, vcc
    v_cndmask_b32_e64 v130, v114, 0, vcc
    v_cndmask_b32 v114, 0, v114, vcc
    v_cndmask_b32 v138, 0, v122, vcc
    v_cndmask_b32_e64 v122, v122, 0, vcc
    v_cndmask_b32_e64 v131, v115, 0, vcc
    v_cndmask_b32 v115, 0, v115, vcc
    v_cndmask_b32 v139, 0, v123, vcc
    v_cndmask_b32_e64 v123, v123, 0, vcc
    v_cndmask_b32_e64 v132, v116, 0, vcc
    v_cndmask_b32 v116, 0, v116, vcc
    v_cndmask_b32 v140, 0, v124, vcc
    v_cndmask_b32_e64 v124, v124, 0, vcc
    v_cndmask_b32_e64 v133, v117, 0, vcc
    v_cndmask_b32 v117, 0, v117, vcc
    v_cndmask_b32 v141, 0, v125, vcc
    v_cndmask_b32_e64 v125, v125, 0, vcc
    v_cndmask_b32_e64 v134, v118, 0, vcc
    v_cndmask_b32 v118, 0, v118, vcc
    v_cndmask_b32 v142, 0, v126, vcc
    v_cndmask_b32_e64 v126, v126, 0, vcc
    v_cndmask_b32_e64 v135, v119, 0, vcc
    v_cndmask_b32 v119, 0, v119, vcc
    v_cndmask_b32 v143, 0, v127, vcc
    v_cndmask_b32_e64 v127, v127, 0, vcc
L_sp_e:
    s_sub_u32 s60, 16, s98
    s_cmp_eq_u32 s98, 0
    s_cselect_b32 s60, 8, s60
    v_bfe_u32 v96, v2, 2, 1
    v_xor_b32 v96, v96, v2
    v_lshrrev_b32 v97, 3, v2
    v_mul_u32_u24 v98, 3, v97
    v_xor_b32 v98, v98, v3
    v_lshlrev_b32 v98, 4, v98
    v_lshl_add_u32 v96, v96, 6, v98
    s_lshl_b32 s61, s98, 3
    s_and_b32 s61, s61, 32
    s_lshl_b32 s62, s98, 10
    s_or_b32 s61, s61, s62
    v_xor_b32 v60, s61, v96
    s_lshl_b32 s61, s60, 3
    s_and_b32 s61, s61, 32
    s_lshl_b32 s62, s60, 10
    s_or_b32 s61, s61, s62
    v_xor_b32 v61, s61, v96
    v_lshlrev_b32 v63, 16, v3
    v_lshl_add_u32 v63, v97, 14, v63
    v_and_b32 v96, 7, v2
    v_lshl_add_u32 v63, v96, 4, v63
    s_lshl_b32 s6, s98, 18
    s_lshl_b32 s61, s56, 11
    s_add_u32 s6, s6, s61
    s_lshl_b32 s61, s57, 7
    s_add_u32 s6, s6, s61
    s_add_u32 s6, s6, 0x200000
    s_add_u32 s7, s6, 32768
    v_lshlrev_b32 v4, 5, v2
    v_and_b32 v96, 1, v3
    v_lshl_add_u32 v4, v96, 9, v4
    v_lshrrev_b32 v96, 1, v3
    v_lshl_add_u32 v4, v96, 4, v4
    s_lshl_b32 s60, s3, 8
    s_add_u32 s93, s60, s58
    s_sub_u32 s94, 2048, s93
    s_and_b32 s94, s94, 2047
    s_mov_b32 s48, s24
    s_mov_b32 s49, s25
    s_mov_b32 s50, 0x400
    s_mov_b32 s51, 0x20000
    s_lshl_b32 s12, s96, 15
    s_lshl_b32 s61, s56, 10
    s_add_u32 s12, s12, s61
    s_lshl_b32 s61, s57, 6
    s_add_u32 s12, s12, s61
    s_cmp_eq_u32 s58, 128
    s_cselect_b32 s12, 0x40000000, s12
    s_add_u32 s13, s12, 131072
    s_add_u32 s14, s12, 262144
    s_add_u32 s15, s12, 393216
    s_waitcnt lgkmcnt(0)
    s_barrier
    buffer_load_dwordx4 v[8:11], v107, s[32:35], s12 offen
    buffer_load_dwordx4 v[12:15], v107, s[32:35], s13 offen
    buffer_load_dwordx4 v[16:19], v107, s[32:35], s14 offen
    buffer_load_dwordx4 v[20:23], v107, s[32:35], s15 offen
    s_load_dword s59, s[30:31], 0
    s_lshl_b32 s12, s93, 10
    s_lshl_b32 s13, s94, 10
    buffer_load_dwordx4 v[232:235], v4, s[32:35], s12 offen
    buffer_load_dwordx4 v[236:239], v4, s[32:35], s13 offen
    buffer_load_dwordx4 v[240:243], v4, s[48:51], 0 offen
    s_lshr_b32 s15, s9, 2
    s_add_u32 s15, s15, 32
    s_and_b32 s15, s15, 31
    s_lshl_b32 s15, s15, 11
    s_add_u32 s15, s15, 0x40000
    s_waitcnt lgkmcnt(0)
    s_add_u32 s59, s59, 0x9e3779b9
    s_bitcmp1_b32 s59, 0
    s_cselect_b32 s91, 1, 0x10000
    s_xor_b32 s92, s91, 0x10001
    v_mov_b32 v104, s91
    v_mov_b32 v105, s92
    v_mov_b32 v106, 0x00010001
    v_mov_b32 v184, 0
    v_mov_b32 v185, 0
    v_mov_b32 v186, 0
    v_mov_b32 v187, 0
    s_barrier
    s_waitcnt vmcnt(3)
    v_pk_mov_b32 v[24:25], v[8:9], v[12:13] op_sel:[0,0]
    v_pk_mov_b32 v[26:27], v[16:17], v[20:21] op_sel:[0,0]
    v_pk_mov_b32 v[28:29], v[8:9], v[12:13] op_sel:[1,1]
    v_pk_mov_b32 v[30:31], v[16:17], v[20:21] op_sel:[1,1]
    v_mfma_f32_16x16x32_bf16 v[64:67], v[40:43], v[24:27], 0
    v_mfma_f32_16x16x32_bf16 v[68:71], v[44:47], v[24:27], 0
    v_pk_mov_b32 v[32:33], v[10:11], v[14:15] op_sel:[0,0]
    v_pk_mov_b32 v[34:35], v[18:19], v[22:23] op_sel:[0,0]
    v_mfma_f32_16x16x32_bf16 v[72:75], v[40:43], v[28:31], 0
    v_mfma_f32_16x16x32_bf16 v[76:79], v[44:47], v[28:31], 0
    v_pk_mov_b32 v[36:37], v[10:11], v[14:15] op_sel:[1,1]
    v_pk_mov_b32 v[38:39], v[18:19], v[22:23] op_sel:[1,1]
    v_mfma_f32_16x16x32_bf16 v[80:83], v[40:43], v[32:35], 0
    v_mfma_f32_16x16x32_bf16 v[84:87], v[44:47], v[32:35], 0
    v_mfma_f32_16x16x32_bf16 v[88:91], v[40:43], v[36:39], 0
    v_cvt_pk_bf16_f32 v8, v64, v68
    v_cvt_pk_bf16_f32 v9, v65, v69
    v_mfma_f32_16x16x32_bf16 v[92:95], v[44:47], v[36:39], 0
    ds_write2st64_b32 v48, v8, v9 offset0:0 offset1:4
    v_cvt_pk_bf16_f32 v10, v66, v70
    v_cvt_pk_bf16_f32 v11, v67, v71
    ds_write2st64_b32 v48, v10, v11 offset0:8 offset1:12
    v_cvt_pk_bf16_f32 v12, v72, v76
    v_cvt_pk_bf16_f32 v13, v73, v77
    ds_write2st64_b32 v49, v12, v13 offset0:0 offset1:4
    v_cvt_pk_bf16_f32 v14, v74, v78
    v_cvt_pk_bf16_f32 v15, v75, v79
    ds_write2st64_b32 v49, v14, v15 offset0:8 offset1:12
    v_cvt_pk_bf16_f32 v16, v80, v84
    v_cvt_pk_bf16_f32 v17, v81, v85
    ds_write2st64_b32 v50, v16, v17 offset0:0 offset1:4
    v_cvt_pk_bf16_f32 v18, v82, v86
    v_cvt_pk_bf16_f32 v19, v83, v87
    ds_write2st64_b32 v50, v18, v19 offset0:8 offset1:12
    v_cvt_pk_bf16_f32 v20, v88, v92
    v_cvt_pk_bf16_f32 v21, v89, v93
    ds_write2st64_b32 v51, v20, v21 offset0:0 offset1:4
    v_cvt_pk_bf16_f32 v22, v90, v94
    v_cvt_pk_bf16_f32 v23, v91, v95
    ds_write2st64_b32 v51, v22, v23 offset0:8 offset1:12
    s_waitcnt lgkmcnt(0)
L_b1:
    s_barrier
    s_cmp_eq_u32 s58, 128
    s_cbranch_scc1 L_ack128
    ds_read_b128 v[52:55], v60
    ds_read_b128 v[56:59], v61
    s_mov_b32 vcc_lo, 0x00ff00ff
    s_mov_b32 vcc_hi, 0x00ff00ff
    s_waitcnt lgkmcnt(1)
    v_mfma_f32_16x16x32_bf16 v[64:67], v[112:115], v[52:55], 0
    v_mfma_f32_16x16x32_bf16 v[68:71], v[116:119], v[52:55], 0
    s_waitcnt lgkmcnt(0)
    v_mfma_f32_16x16x32_bf16 v[72:75], v[120:123], v[56:59], 0
    v_mfma_f32_16x16x32_bf16 v[76:79], v[124:127], v[56:59], 0
    s_cmp_lg_u32 s98, 0
    s_cbranch_scc1 L_s2b
    v_mfma_f32_16x16x32_bf16 v[64:67], v[128:131], v[56:59], v[64:67]
    v_mfma_f32_16x16x32_bf16 v[68:71], v[132:135], v[56:59], v[68:71]
    v_mfma_f32_16x16x32_bf16 v[72:75], v[136:139], v[52:55], v[72:75]
    v_mfma_f32_16x16x32_bf16 v[76:79], v[140:143], v[52:55], v[76:79]
L_s2b:
    s_nop 5
    v_cvt_pk_bf16_f32 v96, v64, v68
    v_cvt_pk_bf16_f32 v97, v65, v69
    v_cvt_pk_bf16_f32 v100, v72, v76
    v_cvt_pk_bf16_f32 v101, v73, v77
    v_bitop3_b32 v96, v106, v104, v96 bitop3:0xca
    v_bitop3_b32 v97, v106, v104, v97 bitop3:0xca
    v_bitop3_b32 v100, v106, v105, v100 bitop3:0xca
    v_bitop3_b32 v101, v106, v105, v101 bitop3:0xca
    v_cndmask_b32_dpp v80, v97, v96, vcc row_ror:8 row_mask:0xf bank_mask:0xf
    s_nop 0
    v_cndmask_b32_dpp v81, v101, v100, vcc row_ror:8 row_mask:0xf bank_mask:0xf
    s_not_b64 vcc, vcc
    v_cndmask_b32_dpp v82, v96, v97, vcc row_ror:8 row_mask:0xf bank_mask:0xf
    v_cndmask_b32_dpp v83, v100, v101, vcc row_ror:8 row_mask:0xf bank_mask:0xf
    buffer_store_dwordx4 v[80:83], v63, s[36:39], s6 offen sc1
    v_cvt_pk_bf16_f32 v98, v66, v70
    v_cvt_pk_bf16_f32 v99, v67, v71
    v_cvt_pk_bf16_f32 v102, v74, v78
    v_cvt_pk_bf16_f32 v103, v75, v79
    v_bitop3_b32 v98, v106, v104, v98 bitop3:0xca
    v_bitop3_b32 v99, v106, v104, v99 bitop3:0xca
    v_bitop3_b32 v102, v106, v105, v102 bitop3:0xca
    v_bitop3_b32 v103, v106, v105, v103 bitop3:0xca
    v_cndmask_b32_dpp v86, v98, v99, vcc row_ror:8 row_mask:0xf bank_mask:0xf
    s_nop 0
    v_cndmask_b32_dpp v87, v102, v103, vcc row_ror:8 row_mask:0xf bank_mask:0xf
    s_not_b64 vcc, vcc
    v_cndmask_b32_dpp v84, v99, v98, vcc row_ror:8 row_mask:0xf bank_mask:0xf
    v_cndmask_b32_dpp v85, v103, v102, vcc row_ror:8 row_mask:0xf bank_mask:0xf
    buffer_store_dwordx4 v[84:87], v63, s[36:39], s7 offen sc1
L_nos2:
    v_lshrrev_b32 v96, 1, v2
    v_lshlrev_b32 v96, 8, v96
    v_add_u32 v96, s58, v96
    v_and_b32 v97, 1, v2
    v_lshlrev_b32 v98, 1, v3
    v_mul_u32_u24 v98, v98, v96
    v_cmp_eq_u32 vcc, 0, v97
    v_and_b32 v99, 2047, v98
    v_add_u32 v98, v98, v96
    v_cvt_f32_u32 v99, v99
    v_mul_f32 v99, 0x3a000000, v99
    v_cos_f32 v100, v99
    v_sin_f32 v101, v99
    v_mul_f32 v100, 0.5, v100
    v_mul_f32 v101, 0.5, v101
    v_cndmask_b32_e64 v102, -v101, v100, vcc
    v_cndmask_b32 v103, v100, v101, vcc
    v_cvt_pk_bf16_f32 v144, v102, v103
    v_cvt_pk_bf16_f32 v148, -v103, v102
    v_cndmask_b32 v102, v101, v100, vcc
    v_cndmask_b32_e64 v103, -v100, v101, vcc
    v_cvt_pk_bf16_f32 v145, v102, -v103
    v_cvt_pk_bf16_f32 v149, -v103, -v102
    s_and_b32 s60, s58, 127
    s_cbranch_scc1 L_ac_a10
    v_add_f32 v100, v100, v100
    v_add_f32 v101, v101, v101
    v_cndmask_b32 v102, 0, v100, vcc
    v_sub_f32 v103, v100, v102
    v_cvt_pk_bf16_f32 v100, v102, v103
    v_cndmask_b32 v102, 0, v101, vcc
    v_sub_f32 v103, v101, v102
    v_cvt_pk_bf16_f32 v101, -v102, -v103
    s_cmp_eq_u32 s58, 0
    s_cselect_b32 s60, -1, 0
    s_cselect_b32 s61, 0, -1
    v_and_b32 v144, s60, v100
    v_and_b32 v148, s60, v101
    v_and_b32 v145, s61, v100
    v_and_b32 v149, s61, v101
L_ac_a10:
    v_and_b32 v99, 2047, v98
    v_cvt_f32_u32 v99, v99
    v_mul_f32 v99, 0x3a000000, v99
    v_cos_f32 v100, v99
    v_sin_f32 v101, v99
    v_mul_f32 v100, 0.5, v100
    v_mul_f32 v101, 0.5, v101
    v_cndmask_b32_e64 v102, -v101, v100, vcc
    v_cndmask_b32 v103, v100, v101, vcc
    v_cvt_pk_bf16_f32 v146, v102, v103
    v_cvt_pk_bf16_f32 v150, -v103, v102
    v_cndmask_b32 v102, v101, v100, vcc
    v_cndmask_b32_e64 v103, -v100, v101, vcc
    v_cvt_pk_bf16_f32 v147, v102, -v103
    v_cvt_pk_bf16_f32 v151, -v103, -v102
    s_and_b32 s60, s58, 127
    s_cbranch_scc1 L_ac_a11
    v_add_f32 v100, v100, v100
    v_add_f32 v101, v101, v101
    v_cndmask_b32 v102, 0, v100, vcc
    v_sub_f32 v103, v100, v102
    v_cvt_pk_bf16_f32 v100, v102, v103
    v_cndmask_b32 v102, 0, v101, vcc
    v_sub_f32 v103, v101, v102
    v_cvt_pk_bf16_f32 v101, -v102, -v103
    s_cmp_eq_u32 s58, 0
    s_cselect_b32 s60, -1, 0
    s_cselect_b32 s61, 0, -1
    v_and_b32 v146, s60, v100
    v_and_b32 v150, s60, v101
    v_and_b32 v147, s61, v100
    v_and_b32 v151, s61, v101
L_ac_a11:
    v_lshlrev_b32 v5, 12, v3
    v_lshl_add_u32 v5, v2, 4, v5
    v_lshrrev_b32 v96, 2, v2
    v_xor_b32 v96, v96, v3
    v_and_b32 v96, 1, v96
    v_bfe_u32 v97, v2, 1, 1
    v_lshl_or_b32 v96, v96, 1, v97
    s_lshr_b32 s60, s3, 1
    v_xor_b32 v96, s60, v96
    v_lshlrev_b32 v96, 4, v96
    v_and_b32 v98, 7, v2
    v_lshl_add_u32 v96, v98, 6, v96
    v_lshl_add_u32 v96, v3, 12, v96
    v_lshrrev_b32 v98, 3, v2
    v_lshl_add_u32 v96, v98, 2, v96
    s_and_b32 s60, s3, 1
    s_lshl_b32 s60, s60, 3
    s_add_u32 s60, s60, 16384
    v_add_u32 v6, s60, v96
    v_xor_b32 v7, 48, v6
    v_bfe_u32 v96, v2, 2, 1
    v_xor_b32 v96, v96, v98
    v_lshl_or_b32 v96, v96, 1, v98
    v_xor_b32 v96, v96, v97
    v_xor_b32 v96, v96, v3
    v_lshlrev_b32 v96, 4, v96
    v_lshl_add_u32 v62, v2, 6, v96
    s_lshl_b32 s60, s3, 4
    s_and_b32 s60, s60, 32
    v_xor_b32 v62, s60, v62
    s_lshl_b32 s60, s3, 11
    s_add_u32 s60, s60, 16384
    v_add_u32 v62, s60, v62
    s_lshl_b32 s14, s9, 14
    s_lshl_b32 s60, s3, 8
    s_add_u32 s14, s14, s60
    s_add_u32 s14, s14, 0x200000
    s_mov_b32 s40, s26
    s_mov_b32 s41, s27
    s_mov_b32 s42, 0x200000
    s_mov_b32 s43, 0x20000
    s_waitcnt vmcnt(2)
    s_cmp_lg_u32 s58, 128
    s_cbranch_scc1 L_a7
    s_waitcnt vmcnt(0)
L_a7:
    v_dot2_f32_bf16 v110, v232, v240, 0
    v_dot2_f32_bf16 v111, v236, v240, 0
    v_dot2_f32_bf16 v110, v233, v241, v110
    v_dot2_f32_bf16 v111, v237, v241, v111
    v_dot2_f32_bf16 v110, v234, v242, v110
    v_dot2_f32_bf16 v111, v238, v242, v111
    v_dot2_f32_bf16 v110, v235, v243, v110
    v_dot2_f32_bf16 v111, v239, v243, v111
    v_permlane16_swap_b32 v232, v234
    v_permlane16_swap_b32 v233, v235
    v_permlane16_swap_b32 v236, v238
    v_permlane16_swap_b32 v237, v239
    v_permlane32_swap_b32 v110, v111
    v_add_f32 v110, v110, v111
    v_mov_b32 v111, v110
    s_nop 1
    v_permlane16_swap_b32 v110, v111
    v_add_f32 v110, v110, v111
    s_nop 1
    v_add_f32_dpp v110, v110, v110 row_ror:8 row_mask:0xf bank_mask:0xf
    v_lshlrev_b32 v216, 16, v232
    v_and_b32 v217, 0xffff0000, v232
    v_add_f32_dpp v110, v110, v110 row_ror:4 row_mask:0xf bank_mask:0xf
    v_lshlrev_b32 v218, 16, v233
    v_and_b32 v219, 0xffff0000, v233
    v_add_f32_dpp v110, v110, v110 row_ror:2 row_mask:0xf bank_mask:0xf
    v_lshlrev_b32 v220, 16, v234
    v_and_b32 v221, 0xffff0000, v234
    v_add_f32_dpp v110, v110, v110 row_ror:1 row_mask:0xf bank_mask:0xf
    v_lshlrev_b32 v222, 16, v235
    v_and_b32 v223, 0xffff0000, v235
    v_mul_f32 v110, 0xbfb8aa3b, v110
    v_lshlrev_b32 v224, 16, v236
    v_and_b32 v225, 0xffff0000, v236
    v_exp_f32 v110, v110
    v_lshlrev_b32 v226, 16, v237
    v_and_b32 v227, 0xffff0000, v237
    v_add_f32 v110, 1.0, v110
    v_lshlrev_b32 v228, 16, v238
    v_and_b32 v229, 0xffff0000, v238
    v_rcp_f32 v110, v110
    v_lshlrev_b32 v230, 16, v239
    v_and_b32 v231, 0xffff0000, v239
    v_mov_b32 v111, v110
    s_nop 1
    v_permlane32_swap_b32 v110, v111
    v_sub_f32 v96, 1.0, v110
    v_sub_f32 v97, 1.0, v111
    v_pk_mul_f32 v[216:217], v[216:217], v[96:97] op_sel:[0,0] op_sel_hi:[1,0]
    v_pk_mul_f32 v[218:219], v[218:219], v[96:97] op_sel:[0,0] op_sel_hi:[1,0]
    v_pk_mul_f32 v[220:221], v[220:221], v[96:97] op_sel:[0,0] op_sel_hi:[1,0]
    v_pk_mul_f32 v[222:223], v[222:223], v[96:97] op_sel:[0,0] op_sel_hi:[1,0]
    v_pk_mul_f32 v[224:225], v[224:225], v[96:97] op_sel:[0,1] op_sel_hi:[1,1]
    v_pk_mul_f32 v[226:227], v[226:227], v[96:97] op_sel:[0,1] op_sel_hi:[1,1]
    v_pk_mul_f32 v[228:229], v[228:229], v[96:97] op_sel:[0,1] op_sel_hi:[1,1]
    v_pk_mul_f32 v[230:231], v[230:231], v[96:97] op_sel:[0,1] op_sel_hi:[1,1]
    v_mov_b32 v109, 43016
    s_cmp_lg_u32 s3, 7
    s_cbranch_scc1 L_a5
    s_waitcnt vmcnt(0)
L_kd:
    buffer_load_dwordx4 v[128:131], v247, s[36:39], s15 offen sc1
    s_waitcnt vmcnt(0)
    v_xor_b32 v129, s59, v129
    v_bitop3_b32 v129, v131, s59, v129 bitop3:0xbe
    v_cmp_ne_u32 vcc, 0, v129
    v_max_u32 v128, v128, v130
    s_nop 0
    s_cbranch_vccz L_kd_ok
    s_sleep 2
    s_sub_u32 s90, s90, 1
    s_cbranch_scc0 L_kd
    s_mov_b32 s90, 0
L_kd_ok:
    v_max_u32_dpp v128, v128, v128 row_ror:8 row_mask:0xf bank_mask:0xf
    s_nop 1
    v_max_u32_dpp v128, v128, v128 row_ror:4 row_mask:0xf bank_mask:0xf
    s_nop 1
    v_max_u32_dpp v128, v128, v128 row_ror:2 row_mask:0xf bank_mask:0xf
    s_nop 1
    v_max_u32_dpp v128, v128, v128 row_ror:1 row_mask:0xf bank_mask:0xf
    s_nop 0
    v_readlane_b32 s97, v128, 0
    v_readlane_b32 s60, v128, 16
    v_readlane_b32 s61, v128, 32
    v_readlane_b32 s62, v128, 48
    s_max_u32 s97, s97, s60
    s_max_u32 s61, s61, s62
    s_max_u32 s97, s97, s61
    s_and_b32 s97, s97, 2047
    v_mov_b32 v108, s97
    ds_write_b32 v109, v108
    s_waitcnt lgkmcnt(0)
L_a5:
    s_barrier
    buffer_load_dwordx4 v[8:11], v5, s[36:39], s14 offen offset:0 sc1
    buffer_load_dwordx4 v[12:15], v5, s[36:39], s14 offen offset:2048 sc1
    ds_read_b32 v109, v109
    ds_read_b128 v[200:203], v247 offset:34816
    ds_read_b128 v[204:207], v247 offset:35840
    ds_read_b128 v[208:211], v247 offset:36864
    ds_read_b128 v[212:215], v247 offset:37888
    ds_read_b128 v[152:155], v247 offset:32768
    ds_read_b128 v[156:159], v247 offset:33792
    ds_read_b128 v[168:171], v247 offset:38912
    ds_read_b128 v[172:175], v247 offset:39936
    ds_read_b128 v[176:179], v247 offset:40960
    ds_read_b128 v[180:183], v247 offset:41984
    s_waitcnt lgkmcnt(0)
    v_readfirstlane_b32 s97, v109
    v_pk_mul_f32 v[184:185], v[200:201], v[110:111] op_sel:[0,0] op_sel_hi:[1,0]
    v_pk_mul_f32 v[186:187], v[202:203], v[110:111] op_sel:[0,0] op_sel_hi:[1,0]
    v_pk_mul_f32 v[188:189], v[204:205], v[110:111] op_sel:[0,0] op_sel_hi:[1,0]
    v_pk_mul_f32 v[190:191], v[206:207], v[110:111] op_sel:[0,0] op_sel_hi:[1,0]
    v_pk_mul_f32 v[192:193], v[208:209], v[110:111] op_sel:[0,0] op_sel_hi:[1,0]
    v_pk_mul_f32 v[194:195], v[210:211], v[110:111] op_sel:[0,0] op_sel_hi:[1,0]
    v_pk_mul_f32 v[196:197], v[212:213], v[110:111] op_sel:[0,0] op_sel_hi:[1,0]
    v_pk_mul_f32 v[198:199], v[214:215], v[110:111] op_sel:[0,0] op_sel_hi:[1,0]
    v_pk_mul_f32 v[200:201], v[200:201], v[110:111] op_sel:[0,1] op_sel_hi:[1,1]
    v_pk_mul_f32 v[202:203], v[202:203], v[110:111] op_sel:[0,1] op_sel_hi:[1,1]
    v_pk_mul_f32 v[204:205], v[204:205], v[110:111] op_sel:[0,1] op_sel_hi:[1,1]
    v_pk_mul_f32 v[206:207], v[206:207], v[110:111] op_sel:[0,1] op_sel_hi:[1,1]
    v_pk_mul_f32 v[208:209], v[208:209], v[110:111] op_sel:[0,1] op_sel_hi:[1,1]
    v_pk_mul_f32 v[210:211], v[210:211], v[110:111] op_sel:[0,1] op_sel_hi:[1,1]
    v_pk_mul_f32 v[212:213], v[212:213], v[110:111] op_sel:[0,1] op_sel_hi:[1,1]
    v_pk_mul_f32 v[214:215], v[214:215], v[110:111] op_sel:[0,1] op_sel_hi:[1,1]
    v_mov_b32 v96, 0x80000000
    v_xor_b32 v160, v96, v152
    v_xor_b32 v164, v96, v156
    v_xor_b32 v161, v96, v153
    v_xor_b32 v165, v96, v157
    v_xor_b32 v162, v96, v154
    v_xor_b32 v166, v96, v158
    v_xor_b32 v163, v96, v155
    v_xor_b32 v167, v96, v159
    s_branch L_a_pw
L_a_pl:
    buffer_load_dwordx4 v[8:11], v5, s[36:39], s14 offen offset:0 sc1
    buffer_load_dwordx4 v[12:15], v5, s[36:39], s14 offen offset:2048 sc1
L_a_pw:
    s_waitcnt vmcnt(0)
    v_swap_b32 v10, v12
    v_swap_b32 v11, v13
    v_xor_b32 v96, v104, v8
    v_xor_b32 v97, v105, v9
    v_mfma_f32_16x16x32_bf16 v[64:67], v[144:147], v[8:11], 0
    v_bitop3_b32 v96, v10, v104, v96 bitop3:0xbe
    v_bitop3_b32 v97, v11, v105, v97 bitop3:0xbe
    v_mfma_f32_16x16x32_bf16 v[68:71], v[148:151], v[8:11], 0
    v_bitop3_b32 v96, v12, v104, v96 bitop3:0xbe
    v_bitop3_b32 v97, v13, v105, v97 bitop3:0xbe
    v_mfma_f32_16x16x32_bf16 v[72:75], v[144:147], v[12:15], 0
    v_bitop3_b32 v96, v14, v104, v96 bitop3:0xbe
    v_bitop3_b32 v97, v15, v105, v97 bitop3:0xbe
    v_mfma_f32_16x16x32_bf16 v[76:79], v[148:151], v[12:15], 0
    v_bitop3_b32 v96, v96, v97, v106 bitop3:0xa8
    v_cmp_ne_u32 vcc, 0, v96
    s_nop 0
    s_cbranch_vccz L_a_pl_ok
    s_sleep 1
    s_sub_u32 s90, s90, 1
    s_cbranch_scc0 L_a_pl
    s_mov_b32 s90, 0
L_a_pl_ok:
    v_cvt_pk_bf16_f32 v16, v64, v68
    v_cvt_pk_bf16_f32 v17, v65, v69
    ds_write2st64_b32 v6, v16, v17 offset0:0 offset1:4
    v_cvt_pk_bf16_f32 v18, v66, v70
    v_cvt_pk_bf16_f32 v19, v67, v71
    ds_write2st64_b32 v6, v18, v19 offset0:8 offset1:12
    v_cvt_pk_bf16_f32 v20, v72, v76
    v_cvt_pk_bf16_f32 v21, v73, v77
    ds_write2st64_b32 v7, v20, v21 offset0:2 offset1:6
    v_cvt_pk_bf16_f32 v22, v74, v78
    v_cvt_pk_bf16_f32 v23, v75, v79
    ds_write2st64_b32 v7, v22, v23 offset0:10 offset1:14
    s_waitcnt lgkmcnt(0)
    s_barrier
    ds_read_b128 v[16:19], v62 offset:0
    ds_read_b128 v[20:23], v62 offset:1024
    s_waitcnt lgkmcnt(1)
    v_mfma_f32_16x16x32_bf16 v[64:67], v[16:19], v[152:155], 0
    v_mfma_f32_16x16x32_bf16 v[68:71], v[16:19], v[156:159], 0
    s_waitcnt lgkmcnt(0)
    v_mfma_f32_16x16x32_bf16 v[72:75], v[20:23], v[152:155], 0
    v_mfma_f32_16x16x32_bf16 v[76:79], v[20:23], v[156:159], 0
    v_mfma_f32_16x16x32_bf16 v[80:83], v[16:19], v[160:163], 0
    s_nop 2
    v_pk_mul_f32 v[96:97], v[64:65], v[184:185]
    v_pk_mul_f32 v[100:101], v[68:69], v[184:185]
    v_mfma_f32_16x16x32_bf16 v[84:87], v[16:19], v[164:167], 0
    v_pk_mul_f32 v[98:99], v[66:67], v[186:187]
    v_pk_mul_f32 v[102:103], v[70:71], v[186:187]
    v_pk_fma_f32 v[96:97], v[68:69], v[188:189], v[96:97]
    v_pk_fma_f32 v[100:101], v[64:65], v[188:189], v[100:101] neg_lo:[1,0,0] neg_hi:[1,0,0]
    v_mfma_f32_16x16x32_bf16 v[88:91], v[20:23], v[160:163], 0
    v_pk_fma_f32 v[98:99], v[70:71], v[190:191], v[98:99]
    v_pk_fma_f32 v[102:103], v[66:67], v[190:191], v[102:103] neg_lo:[1,0,0] neg_hi:[1,0,0]
    v_cvt_pk_bf16_f32 v112, v96, v100
    v_cvt_pk_bf16_f32 v113, v97, v101
    v_mfma_f32_16x16x32_bf16 v[92:95], v[20:23], v[164:167], 0
    v_cvt_pk_bf16_f32 v114, v98, v102
    v_cvt_pk_bf16_f32 v115, v99, v103
    v_pk_mul_f32 v[96:97], v[72:73], v[192:193]
    v_pk_mul_f32 v[100:101], v[76:77], v[192:193]
    v_mfma_f32_16x16x32_bf16 v[232:235], v[112:115], v[168:171], v[216:219]
    v_pk_mul_f32 v[98:99], v[74:75], v[194:195]
    v_pk_mul_f32 v[102:103], v[78:79], v[194:195]
    v_pk_fma_f32 v[96:97], v[76:77], v[196:197], v[96:97]
    v_pk_fma_f32 v[100:101], v[72:73], v[196:197], v[100:101] neg_lo:[1,0,0] neg_hi:[1,0,0]
    v_mfma_f32_16x16x32_bf16 v[236:239], v[112:115], v[172:175], v[220:223]
    v_pk_fma_f32 v[98:99], v[78:79], v[198:199], v[98:99]
    v_pk_fma_f32 v[102:103], v[74:75], v[198:199], v[102:103] neg_lo:[1,0,0] neg_hi:[1,0,0]
    v_cvt_pk_bf16_f32 v116, v96, v100
    v_cvt_pk_bf16_f32 v117, v97, v101
    v_cvt_pk_bf16_f32 v118, v98, v102
    v_cvt_pk_bf16_f32 v119, v99, v103
    v_pk_mul_f32 v[96:97], v[80:81], v[200:201]
    v_pk_mul_f32 v[100:101], v[84:85], v[200:201]
    v_mfma_f32_16x16x32_bf16 v[232:235], v[116:119], v[176:179], v[232:235]
    v_pk_mul_f32 v[98:99], v[82:83], v[202:203]
    v_pk_mul_f32 v[102:103], v[86:87], v[202:203]
    v_pk_fma_f32 v[96:97], v[84:85], v[204:205], v[96:97]
    v_pk_fma_f32 v[100:101], v[80:81], v[204:205], v[100:101] neg_lo:[1,0,0] neg_hi:[1,0,0]
    v_mfma_f32_16x16x32_bf16 v[236:239], v[116:119], v[180:183], v[236:239]
    v_pk_fma_f32 v[98:99], v[86:87], v[206:207], v[98:99]
    v_pk_fma_f32 v[102:103], v[82:83], v[206:207], v[102:103] neg_lo:[1,0,0] neg_hi:[1,0,0]
    v_cvt_pk_bf16_f32 v120, v96, v100
    v_cvt_pk_bf16_f32 v121, v97, v101
    v_cvt_pk_bf16_f32 v122, v98, v102
    v_cvt_pk_bf16_f32 v123, v99, v103
    v_pk_mul_f32 v[96:97], v[88:89], v[208:209]
    v_pk_mul_f32 v[100:101], v[92:93], v[208:209]
    v_mfma_f32_16x16x32_bf16 v[240:243], v[120:123], v[168:171], v[224:227]
    v_pk_mul_f32 v[98:99], v[90:91], v[210:211]
    v_pk_mul_f32 v[102:103], v[94:95], v[210:211]
    v_pk_fma_f32 v[96:97], v[92:93], v[212:213], v[96:97]
    v_pk_fma_f32 v[100:101], v[88:89], v[212:213], v[100:101] neg_lo:[1,0,0] neg_hi:[1,0,0]
    v_mfma_f32_16x16x32_bf16 v[244:247], v[120:123], v[172:175], v[228:231]
    v_pk_fma_f32 v[98:99], v[94:95], v[214:215], v[98:99]
    v_pk_fma_f32 v[102:103], v[90:91], v[214:215], v[102:103] neg_lo:[1,0,0] neg_hi:[1,0,0]
    v_cvt_pk_bf16_f32 v124, v96, v100
    v_cvt_pk_bf16_f32 v125, v97, v101
    v_cvt_pk_bf16_f32 v126, v98, v102
    v_cvt_pk_bf16_f32 v127, v99, v103
    v_cvt_pk_bf16_f32 v8, v232, v233
    v_cvt_pk_bf16_f32 v9, v234, v235
    v_mfma_f32_16x16x32_bf16 v[240:243], v[124:127], v[176:179], v[240:243]
    v_cvt_pk_bf16_f32 v10, v236, v237
    v_cvt_pk_bf16_f32 v11, v238, v239
    v_mfma_f32_16x16x32_bf16 v[244:247], v[124:127], v[180:183], v[244:247]
    v_permlane16_swap_b32 v8, v10
    v_permlane16_swap_b32 v9, v11
    s_cmp_eq_u32 s93, s97
    s_nop 0
    s_cbranch_scc1 L_sk1
    buffer_store_dwordx4 v[8:11], v4, s[40:43], s12 offen sc1
L_sk1:
    v_cvt_pk_bf16_f32 v12, v240, v241
    v_cvt_pk_bf16_f32 v13, v242, v243
    s_nop 0
    v_cvt_pk_bf16_f32 v14, v244, v245
    v_cvt_pk_bf16_f32 v15, v246, v247
    s_nop 0
    v_permlane16_swap_b32 v12, v14
    v_permlane16_swap_b32 v13, v15
    s_cmp_eq_u32 s94, s97
    s_cbranch_scc1 L_sk2
    s_and_b32 s60, s58, 127
    s_cbranch_scc0 L_sk2
    buffer_store_dwordx4 v[12:15], v4, s[40:43], s13 offen sc1
L_sk2:
    s_endpgm
L_ack128:
    s_mov_b64 exec, 1
    v_mov_b32 v96, 0x1000
    v_mov_b32 v97, s59
    buffer_store_dword v97, v96, s[36:39], 0 offen sc1
    s_mov_b64 exec, -1
    s_branch L_nos2
L_low:
    s_lshl_b32 s60, s56, 3
    s_mul_i32 s62, s56, 6
    s_add_u32 s62, s62, 8
    s_cmp_lt_u32 s56, 4
    s_cselect_b32 s60, s60, s62
    s_cselect_b32 s61, 8, 6
    s_and_b32 s62, s57, 7
    s_add_u32 s58, s60, s62
    s_cmp_ge_u32 s62, s61
    s_cbranch_scc1 L_misc
    s_cmp_lt_u32 s57, 8
    s_cbranch_scc1 L_f
    v_lshrrev_b32 v4, 1, v0
    v_and_b32 v5, 1, v0
    v_lshlrev_b32 v5, 6, v5
    s_lshl_b32 s61, s3, 5
    v_add_u32 v4, s61, v4
    v_mul_u32_u24 v4, 3584, v4
    v_add_u32 v4, v4, v5
    s_lshr_b32 s60, s58, 1
    s_lshl_b32 s60, s60, 7
    s_bitcmp1_b32 s58, 0
    s_cselect_b32 s61, 917504, 0
    s_cselect_b32 s62, 458752, 0
    s_add_u32 s61, s61, s60
    s_add_u32 s62, s62, s60
    s_waitcnt lgkmcnt(0)
    s_mov_b32 s44, s18
    s_mov_b32 s45, s19
    s_mov_b32 s46, 0x1c0000
    s_mov_b32 s47, 0x20000
    s_mov_b32 s48, s20
    s_mov_b32 s49, s21
    s_mov_b32 s50, 0x1c0000
    s_mov_b32 s51, 0x20000
    buffer_load_dword v8, v4, s[48:51], s61 offen
    s_barrier
    s_cmp_ge_u32 s3, 4
    s_cbranch_scc1 L_end
    buffer_load_dword v10, v4, s[44:47], s62 offen
    s_endpgm
L_misc:
    s_cmp_eq_u32 s57, 7
    s_cbranch_scc1 L_fin
    s_cmp_eq_u32 s57, 14
    s_cbranch_scc1 L_fin
    s_cmp_eq_u32 s57, 15
    s_cbranch_scc1 L_w
    s_cmp_lg_u32 s56, 4
    s_cbranch_scc1 L_end
    s_mov_b32 s58, 128
    s_mov_b32 s9, 0
    s_mov_b32 s57, 15
    s_branch L_a
L_w:
    s_endpgm
    s_and_b32 s60, s56, 3
    s_lshl3_add_u32 s60, s60, s3
    s_lshl_b32 s61, s60, 12
    s_add_u32 s61, s61, 0x40000
    v_lshlrev_b32 v4, 6, v2
    v_lshl_add_u32 v4, v3, 11, v4
    v_lshlrev_b32 v6, 6, v0
    v_mov_b32 v5, 0
    s_waitcnt lgkmcnt(0)
    s_mov_b32 s36, s30
    s_mov_b32 s37, s31
    s_mov_b32 s38, 0x400000
    s_mov_b32 s39, 0x20000
    s_mov_b32 exec_hi, 0
    buffer_atomic_or v5, v4, s[36:39], s61 offen sc1
    s_cmp_lg_u32 s60, 0
    s_cbranch_scc1 L_end
    s_movk_i32 s61, 0x2000
    buffer_atomic_or v5, v6, s[36:39], s61 offen sc1
    s_endpgm
L_f:
    s_lshr_b32 s95, s58, 1
    s_xor_b32 s98, s3, 7
    v_lshrrev_b32 v8, 3, v0
    v_and_b32 v9, 2, v8
    v_and_b32 v10, 7, v0
    v_xor_b32 v9, v9, v10
    v_lshlrev_b32 v9, 4, v9
    v_lshl_add_u32 v5, v8, 10, v9
    v_xor_b32 v6, 64, v5
    s_lshl_b32 s13, s58, 15
    s_lshl_b32 s61, s3, 7
    s_add_u32 s13, s13, s61
    s_lshl_b32 s6, s3, 12
    s_add_u32 s6, s6, 65536
    s_waitcnt lgkmcnt(0)
    s_load_dword s59, s[30:31], 0
    s_mov_b32 s32, s4
    s_mov_b32 s33, s5
    s_mov_b32 s34, 0x200000
    s_mov_b32 s35, 0x20000
    s_mov_b32 s36, s30
    s_mov_b32 s37, s31
    s_mov_b32 s38, 0x400000
    s_mov_b32 s39, 0x20000
    s_mov_b32 s52, s22
    s_mov_b32 s53, s23
    s_mov_b32 s54, 0x1c0000
    s_mov_b32 s55, 0x20000
    s_waitcnt lgkmcnt(0)
    s_add_u32 s59, s59, 0x9e3779b9
    s_bitcmp1_b32 s59, 0
    s_cselect_b32 s91, 1, 0x10000
    s_xor_b32 s92, s91, 0x10001
    s_add_u32 m0, s6, 0
    s_nop 0
    buffer_load_dwordx4 v5, s[52:55], s13 offen lds
    s_add_u32 s13, s13, 8192
    s_add_u32 m0, s6, 1024
    s_nop 0
    buffer_load_dwordx4 v6, s[52:55], s13 offen lds
    s_add_u32 s13, s13, 8192
    s_add_u32 m0, s6, 2048
    s_nop 0
    buffer_load_dwordx4 v5, s[52:55], s13 offen lds
    s_add_u32 s13, s13, 8192
    s_add_u32 m0, s6, 3072
    s_nop 0
    buffer_load_dwordx4 v6, s[52:55], s13 offen lds
    s_cmp_lt_u32 s98, 4
    s_cselect_b32 s44, s18, s20
    s_cselect_b32 s45, s19, s21
    s_mov_b32 s46, 0x1c0000
    s_mov_b32 s47, 0x20000
    v_lshrrev_b32 v8, 2, v0
    v_mul_u32_u24 v4, 3584, v8
    v_lshrrev_b32 v8, 2, v8
    v_and_b32 v8, 2, v8
    v_and_b32 v9, 3, v0
    v_xor_b32 v8, v8, v9
    v_lshl_add_u32 v4, v8, 4, v4
    s_and_b32 s60, s98, 3
    s_mul_i32 s12, s60, 458752
    s_lshl_b32 s61, s58, 6
    s_add_u32 s12, s12, s61
    s_lshl_b32 s14, s3, 13
    v_lshrrev_b32 v8, 2, v2
    v_lshl_add_u32 v9, v3, 3, v8
    v_and_b32 v10, 3, v0
    v_lshlrev_b32 v10, 3, v10
    v_and_b32 v11, 1, v3
    v_lshl_add_u32 v7, v9, 6, v10
    v_lshl_add_u32 v7, v11, 5, v7
    v_add_u32 v7, s14, v7
    v_xor_b32 v12, 32, v7
    v_lshrrev_b32 v8, 1, v8
    v_lshl_add_u32 v8, v11, 1, v8
    v_lshl_add_u32 v112, v9, 7, v10
    v_lshl_add_u32 v112, v8, 5, v112
    v_add_u32 v112, s6, v112
    v_xor_b32 v113, 32, v112
    v_xor_b32 v114, 64, v112
    v_xor_b32 v115, 96, v112
    s_and_b32 s60, s98, 3
    s_lshl_b32 s60, s60, 8
    s_add_u32 s60, s60, 98304
    v_lshlrev_b32 v14, 4, v3
    v_add_u32 v15, s60, v14
    s_lshl_b32 s60, s98, 7
    s_add_u32 s60, s60, 99328
    v_add_u32 v107, s60, v14
    v_lshl_add_u32 v111, v3, 5, v10
    v_add_u32 v111, 99328, v111
    v_lshlrev_b32 v108, 3, v3
    v_lshl_add_u32 v108, v2, 5, v108
    s_mul_i32 s8, s3, 7168
    s_lshl_b32 s61, s58, 7
    s_add_u32 s8, s8, s61
    s_add_u32 s8, s8, 0x10000
    s_and_b32 s15, s95, 31
    s_lshl_b32 s15, s15, 11
    s_add_u32 s15, s15, 0x40000
    v_lshlrev_b32 v134, 3, v0
    v_lshlrev_b32 v133, 4, v0
    v_mov_b32 v104, s91
    v_mov_b32 v105, s92
    v_mov_b32 v106, 0x00010001
    v_lshlrev_b32 v118, 1, v0
    v_and_b32 v117, 2, v0
    v_cmp_eq_u32 vcc, 0, v117
    s_nop 1
    v_cndmask_b32 v117, v105, v104, vcc
    s_lshl_b32 s7, s58, 2
    s_add_u32 s7, s7, 0x2000
    v_lshlrev_b32 v122, 8, v0
    v_mov_b32 v123, s59
    s_cmp_lg_u32 s3, 2
    s_cbranch_scc1 L_f1
    s_waitcnt vmcnt(0)
    s_barrier
    s_add_u32 m0, s14, 0
    s_nop 0
    buffer_load_dwordx4 v4, s[44:47], s12 offen lds
    s_add_u32 s12, s12, 57344
    s_add_u32 m0, s14, 1024
    s_nop 0
    buffer_load_dwordx4 v4, s[44:47], s12 offen lds
    s_add_u32 s12, s12, 57344
    s_add_u32 m0, s14, 2048
    s_nop 0
    buffer_load_dwordx4 v4, s[44:47], s12 offen lds
    s_add_u32 s12, s12, 57344
    s_add_u32 m0, s14, 3072
    s_nop 0
    buffer_load_dwordx4 v4, s[44:47], s12 offen lds
    s_add_u32 s12, s12, 57344
    s_add_u32 m0, s14, 4096
    s_nop 0
    buffer_load_dwordx4 v4, s[44:47], s12 offen lds
    s_add_u32 s12, s12, 57344
    s_add_u32 m0, s14, 5120
    s_nop 0
    buffer_load_dwordx4 v4, s[44:47], s12 offen lds
    s_add_u32 s12, s12, 57344
    s_add_u32 m0, s14, 6144
    s_nop 0
    buffer_load_dwordx4 v4, s[44:47], s12 offen lds
    s_add_u32 s12, s12, 57344
    s_add_u32 m0, s14, 7168
    s_nop 0
    buffer_load_dwordx4 v4, s[44:47], s12 offen lds
    s_waitcnt vmcnt(4)
    buffer_load_dwordx4 v[128:131], v247, s[36:39], s15 offen sc1
    ds_read_b64_tr_b16 v[48:49], v112 offset:0
    ds_read_b64_tr_b16 v[50:51], v112 offset:512
    ds_read_b64_tr_b16 v[52:53], v113 offset:0
    ds_read_b64_tr_b16 v[54:55], v113 offset:512
    ds_read_b64_tr_b16 v[56:57], v114 offset:0
    ds_read_b64_tr_b16 v[58:59], v114 offset:512
    ds_read_b64_tr_b16 v[60:61], v115 offset:0
    ds_read_b64_tr_b16 v[62:63], v115 offset:512
    s_waitcnt vmcnt(0)
    v_xor_b32 v129, s59, v129
    v_bitop3_b32 v129, v131, s59, v129 bitop3:0xbe
    v_cmp_ne_u32 vcc, 0, v129
    v_max_u32 v128, v128, v130
    s_cbranch_vccnz L_f1b
    s_nop 0
    v_max_u32_dpp v128, v128, v128 row_ror:8 row_mask:0xf bank_mask:0xf
    s_nop 1
    v_max_u32_dpp v128, v128, v128 row_ror:4 row_mask:0xf bank_mask:0xf
    s_nop 1
    v_max_u32_dpp v128, v128, v128 row_ror:2 row_mask:0xf bank_mask:0xf
    s_nop 1
    v_max_u32_dpp v128, v128, v128 row_ror:1 row_mask:0xf bank_mask:0xf
    s_nop 0
    v_readlane_b32 s97, v128, 0
    v_readlane_b32 s60, v128, 16
    v_readlane_b32 s61, v128, 32
    v_readlane_b32 s62, v128, 48
    s_max_u32 s97, s97, s60
    s_max_u32 s61, s61, s62
    s_max_u32 s97, s97, s61
    s_and_b32 s97, s97, 2047
    s_lshl_b32 s60, s97, 10
    s_mov_b32 m0, 98304
    s_nop 0
    buffer_load_dwordx4 v247, s[32:35], s60 offen lds
    s_waitcnt vmcnt(1)
    s_waitcnt vmcnt(14)
    ds_read_b64_tr_b16 v[16:17], v7 offset:0
    ds_read_b64_tr_b16 v[18:19], v7 offset:256
    ds_read_b64_tr_b16 v[20:21], v12 offset:0
    ds_read_b64_tr_b16 v[22:23], v12 offset:256
    s_waitcnt vmcnt(12)
    ds_read_b64_tr_b16 v[24:25], v7 offset:2048
    ds_read_b64_tr_b16 v[26:27], v7 offset:2304
    ds_read_b64_tr_b16 v[28:29], v12 offset:2048
    ds_read_b64_tr_b16 v[30:31], v12 offset:2304
    s_waitcnt vmcnt(10)
    ds_read_b64_tr_b16 v[32:33], v7 offset:4096
    ds_read_b64_tr_b16 v[34:35], v7 offset:4352
    ds_read_b64_tr_b16 v[36:37], v12 offset:4096
    ds_read_b64_tr_b16 v[38:39], v12 offset:4352
    s_waitcnt vmcnt(8)
    ds_read_b64_tr_b16 v[40:41], v7 offset:6144
    ds_read_b64_tr_b16 v[42:43], v7 offset:6400
    ds_read_b64_tr_b16 v[44:45], v12 offset:6144
    ds_read_b64_tr_b16 v[46:47], v12 offset:6400
    s_waitcnt vmcnt(0)
    s_branch L_f2
L_f1b:
L_pk3:
    buffer_load_dwordx4 v[128:131], v133, s[36:39], s15 offen sc1
L_pk3_w:
    s_waitcnt vmcnt(0)
    v_xor_b32 v129, s59, v129
    v_bitop3_b32 v129, v131, s59, v129 bitop3:0xbe
    v_cmp_ne_u32 vcc, 0, v129
    v_max_u32 v128, v128, v130
    s_nop 0
    s_cbranch_vccz L_pk3_ok
    s_sleep 1
    s_sub_u32 s90, s90, 1
    s_cbranch_scc0 L_pk3
    s_mov_b32 s90, 0
L_pk3_ok:
    v_max_u32_dpp v128, v128, v128 row_ror:8 row_mask:0xf bank_mask:0xf
    s_nop 1
    v_max_u32_dpp v128, v128, v128 row_ror:4 row_mask:0xf bank_mask:0xf
    s_nop 1
    v_max_u32_dpp v128, v128, v128 row_ror:2 row_mask:0xf bank_mask:0xf
    s_nop 1
    v_max_u32_dpp v128, v128, v128 row_ror:1 row_mask:0xf bank_mask:0xf
    s_nop 0
    v_readlane_b32 s97, v128, 0
    v_readlane_b32 s60, v128, 16
    v_readlane_b32 s61, v128, 32
    v_readlane_b32 s62, v128, 48
    s_max_u32 s97, s97, s60
    s_max_u32 s61, s61, s62
    s_max_u32 s97, s97, s61
    s_and_b32 s97, s97, 2047
    s_lshl_b32 s60, s97, 10
    s_mov_b32 m0, 98304
    s_nop 0
    buffer_load_dwordx4 v247, s[32:35], s60 offen lds
    s_waitcnt vmcnt(1)
    s_waitcnt vmcnt(14)
    ds_read_b64_tr_b16 v[16:17], v7 offset:0
    ds_read_b64_tr_b16 v[18:19], v7 offset:256
    ds_read_b64_tr_b16 v[20:21], v12 offset:0
    ds_read_b64_tr_b16 v[22:23], v12 offset:256
    s_waitcnt vmcnt(12)
    ds_read_b64_tr_b16 v[24:25], v7 offset:2048
    ds_read_b64_tr_b16 v[26:27], v7 offset:2304
    ds_read_b64_tr_b16 v[28:29], v12 offset:2048
    ds_read_b64_tr_b16 v[30:31], v12 offset:2304
    s_waitcnt vmcnt(10)
    ds_read_b64_tr_b16 v[32:33], v7 offset:4096
    ds_read_b64_tr_b16 v[34:35], v7 offset:4352
    ds_read_b64_tr_b16 v[36:37], v12 offset:4096
    ds_read_b64_tr_b16 v[38:39], v12 offset:4352
    s_waitcnt vmcnt(8)
    ds_read_b64_tr_b16 v[40:41], v7 offset:6144
    ds_read_b64_tr_b16 v[42:43], v7 offset:6400
    ds_read_b64_tr_b16 v[44:45], v12 offset:6144
    ds_read_b64_tr_b16 v[46:47], v12 offset:6400
    s_waitcnt vmcnt(0)
    s_branch L_f2
L_f1:
    s_waitcnt vmcnt(0)
    s_barrier
    s_add_u32 m0, s14, 0
    s_nop 0
    buffer_load_dwordx4 v4, s[44:47], s12 offen lds
    s_add_u32 s12, s12, 57344
    s_add_u32 m0, s14, 1024
    s_nop 0
    buffer_load_dwordx4 v4, s[44:47], s12 offen lds
    s_add_u32 s12, s12, 57344
    s_add_u32 m0, s14, 2048
    s_nop 0
    buffer_load_dwordx4 v4, s[44:47], s12 offen lds
    s_add_u32 s12, s12, 57344
    s_add_u32 m0, s14, 3072
    s_nop 0
    buffer_load_dwordx4 v4, s[44:47], s12 offen lds
    s_add_u32 s12, s12, 57344
    s_add_u32 m0, s14, 4096
    s_nop 0
    buffer_load_dwordx4 v4, s[44:47], s12 offen lds
    s_add_u32 s12, s12, 57344
    s_add_u32 m0, s14, 5120
    s_nop 0
    buffer_load_dwordx4 v4, s[44:47], s12 offen lds
    s_add_u32 s12, s12, 57344
    s_add_u32 m0, s14, 6144
    s_nop 0
    buffer_load_dwordx4 v4, s[44:47], s12 offen lds
    s_add_u32 s12, s12, 57344
    s_add_u32 m0, s14, 7168
    s_nop 0
    buffer_load_dwordx4 v4, s[44:47], s12 offen lds
    ds_read_b64_tr_b16 v[48:49], v112 offset:0
    ds_read_b64_tr_b16 v[50:51], v112 offset:512
    ds_read_b64_tr_b16 v[52:53], v113 offset:0
    ds_read_b64_tr_b16 v[54:55], v113 offset:512
    ds_read_b64_tr_b16 v[56:57], v114 offset:0
    ds_read_b64_tr_b16 v[58:59], v114 offset:512
    ds_read_b64_tr_b16 v[60:61], v115 offset:0
    ds_read_b64_tr_b16 v[62:63], v115 offset:512
    s_waitcnt vmcnt(6)
    ds_read_b64_tr_b16 v[16:17], v7 offset:0
    ds_read_b64_tr_b16 v[18:19], v7 offset:256
    ds_read_b64_tr_b16 v[20:21], v12 offset:0
    ds_read_b64_tr_b16 v[22:23], v12 offset:256
    s_waitcnt vmcnt(4)
    ds_read_b64_tr_b16 v[24:25], v7 offset:2048
    ds_read_b64_tr_b16 v[26:27], v7 offset:2304
    ds_read_b64_tr_b16 v[28:29], v12 offset:2048
    ds_read_b64_tr_b16 v[30:31], v12 offset:2304
    s_waitcnt vmcnt(2)
    ds_read_b64_tr_b16 v[32:33], v7 offset:4096
    ds_read_b64_tr_b16 v[34:35], v7 offset:4352
    ds_read_b64_tr_b16 v[36:37], v12 offset:4096
    ds_read_b64_tr_b16 v[38:39], v12 offset:4352
    s_waitcnt vmcnt(0)
    ds_read_b64_tr_b16 v[40:41], v7 offset:6144
    ds_read_b64_tr_b16 v[42:43], v7 offset:6400
    ds_read_b64_tr_b16 v[44:45], v12 offset:6144
    ds_read_b64_tr_b16 v[46:47], v12 offset:6400
L_f2:
    s_waitcnt lgkmcnt(0)
    s_barrier
    ds_read_b128 v[64:67], v15 offset:0
    ds_read_b128 v[68:71], v15 offset:64
    ds_read_b128 v[72:75], v15 offset:128
    ds_read_b128 v[76:79], v15 offset:192
    s_waitcnt lgkmcnt(3)
    v_mfma_f32_16x16x32_bf16 v[80:83], v[16:19], v[64:67], 0
    v_mfma_f32_16x16x32_bf16 v[84:87], v[20:23], v[64:67], 0
    s_waitcnt lgkmcnt(2)
    v_mfma_f32_16x16x32_bf16 v[80:83], v[24:27], v[68:71], v[80:83]
    v_mfma_f32_16x16x32_bf16 v[84:87], v[28:31], v[68:71], v[84:87]
    s_waitcnt lgkmcnt(1)
    v_mfma_f32_16x16x32_bf16 v[80:83], v[32:35], v[72:75], v[80:83]
    v_mfma_f32_16x16x32_bf16 v[84:87], v[36:39], v[72:75], v[84:87]
    s_waitcnt lgkmcnt(0)
    v_mfma_f32_16x16x32_bf16 v[80:83], v[40:43], v[76:79], v[80:83]
    v_mfma_f32_16x16x32_bf16 v[84:87], v[44:47], v[76:79], v[84:87]
    s_mov_b32 exec_lo, 0x10001
    s_mov_b32 exec_hi, 0x10001
    s_nop 4
    ds_write_b128 v107, v[80:83] offset:0
    ds_write_b128 v107, v[84:87] offset:64
    s_mov_b64 exec, -1
    s_waitcnt lgkmcnt(0)
    s_barrier
    ds_read_b64 v[64:65], v111 offset:0
    ds_read_b64 v[66:67], v111 offset:128
    ds_read_b64 v[68:69], v111 offset:256
    ds_read_b64 v[70:71], v111 offset:384
    ds_read_b64 v[72:73], v111 offset:512
    ds_read_b64 v[74:75], v111 offset:640
    ds_read_b64 v[76:77], v111 offset:768
    ds_read_b64 v[78:79], v111 offset:896
    s_waitcnt lgkmcnt(4)
    v_pk_add_f32 v[64:65], v[64:65], v[66:67]
    v_pk_add_f32 v[68:69], v[68:69], v[70:71]
    v_pk_add_f32 v[64:65], v[64:65], v[68:69]
    v_mul_f32 v67, 0xbfb8aa3b, v65
    v_mul_f32 v66, 0xbfb8aa3b, v64
    v_exp_f32 v67, v67
    v_exp_f32 v66, v66
    v_add_f32 v67, 1.0, v67
    v_add_f32 v66, 1.0, v66
    v_rcp_f32 v67, v67
    v_rcp_f32 v66, v66
    s_nop 0
    v_pk_mul_f32 v[64:65], v[64:65], v[66:67]
    s_waitcnt lgkmcnt(0)
    v_pk_add_f32 v[72:73], v[72:73], v[74:75]
    v_pk_add_f32 v[76:77], v[76:77], v[78:79]
    v_pk_add_f32 v[72:73], v[72:73], v[76:77]
    v_pk_mul_f32 v[64:65], v[64:65], v[72:73]
    v_cvt_pk_bf16_f32 v64, v64, v65
    s_nop 1
    v_mov_b32_dpp v72, v64 quad_perm:[0,0,0,0] row_mask:0xf bank_mask:0xf
    v_mov_b32_dpp v73, v64 quad_perm:[1,1,1,1] row_mask:0xf bank_mask:0xf
    v_mov_b32_dpp v74, v64 quad_perm:[2,2,2,2] row_mask:0xf bank_mask:0xf
    v_mov_b32_dpp v75, v64 quad_perm:[3,3,3,3] row_mask:0xf bank_mask:0xf
    s_nop 1
    v_mfma_f32_16x16x32_bf16 v[88:91], v[72:75], v[48:51], 0
    v_mfma_f32_16x16x32_bf16 v[92:95], v[72:75], v[52:55], 0
    v_mfma_f32_16x16x32_bf16 v[96:99], v[72:75], v[56:59], 0
    v_mfma_f32_16x16x32_bf16 v[100:103], v[72:75], v[60:63], 0
    s_mov_b32 exec_lo, 0xffff0000
    s_mov_b32 exec_hi, 0
    s_nop 3
    v_mov_b32 v88, v92
    s_mov_b32 exec_lo, 0
    s_mov_b32 exec_hi, 0xffff
    v_mov_b32 v88, v96
    s_mov_b32 exec_hi, 0xffff0000
    v_mov_b32 v88, v100
    s_mov_b64 exec, -1
    s_nop 0
    v_mov_b32_dpp v89, v88 quad_perm:[1,1,3,3] row_mask:0xf bank_mask:0xf
    v_cvt_pk_bf16_f32 v120, v88, v89
    s_mov_b32 exec_lo, 0x55555555
    s_mov_b32 exec_hi, 0x55555555
    v_bitop3_b32 v120, v106, v117, v120 bitop3:0xca
    buffer_store_dword v120, v118, s[36:39], s8 offen sc1
    s_mov_b64 exec, -1
    s_endpgm
    v_mfma_f32_16x16x32_bf16 v[88:91], v[48:51], v[72:75], 0
    v_mfma_f32_16x16x32_bf16 v[92:95], v[52:55], v[72:75], 0
    v_mfma_f32_16x16x32_bf16 v[96:99], v[56:59], v[72:75], 0
    v_mfma_f32_16x16x32_bf16 v[100:103], v[60:63], v[72:75], 0
    s_mov_b32 exec_lo, 0x10001
    s_mov_b32 exec_hi, 0x10001
    s_nop 2
    v_cvt_pk_bf16_f32 v120, v88, v89
    v_cvt_pk_bf16_f32 v121, v90, v91
    s_mov_b32 exec_lo, 0x20002
    s_mov_b32 exec_hi, 0x20002
    v_cvt_pk_bf16_f32 v120, v92, v93
    v_cvt_pk_bf16_f32 v121, v94, v95
    s_mov_b32 exec_lo, 0x40004
    s_mov_b32 exec_hi, 0x40004
    v_cvt_pk_bf16_f32 v120, v96, v97
    v_cvt_pk_bf16_f32 v121, v98, v99
    s_mov_b32 exec_lo, 0x80008
    s_mov_b32 exec_hi, 0x80008
    v_cvt_pk_bf16_f32 v120, v100, v101
    v_cvt_pk_bf16_f32 v121, v102, v103
    s_mov_b32 exec_lo, 0x000f000f
    s_mov_b32 exec_hi, 0x000f000f
    v_bitop3_b32 v120, v106, v104, v120 bitop3:0xca
    v_bitop3_b32 v121, v106, v105, v121 bitop3:0xca
    buffer_store_dwordx2 v[120:121], v108, s[36:39], s8 offen sc1
    s_mov_b64 exec, -1
    s_endpgm
L_fin:
    v_lshlrev_b32 v4, 5, v2
    v_and_b32 v96, 1, v3
    v_lshl_add_u32 v4, v96, 9, v4
    v_lshrrev_b32 v96, 1, v3
    v_lshl_add_u32 v4, v96, 4, v4
    s_add_u32 s95, s56, 24
    s_lshr_b32 s99, s57, 1
    s_and_b32 s99, s99, 4
    s_add_u32 s99, s99, s56
    s_sub_u32 s99, s99, 4
    s_waitcnt lgkmcnt(0)
    s_load_dword s59, s[30:31], 0
    s_mov_b32 s32, s4
    s_mov_b32 s33, s5
    s_mov_b32 s34, 0x200000
    s_mov_b32 s35, 0x20000
    s_mov_b32 s36, s30
    s_mov_b32 s37, s31
    s_mov_b32 s38, 0x400000
    s_mov_b32 s39, 0x20000
    s_mov_b32 s48, s24
    s_mov_b32 s49, s25
    s_mov_b32 s50, 0x400
    s_mov_b32 s51, 0x20000
    buffer_load_dwordx4 v[28:31], v4, s[48:51], 0 offen
    s_lshl_b32 s60, s3, 10
    v_lshl_add_u32 v248, v0, 4, s60
    s_add_u32 m0, s60, 32768
    global_load_lds_dwordx4 v248, s[10:11] offset:0
    s_and_b32 s63, s3, 1
    s_add_u32 s63, s63, 8
    s_lshl_b32 s60, s63, 10
    v_lshl_add_u32 v248, v0, 4, s60
    s_add_u32 m0, s60, 32768
    global_load_lds_dwordx4 v248, s[10:11] offset:0
    s_mov_b32 s40, s26
    s_mov_b32 s41, s27
    s_mov_b32 s42, 0x200000
    s_mov_b32 s43, 0x20000
    v_mov_b32 v252, s4
    v_mov_b32 v253, s5
    v_writelane_b32 v252, s26, 1
    v_writelane_b32 v253, s27, 1
    s_add_u32 s63, s30, 0x3000
    v_writelane_b32 v252, s63, 2
    s_addc_u32 s63, s31, 0
    v_writelane_b32 v253, s63, 2
    s_add_u32 s63, s30, 0x203000
    v_writelane_b32 v252, s63, 3
    s_addc_u32 s63, s31, 0
    v_writelane_b32 v253, s63, 3
    s_mov_b64 exec, 0xf
    global_load_dword v254, v[252:253], off
    s_mov_b64 exec, -1
    v_lshlrev_b32 v5, 12, v3
    v_lshl_add_u32 v5, v2, 4, v5
    v_lshrrev_b32 v96, 2, v2
    v_xor_b32 v96, v96, v3
    v_and_b32 v96, 1, v96
    v_bfe_u32 v97, v2, 1, 1
    v_lshl_or_b32 v96, v96, 1, v97
    s_lshr_b32 s60, s3, 1
    v_xor_b32 v96, s60, v96
    v_lshlrev_b32 v96, 4, v96
    v_and_b32 v98, 7, v2
    v_lshl_add_u32 v96, v98, 6, v96
    v_lshl_add_u32 v96, v3, 12, v96
    v_lshrrev_b32 v98, 3, v2
    v_lshl_add_u32 v96, v98, 2, v96
    s_and_b32 s60, s3, 1
    s_lshl_b32 s60, s60, 3
    s_add_u32 s60, s60, 16384
    v_add_u32 v6, s60, v96
    v_xor_b32 v7, 48, v6
    v_bfe_u32 v96, v2, 2, 1
    v_xor_b32 v96, v96, v98
    v_lshl_or_b32 v96, v96, 1, v98
    v_xor_b32 v96, v96, v97
    v_xor_b32 v96, v96, v3
    v_lshlrev_b32 v96, 4, v96
    v_lshl_add_u32 v62, v2, 6, v96
    s_and_b32 s15, s95, 31
    s_lshl_b32 s15, s15, 11
    s_add_u32 s15, s15, 0x40000
    v_lshlrev_b32 v134, 3, v0
    v_lshlrev_b32 v133, 4, v0
    s_mul_i32 s7, s99, 7168
    s_lshl_b32 s61, s3, 10
    s_add_u32 s7, s7, s61
    s_add_u32 s7, s7, 0xfc00
    v_and_b32 v108, 1, v3
    v_lshrrev_b32 v111, 1, v3
    v_lshl_add_u32 v108, v108, 1, v111
    v_and_b32 v107, 7, v2
    v_lshl_add_u32 v108, v2, 2, v108
    s_lshl_b32 s60, s3, 8
    s_add_u32 s60, s60, 43008
    v_lshl_add_u32 v108, v108, 2, s60
    v_and_b32 v111, 3, v2
    v_lshlrev_b32 v111, 6, v111
    v_lshl_add_u32 v111, v3, 4, v111
    v_mov_b32 v109, 43016
    s_waitcnt lgkmcnt(0)
    s_add_u32 s59, s59, 0x9e3779b9
    s_bitcmp1_b32 s59, 0
    s_cselect_b32 s91, 1, 0x10000
    s_xor_b32 s92, s91, 0x10001
    s_cmp_lg_u32 s3, 0
    s_cbranch_scc1 L_fin0
    s_cmp_eq_u32 s99, 0
    s_cbranch_scc1 L_fin0
    s_lshl_b32 s60, s99, 7
    v_mov_b32 v96, 0x1000
    v_mov_b32 v97, s59
    s_mov_b64 exec, 1
    buffer_store_dword v97, v96, s[36:39], s60 offen sc1
    s_mov_b64 exec, -1
L_fin0:
    v_mov_b32 v104, s91
    v_mov_b32 v105, s92
    v_mov_b32 v106, 0x00010001
    s_waitcnt vmcnt(0)
    s_barrier
    s_lshr_b32 s60, s99, 2
    s_lshl_b32 s60, s60, 10
    v_add_u32 v110, s60, v247
    ds_read_b128 v[152:155], v247 offset:32768
    ds_read_b128 v[156:159], v247 offset:33792
    ds_read_b128 v[184:187], v247 offset:34816
    ds_read_b128 v[188:191], v247 offset:35840
    ds_read_b128 v[192:195], v247 offset:36864
    ds_read_b128 v[196:199], v247 offset:37888
    ds_read_b128 v[168:171], v110 offset:38912
    ds_read_b128 v[172:175], v110 offset:40960
    s_cmp_lg_u32 s3, 0
    s_cbranch_scc1 L_fin1a
    v_mov_b32 v80, 0
    v_mov_b32 v81, 0
    v_mov_b32 v82, 0
    v_mov_b32 v83, 0
    buffer_atomic_or_x2 v[80:81], v134, s[36:39], s15 offen sc0 sc1
    buffer_atomic_or_x2 v[82:83], v134, s[36:39], s15 offen offset:512 sc0 sc1
    s_sleep 4
    v_mov_b32 v84, 0
    v_mov_b32 v85, 0
    v_mov_b32 v86, 0
    v_mov_b32 v87, 0
    buffer_atomic_or_x2 v[84:85], v134, s[36:39], s15 offen sc0 sc1
    buffer_atomic_or_x2 v[86:87], v134, s[36:39], s15 offen offset:512 sc0 sc1
    s_sleep 4
    v_mov_b32 v88, 0
    v_mov_b32 v89, 0
    v_mov_b32 v90, 0
    v_mov_b32 v91, 0
    buffer_atomic_or_x2 v[88:89], v134, s[36:39], s15 offen sc0 sc1
    buffer_atomic_or_x2 v[90:91], v134, s[36:39], s15 offen offset:512 sc0 sc1
L_kp4:
    s_waitcnt vmcnt(4)
    v_xor_b32 v129, s59, v81
    v_bitop3_b32 v129, v83, s59, v129 bitop3:0xbe
    v_cmp_ne_u32 vcc, 0, v129
    s_nop 0
    s_cbranch_vccz L_kp4_d0
    v_mov_b32 v80, 0
    v_mov_b32 v81, 0
    v_mov_b32 v82, 0
    v_mov_b32 v83, 0
    buffer_atomic_or_x2 v[80:81], v134, s[36:39], s15 offen sc0 sc1
    buffer_atomic_or_x2 v[82:83], v134, s[36:39], s15 offen offset:512 sc0 sc1
    s_waitcnt vmcnt(4)
    v_xor_b32 v129, s59, v85
    v_bitop3_b32 v129, v87, s59, v129 bitop3:0xbe
    v_cmp_ne_u32 vcc, 0, v129
    s_nop 0
    s_cbranch_vccz L_kp4_d1
    v_mov_b32 v84, 0
    v_mov_b32 v85, 0
    v_mov_b32 v86, 0
    v_mov_b32 v87, 0
    buffer_atomic_or_x2 v[84:85], v134, s[36:39], s15 offen sc0 sc1
    buffer_atomic_or_x2 v[86:87], v134, s[36:39], s15 offen offset:512 sc0 sc1
    s_waitcnt vmcnt(4)
    v_xor_b32 v129, s59, v89
    v_bitop3_b32 v129, v91, s59, v129 bitop3:0xbe
    v_cmp_ne_u32 vcc, 0, v129
    s_nop 0
    s_cbranch_vccz L_kp4_d2
    v_mov_b32 v88, 0
    v_mov_b32 v89, 0
    v_mov_b32 v90, 0
    v_mov_b32 v91, 0
    buffer_atomic_or_x2 v[88:89], v134, s[36:39], s15 offen sc0 sc1
    buffer_atomic_or_x2 v[90:91], v134, s[36:39], s15 offen offset:512 sc0 sc1
    s_sub_u32 s90, s90, 1
    s_cbranch_scc0 L_kp4
    s_waitcnt vmcnt(0)
L_kp4_d0:
    v_max_u32 v128, v80, v82
    s_branch L_kp4_x
L_kp4_d1:
    v_max_u32 v128, v84, v86
    s_branch L_kp4_x
L_kp4_d2:
    v_max_u32 v128, v88, v90
L_kp4_x:
    s_nop 1
    v_max_u32_dpp v128, v128, v128 row_ror:8 row_mask:0xf bank_mask:0xf
    s_nop 1
    v_max_u32_dpp v128, v128, v128 row_ror:4 row_mask:0xf bank_mask:0xf
    s_nop 1
    v_max_u32_dpp v128, v128, v128 row_ror:2 row_mask:0xf bank_mask:0xf
    s_nop 1
    v_max_u32_dpp v128, v128, v128 row_ror:1 row_mask:0xf bank_mask:0xf
    s_nop 0
    v_readlane_b32 s97, v128, 0
    v_readlane_b32 s60, v128, 16
    v_readlane_b32 s61, v128, 32
    v_readlane_b32 s62, v128, 48
    s_max_u32 s97, s97, s60
    s_max_u32 s61, s61, s62
    s_max_u32 s97, s97, s61
    v_mov_b32 v110, s97
    ds_write_b32 v109, v110
    s_and_b32 s60, s97, 2047
    s_lshl_b32 s12, s60, 10
    buffer_load_dwordx4 v[40:43], v4, s[32:35], s12 offen
    s_branch L_fin1
L_fin1a:
    s_lshl3_add_u32 s60, s99, s3
    s_cmp_lg_u32 s60, 2
    s_cbranch_scc1 L_fin1
    v_lshlrev_b32 v128, 7, v0
    s_mov_b64 exec, 0xff
    s_movk_i32 s60, 0x1000
L_ack:
    buffer_load_dword v129, v128, s[36:39], s60 offen sc1
    s_waitcnt vmcnt(0)
    v_cmp_ne_u32 vcc, s59, v129
    s_nop 0
    s_cbranch_vccz L_ack_ok
    s_sleep 1
    s_sub_u32 s90, s90, 1
    s_cbranch_scc0 L_ack
    s_mov_b32 s90, 0
L_ack_ok:
    s_mov_b64 exec, -1
L_fin1:
    s_waitcnt lgkmcnt(0)
    s_barrier
    ds_read_b32 v110, v109
    s_waitcnt lgkmcnt(0)
    v_readfirstlane_b32 s8, v110
    s_nop 0
    s_and_b32 s97, s8, 2047
    s_and_b32 s60, s97, 255
    s_and_b32 s61, s97, 15
    s_and_b32 s62, s97, 7
    s_cselect_b32 s60, s61, s60
    s_cselect_b32 s61, 8, 128
    s_cmp_gt_u32 s60, s61
    s_cselect_b32 s96, 0x80000000, 0
    s_sub_u32 s61, 2048, s97
    s_cmp_lg_u32 s96, 0
    s_cselect_b32 s60, s61, s97
    s_and_b32 s58, s60, 255
    s_lshr_b32 s98, s60, 8
    s_lshr_b32 s60, s58, 4
    s_and_b32 s61, s58, 15
    s_lshl4_add_u32 s9, s61, s60
    s_add_u32 s62, s60, s61
    s_cmp_eq_u32 s61, 8
    s_cselect_b32 s9, s62, s9
    s_cmp_eq_u32 s58, 128
    s_cselect_b32 s9, 0, s9
    s_lshl_b32 s14, s9, 14
    s_lshl_b32 s60, s3, 8
    s_add_u32 s14, s14, s60
    s_add_u32 s14, s14, 0x200000
    v_lshrrev_b32 v96, 1, v2
    v_lshlrev_b32 v96, 8, v96
    v_add_u32 v96, s58, v96
    v_and_b32 v97, 1, v2
    v_lshlrev_b32 v98, 1, v3
    v_mul_u32_u24 v98, v98, v96
    v_cmp_eq_u32 vcc, 0, v97
    v_and_b32 v99, 2047, v98
    v_add_u32 v98, v98, v96
    v_cvt_f32_u32 v99, v99
    v_mul_f32 v99, 0x3a000000, v99
    v_cos_f32 v100, v99
    v_sin_f32 v101, v99
    v_mul_f32 v100, 0.5, v100
    v_mul_f32 v101, 0.5, v101
    v_cndmask_b32_e64 v102, -v101, v100, vcc
    v_cndmask_b32 v103, v100, v101, vcc
    v_cvt_pk_bf16_f32 v144, v102, v103
    v_cvt_pk_bf16_f32 v148, -v103, v102
    v_cndmask_b32 v102, v101, v100, vcc
    v_cndmask_b32_e64 v103, -v100, v101, vcc
    v_cvt_pk_bf16_f32 v145, v102, -v103
    v_cvt_pk_bf16_f32 v149, -v103, -v102
    s_and_b32 s60, s58, 127
    s_cbranch_scc1 L_fin_a10
    v_add_f32 v100, v100, v100
    v_add_f32 v101, v101, v101
    v_cndmask_b32 v102, 0, v100, vcc
    v_sub_f32 v103, v100, v102
    v_cvt_pk_bf16_f32 v100, v102, v103
    v_cndmask_b32 v102, 0, v101, vcc
    v_sub_f32 v103, v101, v102
    v_cvt_pk_bf16_f32 v101, -v102, -v103
    s_cmp_eq_u32 s58, 0
    s_cselect_b32 s60, -1, 0
    s_cselect_b32 s61, 0, -1
    v_and_b32 v144, s60, v100
    v_and_b32 v148, s60, v101
    v_and_b32 v145, s61, v100
    v_and_b32 v149, s61, v101
L_fin_a10:
    v_and_b32 v99, 2047, v98
    v_cvt_f32_u32 v99, v99
    v_mul_f32 v99, 0x3a000000, v99
    v_cos_f32 v100, v99
    v_sin_f32 v101, v99
    v_mul_f32 v100, 0.5, v100
    v_mul_f32 v101, 0.5, v101
    v_cndmask_b32_e64 v102, -v101, v100, vcc
    v_cndmask_b32 v103, v100, v101, vcc
    v_cvt_pk_bf16_f32 v146, v102, v103
    v_cvt_pk_bf16_f32 v150, -v103, v102
    v_cndmask_b32 v102, v101, v100, vcc
    v_cndmask_b32_e64 v103, -v100, v101, vcc
    v_cvt_pk_bf16_f32 v147, v102, -v103
    v_cvt_pk_bf16_f32 v151, -v103, -v102
    s_and_b32 s60, s58, 127
    s_cbranch_scc1 L_fin_a11
    v_add_f32 v100, v100, v100
    v_add_f32 v101, v101, v101
    v_cndmask_b32 v102, 0, v100, vcc
    v_sub_f32 v103, v100, v102
    v_cvt_pk_bf16_f32 v100, v102, v103
    v_cndmask_b32 v102, 0, v101, vcc
    v_sub_f32 v103, v101, v102
    v_cvt_pk_bf16_f32 v101, -v102, -v103
    s_cmp_eq_u32 s58, 0
    s_cselect_b32 s60, -1, 0
    s_cselect_b32 s61, 0, -1
    v_and_b32 v146, s60, v100
    v_and_b32 v150, s60, v101
    v_and_b32 v147, s61, v100
    v_and_b32 v151, s61, v101
L_fin_a11:
    s_cmp_lg_u32 s3, 0
    s_cbranch_scc1 L_fin3
    s_lshl_b32 s60, s98, 4
    s_and_b32 s60, s60, 32
    v_xor_b32 v62, s60, v62
    s_lshl_b32 s60, s98, 11
    s_add_u32 s60, s60, 16384
    v_add_u32 v62, s60, v62
    v_xor_b32 v152, s96, v152
    v_xor_b32 v156, s96, v156
    v_xor_b32 v153, s96, v153
    v_xor_b32 v157, s96, v157
    v_xor_b32 v154, s96, v154
    v_xor_b32 v158, s96, v158
    v_xor_b32 v155, s96, v155
    v_xor_b32 v159, s96, v159
    s_ashr_i32 s60, s8, 31
    s_orn2_b32 s60, 0x80000000, s60
    s_xor_b32 s8, s8, s60
    s_waitcnt vmcnt(0)
    v_dot2_f32_bf16 v32, v40, v28, 0
    v_dot2_f32_bf16 v32, v41, v29, v32
    v_dot2_f32_bf16 v32, v42, v30, v32
    v_dot2_f32_bf16 v32, v43, v31, v32
    s_nop 2
    v_add_f32_dpp v32, v32, v32 row_ror:8 row_mask:0xf bank_mask:0xf
    s_nop 1
    v_add_f32_dpp v32, v32, v32 row_ror:4 row_mask:0xf bank_mask:0xf
    s_nop 1
    v_add_f32_dpp v32, v32, v32 row_ror:2 row_mask:0xf bank_mask:0xf
    s_nop 1
    v_add_f32_dpp v32, v32, v32 row_ror:1 row_mask:0xf bank_mask:0xf
    v_mov_b32 v33, v32
    s_nop 1
    v_permlane32_swap_b32 v32, v33
    v_add_f32 v32, v32, v33
    v_mov_b32 v33, v32
    s_nop 1
    v_permlane16_swap_b32 v32, v33
    v_add_f32 v32, v32, v33
    v_mov_b32 v33, s8
    v_cvt_pk_bf16_f32 v33, v33, v33
    v_cvt_pk_bf16_f32 v32, v32, v32
    v_and_b32 v33, 0xffff0000, v33
    v_and_b32 v32, 0xffff0000, v32
    v_mul_f32 v35, 0xbfb8aa3b, v33
    v_mul_f32 v34, 0xbfb8aa3b, v32
    v_exp_f32 v35, v35
    v_exp_f32 v34, v34
    v_add_f32 v35, 1.0, v35
    v_add_f32 v34, 1.0, v34
    v_rcp_f32 v35, v35
    v_rcp_f32 v34, v34
    v_cvt_pk_bf16_f32 v35, v35, v35
    v_cvt_pk_bf16_f32 v34, v34, v34
    v_and_b32 v35, 0xffff0000, v35
    v_and_b32 v34, 0xffff0000, v34
    v_permlane16_swap_b32 v40, v42
    v_permlane16_swap_b32 v41, v43
    s_bitcmp1_b32 s99, 2
    s_cbranch_scc0 L_fint
    v_mov_b32 v40, v42
    v_mov_b32 v41, v43
L_fint:
    v_sub_f32 v36, 1.0, v34
    v_cvt_pk_bf16_f32 v36, v36, v36
    v_and_b32 v36, 0xffff0000, v36
    v_lshlrev_b32 v216, 16, v40
    v_and_b32 v217, 0xffff0000, v40
    v_pk_mul_f32 v[216:217], v[216:217], v[36:37] op_sel_hi:[1,0]
    v_lshlrev_b32 v218, 16, v41
    v_and_b32 v219, 0xffff0000, v41
    v_pk_mul_f32 v[218:219], v[218:219], v[36:37] op_sel_hi:[1,0]
    v_mul_f32 v38, v35, v36
    v_pk_mul_f32 v[184:185], v[184:185], v[34:35] op_sel_hi:[1,0]
    v_pk_mul_f32 v[186:187], v[186:187], v[34:35] op_sel_hi:[1,0]
    v_pk_mul_f32 v[188:189], v[188:189], v[34:35] op_sel_hi:[1,0]
    v_pk_mul_f32 v[190:191], v[190:191], v[34:35] op_sel_hi:[1,0]
    v_pk_mul_f32 v[192:193], v[192:193], v[34:35] op_sel_hi:[1,0]
    v_pk_mul_f32 v[194:195], v[194:195], v[34:35] op_sel_hi:[1,0]
    v_pk_mul_f32 v[196:197], v[196:197], v[34:35] op_sel_hi:[1,0]
    v_pk_mul_f32 v[198:199], v[198:199], v[34:35] op_sel_hi:[1,0]
L_fin3:
    buffer_load_dwordx4 v[8:11], v5, s[36:39], s14 offen offset:0 sc1
    buffer_load_dwordx4 v[12:15], v5, s[36:39], s14 offen offset:2048 sc1
    s_branch L_fin_pw
L_fin_pl:
    buffer_load_dwordx4 v[8:11], v5, s[36:39], s14 offen offset:0 sc1
    buffer_load_dwordx4 v[12:15], v5, s[36:39], s14 offen offset:2048 sc1
L_fin_pw:
    s_waitcnt vmcnt(0)
    v_swap_b32 v10, v12
    v_swap_b32 v11, v13
    v_xor_b32 v96, v104, v8
    v_xor_b32 v97, v105, v9
    v_mfma_f32_16x16x32_bf16 v[64:67], v[144:147], v[8:11], 0
    v_bitop3_b32 v96, v10, v104, v96 bitop3:0xbe
    v_bitop3_b32 v97, v11, v105, v97 bitop3:0xbe
    v_mfma_f32_16x16x32_bf16 v[68:71], v[148:151], v[8:11], 0
    v_bitop3_b32 v96, v12, v104, v96 bitop3:0xbe
    v_bitop3_b32 v97, v13, v105, v97 bitop3:0xbe
    v_mfma_f32_16x16x32_bf16 v[72:75], v[144:147], v[12:15], 0
    v_bitop3_b32 v96, v14, v104, v96 bitop3:0xbe
    v_bitop3_b32 v97, v15, v105, v97 bitop3:0xbe
    v_mfma_f32_16x16x32_bf16 v[76:79], v[148:151], v[12:15], 0
    v_bitop3_b32 v96, v96, v97, v106 bitop3:0xa8
    v_cmp_ne_u32 vcc, 0, v96
    s_nop 0
    s_cbranch_vccz L_fin_pl_ok
    s_sleep 1
    s_sub_u32 s90, s90, 1
    s_cbranch_scc0 L_fin_pl
    s_mov_b32 s90, 0
L_fin_pl_ok:
    v_cvt_pk_bf16_f32 v16, v64, v68
    v_cvt_pk_bf16_f32 v17, v65, v69
    ds_write2st64_b32 v6, v16, v17 offset0:0 offset1:4
    v_cvt_pk_bf16_f32 v18, v66, v70
    v_cvt_pk_bf16_f32 v19, v67, v71
    ds_write2st64_b32 v6, v18, v19 offset0:8 offset1:12
    v_cvt_pk_bf16_f32 v20, v72, v76
    v_cvt_pk_bf16_f32 v21, v73, v77
    ds_write2st64_b32 v7, v20, v21 offset0:2 offset1:6
    v_cvt_pk_bf16_f32 v22, v74, v78
    v_cvt_pk_bf16_f32 v23, v75, v79
    ds_write2st64_b32 v7, v22, v23 offset0:10 offset1:14
    s_waitcnt lgkmcnt(0)
    s_barrier
    s_cmp_lg_u32 s3, 0
    s_cbranch_scc1 L_pp0
    ds_read_b128 v[16:19], v62 offset:0
    ds_read_b128 v[20:23], v62 offset:1024
    s_waitcnt lgkmcnt(1)
    v_mfma_f32_16x16x32_bf16 v[64:67], v[16:19], v[152:155], 0
    v_mfma_f32_16x16x32_bf16 v[68:71], v[16:19], v[156:159], 0
    s_waitcnt lgkmcnt(0)
    v_mfma_f32_16x16x32_bf16 v[72:75], v[20:23], v[152:155], 0
    v_mfma_f32_16x16x32_bf16 v[76:79], v[20:23], v[156:159], 0
    s_nop 3
    v_pk_mul_f32 v[96:97], v[64:65], v[184:185]
    v_pk_mul_f32 v[100:101], v[68:69], v[184:185]
    v_pk_mul_f32 v[98:99], v[66:67], v[186:187]
    v_pk_mul_f32 v[102:103], v[70:71], v[186:187]
    v_pk_fma_f32 v[96:97], v[68:69], v[188:189], v[96:97]
    v_pk_fma_f32 v[100:101], v[64:65], v[188:189], v[100:101] neg_lo:[1,0,0] neg_hi:[1,0,0]
    v_pk_fma_f32 v[98:99], v[70:71], v[190:191], v[98:99]
    v_pk_fma_f32 v[102:103], v[66:67], v[190:191], v[102:103] neg_lo:[1,0,0] neg_hi:[1,0,0]
    v_cvt_pk_bf16_f32 v112, v96, v100
    v_cvt_pk_bf16_f32 v113, v97, v101
    v_cvt_pk_bf16_f32 v114, v98, v102
    v_cvt_pk_bf16_f32 v115, v99, v103
    s_nop 1
    v_mfma_f32_16x16x32_bf16 v[232:235], v[112:115], v[168:171], v[216:219]
    v_pk_mul_f32 v[96:97], v[72:73], v[192:193]
    v_pk_mul_f32 v[100:101], v[76:77], v[192:193]
    v_pk_mul_f32 v[98:99], v[74:75], v[194:195]
    v_pk_mul_f32 v[102:103], v[78:79], v[194:195]
    v_pk_fma_f32 v[96:97], v[76:77], v[196:197], v[96:97]
    v_pk_fma_f32 v[100:101], v[72:73], v[196:197], v[100:101] neg_lo:[1,0,0] neg_hi:[1,0,0]
    v_pk_fma_f32 v[98:99], v[78:79], v[198:199], v[98:99]
    v_pk_fma_f32 v[102:103], v[74:75], v[198:199], v[102:103] neg_lo:[1,0,0] neg_hi:[1,0,0]
    v_cvt_pk_bf16_f32 v116, v96, v100
    v_cvt_pk_bf16_f32 v117, v97, v101
    v_cvt_pk_bf16_f32 v118, v98, v102
    v_cvt_pk_bf16_f32 v119, v99, v103
    s_nop 1
    v_mfma_f32_16x16x32_bf16 v[232:235], v[116:119], v[172:175], v[232:235]
    v_lshlrev_b32 v4, 5, v2
    v_lshl_add_u32 v4, v3, 3, v4
    s_lshr_b32 s61, s99, 2
    s_lshl_b32 s61, s61, 9
    s_add_u32 s12, s12, s61
    s_and_b32 s61, s99, 3
    s_lshl_b32 s61, s61, 2
    s_lshl_b32 exec_lo, 0x000f000f, s61
    s_mov_b32 exec_hi, exec_lo
    ds_write_b128 v111, v[232:235] offset:45056
    s_mov_b64 exec, 0xffff
    s_waitcnt lgkmcnt(0)
    ds_read_b128 v[232:235], v247 offset:45056
    v_mov_b32 v111, v247
    v_mov_b32 v4, v246
    s_lshl_b32 s12, s97, 10
    s_lshl_b32 s61, s99, 7
    s_add_u32 s12, s12, s61
    s_waitcnt lgkmcnt(0)
    s_branch L_fin5
L_pp0:
    v_mov_b32 v8, 0
    v_mov_b32 v9, 0
    v_mov_b32 v10, 0
    v_mov_b32 v11, 0
    buffer_atomic_or_x2 v[8:9], v246, s[36:39], s7 offen offset:0 sc0 sc1
    buffer_atomic_or_x2 v[10:11], v246, s[36:39], s7 offen offset:512 sc0 sc1
    s_sleep 4
    v_mov_b32 v12, 0
    v_mov_b32 v13, 0
    v_mov_b32 v14, 0
    v_mov_b32 v15, 0
    buffer_atomic_or_x2 v[12:13], v246, s[36:39], s7 offen offset:0 sc0 sc1
    buffer_atomic_or_x2 v[14:15], v246, s[36:39], s7 offen offset:512 sc0 sc1
    s_sleep 4
    v_mov_b32 v16, 0
    v_mov_b32 v17, 0
    v_mov_b32 v18, 0
    v_mov_b32 v19, 0
    buffer_atomic_or_x2 v[16:17], v246, s[36:39], s7 offen offset:0 sc0 sc1
    buffer_atomic_or_x2 v[18:19], v246, s[36:39], s7 offen offset:512 sc0 sc1
L_pa:
    s_waitcnt vmcnt(4)
    v_xor_b32 v96, v104, v8
    v_xor_b32 v97, v105, v9
    v_bitop3_b32 v96, v10, v104, v96 bitop3:0xbe
    v_bitop3_b32 v97, v11, v105, v97 bitop3:0xbe
    v_bitop3_b32 v96, v96, v97, v106 bitop3:0xa8
    v_cmp_ne_u32 vcc, 0, v96
    s_nop 0
    s_cbranch_vccz L_pa_d0
    v_mov_b32 v8, 0
    v_mov_b32 v9, 0
    v_mov_b32 v10, 0
    v_mov_b32 v11, 0
    buffer_atomic_or_x2 v[8:9], v246, s[36:39], s7 offen offset:0 sc0 sc1
    buffer_atomic_or_x2 v[10:11], v246, s[36:39], s7 offen offset:512 sc0 sc1
    s_waitcnt vmcnt(4)
    v_xor_b32 v96, v104, v12
    v_xor_b32 v97, v105, v13
    v_bitop3_b32 v96, v14, v104, v96 bitop3:0xbe
    v_bitop3_b32 v97, v15, v105, v97 bitop3:0xbe
    v_bitop3_b32 v96, v96, v97, v106 bitop3:0xa8
    v_cmp_ne_u32 vcc, 0, v96
    s_nop 0
    s_cbranch_vccz L_pa_d1
    v_mov_b32 v12, 0
    v_mov_b32 v13, 0
    v_mov_b32 v14, 0
    v_mov_b32 v15, 0
    buffer_atomic_or_x2 v[12:13], v246, s[36:39], s7 offen offset:0 sc0 sc1
    buffer_atomic_or_x2 v[14:15], v246, s[36:39], s7 offen offset:512 sc0 sc1
    s_waitcnt vmcnt(4)
    v_xor_b32 v96, v104, v16
    v_xor_b32 v97, v105, v17
    v_bitop3_b32 v96, v18, v104, v96 bitop3:0xbe
    v_bitop3_b32 v97, v19, v105, v97 bitop3:0xbe
    v_bitop3_b32 v96, v96, v97, v106 bitop3:0xa8
    v_cmp_ne_u32 vcc, 0, v96
    s_nop 0
    s_cbranch_vccz L_pa_d2
    v_mov_b32 v16, 0
    v_mov_b32 v17, 0
    v_mov_b32 v18, 0
    v_mov_b32 v19, 0
    buffer_atomic_or_x2 v[16:17], v246, s[36:39], s7 offen offset:0 sc0 sc1
    buffer_atomic_or_x2 v[18:19], v246, s[36:39], s7 offen offset:512 sc0 sc1
    s_sub_u32 s90, s90, 1
    s_cbranch_scc0 L_pa
    s_waitcnt vmcnt(0)
L_pa_d0:
    v_lshlrev_b32 v32, 16, v8
    v_and_b32 v33, 0xffff0000, v8
    v_lshlrev_b32 v34, 16, v9
    v_and_b32 v35, 0xffff0000, v9
    v_lshlrev_b32 v36, 16, v10
    v_and_b32 v37, 0xffff0000, v10
    v_lshlrev_b32 v38, 16, v11
    v_and_b32 v39, 0xffff0000, v11
    s_branch L_pa_x
L_pa_d1:
    v_lshlrev_b32 v32, 16, v12
    v_and_b32 v33, 0xffff0000, v12
    v_lshlrev_b32 v34, 16, v13
    v_and_b32 v35, 0xffff0000, v13
    v_lshlrev_b32 v36, 16, v14
    v_and_b32 v37, 0xffff0000, v14
    v_lshlrev_b32 v38, 16, v15
    v_and_b32 v39, 0xffff0000, v15
    s_branch L_pa_x
L_pa_d2:
    v_lshlrev_b32 v32, 16, v16
    v_and_b32 v33, 0xffff0000, v16
    v_lshlrev_b32 v34, 16, v17
    v_and_b32 v35, 0xffff0000, v17
    v_lshlrev_b32 v36, 16, v18
    v_and_b32 v37, 0xffff0000, v18
    v_lshlrev_b32 v38, 16, v19
    v_and_b32 v39, 0xffff0000, v19
L_pa_x:
    v_pk_add_f32 v[32:33], v[32:33], v[36:37]
    v_pk_add_f32 v[34:35], v[34:35], v[38:39]
    s_nop 0
    v_permlane32_swap_b32 v32, v33
    v_permlane32_swap_b32 v34, v35
    v_add_f32 v32, v32, v33
    v_add_f32 v34, v34, v35
    s_nop 1
    v_permlane16_swap_b32 v32, v34
    v_add_f32 v32, v32, v34
    ds_write_b32 v108, v32
    s_waitcnt lgkmcnt(0)
L_fin5:
    s_barrier
    s_cmp_lg_u32 s3, 0
    s_cbranch_scc1 L_fin7
    ds_read_b128 v[64:67], v111 offset:43264
    ds_read_b128 v[68:71], v111 offset:43520
    ds_read_b128 v[72:75], v111 offset:43776
    ds_read_b128 v[76:79], v111 offset:44032
    ds_read_b128 v[80:83], v111 offset:44288
    ds_read_b128 v[84:87], v111 offset:44544
    ds_read_b128 v[88:91], v111 offset:44800
    s_and_b32 s61, s99, 3
    s_lshl_b32 s61, s61, 2
    s_waitcnt lgkmcnt(0)
    v_pk_add_f32 v[68:69], v[68:69], v[72:73]
    v_pk_add_f32 v[70:71], v[70:71], v[74:75]
    v_pk_add_f32 v[76:77], v[76:77], v[80:81]
    v_pk_add_f32 v[78:79], v[78:79], v[82:83]
    v_pk_add_f32 v[84:85], v[84:85], v[88:89]
    v_pk_add_f32 v[86:87], v[86:87], v[90:91]
    v_pk_add_f32 v[64:65], v[64:65], v[68:69]
    v_pk_add_f32 v[76:77], v[76:77], v[84:85]
    v_pk_add_f32 v[66:67], v[66:67], v[70:71]
    v_pk_add_f32 v[78:79], v[78:79], v[86:87]
    v_pk_add_f32 v[64:65], v[64:65], v[76:77]
    v_pk_add_f32 v[66:67], v[66:67], v[78:79]
    v_pk_fma_f32 v[64:65], v[64:65], v[38:39], v[232:233] op_sel_hi:[1,0,1]
    v_pk_fma_f32 v[66:67], v[66:67], v[38:39], v[234:235] op_sel_hi:[1,0,1]
    v_cvt_pk_bf16_f32 v16, v64, v65
    v_cvt_pk_bf16_f32 v17, v66, v67
    buffer_store_dwordx2 v[16:17], v4, s[40:43], s12 offen sc1
    s_cmp_lg_u32 s99, 0
    s_cbranch_scc1 L_fin7
    s_mov_b64 exec, 1
    v_mov_b32 v20, 0
    v_mov_b32 v21, s59
    buffer_store_dword v21, v20, s[36:39], 0 offen sc1
L_fin7:
    s_endpgm
L_end:
    s_endpgm
.p2align 7
.type L_tab,@object
L_tab:
.long 0x3f80, 0x3f80, 0x3f80, 0x3f80, 0x3f80, 0x3ec43f6d, 0x3f353f35, 0x3f6d3ec4
.long 0x3f80, 0x3f353f35, 0x3f800000, 0x3f35bf35, 0x3f80, 0x3f6d3ec4, 0x3f35bf35, 0xbec4bf6d
.long 0x3f80, 0x3f800000, 0xbf80, 0xbf800000, 0x3f80, 0x3f6dbec4, 0xbf35bf35, 0xbec43f6d
.long 0x3f80, 0x3f35bf35, 0xbf800000, 0x3f353f35, 0x3f80, 0x3ec4bf6d, 0xbf353f35, 0x3f6dbec4
.long 0x3f80, 0xbf80, 0x3f80, 0xbf80, 0x3f80, 0xbec4bf6d, 0x3f353f35, 0xbf6dbec4
.long 0x3f80, 0xbf35bf35, 0x3f800000, 0xbf353f35, 0x3f80, 0xbf6dbec4, 0x3f35bf35, 0x3ec43f6d
.long 0x3f80, 0xbf800000, 0xbf80, 0x3f800000, 0x3f80, 0xbf6d3ec4, 0xbf35bf35, 0x3ec4bf6d
.long 0x3f80, 0xbf353f35, 0xbf800000, 0xbf35bf35, 0x3f80, 0xbec43f6d, 0xbf353f35, 0xbf6d3ec4
.long 0x3f80, 0x3f80, 0x3f80, 0x3f80, 0x3f800000, 0x3f6dbec4, 0x3f35bf35, 0x3ec4bf6d
.long 0xbf80, 0xbf35bf35, 0xbf800000, 0xbf353f35, 0xbf800000, 0xbec43f6d, 0x3f353f35, 0x3f6dbec4
.long 0x3f80, 0x3f800000, 0xbf80, 0xbf800000, 0x3f800000, 0xbec4bf6d, 0xbf353f35, 0x3f6d3ec4
.long 0xbf80, 0xbf353f35, 0x3f800000, 0xbf35bf35, 0xbf800000, 0x3f6d3ec4, 0xbf35bf35, 0x3ec43f6d
.long 0x3f80, 0xbf80, 0x3f80, 0xbf80, 0x3f800000, 0xbf6d3ec4, 0x3f35bf35, 0xbec43f6d
.long 0xbf80, 0x3f353f35, 0xbf800000, 0x3f35bf35, 0xbf800000, 0x3ec4bf6d, 0x3f353f35, 0xbf6d3ec4
.long 0x3f80, 0xbf800000, 0xbf80, 0x3f800000, 0x3f800000, 0x3ec43f6d, 0xbf353f35, 0xbf6dbec4
.long 0xbf80, 0x3f35bf35, 0x3f800000, 0x3f353f35, 0xbf800000, 0xbf6dbec4, 0xbf35bf35, 0xbec4bf6d
.long 0x3f80, 0x3f80, 0x3f80, 0x3f80, 0xbf80, 0xbec4bf6d, 0xbf35bf35, 0xbf6dbec4
.long 0x3f80, 0x3f353f35, 0x3f800000, 0x3f35bf35, 0xbf80, 0xbf6dbec4, 0xbf353f35, 0x3ec43f6d
.long 0x3f80, 0x3f800000, 0xbf80, 0xbf800000, 0xbf80, 0xbf6d3ec4, 0x3f353f35, 0x3ec4bf6d
.long 0x3f80, 0x3f35bf35, 0xbf800000, 0x3f353f35, 0xbf80, 0xbec43f6d, 0x3f35bf35, 0xbf6d3ec4
.long 0x3f80, 0xbf80, 0x3f80, 0xbf80, 0xbf80, 0x3ec43f6d, 0xbf35bf35, 0x3f6d3ec4
.long 0x3f80, 0xbf35bf35, 0x3f800000, 0xbf353f35, 0xbf80, 0x3f6d3ec4, 0xbf353f35, 0xbec4bf6d
.long 0x3f80, 0xbf800000, 0xbf80, 0x3f800000, 0xbf80, 0x3f6dbec4, 0x3f353f35, 0xbec43f6d
.long 0x3f80, 0xbf353f35, 0xbf800000, 0xbf35bf35, 0xbf80, 0x3ec4bf6d, 0x3f35bf35, 0x3f6dbec4
.long 0x3f80, 0x3f80, 0x3f80, 0x3f80, 0xbf800000, 0xbf6d3ec4, 0xbf353f35, 0xbec43f6d
.long 0xbf80, 0xbf35bf35, 0xbf800000, 0xbf353f35, 0x3f800000, 0x3ec4bf6d, 0xbf35bf35, 0xbf6d3ec4
.long 0x3f80, 0x3f800000, 0xbf80, 0xbf800000, 0xbf800000, 0x3ec43f6d, 0x3f35bf35, 0xbf6dbec4
.long 0xbf80, 0xbf353f35, 0x3f800000, 0xbf35bf35, 0x3f800000, 0xbf6dbec4, 0x3f353f35, 0xbec4bf6d
.long 0x3f80, 0xbf80, 0x3f80, 0xbf80, 0xbf800000, 0x3f6dbec4, 0xbf353f35, 0x3ec4bf6d
.long 0xbf80, 0x3f353f35, 0xbf800000, 0x3f35bf35, 0x3f800000, 0xbec43f6d, 0xbf35bf35, 0x3f6dbec4
.long 0x3f80, 0xbf800000, 0xbf80, 0x3f800000, 0xbf800000, 0xbec4bf6d, 0x3f35bf35, 0x3f6d3ec4
.long 0xbf80, 0x3f35bf35, 0x3f800000, 0x3f353f35, 0x3f800000, 0x3f6d3ec4, 0x3f353f35, 0x3ec43f6d
.long 0x3f808000, 0x3f808000, 0x3f808000, 0x3f808000, 0x3f808000, 0x3f6dbec4, 0x3f35bf35, 0x3ec4bf6d
.long 0x3f808000, 0x3f35bf35, 0xbf80, 0xbf35bf35, 0x3f808000, 0x3ec4bf6d, 0xbf35bf35, 0xbf6d3ec4
.long 0x3f808000, 0xbf80, 0xbf808000, 0x3f80, 0x3f808000, 0xbec4bf6d, 0xbf353f35, 0x3f6d3ec4
.long 0x3f808000, 0xbf35bf35, 0x3f80, 0x3f35bf35, 0x3f808000, 0xbf6dbec4, 0x3f353f35, 0xbec4bf6d
.long 0x3f808000, 0xbf808000, 0x3f808000, 0xbf808000, 0x3f808000, 0xbf6d3ec4, 0x3f35bf35, 0xbec43f6d
.long 0x3f808000, 0xbf353f35, 0xbf80, 0x3f353f35, 0x3f808000, 0xbec43f6d, 0xbf35bf35, 0x3f6dbec4
.long 0x3f808000, 0x3f80, 0xbf808000, 0xbf80, 0x3f808000, 0x3ec43f6d, 0xbf353f35, 0xbf6dbec4
.long 0x3f808000, 0x3f353f35, 0x3f80, 0xbf353f35, 0x3f808000, 0x3f6d3ec4, 0x3f353f35, 0x3ec43f6d
.long 0x3f808000, 0x3f808000, 0x3f808000, 0x3f808000, 0xbf80, 0xbec4bf6d, 0xbf35bf35, 0xbf6dbec4
.long 0xbf808000, 0xbf353f35, 0x3f80, 0x3f353f35, 0x3f80, 0x3f6d3ec4, 0x3f35bf35, 0xbec4bf6d
.long 0x3f808000, 0xbf80, 0xbf808000, 0x3f80, 0xbf80, 0xbf6d3ec4, 0x3f353f35, 0x3ec4bf6d
.long 0xbf808000, 0x3f353f35, 0xbf80, 0xbf353f35, 0x3f80, 0x3ec4bf6d, 0xbf353f35, 0x3f6dbec4
.long 0x3f808000, 0xbf808000, 0x3f808000, 0xbf808000, 0xbf80, 0x3ec43f6d, 0xbf35bf35, 0x3f6d3ec4
.long 0xbf808000, 0x3f35bf35, 0x3f80, 0xbf35bf35, 0x3f80, 0xbf6dbec4, 0x3f35bf35, 0x3ec43f6d
.long 0x3f808000, 0x3f80, 0xbf808000, 0xbf80, 0xbf80, 0x3f6dbec4, 0x3f353f35, 0xbec43f6d
.long 0xbf808000, 0xbf35bf35, 0xbf80, 0x3f35bf35, 0x3f80, 0xbec43f6d, 0xbf353f35, 0xbf6d3ec4
.long 0x3f808000, 0x3f808000, 0x3f808000, 0x3f808000, 0xbf808000, 0xbf6d3ec4, 0xbf353f35, 0xbec43f6d
.long 0x3f808000, 0x3f35bf35, 0xbf80, 0xbf35bf35, 0xbf808000, 0xbec43f6d, 0x3f353f35, 0x3f6dbec4
.long 0x3f808000, 0xbf80, 0xbf808000, 0x3f80, 0xbf808000, 0x3ec43f6d, 0x3f35bf35, 0xbf6dbec4
.long 0x3f808000, 0xbf35bf35, 0x3f80, 0x3f35bf35, 0xbf808000, 0x3f6d3ec4, 0xbf35bf35, 0x3ec43f6d
.long 0x3f808000, 0xbf808000, 0x3f808000, 0xbf808000, 0xbf808000, 0x3f6dbec4, 0xbf353f35, 0x3ec4bf6d
.long 0x3f808000, 0xbf353f35, 0xbf80, 0x3f353f35, 0xbf808000, 0x3ec4bf6d, 0x3f353f35, 0xbf6d3ec4
.long 0x3f808000, 0x3f80, 0xbf808000, 0xbf80, 0xbf808000, 0xbec4bf6d, 0x3f35bf35, 0x3f6d3ec4
.long 0x3f808000, 0x3f353f35, 0x3f80, 0xbf353f35, 0xbf808000, 0xbf6dbec4, 0xbf35bf35, 0xbec4bf6d
.long 0x3f808000, 0x3f808000, 0x3f808000, 0x3f808000, 0x3f80, 0x3ec43f6d, 0x3f353f35, 0x3f6d3ec4
.long 0xbf808000, 0xbf353f35, 0x3f80, 0x3f353f35, 0xbf80, 0xbf6dbec4, 0xbf353f35, 0x3ec43f6d
.long 0x3f808000, 0xbf80, 0xbf808000, 0x3f80, 0x3f80, 0x3f6dbec4, 0xbf35bf35, 0xbec43f6d
.long 0xbf808000, 0x3f353f35, 0xbf80, 0xbf353f35, 0xbf80, 0xbec43f6d, 0x3f35bf35, 0xbf6d3ec4
.long 0x3f808000, 0xbf808000, 0x3f808000, 0xbf808000, 0x3f80, 0xbec4bf6d, 0x3f353f35, 0xbf6dbec4
.long 0xbf808000, 0x3f35bf35, 0x3f80, 0xbf35bf35, 0xbf80, 0x3f6d3ec4, 0xbf353f35, 0xbec4bf6d
.long 0x3f808000, 0x3f80, 0xbf808000, 0xbf80, 0x3f80, 0xbf6d3ec4, 0xbf35bf35, 0x3ec4bf6d
.long 0xbf808000, 0xbf35bf35, 0xbf80, 0x3f35bf35, 0xbf80, 0x3ec4bf6d, 0x3f35bf35, 0x3f6dbec4
.long 0x3f800000, 0x3f800000, 0x3f800000, 0x3f800000, 0x3f800000, 0x3f7fec43, 0x3f7fb10f, 0x3f7f4e6d
.long 0x3f800000, 0x3f7fb10f, 0x3f7ec46d, 0x3f7d3aac, 0x3f800000, 0x3f7f4e6d, 0x3f7d3aac, 0x3f79c79d
.long 0x3f800000, 0x3f7ec46d, 0x3f7b14be, 0x3f74fa0b, 0x3f800000, 0x3f7e1324, 0x3f7853f8, 0x3f6ed89e
.long 0x3f800000, 0x3f7d3aac, 0x3f74fa0b, 0x3f676bd8, 0x3f800000, 0x3f7c3b28, 0x3f710908, 0x3f5ebe05
.long 0x3f800000, 0x3f7b14be, 0x3f6c835e, 0x3f54db31, 0x3f800000, 0x3f79c79d, 0x3f676bd8, 0x3f49d112
.long 0x3f800000, 0x3f7853f8, 0x3f61c598, 0x3f3daef9, 0x3f800000, 0x3f76ba07, 0x3f5b941a, 0x3f3085bb
.long 0x3f800000, 0x3f74fa0b, 0x3f54db31, 0x3f226799, 0x3f800000, 0x3f731447, 0x3f4d9f02, 0x3f13682a
.long 0x3f800000, 0x3f710908, 0x3f45e403, 0x3f039c3d, 0x3f800000, 0x3f6ed89e, 0x3f3daef9, 0x3ee63375
.long 0x3f800000, 0x3f800000, 0x3f800000, 0x3f800000, 0x3f7ec46d, 0x3f7e1324, 0x3f7d3aac, 0x3f7c3b28
.long 0x3f7b14be, 0x3f7853f8, 0x3f74fa0b, 0x3f710908, 0x3f74fa0b, 0x3f6ed89e, 0x3f676bd8, 0x3f5ebe05
.long 0x3f6c835e, 0x3f61c598, 0x3f54db31, 0x3f45e403, 0x3f61c598, 0x3f514d3d, 0x3f3daef9, 0x3f273656
.long 0x3f54db31, 0x3f3daef9, 0x3f226799, 0x3f039c3d, 0x3f45e403, 0x3f273656, 0x3f039c3d, 0x3eb8442a
.long 0x3f3504f3, 0x3f0e39da, 0x3ec3ef15, 0x3e47c5c2, 0x3f226799, 0x3ee63375, 0x3e78cfcc, 0x3cc90ab0
.long 0x3f0e39da, 0x3eac7cd4, 0x3dc8bd36, 0xbe164083, 0x3ef15aea, 0x3e605c13, 0xbd48fb30, 0xbea09ae5
.long 0x3ec3ef15, 0x3dc8bd36, 0xbe47c5c2, 0xbef15aea, 0x3e94a031, 0xbcc90ab0, 0xbeac7cd4, 0xbf1d7fd1
.long 0x3e47c5c2, 0xbe164083, 0xbef15aea, 0xbf3daef9, 0x3dc8bd36, 0xbe888e93, 0xbf187fc0, 0xbf584853
.long 0x3f800000, 0x3f800000, 0x3f800000, 0x3f800000, 0x3f7b14be, 0x3f79c79d, 0x3f7853f8, 0x3f76ba07
.long 0x3f6c835e, 0x3f676bd8, 0x3f61c598, 0x3f5b941a, 0x3f54db31, 0x3f49d112, 0x3f3daef9, 0x3f3085bb
.long 0x3f3504f3, 0x3f226799, 0x3f0e39da, 0x3ef15aea, 0x3f0e39da, 0x3ee63375, 0x3eac7cd4, 0x3e605c13
.long 0x3ec3ef15, 0x3e78cfcc, 0x3dc8bd36, 0xbd48fb30, 0x3e47c5c2, 0x3cc90ab0, 0xbe164083, 0xbea09ae5
.long 0x0, 0xbe47c5c2, 0xbec3ef15, 0xbf0e39da, 0xbe47c5c2, 0xbecf7bca, 0xbf187fc0, 0xbf41d870
.long 0xbec3ef15, 0xbf187fc0, 0xbf45e403, 0xbf676bd8, 0xbf0e39da, 0xbf41d870, 0xbf676bd8, 0xbf7c3b28
.long 0xbf3504f3, 0xbf61c598, 0xbf7b14be, 0xbf7ec46d, 0xbf54db31, 0xbf76ba07, 0xbf7fb10f, 0xbf6ed89e
.long 0xbf6c835e, 0xbf7fb10f, 0xbf74fa0b, 0xbf4d9f02, 0xbf7b14be, 0xbf7c3b28, 0xbf5b941a, 0xbf1d7fd1
.long 0x3f800000, 0x3f800000, 0x3f800000, 0x3f800000, 0x3f74fa0b, 0x3f731447, 0x3f710908, 0x3f6ed89e
.long 0x3f54db31, 0x3f4d9f02, 0x3f45e403, 0x3f3daef9, 0x3f226799, 0x3f13682a, 0x3f039c3d, 0x3ee63375
.long 0x3ec3ef15, 0x3e94a031, 0x3e47c5c2, 0x3dc8bd36, 0x3dc8bd36, 0xbcc90ab0, 0xbe164083, 0xbe888e93
.long 0xbe47c5c2, 0xbeac7cd4, 0xbef15aea, 0xbf187fc0, 0xbef15aea, 0xbf1d7fd1, 0xbf3daef9, 0xbf584853
.long 0xbf3504f3, 0xbf54db31, 0xbf6c835e, 0xbf7b14be, 0xbf61c598, 0xbf76ba07, 0xbf7fb10f, 0xbf7c3b28
.long 0xbf7b14be, 0xbf7fb10f, 0xbf74fa0b, 0xbf5b941a, 0xbf7ec46d, 0xbf6ed89e, 0xbf4d9f02, 0xbf1d7fd1
.long 0xbf6c835e, 0xbf45e403, 0xbf0e39da, 0xbe94a031, 0xbf45e403, 0xbf08f59b, 0xbe78cfcc, 0x3d96a905
.long 0xbf0e39da, 0xbe78cfcc, 0x3dc8bd36, 0x3edae880, 0xbe94a031, 0x3d96a905, 0x3edae880, 0x3f396842
.long 0x0, 0x0, 0x0, 0x0, 0x0, 0x3cc90ab0, 0x3d48fb30, 0x3d96a905
.long 0x0, 0x3d48fb30, 0x3dc8bd36, 0x3e164083, 0x0, 0x3d96a905, 0x3e164083, 0x3e605c13
.long 0x0, 0x3dc8bd36, 0x3e47c5c2, 0x3e94a031, 0x0, 0x3dfab273, 0x3e78cfcc, 0x3eb8442a
.long 0x0, 0x3e164083, 0x3e94a031, 0x3edae880, 0x0, 0x3e2f10a2, 0x3eac7cd4, 0x3efc5d27
.long 0x0, 0x3e47c5c2, 0x3ec3ef15, 0x3f0e39da, 0x0, 0x3e605c13, 0x3edae880, 0x3f1d7fd1
.long 0x0, 0x3e78cfcc, 0x3ef15aea, 0x3f2beb4a, 0x0, 0x3e888e93, 0x3f039c3d, 0x3f396842
.long 0x0, 0x3e94a031, 0x3f0e39da, 0x3f45e403, 0x0, 0x3ea09ae5, 0x3f187fc0, 0x3f514d3d
.long 0x0, 0x3eac7cd4, 0x3f226799, 0x3f5b941a, 0x0, 0x3eb8442a, 0x3f2beb4a, 0x3f64aa59
.long 0x0, 0x0, 0x0, 0x0, 0x3dc8bd36, 0x3dfab273, 0x3e164083, 0x3e2f10a2
.long 0x3e47c5c2, 0x3e78cfcc, 0x3e94a031, 0x3eac7cd4, 0x3e94a031, 0x3eb8442a, 0x3edae880, 0x3efc5d27
.long 0x3ec3ef15, 0x3ef15aea, 0x3f0e39da, 0x3f226799, 0x3ef15aea, 0x3f13682a, 0x3f2beb4a, 0x3f41d870
.long 0x3f0e39da, 0x3f2beb4a, 0x3f45e403, 0x3f5b941a, 0x3f226799, 0x3f41d870, 0x3f5b941a, 0x3f6ed89e
.long 0x3f3504f3, 0x3f54db31, 0x3f6c835e, 0x3f7b14be, 0x3f45e403, 0x3f64aa59, 0x3f7853f8, 0x3f7fec43
.long 0x3f54db31, 0x3f710908, 0x3f7ec46d, 0x3f7d3aac, 0x3f61c598, 0x3f79c79d, 0x3f7fb10f, 0x3f731447
.long 0x3f6c835e, 0x3f7ec46d, 0x3f7b14be, 0x3f61c598, 0x3f74fa0b, 0x3f7fec43, 0x3f710908, 0x3f49d112
.long 0x3f7b14be, 0x3f7d3aac, 0x3f61c598, 0x3f2beb4a, 0x3f7ec46d, 0x3f76ba07, 0x3f4d9f02, 0x3f08f59b
.long 0x0, 0x0, 0x0, 0x0, 0x3e47c5c2, 0x3e605c13, 0x3e78cfcc, 0x3e888e93
.long 0x3ec3ef15, 0x3edae880, 0x3ef15aea, 0x3f039c3d, 0x3f0e39da, 0x3f1d7fd1, 0x3f2beb4a, 0x3f396842
.long 0x3f3504f3, 0x3f45e403, 0x3f54db31, 0x3f61c598, 0x3f54db31, 0x3f64aa59, 0x3f710908, 0x3f79c79d
.long 0x3f6c835e, 0x3f7853f8, 0x3f7ec46d, 0x3f7fb10f, 0x3f7b14be, 0x3f7fec43, 0x3f7d3aac, 0x3f731447
.long 0x3f800000, 0x3f7b14be, 0x3f6c835e, 0x3f54db31, 0x3f7b14be, 0x3f6a09a7, 0x3f4d9f02, 0x3f273656
.long 0x3f6c835e, 0x3f4d9f02, 0x3f226799, 0x3edae880, 0x3f54db31, 0x3f273656, 0x3edae880, 0x3e2f10a2
.long 0x3f3504f3, 0x3ef15aea, 0x3e47c5c2, 0xbdc8bd36, 0x3f0e39da, 0x3e888e93, 0xbd48fb30, 0xbeb8442a
.long 0x3ec3ef15, 0x3d48fb30, 0xbe94a031, 0xbf187fc0, 0x3e47c5c2, 0xbe2f10a2, 0xbf039c3d, 0xbf49d112
.long 0x0, 0x0, 0x0, 0x0, 0x3e94a031, 0x3ea09ae5, 0x3eac7cd4, 0x3eb8442a
.long 0x3f0e39da, 0x3f187fc0, 0x3f226799, 0x3f2beb4a, 0x3f45e403, 0x3f514d3d, 0x3f5b941a, 0x3f64aa59
.long 0x3f6c835e, 0x3f74fa0b, 0x3f7b14be, 0x3f7ec46d, 0x3f7ec46d, 0x3f7fec43, 0x3f7d3aac, 0x3f76ba07
.long 0x3f7b14be, 0x3f710908, 0x3f61c598, 0x3f4d9f02, 0x3f61c598, 0x3f49d112, 0x3f2beb4a, 0x3f08f59b
.long 0x3f3504f3, 0x3f0e39da, 0x3ec3ef15, 0x3e47c5c2, 0x3ef15aea, 0x3e888e93, 0x3d48fb30, 0xbe2f10a2
.long 0x3e47c5c2, 0xbd48fb30, 0xbe94a031, 0xbf039c3d, 0xbdc8bd36, 0xbeb8442a, 0xbf187fc0, 0xbf49d112
.long 0xbec3ef15, 0xbf226799, 0xbf54db31, 0xbf74fa0b, 0xbf226799, 0xbf584853, 0xbf7853f8, 0xbf7f4e6d
.long 0xbf54db31, 0xbf7853f8, 0xbf7ec46d, 0xbf676bd8, 0xbf74fa0b, 0xbf7f4e6d, 0xbf676bd8, 0xbf3085bb
.long 0x3f800000, 0x3f800000, 0x3f800000, 0x3f800000, 0x3f7ffb11, 0x3f7fd397, 0x3f7f84ab, 0x3f7f0e58
.long 0x3f7fec43, 0x3f7f4e6d, 0x3f7e1324, 0x3f7c3b28, 0x3f7fd397, 0x3f7e70b0, 0x3f7baccd, 0x3f778bc5
.long 0x3f7fb10f, 0x3f7d3aac, 0x3f7853f8, 0x3f710908, 0x3f7f84ab, 0x3f7baccd, 0x3f740bdd, 0x3f68bf3c
.long 0x3f7f4e6d, 0x3f79c79d, 0x3f6ed89e, 0x3f5ebe05, 0x3f7f0e58, 0x3f778bc5, 0x3f68bf3c, 0x3f531849
.long 0x3f7ec46d, 0x3f74fa0b, 0x3f61c598, 0x3f45e403, 0x3f7e70b0, 0x3f721352, 0x3f59f26a, 0x3f373a23
.long 0x3f7e1324, 0x3f6ed89e, 0x3f514d3d, 0x3f273656, 0x3f7dabcc, 0x3f6b4b0c, 0x3f47de65, 0x3f15f6d9
.long 0x3f7d3aac, 0x3f676bd8, 0x3f3daef9, 0x3f039c3d, 0x3f7cbfc9, 0x3f633c5a, 0x3f32c8c9, 0x3ee0924f
.long 0x3f7c3b28, 0x3f5ebe05, 0x3f273656, 0x3eb8442a, 0x3f7baccd, 0x3f59f26a, 0x3f1b02c6, 0x3e8e9a22
.long 0x3f800000, 0x3f800000, 0x3f800000, 0x3f800000, 0x3f7e70b0, 0x3f7dabcc, 0x3f7cbfc9, 0x3f7baccd
.long 0x3f79c79d, 0x3f76ba07, 0x3f731447, 0x3f6ed89e, 0x3f721352, 0x3f6b4b0c, 0x3f633c5a, 0x3f59f26a
.long 0x3f676bd8, 0x3f5b941a, 0x3f4d9f02, 0x3f3daef9, 0x3f59f26a, 0x3f47de65, 0x3f32c8c9, 0x3f1b02c6
.long 0x3f49d112, 0x3f3085bb, 0x3f13682a, 0x3ee63375, 0x3f373a23, 0x3f15f6d9, 0x3ee0924f, 0x3e8e9a22
.long 0x3f226799, 0x3ef15aea, 0x3e94a031, 0x3dc8bd36, 0x3f0b9a6b, 0x3eb263ef, 0x3e09cf86, 0xbdafb680
.long 0x3ee63375, 0x3e605c13, 0xbcc90ab0, 0xbe888e93, 0x3eb263ef, 0x3dafb680, 0xbe3b6ecf, 0xbee0924f
.long 0x3e78cfcc, 0xbd48fb30, 0xbeac7cd4, 0xbf187fc0, 0x3e09cf86, 0xbe3b6ecf, 0xbef6e0cb, 0xbf3b8f3b
.long 0x3cc90ab0, 0xbea09ae5, 0xbf1d7fd1, 0xbf584853, 0xbdafb680, 0xbee0924f, 0xbf3b8f3b, 0xbf6db293
.long 0x3f800000, 0x3f800000, 0x3f800000, 0x3f800000, 0x3f7a7302, 0x3f791298, 0x3f778bc5, 0x3f75dec6
.long 0x3f6a09a7, 0x3f64aa59, 0x3f5ebe05, 0x3f584853, 0x3f4f7a1f, 0x3f43e200, 0x3f373a23, 0x3f299415
.long 0x3f2beb4a, 0x3f187fc0, 0x3f039c3d, 0x3edae880, 0x3f00e7e4, 0x3ec9b953, 0x3e8e9a22, 0x3e22abb6
.long 0x3ea09ae5, 0x3e2f10a2, 0x3cc90ab0, 0xbdfab273, 0x3de1bc2e, 0xbd7b2b74, 0xbe6c9a7f, 0xbec9b953
.long 0xbdc8bd36, 0xbe94a031, 0xbef15aea, 0xbf226799, 0xbe9aa086, 0xbf00e7e4, 0xbf2e3bde, 0xbf531849
.long 0xbefc5d27, 0xbf3085bb, 0xbf584853, 0xbf731447, 0xbf299415, 0xbf5695e5, 0xbf740bdd, 0xbf7fd397
.long 0xbf4d9f02, 0xbf710908, 0xbf7fb10f, 0xbf7853f8, 0xbf68bf3c, 0xbf7e70b0, 0xbf7a7302, 0xbf5d2d53
.long 0xbf79c79d, 0xbf7e1324, 0xbf64aa59, 0xbf3085bb, 0xbf7ffb11, 0xbf6ff573, 0xbf3fc767, 0xbeebcbbb
.long 0x3f800000, 0x3f800000, 0x3f800000, 0x3f800000, 0x3f740bdd, 0x3f721352, 0x3f6ff573, 0x3f6db293
.long 0x3f514d3d, 0x3f49d112, 0x3f41d870, 0x3f396842, 0x3f1b02c6, 0x3f0b9a6b, 0x3ef6e0cb, 0x3ed53641
.long 0x3eac7cd4, 0x3e78cfcc, 0x3e164083, 0x3d48fb30, 0x3d16c32c, 0xbdafb680, 0xbe541501, 0xbea68f12
.long 0xbe888e93, 0xbecf7bca, 0xbf08f59b, 0xbf273656, 0xbf0b9a6b, 0xbf2e3bde, 0xbf4bbbf8, 0xbf633c5a
.long 0xbf45e403, 0xbf61c598, 0xbf74fa0b, 0xbf7ec46d, 0xbf6db293, 0xbf7cbfc9, 0xbf7f84ab, 0xbf75dec6
.long 0xbf7f4e6d, 0xbf7c3b28, 0xbf6a09a7, 0xbf49d112, 0xbf791298, 0xbf604621, 0xbf373a23, 0xbf00e7e4
.long 0xbf5b941a, 0xbf2beb4a, 0xbedae880, 0xbe164083, 0xbf299415, 0xbec9b953, 0xbdafb680, 0x3e6c9a7f
.long 0xbecf7bca, 0xbd96a905, 0x3e888e93, 0x3f13682a, 0xbde1bc2e, 0x3e827dc0, 0x3f15f6d9, 0x3f5695e5
.long 0x0, 0x0, 0x0, 0x0, 0x3c490e90, 0x3d16c32c, 0x3d7b2b74, 0x3dafb680
.long 0x3cc90ab0, 0x3d96a905, 0x3dfab273, 0x3e2f10a2, 0x3d16c32c, 0x3de1bc2e, 0x3e3b6ecf, 0x3e827dc0
.long 0x3d48fb30, 0x3e164083, 0x3e78cfcc, 0x3eac7cd4, 0x3d7b2b74, 0x3e3b6ecf, 0x3e9aa086, 0x3ed53641
.long 0x3d96a905, 0x3e605c13, 0x3eb8442a, 0x3efc5d27, 0x3dafb680, 0x3e827dc0, 0x3ed53641, 0x3f10d3cd
.long 0x3dc8bd36, 0x3e94a031, 0x3ef15aea, 0x3f226799, 0x3de1bc2e, 0x3ea68f12, 0x3f064b82, 0x3f32c8c9
.long 0x3dfab273, 0x3eb8442a, 0x3f13682a, 0x3f41d870, 0x3e09cf86, 0x3ec9b953, 0x3f1ff6cb, 0x3f4f7a1f
.long 0x3e164083, 0x3edae880, 0x3f2beb4a, 0x3f5b941a, 0x3e22abb6, 0x3eebcbbb, 0x3f373a23, 0x3f660f88
.long 0x3e2f10a2, 0x3efc5d27, 0x3f41d870, 0x3f6ed89e, 0x3e3b6ecf, 0x3f064b82, 0x3f4bbbf8, 0x3f75dec6
.long 0x0, 0x0, 0x0, 0x0, 0x3de1bc2e, 0x3e09cf86, 0x3e22abb6, 0x3e3b6ecf
.long 0x3e605c13, 0x3e888e93, 0x3ea09ae5, 0x3eb8442a, 0x3ea68f12, 0x3ec9b953, 0x3eebcbbb, 0x3f064b82
.long 0x3edae880, 0x3f039c3d, 0x3f187fc0, 0x3f2beb4a, 0x3f064b82, 0x3f1ff6cb, 0x3f373a23, 0x3f4bbbf8
.long 0x3f1d7fd1, 0x3f396842, 0x3f514d3d, 0x3f64aa59, 0x3f32c8c9, 0x3f4f7a1f, 0x3f660f88, 0x3f75dec6
.long 0x3f45e403, 0x3f61c598, 0x3f74fa0b, 0x3f7ec46d, 0x3f5695e5, 0x3f6ff573, 0x3f7dabcc, 0x3f7f0e58
.long 0x3f64aa59, 0x3f79c79d, 0x3f7fec43, 0x3f76ba07, 0x3f6ff573, 0x3f7f0e58, 0x3f7baccd, 0x3f660f88
.long 0x3f7853f8, 0x3f7fb10f, 0x3f710908, 0x3f4d9f02, 0x3f7dabcc, 0x3f7baccd, 0x3f604621, 0x3f2e3bde
.long 0x3f7fec43, 0x3f731447, 0x3f49d112, 0x3f08f59b, 0x3f7f0e58, 0x3f660f88, 0x3f2e3bde, 0x3ebe1d4a
.long 0x0, 0x0, 0x0, 0x0, 0x3e541501, 0x3e6c9a7f, 0x3e827dc0, 0x3e8e9a22
.long 0x3ecf7bca, 0x3ee63375, 0x3efc5d27, 0x3f08f59b, 0x3f15f6d9, 0x3f24d225, 0x3f32c8c9, 0x3f3fc767
.long 0x3f3daef9, 0x3f4d9f02, 0x3f5b941a, 0x3f676bd8, 0x3f5d2d53, 0x3f6b4b0c, 0x3f75dec6, 0x3f7cbfc9
.long 0x3f731447, 0x3f7c3b28, 0x3f7fec43, 0x3f7e1324, 0x3f7e70b0, 0x3f7f84ab, 0x3f791298, 0x3f6b4b0c
.long 0x3f7ec46d, 0x3f74fa0b, 0x3f61c598, 0x3f45e403, 0x3f740bdd, 0x3f5d2d53, 0x3f3b8f3b, 0x3f10d3cd
.long 0x3f5ebe05, 0x3f396842, 0x3f08f59b, 0x3ea09ae5, 0x3f3fc767, 0x3f0b9a6b, 0x3e9aa086, 0x3d16c32c
.long 0x3f187fc0, 0x3eac7cd4, 0x3d48fb30, 0xbe78cfcc, 0x3ed53641, 0x3de1bc2e, 0xbe541501, 0xbf00e7e4
.long 0x3e605c13, 0xbdfab273, 0xbee63375, 0xbf396842, 0x3c490e90, 0xbeb263ef, 0xbf299415, 0xbf633c5a
.long 0x0, 0x0, 0x0, 0x0, 0x3e9aa086, 0x3ea68f12, 0x3eb263ef, 0x3ebe1d4a
.long 0x3f13682a, 0x3f1d7fd1, 0x3f273656, 0x3f3085bb, 0x3f4bbbf8, 0x3f5695e5, 0x3f604621, 0x3f68bf3c
.long 0x3f710908, 0x3f7853f8, 0x3f7d3aac, 0x3f7fb10f, 0x3f7fd397, 0x3f7f0e58, 0x3f7a7302, 0x3f721352
.long 0x3f76ba07, 0x3f6a09a7, 0x3f584853, 0x3f41d870, 0x3f5695e5, 0x3f3b8f3b, 0x3f1b02c6, 0x3eebcbbb
.long 0x3f226799, 0x3ef15aea, 0x3e94a031, 0x3dc8bd36, 0x3ebe1d4a, 0x3e22abb6, 0xbd7b2b74, 0xbe8e9a22
.long 0x3d96a905, 0xbe2f10a2, 0xbecf7bca, 0xbf1d7fd1, 0xbe6c9a7f, 0xbef6e0cb, 0xbf32c8c9, 0xbf5d2d53
.long 0xbf039c3d, 0xbf3daef9, 0xbf676bd8, 0xbf7d3aac, 0xbf3fc767, 0xbf6b4b0c, 0xbf7f0e58, 0xbf791298
.long 0xbf6a09a7, 0xbf7f4e6d, 0xbf76ba07, 0xbf514d3d, 0xbf7e70b0, 0xbf778bc5, 0xbf4f7a1f, 0xbf0b9a6b
.long 0x3f80, 0x3f80, 0x3f80, 0x3f80, 0x3f80, 0x3ec43f6d, 0x3f353f35, 0x3f6d3ec4
.long 0x3f80, 0x3f353f35, 0x3f800000, 0x3f35bf35, 0x3f80, 0x3f6d3ec4, 0x3f35bf35, 0xbec4bf6d
.long 0x3f80, 0x3f800000, 0xbf80, 0xbf800000, 0x3f80, 0x3f6dbec4, 0xbf35bf35, 0xbec43f6d
.long 0x3f80, 0x3f35bf35, 0xbf800000, 0x3f353f35, 0x3f80, 0x3ec4bf6d, 0xbf353f35, 0x3f6dbec4
.long 0x3f80, 0xbf80, 0x3f80, 0xbf80, 0x3f80, 0xbec4bf6d, 0x3f353f35, 0xbf6dbec4
.long 0x3f80, 0xbf35bf35, 0x3f800000, 0xbf353f35, 0x3f80, 0xbf6dbec4, 0x3f35bf35, 0x3ec43f6d
.long 0x3f80, 0xbf800000, 0xbf80, 0x3f800000, 0x3f80, 0xbf6d3ec4, 0xbf35bf35, 0x3ec4bf6d
.long 0x3f80, 0xbf353f35, 0xbf800000, 0xbf35bf35, 0x3f80, 0xbec43f6d, 0xbf353f35, 0xbf6d3ec4
.long 0x3f80, 0x3f80, 0x3f80, 0x3f80, 0x3f800000, 0x3f6dbec4, 0x3f35bf35, 0x3ec4bf6d
.long 0xbf80, 0xbf35bf35, 0xbf800000, 0xbf353f35, 0xbf800000, 0xbec43f6d, 0x3f353f35, 0x3f6dbec4
.long 0x3f80, 0x3f800000, 0xbf80, 0xbf800000, 0x3f800000, 0xbec4bf6d, 0xbf353f35, 0x3f6d3ec4
.long 0xbf80, 0xbf353f35, 0x3f800000, 0xbf35bf35, 0xbf800000, 0x3f6d3ec4, 0xbf35bf35, 0x3ec43f6d
.long 0x3f80, 0xbf80, 0x3f80, 0xbf80, 0x3f800000, 0xbf6d3ec4, 0x3f35bf35, 0xbec43f6d
.long 0xbf80, 0x3f353f35, 0xbf800000, 0x3f35bf35, 0xbf800000, 0x3ec4bf6d, 0x3f353f35, 0xbf6d3ec4
.long 0x3f80, 0xbf800000, 0xbf80, 0x3f800000, 0x3f800000, 0x3ec43f6d, 0xbf353f35, 0xbf6dbec4
.long 0xbf80, 0x3f35bf35, 0x3f800000, 0x3f353f35, 0xbf800000, 0xbf6dbec4, 0xbf35bf35, 0xbec4bf6d
.long 0x3f80, 0x3f80, 0x3f80, 0x3f80, 0xbf80, 0xbec4bf6d, 0xbf35bf35, 0xbf6dbec4
.long 0x3f80, 0x3f353f35, 0x3f800000, 0x3f35bf35, 0xbf80, 0xbf6dbec4, 0xbf353f35, 0x3ec43f6d
.long 0x3f80, 0x3f800000, 0xbf80, 0xbf800000, 0xbf80, 0xbf6d3ec4, 0x3f353f35, 0x3ec4bf6d
.long 0x3f80, 0x3f35bf35, 0xbf800000, 0x3f353f35, 0xbf80, 0xbec43f6d, 0x3f35bf35, 0xbf6d3ec4
.long 0x3f80, 0xbf80, 0x3f80, 0xbf80, 0xbf80, 0x3ec43f6d, 0xbf35bf35, 0x3f6d3ec4
.long 0x3f80, 0xbf35bf35, 0x3f800000, 0xbf353f35, 0xbf80, 0x3f6d3ec4, 0xbf353f35, 0xbec4bf6d
.long 0x3f80, 0xbf800000, 0xbf80, 0x3f800000, 0xbf80, 0x3f6dbec4, 0x3f353f35, 0xbec43f6d
.long 0x3f80, 0xbf353f35, 0xbf800000, 0xbf35bf35, 0xbf80, 0x3ec4bf6d, 0x3f35bf35, 0x3f6dbec4
.long 0x3f80, 0x3f80, 0x3f80, 0x3f80, 0xbf800000, 0xbf6d3ec4, 0xbf353f35, 0xbec43f6d
.long 0xbf80, 0xbf35bf35, 0xbf800000, 0xbf353f35, 0x3f800000, 0x3ec4bf6d, 0xbf35bf35, 0xbf6d3ec4
.long 0x3f80, 0x3f800000, 0xbf80, 0xbf800000, 0xbf800000, 0x3ec43f6d, 0x3f35bf35, 0xbf6dbec4
.long 0xbf80, 0xbf353f35, 0x3f800000, 0xbf35bf35, 0x3f800000, 0xbf6dbec4, 0x3f353f35, 0xbec4bf6d
.long 0x3f80, 0xbf80, 0x3f80, 0xbf80, 0xbf800000, 0x3f6dbec4, 0xbf353f35, 0x3ec4bf6d
.long 0xbf80, 0x3f353f35, 0xbf800000, 0x3f35bf35, 0x3f800000, 0xbec43f6d, 0xbf35bf35, 0x3f6dbec4
.long 0x3f80, 0xbf800000, 0xbf80, 0x3f800000, 0xbf800000, 0xbec4bf6d, 0x3f35bf35, 0x3f6d3ec4
.long 0xbf80, 0x3f35bf35, 0x3f800000, 0x3f353f35, 0x3f800000, 0x3f6d3ec4, 0x3f353f35, 0x3ec43f6d
.long 0x3f80, 0x3f80, 0x3f80, 0x3f80, 0x3f80, 0x3ec43f6d, 0x3f353f35, 0x3f6d3ec4
.long 0x3f80, 0x3f353f35, 0x3f800000, 0x3f35bf35, 0x3f80, 0x3f6d3ec4, 0x3f35bf35, 0xbec4bf6d
.long 0x3f80, 0x3f800000, 0xbf80, 0xbf800000, 0x3f80, 0x3f6dbec4, 0xbf35bf35, 0xbec43f6d
.long 0x3f80, 0x3f35bf35, 0xbf800000, 0x3f353f35, 0x3f80, 0x3ec4bf6d, 0xbf353f35, 0x3f6dbec4
.long 0x3f80, 0xbf80, 0x3f80, 0xbf80, 0x3f80, 0xbec4bf6d, 0x3f353f35, 0xbf6dbec4
.long 0x3f80, 0xbf35bf35, 0x3f800000, 0xbf353f35, 0x3f80, 0xbf6dbec4, 0x3f35bf35, 0x3ec43f6d
.long 0x3f80, 0xbf800000, 0xbf80, 0x3f800000, 0x3f80, 0xbf6d3ec4, 0xbf35bf35, 0x3ec4bf6d
.long 0x3f80, 0xbf353f35, 0xbf800000, 0xbf35bf35, 0x3f80, 0xbec43f6d, 0xbf353f35, 0xbf6d3ec4
.long 0x3f80, 0x3f80, 0x3f80, 0x3f80, 0x3f800000, 0x3f6dbec4, 0x3f35bf35, 0x3ec4bf6d
.long 0xbf80, 0xbf35bf35, 0xbf800000, 0xbf353f35, 0xbf800000, 0xbec43f6d, 0x3f353f35, 0x3f6dbec4
.long 0x3f80, 0x3f800000, 0xbf80, 0xbf800000, 0x3f800000, 0xbec4bf6d, 0xbf353f35, 0x3f6d3ec4
.long 0xbf80, 0xbf353f35, 0x3f800000, 0xbf35bf35, 0xbf800000, 0x3f6d3ec4, 0xbf35bf35, 0x3ec43f6d
.long 0x3f80, 0xbf80, 0x3f80, 0xbf80, 0x3f800000, 0xbf6d3ec4, 0x3f35bf35, 0xbec43f6d
.long 0xbf80, 0x3f353f35, 0xbf800000, 0x3f35bf35, 0xbf800000, 0x3ec4bf6d, 0x3f353f35, 0xbf6d3ec4
.long 0x3f80, 0xbf800000, 0xbf80, 0x3f800000, 0x3f800000, 0x3ec43f6d, 0xbf353f35, 0xbf6dbec4
.long 0xbf80, 0x3f35bf35, 0x3f800000, 0x3f353f35, 0xbf800000, 0xbf6dbec4, 0xbf35bf35, 0xbec4bf6d
.long 0x3f80, 0x3f80, 0x3f80, 0x3f80, 0xbf80, 0xbec4bf6d, 0xbf35bf35, 0xbf6dbec4
.long 0x3f80, 0x3f353f35, 0x3f800000, 0x3f35bf35, 0xbf80, 0xbf6dbec4, 0xbf353f35, 0x3ec43f6d
.long 0x3f80, 0x3f800000, 0xbf80, 0xbf800000, 0xbf80, 0xbf6d3ec4, 0x3f353f35, 0x3ec4bf6d
.long 0x3f80, 0x3f35bf35, 0xbf800000, 0x3f353f35, 0xbf80, 0xbec43f6d, 0x3f35bf35, 0xbf6d3ec4
.long 0x3f80, 0xbf80, 0x3f80, 0xbf80, 0xbf80, 0x3ec43f6d, 0xbf35bf35, 0x3f6d3ec4
.long 0x3f80, 0xbf35bf35, 0x3f800000, 0xbf353f35, 0xbf80, 0x3f6d3ec4, 0xbf353f35, 0xbec4bf6d
.long 0x3f80, 0xbf800000, 0xbf80, 0x3f800000, 0xbf80, 0x3f6dbec4, 0x3f353f35, 0xbec43f6d
.long 0x3f80, 0xbf353f35, 0xbf800000, 0xbf35bf35, 0xbf80, 0x3ec4bf6d, 0x3f35bf35, 0x3f6dbec4
.long 0x3f80, 0x3f80, 0x3f80, 0x3f80, 0xbf800000, 0xbf6d3ec4, 0xbf353f35, 0xbec43f6d
.long 0xbf80, 0xbf35bf35, 0xbf800000, 0xbf353f35, 0x3f800000, 0x3ec4bf6d, 0xbf35bf35, 0xbf6d3ec4
.long 0x3f80, 0x3f800000, 0xbf80, 0xbf800000, 0xbf800000, 0x3ec43f6d, 0x3f35bf35, 0xbf6dbec4
.long 0xbf80, 0xbf353f35, 0x3f800000, 0xbf35bf35, 0x3f800000, 0xbf6dbec4, 0x3f353f35, 0xbec4bf6d
.long 0x3f80, 0xbf80, 0x3f80, 0xbf80, 0xbf800000, 0x3f6dbec4, 0xbf353f35, 0x3ec4bf6d
.long 0xbf80, 0x3f353f35, 0xbf800000, 0x3f35bf35, 0x3f800000, 0xbec43f6d, 0xbf35bf35, 0x3f6dbec4
.long 0x3f80, 0xbf800000, 0xbf80, 0x3f800000, 0xbf800000, 0xbec4bf6d, 0x3f35bf35, 0x3f6d3ec4
.long 0xbf80, 0x3f35bf35, 0x3f800000, 0x3f353f35, 0x3f800000, 0x3f6d3ec4, 0x3f353f35, 0x3ec43f6d
.long 0x3f80, 0x3f80, 0x3f80, 0x3f80, 0x3e483f7b, 0x3f0e3f55, 0x3f553f0e, 0x3f7b3e48
.long 0x3ec43f6d, 0x3f6d3ec4, 0x3f6dbec4, 0x3ec4bf6d, 0x3f0e3f55, 0x3f7bbe48, 0x3e48bf7b, 0xbf55bf0e
.long 0x3f353f35, 0x3f35bf35, 0xbf35bf35, 0xbf353f35, 0x3f553f0e, 0x3e48bf7b, 0xbf7b3e48, 0x3f0e3f55
.long 0x3f6d3ec4, 0xbec4bf6d, 0xbec43f6d, 0x3f6dbec4, 0x3f7b3e48, 0xbf55bf0e, 0x3f0e3f55, 0xbe48bf7b
.long 0x3f800000, 0xbf800000, 0x3f800000, 0xbf800000, 0x3f7bbe48, 0xbf553f0e, 0x3f0ebf55, 0xbe483f7b
.long 0x3f6dbec4, 0xbec43f6d, 0xbec4bf6d, 0x3f6d3ec4, 0x3f55bf0e, 0x3e483f7b, 0xbf7bbe48, 0x3f0ebf55
.long 0x3f35bf35, 0x3f353f35, 0xbf353f35, 0xbf35bf35, 0x3f0ebf55, 0x3f7b3e48, 0x3e483f7b, 0xbf553f0e
.long 0x3ec4bf6d, 0x3f6dbec4, 0x3f6d3ec4, 0x3ec43f6d, 0x3e48bf7b, 0x3f0ebf55, 0x3f55bf0e, 0x3f7bbe48
.long 0x3f80, 0x3f80, 0x3f80, 0x3f80, 0x3f7bbe48, 0x3f55bf0e, 0x3f0ebf55, 0x3e48bf7b
.long 0xbec4bf6d, 0xbf6dbec4, 0xbf6d3ec4, 0xbec43f6d, 0xbf553f0e, 0x3e483f7b, 0x3f7b3e48, 0x3f0ebf55
.long 0x3f353f35, 0x3f35bf35, 0xbf35bf35, 0xbf353f35, 0x3f0ebf55, 0xbf7bbe48, 0x3e483f7b, 0x3f55bf0e
.long 0xbf6dbec4, 0x3ec43f6d, 0x3ec4bf6d, 0xbf6d3ec4, 0xbe483f7b, 0x3f0ebf55, 0xbf553f0e, 0x3f7bbe48
.long 0x3f800000, 0xbf800000, 0x3f800000, 0xbf800000, 0xbe48bf7b, 0x3f0e3f55, 0xbf55bf0e, 0x3f7b3e48
.long 0xbf6d3ec4, 0x3ec4bf6d, 0x3ec43f6d, 0xbf6dbec4, 0x3f0e3f55, 0xbf7b3e48, 0x3e48bf7b, 0x3f553f0e
.long 0x3f35bf35, 0x3f353f35, 0xbf353f35, 0xbf35bf35, 0xbf55bf0e, 0x3e48bf7b, 0x3f7bbe48, 0x3f0e3f55
.long 0xbec43f6d, 0xbf6d3ec4, 0xbf6dbec4, 0xbec4bf6d, 0x3f7b3e48, 0x3f553f0e, 0x3f0e3f55, 0x3e483f7b
.long 0x3f80, 0x3f80, 0x3f80, 0x3f80, 0xbe48bf7b, 0xbf0ebf55, 0xbf55bf0e, 0xbf7bbe48
.long 0x3ec43f6d, 0x3f6d3ec4, 0x3f6dbec4, 0x3ec4bf6d, 0xbf0ebf55, 0xbf7b3e48, 0xbe483f7b, 0x3f553f0e
.long 0x3f353f35, 0x3f35bf35, 0xbf35bf35, 0xbf353f35, 0xbf55bf0e, 0xbe483f7b, 0x3f7bbe48, 0xbf0ebf55
.long 0x3f6d3ec4, 0xbec4bf6d, 0xbec43f6d, 0x3f6dbec4, 0xbf7bbe48, 0x3f553f0e, 0xbf0ebf55, 0x3e483f7b
.long 0x3f800000, 0xbf800000, 0x3f800000, 0xbf800000, 0xbf7b3e48, 0x3f55bf0e, 0xbf0e3f55, 0x3e48bf7b
.long 0x3f6dbec4, 0xbec43f6d, 0xbec4bf6d, 0x3f6d3ec4, 0xbf553f0e, 0xbe48bf7b, 0x3f7b3e48, 0xbf0e3f55
.long 0x3f35bf35, 0x3f353f35, 0xbf353f35, 0xbf35bf35, 0xbf0e3f55, 0xbf7bbe48, 0xbe48bf7b, 0x3f55bf0e
.long 0x3ec4bf6d, 0x3f6dbec4, 0x3f6d3ec4, 0x3ec43f6d, 0xbe483f7b, 0xbf0e3f55, 0xbf553f0e, 0xbf7b3e48
.long 0x3f80, 0x3f80, 0x3f80, 0x3f80, 0xbf7b3e48, 0xbf553f0e, 0xbf0e3f55, 0xbe483f7b
.long 0xbec4bf6d, 0xbf6dbec4, 0xbf6d3ec4, 0xbec43f6d, 0x3f55bf0e, 0xbe48bf7b, 0xbf7bbe48, 0xbf0e3f55
.long 0x3f353f35, 0x3f35bf35, 0xbf35bf35, 0xbf353f35, 0xbf0e3f55, 0x3f7b3e48, 0xbe48bf7b, 0xbf553f0e
.long 0xbf6dbec4, 0x3ec43f6d, 0x3ec4bf6d, 0xbf6d3ec4, 0x3e48bf7b, 0xbf0e3f55, 0x3f55bf0e, 0xbf7b3e48
.long 0x3f800000, 0xbf800000, 0x3f800000, 0xbf800000, 0x3e483f7b, 0xbf0ebf55, 0x3f553f0e, 0xbf7bbe48
.long 0xbf6d3ec4, 0x3ec4bf6d, 0x3ec43f6d, 0xbf6dbec4, 0xbf0ebf55, 0x3f7bbe48, 0xbe483f7b, 0xbf55bf0e
.long 0x3f35bf35, 0x3f353f35, 0xbf353f35, 0xbf35bf35, 0x3f553f0e, 0xbe483f7b, 0xbf7b3e48, 0xbf0ebf55
.long 0xbec43f6d, 0xbf6d3ec4, 0xbf6dbec4, 0xbec4bf6d, 0xbf7bbe48, 0xbf55bf0e, 0xbf0ebf55, 0xbe48bf7b
.long 0xbf80, 0xbf80, 0xbf80, 0xbf80, 0xbe48bf7b, 0xbf0ebf55, 0xbf55bf0e, 0xbf7bbe48
.long 0xbec4bf6d, 0xbf6dbec4, 0xbf6d3ec4, 0xbec43f6d, 0xbf0ebf55, 0xbf7b3e48, 0xbe483f7b, 0x3f553f0e
.long 0xbf35bf35, 0xbf353f35, 0x3f353f35, 0x3f35bf35, 0xbf55bf0e, 0xbe483f7b, 0x3f7bbe48, 0xbf0ebf55
.long 0xbf6dbec4, 0x3ec43f6d, 0x3ec4bf6d, 0xbf6d3ec4, 0xbf7bbe48, 0x3f553f0e, 0xbf0ebf55, 0x3e483f7b
.long 0xbf800000, 0x3f800000, 0xbf800000, 0x3f800000, 0xbf7b3e48, 0x3f55bf0e, 0xbf0e3f55, 0x3e48bf7b
.long 0xbf6d3ec4, 0x3ec4bf6d, 0x3ec43f6d, 0xbf6dbec4, 0xbf553f0e, 0xbe48bf7b, 0x3f7b3e48, 0xbf0e3f55
.long 0xbf353f35, 0xbf35bf35, 0x3f35bf35, 0x3f353f35, 0xbf0e3f55, 0xbf7bbe48, 0xbe48bf7b, 0x3f55bf0e
.long 0xbec43f6d, 0xbf6d3ec4, 0xbf6dbec4, 0xbec4bf6d, 0xbe483f7b, 0xbf0e3f55, 0xbf553f0e, 0xbf7b3e48
.long 0xbf80, 0xbf80, 0xbf80, 0xbf80, 0xbf7b3e48, 0xbf553f0e, 0xbf0e3f55, 0xbe483f7b
.long 0x3ec43f6d, 0x3f6d3ec4, 0x3f6dbec4, 0x3ec4bf6d, 0x3f55bf0e, 0xbe48bf7b, 0xbf7bbe48, 0xbf0e3f55
.long 0xbf35bf35, 0xbf353f35, 0x3f353f35, 0x3f35bf35, 0xbf0e3f55, 0x3f7b3e48, 0xbe48bf7b, 0xbf553f0e
.long 0x3f6d3ec4, 0xbec4bf6d, 0xbec43f6d, 0x3f6dbec4, 0x3e48bf7b, 0xbf0e3f55, 0x3f55bf0e, 0xbf7b3e48
.long 0xbf800000, 0x3f800000, 0xbf800000, 0x3f800000, 0x3e483f7b, 0xbf0ebf55, 0x3f553f0e, 0xbf7bbe48
.long 0x3f6dbec4, 0xbec43f6d, 0xbec4bf6d, 0x3f6d3ec4, 0xbf0ebf55, 0x3f7bbe48, 0xbe483f7b, 0xbf55bf0e
.long 0xbf353f35, 0xbf35bf35, 0x3f35bf35, 0x3f353f35, 0x3f553f0e, 0xbe483f7b, 0xbf7b3e48, 0xbf0ebf55
.long 0x3ec4bf6d, 0x3f6dbec4, 0x3f6d3ec4, 0x3ec43f6d, 0xbf7bbe48, 0xbf55bf0e, 0xbf0ebf55, 0xbe48bf7b
.long 0xbf80, 0xbf80, 0xbf80, 0xbf80, 0x3e483f7b, 0x3f0e3f55, 0x3f553f0e, 0x3f7b3e48
.long 0xbec4bf6d, 0xbf6dbec4, 0xbf6d3ec4, 0xbec43f6d, 0x3f0e3f55, 0x3f7bbe48, 0x3e48bf7b, 0xbf55bf0e
.long 0xbf35bf35, 0xbf353f35, 0x3f353f35, 0x3f35bf35, 0x3f553f0e, 0x3e48bf7b, 0xbf7b3e48, 0x3f0e3f55
.long 0xbf6dbec4, 0x3ec43f6d, 0x3ec4bf6d, 0xbf6d3ec4, 0x3f7b3e48, 0xbf55bf0e, 0x3f0e3f55, 0xbe48bf7b
.long 0xbf800000, 0x3f800000, 0xbf800000, 0x3f800000, 0x3f7bbe48, 0xbf553f0e, 0x3f0ebf55, 0xbe483f7b
.long 0xbf6d3ec4, 0x3ec4bf6d, 0x3ec43f6d, 0xbf6dbec4, 0x3f55bf0e, 0x3e483f7b, 0xbf7bbe48, 0x3f0ebf55
.long 0xbf353f35, 0xbf35bf35, 0x3f35bf35, 0x3f353f35, 0x3f0ebf55, 0x3f7b3e48, 0x3e483f7b, 0xbf553f0e
.long 0xbec43f6d, 0xbf6d3ec4, 0xbf6dbec4, 0xbec4bf6d, 0x3e48bf7b, 0x3f0ebf55, 0x3f55bf0e, 0x3f7bbe48
.long 0xbf80, 0xbf80, 0xbf80, 0xbf80, 0x3f7bbe48, 0x3f55bf0e, 0x3f0ebf55, 0x3e48bf7b
.long 0x3ec43f6d, 0x3f6d3ec4, 0x3f6dbec4, 0x3ec4bf6d, 0xbf553f0e, 0x3e483f7b, 0x3f7b3e48, 0x3f0ebf55
.long 0xbf35bf35, 0xbf353f35, 0x3f353f35, 0x3f35bf35, 0x3f0ebf55, 0xbf7bbe48, 0x3e483f7b, 0x3f55bf0e
.long 0x3f6d3ec4, 0xbec4bf6d, 0xbec43f6d, 0x3f6dbec4, 0xbe483f7b, 0x3f0ebf55, 0xbf553f0e, 0x3f7bbe48
.long 0xbf800000, 0x3f800000, 0xbf800000, 0x3f800000, 0xbe48bf7b, 0x3f0e3f55, 0xbf55bf0e, 0x3f7b3e48
.long 0x3f6dbec4, 0xbec43f6d, 0xbec4bf6d, 0x3f6d3ec4, 0x3f0e3f55, 0xbf7b3e48, 0x3e48bf7b, 0x3f553f0e
.long 0xbf353f35, 0xbf35bf35, 0x3f35bf35, 0x3f353f35, 0xbf55bf0e, 0x3e48bf7b, 0x3f7bbe48, 0x3f0e3f55
.long 0x3ec4bf6d, 0x3f6dbec4, 0x3f6d3ec4, 0x3ec43f6d, 0x3f7b3e48, 0x3f553f0e, 0x3f0e3f55, 0x3e483f7b
L_tabend:
.size L_tab, L_tabend - L_tab
.section .rodata,"a"
.p2align 6
.amdhsa_kernel gated_mix__spectral_fnet__moe_arch_mod__prompt_kernel
  .amdhsa_next_free_vgpr 256
  .amdhsa_next_free_sgpr 102
  .amdhsa_accum_offset 256
  .amdhsa_group_segment_fixed_size 0
  .amdhsa_kernarg_size 112
  .amdhsa_user_sgpr_count 2
  .amdhsa_user_sgpr_kernarg_segment_ptr 1
  .amdhsa_system_sgpr_workgroup_id_x 1
.end_amdhsa_kernel
```

```asm
; @launch grid=(256,1,1) block=(512,1,1) lds=100352
.amdgcn_target "amdgcn-amd-amdhsa--gfx950"
.text
.globl gated_mix__spectral_fnet__moe_arch_mod__prompt_kernel
.p2align 8
.type gated_mix__spectral_fnet__moe_arch_mod__prompt_kernel,@function
gated_mix__spectral_fnet__moe_arch_mod__prompt_kernel:
    s_cmp_ge_u32 s2, 256
    s_cbranch_scc1 L_end
    s_load_dwordx2 s[4:5], s[0:1], 0
    s_load_dwordx16 s[16:31], s[0:1], 48
    s_getpc_b64 s[10:11]
L_pc:
    v_lshrrev_b32 v1, 6, v0
    s_lshr_b32 s57, s2, 3
    v_lshl_add_u32 v4, v0, 5, s57
    v_lshlrev_b32 v4, 7, v4
    v_cmp_gt_u32 vcc, L_tabend - L_pc, v4
    s_nop 0
    s_and_saveexec_b64 s[12:13], vcc
    s_cbranch_execz L_nocpf
    global_load_dword v249, v4, s[10:11]
L_nocpf:
    s_mov_b64 exec, s[12:13]
    v_and_b32 v0, 63, v0
    v_readfirstlane_b32 s3, v1
    v_and_b32 v2, 15, v0
    v_lshrrev_b32 v3, 4, v0
    v_lshlrev_b32 v247, 4, v0
    v_lshlrev_b32 v246, 3, v0
    s_add_u32 s10, s10, L_tab - L_pc
    s_addc_u32 s11, s11, 0
    s_and_b32 s56, s2, 7
    s_mov_b32 s90, 400000
    s_cmp_lt_u32 s57, 16
    s_cbranch_scc1 L_low
    s_sub_u32 s57, s57, 16
    s_lshl4_add_u32 s9, s56, s57
    s_lshl4_add_u32 s58, s57, s56
    s_sub_u32 s62, s58, 120
    s_cmp_lt_u32 s9, 8
    s_cselect_b32 s62, s58, s62
    s_cmp_lt_u32 s9, 16
    s_cselect_b32 s58, s62, s58
L_a:
    s_cmp_ge_u32 s3, 4
    s_cbranch_scc1 L_p1w
    s_lshl2_add_u32 s60, s57, s3
    s_lshl_b32 s60, s60, 5
    s_add_u32 s60, s60, s56
    s_lshl_b32 s12, s60, 10
    s_cmp_eq_u32 s58, 128
    s_cselect_b32 s12, 0x40000000, s12
    s_add_u32 s13, s12, 8192
    s_add_u32 s14, s12, 16384
    s_add_u32 s15, s12, 24576
    s_waitcnt lgkmcnt(0)
    s_load_dword s59, s[30:31], 0
    s_mov_b32 s32, s4
    s_mov_b32 s33, s5
    s_mov_b32 s34, 0x200000
    s_mov_b32 s35, 0x20000
    s_mov_b32 s36, s30
    s_mov_b32 s37, s31
    s_mov_b32 s38, 0x400000
    s_mov_b32 s39, 0x20000
    buffer_load_dwordx4 v[8:11], v247, s[32:35], s12 offen
    buffer_load_dwordx4 v[12:15], v247, s[32:35], s13 offen
    buffer_load_dwordx4 v[16:19], v247, s[32:35], s14 offen
    buffer_load_dwordx4 v[20:23], v247, s[32:35], s15 offen
    s_mov_b32 s44, s16
    s_mov_b32 s45, s17
    s_mov_b32 s46, 0x400
    s_mov_b32 s47, 0x20000
    buffer_load_dwordx4 v[24:27], v247, s[44:47], 0 offen
    v_and_b32 v36, 1, v3
    v_lshrrev_b32 v108, 1, v3
    v_lshl_add_u32 v36, v36, 1, v108
    v_lshl_add_u32 v36, v36, 3, s60
    v_mov_b32 v108, 43008
    v_mov_b32 v109, 1
    s_mov_b32 s8, 0xfffff800
    s_lshl3_add_u32 s15, s57, s56
    s_lshl_b32 s15, s15, 3
    s_add_u32 s15, s15, 0x40000
    v_lshlrev_b32 v37, 11, v0
    s_xor_b32 s98, s3, 4
    v_lshl_add_u32 v96, v2, 4, s98
    v_lshlrev_b32 v98, 2, v3
    v_cvt_f32_u32 v98, v98
    v_cvt_f32_u32 v96, v96
    v_mul_f32 v96, 0x3b800000, v96
    v_mul_f32 v99, v98, v96
    v_cos_f32 v102, v99
    v_sin_f32 v103, v99
    v_add_f32 v99, v99, v96
    v_cvt_pk_bf16_f32 v112, v102, v103
    v_cvt_pk_bf16_f32 v116, -v103, v102
    v_cos_f32 v102, v99
    v_sin_f32 v103, v99
    v_add_f32 v99, v99, v96
    v_cvt_pk_bf16_f32 v113, v102, v103
    v_cvt_pk_bf16_f32 v117, -v103, v102
    v_cos_f32 v102, v99
    v_sin_f32 v103, v99
    v_add_f32 v99, v99, v96
    v_cvt_pk_bf16_f32 v114, v102, v103
    v_cvt_pk_bf16_f32 v118, -v103, v102
    v_cos_f32 v102, v99
    v_sin_f32 v103, v99
    s_nop 0
    v_cvt_pk_bf16_f32 v115, v102, v103
    v_cvt_pk_bf16_f32 v119, -v103, v102
    v_mov_b32 v96, 0x80000000
    v_mov_b32 v97, 0x8000
    v_xor_b32 v120, v96, v112
    v_xor_b32 v124, v97, v116
    v_xor_b32 v121, v96, v113
    v_xor_b32 v125, v97, v117
    v_xor_b32 v122, v96, v114
    v_xor_b32 v126, v97, v118
    v_xor_b32 v123, v96, v115
    v_xor_b32 v127, v97, v119
    s_sub_u32 s60, 16, s98
    s_cmp_eq_u32 s98, 0
    s_cselect_b32 s60, 8, s60
    v_bfe_u32 v96, v2, 2, 1
    v_xor_b32 v96, v96, v2
    v_lshrrev_b32 v97, 3, v2
    v_mul_u32_u24 v98, 3, v97
    v_xor_b32 v98, v98, v3
    v_lshlrev_b32 v98, 4, v98
    v_lshl_add_u32 v96, v96, 6, v98
    s_lshl_b32 s61, s98, 3
    s_and_b32 s61, s61, 32
    s_lshl_b32 s62, s98, 10
    s_or_b32 s61, s61, s62
    v_xor_b32 v60, s61, v96
    s_lshl_b32 s61, s60, 3
    s_and_b32 s61, s61, 32
    s_lshl_b32 s62, s60, 10
    s_or_b32 s61, s61, s62
    v_xor_b32 v61, s61, v96
    v_lshlrev_b32 v63, 16, v3
    v_lshl_add_u32 v63, v97, 14, v63
    v_and_b32 v96, 7, v2
    v_lshl_add_u32 v63, v96, 4, v63
    s_lshl_b32 s6, s98, 18
    s_lshl_b32 s61, s56, 11
    s_add_u32 s6, s6, s61
    s_lshl_b32 s61, s57, 7
    s_add_u32 s6, s6, s61
    s_add_u32 s6, s6, 0x200000
    s_add_u32 s7, s6, 32768
    v_lshlrev_b32 v4, 5, v2
    v_and_b32 v96, 1, v3
    v_lshl_add_u32 v4, v96, 9, v4
    v_lshrrev_b32 v96, 1, v3
    v_lshl_add_u32 v4, v96, 4, v4
    s_lshl_b32 s60, s3, 8
    s_add_u32 s93, s60, s58
    s_sub_u32 s94, 2048, s93
    s_and_b32 s94, s94, 2047
    s_mov_b32 s48, s24
    s_mov_b32 s49, s25
    s_mov_b32 s50, 0x400
    s_mov_b32 s51, 0x20000
    s_waitcnt vmcnt(1)
    s_barrier
    s_waitcnt vmcnt(0)
    v_dot2_f32_bf16 v32, v8, v24, 0
    v_dot2_f32_bf16 v33, v12, v24, 0
    v_dot2_f32_bf16 v34, v16, v24, 0
    v_dot2_f32_bf16 v35, v20, v24, 0
    v_dot2_f32_bf16 v32, v9, v25, v32
    v_dot2_f32_bf16 v33, v13, v25, v33
    v_dot2_f32_bf16 v34, v17, v25, v34
    v_dot2_f32_bf16 v35, v21, v25, v35
    v_dot2_f32_bf16 v32, v10, v26, v32
    v_dot2_f32_bf16 v33, v14, v26, v33
    v_dot2_f32_bf16 v34, v18, v26, v34
    v_dot2_f32_bf16 v35, v22, v26, v35
    v_dot2_f32_bf16 v32, v11, v27, v32
    v_dot2_f32_bf16 v33, v15, v27, v33
    v_dot2_f32_bf16 v34, v19, v27, v34
    v_dot2_f32_bf16 v35, v23, v27, v35
    s_waitcnt lgkmcnt(0)
    s_add_u32 s59, s59, 0x9e3779b9
    s_bitcmp1_b32 s59, 0
    s_cselect_b32 s91, 1, 0x10000
    s_xor_b32 s92, s91, 0x10001
    v_permlane32_swap_b32 v32, v33
    v_permlane32_swap_b32 v34, v35
    v_add_f32 v32, v32, v33
    v_add_f32 v34, v34, v35
    s_nop 1
    v_permlane16_swap_b32 v32, v34
    v_add_f32 v32, v32, v34
    v_mov_b32 v39, s59
    s_nop 0
    v_add_f32_dpp v32, v32, v32 row_ror:8 row_mask:0xf bank_mask:0xf
    s_nop 1
    v_add_f32_dpp v32, v32, v32 row_ror:4 row_mask:0xf bank_mask:0xf
    s_nop 1
    v_add_f32_dpp v32, v32, v32 row_ror:2 row_mask:0xf bank_mask:0xf
    s_nop 1
    v_add_f32_dpp v32, v32, v32 row_ror:1 row_mask:0xf bank_mask:0xf
    v_ashrrev_i32 v33, 31, v32
    v_or_b32 v33, 0x80000000, v33
    v_xor_b32 v33, v33, v32
    v_and_or_b32 v33, v33, s8, v36
    s_mov_b32 exec_lo, 0x10001
    s_mov_b32 exec_hi, 0x10001
    ds_max_u32 v108, v33
    s_mov_b64 exec, -1
    s_waitcnt lgkmcnt(0)
    s_barrier
    s_cmp_lg_u32 s3, 0
    s_cbranch_scc1 L_b1a
    ds_read_b32 v38, v108
    s_waitcnt lgkmcnt(0)
    s_cmp_eq_u32 s58, 128
    s_cbranch_scc1 L_b1a
    s_mov_b64 exec, 0xffffffff
    buffer_store_dwordx2 v[38:39], v37, s[36:39], s15 offen sc1
    s_mov_b64 exec, -1
L_b1a:
    s_lshl_b32 s63, s3, 1
    s_lshl_b32 s60, s63, 10
    v_lshl_add_u32 v248, v0, 4, s60
    s_add_u32 m0, s60, 32768
    global_load_lds_dwordx4 v248, s[10:11] offset:0
    global_load_lds_dwordx4 v248, s[10:11] offset:1024
    s_and_b32 s63, s3, 1
    s_add_u32 s63, s63, 8
    s_lshl_b32 s60, s63, 10
    v_lshl_add_u32 v248, v0, 4, s60
    s_add_u32 m0, s60, 32768
    global_load_lds_dwordx4 v248, s[10:11] offset:0
    s_lshl_b32 s12, s93, 10
    s_lshl_b32 s13, s94, 10
    buffer_load_dwordx4 v[232:235], v4, s[32:35], s12 offen
    buffer_load_dwordx4 v[236:239], v4, s[32:35], s13 offen
    buffer_load_dwordx4 v[240:243], v4, s[48:51], 0 offen
    v_mov_b32 v104, s91
    v_mov_b32 v105, s92
    v_mov_b32 v106, 0x00010001
    s_branch L_b1
L_p1w:
    s_sub_u32 s96, s3, 4
    s_lshl_b32 s60, s56, 2
    s_mul_i32 s61, s56, 3
    s_add_u32 s61, s61, 4
    s_cmp_lt_u32 s56, 4
    s_cselect_b32 s60, s60, s61
    s_cselect_b32 s61, 16, 12
    s_cmp_ge_u32 s57, s61
    s_cselect_b32 s63, 8, s96
    s_lshr_b32 s61, s57, 2
    s_add_u32 s60, s60, s61
    s_lshl_b32 s6, s60, 7
    s_and_b32 s61, s57, 3
    s_mul_i32 s61, s61, 3
    s_add_u32 s61, s61, s96
    s_lshl_b32 s61, s61, 5
    s_add_u32 s61, s61, 128
    v_lshrrev_b32 v100, 1, v0
    v_add_u32 v100, s61, v100
    v_mul_u32_u24 v100, 3584, v100
    v_and_b32 v101, 1, v0
    v_lshl_add_u32 v100, v101, 6, v100
    s_waitcnt lgkmcnt(0)
    s_mov_b32 s52, s18
    s_mov_b32 s53, s19
    s_mov_b32 s54, 0x1c0000
    s_mov_b32 s55, 0x20000
    s_cmp_ge_u32 s63, 3
    s_cbranch_scc1 L_noapf
    buffer_load_dword v255, v100, s[52:55], s6 offen
L_noapf:
    s_waitcnt lgkmcnt(0)
    s_mov_b32 s32, s4
    s_mov_b32 s33, s5
    s_mov_b32 s34, 0x200000
    s_mov_b32 s35, 0x20000
    s_mov_b32 s36, s30
    s_mov_b32 s37, s31
    s_mov_b32 s38, 0x400000
    s_mov_b32 s39, 0x20000
    s_cmp_lg_u32 s3, 7
    s_cbranch_scc1 L_nomt
    v_mov_b32 v252, s16
    v_mov_b32 v253, s17
    v_writelane_b32 v252, s24, 1
    v_writelane_b32 v253, s25, 1
    v_writelane_b32 v252, s26, 2
    v_writelane_b32 v253, s27, 2
    s_add_u32 s63, s30, 0x3000
    v_writelane_b32 v252, s63, 3
    s_addc_u32 s63, s31, 0
    v_writelane_b32 v253, s63, 3
    s_add_u32 s63, s30, 0x203000
    v_writelane_b32 v252, s63, 4
    s_addc_u32 s63, s31, 0
    v_writelane_b32 v253, s63, 4
    s_mov_b64 exec, 0x1f
    global_load_dword v254, v[252:253], off
    s_mov_b64 exec, -1
L_nomt:
    v_lshlrev_b32 v107, 19, v3
    v_bfe_u32 v108, v0, 2, 2
    v_lshl_add_u32 v107, v108, 13, v107
    v_and_b32 v109, 3, v0
    v_lshl_add_u32 v107, v109, 4, v107
    v_mov_b32 v96, 43008
    v_mov_b32 v98, 0
    v_mov_b32 v99, 0
    ds_write_b64 v96, v[98:99]
    v_lshlrev_b32 v96, 2, v3
    v_cvt_f32_u32 v96, v96
    v_cvt_f32_u32 v97, v2
    v_mul_f32 v97, 0x3d800000, v97
    v_mul_f32 v96, v96, v97
    v_cos_f32 v102, v96
    v_sin_f32 v103, v96
    v_add_f32 v96, v96, v97
    v_cvt_pk_bf16_f32 v40, v102, v103
    v_cvt_pk_bf16_f32 v44, -v103, v102
    v_cos_f32 v102, v96
    v_sin_f32 v103, v96
    v_add_f32 v96, v96, v97
    v_cvt_pk_bf16_f32 v41, v102, v103
    v_cvt_pk_bf16_f32 v45, -v103, v102
    v_cos_f32 v102, v96
    v_sin_f32 v103, v96
    v_add_f32 v96, v96, v97
    v_cvt_pk_bf16_f32 v42, v102, v103
    v_cvt_pk_bf16_f32 v46, -v103, v102
    v_cos_f32 v102, v96
    v_sin_f32 v103, v96
    s_nop 0
    v_cvt_pk_bf16_f32 v43, v102, v103
    v_cvt_pk_bf16_f32 v47, -v103, v102
    v_lshrrev_b32 v96, 1, v109
    v_mul_u32_u24 v96, 3, v96
    v_lshlrev_b32 v97, 1, v3
    v_and_b32 v97, 2, v97
    v_xor_b32 v96, v96, v97
    v_xor_b32 v96, s96, v96
    v_lshl_add_u32 v96, v96, 2, v108
    v_lshlrev_b32 v96, 2, v96
    v_lshl_add_u32 v96, v109, 8, v96
    v_lshl_add_u32 v96, v3, 12, v96
    v_and_b32 v97, 1, v109
    v_lshl_add_u32 v48, v97, 6, v96
    v_xor_b32 v49, 64, v48
    v_add_u32 v50, 128, v48
    v_add_u32 v51, 128, v49
    s_xor_b32 s98, s3, 4
    v_lshl_add_u32 v96, v2, 4, s98
    s_cmp_eq_u32 s98, 0
    s_cselect_b32 s60, 120, 0
    v_subrev_u32 v98, s60, v96
    v_cmp_gt_u32 vcc, 8, v2
    s_nop 1
    v_cndmask_b32 v96, v98, v96, vcc
    v_lshlrev_b32 v98, 2, v3
    v_cvt_f32_u32 v98, v98
    v_cvt_f32_u32 v96, v96
    v_mul_f32 v96, 0x3b800000, v96
    v_mul_f32 v99, v98, v96
    v_cos_f32 v102, v99
    v_sin_f32 v103, v99
    v_add_f32 v99, v99, v96
    v_cvt_pk_bf16_f32 v112, v102, v103
    v_cvt_pk_bf16_f32 v116, -v103, v102
    v_cos_f32 v102, v99
    v_sin_f32 v103, v99
    v_add_f32 v99, v99, v96
    v_cvt_pk_bf16_f32 v113, v102, v103
    v_cvt_pk_bf16_f32 v117, -v103, v102
    v_cos_f32 v102, v99
    v_sin_f32 v103, v99
    v_add_f32 v99, v99, v96
    v_cvt_pk_bf16_f32 v114, v102, v103
    v_cvt_pk_bf16_f32 v118, -v103, v102
    v_cos_f32 v102, v99
    v_sin_f32 v103, v99
    s_nop 0
    v_cvt_pk_bf16_f32 v115, v102, v103
    v_cvt_pk_bf16_f32 v119, -v103, v102
    v_mov_b32 v96, 0x80000000
    v_mov_b32 v97, 0x8000
    v_xor_b32 v120, v96, v112
    v_xor_b32 v124, v97, v116
    v_xor_b32 v121, v96, v113
    v_xor_b32 v125, v97, v117
    v_xor_b32 v122, v96, v114
    v_xor_b32 v126, v97, v118
    v_xor_b32 v123, v96, v115
    v_xor_b32 v127, v97, v119
    s_cmp_lg_u32 s98, 0
    s_cbranch_scc1 L_sp_e
    s_mov_b32 exec_lo, 0x10001
    s_mov_b32 exec_hi, 0x10001
    v_mov_b32 v121, 0xbf80
    v_mov_b32 v125, 0xbf800000
    v_mov_b32 v123, 0xbf80
    v_mov_b32 v127, 0xbf800000
    s_mov_b64 exec, -1
    v_cndmask_b32_e64 v128, v112, 0, vcc
    v_cndmask_b32 v112, 0, v112, vcc
    v_cndmask_b32 v136, 0, v120, vcc
    v_cndmask_b32_e64 v120, v120, 0, vcc
    v_cndmask_b32_e64 v129, v113, 0, vcc
    v_cndmask_b32 v113, 0, v113, vcc
    v_cndmask_b32 v137, 0, v121, vcc
    v_cndmask_b32_e64 v121, v121, 0, vcc
    v_cndmask_b32_e64 v130, v114, 0, vcc
    v_cndmask_b32 v114, 0, v114, vcc
    v_cndmask_b32 v138, 0, v122, vcc
    v_cndmask_b32_e64 v122, v122, 0, vcc
    v_cndmask_b32_e64 v131, v115, 0, vcc
    v_cndmask_b32 v115, 0, v115, vcc
    v_cndmask_b32 v139, 0, v123, vcc
    v_cndmask_b32_e64 v123, v123, 0, vcc
    v_cndmask_b32_e64 v132, v116, 0, vcc
    v_cndmask_b32 v116, 0, v116, vcc
    v_cndmask_b32 v140, 0, v124, vcc
    v_cndmask_b32_e64 v124, v124, 0, vcc
    v_cndmask_b32_e64 v133, v117, 0, vcc
    v_cndmask_b32 v117, 0, v117, vcc
    v_cndmask_b32 v141, 0, v125, vcc
    v_cndmask_b32_e64 v125, v125, 0, vcc
    v_cndmask_b32_e64 v134, v118, 0, vcc
    v_cndmask_b32 v118, 0, v118, vcc
    v_cndmask_b32 v142, 0, v126, vcc
    v_cndmask_b32_e64 v126, v126, 0, vcc
    v_cndmask_b32_e64 v135, v119, 0, vcc
    v_cndmask_b32 v119, 0, v119, vcc
    v_cndmask_b32 v143, 0, v127, vcc
    v_cndmask_b32_e64 v127, v127, 0, vcc
L_sp_e:
    s_sub_u32 s60, 16, s98
    s_cmp_eq_u32 s98, 0
    s_cselect_b32 s60, 8, s60
    v_bfe_u32 v96, v2, 2, 1
    v_xor_b32 v96, v96, v2
    v_lshrrev_b32 v97, 3, v2
    v_mul_u32_u24 v98, 3, v97
    v_xor_b32 v98, v98, v3
    v_lshlrev_b32 v98, 4, v98
    v_lshl_add_u32 v96, v96, 6, v98
    s_lshl_b32 s61, s98, 3
    s_and_b32 s61, s61, 32
    s_lshl_b32 s62, s98, 10
    s_or_b32 s61, s61, s62
    v_xor_b32 v60, s61, v96
    s_lshl_b32 s61, s60, 3
    s_and_b32 s61, s61, 32
    s_lshl_b32 s62, s60, 10
    s_or_b32 s61, s61, s62
    v_xor_b32 v61, s61, v96
    v_lshlrev_b32 v63, 16, v3
    v_lshl_add_u32 v63, v97, 14, v63
    v_and_b32 v96, 7, v2
    v_lshl_add_u32 v63, v96, 4, v63
    s_lshl_b32 s6, s98, 18
    s_lshl_b32 s61, s56, 11
    s_add_u32 s6, s6, s61
    s_lshl_b32 s61, s57, 7
    s_add_u32 s6, s6, s61
    s_add_u32 s6, s6, 0x200000
    s_add_u32 s7, s6, 32768
    v_lshlrev_b32 v4, 5, v2
    v_and_b32 v96, 1, v3
    v_lshl_add_u32 v4, v96, 9, v4
    v_lshrrev_b32 v96, 1, v3
    v_lshl_add_u32 v4, v96, 4, v4
    s_lshl_b32 s60, s3, 8
    s_add_u32 s93, s60, s58
    s_sub_u32 s94, 2048, s93
    s_and_b32 s94, s94, 2047
    s_mov_b32 s48, s24
    s_mov_b32 s49, s25
    s_mov_b32 s50, 0x400
    s_mov_b32 s51, 0x20000
    s_lshl_b32 s12, s96, 15
    s_lshl_b32 s61, s56, 10
    s_add_u32 s12, s12, s61
    s_lshl_b32 s61, s57, 6
    s_add_u32 s12, s12, s61
    s_cmp_eq_u32 s58, 128
    s_cselect_b32 s12, 0x40000000, s12
    s_add_u32 s13, s12, 131072
    s_add_u32 s14, s12, 262144
    s_add_u32 s15, s12, 393216
    s_waitcnt lgkmcnt(0)
    s_barrier
    buffer_load_dwordx4 v[8:11], v107, s[32:35], s12 offen
    buffer_load_dwordx4 v[12:15], v107, s[32:35], s13 offen
    buffer_load_dwordx4 v[16:19], v107, s[32:35], s14 offen
    buffer_load_dwordx4 v[20:23], v107, s[32:35], s15 offen
    s_load_dword s59, s[30:31], 0
    s_lshl_b32 s12, s93, 10
    s_lshl_b32 s13, s94, 10
    buffer_load_dwordx4 v[232:235], v4, s[32:35], s12 offen
    buffer_load_dwordx4 v[236:239], v4, s[32:35], s13 offen
    buffer_load_dwordx4 v[240:243], v4, s[48:51], 0 offen
    s_lshr_b32 s15, s9, 2
    s_add_u32 s15, s15, 32
    s_and_b32 s15, s15, 31
    s_lshl_b32 s15, s15, 11
    s_add_u32 s15, s15, 0x40000
    s_waitcnt lgkmcnt(0)
    s_add_u32 s59, s59, 0x9e3779b9
    s_bitcmp1_b32 s59, 0
    s_cselect_b32 s91, 1, 0x10000
    s_xor_b32 s92, s91, 0x10001
    v_mov_b32 v104, s91
    v_mov_b32 v105, s92
    v_mov_b32 v106, 0x00010001
    v_mov_b32 v184, 0
    v_mov_b32 v185, 0
    v_mov_b32 v186, 0
    v_mov_b32 v187, 0
    s_barrier
    s_waitcnt vmcnt(3)
    v_pk_mov_b32 v[24:25], v[8:9], v[12:13] op_sel:[0,0]
    v_pk_mov_b32 v[26:27], v[16:17], v[20:21] op_sel:[0,0]
    v_pk_mov_b32 v[28:29], v[8:9], v[12:13] op_sel:[1,1]
    v_pk_mov_b32 v[30:31], v[16:17], v[20:21] op_sel:[1,1]
    v_mfma_f32_16x16x32_bf16 v[64:67], v[40:43], v[24:27], 0
    v_mfma_f32_16x16x32_bf16 v[68:71], v[44:47], v[24:27], 0
    v_pk_mov_b32 v[32:33], v[10:11], v[14:15] op_sel:[0,0]
    v_pk_mov_b32 v[34:35], v[18:19], v[22:23] op_sel:[0,0]
    v_mfma_f32_16x16x32_bf16 v[72:75], v[40:43], v[28:31], 0
    v_mfma_f32_16x16x32_bf16 v[76:79], v[44:47], v[28:31], 0
    v_pk_mov_b32 v[36:37], v[10:11], v[14:15] op_sel:[1,1]
    v_pk_mov_b32 v[38:39], v[18:19], v[22:23] op_sel:[1,1]
    v_mfma_f32_16x16x32_bf16 v[80:83], v[40:43], v[32:35], 0
    v_mfma_f32_16x16x32_bf16 v[84:87], v[44:47], v[32:35], 0
    v_mfma_f32_16x16x32_bf16 v[88:91], v[40:43], v[36:39], 0
    v_cvt_pk_bf16_f32 v8, v64, v68
    v_cvt_pk_bf16_f32 v9, v65, v69
    v_mfma_f32_16x16x32_bf16 v[92:95], v[44:47], v[36:39], 0
    ds_write2st64_b32 v48, v8, v9 offset0:0 offset1:4
    v_cvt_pk_bf16_f32 v10, v66, v70
    v_cvt_pk_bf16_f32 v11, v67, v71
    ds_write2st64_b32 v48, v10, v11 offset0:8 offset1:12
    v_cvt_pk_bf16_f32 v12, v72, v76
    v_cvt_pk_bf16_f32 v13, v73, v77
    ds_write2st64_b32 v49, v12, v13 offset0:0 offset1:4
    v_cvt_pk_bf16_f32 v14, v74, v78
    v_cvt_pk_bf16_f32 v15, v75, v79
    ds_write2st64_b32 v49, v14, v15 offset0:8 offset1:12
    v_cvt_pk_bf16_f32 v16, v80, v84
    v_cvt_pk_bf16_f32 v17, v81, v85
    ds_write2st64_b32 v50, v16, v17 offset0:0 offset1:4
    v_cvt_pk_bf16_f32 v18, v82, v86
    v_cvt_pk_bf16_f32 v19, v83, v87
    ds_write2st64_b32 v50, v18, v19 offset0:8 offset1:12
    v_cvt_pk_bf16_f32 v20, v88, v92
    v_cvt_pk_bf16_f32 v21, v89, v93
    ds_write2st64_b32 v51, v20, v21 offset0:0 offset1:4
    v_cvt_pk_bf16_f32 v22, v90, v94
    v_cvt_pk_bf16_f32 v23, v91, v95
    ds_write2st64_b32 v51, v22, v23 offset0:8 offset1:12
    s_waitcnt lgkmcnt(0)
L_b1:
    s_barrier
    s_cmp_eq_u32 s58, 128
    s_cbranch_scc1 L_ack128
    ds_read_b128 v[52:55], v60
    ds_read_b128 v[56:59], v61
    s_mov_b32 vcc_lo, 0x00ff00ff
    s_mov_b32 vcc_hi, 0x00ff00ff
    s_waitcnt lgkmcnt(1)
    v_mfma_f32_16x16x32_bf16 v[64:67], v[112:115], v[52:55], 0
    v_mfma_f32_16x16x32_bf16 v[68:71], v[116:119], v[52:55], 0
    s_waitcnt lgkmcnt(0)
    v_mfma_f32_16x16x32_bf16 v[72:75], v[120:123], v[56:59], 0
    v_mfma_f32_16x16x32_bf16 v[76:79], v[124:127], v[56:59], 0
    s_cmp_lg_u32 s98, 0
    s_cbranch_scc1 L_s2b
    v_mfma_f32_16x16x32_bf16 v[64:67], v[128:131], v[56:59], v[64:67]
    v_mfma_f32_16x16x32_bf16 v[68:71], v[132:135], v[56:59], v[68:71]
    v_mfma_f32_16x16x32_bf16 v[72:75], v[136:139], v[52:55], v[72:75]
    v_mfma_f32_16x16x32_bf16 v[76:79], v[140:143], v[52:55], v[76:79]
L_s2b:
    s_nop 5
    v_cvt_pk_bf16_f32 v96, v64, v68
    v_cvt_pk_bf16_f32 v97, v65, v69
    v_cvt_pk_bf16_f32 v100, v72, v76
    v_cvt_pk_bf16_f32 v101, v73, v77
    v_bitop3_b32 v96, v106, v104, v96 bitop3:0xca
    v_bitop3_b32 v97, v106, v104, v97 bitop3:0xca
    v_bitop3_b32 v100, v106, v105, v100 bitop3:0xca
    v_bitop3_b32 v101, v106, v105, v101 bitop3:0xca
    v_cndmask_b32_dpp v80, v97, v96, vcc row_ror:8 row_mask:0xf bank_mask:0xf
    s_nop 0
    v_cndmask_b32_dpp v81, v101, v100, vcc row_ror:8 row_mask:0xf bank_mask:0xf
    s_not_b64 vcc, vcc
    v_cndmask_b32_dpp v82, v96, v97, vcc row_ror:8 row_mask:0xf bank_mask:0xf
    v_cndmask_b32_dpp v83, v100, v101, vcc row_ror:8 row_mask:0xf bank_mask:0xf
    buffer_store_dwordx4 v[80:83], v63, s[36:39], s6 offen sc1
    v_cvt_pk_bf16_f32 v98, v66, v70
    v_cvt_pk_bf16_f32 v99, v67, v71
    v_cvt_pk_bf16_f32 v102, v74, v78
    v_cvt_pk_bf16_f32 v103, v75, v79
    v_bitop3_b32 v98, v106, v104, v98 bitop3:0xca
    v_bitop3_b32 v99, v106, v104, v99 bitop3:0xca
    v_bitop3_b32 v102, v106, v105, v102 bitop3:0xca
    v_bitop3_b32 v103, v106, v105, v103 bitop3:0xca
    v_cndmask_b32_dpp v86, v98, v99, vcc row_ror:8 row_mask:0xf bank_mask:0xf
    s_nop 0
    v_cndmask_b32_dpp v87, v102, v103, vcc row_ror:8 row_mask:0xf bank_mask:0xf
    s_not_b64 vcc, vcc
    v_cndmask_b32_dpp v84, v99, v98, vcc row_ror:8 row_mask:0xf bank_mask:0xf
    v_cndmask_b32_dpp v85, v103, v102, vcc row_ror:8 row_mask:0xf bank_mask:0xf
    buffer_store_dwordx4 v[84:87], v63, s[36:39], s7 offen sc1
L_nos2:
    v_lshrrev_b32 v96, 1, v2
    v_lshlrev_b32 v96, 8, v96
    v_add_u32 v96, s58, v96
    v_and_b32 v97, 1, v2
    v_lshlrev_b32 v98, 1, v3
    v_mul_u32_u24 v98, v98, v96
    v_cmp_eq_u32 vcc, 0, v97
    v_and_b32 v99, 2047, v98
    v_add_u32 v98, v98, v96
    v_cvt_f32_u32 v99, v99
    v_mul_f32 v99, 0x3a000000, v99
    v_cos_f32 v100, v99
    v_sin_f32 v101, v99
    v_mul_f32 v100, 0.5, v100
    v_mul_f32 v101, 0.5, v101
    v_cndmask_b32_e64 v102, -v101, v100, vcc
    v_cndmask_b32 v103, v100, v101, vcc
    v_cvt_pk_bf16_f32 v144, v102, v103
    v_cvt_pk_bf16_f32 v148, -v103, v102
    v_cndmask_b32 v102, v101, v100, vcc
    v_cndmask_b32_e64 v103, -v100, v101, vcc
    v_cvt_pk_bf16_f32 v145, v102, -v103
    v_cvt_pk_bf16_f32 v149, -v103, -v102
    s_and_b32 s60, s58, 127
    s_cbranch_scc1 L_ac_a10
    v_add_f32 v100, v100, v100
    v_add_f32 v101, v101, v101
    v_cndmask_b32 v102, 0, v100, vcc
    v_sub_f32 v103, v100, v102
    v_cvt_pk_bf16_f32 v100, v102, v103
    v_cndmask_b32 v102, 0, v101, vcc
    v_sub_f32 v103, v101, v102
    v_cvt_pk_bf16_f32 v101, -v102, -v103
    s_cmp_eq_u32 s58, 0
    s_cselect_b32 s60, -1, 0
    s_cselect_b32 s61, 0, -1
    v_and_b32 v144, s60, v100
    v_and_b32 v148, s60, v101
    v_and_b32 v145, s61, v100
    v_and_b32 v149, s61, v101
L_ac_a10:
    v_and_b32 v99, 2047, v98
    v_cvt_f32_u32 v99, v99
    v_mul_f32 v99, 0x3a000000, v99
    v_cos_f32 v100, v99
    v_sin_f32 v101, v99
    v_mul_f32 v100, 0.5, v100
    v_mul_f32 v101, 0.5, v101
    v_cndmask_b32_e64 v102, -v101, v100, vcc
    v_cndmask_b32 v103, v100, v101, vcc
    v_cvt_pk_bf16_f32 v146, v102, v103
    v_cvt_pk_bf16_f32 v150, -v103, v102
    v_cndmask_b32 v102, v101, v100, vcc
    v_cndmask_b32_e64 v103, -v100, v101, vcc
    v_cvt_pk_bf16_f32 v147, v102, -v103
    v_cvt_pk_bf16_f32 v151, -v103, -v102
    s_and_b32 s60, s58, 127
    s_cbranch_scc1 L_ac_a11
    v_add_f32 v100, v100, v100
    v_add_f32 v101, v101, v101
    v_cndmask_b32 v102, 0, v100, vcc
    v_sub_f32 v103, v100, v102
    v_cvt_pk_bf16_f32 v100, v102, v103
    v_cndmask_b32 v102, 0, v101, vcc
    v_sub_f32 v103, v101, v102
    v_cvt_pk_bf16_f32 v101, -v102, -v103
    s_cmp_eq_u32 s58, 0
    s_cselect_b32 s60, -1, 0
    s_cselect_b32 s61, 0, -1
    v_and_b32 v146, s60, v100
    v_and_b32 v150, s60, v101
    v_and_b32 v147, s61, v100
    v_and_b32 v151, s61, v101
L_ac_a11:
    v_lshlrev_b32 v5, 12, v3
    v_lshl_add_u32 v5, v2, 4, v5
    v_lshrrev_b32 v96, 2, v2
    v_xor_b32 v96, v96, v3
    v_and_b32 v96, 1, v96
    v_bfe_u32 v97, v2, 1, 1
    v_lshl_or_b32 v96, v96, 1, v97
    s_lshr_b32 s60, s3, 1
    v_xor_b32 v96, s60, v96
    v_lshlrev_b32 v96, 4, v96
    v_and_b32 v98, 7, v2
    v_lshl_add_u32 v96, v98, 6, v96
    v_lshl_add_u32 v96, v3, 12, v96
    v_lshrrev_b32 v98, 3, v2
    v_lshl_add_u32 v96, v98, 2, v96
    s_and_b32 s60, s3, 1
    s_lshl_b32 s60, s60, 3
    s_add_u32 s60, s60, 16384
    v_add_u32 v6, s60, v96
    v_xor_b32 v7, 48, v6
    v_bfe_u32 v96, v2, 2, 1
    v_xor_b32 v96, v96, v98
    v_lshl_or_b32 v96, v96, 1, v98
    v_xor_b32 v96, v96, v97
    v_xor_b32 v96, v96, v3
    v_lshlrev_b32 v96, 4, v96
    v_lshl_add_u32 v62, v2, 6, v96
    s_lshl_b32 s60, s3, 4
    s_and_b32 s60, s60, 32
    v_xor_b32 v62, s60, v62
    s_lshl_b32 s60, s3, 11
    s_add_u32 s60, s60, 16384
    v_add_u32 v62, s60, v62
    s_lshl_b32 s14, s9, 14
    s_lshl_b32 s60, s3, 8
    s_add_u32 s14, s14, s60
    s_add_u32 s14, s14, 0x200000
    s_mov_b32 s40, s26
    s_mov_b32 s41, s27
    s_mov_b32 s42, 0x200000
    s_mov_b32 s43, 0x20000
    s_waitcnt vmcnt(2)
    s_cmp_lg_u32 s58, 128
    s_cbranch_scc1 L_a7
    s_waitcnt vmcnt(0)
L_a7:
    v_dot2_f32_bf16 v110, v232, v240, 0
    v_dot2_f32_bf16 v111, v236, v240, 0
    v_dot2_f32_bf16 v110, v233, v241, v110
    v_dot2_f32_bf16 v111, v237, v241, v111
    v_dot2_f32_bf16 v110, v234, v242, v110
    v_dot2_f32_bf16 v111, v238, v242, v111
    v_dot2_f32_bf16 v110, v235, v243, v110
    v_dot2_f32_bf16 v111, v239, v243, v111
    v_permlane16_swap_b32 v232, v234
    v_permlane16_swap_b32 v233, v235
    v_permlane16_swap_b32 v236, v238
    v_permlane16_swap_b32 v237, v239
    v_permlane32_swap_b32 v110, v111
    v_add_f32 v110, v110, v111
    v_mov_b32 v111, v110
    s_nop 1
    v_permlane16_swap_b32 v110, v111
    v_add_f32 v110, v110, v111
    s_nop 1
    v_add_f32_dpp v110, v110, v110 row_ror:8 row_mask:0xf bank_mask:0xf
    v_lshlrev_b32 v216, 16, v232
    v_and_b32 v217, 0xffff0000, v232
    v_add_f32_dpp v110, v110, v110 row_ror:4 row_mask:0xf bank_mask:0xf
    v_lshlrev_b32 v218, 16, v233
    v_and_b32 v219, 0xffff0000, v233
    v_add_f32_dpp v110, v110, v110 row_ror:2 row_mask:0xf bank_mask:0xf
    v_lshlrev_b32 v220, 16, v234
    v_and_b32 v221, 0xffff0000, v234
    v_add_f32_dpp v110, v110, v110 row_ror:1 row_mask:0xf bank_mask:0xf
    v_lshlrev_b32 v222, 16, v235
    v_and_b32 v223, 0xffff0000, v235
    v_mul_f32 v110, 0xbfb8aa3b, v110
    v_lshlrev_b32 v224, 16, v236
    v_and_b32 v225, 0xffff0000, v236
    v_exp_f32 v110, v110
    v_lshlrev_b32 v226, 16, v237
    v_and_b32 v227, 0xffff0000, v237
    v_add_f32 v110, 1.0, v110
    v_lshlrev_b32 v228, 16, v238
    v_and_b32 v229, 0xffff0000, v238
    v_rcp_f32 v110, v110
    v_lshlrev_b32 v230, 16, v239
    v_and_b32 v231, 0xffff0000, v239
    v_mov_b32 v111, v110
    s_nop 1
    v_permlane32_swap_b32 v110, v111
    v_sub_f32 v96, 1.0, v110
    v_sub_f32 v97, 1.0, v111
    v_pk_mul_f32 v[216:217], v[216:217], v[96:97] op_sel:[0,0] op_sel_hi:[1,0]
    v_pk_mul_f32 v[218:219], v[218:219], v[96:97] op_sel:[0,0] op_sel_hi:[1,0]
    v_pk_mul_f32 v[220:221], v[220:221], v[96:97] op_sel:[0,0] op_sel_hi:[1,0]
    v_pk_mul_f32 v[222:223], v[222:223], v[96:97] op_sel:[0,0] op_sel_hi:[1,0]
    v_pk_mul_f32 v[224:225], v[224:225], v[96:97] op_sel:[0,1] op_sel_hi:[1,1]
    v_pk_mul_f32 v[226:227], v[226:227], v[96:97] op_sel:[0,1] op_sel_hi:[1,1]
    v_pk_mul_f32 v[228:229], v[228:229], v[96:97] op_sel:[0,1] op_sel_hi:[1,1]
    v_pk_mul_f32 v[230:231], v[230:231], v[96:97] op_sel:[0,1] op_sel_hi:[1,1]
    v_mov_b32 v109, 43016
    s_cmp_lg_u32 s3, 7
    s_cbranch_scc1 L_a5
    s_waitcnt vmcnt(0)
L_kd:
    buffer_load_dwordx4 v[128:131], v247, s[36:39], s15 offen sc1
    s_waitcnt vmcnt(0)
    v_xor_b32 v129, s59, v129
    v_bitop3_b32 v129, v131, s59, v129 bitop3:0xbe
    v_cmp_ne_u32 vcc, 0, v129
    v_max_u32 v128, v128, v130
    s_nop 0
    s_cbranch_vccz L_kd_ok
    s_sleep 2
    s_sub_u32 s90, s90, 1
    s_cbranch_scc0 L_kd
    s_mov_b32 s90, 0
L_kd_ok:
    v_max_u32_dpp v128, v128, v128 row_ror:8 row_mask:0xf bank_mask:0xf
    s_nop 1
    v_max_u32_dpp v128, v128, v128 row_ror:4 row_mask:0xf bank_mask:0xf
    s_nop 1
    v_max_u32_dpp v128, v128, v128 row_ror:2 row_mask:0xf bank_mask:0xf
    s_nop 1
    v_max_u32_dpp v128, v128, v128 row_ror:1 row_mask:0xf bank_mask:0xf
    s_nop 0
    v_readlane_b32 s97, v128, 0
    v_readlane_b32 s60, v128, 16
    v_readlane_b32 s61, v128, 32
    v_readlane_b32 s62, v128, 48
    s_max_u32 s97, s97, s60
    s_max_u32 s61, s61, s62
    s_max_u32 s97, s97, s61
    s_and_b32 s97, s97, 2047
    v_mov_b32 v108, s97
    ds_write_b32 v109, v108
    s_waitcnt lgkmcnt(0)
L_a5:
    s_barrier
    buffer_load_dwordx4 v[8:11], v5, s[36:39], s14 offen offset:0 sc1
    buffer_load_dwordx4 v[12:15], v5, s[36:39], s14 offen offset:2048 sc1
    ds_read_b32 v109, v109
    ds_read_b128 v[200:203], v247 offset:34816
    ds_read_b128 v[204:207], v247 offset:35840
    ds_read_b128 v[208:211], v247 offset:36864
    ds_read_b128 v[212:215], v247 offset:37888
    ds_read_b128 v[152:155], v247 offset:32768
    ds_read_b128 v[156:159], v247 offset:33792
    ds_read_b128 v[168:171], v247 offset:38912
    ds_read_b128 v[172:175], v247 offset:39936
    ds_read_b128 v[176:179], v247 offset:40960
    ds_read_b128 v[180:183], v247 offset:41984
    s_waitcnt lgkmcnt(0)
    v_readfirstlane_b32 s97, v109
    v_pk_mul_f32 v[184:185], v[200:201], v[110:111] op_sel:[0,0] op_sel_hi:[1,0]
    v_pk_mul_f32 v[186:187], v[202:203], v[110:111] op_sel:[0,0] op_sel_hi:[1,0]
    v_pk_mul_f32 v[188:189], v[204:205], v[110:111] op_sel:[0,0] op_sel_hi:[1,0]
    v_pk_mul_f32 v[190:191], v[206:207], v[110:111] op_sel:[0,0] op_sel_hi:[1,0]
    v_pk_mul_f32 v[192:193], v[208:209], v[110:111] op_sel:[0,0] op_sel_hi:[1,0]
    v_pk_mul_f32 v[194:195], v[210:211], v[110:111] op_sel:[0,0] op_sel_hi:[1,0]
    v_pk_mul_f32 v[196:197], v[212:213], v[110:111] op_sel:[0,0] op_sel_hi:[1,0]
    v_pk_mul_f32 v[198:199], v[214:215], v[110:111] op_sel:[0,0] op_sel_hi:[1,0]
    v_pk_mul_f32 v[200:201], v[200:201], v[110:111] op_sel:[0,1] op_sel_hi:[1,1]
    v_pk_mul_f32 v[202:203], v[202:203], v[110:111] op_sel:[0,1] op_sel_hi:[1,1]
    v_pk_mul_f32 v[204:205], v[204:205], v[110:111] op_sel:[0,1] op_sel_hi:[1,1]
    v_pk_mul_f32 v[206:207], v[206:207], v[110:111] op_sel:[0,1] op_sel_hi:[1,1]
    v_pk_mul_f32 v[208:209], v[208:209], v[110:111] op_sel:[0,1] op_sel_hi:[1,1]
    v_pk_mul_f32 v[210:211], v[210:211], v[110:111] op_sel:[0,1] op_sel_hi:[1,1]
    v_pk_mul_f32 v[212:213], v[212:213], v[110:111] op_sel:[0,1] op_sel_hi:[1,1]
    v_pk_mul_f32 v[214:215], v[214:215], v[110:111] op_sel:[0,1] op_sel_hi:[1,1]
    v_mov_b32 v96, 0x80000000
    v_xor_b32 v160, v96, v152
    v_xor_b32 v164, v96, v156
    v_xor_b32 v161, v96, v153
    v_xor_b32 v165, v96, v157
    v_xor_b32 v162, v96, v154
    v_xor_b32 v166, v96, v158
    v_xor_b32 v163, v96, v155
    v_xor_b32 v167, v96, v159
    s_branch L_a_pw
L_a_pl:
    buffer_load_dwordx4 v[8:11], v5, s[36:39], s14 offen offset:0 sc1
    buffer_load_dwordx4 v[12:15], v5, s[36:39], s14 offen offset:2048 sc1
L_a_pw:
    s_waitcnt vmcnt(0)
    v_swap_b32 v10, v12
    v_swap_b32 v11, v13
    v_xor_b32 v96, v104, v8
    v_xor_b32 v97, v105, v9
    v_mfma_f32_16x16x32_bf16 v[64:67], v[144:147], v[8:11], 0
    v_bitop3_b32 v96, v10, v104, v96 bitop3:0xbe
    v_bitop3_b32 v97, v11, v105, v97 bitop3:0xbe
    v_mfma_f32_16x16x32_bf16 v[68:71], v[148:151], v[8:11], 0
    v_bitop3_b32 v96, v12, v104, v96 bitop3:0xbe
    v_bitop3_b32 v97, v13, v105, v97 bitop3:0xbe
    v_mfma_f32_16x16x32_bf16 v[72:75], v[144:147], v[12:15], 0
    v_bitop3_b32 v96, v14, v104, v96 bitop3:0xbe
    v_bitop3_b32 v97, v15, v105, v97 bitop3:0xbe
    v_mfma_f32_16x16x32_bf16 v[76:79], v[148:151], v[12:15], 0
    v_bitop3_b32 v96, v96, v97, v106 bitop3:0xa8
    v_cmp_ne_u32 vcc, 0, v96
    s_nop 0
    s_cbranch_vccz L_a_pl_ok
    s_sleep 1
    s_sub_u32 s90, s90, 1
    s_cbranch_scc0 L_a_pl
    s_mov_b32 s90, 0
L_a_pl_ok:
    v_cvt_pk_bf16_f32 v16, v64, v68
    v_cvt_pk_bf16_f32 v17, v65, v69
    ds_write2st64_b32 v6, v16, v17 offset0:0 offset1:4
    v_cvt_pk_bf16_f32 v18, v66, v70
    v_cvt_pk_bf16_f32 v19, v67, v71
    ds_write2st64_b32 v6, v18, v19 offset0:8 offset1:12
    v_cvt_pk_bf16_f32 v20, v72, v76
    v_cvt_pk_bf16_f32 v21, v73, v77
    ds_write2st64_b32 v7, v20, v21 offset0:2 offset1:6
    v_cvt_pk_bf16_f32 v22, v74, v78
    v_cvt_pk_bf16_f32 v23, v75, v79
    ds_write2st64_b32 v7, v22, v23 offset0:10 offset1:14
    s_waitcnt lgkmcnt(0)
    s_barrier
    ds_read_b128 v[16:19], v62 offset:0
    ds_read_b128 v[20:23], v62 offset:1024
    s_waitcnt lgkmcnt(1)
    v_mfma_f32_16x16x32_bf16 v[64:67], v[16:19], v[152:155], 0
    v_mfma_f32_16x16x32_bf16 v[68:71], v[16:19], v[156:159], 0
    s_waitcnt lgkmcnt(0)
    v_mfma_f32_16x16x32_bf16 v[72:75], v[20:23], v[152:155], 0
    v_mfma_f32_16x16x32_bf16 v[76:79], v[20:23], v[156:159], 0
    s_nop 3
    v_pk_mul_f32 v[96:97], v[64:65], v[184:185]
    v_pk_mul_f32 v[100:101], v[68:69], v[184:185]
    v_pk_mul_f32 v[98:99], v[66:67], v[186:187]
    v_pk_mul_f32 v[102:103], v[70:71], v[186:187]
    v_pk_fma_f32 v[96:97], v[68:69], v[188:189], v[96:97]
    v_pk_fma_f32 v[100:101], v[64:65], v[188:189], v[100:101] neg_lo:[1,0,0] neg_hi:[1,0,0]
    v_pk_fma_f32 v[98:99], v[70:71], v[190:191], v[98:99]
    v_pk_fma_f32 v[102:103], v[66:67], v[190:191], v[102:103] neg_lo:[1,0,0] neg_hi:[1,0,0]
    v_mfma_f32_16x16x32_bf16 v[80:83], v[16:19], v[160:163], 0
    v_cvt_pk_bf16_f32 v112, v96, v100
    v_cvt_pk_bf16_f32 v113, v97, v101
    v_mfma_f32_16x16x32_bf16 v[84:87], v[16:19], v[164:167], 0
    v_cvt_pk_bf16_f32 v114, v98, v102
    v_cvt_pk_bf16_f32 v115, v99, v103
    v_pk_mul_f32 v[24:25], v[72:73], v[192:193]
    v_pk_mul_f32 v[28:29], v[76:77], v[192:193]
    v_pk_mul_f32 v[26:27], v[74:75], v[194:195]
    v_pk_mul_f32 v[30:31], v[78:79], v[194:195]
    v_pk_fma_f32 v[24:25], v[76:77], v[196:197], v[24:25]
    v_pk_fma_f32 v[28:29], v[72:73], v[196:197], v[28:29] neg_lo:[1,0,0] neg_hi:[1,0,0]
    v_pk_fma_f32 v[26:27], v[78:79], v[198:199], v[26:27]
    v_pk_fma_f32 v[30:31], v[74:75], v[198:199], v[30:31] neg_lo:[1,0,0] neg_hi:[1,0,0]
    v_mfma_f32_16x16x32_bf16 v[88:91], v[20:23], v[160:163], 0
    v_cvt_pk_bf16_f32 v116, v24, v28
    v_cvt_pk_bf16_f32 v117, v25, v29
    v_mfma_f32_16x16x32_bf16 v[92:95], v[20:23], v[164:167], 0
    v_cvt_pk_bf16_f32 v118, v26, v30
    v_cvt_pk_bf16_f32 v119, v27, v31
    v_pk_mul_f32 v[96:97], v[80:81], v[200:201]
    v_pk_mul_f32 v[100:101], v[84:85], v[200:201]
    v_pk_mul_f32 v[98:99], v[82:83], v[202:203]
    v_pk_mul_f32 v[102:103], v[86:87], v[202:203]
    v_pk_fma_f32 v[96:97], v[84:85], v[204:205], v[96:97]
    v_pk_fma_f32 v[100:101], v[80:81], v[204:205], v[100:101] neg_lo:[1,0,0] neg_hi:[1,0,0]
    v_pk_fma_f32 v[98:99], v[86:87], v[206:207], v[98:99]
    v_pk_fma_f32 v[102:103], v[82:83], v[206:207], v[102:103] neg_lo:[1,0,0] neg_hi:[1,0,0]
    v_mfma_f32_16x16x32_bf16 v[232:235], v[112:115], v[168:171], v[216:219]
    v_cvt_pk_bf16_f32 v120, v96, v100
    v_cvt_pk_bf16_f32 v121, v97, v101
    v_mfma_f32_16x16x32_bf16 v[236:239], v[112:115], v[172:175], v[220:223]
    v_cvt_pk_bf16_f32 v122, v98, v102
    v_cvt_pk_bf16_f32 v123, v99, v103
    v_pk_mul_f32 v[24:25], v[88:89], v[208:209]
    v_pk_mul_f32 v[28:29], v[92:93], v[208:209]
    v_pk_mul_f32 v[26:27], v[90:91], v[210:211]
    v_pk_mul_f32 v[30:31], v[94:95], v[210:211]
    v_pk_fma_f32 v[24:25], v[92:93], v[212:213], v[24:25]
    v_pk_fma_f32 v[28:29], v[88:89], v[212:213], v[28:29] neg_lo:[1,0,0] neg_hi:[1,0,0]
    v_pk_fma_f32 v[26:27], v[94:95], v[214:215], v[26:27]
    v_pk_fma_f32 v[30:31], v[90:91], v[214:215], v[30:31] neg_lo:[1,0,0] neg_hi:[1,0,0]
    v_mfma_f32_16x16x32_bf16 v[232:235], v[116:119], v[176:179], v[232:235]
    v_cvt_pk_bf16_f32 v124, v24, v28
    v_cvt_pk_bf16_f32 v125, v25, v29
    v_mfma_f32_16x16x32_bf16 v[236:239], v[116:119], v[180:183], v[236:239]
    v_cvt_pk_bf16_f32 v126, v26, v30
    v_cvt_pk_bf16_f32 v127, v27, v31
    v_mfma_f32_16x16x32_bf16 v[240:243], v[120:123], v[168:171], v[224:227]
    v_mfma_f32_16x16x32_bf16 v[244:247], v[120:123], v[172:175], v[228:231]
    v_mfma_f32_16x16x32_bf16 v[240:243], v[124:127], v[176:179], v[240:243]
    v_cvt_pk_bf16_f32 v8, v232, v233
    v_cvt_pk_bf16_f32 v9, v234, v235
    v_mfma_f32_16x16x32_bf16 v[244:247], v[124:127], v[180:183], v[244:247]
    v_cvt_pk_bf16_f32 v10, v236, v237
    v_cvt_pk_bf16_f32 v11, v238, v239
    s_nop 0
    v_permlane16_swap_b32 v8, v10
    v_permlane16_swap_b32 v9, v11
    s_cmp_eq_u32 s93, s97
    s_cbranch_scc1 L_sk1
    buffer_store_dwordx4 v[8:11], v4, s[40:43], s12 offen sc1
L_sk1:
    v_cvt_pk_bf16_f32 v12, v240, v241
    v_cvt_pk_bf16_f32 v13, v242, v243
    v_cvt_pk_bf16_f32 v14, v244, v245
    v_cvt_pk_bf16_f32 v15, v246, v247
    s_nop 0
    v_permlane16_swap_b32 v12, v14
    v_permlane16_swap_b32 v13, v15
    s_cmp_eq_u32 s94, s97
    s_cbranch_scc1 L_sk2
    s_and_b32 s60, s58, 127
    s_cbranch_scc0 L_sk2
    buffer_store_dwordx4 v[12:15], v4, s[40:43], s13 offen sc1
L_sk2:
    s_endpgm
L_ack128:
    s_mov_b64 exec, 1
    v_mov_b32 v96, 0x1000
    v_mov_b32 v97, s59
    buffer_store_dword v97, v96, s[36:39], 0 offen sc1
    s_mov_b64 exec, -1
    s_branch L_nos2
L_low:
    s_lshl_b32 s60, s56, 3
    s_mul_i32 s62, s56, 6
    s_add_u32 s62, s62, 8
    s_cmp_lt_u32 s56, 4
    s_cselect_b32 s60, s60, s62
    s_cselect_b32 s61, 8, 6
    s_and_b32 s62, s57, 7
    s_add_u32 s58, s60, s62
    s_cmp_ge_u32 s62, s61
    s_cbranch_scc1 L_misc
    s_cmp_lt_u32 s57, 8
    s_cbranch_scc1 L_f
    v_lshrrev_b32 v4, 1, v0
    v_and_b32 v5, 1, v0
    v_lshlrev_b32 v5, 6, v5
    s_lshl_b32 s61, s3, 5
    v_add_u32 v4, s61, v4
    v_lshl_add_u32 v6, v4, 7, v5
    v_mul_u32_u24 v4, 3584, v4
    v_add_u32 v4, v4, v5
    s_lshr_b32 s60, s58, 1
    s_lshl_b32 s60, s60, 7
    s_bitcmp1_b32 s58, 0
    s_cselect_b32 s61, 917504, 0
    s_cselect_b32 s62, 229376, 0
    s_add_u32 s61, s61, s60
    s_add_u32 s62, s62, s60
    s_waitcnt lgkmcnt(0)
    s_mov_b32 s44, s18
    s_mov_b32 s45, s19
    s_mov_b32 s46, 0x1c0000
    s_mov_b32 s47, 0x20000
    s_mov_b32 s48, s20
    s_mov_b32 s49, s21
    s_mov_b32 s50, 0x1c0000
    s_mov_b32 s51, 0x20000
    buffer_load_dword v8, v4, s[48:51], s61 offen
    s_mov_b32 s52, s22
    s_mov_b32 s53, s23
    s_mov_b32 s54, 0x1c0000
    s_mov_b32 s55, 0x20000
    s_lshl_b32 s62, s58, 15
    s_barrier
    buffer_load_dword v10, v6, s[52:55], s62 offen
    s_endpgm
L_misc:
    s_cmp_eq_u32 s57, 7
    s_cbranch_scc1 L_fin
    s_cmp_eq_u32 s57, 14
    s_cbranch_scc1 L_fin
    s_cmp_eq_u32 s57, 15
    s_cbranch_scc1 L_w
    s_cmp_lg_u32 s56, 4
    s_cbranch_scc1 L_end
    s_mov_b32 s58, 128
    s_mov_b32 s9, 0
    s_mov_b32 s57, 15
    s_branch L_a
L_w:
    s_endpgm
    s_and_b32 s60, s56, 3
    s_lshl3_add_u32 s60, s60, s3
    s_lshl_b32 s61, s60, 12
    s_add_u32 s61, s61, 0x40000
    v_lshlrev_b32 v4, 6, v2
    v_lshl_add_u32 v4, v3, 11, v4
    v_lshlrev_b32 v6, 6, v0
    v_mov_b32 v5, 0
    s_waitcnt lgkmcnt(0)
    s_mov_b32 s36, s30
    s_mov_b32 s37, s31
    s_mov_b32 s38, 0x400000
    s_mov_b32 s39, 0x20000
    s_mov_b32 exec_hi, 0
    buffer_atomic_or v5, v4, s[36:39], s61 offen sc1
    s_cmp_lg_u32 s60, 0
    s_cbranch_scc1 L_end
    s_movk_i32 s61, 0x2000
    buffer_atomic_or v5, v6, s[36:39], s61 offen sc1
    s_endpgm
L_f:
    s_lshr_b32 s95, s58, 1
    s_xor_b32 s98, s3, 7
    v_lshrrev_b32 v8, 3, v0
    v_and_b32 v9, 2, v8
    v_and_b32 v10, 7, v0
    v_xor_b32 v9, v9, v10
    v_lshlrev_b32 v9, 4, v9
    v_lshl_add_u32 v5, v8, 10, v9
    v_xor_b32 v6, 64, v5
    s_lshl_b32 s13, s58, 15
    s_lshl_b32 s61, s3, 7
    s_add_u32 s13, s13, s61
    s_lshl_b32 s6, s3, 12
    s_add_u32 s6, s6, 65536
    s_waitcnt lgkmcnt(0)
    s_load_dword s59, s[30:31], 0
    s_mov_b32 s32, s4
    s_mov_b32 s33, s5
    s_mov_b32 s34, 0x200000
    s_mov_b32 s35, 0x20000
    s_mov_b32 s36, s30
    s_mov_b32 s37, s31
    s_mov_b32 s38, 0x400000
    s_mov_b32 s39, 0x20000
    s_mov_b32 s52, s22
    s_mov_b32 s53, s23
    s_mov_b32 s54, 0x1c0000
    s_mov_b32 s55, 0x20000
    s_waitcnt lgkmcnt(0)
    s_add_u32 s59, s59, 0x9e3779b9
    s_bitcmp1_b32 s59, 0
    s_cselect_b32 s91, 1, 0x10000
    s_xor_b32 s92, s91, 0x10001
    s_cmp_lt_u32 s98, 4
    s_cselect_b32 s44, s18, s20
    s_cselect_b32 s45, s19, s21
    s_mov_b32 s46, 0x1c0000
    s_mov_b32 s47, 0x20000
    v_lshrrev_b32 v8, 2, v0
    v_mul_u32_u24 v4, 3584, v8
    v_lshrrev_b32 v8, 2, v8
    v_and_b32 v8, 2, v8
    v_and_b32 v9, 3, v0
    v_xor_b32 v8, v8, v9
    v_lshl_add_u32 v4, v8, 4, v4
    s_and_b32 s60, s98, 3
    s_mul_i32 s12, s60, 458752
    s_lshl_b32 s61, s58, 6
    s_add_u32 s12, s12, s61
    s_lshl_b32 s14, s3, 13
    s_cmp_ge_u32 s98, 1
    s_cbranch_scc1 L_fd0
    s_add_u32 m0, s14, 0
    s_nop 0
    buffer_load_dwordx4 v4, s[44:47], s12 offen lds
    s_add_u32 s12, s12, 57344
    s_add_u32 m0, s14, 1024
    s_nop 0
    buffer_load_dwordx4 v4, s[44:47], s12 offen lds
    s_add_u32 s12, s12, 57344
    s_add_u32 m0, s14, 2048
    s_nop 0
    buffer_load_dwordx4 v4, s[44:47], s12 offen lds
    s_add_u32 s12, s12, 57344
    s_add_u32 m0, s14, 3072
    s_nop 0
    buffer_load_dwordx4 v4, s[44:47], s12 offen lds
    s_add_u32 s12, s12, 57344
    s_add_u32 m0, s14, 4096
    s_nop 0
    buffer_load_dwordx4 v4, s[44:47], s12 offen lds
    s_add_u32 s12, s12, 57344
    s_add_u32 m0, s14, 5120
    s_nop 0
    buffer_load_dwordx4 v4, s[44:47], s12 offen lds
    s_add_u32 s12, s12, 57344
    s_add_u32 m0, s14, 6144
    s_nop 0
    buffer_load_dwordx4 v4, s[44:47], s12 offen lds
    s_add_u32 s12, s12, 57344
    s_add_u32 m0, s14, 7168
    s_nop 0
    buffer_load_dwordx4 v4, s[44:47], s12 offen lds
L_fd0:
    v_lshrrev_b32 v8, 2, v2
    v_lshl_add_u32 v9, v3, 3, v8
    v_and_b32 v10, 3, v0
    v_lshlrev_b32 v10, 3, v10
    v_and_b32 v11, 1, v3
    v_lshl_add_u32 v7, v9, 6, v10
    v_lshl_add_u32 v7, v11, 5, v7
    v_add_u32 v7, s14, v7
    v_xor_b32 v12, 32, v7
    v_lshrrev_b32 v8, 1, v8
    v_lshl_add_u32 v8, v11, 1, v8
    v_lshl_add_u32 v112, v9, 7, v10
    v_lshl_add_u32 v112, v8, 5, v112
    v_add_u32 v112, s6, v112
    v_xor_b32 v113, 32, v112
    v_xor_b32 v114, 64, v112
    v_xor_b32 v115, 96, v112
    s_and_b32 s60, s98, 3
    s_lshl_b32 s60, s60, 8
    s_add_u32 s60, s60, 98304
    v_lshlrev_b32 v14, 4, v3
    v_add_u32 v15, s60, v14
    s_lshl_b32 s60, s98, 7
    s_add_u32 s60, s60, 99328
    v_add_u32 v107, s60, v14
    v_lshl_add_u32 v111, v3, 5, v10
    v_add_u32 v111, 99328, v111
    v_lshlrev_b32 v108, 3, v3
    v_lshl_add_u32 v108, v2, 5, v108
    s_mul_i32 s8, s3, 7168
    s_lshl_b32 s61, s58, 7
    s_add_u32 s8, s8, s61
    s_add_u32 s8, s8, 0x10000
    s_and_b32 s15, s95, 31
    s_lshl_b32 s15, s15, 11
    s_add_u32 s15, s15, 0x40000
    v_lshlrev_b32 v134, 3, v0
    v_lshlrev_b32 v133, 4, v0
    v_mov_b32 v104, s91
    v_mov_b32 v105, s92
    v_mov_b32 v106, 0x00010001
    v_lshlrev_b32 v118, 1, v0
    v_and_b32 v117, 2, v0
    v_cmp_eq_u32 vcc, 0, v117
    s_nop 1
    v_cndmask_b32 v117, v105, v104, vcc
    s_lshl_b32 s7, s58, 2
    s_add_u32 s7, s7, 0x2000
    v_lshlrev_b32 v122, 8, v0
    v_mov_b32 v123, s59
    s_cmp_ge_u32 s98, 1
    s_cbranch_scc1 L_fd1
    s_waitcnt vmcnt(0)
    s_barrier
    s_waitcnt vmcnt(6)
    ds_read_b64_tr_b16 v[16:17], v7 offset:0
    ds_read_b64_tr_b16 v[18:19], v7 offset:256
    ds_read_b64_tr_b16 v[20:21], v12 offset:0
    ds_read_b64_tr_b16 v[22:23], v12 offset:256
    s_waitcnt vmcnt(4)
    ds_read_b64_tr_b16 v[24:25], v7 offset:2048
    ds_read_b64_tr_b16 v[26:27], v7 offset:2304
    ds_read_b64_tr_b16 v[28:29], v12 offset:2048
    ds_read_b64_tr_b16 v[30:31], v12 offset:2304
    s_waitcnt vmcnt(2)
    ds_read_b64_tr_b16 v[32:33], v7 offset:4096
    ds_read_b64_tr_b16 v[34:35], v7 offset:4352
    ds_read_b64_tr_b16 v[36:37], v12 offset:4096
    ds_read_b64_tr_b16 v[38:39], v12 offset:4352
    s_waitcnt vmcnt(0)
    ds_read_b64_tr_b16 v[40:41], v7 offset:6144
    ds_read_b64_tr_b16 v[42:43], v7 offset:6400
    ds_read_b64_tr_b16 v[44:45], v12 offset:6144
    ds_read_b64_tr_b16 v[46:47], v12 offset:6400
    s_barrier
    s_add_u32 m0, s6, 0
    s_nop 0
    buffer_load_dwordx4 v5, s[52:55], s13 offen lds
    s_add_u32 s13, s13, 8192
    s_add_u32 m0, s6, 1024
    s_nop 0
    buffer_load_dwordx4 v6, s[52:55], s13 offen lds
    s_add_u32 s13, s13, 8192
    s_add_u32 m0, s6, 2048
    s_nop 0
    buffer_load_dwordx4 v5, s[52:55], s13 offen lds
    s_add_u32 s13, s13, 8192
    s_add_u32 m0, s6, 3072
    s_nop 0
    buffer_load_dwordx4 v6, s[52:55], s13 offen lds
    s_branch L_f2
L_fd1:
    s_barrier
    s_cmp_lg_u32 s3, 2
    s_cbranch_scc1 L_f1
    s_add_u32 m0, s14, 0
    s_nop 0
    buffer_load_dwordx4 v4, s[44:47], s12 offen lds
    s_add_u32 s12, s12, 57344
    s_add_u32 m0, s14, 1024
    s_nop 0
    buffer_load_dwordx4 v4, s[44:47], s12 offen lds
    s_add_u32 s12, s12, 57344
    s_add_u32 m0, s14, 2048
    s_nop 0
    buffer_load_dwordx4 v4, s[44:47], s12 offen lds
    s_add_u32 s12, s12, 57344
    s_add_u32 m0, s14, 3072
    s_nop 0
    buffer_load_dwordx4 v4, s[44:47], s12 offen lds
    s_add_u32 s12, s12, 57344
    s_add_u32 m0, s14, 4096
    s_nop 0
    buffer_load_dwordx4 v4, s[44:47], s12 offen lds
    s_add_u32 s12, s12, 57344
    s_add_u32 m0, s14, 5120
    s_nop 0
    buffer_load_dwordx4 v4, s[44:47], s12 offen lds
    s_add_u32 s12, s12, 57344
    s_add_u32 m0, s14, 6144
    s_nop 0
    buffer_load_dwordx4 v4, s[44:47], s12 offen lds
    s_add_u32 s12, s12, 57344
    s_add_u32 m0, s14, 7168
    s_nop 0
    buffer_load_dwordx4 v4, s[44:47], s12 offen lds
    s_waitcnt vmcnt(0)
    buffer_load_dwordx4 v[128:131], v247, s[36:39], s15 offen sc1
    s_barrier
    s_waitcnt vmcnt(0)
    v_xor_b32 v129, s59, v129
    v_bitop3_b32 v129, v131, s59, v129 bitop3:0xbe
    v_cmp_ne_u32 vcc, 0, v129
    v_max_u32 v128, v128, v130
    s_nop 0
    s_cbranch_vccz L_f1a
L_pk3:
    buffer_load_dwordx4 v[128:131], v133, s[36:39], s15 offen sc1
L_pk3_w:
    s_waitcnt vmcnt(0)
    v_xor_b32 v129, s59, v129
    v_bitop3_b32 v129, v131, s59, v129 bitop3:0xbe
    v_cmp_ne_u32 vcc, 0, v129
    v_max_u32 v128, v128, v130
    s_nop 0
    s_cbranch_vccz L_pk3_ok
    s_sleep 1
    s_sub_u32 s90, s90, 1
    s_cbranch_scc0 L_pk3
    s_mov_b32 s90, 0
L_pk3_ok:
    v_max_u32_dpp v128, v128, v128 row_ror:8 row_mask:0xf bank_mask:0xf
    s_nop 1
    v_max_u32_dpp v128, v128, v128 row_ror:4 row_mask:0xf bank_mask:0xf
    s_nop 1
    v_max_u32_dpp v128, v128, v128 row_ror:2 row_mask:0xf bank_mask:0xf
    s_nop 1
    v_max_u32_dpp v128, v128, v128 row_ror:1 row_mask:0xf bank_mask:0xf
    s_nop 0
    v_readlane_b32 s97, v128, 0
    v_readlane_b32 s60, v128, 16
    v_readlane_b32 s61, v128, 32
    v_readlane_b32 s62, v128, 48
    s_max_u32 s97, s97, s60
    s_max_u32 s61, s61, s62
    s_max_u32 s97, s97, s61
    s_branch L_f1b
L_f1a:
    v_max_u32_dpp v128, v128, v128 row_ror:8 row_mask:0xf bank_mask:0xf
    s_nop 1
    v_max_u32_dpp v128, v128, v128 row_ror:4 row_mask:0xf bank_mask:0xf
    s_nop 1
    v_max_u32_dpp v128, v128, v128 row_ror:2 row_mask:0xf bank_mask:0xf
    s_nop 1
    v_max_u32_dpp v128, v128, v128 row_ror:1 row_mask:0xf bank_mask:0xf
    s_nop 0
    v_readlane_b32 s97, v128, 0
    v_readlane_b32 s60, v128, 16
    v_readlane_b32 s61, v128, 32
    v_readlane_b32 s62, v128, 48
    s_max_u32 s97, s97, s60
    s_max_u32 s61, s61, s62
    s_max_u32 s97, s97, s61
L_f1b:
    s_and_b32 s97, s97, 2047
    s_lshl_b32 s60, s97, 10
    s_mov_b32 m0, 98304
    s_nop 0
    buffer_load_dwordx4 v247, s[32:35], s60 offen lds
    s_add_u32 m0, s6, 0
    s_nop 0
    buffer_load_dwordx4 v5, s[52:55], s13 offen lds
    s_add_u32 s13, s13, 8192
    s_add_u32 m0, s6, 1024
    s_nop 0
    buffer_load_dwordx4 v6, s[52:55], s13 offen lds
    s_add_u32 s13, s13, 8192
    s_add_u32 m0, s6, 2048
    s_nop 0
    buffer_load_dwordx4 v5, s[52:55], s13 offen lds
    s_add_u32 s13, s13, 8192
    s_add_u32 m0, s6, 3072
    s_nop 0
    buffer_load_dwordx4 v6, s[52:55], s13 offen lds
    s_waitcnt vmcnt(14)
    ds_read_b64_tr_b16 v[16:17], v7 offset:0
    ds_read_b64_tr_b16 v[18:19], v7 offset:256
    ds_read_b64_tr_b16 v[20:21], v12 offset:0
    ds_read_b64_tr_b16 v[22:23], v12 offset:256
    s_waitcnt vmcnt(12)
    ds_read_b64_tr_b16 v[24:25], v7 offset:2048
    ds_read_b64_tr_b16 v[26:27], v7 offset:2304
    ds_read_b64_tr_b16 v[28:29], v12 offset:2048
    ds_read_b64_tr_b16 v[30:31], v12 offset:2304
    s_waitcnt vmcnt(10)
    ds_read_b64_tr_b16 v[32:33], v7 offset:4096
    ds_read_b64_tr_b16 v[34:35], v7 offset:4352
    ds_read_b64_tr_b16 v[36:37], v12 offset:4096
    ds_read_b64_tr_b16 v[38:39], v12 offset:4352
    s_waitcnt vmcnt(8)
    ds_read_b64_tr_b16 v[40:41], v7 offset:6144
    ds_read_b64_tr_b16 v[42:43], v7 offset:6400
    ds_read_b64_tr_b16 v[44:45], v12 offset:6144
    ds_read_b64_tr_b16 v[46:47], v12 offset:6400
    s_waitcnt vmcnt(4)
    s_branch L_f2
L_f1:
    s_add_u32 m0, s14, 0
    s_nop 0
    buffer_load_dwordx4 v4, s[44:47], s12 offen lds
    s_add_u32 s12, s12, 57344
    s_add_u32 m0, s14, 1024
    s_nop 0
    buffer_load_dwordx4 v4, s[44:47], s12 offen lds
    s_add_u32 s12, s12, 57344
    s_add_u32 m0, s14, 2048
    s_nop 0
    buffer_load_dwordx4 v4, s[44:47], s12 offen lds
    s_add_u32 s12, s12, 57344
    s_add_u32 m0, s14, 3072
    s_nop 0
    buffer_load_dwordx4 v4, s[44:47], s12 offen lds
    s_add_u32 s12, s12, 57344
    s_add_u32 m0, s14, 4096
    s_nop 0
    buffer_load_dwordx4 v4, s[44:47], s12 offen lds
    s_add_u32 s12, s12, 57344
    s_add_u32 m0, s14, 5120
    s_nop 0
    buffer_load_dwordx4 v4, s[44:47], s12 offen lds
    s_add_u32 s12, s12, 57344
    s_add_u32 m0, s14, 6144
    s_nop 0
    buffer_load_dwordx4 v4, s[44:47], s12 offen lds
    s_add_u32 s12, s12, 57344
    s_add_u32 m0, s14, 7168
    s_nop 0
    buffer_load_dwordx4 v4, s[44:47], s12 offen lds
    s_barrier
    s_add_u32 m0, s6, 0
    s_nop 0
    buffer_load_dwordx4 v5, s[52:55], s13 offen lds
    s_add_u32 s13, s13, 8192
    s_add_u32 m0, s6, 1024
    s_nop 0
    buffer_load_dwordx4 v6, s[52:55], s13 offen lds
    s_add_u32 s13, s13, 8192
    s_add_u32 m0, s6, 2048
    s_nop 0
    buffer_load_dwordx4 v5, s[52:55], s13 offen lds
    s_add_u32 s13, s13, 8192
    s_add_u32 m0, s6, 3072
    s_nop 0
    buffer_load_dwordx4 v6, s[52:55], s13 offen lds
    s_waitcnt vmcnt(10)
    ds_read_b64_tr_b16 v[16:17], v7 offset:0
    ds_read_b64_tr_b16 v[18:19], v7 offset:256
    ds_read_b64_tr_b16 v[20:21], v12 offset:0
    ds_read_b64_tr_b16 v[22:23], v12 offset:256
    s_waitcnt vmcnt(8)
    ds_read_b64_tr_b16 v[24:25], v7 offset:2048
    ds_read_b64_tr_b16 v[26:27], v7 offset:2304
    ds_read_b64_tr_b16 v[28:29], v12 offset:2048
    ds_read_b64_tr_b16 v[30:31], v12 offset:2304
    s_waitcnt vmcnt(6)
    ds_read_b64_tr_b16 v[32:33], v7 offset:4096
    ds_read_b64_tr_b16 v[34:35], v7 offset:4352
    ds_read_b64_tr_b16 v[36:37], v12 offset:4096
    ds_read_b64_tr_b16 v[38:39], v12 offset:4352
    s_waitcnt vmcnt(4)
    ds_read_b64_tr_b16 v[40:41], v7 offset:6144
    ds_read_b64_tr_b16 v[42:43], v7 offset:6400
    ds_read_b64_tr_b16 v[44:45], v12 offset:6144
    ds_read_b64_tr_b16 v[46:47], v12 offset:6400
L_f2:
    s_waitcnt lgkmcnt(0)
    s_barrier
    ds_read_b128 v[64:67], v15 offset:0
    ds_read_b128 v[68:71], v15 offset:64
    ds_read_b128 v[72:75], v15 offset:128
    ds_read_b128 v[76:79], v15 offset:192
    s_waitcnt lgkmcnt(3)
    v_mfma_f32_16x16x32_bf16 v[80:83], v[16:19], v[64:67], 0
    v_mfma_f32_16x16x32_bf16 v[84:87], v[20:23], v[64:67], 0
    s_waitcnt lgkmcnt(2)
    v_mfma_f32_16x16x32_bf16 v[80:83], v[24:27], v[68:71], v[80:83]
    v_mfma_f32_16x16x32_bf16 v[84:87], v[28:31], v[68:71], v[84:87]
    s_waitcnt lgkmcnt(1)
    v_mfma_f32_16x16x32_bf16 v[80:83], v[32:35], v[72:75], v[80:83]
    v_mfma_f32_16x16x32_bf16 v[84:87], v[36:39], v[72:75], v[84:87]
    s_waitcnt lgkmcnt(0)
    v_mfma_f32_16x16x32_bf16 v[80:83], v[40:43], v[76:79], v[80:83]
    v_mfma_f32_16x16x32_bf16 v[84:87], v[44:47], v[76:79], v[84:87]
    s_mov_b32 exec_lo, 0x10001
    s_mov_b32 exec_hi, 0x10001
    s_nop 4
    ds_write_b128 v107, v[80:83] offset:0
    ds_write_b128 v107, v[84:87] offset:64
    s_mov_b64 exec, -1
    s_waitcnt lgkmcnt(0)
    s_barrier
    ds_read_b64 v[64:65], v111 offset:0
    ds_read_b64 v[66:67], v111 offset:128
    ds_read_b64 v[68:69], v111 offset:256
    ds_read_b64 v[70:71], v111 offset:384
    ds_read_b64 v[72:73], v111 offset:512
    ds_read_b64 v[74:75], v111 offset:640
    ds_read_b64 v[76:77], v111 offset:768
    ds_read_b64 v[78:79], v111 offset:896
    s_waitcnt vmcnt(0)
    ds_read_b64_tr_b16 v[48:49], v112 offset:0
    ds_read_b64_tr_b16 v[50:51], v112 offset:512
    ds_read_b64_tr_b16 v[52:53], v113 offset:0
    ds_read_b64_tr_b16 v[54:55], v113 offset:512
    ds_read_b64_tr_b16 v[56:57], v114 offset:0
    ds_read_b64_tr_b16 v[58:59], v114 offset:512
    ds_read_b64_tr_b16 v[60:61], v115 offset:0
    ds_read_b64_tr_b16 v[62:63], v115 offset:512
    s_waitcnt lgkmcnt(12)
    v_pk_add_f32 v[64:65], v[64:65], v[66:67]
    v_pk_add_f32 v[68:69], v[68:69], v[70:71]
    v_pk_add_f32 v[64:65], v[64:65], v[68:69]
    v_mul_f32 v67, 0xbfb8aa3b, v65
    v_mul_f32 v66, 0xbfb8aa3b, v64
    v_exp_f32 v67, v67
    v_exp_f32 v66, v66
    v_add_f32 v67, 1.0, v67
    v_add_f32 v66, 1.0, v66
    v_rcp_f32 v67, v67
    v_rcp_f32 v66, v66
    s_nop 0
    v_pk_mul_f32 v[64:65], v[64:65], v[66:67]
    s_waitcnt lgkmcnt(8)
    v_pk_add_f32 v[72:73], v[72:73], v[74:75]
    v_pk_add_f32 v[76:77], v[76:77], v[78:79]
    v_pk_add_f32 v[72:73], v[72:73], v[76:77]
    v_pk_mul_f32 v[64:65], v[64:65], v[72:73]
    v_cvt_pk_bf16_f32 v64, v64, v65
    s_nop 1
    v_mov_b32_dpp v72, v64 quad_perm:[0,0,0,0] row_mask:0xf bank_mask:0xf
    v_mov_b32_dpp v73, v64 quad_perm:[1,1,1,1] row_mask:0xf bank_mask:0xf
    v_mov_b32_dpp v74, v64 quad_perm:[2,2,2,2] row_mask:0xf bank_mask:0xf
    v_mov_b32_dpp v75, v64 quad_perm:[3,3,3,3] row_mask:0xf bank_mask:0xf
    s_waitcnt lgkmcnt(6)
    s_nop 0
    v_mfma_f32_16x16x32_bf16 v[88:91], v[72:75], v[48:51], 0
    s_waitcnt lgkmcnt(4)
    v_mfma_f32_16x16x32_bf16 v[92:95], v[72:75], v[52:55], 0
    s_waitcnt lgkmcnt(2)
    v_mfma_f32_16x16x32_bf16 v[96:99], v[72:75], v[56:59], 0
    s_waitcnt lgkmcnt(0)
    v_mfma_f32_16x16x32_bf16 v[100:103], v[72:75], v[60:63], 0
    s_mov_b32 exec_lo, 0xffff0000
    s_mov_b32 exec_hi, 0
    s_nop 1
    v_mov_b32 v88, v92
    s_mov_b32 exec_lo, 0
    s_mov_b32 exec_hi, 0xffff
    v_mov_b32 v88, v96
    s_mov_b32 exec_hi, 0xffff0000
    v_mov_b32 v88, v100
    s_mov_b64 exec, -1
    s_nop 0
    v_mov_b32_dpp v89, v88 quad_perm:[1,1,3,3] row_mask:0xf bank_mask:0xf
    v_cvt_pk_bf16_f32 v120, v88, v89
    s_mov_b32 exec_lo, 0x55555555
    s_mov_b32 exec_hi, 0x55555555
    v_bitop3_b32 v120, v106, v117, v120 bitop3:0xca
    buffer_store_dword v120, v118, s[36:39], s8 offen sc1
    s_mov_b64 exec, -1
    s_endpgm
    v_mfma_f32_16x16x32_bf16 v[88:91], v[48:51], v[72:75], 0
    v_mfma_f32_16x16x32_bf16 v[92:95], v[52:55], v[72:75], 0
    v_mfma_f32_16x16x32_bf16 v[96:99], v[56:59], v[72:75], 0
    v_mfma_f32_16x16x32_bf16 v[100:103], v[60:63], v[72:75], 0
    s_mov_b32 exec_lo, 0x10001
    s_mov_b32 exec_hi, 0x10001
    s_nop 2
    v_cvt_pk_bf16_f32 v120, v88, v89
    v_cvt_pk_bf16_f32 v121, v90, v91
    s_mov_b32 exec_lo, 0x20002
    s_mov_b32 exec_hi, 0x20002
    v_cvt_pk_bf16_f32 v120, v92, v93
    v_cvt_pk_bf16_f32 v121, v94, v95
    s_mov_b32 exec_lo, 0x40004
    s_mov_b32 exec_hi, 0x40004
    v_cvt_pk_bf16_f32 v120, v96, v97
    v_cvt_pk_bf16_f32 v121, v98, v99
    s_mov_b32 exec_lo, 0x80008
    s_mov_b32 exec_hi, 0x80008
    v_cvt_pk_bf16_f32 v120, v100, v101
    v_cvt_pk_bf16_f32 v121, v102, v103
    s_mov_b32 exec_lo, 0x000f000f
    s_mov_b32 exec_hi, 0x000f000f
    v_bitop3_b32 v120, v106, v104, v120 bitop3:0xca
    v_bitop3_b32 v121, v106, v105, v121 bitop3:0xca
    buffer_store_dwordx2 v[120:121], v108, s[36:39], s8 offen sc1
    s_mov_b64 exec, -1
    s_endpgm
L_fin:
    v_lshlrev_b32 v4, 5, v2
    v_and_b32 v96, 1, v3
    v_lshl_add_u32 v4, v96, 9, v4
    v_lshrrev_b32 v96, 1, v3
    v_lshl_add_u32 v4, v96, 4, v4
    s_add_u32 s95, s56, 24
    s_lshr_b32 s99, s57, 1
    s_and_b32 s99, s99, 4
    s_add_u32 s99, s99, s56
    s_sub_u32 s99, s99, 4
    s_waitcnt lgkmcnt(0)
    s_load_dword s59, s[30:31], 0
    s_mov_b32 s32, s4
    s_mov_b32 s33, s5
    s_mov_b32 s34, 0x200000
    s_mov_b32 s35, 0x20000
    s_mov_b32 s36, s30
    s_mov_b32 s37, s31
    s_mov_b32 s38, 0x400000
    s_mov_b32 s39, 0x20000
    s_mov_b32 s48, s24
    s_mov_b32 s49, s25
    s_mov_b32 s50, 0x400
    s_mov_b32 s51, 0x20000
    buffer_load_dwordx4 v[28:31], v4, s[48:51], 0 offen
    s_lshl_b32 s60, s3, 10
    v_lshl_add_u32 v248, v0, 4, s60
    s_add_u32 m0, s60, 32768
    global_load_lds_dwordx4 v248, s[10:11] offset:0
    s_and_b32 s63, s3, 1
    s_add_u32 s63, s63, 8
    s_lshl_b32 s60, s63, 10
    v_lshl_add_u32 v248, v0, 4, s60
    s_add_u32 m0, s60, 32768
    global_load_lds_dwordx4 v248, s[10:11] offset:0
    s_mov_b32 s40, s26
    s_mov_b32 s41, s27
    s_mov_b32 s42, 0x200000
    s_mov_b32 s43, 0x20000
    v_mov_b32 v252, s4
    v_mov_b32 v253, s5
    v_writelane_b32 v252, s26, 1
    v_writelane_b32 v253, s27, 1
    s_add_u32 s63, s30, 0x3000
    v_writelane_b32 v252, s63, 2
    s_addc_u32 s63, s31, 0
    v_writelane_b32 v253, s63, 2
    s_add_u32 s63, s30, 0x203000
    v_writelane_b32 v252, s63, 3
    s_addc_u32 s63, s31, 0
    v_writelane_b32 v253, s63, 3
    s_mov_b64 exec, 0xf
    global_load_dword v254, v[252:253], off
    s_mov_b64 exec, -1
    v_lshlrev_b32 v5, 12, v3
    v_lshl_add_u32 v5, v2, 4, v5
    v_lshrrev_b32 v96, 2, v2
    v_xor_b32 v96, v96, v3
    v_and_b32 v96, 1, v96
    v_bfe_u32 v97, v2, 1, 1
    v_lshl_or_b32 v96, v96, 1, v97
    s_lshr_b32 s60, s3, 1
    v_xor_b32 v96, s60, v96
    v_lshlrev_b32 v96, 4, v96
    v_and_b32 v98, 7, v2
    v_lshl_add_u32 v96, v98, 6, v96
    v_lshl_add_u32 v96, v3, 12, v96
    v_lshrrev_b32 v98, 3, v2
    v_lshl_add_u32 v96, v98, 2, v96
    s_and_b32 s60, s3, 1
    s_lshl_b32 s60, s60, 3
    s_add_u32 s60, s60, 16384
    v_add_u32 v6, s60, v96
    v_xor_b32 v7, 48, v6
    v_bfe_u32 v96, v2, 2, 1
    v_xor_b32 v96, v96, v98
    v_lshl_or_b32 v96, v96, 1, v98
    v_xor_b32 v96, v96, v97
    v_xor_b32 v96, v96, v3
    v_lshlrev_b32 v96, 4, v96
    v_lshl_add_u32 v62, v2, 6, v96
    s_and_b32 s15, s95, 31
    s_lshl_b32 s15, s15, 11
    s_add_u32 s15, s15, 0x40000
    v_lshlrev_b32 v134, 3, v0
    v_lshlrev_b32 v133, 4, v0
    s_mul_i32 s7, s99, 7168
    s_lshl_b32 s61, s3, 10
    s_add_u32 s7, s7, s61
    s_add_u32 s7, s7, 0xfc00
    v_and_b32 v108, 1, v3
    v_lshrrev_b32 v111, 1, v3
    v_lshl_add_u32 v108, v108, 1, v111
    v_and_b32 v107, 7, v2
    v_lshl_add_u32 v108, v2, 2, v108
    s_lshl_b32 s60, s3, 8
    s_add_u32 s60, s60, 43008
    v_lshl_add_u32 v108, v108, 2, s60
    v_and_b32 v111, 3, v2
    v_lshlrev_b32 v111, 6, v111
    v_lshl_add_u32 v111, v3, 4, v111
    v_mov_b32 v109, 43016
    s_waitcnt lgkmcnt(0)
    s_add_u32 s59, s59, 0x9e3779b9
    s_bitcmp1_b32 s59, 0
    s_cselect_b32 s91, 1, 0x10000
    s_xor_b32 s92, s91, 0x10001
    s_cmp_lg_u32 s3, 0
    s_cbranch_scc1 L_fin0
    s_cmp_eq_u32 s99, 0
    s_cbranch_scc1 L_fin0
    s_lshl_b32 s60, s99, 7
    v_mov_b32 v96, 0x1000
    v_mov_b32 v97, s59
    s_mov_b64 exec, 1
    buffer_store_dword v97, v96, s[36:39], s60 offen sc1
    s_mov_b64 exec, -1
L_fin0:
    v_mov_b32 v104, s91
    v_mov_b32 v105, s92
    v_mov_b32 v106, 0x00010001
    s_waitcnt vmcnt(0)
    s_barrier
    s_lshr_b32 s60, s99, 2
    s_lshl_b32 s60, s60, 10
    v_add_u32 v110, s60, v247
    ds_read_b128 v[152:155], v247 offset:32768
    ds_read_b128 v[156:159], v247 offset:33792
    ds_read_b128 v[184:187], v247 offset:34816
    ds_read_b128 v[188:191], v247 offset:35840
    ds_read_b128 v[192:195], v247 offset:36864
    ds_read_b128 v[196:199], v247 offset:37888
    ds_read_b128 v[168:171], v110 offset:38912
    ds_read_b128 v[172:175], v110 offset:40960
    s_cmp_lg_u32 s3, 0
    s_cbranch_scc1 L_fin1a
    v_mov_b32 v80, 0
    v_mov_b32 v81, 0
    v_mov_b32 v82, 0
    v_mov_b32 v83, 0
    buffer_atomic_or_x2 v[80:81], v134, s[36:39], s15 offen sc0 sc1
    buffer_atomic_or_x2 v[82:83], v134, s[36:39], s15 offen offset:512 sc0 sc1
    s_sleep 4
    v_mov_b32 v84, 0
    v_mov_b32 v85, 0
    v_mov_b32 v86, 0
    v_mov_b32 v87, 0
    buffer_atomic_or_x2 v[84:85], v134, s[36:39], s15 offen sc0 sc1
    buffer_atomic_or_x2 v[86:87], v134, s[36:39], s15 offen offset:512 sc0 sc1
    s_sleep 4
    v_mov_b32 v88, 0
    v_mov_b32 v89, 0
    v_mov_b32 v90, 0
    v_mov_b32 v91, 0
    buffer_atomic_or_x2 v[88:89], v134, s[36:39], s15 offen sc0 sc1
    buffer_atomic_or_x2 v[90:91], v134, s[36:39], s15 offen offset:512 sc0 sc1
L_kp4:
    s_waitcnt vmcnt(4)
    v_xor_b32 v129, s59, v81
    v_bitop3_b32 v129, v83, s59, v129 bitop3:0xbe
    v_cmp_ne_u32 vcc, 0, v129
    s_nop 0
    s_cbranch_vccz L_kp4_d0
    v_mov_b32 v80, 0
    v_mov_b32 v81, 0
    v_mov_b32 v82, 0
    v_mov_b32 v83, 0
    buffer_atomic_or_x2 v[80:81], v134, s[36:39], s15 offen sc0 sc1
    buffer_atomic_or_x2 v[82:83], v134, s[36:39], s15 offen offset:512 sc0 sc1
    s_waitcnt vmcnt(4)
    v_xor_b32 v129, s59, v85
    v_bitop3_b32 v129, v87, s59, v129 bitop3:0xbe
    v_cmp_ne_u32 vcc, 0, v129
    s_nop 0
    s_cbranch_vccz L_kp4_d1
    v_mov_b32 v84, 0
    v_mov_b32 v85, 0
    v_mov_b32 v86, 0
    v_mov_b32 v87, 0
    buffer_atomic_or_x2 v[84:85], v134, s[36:39], s15 offen sc0 sc1
    buffer_atomic_or_x2 v[86:87], v134, s[36:39], s15 offen offset:512 sc0 sc1
    s_waitcnt vmcnt(4)
    v_xor_b32 v129, s59, v89
    v_bitop3_b32 v129, v91, s59, v129 bitop3:0xbe
    v_cmp_ne_u32 vcc, 0, v129
    s_nop 0
    s_cbranch_vccz L_kp4_d2
    v_mov_b32 v88, 0
    v_mov_b32 v89, 0
    v_mov_b32 v90, 0
    v_mov_b32 v91, 0
    buffer_atomic_or_x2 v[88:89], v134, s[36:39], s15 offen sc0 sc1
    buffer_atomic_or_x2 v[90:91], v134, s[36:39], s15 offen offset:512 sc0 sc1
    s_sub_u32 s90, s90, 1
    s_cbranch_scc0 L_kp4
    s_waitcnt vmcnt(0)
L_kp4_d0:
    v_max_u32 v128, v80, v82
    s_branch L_kp4_x
L_kp4_d1:
    v_max_u32 v128, v84, v86
    s_branch L_kp4_x
L_kp4_d2:
    v_max_u32 v128, v88, v90
L_kp4_x:
    s_nop 1
    v_max_u32_dpp v128, v128, v128 row_ror:8 row_mask:0xf bank_mask:0xf
    s_nop 1
    v_max_u32_dpp v128, v128, v128 row_ror:4 row_mask:0xf bank_mask:0xf
    s_nop 1
    v_max_u32_dpp v128, v128, v128 row_ror:2 row_mask:0xf bank_mask:0xf
    s_nop 1
    v_max_u32_dpp v128, v128, v128 row_ror:1 row_mask:0xf bank_mask:0xf
    s_nop 0
    v_readlane_b32 s97, v128, 0
    v_readlane_b32 s60, v128, 16
    v_readlane_b32 s61, v128, 32
    v_readlane_b32 s62, v128, 48
    s_max_u32 s97, s97, s60
    s_max_u32 s61, s61, s62
    s_max_u32 s97, s97, s61
    v_mov_b32 v110, s97
    ds_write_b32 v109, v110
    s_and_b32 s60, s97, 2047
    s_lshl_b32 s12, s60, 10
    buffer_load_dwordx4 v[40:43], v4, s[32:35], s12 offen
    s_branch L_fin1
L_fin1a:
    s_lshl3_add_u32 s60, s99, s3
    s_cmp_lg_u32 s60, 2
    s_cbranch_scc1 L_fin1
    v_lshlrev_b32 v128, 7, v0
    s_mov_b64 exec, 0xff
    s_movk_i32 s60, 0x1000
L_ack:
    buffer_load_dword v129, v128, s[36:39], s60 offen sc1
    s_waitcnt vmcnt(0)
    v_cmp_ne_u32 vcc, s59, v129
    s_nop 0
    s_cbranch_vccz L_ack_ok
    s_sleep 1
    s_sub_u32 s90, s90, 1
    s_cbranch_scc0 L_ack
    s_mov_b32 s90, 0
L_ack_ok:
    s_mov_b64 exec, -1
L_fin1:
    s_waitcnt lgkmcnt(0)
    s_barrier
    ds_read_b32 v110, v109
    s_waitcnt lgkmcnt(0)
    v_readfirstlane_b32 s8, v110
    s_nop 0
    s_and_b32 s97, s8, 2047
    s_and_b32 s60, s97, 255
    s_and_b32 s61, s97, 15
    s_and_b32 s62, s97, 7
    s_cselect_b32 s60, s61, s60
    s_cselect_b32 s61, 8, 128
    s_cmp_gt_u32 s60, s61
    s_cselect_b32 s96, 0x80000000, 0
    s_sub_u32 s61, 2048, s97
    s_cmp_lg_u32 s96, 0
    s_cselect_b32 s60, s61, s97
    s_and_b32 s58, s60, 255
    s_lshr_b32 s98, s60, 8
    s_lshr_b32 s60, s58, 4
    s_and_b32 s61, s58, 15
    s_lshl4_add_u32 s9, s61, s60
    s_add_u32 s62, s60, s61
    s_cmp_eq_u32 s61, 8
    s_cselect_b32 s9, s62, s9
    s_cmp_eq_u32 s58, 128
    s_cselect_b32 s9, 0, s9
    s_lshl_b32 s14, s9, 14
    s_lshl_b32 s60, s3, 8
    s_add_u32 s14, s14, s60
    s_add_u32 s14, s14, 0x200000
    v_lshrrev_b32 v96, 1, v2
    v_lshlrev_b32 v96, 8, v96
    v_add_u32 v96, s58, v96
    v_and_b32 v97, 1, v2
    v_lshlrev_b32 v98, 1, v3
    v_mul_u32_u24 v98, v98, v96
    v_cmp_eq_u32 vcc, 0, v97
    v_and_b32 v99, 2047, v98
    v_add_u32 v98, v98, v96
    v_cvt_f32_u32 v99, v99
    v_mul_f32 v99, 0x3a000000, v99
    v_cos_f32 v100, v99
    v_sin_f32 v101, v99
    v_mul_f32 v100, 0.5, v100
    v_mul_f32 v101, 0.5, v101
    v_cndmask_b32_e64 v102, -v101, v100, vcc
    v_cndmask_b32 v103, v100, v101, vcc
    v_cvt_pk_bf16_f32 v144, v102, v103
    v_cvt_pk_bf16_f32 v148, -v103, v102
    v_cndmask_b32 v102, v101, v100, vcc
    v_cndmask_b32_e64 v103, -v100, v101, vcc
    v_cvt_pk_bf16_f32 v145, v102, -v103
    v_cvt_pk_bf16_f32 v149, -v103, -v102
    s_and_b32 s60, s58, 127
    s_cbranch_scc1 L_fin_a10
    v_add_f32 v100, v100, v100
    v_add_f32 v101, v101, v101
    v_cndmask_b32 v102, 0, v100, vcc
    v_sub_f32 v103, v100, v102
    v_cvt_pk_bf16_f32 v100, v102, v103
    v_cndmask_b32 v102, 0, v101, vcc
    v_sub_f32 v103, v101, v102
    v_cvt_pk_bf16_f32 v101, -v102, -v103
    s_cmp_eq_u32 s58, 0
    s_cselect_b32 s60, -1, 0
    s_cselect_b32 s61, 0, -1
    v_and_b32 v144, s60, v100
    v_and_b32 v148, s60, v101
    v_and_b32 v145, s61, v100
    v_and_b32 v149, s61, v101
L_fin_a10:
    v_and_b32 v99, 2047, v98
    v_cvt_f32_u32 v99, v99
    v_mul_f32 v99, 0x3a000000, v99
    v_cos_f32 v100, v99
    v_sin_f32 v101, v99
    v_mul_f32 v100, 0.5, v100
    v_mul_f32 v101, 0.5, v101
    v_cndmask_b32_e64 v102, -v101, v100, vcc
    v_cndmask_b32 v103, v100, v101, vcc
    v_cvt_pk_bf16_f32 v146, v102, v103
    v_cvt_pk_bf16_f32 v150, -v103, v102
    v_cndmask_b32 v102, v101, v100, vcc
    v_cndmask_b32_e64 v103, -v100, v101, vcc
    v_cvt_pk_bf16_f32 v147, v102, -v103
    v_cvt_pk_bf16_f32 v151, -v103, -v102
    s_and_b32 s60, s58, 127
    s_cbranch_scc1 L_fin_a11
    v_add_f32 v100, v100, v100
    v_add_f32 v101, v101, v101
    v_cndmask_b32 v102, 0, v100, vcc
    v_sub_f32 v103, v100, v102
    v_cvt_pk_bf16_f32 v100, v102, v103
    v_cndmask_b32 v102, 0, v101, vcc
    v_sub_f32 v103, v101, v102
    v_cvt_pk_bf16_f32 v101, -v102, -v103
    s_cmp_eq_u32 s58, 0
    s_cselect_b32 s60, -1, 0
    s_cselect_b32 s61, 0, -1
    v_and_b32 v146, s60, v100
    v_and_b32 v150, s60, v101
    v_and_b32 v147, s61, v100
    v_and_b32 v151, s61, v101
L_fin_a11:
    s_cmp_lg_u32 s3, 0
    s_cbranch_scc1 L_fin3
    s_lshl_b32 s60, s98, 4
    s_and_b32 s60, s60, 32
    v_xor_b32 v62, s60, v62
    s_lshl_b32 s60, s98, 11
    s_add_u32 s60, s60, 16384
    v_add_u32 v62, s60, v62
    v_xor_b32 v152, s96, v152
    v_xor_b32 v156, s96, v156
    v_xor_b32 v153, s96, v153
    v_xor_b32 v157, s96, v157
    v_xor_b32 v154, s96, v154
    v_xor_b32 v158, s96, v158
    v_xor_b32 v155, s96, v155
    v_xor_b32 v159, s96, v159
    s_ashr_i32 s60, s8, 31
    s_orn2_b32 s60, 0x80000000, s60
    s_xor_b32 s8, s8, s60
    s_waitcnt vmcnt(0)
    v_dot2_f32_bf16 v32, v40, v28, 0
    v_dot2_f32_bf16 v32, v41, v29, v32
    v_dot2_f32_bf16 v32, v42, v30, v32
    v_dot2_f32_bf16 v32, v43, v31, v32
    s_nop 2
    v_add_f32_dpp v32, v32, v32 row_ror:8 row_mask:0xf bank_mask:0xf
    s_nop 1
    v_add_f32_dpp v32, v32, v32 row_ror:4 row_mask:0xf bank_mask:0xf
    s_nop 1
    v_add_f32_dpp v32, v32, v32 row_ror:2 row_mask:0xf bank_mask:0xf
    s_nop 1
    v_add_f32_dpp v32, v32, v32 row_ror:1 row_mask:0xf bank_mask:0xf
    v_mov_b32 v33, v32
    s_nop 1
    v_permlane32_swap_b32 v32, v33
    v_add_f32 v32, v32, v33
    v_mov_b32 v33, v32
    s_nop 1
    v_permlane16_swap_b32 v32, v33
    v_add_f32 v32, v32, v33
    v_mov_b32 v33, s8
    v_cvt_pk_bf16_f32 v33, v33, v33
    v_cvt_pk_bf16_f32 v32, v32, v32
    v_and_b32 v33, 0xffff0000, v33
    v_and_b32 v32, 0xffff0000, v32
    v_mul_f32 v35, 0xbfb8aa3b, v33
    v_mul_f32 v34, 0xbfb8aa3b, v32
    v_exp_f32 v35, v35
    v_exp_f32 v34, v34
    v_add_f32 v35, 1.0, v35
    v_add_f32 v34, 1.0, v34
    v_rcp_f32 v35, v35
    v_rcp_f32 v34, v34
    v_cvt_pk_bf16_f32 v35, v35, v35
    v_cvt_pk_bf16_f32 v34, v34, v34
    v_and_b32 v35, 0xffff0000, v35
    v_and_b32 v34, 0xffff0000, v34
    v_permlane16_swap_b32 v40, v42
    v_permlane16_swap_b32 v41, v43
    s_bitcmp1_b32 s99, 2
    s_cbranch_scc0 L_fint
    v_mov_b32 v40, v42
    v_mov_b32 v41, v43
L_fint:
    v_sub_f32 v36, 1.0, v34
    v_cvt_pk_bf16_f32 v36, v36, v36
    v_and_b32 v36, 0xffff0000, v36
    v_lshlrev_b32 v216, 16, v40
    v_and_b32 v217, 0xffff0000, v40
    v_pk_mul_f32 v[216:217], v[216:217], v[36:37] op_sel_hi:[1,0]
    v_lshlrev_b32 v218, 16, v41
    v_and_b32 v219, 0xffff0000, v41
    v_pk_mul_f32 v[218:219], v[218:219], v[36:37] op_sel_hi:[1,0]
    v_mul_f32 v38, v35, v36
    v_pk_mul_f32 v[184:185], v[184:185], v[34:35] op_sel_hi:[1,0]
    v_pk_mul_f32 v[186:187], v[186:187], v[34:35] op_sel_hi:[1,0]
    v_pk_mul_f32 v[188:189], v[188:189], v[34:35] op_sel_hi:[1,0]
    v_pk_mul_f32 v[190:191], v[190:191], v[34:35] op_sel_hi:[1,0]
    v_pk_mul_f32 v[192:193], v[192:193], v[34:35] op_sel_hi:[1,0]
    v_pk_mul_f32 v[194:195], v[194:195], v[34:35] op_sel_hi:[1,0]
    v_pk_mul_f32 v[196:197], v[196:197], v[34:35] op_sel_hi:[1,0]
    v_pk_mul_f32 v[198:199], v[198:199], v[34:35] op_sel_hi:[1,0]
L_fin3:
    buffer_load_dwordx4 v[8:11], v5, s[36:39], s14 offen offset:0 sc1
    buffer_load_dwordx4 v[12:15], v5, s[36:39], s14 offen offset:2048 sc1
    s_branch L_fin_pw
L_fin_pl:
    buffer_load_dwordx4 v[8:11], v5, s[36:39], s14 offen offset:0 sc1
    buffer_load_dwordx4 v[12:15], v5, s[36:39], s14 offen offset:2048 sc1
L_fin_pw:
    s_waitcnt vmcnt(0)
    v_swap_b32 v10, v12
    v_swap_b32 v11, v13
    v_xor_b32 v96, v104, v8
    v_xor_b32 v97, v105, v9
    v_mfma_f32_16x16x32_bf16 v[64:67], v[144:147], v[8:11], 0
    v_bitop3_b32 v96, v10, v104, v96 bitop3:0xbe
    v_bitop3_b32 v97, v11, v105, v97 bitop3:0xbe
    v_mfma_f32_16x16x32_bf16 v[68:71], v[148:151], v[8:11], 0
    v_bitop3_b32 v96, v12, v104, v96 bitop3:0xbe
    v_bitop3_b32 v97, v13, v105, v97 bitop3:0xbe
    v_mfma_f32_16x16x32_bf16 v[72:75], v[144:147], v[12:15], 0
    v_bitop3_b32 v96, v14, v104, v96 bitop3:0xbe
    v_bitop3_b32 v97, v15, v105, v97 bitop3:0xbe
    v_mfma_f32_16x16x32_bf16 v[76:79], v[148:151], v[12:15], 0
    v_bitop3_b32 v96, v96, v97, v106 bitop3:0xa8
    v_cmp_ne_u32 vcc, 0, v96
    s_nop 0
    s_cbranch_vccz L_fin_pl_ok
    s_sleep 1
    s_sub_u32 s90, s90, 1
    s_cbranch_scc0 L_fin_pl
    s_mov_b32 s90, 0
L_fin_pl_ok:
    v_cvt_pk_bf16_f32 v16, v64, v68
    v_cvt_pk_bf16_f32 v17, v65, v69
    ds_write2st64_b32 v6, v16, v17 offset0:0 offset1:4
    v_cvt_pk_bf16_f32 v18, v66, v70
    v_cvt_pk_bf16_f32 v19, v67, v71
    ds_write2st64_b32 v6, v18, v19 offset0:8 offset1:12
    v_cvt_pk_bf16_f32 v20, v72, v76
    v_cvt_pk_bf16_f32 v21, v73, v77
    ds_write2st64_b32 v7, v20, v21 offset0:2 offset1:6
    v_cvt_pk_bf16_f32 v22, v74, v78
    v_cvt_pk_bf16_f32 v23, v75, v79
    ds_write2st64_b32 v7, v22, v23 offset0:10 offset1:14
    s_waitcnt lgkmcnt(0)
    s_barrier
    s_cmp_lg_u32 s3, 0
    s_cbranch_scc1 L_pp0
    ds_read_b128 v[16:19], v62 offset:0
    ds_read_b128 v[20:23], v62 offset:1024
    s_waitcnt lgkmcnt(1)
    v_mfma_f32_16x16x32_bf16 v[64:67], v[16:19], v[152:155], 0
    v_mfma_f32_16x16x32_bf16 v[68:71], v[16:19], v[156:159], 0
    s_waitcnt lgkmcnt(0)
    v_mfma_f32_16x16x32_bf16 v[72:75], v[20:23], v[152:155], 0
    v_mfma_f32_16x16x32_bf16 v[76:79], v[20:23], v[156:159], 0
    s_nop 3
    v_pk_mul_f32 v[96:97], v[64:65], v[184:185]
    v_pk_mul_f32 v[100:101], v[68:69], v[184:185]
    v_pk_mul_f32 v[98:99], v[66:67], v[186:187]
    v_pk_mul_f32 v[102:103], v[70:71], v[186:187]
    v_pk_fma_f32 v[96:97], v[68:69], v[188:189], v[96:97]
    v_pk_fma_f32 v[100:101], v[64:65], v[188:189], v[100:101] neg_lo:[1,0,0] neg_hi:[1,0,0]
    v_pk_fma_f32 v[98:99], v[70:71], v[190:191], v[98:99]
    v_pk_fma_f32 v[102:103], v[66:67], v[190:191], v[102:103] neg_lo:[1,0,0] neg_hi:[1,0,0]
    v_cvt_pk_bf16_f32 v112, v96, v100
    v_cvt_pk_bf16_f32 v113, v97, v101
    v_cvt_pk_bf16_f32 v114, v98, v102
    v_cvt_pk_bf16_f32 v115, v99, v103
    s_nop 1
    v_mfma_f32_16x16x32_bf16 v[232:235], v[112:115], v[168:171], v[216:219]
    v_pk_mul_f32 v[96:97], v[72:73], v[192:193]
    v_pk_mul_f32 v[100:101], v[76:77], v[192:193]
    v_pk_mul_f32 v[98:99], v[74:75], v[194:195]
    v_pk_mul_f32 v[102:103], v[78:79], v[194:195]
    v_pk_fma_f32 v[96:97], v[76:77], v[196:197], v[96:97]
    v_pk_fma_f32 v[100:101], v[72:73], v[196:197], v[100:101] neg_lo:[1,0,0] neg_hi:[1,0,0]
    v_pk_fma_f32 v[98:99], v[78:79], v[198:199], v[98:99]
    v_pk_fma_f32 v[102:103], v[74:75], v[198:199], v[102:103] neg_lo:[1,0,0] neg_hi:[1,0,0]
    v_cvt_pk_bf16_f32 v116, v96, v100
    v_cvt_pk_bf16_f32 v117, v97, v101
    v_cvt_pk_bf16_f32 v118, v98, v102
    v_cvt_pk_bf16_f32 v119, v99, v103
    s_nop 1
    v_mfma_f32_16x16x32_bf16 v[232:235], v[116:119], v[172:175], v[232:235]
    v_lshlrev_b32 v4, 5, v2
    v_lshl_add_u32 v4, v3, 3, v4
    s_lshr_b32 s61, s99, 2
    s_lshl_b32 s61, s61, 9
    s_add_u32 s12, s12, s61
    s_and_b32 s61, s99, 3
    s_lshl_b32 s61, s61, 2
    s_lshl_b32 exec_lo, 0x000f000f, s61
    s_mov_b32 exec_hi, exec_lo
    ds_write_b128 v111, v[232:235] offset:45056
    s_mov_b64 exec, 0xffff
    s_waitcnt lgkmcnt(0)
    ds_read_b128 v[232:235], v247 offset:45056
    v_mov_b32 v111, v247
    v_mov_b32 v4, v246
    s_lshl_b32 s12, s97, 10
    s_lshl_b32 s61, s99, 7
    s_add_u32 s12, s12, s61
    s_waitcnt lgkmcnt(0)
    s_branch L_fin5
L_pp0:
    v_mov_b32 v8, 0
    v_mov_b32 v9, 0
    v_mov_b32 v10, 0
    v_mov_b32 v11, 0
    buffer_atomic_or_x2 v[8:9], v246, s[36:39], s7 offen offset:0 sc0 sc1
    buffer_atomic_or_x2 v[10:11], v246, s[36:39], s7 offen offset:512 sc0 sc1
    s_sleep 4
    v_mov_b32 v12, 0
    v_mov_b32 v13, 0
    v_mov_b32 v14, 0
    v_mov_b32 v15, 0
    buffer_atomic_or_x2 v[12:13], v246, s[36:39], s7 offen offset:0 sc0 sc1
    buffer_atomic_or_x2 v[14:15], v246, s[36:39], s7 offen offset:512 sc0 sc1
    s_sleep 4
    v_mov_b32 v16, 0
    v_mov_b32 v17, 0
    v_mov_b32 v18, 0
    v_mov_b32 v19, 0
    buffer_atomic_or_x2 v[16:17], v246, s[36:39], s7 offen offset:0 sc0 sc1
    buffer_atomic_or_x2 v[18:19], v246, s[36:39], s7 offen offset:512 sc0 sc1
L_pa:
    s_waitcnt vmcnt(4)
    v_xor_b32 v96, v104, v8
    v_xor_b32 v97, v105, v9
    v_bitop3_b32 v96, v10, v104, v96 bitop3:0xbe
    v_bitop3_b32 v97, v11, v105, v97 bitop3:0xbe
    v_bitop3_b32 v96, v96, v97, v106 bitop3:0xa8
    v_cmp_ne_u32 vcc, 0, v96
    s_nop 0
    s_cbranch_vccz L_pa_d0
    v_mov_b32 v8, 0
    v_mov_b32 v9, 0
    v_mov_b32 v10, 0
    v_mov_b32 v11, 0
    buffer_atomic_or_x2 v[8:9], v246, s[36:39], s7 offen offset:0 sc0 sc1
    buffer_atomic_or_x2 v[10:11], v246, s[36:39], s7 offen offset:512 sc0 sc1
    s_waitcnt vmcnt(4)
    v_xor_b32 v96, v104, v12
    v_xor_b32 v97, v105, v13
    v_bitop3_b32 v96, v14, v104, v96 bitop3:0xbe
    v_bitop3_b32 v97, v15, v105, v97 bitop3:0xbe
    v_bitop3_b32 v96, v96, v97, v106 bitop3:0xa8
    v_cmp_ne_u32 vcc, 0, v96
    s_nop 0
    s_cbranch_vccz L_pa_d1
    v_mov_b32 v12, 0
    v_mov_b32 v13, 0
    v_mov_b32 v14, 0
    v_mov_b32 v15, 0
    buffer_atomic_or_x2 v[12:13], v246, s[36:39], s7 offen offset:0 sc0 sc1
    buffer_atomic_or_x2 v[14:15], v246, s[36:39], s7 offen offset:512 sc0 sc1
    s_waitcnt vmcnt(4)
    v_xor_b32 v96, v104, v16
    v_xor_b32 v97, v105, v17
    v_bitop3_b32 v96, v18, v104, v96 bitop3:0xbe
    v_bitop3_b32 v97, v19, v105, v97 bitop3:0xbe
    v_bitop3_b32 v96, v96, v97, v106 bitop3:0xa8
    v_cmp_ne_u32 vcc, 0, v96
    s_nop 0
    s_cbranch_vccz L_pa_d2
    v_mov_b32 v16, 0
    v_mov_b32 v17, 0
    v_mov_b32 v18, 0
    v_mov_b32 v19, 0
    buffer_atomic_or_x2 v[16:17], v246, s[36:39], s7 offen offset:0 sc0 sc1
    buffer_atomic_or_x2 v[18:19], v246, s[36:39], s7 offen offset:512 sc0 sc1
    s_sub_u32 s90, s90, 1
    s_cbranch_scc0 L_pa
    s_waitcnt vmcnt(0)
L_pa_d0:
    v_lshlrev_b32 v32, 16, v8
    v_and_b32 v33, 0xffff0000, v8
    v_lshlrev_b32 v34, 16, v9
    v_and_b32 v35, 0xffff0000, v9
    v_lshlrev_b32 v36, 16, v10
    v_and_b32 v37, 0xffff0000, v10
    v_lshlrev_b32 v38, 16, v11
    v_and_b32 v39, 0xffff0000, v11
    s_branch L_pa_x
L_pa_d1:
    v_lshlrev_b32 v32, 16, v12
    v_and_b32 v33, 0xffff0000, v12
    v_lshlrev_b32 v34, 16, v13
    v_and_b32 v35, 0xffff0000, v13
    v_lshlrev_b32 v36, 16, v14
    v_and_b32 v37, 0xffff0000, v14
    v_lshlrev_b32 v38, 16, v15
    v_and_b32 v39, 0xffff0000, v15
    s_branch L_pa_x
L_pa_d2:
    v_lshlrev_b32 v32, 16, v16
    v_and_b32 v33, 0xffff0000, v16
    v_lshlrev_b32 v34, 16, v17
    v_and_b32 v35, 0xffff0000, v17
    v_lshlrev_b32 v36, 16, v18
    v_and_b32 v37, 0xffff0000, v18
    v_lshlrev_b32 v38, 16, v19
    v_and_b32 v39, 0xffff0000, v19
L_pa_x:
    v_pk_add_f32 v[32:33], v[32:33], v[36:37]
    v_pk_add_f32 v[34:35], v[34:35], v[38:39]
    s_nop 0
    v_permlane32_swap_b32 v32, v33
    v_permlane32_swap_b32 v34, v35
    v_add_f32 v32, v32, v33
    v_add_f32 v34, v34, v35
    s_nop 1
    v_permlane16_swap_b32 v32, v34
    v_add_f32 v32, v32, v34
    ds_write_b32 v108, v32
    s_waitcnt lgkmcnt(0)
L_fin5:
    s_barrier
    s_cmp_lg_u32 s3, 0
    s_cbranch_scc1 L_fin7
    ds_read_b128 v[64:67], v111 offset:43264
    ds_read_b128 v[68:71], v111 offset:43520
    ds_read_b128 v[72:75], v111 offset:43776
    ds_read_b128 v[76:79], v111 offset:44032
    ds_read_b128 v[80:83], v111 offset:44288
    ds_read_b128 v[84:87], v111 offset:44544
    ds_read_b128 v[88:91], v111 offset:44800
    s_and_b32 s61, s99, 3
    s_lshl_b32 s61, s61, 2
    s_waitcnt lgkmcnt(0)
    v_pk_add_f32 v[68:69], v[68:69], v[72:73]
    v_pk_add_f32 v[70:71], v[70:71], v[74:75]
    v_pk_add_f32 v[76:77], v[76:77], v[80:81]
    v_pk_add_f32 v[78:79], v[78:79], v[82:83]
    v_pk_add_f32 v[84:85], v[84:85], v[88:89]
    v_pk_add_f32 v[86:87], v[86:87], v[90:91]
    v_pk_add_f32 v[64:65], v[64:65], v[68:69]
    v_pk_add_f32 v[76:77], v[76:77], v[84:85]
    v_pk_add_f32 v[66:67], v[66:67], v[70:71]
    v_pk_add_f32 v[78:79], v[78:79], v[86:87]
    v_pk_add_f32 v[64:65], v[64:65], v[76:77]
    v_pk_add_f32 v[66:67], v[66:67], v[78:79]
    v_pk_fma_f32 v[64:65], v[64:65], v[38:39], v[232:233] op_sel_hi:[1,0,1]
    v_pk_fma_f32 v[66:67], v[66:67], v[38:39], v[234:235] op_sel_hi:[1,0,1]
    v_cvt_pk_bf16_f32 v16, v64, v65
    v_cvt_pk_bf16_f32 v17, v66, v67
    buffer_store_dwordx2 v[16:17], v4, s[40:43], s12 offen sc1
    s_cmp_lg_u32 s99, 0
    s_cbranch_scc1 L_fin7
    s_mov_b64 exec, 1
    v_mov_b32 v20, 0
    v_mov_b32 v21, s59
    buffer_store_dword v21, v20, s[36:39], 0 offen sc1
L_fin7:
    s_endpgm
L_end:
    s_endpgm
.p2align 7
.type L_tab,@object
L_tab:
.long 0x3f80, 0x3f80, 0x3f80, 0x3f80, 0x3f80, 0x3ec43f6d, 0x3f353f35, 0x3f6d3ec4
.long 0x3f80, 0x3f353f35, 0x3f800000, 0x3f35bf35, 0x3f80, 0x3f6d3ec4, 0x3f35bf35, 0xbec4bf6d
.long 0x3f80, 0x3f800000, 0xbf80, 0xbf800000, 0x3f80, 0x3f6dbec4, 0xbf35bf35, 0xbec43f6d
.long 0x3f80, 0x3f35bf35, 0xbf800000, 0x3f353f35, 0x3f80, 0x3ec4bf6d, 0xbf353f35, 0x3f6dbec4
.long 0x3f80, 0xbf80, 0x3f80, 0xbf80, 0x3f80, 0xbec4bf6d, 0x3f353f35, 0xbf6dbec4
.long 0x3f80, 0xbf35bf35, 0x3f800000, 0xbf353f35, 0x3f80, 0xbf6dbec4, 0x3f35bf35, 0x3ec43f6d
.long 0x3f80, 0xbf800000, 0xbf80, 0x3f800000, 0x3f80, 0xbf6d3ec4, 0xbf35bf35, 0x3ec4bf6d
.long 0x3f80, 0xbf353f35, 0xbf800000, 0xbf35bf35, 0x3f80, 0xbec43f6d, 0xbf353f35, 0xbf6d3ec4
.long 0x3f80, 0x3f80, 0x3f80, 0x3f80, 0x3f800000, 0x3f6dbec4, 0x3f35bf35, 0x3ec4bf6d
.long 0xbf80, 0xbf35bf35, 0xbf800000, 0xbf353f35, 0xbf800000, 0xbec43f6d, 0x3f353f35, 0x3f6dbec4
.long 0x3f80, 0x3f800000, 0xbf80, 0xbf800000, 0x3f800000, 0xbec4bf6d, 0xbf353f35, 0x3f6d3ec4
.long 0xbf80, 0xbf353f35, 0x3f800000, 0xbf35bf35, 0xbf800000, 0x3f6d3ec4, 0xbf35bf35, 0x3ec43f6d
.long 0x3f80, 0xbf80, 0x3f80, 0xbf80, 0x3f800000, 0xbf6d3ec4, 0x3f35bf35, 0xbec43f6d
.long 0xbf80, 0x3f353f35, 0xbf800000, 0x3f35bf35, 0xbf800000, 0x3ec4bf6d, 0x3f353f35, 0xbf6d3ec4
.long 0x3f80, 0xbf800000, 0xbf80, 0x3f800000, 0x3f800000, 0x3ec43f6d, 0xbf353f35, 0xbf6dbec4
.long 0xbf80, 0x3f35bf35, 0x3f800000, 0x3f353f35, 0xbf800000, 0xbf6dbec4, 0xbf35bf35, 0xbec4bf6d
.long 0x3f80, 0x3f80, 0x3f80, 0x3f80, 0xbf80, 0xbec4bf6d, 0xbf35bf35, 0xbf6dbec4
.long 0x3f80, 0x3f353f35, 0x3f800000, 0x3f35bf35, 0xbf80, 0xbf6dbec4, 0xbf353f35, 0x3ec43f6d
.long 0x3f80, 0x3f800000, 0xbf80, 0xbf800000, 0xbf80, 0xbf6d3ec4, 0x3f353f35, 0x3ec4bf6d
.long 0x3f80, 0x3f35bf35, 0xbf800000, 0x3f353f35, 0xbf80, 0xbec43f6d, 0x3f35bf35, 0xbf6d3ec4
.long 0x3f80, 0xbf80, 0x3f80, 0xbf80, 0xbf80, 0x3ec43f6d, 0xbf35bf35, 0x3f6d3ec4
.long 0x3f80, 0xbf35bf35, 0x3f800000, 0xbf353f35, 0xbf80, 0x3f6d3ec4, 0xbf353f35, 0xbec4bf6d
.long 0x3f80, 0xbf800000, 0xbf80, 0x3f800000, 0xbf80, 0x3f6dbec4, 0x3f353f35, 0xbec43f6d
.long 0x3f80, 0xbf353f35, 0xbf800000, 0xbf35bf35, 0xbf80, 0x3ec4bf6d, 0x3f35bf35, 0x3f6dbec4
.long 0x3f80, 0x3f80, 0x3f80, 0x3f80, 0xbf800000, 0xbf6d3ec4, 0xbf353f35, 0xbec43f6d
.long 0xbf80, 0xbf35bf35, 0xbf800000, 0xbf353f35, 0x3f800000, 0x3ec4bf6d, 0xbf35bf35, 0xbf6d3ec4
.long 0x3f80, 0x3f800000, 0xbf80, 0xbf800000, 0xbf800000, 0x3ec43f6d, 0x3f35bf35, 0xbf6dbec4
.long 0xbf80, 0xbf353f35, 0x3f800000, 0xbf35bf35, 0x3f800000, 0xbf6dbec4, 0x3f353f35, 0xbec4bf6d
.long 0x3f80, 0xbf80, 0x3f80, 0xbf80, 0xbf800000, 0x3f6dbec4, 0xbf353f35, 0x3ec4bf6d
.long 0xbf80, 0x3f353f35, 0xbf800000, 0x3f35bf35, 0x3f800000, 0xbec43f6d, 0xbf35bf35, 0x3f6dbec4
.long 0x3f80, 0xbf800000, 0xbf80, 0x3f800000, 0xbf800000, 0xbec4bf6d, 0x3f35bf35, 0x3f6d3ec4
.long 0xbf80, 0x3f35bf35, 0x3f800000, 0x3f353f35, 0x3f800000, 0x3f6d3ec4, 0x3f353f35, 0x3ec43f6d
.long 0x3f808000, 0x3f808000, 0x3f808000, 0x3f808000, 0x3f808000, 0x3f6dbec4, 0x3f35bf35, 0x3ec4bf6d
.long 0x3f808000, 0x3f35bf35, 0xbf80, 0xbf35bf35, 0x3f808000, 0x3ec4bf6d, 0xbf35bf35, 0xbf6d3ec4
.long 0x3f808000, 0xbf80, 0xbf808000, 0x3f80, 0x3f808000, 0xbec4bf6d, 0xbf353f35, 0x3f6d3ec4
.long 0x3f808000, 0xbf35bf35, 0x3f80, 0x3f35bf35, 0x3f808000, 0xbf6dbec4, 0x3f353f35, 0xbec4bf6d
.long 0x3f808000, 0xbf808000, 0x3f808000, 0xbf808000, 0x3f808000, 0xbf6d3ec4, 0x3f35bf35, 0xbec43f6d
.long 0x3f808000, 0xbf353f35, 0xbf80, 0x3f353f35, 0x3f808000, 0xbec43f6d, 0xbf35bf35, 0x3f6dbec4
.long 0x3f808000, 0x3f80, 0xbf808000, 0xbf80, 0x3f808000, 0x3ec43f6d, 0xbf353f35, 0xbf6dbec4
.long 0x3f808000, 0x3f353f35, 0x3f80, 0xbf353f35, 0x3f808000, 0x3f6d3ec4, 0x3f353f35, 0x3ec43f6d
.long 0x3f808000, 0x3f808000, 0x3f808000, 0x3f808000, 0xbf80, 0xbec4bf6d, 0xbf35bf35, 0xbf6dbec4
.long 0xbf808000, 0xbf353f35, 0x3f80, 0x3f353f35, 0x3f80, 0x3f6d3ec4, 0x3f35bf35, 0xbec4bf6d
.long 0x3f808000, 0xbf80, 0xbf808000, 0x3f80, 0xbf80, 0xbf6d3ec4, 0x3f353f35, 0x3ec4bf6d
.long 0xbf808000, 0x3f353f35, 0xbf80, 0xbf353f35, 0x3f80, 0x3ec4bf6d, 0xbf353f35, 0x3f6dbec4
.long 0x3f808000, 0xbf808000, 0x3f808000, 0xbf808000, 0xbf80, 0x3ec43f6d, 0xbf35bf35, 0x3f6d3ec4
.long 0xbf808000, 0x3f35bf35, 0x3f80, 0xbf35bf35, 0x3f80, 0xbf6dbec4, 0x3f35bf35, 0x3ec43f6d
.long 0x3f808000, 0x3f80, 0xbf808000, 0xbf80, 0xbf80, 0x3f6dbec4, 0x3f353f35, 0xbec43f6d
.long 0xbf808000, 0xbf35bf35, 0xbf80, 0x3f35bf35, 0x3f80, 0xbec43f6d, 0xbf353f35, 0xbf6d3ec4
.long 0x3f808000, 0x3f808000, 0x3f808000, 0x3f808000, 0xbf808000, 0xbf6d3ec4, 0xbf353f35, 0xbec43f6d
.long 0x3f808000, 0x3f35bf35, 0xbf80, 0xbf35bf35, 0xbf808000, 0xbec43f6d, 0x3f353f35, 0x3f6dbec4
.long 0x3f808000, 0xbf80, 0xbf808000, 0x3f80, 0xbf808000, 0x3ec43f6d, 0x3f35bf35, 0xbf6dbec4
.long 0x3f808000, 0xbf35bf35, 0x3f80, 0x3f35bf35, 0xbf808000, 0x3f6d3ec4, 0xbf35bf35, 0x3ec43f6d
.long 0x3f808000, 0xbf808000, 0x3f808000, 0xbf808000, 0xbf808000, 0x3f6dbec4, 0xbf353f35, 0x3ec4bf6d
.long 0x3f808000, 0xbf353f35, 0xbf80, 0x3f353f35, 0xbf808000, 0x3ec4bf6d, 0x3f353f35, 0xbf6d3ec4
.long 0x3f808000, 0x3f80, 0xbf808000, 0xbf80, 0xbf808000, 0xbec4bf6d, 0x3f35bf35, 0x3f6d3ec4
.long 0x3f808000, 0x3f353f35, 0x3f80, 0xbf353f35, 0xbf808000, 0xbf6dbec4, 0xbf35bf35, 0xbec4bf6d
.long 0x3f808000, 0x3f808000, 0x3f808000, 0x3f808000, 0x3f80, 0x3ec43f6d, 0x3f353f35, 0x3f6d3ec4
.long 0xbf808000, 0xbf353f35, 0x3f80, 0x3f353f35, 0xbf80, 0xbf6dbec4, 0xbf353f35, 0x3ec43f6d
.long 0x3f808000, 0xbf80, 0xbf808000, 0x3f80, 0x3f80, 0x3f6dbec4, 0xbf35bf35, 0xbec43f6d
.long 0xbf808000, 0x3f353f35, 0xbf80, 0xbf353f35, 0xbf80, 0xbec43f6d, 0x3f35bf35, 0xbf6d3ec4
.long 0x3f808000, 0xbf808000, 0x3f808000, 0xbf808000, 0x3f80, 0xbec4bf6d, 0x3f353f35, 0xbf6dbec4
.long 0xbf808000, 0x3f35bf35, 0x3f80, 0xbf35bf35, 0xbf80, 0x3f6d3ec4, 0xbf353f35, 0xbec4bf6d
.long 0x3f808000, 0x3f80, 0xbf808000, 0xbf80, 0x3f80, 0xbf6d3ec4, 0xbf35bf35, 0x3ec4bf6d
.long 0xbf808000, 0xbf35bf35, 0xbf80, 0x3f35bf35, 0xbf80, 0x3ec4bf6d, 0x3f35bf35, 0x3f6dbec4
.long 0x3f800000, 0x3f800000, 0x3f800000, 0x3f800000, 0x3f800000, 0x3f7fec43, 0x3f7fb10f, 0x3f7f4e6d
.long 0x3f800000, 0x3f7fb10f, 0x3f7ec46d, 0x3f7d3aac, 0x3f800000, 0x3f7f4e6d, 0x3f7d3aac, 0x3f79c79d
.long 0x3f800000, 0x3f7ec46d, 0x3f7b14be, 0x3f74fa0b, 0x3f800000, 0x3f7e1324, 0x3f7853f8, 0x3f6ed89e
.long 0x3f800000, 0x3f7d3aac, 0x3f74fa0b, 0x3f676bd8, 0x3f800000, 0x3f7c3b28, 0x3f710908, 0x3f5ebe05
.long 0x3f800000, 0x3f7b14be, 0x3f6c835e, 0x3f54db31, 0x3f800000, 0x3f79c79d, 0x3f676bd8, 0x3f49d112
.long 0x3f800000, 0x3f7853f8, 0x3f61c598, 0x3f3daef9, 0x3f800000, 0x3f76ba07, 0x3f5b941a, 0x3f3085bb
.long 0x3f800000, 0x3f74fa0b, 0x3f54db31, 0x3f226799, 0x3f800000, 0x3f731447, 0x3f4d9f02, 0x3f13682a
.long 0x3f800000, 0x3f710908, 0x3f45e403, 0x3f039c3d, 0x3f800000, 0x3f6ed89e, 0x3f3daef9, 0x3ee63375
.long 0x3f800000, 0x3f800000, 0x3f800000, 0x3f800000, 0x3f7ec46d, 0x3f7e1324, 0x3f7d3aac, 0x3f7c3b28
.long 0x3f7b14be, 0x3f7853f8, 0x3f74fa0b, 0x3f710908, 0x3f74fa0b, 0x3f6ed89e, 0x3f676bd8, 0x3f5ebe05
.long 0x3f6c835e, 0x3f61c598, 0x3f54db31, 0x3f45e403, 0x3f61c598, 0x3f514d3d, 0x3f3daef9, 0x3f273656
.long 0x3f54db31, 0x3f3daef9, 0x3f226799, 0x3f039c3d, 0x3f45e403, 0x3f273656, 0x3f039c3d, 0x3eb8442a
.long 0x3f3504f3, 0x3f0e39da, 0x3ec3ef15, 0x3e47c5c2, 0x3f226799, 0x3ee63375, 0x3e78cfcc, 0x3cc90ab0
.long 0x3f0e39da, 0x3eac7cd4, 0x3dc8bd36, 0xbe164083, 0x3ef15aea, 0x3e605c13, 0xbd48fb30, 0xbea09ae5
.long 0x3ec3ef15, 0x3dc8bd36, 0xbe47c5c2, 0xbef15aea, 0x3e94a031, 0xbcc90ab0, 0xbeac7cd4, 0xbf1d7fd1
.long 0x3e47c5c2, 0xbe164083, 0xbef15aea, 0xbf3daef9, 0x3dc8bd36, 0xbe888e93, 0xbf187fc0, 0xbf584853
.long 0x3f800000, 0x3f800000, 0x3f800000, 0x3f800000, 0x3f7b14be, 0x3f79c79d, 0x3f7853f8, 0x3f76ba07
.long 0x3f6c835e, 0x3f676bd8, 0x3f61c598, 0x3f5b941a, 0x3f54db31, 0x3f49d112, 0x3f3daef9, 0x3f3085bb
.long 0x3f3504f3, 0x3f226799, 0x3f0e39da, 0x3ef15aea, 0x3f0e39da, 0x3ee63375, 0x3eac7cd4, 0x3e605c13
.long 0x3ec3ef15, 0x3e78cfcc, 0x3dc8bd36, 0xbd48fb30, 0x3e47c5c2, 0x3cc90ab0, 0xbe164083, 0xbea09ae5
.long 0x0, 0xbe47c5c2, 0xbec3ef15, 0xbf0e39da, 0xbe47c5c2, 0xbecf7bca, 0xbf187fc0, 0xbf41d870
.long 0xbec3ef15, 0xbf187fc0, 0xbf45e403, 0xbf676bd8, 0xbf0e39da, 0xbf41d870, 0xbf676bd8, 0xbf7c3b28
.long 0xbf3504f3, 0xbf61c598, 0xbf7b14be, 0xbf7ec46d, 0xbf54db31, 0xbf76ba07, 0xbf7fb10f, 0xbf6ed89e
.long 0xbf6c835e, 0xbf7fb10f, 0xbf74fa0b, 0xbf4d9f02, 0xbf7b14be, 0xbf7c3b28, 0xbf5b941a, 0xbf1d7fd1
.long 0x3f800000, 0x3f800000, 0x3f800000, 0x3f800000, 0x3f74fa0b, 0x3f731447, 0x3f710908, 0x3f6ed89e
.long 0x3f54db31, 0x3f4d9f02, 0x3f45e403, 0x3f3daef9, 0x3f226799, 0x3f13682a, 0x3f039c3d, 0x3ee63375
.long 0x3ec3ef15, 0x3e94a031, 0x3e47c5c2, 0x3dc8bd36, 0x3dc8bd36, 0xbcc90ab0, 0xbe164083, 0xbe888e93
.long 0xbe47c5c2, 0xbeac7cd4, 0xbef15aea, 0xbf187fc0, 0xbef15aea, 0xbf1d7fd1, 0xbf3daef9, 0xbf584853
.long 0xbf3504f3, 0xbf54db31, 0xbf6c835e, 0xbf7b14be, 0xbf61c598, 0xbf76ba07, 0xbf7fb10f, 0xbf7c3b28
.long 0xbf7b14be, 0xbf7fb10f, 0xbf74fa0b, 0xbf5b941a, 0xbf7ec46d, 0xbf6ed89e, 0xbf4d9f02, 0xbf1d7fd1
.long 0xbf6c835e, 0xbf45e403, 0xbf0e39da, 0xbe94a031, 0xbf45e403, 0xbf08f59b, 0xbe78cfcc, 0x3d96a905
.long 0xbf0e39da, 0xbe78cfcc, 0x3dc8bd36, 0x3edae880, 0xbe94a031, 0x3d96a905, 0x3edae880, 0x3f396842
.long 0x0, 0x0, 0x0, 0x0, 0x0, 0x3cc90ab0, 0x3d48fb30, 0x3d96a905
.long 0x0, 0x3d48fb30, 0x3dc8bd36, 0x3e164083, 0x0, 0x3d96a905, 0x3e164083, 0x3e605c13
.long 0x0, 0x3dc8bd36, 0x3e47c5c2, 0x3e94a031, 0x0, 0x3dfab273, 0x3e78cfcc, 0x3eb8442a
.long 0x0, 0x3e164083, 0x3e94a031, 0x3edae880, 0x0, 0x3e2f10a2, 0x3eac7cd4, 0x3efc5d27
.long 0x0, 0x3e47c5c2, 0x3ec3ef15, 0x3f0e39da, 0x0, 0x3e605c13, 0x3edae880, 0x3f1d7fd1
.long 0x0, 0x3e78cfcc, 0x3ef15aea, 0x3f2beb4a, 0x0, 0x3e888e93, 0x3f039c3d, 0x3f396842
.long 0x0, 0x3e94a031, 0x3f0e39da, 0x3f45e403, 0x0, 0x3ea09ae5, 0x3f187fc0, 0x3f514d3d
.long 0x0, 0x3eac7cd4, 0x3f226799, 0x3f5b941a, 0x0, 0x3eb8442a, 0x3f2beb4a, 0x3f64aa59
.long 0x0, 0x0, 0x0, 0x0, 0x3dc8bd36, 0x3dfab273, 0x3e164083, 0x3e2f10a2
.long 0x3e47c5c2, 0x3e78cfcc, 0x3e94a031, 0x3eac7cd4, 0x3e94a031, 0x3eb8442a, 0x3edae880, 0x3efc5d27
.long 0x3ec3ef15, 0x3ef15aea, 0x3f0e39da, 0x3f226799, 0x3ef15aea, 0x3f13682a, 0x3f2beb4a, 0x3f41d870
.long 0x3f0e39da, 0x3f2beb4a, 0x3f45e403, 0x3f5b941a, 0x3f226799, 0x3f41d870, 0x3f5b941a, 0x3f6ed89e
.long 0x3f3504f3, 0x3f54db31, 0x3f6c835e, 0x3f7b14be, 0x3f45e403, 0x3f64aa59, 0x3f7853f8, 0x3f7fec43
.long 0x3f54db31, 0x3f710908, 0x3f7ec46d, 0x3f7d3aac, 0x3f61c598, 0x3f79c79d, 0x3f7fb10f, 0x3f731447
.long 0x3f6c835e, 0x3f7ec46d, 0x3f7b14be, 0x3f61c598, 0x3f74fa0b, 0x3f7fec43, 0x3f710908, 0x3f49d112
.long 0x3f7b14be, 0x3f7d3aac, 0x3f61c598, 0x3f2beb4a, 0x3f7ec46d, 0x3f76ba07, 0x3f4d9f02, 0x3f08f59b
.long 0x0, 0x0, 0x0, 0x0, 0x3e47c5c2, 0x3e605c13, 0x3e78cfcc, 0x3e888e93
.long 0x3ec3ef15, 0x3edae880, 0x3ef15aea, 0x3f039c3d, 0x3f0e39da, 0x3f1d7fd1, 0x3f2beb4a, 0x3f396842
.long 0x3f3504f3, 0x3f45e403, 0x3f54db31, 0x3f61c598, 0x3f54db31, 0x3f64aa59, 0x3f710908, 0x3f79c79d
.long 0x3f6c835e, 0x3f7853f8, 0x3f7ec46d, 0x3f7fb10f, 0x3f7b14be, 0x3f7fec43, 0x3f7d3aac, 0x3f731447
.long 0x3f800000, 0x3f7b14be, 0x3f6c835e, 0x3f54db31, 0x3f7b14be, 0x3f6a09a7, 0x3f4d9f02, 0x3f273656
.long 0x3f6c835e, 0x3f4d9f02, 0x3f226799, 0x3edae880, 0x3f54db31, 0x3f273656, 0x3edae880, 0x3e2f10a2
.long 0x3f3504f3, 0x3ef15aea, 0x3e47c5c2, 0xbdc8bd36, 0x3f0e39da, 0x3e888e93, 0xbd48fb30, 0xbeb8442a
.long 0x3ec3ef15, 0x3d48fb30, 0xbe94a031, 0xbf187fc0, 0x3e47c5c2, 0xbe2f10a2, 0xbf039c3d, 0xbf49d112
.long 0x0, 0x0, 0x0, 0x0, 0x3e94a031, 0x3ea09ae5, 0x3eac7cd4, 0x3eb8442a
.long 0x3f0e39da, 0x3f187fc0, 0x3f226799, 0x3f2beb4a, 0x3f45e403, 0x3f514d3d, 0x3f5b941a, 0x3f64aa59
.long 0x3f6c835e, 0x3f74fa0b, 0x3f7b14be, 0x3f7ec46d, 0x3f7ec46d, 0x3f7fec43, 0x3f7d3aac, 0x3f76ba07
.long 0x3f7b14be, 0x3f710908, 0x3f61c598, 0x3f4d9f02, 0x3f61c598, 0x3f49d112, 0x3f2beb4a, 0x3f08f59b
.long 0x3f3504f3, 0x3f0e39da, 0x3ec3ef15, 0x3e47c5c2, 0x3ef15aea, 0x3e888e93, 0x3d48fb30, 0xbe2f10a2
.long 0x3e47c5c2, 0xbd48fb30, 0xbe94a031, 0xbf039c3d, 0xbdc8bd36, 0xbeb8442a, 0xbf187fc0, 0xbf49d112
.long 0xbec3ef15, 0xbf226799, 0xbf54db31, 0xbf74fa0b, 0xbf226799, 0xbf584853, 0xbf7853f8, 0xbf7f4e6d
.long 0xbf54db31, 0xbf7853f8, 0xbf7ec46d, 0xbf676bd8, 0xbf74fa0b, 0xbf7f4e6d, 0xbf676bd8, 0xbf3085bb
.long 0x3f800000, 0x3f800000, 0x3f800000, 0x3f800000, 0x3f7ffb11, 0x3f7fd397, 0x3f7f84ab, 0x3f7f0e58
.long 0x3f7fec43, 0x3f7f4e6d, 0x3f7e1324, 0x3f7c3b28, 0x3f7fd397, 0x3f7e70b0, 0x3f7baccd, 0x3f778bc5
.long 0x3f7fb10f, 0x3f7d3aac, 0x3f7853f8, 0x3f710908, 0x3f7f84ab, 0x3f7baccd, 0x3f740bdd, 0x3f68bf3c
.long 0x3f7f4e6d, 0x3f79c79d, 0x3f6ed89e, 0x3f5ebe05, 0x3f7f0e58, 0x3f778bc5, 0x3f68bf3c, 0x3f531849
.long 0x3f7ec46d, 0x3f74fa0b, 0x3f61c598, 0x3f45e403, 0x3f7e70b0, 0x3f721352, 0x3f59f26a, 0x3f373a23
.long 0x3f7e1324, 0x3f6ed89e, 0x3f514d3d, 0x3f273656, 0x3f7dabcc, 0x3f6b4b0c, 0x3f47de65, 0x3f15f6d9
.long 0x3f7d3aac, 0x3f676bd8, 0x3f3daef9, 0x3f039c3d, 0x3f7cbfc9, 0x3f633c5a, 0x3f32c8c9, 0x3ee0924f
.long 0x3f7c3b28, 0x3f5ebe05, 0x3f273656, 0x3eb8442a, 0x3f7baccd, 0x3f59f26a, 0x3f1b02c6, 0x3e8e9a22
.long 0x3f800000, 0x3f800000, 0x3f800000, 0x3f800000, 0x3f7e70b0, 0x3f7dabcc, 0x3f7cbfc9, 0x3f7baccd
.long 0x3f79c79d, 0x3f76ba07, 0x3f731447, 0x3f6ed89e, 0x3f721352, 0x3f6b4b0c, 0x3f633c5a, 0x3f59f26a
.long 0x3f676bd8, 0x3f5b941a, 0x3f4d9f02, 0x3f3daef9, 0x3f59f26a, 0x3f47de65, 0x3f32c8c9, 0x3f1b02c6
.long 0x3f49d112, 0x3f3085bb, 0x3f13682a, 0x3ee63375, 0x3f373a23, 0x3f15f6d9, 0x3ee0924f, 0x3e8e9a22
.long 0x3f226799, 0x3ef15aea, 0x3e94a031, 0x3dc8bd36, 0x3f0b9a6b, 0x3eb263ef, 0x3e09cf86, 0xbdafb680
.long 0x3ee63375, 0x3e605c13, 0xbcc90ab0, 0xbe888e93, 0x3eb263ef, 0x3dafb680, 0xbe3b6ecf, 0xbee0924f
.long 0x3e78cfcc, 0xbd48fb30, 0xbeac7cd4, 0xbf187fc0, 0x3e09cf86, 0xbe3b6ecf, 0xbef6e0cb, 0xbf3b8f3b
.long 0x3cc90ab0, 0xbea09ae5, 0xbf1d7fd1, 0xbf584853, 0xbdafb680, 0xbee0924f, 0xbf3b8f3b, 0xbf6db293
.long 0x3f800000, 0x3f800000, 0x3f800000, 0x3f800000, 0x3f7a7302, 0x3f791298, 0x3f778bc5, 0x3f75dec6
.long 0x3f6a09a7, 0x3f64aa59, 0x3f5ebe05, 0x3f584853, 0x3f4f7a1f, 0x3f43e200, 0x3f373a23, 0x3f299415
.long 0x3f2beb4a, 0x3f187fc0, 0x3f039c3d, 0x3edae880, 0x3f00e7e4, 0x3ec9b953, 0x3e8e9a22, 0x3e22abb6
.long 0x3ea09ae5, 0x3e2f10a2, 0x3cc90ab0, 0xbdfab273, 0x3de1bc2e, 0xbd7b2b74, 0xbe6c9a7f, 0xbec9b953
.long 0xbdc8bd36, 0xbe94a031, 0xbef15aea, 0xbf226799, 0xbe9aa086, 0xbf00e7e4, 0xbf2e3bde, 0xbf531849
.long 0xbefc5d27, 0xbf3085bb, 0xbf584853, 0xbf731447, 0xbf299415, 0xbf5695e5, 0xbf740bdd, 0xbf7fd397
.long 0xbf4d9f02, 0xbf710908, 0xbf7fb10f, 0xbf7853f8, 0xbf68bf3c, 0xbf7e70b0, 0xbf7a7302, 0xbf5d2d53
.long 0xbf79c79d, 0xbf7e1324, 0xbf64aa59, 0xbf3085bb, 0xbf7ffb11, 0xbf6ff573, 0xbf3fc767, 0xbeebcbbb
.long 0x3f800000, 0x3f800000, 0x3f800000, 0x3f800000, 0x3f740bdd, 0x3f721352, 0x3f6ff573, 0x3f6db293
.long 0x3f514d3d, 0x3f49d112, 0x3f41d870, 0x3f396842, 0x3f1b02c6, 0x3f0b9a6b, 0x3ef6e0cb, 0x3ed53641
.long 0x3eac7cd4, 0x3e78cfcc, 0x3e164083, 0x3d48fb30, 0x3d16c32c, 0xbdafb680, 0xbe541501, 0xbea68f12
.long 0xbe888e93, 0xbecf7bca, 0xbf08f59b, 0xbf273656, 0xbf0b9a6b, 0xbf2e3bde, 0xbf4bbbf8, 0xbf633c5a
.long 0xbf45e403, 0xbf61c598, 0xbf74fa0b, 0xbf7ec46d, 0xbf6db293, 0xbf7cbfc9, 0xbf7f84ab, 0xbf75dec6
.long 0xbf7f4e6d, 0xbf7c3b28, 0xbf6a09a7, 0xbf49d112, 0xbf791298, 0xbf604621, 0xbf373a23, 0xbf00e7e4
.long 0xbf5b941a, 0xbf2beb4a, 0xbedae880, 0xbe164083, 0xbf299415, 0xbec9b953, 0xbdafb680, 0x3e6c9a7f
.long 0xbecf7bca, 0xbd96a905, 0x3e888e93, 0x3f13682a, 0xbde1bc2e, 0x3e827dc0, 0x3f15f6d9, 0x3f5695e5
.long 0x0, 0x0, 0x0, 0x0, 0x3c490e90, 0x3d16c32c, 0x3d7b2b74, 0x3dafb680
.long 0x3cc90ab0, 0x3d96a905, 0x3dfab273, 0x3e2f10a2, 0x3d16c32c, 0x3de1bc2e, 0x3e3b6ecf, 0x3e827dc0
.long 0x3d48fb30, 0x3e164083, 0x3e78cfcc, 0x3eac7cd4, 0x3d7b2b74, 0x3e3b6ecf, 0x3e9aa086, 0x3ed53641
.long 0x3d96a905, 0x3e605c13, 0x3eb8442a, 0x3efc5d27, 0x3dafb680, 0x3e827dc0, 0x3ed53641, 0x3f10d3cd
.long 0x3dc8bd36, 0x3e94a031, 0x3ef15aea, 0x3f226799, 0x3de1bc2e, 0x3ea68f12, 0x3f064b82, 0x3f32c8c9
.long 0x3dfab273, 0x3eb8442a, 0x3f13682a, 0x3f41d870, 0x3e09cf86, 0x3ec9b953, 0x3f1ff6cb, 0x3f4f7a1f
.long 0x3e164083, 0x3edae880, 0x3f2beb4a, 0x3f5b941a, 0x3e22abb6, 0x3eebcbbb, 0x3f373a23, 0x3f660f88
.long 0x3e2f10a2, 0x3efc5d27, 0x3f41d870, 0x3f6ed89e, 0x3e3b6ecf, 0x3f064b82, 0x3f4bbbf8, 0x3f75dec6
.long 0x0, 0x0, 0x0, 0x0, 0x3de1bc2e, 0x3e09cf86, 0x3e22abb6, 0x3e3b6ecf
.long 0x3e605c13, 0x3e888e93, 0x3ea09ae5, 0x3eb8442a, 0x3ea68f12, 0x3ec9b953, 0x3eebcbbb, 0x3f064b82
.long 0x3edae880, 0x3f039c3d, 0x3f187fc0, 0x3f2beb4a, 0x3f064b82, 0x3f1ff6cb, 0x3f373a23, 0x3f4bbbf8
.long 0x3f1d7fd1, 0x3f396842, 0x3f514d3d, 0x3f64aa59, 0x3f32c8c9, 0x3f4f7a1f, 0x3f660f88, 0x3f75dec6
.long 0x3f45e403, 0x3f61c598, 0x3f74fa0b, 0x3f7ec46d, 0x3f5695e5, 0x3f6ff573, 0x3f7dabcc, 0x3f7f0e58
.long 0x3f64aa59, 0x3f79c79d, 0x3f7fec43, 0x3f76ba07, 0x3f6ff573, 0x3f7f0e58, 0x3f7baccd, 0x3f660f88
.long 0x3f7853f8, 0x3f7fb10f, 0x3f710908, 0x3f4d9f02, 0x3f7dabcc, 0x3f7baccd, 0x3f604621, 0x3f2e3bde
.long 0x3f7fec43, 0x3f731447, 0x3f49d112, 0x3f08f59b, 0x3f7f0e58, 0x3f660f88, 0x3f2e3bde, 0x3ebe1d4a
.long 0x0, 0x0, 0x0, 0x0, 0x3e541501, 0x3e6c9a7f, 0x3e827dc0, 0x3e8e9a22
.long 0x3ecf7bca, 0x3ee63375, 0x3efc5d27, 0x3f08f59b, 0x3f15f6d9, 0x3f24d225, 0x3f32c8c9, 0x3f3fc767
.long 0x3f3daef9, 0x3f4d9f02, 0x3f5b941a, 0x3f676bd8, 0x3f5d2d53, 0x3f6b4b0c, 0x3f75dec6, 0x3f7cbfc9
.long 0x3f731447, 0x3f7c3b28, 0x3f7fec43, 0x3f7e1324, 0x3f7e70b0, 0x3f7f84ab, 0x3f791298, 0x3f6b4b0c
.long 0x3f7ec46d, 0x3f74fa0b, 0x3f61c598, 0x3f45e403, 0x3f740bdd, 0x3f5d2d53, 0x3f3b8f3b, 0x3f10d3cd
.long 0x3f5ebe05, 0x3f396842, 0x3f08f59b, 0x3ea09ae5, 0x3f3fc767, 0x3f0b9a6b, 0x3e9aa086, 0x3d16c32c
.long 0x3f187fc0, 0x3eac7cd4, 0x3d48fb30, 0xbe78cfcc, 0x3ed53641, 0x3de1bc2e, 0xbe541501, 0xbf00e7e4
.long 0x3e605c13, 0xbdfab273, 0xbee63375, 0xbf396842, 0x3c490e90, 0xbeb263ef, 0xbf299415, 0xbf633c5a
.long 0x0, 0x0, 0x0, 0x0, 0x3e9aa086, 0x3ea68f12, 0x3eb263ef, 0x3ebe1d4a
.long 0x3f13682a, 0x3f1d7fd1, 0x3f273656, 0x3f3085bb, 0x3f4bbbf8, 0x3f5695e5, 0x3f604621, 0x3f68bf3c
.long 0x3f710908, 0x3f7853f8, 0x3f7d3aac, 0x3f7fb10f, 0x3f7fd397, 0x3f7f0e58, 0x3f7a7302, 0x3f721352
.long 0x3f76ba07, 0x3f6a09a7, 0x3f584853, 0x3f41d870, 0x3f5695e5, 0x3f3b8f3b, 0x3f1b02c6, 0x3eebcbbb
.long 0x3f226799, 0x3ef15aea, 0x3e94a031, 0x3dc8bd36, 0x3ebe1d4a, 0x3e22abb6, 0xbd7b2b74, 0xbe8e9a22
.long 0x3d96a905, 0xbe2f10a2, 0xbecf7bca, 0xbf1d7fd1, 0xbe6c9a7f, 0xbef6e0cb, 0xbf32c8c9, 0xbf5d2d53
.long 0xbf039c3d, 0xbf3daef9, 0xbf676bd8, 0xbf7d3aac, 0xbf3fc767, 0xbf6b4b0c, 0xbf7f0e58, 0xbf791298
.long 0xbf6a09a7, 0xbf7f4e6d, 0xbf76ba07, 0xbf514d3d, 0xbf7e70b0, 0xbf778bc5, 0xbf4f7a1f, 0xbf0b9a6b
.long 0x3f80, 0x3f80, 0x3f80, 0x3f80, 0x3f80, 0x3ec43f6d, 0x3f353f35, 0x3f6d3ec4
.long 0x3f80, 0x3f353f35, 0x3f800000, 0x3f35bf35, 0x3f80, 0x3f6d3ec4, 0x3f35bf35, 0xbec4bf6d
.long 0x3f80, 0x3f800000, 0xbf80, 0xbf800000, 0x3f80, 0x3f6dbec4, 0xbf35bf35, 0xbec43f6d
.long 0x3f80, 0x3f35bf35, 0xbf800000, 0x3f353f35, 0x3f80, 0x3ec4bf6d, 0xbf353f35, 0x3f6dbec4
.long 0x3f80, 0xbf80, 0x3f80, 0xbf80, 0x3f80, 0xbec4bf6d, 0x3f353f35, 0xbf6dbec4
.long 0x3f80, 0xbf35bf35, 0x3f800000, 0xbf353f35, 0x3f80, 0xbf6dbec4, 0x3f35bf35, 0x3ec43f6d
.long 0x3f80, 0xbf800000, 0xbf80, 0x3f800000, 0x3f80, 0xbf6d3ec4, 0xbf35bf35, 0x3ec4bf6d
.long 0x3f80, 0xbf353f35, 0xbf800000, 0xbf35bf35, 0x3f80, 0xbec43f6d, 0xbf353f35, 0xbf6d3ec4
.long 0x3f80, 0x3f80, 0x3f80, 0x3f80, 0x3f800000, 0x3f6dbec4, 0x3f35bf35, 0x3ec4bf6d
.long 0xbf80, 0xbf35bf35, 0xbf800000, 0xbf353f35, 0xbf800000, 0xbec43f6d, 0x3f353f35, 0x3f6dbec4
.long 0x3f80, 0x3f800000, 0xbf80, 0xbf800000, 0x3f800000, 0xbec4bf6d, 0xbf353f35, 0x3f6d3ec4
.long 0xbf80, 0xbf353f35, 0x3f800000, 0xbf35bf35, 0xbf800000, 0x3f6d3ec4, 0xbf35bf35, 0x3ec43f6d
.long 0x3f80, 0xbf80, 0x3f80, 0xbf80, 0x3f800000, 0xbf6d3ec4, 0x3f35bf35, 0xbec43f6d
.long 0xbf80, 0x3f353f35, 0xbf800000, 0x3f35bf35, 0xbf800000, 0x3ec4bf6d, 0x3f353f35, 0xbf6d3ec4
.long 0x3f80, 0xbf800000, 0xbf80, 0x3f800000, 0x3f800000, 0x3ec43f6d, 0xbf353f35, 0xbf6dbec4
.long 0xbf80, 0x3f35bf35, 0x3f800000, 0x3f353f35, 0xbf800000, 0xbf6dbec4, 0xbf35bf35, 0xbec4bf6d
.long 0x3f80, 0x3f80, 0x3f80, 0x3f80, 0xbf80, 0xbec4bf6d, 0xbf35bf35, 0xbf6dbec4
.long 0x3f80, 0x3f353f35, 0x3f800000, 0x3f35bf35, 0xbf80, 0xbf6dbec4, 0xbf353f35, 0x3ec43f6d
.long 0x3f80, 0x3f800000, 0xbf80, 0xbf800000, 0xbf80, 0xbf6d3ec4, 0x3f353f35, 0x3ec4bf6d
.long 0x3f80, 0x3f35bf35, 0xbf800000, 0x3f353f35, 0xbf80, 0xbec43f6d, 0x3f35bf35, 0xbf6d3ec4
.long 0x3f80, 0xbf80, 0x3f80, 0xbf80, 0xbf80, 0x3ec43f6d, 0xbf35bf35, 0x3f6d3ec4
.long 0x3f80, 0xbf35bf35, 0x3f800000, 0xbf353f35, 0xbf80, 0x3f6d3ec4, 0xbf353f35, 0xbec4bf6d
.long 0x3f80, 0xbf800000, 0xbf80, 0x3f800000, 0xbf80, 0x3f6dbec4, 0x3f353f35, 0xbec43f6d
.long 0x3f80, 0xbf353f35, 0xbf800000, 0xbf35bf35, 0xbf80, 0x3ec4bf6d, 0x3f35bf35, 0x3f6dbec4
.long 0x3f80, 0x3f80, 0x3f80, 0x3f80, 0xbf800000, 0xbf6d3ec4, 0xbf353f35, 0xbec43f6d
.long 0xbf80, 0xbf35bf35, 0xbf800000, 0xbf353f35, 0x3f800000, 0x3ec4bf6d, 0xbf35bf35, 0xbf6d3ec4
.long 0x3f80, 0x3f800000, 0xbf80, 0xbf800000, 0xbf800000, 0x3ec43f6d, 0x3f35bf35, 0xbf6dbec4
.long 0xbf80, 0xbf353f35, 0x3f800000, 0xbf35bf35, 0x3f800000, 0xbf6dbec4, 0x3f353f35, 0xbec4bf6d
.long 0x3f80, 0xbf80, 0x3f80, 0xbf80, 0xbf800000, 0x3f6dbec4, 0xbf353f35, 0x3ec4bf6d
.long 0xbf80, 0x3f353f35, 0xbf800000, 0x3f35bf35, 0x3f800000, 0xbec43f6d, 0xbf35bf35, 0x3f6dbec4
.long 0x3f80, 0xbf800000, 0xbf80, 0x3f800000, 0xbf800000, 0xbec4bf6d, 0x3f35bf35, 0x3f6d3ec4
.long 0xbf80, 0x3f35bf35, 0x3f800000, 0x3f353f35, 0x3f800000, 0x3f6d3ec4, 0x3f353f35, 0x3ec43f6d
.long 0x3f80, 0x3f80, 0x3f80, 0x3f80, 0x3f80, 0x3ec43f6d, 0x3f353f35, 0x3f6d3ec4
.long 0x3f80, 0x3f353f35, 0x3f800000, 0x3f35bf35, 0x3f80, 0x3f6d3ec4, 0x3f35bf35, 0xbec4bf6d
.long 0x3f80, 0x3f800000, 0xbf80, 0xbf800000, 0x3f80, 0x3f6dbec4, 0xbf35bf35, 0xbec43f6d
.long 0x3f80, 0x3f35bf35, 0xbf800000, 0x3f353f35, 0x3f80, 0x3ec4bf6d, 0xbf353f35, 0x3f6dbec4
.long 0x3f80, 0xbf80, 0x3f80, 0xbf80, 0x3f80, 0xbec4bf6d, 0x3f353f35, 0xbf6dbec4
.long 0x3f80, 0xbf35bf35, 0x3f800000, 0xbf353f35, 0x3f80, 0xbf6dbec4, 0x3f35bf35, 0x3ec43f6d
.long 0x3f80, 0xbf800000, 0xbf80, 0x3f800000, 0x3f80, 0xbf6d3ec4, 0xbf35bf35, 0x3ec4bf6d
.long 0x3f80, 0xbf353f35, 0xbf800000, 0xbf35bf35, 0x3f80, 0xbec43f6d, 0xbf353f35, 0xbf6d3ec4
.long 0x3f80, 0x3f80, 0x3f80, 0x3f80, 0x3f800000, 0x3f6dbec4, 0x3f35bf35, 0x3ec4bf6d
.long 0xbf80, 0xbf35bf35, 0xbf800000, 0xbf353f35, 0xbf800000, 0xbec43f6d, 0x3f353f35, 0x3f6dbec4
.long 0x3f80, 0x3f800000, 0xbf80, 0xbf800000, 0x3f800000, 0xbec4bf6d, 0xbf353f35, 0x3f6d3ec4
.long 0xbf80, 0xbf353f35, 0x3f800000, 0xbf35bf35, 0xbf800000, 0x3f6d3ec4, 0xbf35bf35, 0x3ec43f6d
.long 0x3f80, 0xbf80, 0x3f80, 0xbf80, 0x3f800000, 0xbf6d3ec4, 0x3f35bf35, 0xbec43f6d
.long 0xbf80, 0x3f353f35, 0xbf800000, 0x3f35bf35, 0xbf800000, 0x3ec4bf6d, 0x3f353f35, 0xbf6d3ec4
.long 0x3f80, 0xbf800000, 0xbf80, 0x3f800000, 0x3f800000, 0x3ec43f6d, 0xbf353f35, 0xbf6dbec4
.long 0xbf80, 0x3f35bf35, 0x3f800000, 0x3f353f35, 0xbf800000, 0xbf6dbec4, 0xbf35bf35, 0xbec4bf6d
.long 0x3f80, 0x3f80, 0x3f80, 0x3f80, 0xbf80, 0xbec4bf6d, 0xbf35bf35, 0xbf6dbec4
.long 0x3f80, 0x3f353f35, 0x3f800000, 0x3f35bf35, 0xbf80, 0xbf6dbec4, 0xbf353f35, 0x3ec43f6d
.long 0x3f80, 0x3f800000, 0xbf80, 0xbf800000, 0xbf80, 0xbf6d3ec4, 0x3f353f35, 0x3ec4bf6d
.long 0x3f80, 0x3f35bf35, 0xbf800000, 0x3f353f35, 0xbf80, 0xbec43f6d, 0x3f35bf35, 0xbf6d3ec4
.long 0x3f80, 0xbf80, 0x3f80, 0xbf80, 0xbf80, 0x3ec43f6d, 0xbf35bf35, 0x3f6d3ec4
.long 0x3f80, 0xbf35bf35, 0x3f800000, 0xbf353f35, 0xbf80, 0x3f6d3ec4, 0xbf353f35, 0xbec4bf6d
.long 0x3f80, 0xbf800000, 0xbf80, 0x3f800000, 0xbf80, 0x3f6dbec4, 0x3f353f35, 0xbec43f6d
.long 0x3f80, 0xbf353f35, 0xbf800000, 0xbf35bf35, 0xbf80, 0x3ec4bf6d, 0x3f35bf35, 0x3f6dbec4
.long 0x3f80, 0x3f80, 0x3f80, 0x3f80, 0xbf800000, 0xbf6d3ec4, 0xbf353f35, 0xbec43f6d
.long 0xbf80, 0xbf35bf35, 0xbf800000, 0xbf353f35, 0x3f800000, 0x3ec4bf6d, 0xbf35bf35, 0xbf6d3ec4
.long 0x3f80, 0x3f800000, 0xbf80, 0xbf800000, 0xbf800000, 0x3ec43f6d, 0x3f35bf35, 0xbf6dbec4
.long 0xbf80, 0xbf353f35, 0x3f800000, 0xbf35bf35, 0x3f800000, 0xbf6dbec4, 0x3f353f35, 0xbec4bf6d
.long 0x3f80, 0xbf80, 0x3f80, 0xbf80, 0xbf800000, 0x3f6dbec4, 0xbf353f35, 0x3ec4bf6d
.long 0xbf80, 0x3f353f35, 0xbf800000, 0x3f35bf35, 0x3f800000, 0xbec43f6d, 0xbf35bf35, 0x3f6dbec4
.long 0x3f80, 0xbf800000, 0xbf80, 0x3f800000, 0xbf800000, 0xbec4bf6d, 0x3f35bf35, 0x3f6d3ec4
.long 0xbf80, 0x3f35bf35, 0x3f800000, 0x3f353f35, 0x3f800000, 0x3f6d3ec4, 0x3f353f35, 0x3ec43f6d
.long 0x3f80, 0x3f80, 0x3f80, 0x3f80, 0x3e483f7b, 0x3f0e3f55, 0x3f553f0e, 0x3f7b3e48
.long 0x3ec43f6d, 0x3f6d3ec4, 0x3f6dbec4, 0x3ec4bf6d, 0x3f0e3f55, 0x3f7bbe48, 0x3e48bf7b, 0xbf55bf0e
.long 0x3f353f35, 0x3f35bf35, 0xbf35bf35, 0xbf353f35, 0x3f553f0e, 0x3e48bf7b, 0xbf7b3e48, 0x3f0e3f55
.long 0x3f6d3ec4, 0xbec4bf6d, 0xbec43f6d, 0x3f6dbec4, 0x3f7b3e48, 0xbf55bf0e, 0x3f0e3f55, 0xbe48bf7b
.long 0x3f800000, 0xbf800000, 0x3f800000, 0xbf800000, 0x3f7bbe48, 0xbf553f0e, 0x3f0ebf55, 0xbe483f7b
.long 0x3f6dbec4, 0xbec43f6d, 0xbec4bf6d, 0x3f6d3ec4, 0x3f55bf0e, 0x3e483f7b, 0xbf7bbe48, 0x3f0ebf55
.long 0x3f35bf35, 0x3f353f35, 0xbf353f35, 0xbf35bf35, 0x3f0ebf55, 0x3f7b3e48, 0x3e483f7b, 0xbf553f0e
.long 0x3ec4bf6d, 0x3f6dbec4, 0x3f6d3ec4, 0x3ec43f6d, 0x3e48bf7b, 0x3f0ebf55, 0x3f55bf0e, 0x3f7bbe48
.long 0x3f80, 0x3f80, 0x3f80, 0x3f80, 0x3f7bbe48, 0x3f55bf0e, 0x3f0ebf55, 0x3e48bf7b
.long 0xbec4bf6d, 0xbf6dbec4, 0xbf6d3ec4, 0xbec43f6d, 0xbf553f0e, 0x3e483f7b, 0x3f7b3e48, 0x3f0ebf55
.long 0x3f353f35, 0x3f35bf35, 0xbf35bf35, 0xbf353f35, 0x3f0ebf55, 0xbf7bbe48, 0x3e483f7b, 0x3f55bf0e
.long 0xbf6dbec4, 0x3ec43f6d, 0x3ec4bf6d, 0xbf6d3ec4, 0xbe483f7b, 0x3f0ebf55, 0xbf553f0e, 0x3f7bbe48
.long 0x3f800000, 0xbf800000, 0x3f800000, 0xbf800000, 0xbe48bf7b, 0x3f0e3f55, 0xbf55bf0e, 0x3f7b3e48
.long 0xbf6d3ec4, 0x3ec4bf6d, 0x3ec43f6d, 0xbf6dbec4, 0x3f0e3f55, 0xbf7b3e48, 0x3e48bf7b, 0x3f553f0e
.long 0x3f35bf35, 0x3f353f35, 0xbf353f35, 0xbf35bf35, 0xbf55bf0e, 0x3e48bf7b, 0x3f7bbe48, 0x3f0e3f55
.long 0xbec43f6d, 0xbf6d3ec4, 0xbf6dbec4, 0xbec4bf6d, 0x3f7b3e48, 0x3f553f0e, 0x3f0e3f55, 0x3e483f7b
.long 0x3f80, 0x3f80, 0x3f80, 0x3f80, 0xbe48bf7b, 0xbf0ebf55, 0xbf55bf0e, 0xbf7bbe48
.long 0x3ec43f6d, 0x3f6d3ec4, 0x3f6dbec4, 0x3ec4bf6d, 0xbf0ebf55, 0xbf7b3e48, 0xbe483f7b, 0x3f553f0e
.long 0x3f353f35, 0x3f35bf35, 0xbf35bf35, 0xbf353f35, 0xbf55bf0e, 0xbe483f7b, 0x3f7bbe48, 0xbf0ebf55
.long 0x3f6d3ec4, 0xbec4bf6d, 0xbec43f6d, 0x3f6dbec4, 0xbf7bbe48, 0x3f553f0e, 0xbf0ebf55, 0x3e483f7b
.long 0x3f800000, 0xbf800000, 0x3f800000, 0xbf800000, 0xbf7b3e48, 0x3f55bf0e, 0xbf0e3f55, 0x3e48bf7b
.long 0x3f6dbec4, 0xbec43f6d, 0xbec4bf6d, 0x3f6d3ec4, 0xbf553f0e, 0xbe48bf7b, 0x3f7b3e48, 0xbf0e3f55
.long 0x3f35bf35, 0x3f353f35, 0xbf353f35, 0xbf35bf35, 0xbf0e3f55, 0xbf7bbe48, 0xbe48bf7b, 0x3f55bf0e
.long 0x3ec4bf6d, 0x3f6dbec4, 0x3f6d3ec4, 0x3ec43f6d, 0xbe483f7b, 0xbf0e3f55, 0xbf553f0e, 0xbf7b3e48
.long 0x3f80, 0x3f80, 0x3f80, 0x3f80, 0xbf7b3e48, 0xbf553f0e, 0xbf0e3f55, 0xbe483f7b
.long 0xbec4bf6d, 0xbf6dbec4, 0xbf6d3ec4, 0xbec43f6d, 0x3f55bf0e, 0xbe48bf7b, 0xbf7bbe48, 0xbf0e3f55
.long 0x3f353f35, 0x3f35bf35, 0xbf35bf35, 0xbf353f35, 0xbf0e3f55, 0x3f7b3e48, 0xbe48bf7b, 0xbf553f0e
.long 0xbf6dbec4, 0x3ec43f6d, 0x3ec4bf6d, 0xbf6d3ec4, 0x3e48bf7b, 0xbf0e3f55, 0x3f55bf0e, 0xbf7b3e48
.long 0x3f800000, 0xbf800000, 0x3f800000, 0xbf800000, 0x3e483f7b, 0xbf0ebf55, 0x3f553f0e, 0xbf7bbe48
.long 0xbf6d3ec4, 0x3ec4bf6d, 0x3ec43f6d, 0xbf6dbec4, 0xbf0ebf55, 0x3f7bbe48, 0xbe483f7b, 0xbf55bf0e
.long 0x3f35bf35, 0x3f353f35, 0xbf353f35, 0xbf35bf35, 0x3f553f0e, 0xbe483f7b, 0xbf7b3e48, 0xbf0ebf55
.long 0xbec43f6d, 0xbf6d3ec4, 0xbf6dbec4, 0xbec4bf6d, 0xbf7bbe48, 0xbf55bf0e, 0xbf0ebf55, 0xbe48bf7b
.long 0xbf80, 0xbf80, 0xbf80, 0xbf80, 0xbe48bf7b, 0xbf0ebf55, 0xbf55bf0e, 0xbf7bbe48
.long 0xbec4bf6d, 0xbf6dbec4, 0xbf6d3ec4, 0xbec43f6d, 0xbf0ebf55, 0xbf7b3e48, 0xbe483f7b, 0x3f553f0e
.long 0xbf35bf35, 0xbf353f35, 0x3f353f35, 0x3f35bf35, 0xbf55bf0e, 0xbe483f7b, 0x3f7bbe48, 0xbf0ebf55
.long 0xbf6dbec4, 0x3ec43f6d, 0x3ec4bf6d, 0xbf6d3ec4, 0xbf7bbe48, 0x3f553f0e, 0xbf0ebf55, 0x3e483f7b
.long 0xbf800000, 0x3f800000, 0xbf800000, 0x3f800000, 0xbf7b3e48, 0x3f55bf0e, 0xbf0e3f55, 0x3e48bf7b
.long 0xbf6d3ec4, 0x3ec4bf6d, 0x3ec43f6d, 0xbf6dbec4, 0xbf553f0e, 0xbe48bf7b, 0x3f7b3e48, 0xbf0e3f55
.long 0xbf353f35, 0xbf35bf35, 0x3f35bf35, 0x3f353f35, 0xbf0e3f55, 0xbf7bbe48, 0xbe48bf7b, 0x3f55bf0e
.long 0xbec43f6d, 0xbf6d3ec4, 0xbf6dbec4, 0xbec4bf6d, 0xbe483f7b, 0xbf0e3f55, 0xbf553f0e, 0xbf7b3e48
.long 0xbf80, 0xbf80, 0xbf80, 0xbf80, 0xbf7b3e48, 0xbf553f0e, 0xbf0e3f55, 0xbe483f7b
.long 0x3ec43f6d, 0x3f6d3ec4, 0x3f6dbec4, 0x3ec4bf6d, 0x3f55bf0e, 0xbe48bf7b, 0xbf7bbe48, 0xbf0e3f55
.long 0xbf35bf35, 0xbf353f35, 0x3f353f35, 0x3f35bf35, 0xbf0e3f55, 0x3f7b3e48, 0xbe48bf7b, 0xbf553f0e
.long 0x3f6d3ec4, 0xbec4bf6d, 0xbec43f6d, 0x3f6dbec4, 0x3e48bf7b, 0xbf0e3f55, 0x3f55bf0e, 0xbf7b3e48
.long 0xbf800000, 0x3f800000, 0xbf800000, 0x3f800000, 0x3e483f7b, 0xbf0ebf55, 0x3f553f0e, 0xbf7bbe48
.long 0x3f6dbec4, 0xbec43f6d, 0xbec4bf6d, 0x3f6d3ec4, 0xbf0ebf55, 0x3f7bbe48, 0xbe483f7b, 0xbf55bf0e
.long 0xbf353f35, 0xbf35bf35, 0x3f35bf35, 0x3f353f35, 0x3f553f0e, 0xbe483f7b, 0xbf7b3e48, 0xbf0ebf55
.long 0x3ec4bf6d, 0x3f6dbec4, 0x3f6d3ec4, 0x3ec43f6d, 0xbf7bbe48, 0xbf55bf0e, 0xbf0ebf55, 0xbe48bf7b
.long 0xbf80, 0xbf80, 0xbf80, 0xbf80, 0x3e483f7b, 0x3f0e3f55, 0x3f553f0e, 0x3f7b3e48
.long 0xbec4bf6d, 0xbf6dbec4, 0xbf6d3ec4, 0xbec43f6d, 0x3f0e3f55, 0x3f7bbe48, 0x3e48bf7b, 0xbf55bf0e
.long 0xbf35bf35, 0xbf353f35, 0x3f353f35, 0x3f35bf35, 0x3f553f0e, 0x3e48bf7b, 0xbf7b3e48, 0x3f0e3f55
.long 0xbf6dbec4, 0x3ec43f6d, 0x3ec4bf6d, 0xbf6d3ec4, 0x3f7b3e48, 0xbf55bf0e, 0x3f0e3f55, 0xbe48bf7b
.long 0xbf800000, 0x3f800000, 0xbf800000, 0x3f800000, 0x3f7bbe48, 0xbf553f0e, 0x3f0ebf55, 0xbe483f7b
.long 0xbf6d3ec4, 0x3ec4bf6d, 0x3ec43f6d, 0xbf6dbec4, 0x3f55bf0e, 0x3e483f7b, 0xbf7bbe48, 0x3f0ebf55
.long 0xbf353f35, 0xbf35bf35, 0x3f35bf35, 0x3f353f35, 0x3f0ebf55, 0x3f7b3e48, 0x3e483f7b, 0xbf553f0e
.long 0xbec43f6d, 0xbf6d3ec4, 0xbf6dbec4, 0xbec4bf6d, 0x3e48bf7b, 0x3f0ebf55, 0x3f55bf0e, 0x3f7bbe48
.long 0xbf80, 0xbf80, 0xbf80, 0xbf80, 0x3f7bbe48, 0x3f55bf0e, 0x3f0ebf55, 0x3e48bf7b
.long 0x3ec43f6d, 0x3f6d3ec4, 0x3f6dbec4, 0x3ec4bf6d, 0xbf553f0e, 0x3e483f7b, 0x3f7b3e48, 0x3f0ebf55
.long 0xbf35bf35, 0xbf353f35, 0x3f353f35, 0x3f35bf35, 0x3f0ebf55, 0xbf7bbe48, 0x3e483f7b, 0x3f55bf0e
.long 0x3f6d3ec4, 0xbec4bf6d, 0xbec43f6d, 0x3f6dbec4, 0xbe483f7b, 0x3f0ebf55, 0xbf553f0e, 0x3f7bbe48
.long 0xbf800000, 0x3f800000, 0xbf800000, 0x3f800000, 0xbe48bf7b, 0x3f0e3f55, 0xbf55bf0e, 0x3f7b3e48
.long 0x3f6dbec4, 0xbec43f6d, 0xbec4bf6d, 0x3f6d3ec4, 0x3f0e3f55, 0xbf7b3e48, 0x3e48bf7b, 0x3f553f0e
.long 0xbf353f35, 0xbf35bf35, 0x3f35bf35, 0x3f353f35, 0xbf55bf0e, 0x3e48bf7b, 0x3f7bbe48, 0x3f0e3f55
.long 0x3ec4bf6d, 0x3f6dbec4, 0x3f6d3ec4, 0x3ec43f6d, 0x3f7b3e48, 0x3f553f0e, 0x3f0e3f55, 0x3e483f7b
L_tabend:
.size L_tab, L_tabend - L_tab
.section .rodata,"a"
.p2align 6
.amdhsa_kernel gated_mix__spectral_fnet__moe_arch_mod__prompt_kernel
  .amdhsa_next_free_vgpr 256
  .amdhsa_next_free_sgpr 102
  .amdhsa_accum_offset 256
  .amdhsa_group_segment_fixed_size 0
  .amdhsa_kernarg_size 112
  .amdhsa_user_sgpr_count 2
  .amdhsa_user_sgpr_kernarg_segment_ptr 1
  .amdhsa_system_sgpr_workgroup_id_x 1
.end_amdhsa_kernel
```

```asm
; @launch grid=(256,1,1) block=(512,1,1) lds=100352
.amdgcn_target "amdgcn-amd-amdhsa--gfx950"
.text
.globl gated_mix__spectral_fnet__moe_arch_mod__prompt_kernel
.p2align 8
.type gated_mix__spectral_fnet__moe_arch_mod__prompt_kernel,@function
gated_mix__spectral_fnet__moe_arch_mod__prompt_kernel:
    s_cmp_ge_u32 s2, 256
    s_cbranch_scc1 L_end
    s_load_dwordx2 s[4:5], s[0:1], 0
    s_load_dwordx16 s[16:31], s[0:1], 48
    s_getpc_b64 s[10:11]
L_pc:
    v_lshrrev_b32 v1, 6, v0
    s_lshr_b32 s57, s2, 3
    v_lshl_add_u32 v4, v0, 5, s57
    v_lshlrev_b32 v4, 7, v4
    v_cmp_gt_u32 vcc, L_tabend - L_pc, v4
    s_nop 0
    s_and_saveexec_b64 s[12:13], vcc
    s_cbranch_execz L_nocpf
    global_load_dword v249, v4, s[10:11]
L_nocpf:
    s_mov_b64 exec, s[12:13]
    v_and_b32 v0, 63, v0
    v_readfirstlane_b32 s3, v1
    v_and_b32 v2, 15, v0
    v_lshrrev_b32 v3, 4, v0
    v_lshlrev_b32 v247, 4, v0
    v_lshlrev_b32 v246, 3, v0
    s_add_u32 s10, s10, L_tab - L_pc
    s_addc_u32 s11, s11, 0
    s_and_b32 s56, s2, 7
    s_mov_b32 s90, 400000
    s_cmp_lt_u32 s57, 16
    s_cbranch_scc1 L_low
    s_sub_u32 s57, s57, 16
    s_lshl4_add_u32 s9, s56, s57
    s_lshl4_add_u32 s58, s57, s56
    s_sub_u32 s62, s58, 120
    s_cmp_lt_u32 s9, 8
    s_cselect_b32 s62, s58, s62
    s_cmp_lt_u32 s9, 16
    s_cselect_b32 s58, s62, s58
L_a:
    s_cmp_ge_u32 s3, 4
    s_cbranch_scc1 L_p1w
    s_lshl2_add_u32 s60, s57, s3
    s_lshl_b32 s60, s60, 5
    s_add_u32 s60, s60, s56
    s_lshl_b32 s12, s60, 10
    s_cmp_eq_u32 s58, 128
    s_cselect_b32 s12, 0x40000000, s12
    s_add_u32 s13, s12, 8192
    s_add_u32 s14, s12, 16384
    s_add_u32 s15, s12, 24576
    s_waitcnt lgkmcnt(0)
    s_load_dword s59, s[30:31], 0
    s_mov_b32 s32, s4
    s_mov_b32 s33, s5
    s_mov_b32 s34, 0x200000
    s_mov_b32 s35, 0x20000
    s_mov_b32 s36, s30
    s_mov_b32 s37, s31
    s_mov_b32 s38, 0x400000
    s_mov_b32 s39, 0x20000
    buffer_load_dwordx4 v[8:11], v247, s[32:35], s12 offen
    buffer_load_dwordx4 v[12:15], v247, s[32:35], s13 offen
    buffer_load_dwordx4 v[16:19], v247, s[32:35], s14 offen
    buffer_load_dwordx4 v[20:23], v247, s[32:35], s15 offen
    s_mov_b32 s44, s16
    s_mov_b32 s45, s17
    s_mov_b32 s46, 0x400
    s_mov_b32 s47, 0x20000
    buffer_load_dwordx4 v[24:27], v247, s[44:47], 0 offen
    v_and_b32 v36, 1, v3
    v_lshrrev_b32 v108, 1, v3
    v_lshl_add_u32 v36, v36, 1, v108
    v_lshl_add_u32 v36, v36, 3, s60
    v_mov_b32 v108, 43008
    s_mov_b32 s8, 0xfffff800
    s_lshl3_add_u32 s15, s57, s56
    s_lshl_b32 s15, s15, 3
    s_add_u32 s15, s15, 0x40000
    v_lshlrev_b32 v37, 11, v0
    s_xor_b32 s98, s3, 4
    v_lshl_add_u32 v96, v2, 4, s98
    v_lshlrev_b32 v98, 2, v3
    v_cvt_f32_u32 v98, v98
    v_cvt_f32_u32 v96, v96
    v_mul_f32 v96, 0x3b800000, v96
    v_mul_f32 v99, v98, v96
    v_cos_f32 v102, v99
    v_sin_f32 v103, v99
    v_add_f32 v99, v99, v96
    v_cvt_pk_bf16_f32 v112, v102, v103
    v_cvt_pk_bf16_f32 v116, -v103, v102
    v_cos_f32 v102, v99
    v_sin_f32 v103, v99
    v_add_f32 v99, v99, v96
    v_cvt_pk_bf16_f32 v113, v102, v103
    v_cvt_pk_bf16_f32 v117, -v103, v102
    v_cos_f32 v102, v99
    v_sin_f32 v103, v99
    v_add_f32 v99, v99, v96
    v_cvt_pk_bf16_f32 v114, v102, v103
    v_cvt_pk_bf16_f32 v118, -v103, v102
    v_cos_f32 v102, v99
    v_sin_f32 v103, v99
    s_nop 0
    v_cvt_pk_bf16_f32 v115, v102, v103
    v_cvt_pk_bf16_f32 v119, -v103, v102
    v_mov_b32 v96, 0x80000000
    v_mov_b32 v97, 0x8000
    v_xor_b32 v120, v96, v112
    v_xor_b32 v124, v97, v116
    v_xor_b32 v121, v96, v113
    v_xor_b32 v125, v97, v117
    v_xor_b32 v122, v96, v114
    v_xor_b32 v126, v97, v118
    v_xor_b32 v123, v96, v115
    v_xor_b32 v127, v97, v119
    s_sub_u32 s60, 16, s98
    s_cmp_eq_u32 s98, 0
    s_cselect_b32 s60, 8, s60
    v_bfe_u32 v96, v2, 2, 1
    v_xor_b32 v96, v96, v2
    v_lshrrev_b32 v97, 3, v2
    v_mul_u32_u24 v98, 3, v97
    v_xor_b32 v98, v98, v3
    v_lshlrev_b32 v98, 4, v98
    v_lshl_add_u32 v96, v96, 6, v98
    s_lshl_b32 s61, s98, 3
    s_and_b32 s61, s61, 32
    s_lshl_b32 s62, s98, 10
    s_or_b32 s61, s61, s62
    v_xor_b32 v60, s61, v96
    s_lshl_b32 s61, s60, 3
    s_and_b32 s61, s61, 32
    s_lshl_b32 s62, s60, 10
    s_or_b32 s61, s61, s62
    v_xor_b32 v61, s61, v96
    v_lshlrev_b32 v63, 16, v3
    v_lshl_add_u32 v63, v97, 14, v63
    v_and_b32 v96, 7, v2
    v_lshl_add_u32 v63, v96, 4, v63
    s_lshl_b32 s6, s98, 18
    s_lshl_b32 s61, s56, 11
    s_add_u32 s6, s6, s61
    s_lshl_b32 s61, s57, 7
    s_add_u32 s6, s6, s61
    s_add_u32 s6, s6, 0x200000
    s_add_u32 s7, s6, 32768
    v_lshlrev_b32 v4, 5, v2
    v_and_b32 v96, 1, v3
    v_lshl_add_u32 v4, v96, 9, v4
    v_lshrrev_b32 v96, 1, v3
    v_lshl_add_u32 v4, v96, 4, v4
    s_lshl_b32 s60, s3, 8
    s_add_u32 s93, s60, s58
    s_sub_u32 s94, 2048, s93
    s_and_b32 s94, s94, 2047
    s_mov_b32 s48, s24
    s_mov_b32 s49, s25
    s_mov_b32 s50, 0x400
    s_mov_b32 s51, 0x20000
    s_waitcnt vmcnt(1)
    s_barrier
    s_waitcnt vmcnt(0)
    v_dot2_f32_bf16 v32, v8, v24, 0
    v_dot2_f32_bf16 v33, v12, v24, 0
    v_dot2_f32_bf16 v34, v16, v24, 0
    v_dot2_f32_bf16 v35, v20, v24, 0
    v_dot2_f32_bf16 v32, v9, v25, v32
    v_dot2_f32_bf16 v33, v13, v25, v33
    v_dot2_f32_bf16 v34, v17, v25, v34
    v_dot2_f32_bf16 v35, v21, v25, v35
    v_dot2_f32_bf16 v32, v10, v26, v32
    v_dot2_f32_bf16 v33, v14, v26, v33
    v_dot2_f32_bf16 v34, v18, v26, v34
    v_dot2_f32_bf16 v35, v22, v26, v35
    v_dot2_f32_bf16 v32, v11, v27, v32
    v_dot2_f32_bf16 v33, v15, v27, v33
    v_dot2_f32_bf16 v34, v19, v27, v34
    v_dot2_f32_bf16 v35, v23, v27, v35
    s_waitcnt lgkmcnt(0)
    s_add_u32 s59, s59, 0x9e3779b9
    s_bitcmp1_b32 s59, 0
    s_cselect_b32 s91, 1, 0x10000
    s_xor_b32 s92, s91, 0x10001
    v_permlane32_swap_b32 v32, v33
    v_permlane32_swap_b32 v34, v35
    v_add_f32 v32, v32, v33
    v_add_f32 v34, v34, v35
    s_nop 1
    v_permlane16_swap_b32 v32, v34
    v_add_f32 v32, v32, v34
    v_mov_b32 v39, s59
    s_nop 0
    v_add_f32_dpp v32, v32, v32 row_ror:8 row_mask:0xf bank_mask:0xf
    s_nop 1
    v_add_f32_dpp v32, v32, v32 row_ror:4 row_mask:0xf bank_mask:0xf
    s_nop 1
    v_add_f32_dpp v32, v32, v32 row_ror:2 row_mask:0xf bank_mask:0xf
    s_nop 1
    v_add_f32_dpp v32, v32, v32 row_ror:1 row_mask:0xf bank_mask:0xf
    v_ashrrev_i32 v33, 31, v32
    v_or_b32 v33, 0x80000000, v33
    v_xor_b32 v33, v33, v32
    v_and_or_b32 v33, v33, s8, v36
    s_mov_b32 exec_lo, 0x10001
    s_mov_b32 exec_hi, 0x10001
    ds_max_u32 v108, v33
    s_mov_b64 exec, -1
    s_waitcnt lgkmcnt(0)
    s_barrier
    s_cmp_lg_u32 s3, 0
    s_cbranch_scc1 L_b1a
    ds_read_b32 v38, v108
    s_waitcnt lgkmcnt(0)
    s_cmp_eq_u32 s58, 128
    s_cbranch_scc1 L_b1a
    s_mov_b64 exec, 0xffffffff
    buffer_store_dwordx2 v[38:39], v37, s[36:39], s15 offen sc1
    s_mov_b64 exec, -1
L_b1a:
    s_lshl_b32 s63, s3, 1
    s_lshl_b32 s60, s63, 10
    v_lshl_add_u32 v248, v0, 4, s60
    s_add_u32 m0, s60, 32768
    global_load_lds_dwordx4 v248, s[10:11] offset:0
    global_load_lds_dwordx4 v248, s[10:11] offset:1024
    s_and_b32 s63, s3, 1
    s_add_u32 s63, s63, 8
    s_lshl_b32 s60, s63, 10
    v_lshl_add_u32 v248, v0, 4, s60
    s_add_u32 m0, s60, 32768
    global_load_lds_dwordx4 v248, s[10:11] offset:0
    s_lshl_b32 s12, s93, 10
    s_lshl_b32 s13, s94, 10
    buffer_load_dwordx4 v[232:235], v4, s[32:35], s12 offen
    buffer_load_dwordx4 v[236:239], v4, s[32:35], s13 offen
    buffer_load_dwordx4 v[240:243], v4, s[48:51], 0 offen
    v_mov_b32 v104, s91
    v_mov_b32 v105, s92
    v_mov_b32 v106, 0x00010001
    s_branch L_b1
L_p1w:
    s_sub_u32 s96, s3, 4
    s_lshl_b32 s60, s56, 2
    s_mul_i32 s61, s56, 3
    s_add_u32 s61, s61, 4
    s_cmp_lt_u32 s56, 4
    s_cselect_b32 s60, s60, s61
    s_cselect_b32 s61, 16, 12
    s_cmp_ge_u32 s57, s61
    s_cselect_b32 s63, 8, s96
    s_lshr_b32 s61, s57, 2
    s_add_u32 s60, s60, s61
    s_lshl_b32 s6, s60, 7
    s_and_b32 s61, s57, 3
    s_mul_i32 s61, s61, 3
    s_add_u32 s61, s61, s96
    s_lshl_b32 s61, s61, 5
    s_add_u32 s61, s61, 128
    v_lshrrev_b32 v100, 1, v0
    v_add_u32 v100, s61, v100
    v_mul_u32_u24 v100, 3584, v100
    v_and_b32 v101, 1, v0
    v_lshl_add_u32 v100, v101, 6, v100
    s_waitcnt lgkmcnt(0)
    s_mov_b32 s52, s18
    s_mov_b32 s53, s19
    s_mov_b32 s54, 0x1c0000
    s_mov_b32 s55, 0x20000
    s_cmp_ge_u32 s63, 3
    s_cbranch_scc1 L_noapf
    buffer_load_dword v255, v100, s[52:55], s6 offen
L_noapf:
    s_waitcnt lgkmcnt(0)
    s_mov_b32 s32, s4
    s_mov_b32 s33, s5
    s_mov_b32 s34, 0x200000
    s_mov_b32 s35, 0x20000
    s_mov_b32 s36, s30
    s_mov_b32 s37, s31
    s_mov_b32 s38, 0x400000
    s_mov_b32 s39, 0x20000
    s_cmp_lg_u32 s3, 7
    s_cbranch_scc1 L_nomt
    v_mov_b32 v252, s16
    v_mov_b32 v253, s17
    v_writelane_b32 v252, s24, 1
    v_writelane_b32 v253, s25, 1
    v_writelane_b32 v252, s26, 2
    v_writelane_b32 v253, s27, 2
    s_add_u32 s63, s30, 0x3000
    v_writelane_b32 v252, s63, 3
    s_addc_u32 s63, s31, 0
    v_writelane_b32 v253, s63, 3
    s_add_u32 s63, s30, 0x203000
    v_writelane_b32 v252, s63, 4
    s_addc_u32 s63, s31, 0
    v_writelane_b32 v253, s63, 4
    s_mov_b64 exec, 0x1f
    global_load_dword v254, v[252:253], off
    s_mov_b64 exec, -1
L_nomt:
    v_lshlrev_b32 v107, 19, v3
    v_bfe_u32 v108, v0, 2, 2
    v_lshl_add_u32 v107, v108, 13, v107
    v_and_b32 v109, 3, v0
    v_lshl_add_u32 v107, v109, 4, v107
    v_mov_b32 v96, 43008
    v_mov_b32 v98, 0
    v_mov_b32 v99, 0
    ds_write_b64 v96, v[98:99]
    v_lshlrev_b32 v96, 2, v3
    v_cvt_f32_u32 v96, v96
    v_cvt_f32_u32 v97, v2
    v_mul_f32 v97, 0x3d800000, v97
    v_mul_f32 v96, v96, v97
    v_cos_f32 v102, v96
    v_sin_f32 v103, v96
    v_add_f32 v96, v96, v97
    v_cvt_pk_bf16_f32 v40, v102, v103
    v_cvt_pk_bf16_f32 v44, -v103, v102
    v_cos_f32 v102, v96
    v_sin_f32 v103, v96
    v_add_f32 v96, v96, v97
    v_cvt_pk_bf16_f32 v41, v102, v103
    v_cvt_pk_bf16_f32 v45, -v103, v102
    v_cos_f32 v102, v96
    v_sin_f32 v103, v96
    v_add_f32 v96, v96, v97
    v_cvt_pk_bf16_f32 v42, v102, v103
    v_cvt_pk_bf16_f32 v46, -v103, v102
    v_cos_f32 v102, v96
    v_sin_f32 v103, v96
    s_nop 0
    v_cvt_pk_bf16_f32 v43, v102, v103
    v_cvt_pk_bf16_f32 v47, -v103, v102
    v_lshrrev_b32 v96, 1, v109
    v_mul_u32_u24 v96, 3, v96
    v_lshlrev_b32 v97, 1, v3
    v_and_b32 v97, 2, v97
    v_xor_b32 v96, v96, v97
    v_xor_b32 v96, s96, v96
    v_lshl_add_u32 v96, v96, 2, v108
    v_lshlrev_b32 v96, 2, v96
    v_lshl_add_u32 v96, v109, 8, v96
    v_lshl_add_u32 v96, v3, 12, v96
    v_and_b32 v97, 1, v109
    v_lshl_add_u32 v48, v97, 6, v96
    v_xor_b32 v49, 64, v48
    v_add_u32 v50, 128, v48
    v_add_u32 v51, 128, v49
    s_xor_b32 s98, s3, 4
    v_lshl_add_u32 v96, v2, 4, s98
    s_cmp_eq_u32 s98, 0
    s_cselect_b32 s60, 120, 0
    v_subrev_u32 v98, s60, v96
    v_cmp_gt_u32 vcc, 8, v2
    s_nop 1
    v_cndmask_b32 v96, v98, v96, vcc
    v_lshlrev_b32 v98, 2, v3
    v_cvt_f32_u32 v98, v98
    v_cvt_f32_u32 v96, v96
    v_mul_f32 v96, 0x3b800000, v96
    v_mul_f32 v99, v98, v96
    v_cos_f32 v102, v99
    v_sin_f32 v103, v99
    v_add_f32 v99, v99, v96
    v_cvt_pk_bf16_f32 v112, v102, v103
    v_cvt_pk_bf16_f32 v116, -v103, v102
    v_cos_f32 v102, v99
    v_sin_f32 v103, v99
    v_add_f32 v99, v99, v96
    v_cvt_pk_bf16_f32 v113, v102, v103
    v_cvt_pk_bf16_f32 v117, -v103, v102
    v_cos_f32 v102, v99
    v_sin_f32 v103, v99
    v_add_f32 v99, v99, v96
    v_cvt_pk_bf16_f32 v114, v102, v103
    v_cvt_pk_bf16_f32 v118, -v103, v102
    v_cos_f32 v102, v99
    v_sin_f32 v103, v99
    s_nop 0
    v_cvt_pk_bf16_f32 v115, v102, v103
    v_cvt_pk_bf16_f32 v119, -v103, v102
    v_mov_b32 v96, 0x80000000
    v_mov_b32 v97, 0x8000
    v_xor_b32 v120, v96, v112
    v_xor_b32 v124, v97, v116
    v_xor_b32 v121, v96, v113
    v_xor_b32 v125, v97, v117
    v_xor_b32 v122, v96, v114
    v_xor_b32 v126, v97, v118
    v_xor_b32 v123, v96, v115
    v_xor_b32 v127, v97, v119
    s_cmp_lg_u32 s98, 0
    s_cbranch_scc1 L_sp_e
    s_mov_b32 exec_lo, 0x10001
    s_mov_b32 exec_hi, 0x10001
    v_mov_b32 v121, 0xbf80
    v_mov_b32 v125, 0xbf800000
    v_mov_b32 v123, 0xbf80
    v_mov_b32 v127, 0xbf800000
    s_mov_b64 exec, -1
    v_cndmask_b32_e64 v128, v112, 0, vcc
    v_cndmask_b32 v112, 0, v112, vcc
    v_cndmask_b32 v136, 0, v120, vcc
    v_cndmask_b32_e64 v120, v120, 0, vcc
    v_cndmask_b32_e64 v129, v113, 0, vcc
    v_cndmask_b32 v113, 0, v113, vcc
    v_cndmask_b32 v137, 0, v121, vcc
    v_cndmask_b32_e64 v121, v121, 0, vcc
    v_cndmask_b32_e64 v130, v114, 0, vcc
    v_cndmask_b32 v114, 0, v114, vcc
    v_cndmask_b32 v138, 0, v122, vcc
    v_cndmask_b32_e64 v122, v122, 0, vcc
    v_cndmask_b32_e64 v131, v115, 0, vcc
    v_cndmask_b32 v115, 0, v115, vcc
    v_cndmask_b32 v139, 0, v123, vcc
    v_cndmask_b32_e64 v123, v123, 0, vcc
    v_cndmask_b32_e64 v132, v116, 0, vcc
    v_cndmask_b32 v116, 0, v116, vcc
    v_cndmask_b32 v140, 0, v124, vcc
    v_cndmask_b32_e64 v124, v124, 0, vcc
    v_cndmask_b32_e64 v133, v117, 0, vcc
    v_cndmask_b32 v117, 0, v117, vcc
    v_cndmask_b32 v141, 0, v125, vcc
    v_cndmask_b32_e64 v125, v125, 0, vcc
    v_cndmask_b32_e64 v134, v118, 0, vcc
    v_cndmask_b32 v118, 0, v118, vcc
    v_cndmask_b32 v142, 0, v126, vcc
    v_cndmask_b32_e64 v126, v126, 0, vcc
    v_cndmask_b32_e64 v135, v119, 0, vcc
    v_cndmask_b32 v119, 0, v119, vcc
    v_cndmask_b32 v143, 0, v127, vcc
    v_cndmask_b32_e64 v127, v127, 0, vcc
L_sp_e:
    s_sub_u32 s60, 16, s98
    s_cmp_eq_u32 s98, 0
    s_cselect_b32 s60, 8, s60
    v_bfe_u32 v96, v2, 2, 1
    v_xor_b32 v96, v96, v2
    v_lshrrev_b32 v97, 3, v2
    v_mul_u32_u24 v98, 3, v97
    v_xor_b32 v98, v98, v3
    v_lshlrev_b32 v98, 4, v98
    v_lshl_add_u32 v96, v96, 6, v98
    s_lshl_b32 s61, s98, 3
    s_and_b32 s61, s61, 32
    s_lshl_b32 s62, s98, 10
    s_or_b32 s61, s61, s62
    v_xor_b32 v60, s61, v96
    s_lshl_b32 s61, s60, 3
    s_and_b32 s61, s61, 32
    s_lshl_b32 s62, s60, 10
    s_or_b32 s61, s61, s62
    v_xor_b32 v61, s61, v96
    v_lshlrev_b32 v63, 16, v3
    v_lshl_add_u32 v63, v97, 14, v63
    v_and_b32 v96, 7, v2
    v_lshl_add_u32 v63, v96, 4, v63
    s_lshl_b32 s6, s98, 18
    s_lshl_b32 s61, s56, 11
    s_add_u32 s6, s6, s61
    s_lshl_b32 s61, s57, 7
    s_add_u32 s6, s6, s61
    s_add_u32 s6, s6, 0x200000
    s_add_u32 s7, s6, 32768
    v_lshlrev_b32 v4, 5, v2
    v_and_b32 v96, 1, v3
    v_lshl_add_u32 v4, v96, 9, v4
    v_lshrrev_b32 v96, 1, v3
    v_lshl_add_u32 v4, v96, 4, v4
    s_lshl_b32 s60, s3, 8
    s_add_u32 s93, s60, s58
    s_sub_u32 s94, 2048, s93
    s_and_b32 s94, s94, 2047
    s_mov_b32 s48, s24
    s_mov_b32 s49, s25
    s_mov_b32 s50, 0x400
    s_mov_b32 s51, 0x20000
    s_lshl_b32 s12, s96, 15
    s_lshl_b32 s61, s56, 10
    s_add_u32 s12, s12, s61
    s_lshl_b32 s61, s57, 6
    s_add_u32 s12, s12, s61
    s_cmp_eq_u32 s58, 128
    s_cselect_b32 s12, 0x40000000, s12
    s_add_u32 s13, s12, 131072
    s_add_u32 s14, s12, 262144
    s_add_u32 s15, s12, 393216
    s_waitcnt lgkmcnt(0)
    s_barrier
    buffer_load_dwordx4 v[8:11], v107, s[32:35], s12 offen
    buffer_load_dwordx4 v[12:15], v107, s[32:35], s13 offen
    buffer_load_dwordx4 v[16:19], v107, s[32:35], s14 offen
    buffer_load_dwordx4 v[20:23], v107, s[32:35], s15 offen
    s_load_dword s59, s[30:31], 0
    s_lshl_b32 s12, s93, 10
    s_lshl_b32 s13, s94, 10
    buffer_load_dwordx4 v[232:235], v4, s[32:35], s12 offen
    buffer_load_dwordx4 v[236:239], v4, s[32:35], s13 offen
    buffer_load_dwordx4 v[240:243], v4, s[48:51], 0 offen
    s_lshr_b32 s15, s9, 2
    s_add_u32 s15, s15, 32
    s_and_b32 s15, s15, 31
    s_lshl_b32 s15, s15, 11
    s_add_u32 s15, s15, 0x40000
    s_waitcnt lgkmcnt(0)
    s_add_u32 s59, s59, 0x9e3779b9
    s_bitcmp1_b32 s59, 0
    s_cselect_b32 s91, 1, 0x10000
    s_xor_b32 s92, s91, 0x10001
    v_mov_b32 v104, s91
    v_mov_b32 v105, s92
    v_mov_b32 v106, 0x00010001
    s_barrier
    s_waitcnt vmcnt(3)
    v_pk_mov_b32 v[24:25], v[8:9], v[12:13] op_sel:[0,0]
    v_pk_mov_b32 v[26:27], v[16:17], v[20:21] op_sel:[0,0]
    v_pk_mov_b32 v[28:29], v[8:9], v[12:13] op_sel:[1,1]
    v_pk_mov_b32 v[30:31], v[16:17], v[20:21] op_sel:[1,1]
    v_mfma_f32_16x16x32_bf16 v[64:67], v[40:43], v[24:27], 0
    v_mfma_f32_16x16x32_bf16 v[68:71], v[44:47], v[24:27], 0
    v_pk_mov_b32 v[32:33], v[10:11], v[14:15] op_sel:[0,0]
    v_pk_mov_b32 v[34:35], v[18:19], v[22:23] op_sel:[0,0]
    v_mfma_f32_16x16x32_bf16 v[72:75], v[40:43], v[28:31], 0
    v_mfma_f32_16x16x32_bf16 v[76:79], v[44:47], v[28:31], 0
    v_pk_mov_b32 v[36:37], v[10:11], v[14:15] op_sel:[1,1]
    v_pk_mov_b32 v[38:39], v[18:19], v[22:23] op_sel:[1,1]
    v_mfma_f32_16x16x32_bf16 v[80:83], v[40:43], v[32:35], 0
    v_mfma_f32_16x16x32_bf16 v[84:87], v[44:47], v[32:35], 0
    v_mfma_f32_16x16x32_bf16 v[88:91], v[40:43], v[36:39], 0
    v_cvt_pk_bf16_f32 v8, v64, v68
    v_cvt_pk_bf16_f32 v9, v65, v69
    v_mfma_f32_16x16x32_bf16 v[92:95], v[44:47], v[36:39], 0
    ds_write2st64_b32 v48, v8, v9 offset0:0 offset1:4
    v_cvt_pk_bf16_f32 v10, v66, v70
    v_cvt_pk_bf16_f32 v11, v67, v71
    ds_write2st64_b32 v48, v10, v11 offset0:8 offset1:12
    v_cvt_pk_bf16_f32 v12, v72, v76
    v_cvt_pk_bf16_f32 v13, v73, v77
    ds_write2st64_b32 v49, v12, v13 offset0:0 offset1:4
    v_cvt_pk_bf16_f32 v14, v74, v78
    v_cvt_pk_bf16_f32 v15, v75, v79
    ds_write2st64_b32 v49, v14, v15 offset0:8 offset1:12
    v_cvt_pk_bf16_f32 v16, v80, v84
    v_cvt_pk_bf16_f32 v17, v81, v85
    ds_write2st64_b32 v50, v16, v17 offset0:0 offset1:4
    v_cvt_pk_bf16_f32 v18, v82, v86
    v_cvt_pk_bf16_f32 v19, v83, v87
    ds_write2st64_b32 v50, v18, v19 offset0:8 offset1:12
    v_cvt_pk_bf16_f32 v20, v88, v92
    v_cvt_pk_bf16_f32 v21, v89, v93
    ds_write2st64_b32 v51, v20, v21 offset0:0 offset1:4
    v_cvt_pk_bf16_f32 v22, v90, v94
    v_cvt_pk_bf16_f32 v23, v91, v95
    ds_write2st64_b32 v51, v22, v23 offset0:8 offset1:12
    s_waitcnt lgkmcnt(0)
L_b1:
    s_barrier
    s_cmp_eq_u32 s58, 128
    s_cbranch_scc1 L_ack128
    ds_read_b128 v[52:55], v60
    ds_read_b128 v[56:59], v61
    s_mov_b32 vcc_lo, 0x00ff00ff
    s_mov_b32 vcc_hi, 0x00ff00ff
    s_waitcnt lgkmcnt(1)
    v_mfma_f32_16x16x32_bf16 v[64:67], v[112:115], v[52:55], 0
    v_mfma_f32_16x16x32_bf16 v[68:71], v[116:119], v[52:55], 0
    s_waitcnt lgkmcnt(0)
    v_mfma_f32_16x16x32_bf16 v[72:75], v[120:123], v[56:59], 0
    v_mfma_f32_16x16x32_bf16 v[76:79], v[124:127], v[56:59], 0
    s_cmp_lg_u32 s98, 0
    s_cbranch_scc1 L_s2b
    v_mfma_f32_16x16x32_bf16 v[64:67], v[128:131], v[56:59], v[64:67]
    v_mfma_f32_16x16x32_bf16 v[68:71], v[132:135], v[56:59], v[68:71]
    v_mfma_f32_16x16x32_bf16 v[72:75], v[136:139], v[52:55], v[72:75]
    v_mfma_f32_16x16x32_bf16 v[76:79], v[140:143], v[52:55], v[76:79]
L_s2b:
    s_nop 5
    v_cvt_pk_bf16_f32 v96, v64, v68
    v_cvt_pk_bf16_f32 v97, v65, v69
    v_cvt_pk_bf16_f32 v100, v72, v76
    v_cvt_pk_bf16_f32 v101, v73, v77
    v_bitop3_b32 v96, v106, v104, v96 bitop3:0xca
    v_bitop3_b32 v97, v106, v104, v97 bitop3:0xca
    v_bitop3_b32 v100, v106, v105, v100 bitop3:0xca
    v_bitop3_b32 v101, v106, v105, v101 bitop3:0xca
    v_cndmask_b32_dpp v80, v97, v96, vcc row_ror:8 row_mask:0xf bank_mask:0xf
    s_nop 0
    v_cndmask_b32_dpp v81, v101, v100, vcc row_ror:8 row_mask:0xf bank_mask:0xf
    s_not_b64 vcc, vcc
    v_cndmask_b32_dpp v82, v96, v97, vcc row_ror:8 row_mask:0xf bank_mask:0xf
    v_cndmask_b32_dpp v83, v100, v101, vcc row_ror:8 row_mask:0xf bank_mask:0xf
    buffer_store_dwordx4 v[80:83], v63, s[36:39], s6 offen sc1
    v_cvt_pk_bf16_f32 v98, v66, v70
    v_cvt_pk_bf16_f32 v99, v67, v71
    v_cvt_pk_bf16_f32 v102, v74, v78
    v_cvt_pk_bf16_f32 v103, v75, v79
    v_bitop3_b32 v98, v106, v104, v98 bitop3:0xca
    v_bitop3_b32 v99, v106, v104, v99 bitop3:0xca
    v_bitop3_b32 v102, v106, v105, v102 bitop3:0xca
    v_bitop3_b32 v103, v106, v105, v103 bitop3:0xca
    v_cndmask_b32_dpp v86, v98, v99, vcc row_ror:8 row_mask:0xf bank_mask:0xf
    s_nop 0
    v_cndmask_b32_dpp v87, v102, v103, vcc row_ror:8 row_mask:0xf bank_mask:0xf
    s_not_b64 vcc, vcc
    v_cndmask_b32_dpp v84, v99, v98, vcc row_ror:8 row_mask:0xf bank_mask:0xf
    v_cndmask_b32_dpp v85, v103, v102, vcc row_ror:8 row_mask:0xf bank_mask:0xf
    buffer_store_dwordx4 v[84:87], v63, s[36:39], s7 offen sc1
L_nos2:
    v_lshrrev_b32 v96, 1, v2
    v_lshlrev_b32 v96, 8, v96
    v_add_u32 v96, s58, v96
    v_and_b32 v97, 1, v2
    v_lshlrev_b32 v98, 1, v3
    v_mul_u32_u24 v98, v98, v96
    v_cmp_eq_u32 vcc, 0, v97
    v_and_b32 v99, 2047, v98
    v_add_u32 v98, v98, v96
    v_cvt_f32_u32 v99, v99
    v_mul_f32 v99, 0x3a000000, v99
    v_cos_f32 v100, v99
    v_sin_f32 v101, v99
    v_mul_f32 v100, 0.5, v100
    v_mul_f32 v101, 0.5, v101
    v_cndmask_b32_e64 v102, -v101, v100, vcc
    v_cndmask_b32 v103, v100, v101, vcc
    v_cvt_pk_bf16_f32 v144, v102, v103
    v_cvt_pk_bf16_f32 v148, -v103, v102
    v_cndmask_b32 v102, v101, v100, vcc
    v_cndmask_b32_e64 v103, -v100, v101, vcc
    v_cvt_pk_bf16_f32 v145, v102, -v103
    v_cvt_pk_bf16_f32 v149, -v103, -v102
    s_and_b32 s60, s58, 127
    s_cbranch_scc1 L_ac_a10
    v_add_f32 v100, v100, v100
    v_add_f32 v101, v101, v101
    v_cndmask_b32 v102, 0, v100, vcc
    v_sub_f32 v103, v100, v102
    v_cvt_pk_bf16_f32 v100, v102, v103
    v_cndmask_b32 v102, 0, v101, vcc
    v_sub_f32 v103, v101, v102
    v_cvt_pk_bf16_f32 v101, -v102, -v103
    s_cmp_eq_u32 s58, 0
    s_cselect_b32 s60, -1, 0
    s_cselect_b32 s61, 0, -1
    v_and_b32 v144, s60, v100
    v_and_b32 v148, s60, v101
    v_and_b32 v145, s61, v100
    v_and_b32 v149, s61, v101
L_ac_a10:
    v_and_b32 v99, 2047, v98
    v_cvt_f32_u32 v99, v99
    v_mul_f32 v99, 0x3a000000, v99
    v_cos_f32 v100, v99
    v_sin_f32 v101, v99
    v_mul_f32 v100, 0.5, v100
    v_mul_f32 v101, 0.5, v101
    v_cndmask_b32_e64 v102, -v101, v100, vcc
    v_cndmask_b32 v103, v100, v101, vcc
    v_cvt_pk_bf16_f32 v146, v102, v103
    v_cvt_pk_bf16_f32 v150, -v103, v102
    v_cndmask_b32 v102, v101, v100, vcc
    v_cndmask_b32_e64 v103, -v100, v101, vcc
    v_cvt_pk_bf16_f32 v147, v102, -v103
    v_cvt_pk_bf16_f32 v151, -v103, -v102
    s_and_b32 s60, s58, 127
    s_cbranch_scc1 L_ac_a11
    v_add_f32 v100, v100, v100
    v_add_f32 v101, v101, v101
    v_cndmask_b32 v102, 0, v100, vcc
    v_sub_f32 v103, v100, v102
    v_cvt_pk_bf16_f32 v100, v102, v103
    v_cndmask_b32 v102, 0, v101, vcc
    v_sub_f32 v103, v101, v102
    v_cvt_pk_bf16_f32 v101, -v102, -v103
    s_cmp_eq_u32 s58, 0
    s_cselect_b32 s60, -1, 0
    s_cselect_b32 s61, 0, -1
    v_and_b32 v146, s60, v100
    v_and_b32 v150, s60, v101
    v_and_b32 v147, s61, v100
    v_and_b32 v151, s61, v101
L_ac_a11:
    v_lshlrev_b32 v5, 12, v3
    v_lshl_add_u32 v5, v2, 4, v5
    v_lshrrev_b32 v96, 2, v2
    v_xor_b32 v96, v96, v3
    v_and_b32 v96, 1, v96
    v_bfe_u32 v97, v2, 1, 1
    v_lshl_or_b32 v96, v96, 1, v97
    s_lshr_b32 s60, s3, 1
    v_xor_b32 v96, s60, v96
    v_lshlrev_b32 v96, 4, v96
    v_and_b32 v98, 7, v2
    v_lshl_add_u32 v96, v98, 6, v96
    v_lshl_add_u32 v96, v3, 12, v96
    v_lshrrev_b32 v98, 3, v2
    v_lshl_add_u32 v96, v98, 2, v96
    s_and_b32 s60, s3, 1
    s_lshl_b32 s60, s60, 3
    s_add_u32 s60, s60, 16384
    v_add_u32 v6, s60, v96
    v_xor_b32 v7, 48, v6
    v_bfe_u32 v96, v2, 2, 1
    v_xor_b32 v96, v96, v98
    v_lshl_or_b32 v96, v96, 1, v98
    v_xor_b32 v96, v96, v97
    v_xor_b32 v96, v96, v3
    v_lshlrev_b32 v96, 4, v96
    v_lshl_add_u32 v62, v2, 6, v96
    s_lshl_b32 s60, s3, 4
    s_and_b32 s60, s60, 32
    v_xor_b32 v62, s60, v62
    s_lshl_b32 s60, s3, 11
    s_add_u32 s60, s60, 16384
    v_add_u32 v62, s60, v62
    s_lshl_b32 s14, s9, 14
    s_lshl_b32 s60, s3, 8
    s_add_u32 s14, s14, s60
    s_add_u32 s14, s14, 0x200000
    s_mov_b32 s40, s26
    s_mov_b32 s41, s27
    s_mov_b32 s42, 0x200000
    s_mov_b32 s43, 0x20000
    s_waitcnt vmcnt(2)
    s_cmp_lg_u32 s58, 128
    s_cbranch_scc1 L_a7
    s_waitcnt vmcnt(0)
L_a7:
    v_dot2_f32_bf16 v110, v232, v240, 0
    v_dot2_f32_bf16 v111, v236, v240, 0
    v_dot2_f32_bf16 v110, v233, v241, v110
    v_dot2_f32_bf16 v111, v237, v241, v111
    v_dot2_f32_bf16 v110, v234, v242, v110
    v_dot2_f32_bf16 v111, v238, v242, v111
    v_dot2_f32_bf16 v110, v235, v243, v110
    v_dot2_f32_bf16 v111, v239, v243, v111
    v_permlane16_swap_b32 v232, v234
    v_permlane16_swap_b32 v233, v235
    v_permlane16_swap_b32 v236, v238
    v_permlane16_swap_b32 v237, v239
    v_permlane32_swap_b32 v110, v111
    v_add_f32 v110, v110, v111
    v_mov_b32 v111, v110
    s_nop 1
    v_permlane16_swap_b32 v110, v111
    v_add_f32 v110, v110, v111
    s_nop 1
    v_add_f32_dpp v110, v110, v110 row_ror:8 row_mask:0xf bank_mask:0xf
    v_lshlrev_b32 v216, 16, v232
    v_and_b32 v217, 0xffff0000, v232
    v_add_f32_dpp v110, v110, v110 row_ror:4 row_mask:0xf bank_mask:0xf
    v_lshlrev_b32 v218, 16, v233
    v_and_b32 v219, 0xffff0000, v233
    v_add_f32_dpp v110, v110, v110 row_ror:2 row_mask:0xf bank_mask:0xf
    v_lshlrev_b32 v220, 16, v234
    v_and_b32 v221, 0xffff0000, v234
    v_add_f32_dpp v110, v110, v110 row_ror:1 row_mask:0xf bank_mask:0xf
    v_lshlrev_b32 v222, 16, v235
    v_and_b32 v223, 0xffff0000, v235
    v_mul_f32 v110, 0xbfb8aa3b, v110
    v_lshlrev_b32 v224, 16, v236
    v_and_b32 v225, 0xffff0000, v236
    v_exp_f32 v110, v110
    v_lshlrev_b32 v226, 16, v237
    v_and_b32 v227, 0xffff0000, v237
    v_add_f32 v110, 1.0, v110
    v_lshlrev_b32 v228, 16, v238
    v_and_b32 v229, 0xffff0000, v238
    v_rcp_f32 v110, v110
    v_lshlrev_b32 v230, 16, v239
    v_and_b32 v231, 0xffff0000, v239
    v_mov_b32 v111, v110
    s_nop 1
    v_permlane32_swap_b32 v110, v111
    v_sub_f32 v96, 1.0, v110
    v_sub_f32 v97, 1.0, v111
    v_pk_mul_f32 v[216:217], v[216:217], v[96:97] op_sel:[0,0] op_sel_hi:[1,0]
    v_pk_mul_f32 v[218:219], v[218:219], v[96:97] op_sel:[0,0] op_sel_hi:[1,0]
    v_pk_mul_f32 v[220:221], v[220:221], v[96:97] op_sel:[0,0] op_sel_hi:[1,0]
    v_pk_mul_f32 v[222:223], v[222:223], v[96:97] op_sel:[0,0] op_sel_hi:[1,0]
    v_pk_mul_f32 v[224:225], v[224:225], v[96:97] op_sel:[0,1] op_sel_hi:[1,1]
    v_pk_mul_f32 v[226:227], v[226:227], v[96:97] op_sel:[0,1] op_sel_hi:[1,1]
    v_pk_mul_f32 v[228:229], v[228:229], v[96:97] op_sel:[0,1] op_sel_hi:[1,1]
    v_pk_mul_f32 v[230:231], v[230:231], v[96:97] op_sel:[0,1] op_sel_hi:[1,1]
    v_mov_b32 v109, 43016
    s_cmp_lg_u32 s3, 7
    s_cbranch_scc1 L_a5
    s_waitcnt vmcnt(0)
L_kd:
    buffer_load_dwordx4 v[128:131], v247, s[36:39], s15 offen sc1
    s_waitcnt vmcnt(0)
    v_xor_b32 v129, s59, v129
    v_bitop3_b32 v129, v131, s59, v129 bitop3:0xbe
    v_cmp_ne_u32 vcc, 0, v129
    v_max_u32 v128, v128, v130
    s_nop 0
    s_cbranch_vccz L_kd_ok
    s_sleep 2
    s_sub_u32 s90, s90, 1
    s_cbranch_scc0 L_kd
    s_mov_b32 s90, 0
L_kd_ok:
    v_max_u32_dpp v128, v128, v128 row_ror:8 row_mask:0xf bank_mask:0xf
    s_nop 1
    v_max_u32_dpp v128, v128, v128 row_ror:4 row_mask:0xf bank_mask:0xf
    s_nop 1
    v_max_u32_dpp v128, v128, v128 row_ror:2 row_mask:0xf bank_mask:0xf
    s_nop 1
    v_max_u32_dpp v128, v128, v128 row_ror:1 row_mask:0xf bank_mask:0xf
    s_nop 0
    v_readlane_b32 s97, v128, 0
    v_readlane_b32 s60, v128, 16
    v_readlane_b32 s61, v128, 32
    v_readlane_b32 s62, v128, 48
    s_max_u32 s97, s97, s60
    s_max_u32 s61, s61, s62
    s_max_u32 s97, s97, s61
    s_and_b32 s97, s97, 2047
    v_mov_b32 v108, s97
    ds_write_b32 v109, v108
    s_waitcnt lgkmcnt(0)
L_a5:
    s_barrier
    buffer_load_dwordx4 v[8:11], v5, s[36:39], s14 offen offset:0 sc1
    buffer_load_dwordx4 v[12:15], v5, s[36:39], s14 offen offset:2048 sc1
    ds_read_b32 v109, v109
    ds_read_b128 v[200:203], v247 offset:34816
    ds_read_b128 v[204:207], v247 offset:35840
    ds_read_b128 v[208:211], v247 offset:36864
    ds_read_b128 v[212:215], v247 offset:37888
    ds_read_b128 v[152:155], v247 offset:32768
    ds_read_b128 v[156:159], v247 offset:33792
    ds_read_b128 v[168:171], v247 offset:38912
    ds_read_b128 v[172:175], v247 offset:39936
    ds_read_b128 v[176:179], v247 offset:40960
    ds_read_b128 v[180:183], v247 offset:41984
    s_waitcnt lgkmcnt(0)
    v_readfirstlane_b32 s97, v109
    v_pk_mul_f32 v[184:185], v[200:201], v[110:111] op_sel:[0,0] op_sel_hi:[1,0]
    v_pk_mul_f32 v[186:187], v[202:203], v[110:111] op_sel:[0,0] op_sel_hi:[1,0]
    v_pk_mul_f32 v[188:189], v[204:205], v[110:111] op_sel:[0,0] op_sel_hi:[1,0]
    v_pk_mul_f32 v[190:191], v[206:207], v[110:111] op_sel:[0,0] op_sel_hi:[1,0]
    v_pk_mul_f32 v[192:193], v[208:209], v[110:111] op_sel:[0,0] op_sel_hi:[1,0]
    v_pk_mul_f32 v[194:195], v[210:211], v[110:111] op_sel:[0,0] op_sel_hi:[1,0]
    v_pk_mul_f32 v[196:197], v[212:213], v[110:111] op_sel:[0,0] op_sel_hi:[1,0]
    v_pk_mul_f32 v[198:199], v[214:215], v[110:111] op_sel:[0,0] op_sel_hi:[1,0]
    v_pk_mul_f32 v[200:201], v[200:201], v[110:111] op_sel:[0,1] op_sel_hi:[1,1]
    v_pk_mul_f32 v[202:203], v[202:203], v[110:111] op_sel:[0,1] op_sel_hi:[1,1]
    v_pk_mul_f32 v[204:205], v[204:205], v[110:111] op_sel:[0,1] op_sel_hi:[1,1]
    v_pk_mul_f32 v[206:207], v[206:207], v[110:111] op_sel:[0,1] op_sel_hi:[1,1]
    v_pk_mul_f32 v[208:209], v[208:209], v[110:111] op_sel:[0,1] op_sel_hi:[1,1]
    v_pk_mul_f32 v[210:211], v[210:211], v[110:111] op_sel:[0,1] op_sel_hi:[1,1]
    v_pk_mul_f32 v[212:213], v[212:213], v[110:111] op_sel:[0,1] op_sel_hi:[1,1]
    v_pk_mul_f32 v[214:215], v[214:215], v[110:111] op_sel:[0,1] op_sel_hi:[1,1]
    v_mov_b32 v96, 0x80000000
    v_xor_b32 v160, v96, v152
    v_xor_b32 v164, v96, v156
    v_xor_b32 v161, v96, v153
    v_xor_b32 v165, v96, v157
    v_xor_b32 v162, v96, v154
    v_xor_b32 v166, v96, v158
    v_xor_b32 v163, v96, v155
    v_xor_b32 v167, v96, v159
    s_branch L_a_pw
L_a_pl:
    buffer_load_dwordx4 v[8:11], v5, s[36:39], s14 offen offset:0 sc1
    buffer_load_dwordx4 v[12:15], v5, s[36:39], s14 offen offset:2048 sc1
L_a_pw:
    s_waitcnt vmcnt(0)
    v_swap_b32 v10, v12
    v_swap_b32 v11, v13
    v_xor_b32 v96, v104, v8
    v_xor_b32 v97, v105, v9
    v_mfma_f32_16x16x32_bf16 v[64:67], v[144:147], v[8:11], 0
    v_bitop3_b32 v96, v10, v104, v96 bitop3:0xbe
    v_bitop3_b32 v97, v11, v105, v97 bitop3:0xbe
    v_mfma_f32_16x16x32_bf16 v[68:71], v[148:151], v[8:11], 0
    v_bitop3_b32 v96, v12, v104, v96 bitop3:0xbe
    v_bitop3_b32 v97, v13, v105, v97 bitop3:0xbe
    v_mfma_f32_16x16x32_bf16 v[72:75], v[144:147], v[12:15], 0
    v_bitop3_b32 v96, v14, v104, v96 bitop3:0xbe
    v_bitop3_b32 v97, v15, v105, v97 bitop3:0xbe
    v_mfma_f32_16x16x32_bf16 v[76:79], v[148:151], v[12:15], 0
    v_bitop3_b32 v96, v96, v97, v106 bitop3:0xa8
    v_cmp_ne_u32 vcc, 0, v96
    s_nop 0
    s_cbranch_vccz L_a_pl_ok
    s_sleep 1
    s_sub_u32 s90, s90, 1
    s_cbranch_scc0 L_a_pl
    s_mov_b32 s90, 0
L_a_pl_ok:
    v_cvt_pk_bf16_f32 v16, v64, v68
    v_cvt_pk_bf16_f32 v17, v65, v69
    ds_write2st64_b32 v6, v16, v17 offset0:0 offset1:4
    v_cvt_pk_bf16_f32 v18, v66, v70
    v_cvt_pk_bf16_f32 v19, v67, v71
    ds_write2st64_b32 v6, v18, v19 offset0:8 offset1:12
    v_cvt_pk_bf16_f32 v20, v72, v76
    v_cvt_pk_bf16_f32 v21, v73, v77
    ds_write2st64_b32 v7, v20, v21 offset0:2 offset1:6
    v_cvt_pk_bf16_f32 v22, v74, v78
    v_cvt_pk_bf16_f32 v23, v75, v79
    ds_write2st64_b32 v7, v22, v23 offset0:10 offset1:14
    s_waitcnt lgkmcnt(0)
    s_barrier
    ds_read_b128 v[16:19], v62 offset:0
    ds_read_b128 v[20:23], v62 offset:1024
    s_waitcnt lgkmcnt(1)
    v_mfma_f32_16x16x32_bf16 v[64:67], v[16:19], v[152:155], 0
    v_mfma_f32_16x16x32_bf16 v[68:71], v[16:19], v[156:159], 0
    s_waitcnt lgkmcnt(0)
    v_mfma_f32_16x16x32_bf16 v[72:75], v[20:23], v[152:155], 0
    v_mfma_f32_16x16x32_bf16 v[76:79], v[20:23], v[156:159], 0
    s_nop 3
    v_pk_mul_f32 v[96:97], v[64:65], v[184:185]
    v_pk_mul_f32 v[100:101], v[68:69], v[184:185]
    v_pk_mul_f32 v[98:99], v[66:67], v[186:187]
    v_pk_mul_f32 v[102:103], v[70:71], v[186:187]
    v_pk_fma_f32 v[96:97], v[68:69], v[188:189], v[96:97]
    v_pk_fma_f32 v[100:101], v[64:65], v[188:189], v[100:101] neg_lo:[1,0,0] neg_hi:[1,0,0]
    v_pk_fma_f32 v[98:99], v[70:71], v[190:191], v[98:99]
    v_pk_fma_f32 v[102:103], v[66:67], v[190:191], v[102:103] neg_lo:[1,0,0] neg_hi:[1,0,0]
    v_mfma_f32_16x16x32_bf16 v[80:83], v[16:19], v[160:163], 0
    v_cvt_pk_bf16_f32 v112, v96, v100
    v_cvt_pk_bf16_f32 v113, v97, v101
    v_mfma_f32_16x16x32_bf16 v[84:87], v[16:19], v[164:167], 0
    v_cvt_pk_bf16_f32 v114, v98, v102
    v_cvt_pk_bf16_f32 v115, v99, v103
    v_pk_mul_f32 v[24:25], v[72:73], v[192:193]
    v_pk_mul_f32 v[28:29], v[76:77], v[192:193]
    v_pk_mul_f32 v[26:27], v[74:75], v[194:195]
    v_pk_mul_f32 v[30:31], v[78:79], v[194:195]
    v_pk_fma_f32 v[24:25], v[76:77], v[196:197], v[24:25]
    v_pk_fma_f32 v[28:29], v[72:73], v[196:197], v[28:29] neg_lo:[1,0,0] neg_hi:[1,0,0]
    v_pk_fma_f32 v[26:27], v[78:79], v[198:199], v[26:27]
    v_pk_fma_f32 v[30:31], v[74:75], v[198:199], v[30:31] neg_lo:[1,0,0] neg_hi:[1,0,0]
    v_mfma_f32_16x16x32_bf16 v[88:91], v[20:23], v[160:163], 0
    v_cvt_pk_bf16_f32 v116, v24, v28
    v_cvt_pk_bf16_f32 v117, v25, v29
    v_mfma_f32_16x16x32_bf16 v[92:95], v[20:23], v[164:167], 0
    v_cvt_pk_bf16_f32 v118, v26, v30
    v_cvt_pk_bf16_f32 v119, v27, v31
    v_pk_mul_f32 v[96:97], v[80:81], v[200:201]
    v_pk_mul_f32 v[100:101], v[84:85], v[200:201]
    v_pk_mul_f32 v[98:99], v[82:83], v[202:203]
    v_pk_mul_f32 v[102:103], v[86:87], v[202:203]
    v_pk_fma_f32 v[96:97], v[84:85], v[204:205], v[96:97]
    v_pk_fma_f32 v[100:101], v[80:81], v[204:205], v[100:101] neg_lo:[1,0,0] neg_hi:[1,0,0]
    v_pk_fma_f32 v[98:99], v[86:87], v[206:207], v[98:99]
    v_pk_fma_f32 v[102:103], v[82:83], v[206:207], v[102:103] neg_lo:[1,0,0] neg_hi:[1,0,0]
    v_mfma_f32_16x16x32_bf16 v[232:235], v[112:115], v[168:171], v[216:219]
    v_cvt_pk_bf16_f32 v120, v96, v100
    v_cvt_pk_bf16_f32 v121, v97, v101
    v_mfma_f32_16x16x32_bf16 v[236:239], v[112:115], v[172:175], v[220:223]
    v_cvt_pk_bf16_f32 v122, v98, v102
    v_cvt_pk_bf16_f32 v123, v99, v103
    v_pk_mul_f32 v[24:25], v[88:89], v[208:209]
    v_pk_mul_f32 v[28:29], v[92:93], v[208:209]
    v_pk_mul_f32 v[26:27], v[90:91], v[210:211]
    v_pk_mul_f32 v[30:31], v[94:95], v[210:211]
    v_pk_fma_f32 v[24:25], v[92:93], v[212:213], v[24:25]
    v_pk_fma_f32 v[28:29], v[88:89], v[212:213], v[28:29] neg_lo:[1,0,0] neg_hi:[1,0,0]
    v_pk_fma_f32 v[26:27], v[94:95], v[214:215], v[26:27]
    v_pk_fma_f32 v[30:31], v[90:91], v[214:215], v[30:31] neg_lo:[1,0,0] neg_hi:[1,0,0]
    v_mfma_f32_16x16x32_bf16 v[232:235], v[116:119], v[176:179], v[232:235]
    v_cvt_pk_bf16_f32 v124, v24, v28
    v_cvt_pk_bf16_f32 v125, v25, v29
    v_mfma_f32_16x16x32_bf16 v[236:239], v[116:119], v[180:183], v[236:239]
    v_cvt_pk_bf16_f32 v126, v26, v30
    v_cvt_pk_bf16_f32 v127, v27, v31
    v_mfma_f32_16x16x32_bf16 v[240:243], v[120:123], v[168:171], v[224:227]
    v_mfma_f32_16x16x32_bf16 v[244:247], v[120:123], v[172:175], v[228:231]
    v_mfma_f32_16x16x32_bf16 v[240:243], v[124:127], v[176:179], v[240:243]
    v_cvt_pk_bf16_f32 v8, v232, v233
    v_cvt_pk_bf16_f32 v9, v234, v235
    v_mfma_f32_16x16x32_bf16 v[244:247], v[124:127], v[180:183], v[244:247]
    v_cvt_pk_bf16_f32 v10, v236, v237
    v_cvt_pk_bf16_f32 v11, v238, v239
    s_nop 0
    v_permlane16_swap_b32 v8, v10
    v_permlane16_swap_b32 v9, v11
    s_cmp_eq_u32 s93, s97
    s_cbranch_scc1 L_sk1
    buffer_store_dwordx4 v[8:11], v4, s[40:43], s12 offen sc1
L_sk1:
    v_cvt_pk_bf16_f32 v12, v240, v241
    v_cvt_pk_bf16_f32 v13, v242, v243
    v_cvt_pk_bf16_f32 v14, v244, v245
    v_cvt_pk_bf16_f32 v15, v246, v247
    s_nop 0
    v_permlane16_swap_b32 v12, v14
    v_permlane16_swap_b32 v13, v15
    s_cmp_eq_u32 s94, s97
    s_cbranch_scc1 L_sk2
    s_and_b32 s60, s58, 127
    s_cbranch_scc0 L_sk2
    buffer_store_dwordx4 v[12:15], v4, s[40:43], s13 offen sc1
L_sk2:
    s_endpgm
L_ack128:
    s_mov_b64 exec, 1
    v_mov_b32 v96, 0x1000
    v_mov_b32 v97, s59
    buffer_store_dword v97, v96, s[36:39], 0 offen sc1
    s_mov_b64 exec, -1
    s_branch L_nos2
L_low:
    s_lshl_b32 s60, s56, 3
    s_mul_i32 s62, s56, 6
    s_add_u32 s62, s62, 8
    s_cmp_lt_u32 s56, 4
    s_cselect_b32 s60, s60, s62
    s_cselect_b32 s61, 8, 6
    s_and_b32 s62, s57, 7
    s_add_u32 s58, s60, s62
    s_cmp_ge_u32 s62, s61
    s_cbranch_scc1 L_misc
    s_cmp_lt_u32 s57, 8
    s_cbranch_scc1 L_f
    v_lshrrev_b32 v4, 1, v0
    v_and_b32 v5, 1, v0
    v_lshlrev_b32 v5, 6, v5
    s_lshl_b32 s61, s3, 5
    v_add_u32 v4, s61, v4
    v_lshl_add_u32 v6, v4, 7, v5
    v_mul_u32_u24 v4, 3584, v4
    v_add_u32 v4, v4, v5
    s_lshr_b32 s60, s58, 1
    s_lshl_b32 s60, s60, 7
    s_bitcmp1_b32 s58, 0
    s_cselect_b32 s61, 917504, 0
    s_add_u32 s61, s61, s60
    s_waitcnt lgkmcnt(0)
    s_mov_b32 s48, s20
    s_mov_b32 s49, s21
    s_mov_b32 s50, 0x1c0000
    s_mov_b32 s51, 0x20000
    buffer_load_dword v8, v4, s[48:51], s61 offen
    s_mov_b32 s52, s22
    s_mov_b32 s53, s23
    s_mov_b32 s54, 0x1c0000
    s_mov_b32 s55, 0x20000
    s_lshl_b32 s62, s58, 15
    s_barrier
    buffer_load_dword v10, v6, s[52:55], s62 offen
    s_endpgm
L_misc:
    s_cmp_eq_u32 s57, 7
    s_cbranch_scc1 L_fin
    s_cmp_eq_u32 s57, 14
    s_cbranch_scc1 L_fin
    s_cmp_lg_u32 s2, 52
    s_cbranch_scc1 L_end
    s_mov_b32 s58, 128
    s_mov_b32 s9, 0
    s_mov_b32 s57, 15
    s_branch L_a
L_f:
    s_lshr_b32 s95, s58, 1
    s_xor_b32 s98, s3, 7
    v_lshrrev_b32 v8, 3, v0
    v_and_b32 v9, 2, v8
    v_and_b32 v10, 7, v0
    v_xor_b32 v9, v9, v10
    v_lshlrev_b32 v9, 4, v9
    v_lshl_add_u32 v5, v8, 10, v9
    v_xor_b32 v6, 64, v5
    s_lshl_b32 s13, s58, 15
    s_lshl_b32 s61, s3, 7
    s_add_u32 s13, s13, s61
    s_lshl_b32 s6, s3, 12
    s_add_u32 s6, s6, 65536
    s_waitcnt lgkmcnt(0)
    s_load_dword s59, s[30:31], 0
    s_mov_b32 s32, s4
    s_mov_b32 s33, s5
    s_mov_b32 s34, 0x200000
    s_mov_b32 s35, 0x20000
    s_mov_b32 s36, s30
    s_mov_b32 s37, s31
    s_mov_b32 s38, 0x400000
    s_mov_b32 s39, 0x20000
    s_mov_b32 s52, s22
    s_mov_b32 s53, s23
    s_mov_b32 s54, 0x1c0000
    s_mov_b32 s55, 0x20000
    s_waitcnt lgkmcnt(0)
    s_add_u32 s59, s59, 0x9e3779b9
    s_bitcmp1_b32 s59, 0
    s_cselect_b32 s91, 1, 0x10000
    s_xor_b32 s92, s91, 0x10001
    s_cmp_lt_u32 s98, 4
    s_cselect_b32 s44, s18, s20
    s_cselect_b32 s45, s19, s21
    s_mov_b32 s46, 0x1c0000
    s_mov_b32 s47, 0x20000
    v_lshrrev_b32 v8, 2, v0
    v_mul_u32_u24 v4, 3584, v8
    v_lshrrev_b32 v8, 2, v8
    v_and_b32 v8, 2, v8
    v_and_b32 v9, 3, v0
    v_xor_b32 v8, v8, v9
    v_lshl_add_u32 v4, v8, 4, v4
    s_and_b32 s60, s98, 3
    s_mul_i32 s12, s60, 458752
    s_lshl_b32 s61, s58, 6
    s_add_u32 s12, s12, s61
    s_lshl_b32 s14, s3, 13
    s_cmp_ge_u32 s98, 1
    s_cbranch_scc1 L_fd0
    s_add_u32 m0, s14, 0
    s_nop 0
    buffer_load_dwordx4 v4, s[44:47], s12 offen lds
    s_add_u32 s12, s12, 57344
    s_add_u32 m0, s14, 1024
    s_nop 0
    buffer_load_dwordx4 v4, s[44:47], s12 offen lds
    s_add_u32 s12, s12, 57344
    s_add_u32 m0, s14, 2048
    s_nop 0
    buffer_load_dwordx4 v4, s[44:47], s12 offen lds
    s_add_u32 s12, s12, 57344
    s_add_u32 m0, s14, 3072
    s_nop 0
    buffer_load_dwordx4 v4, s[44:47], s12 offen lds
    s_add_u32 s12, s12, 57344
    s_add_u32 m0, s14, 4096
    s_nop 0
    buffer_load_dwordx4 v4, s[44:47], s12 offen lds
    s_add_u32 s12, s12, 57344
    s_add_u32 m0, s14, 5120
    s_nop 0
    buffer_load_dwordx4 v4, s[44:47], s12 offen lds
    s_add_u32 s12, s12, 57344
    s_add_u32 m0, s14, 6144
    s_nop 0
    buffer_load_dwordx4 v4, s[44:47], s12 offen lds
    s_add_u32 s12, s12, 57344
    s_add_u32 m0, s14, 7168
    s_nop 0
    buffer_load_dwordx4 v4, s[44:47], s12 offen lds
L_fd0:
    v_lshrrev_b32 v8, 2, v2
    v_lshl_add_u32 v9, v3, 3, v8
    v_and_b32 v10, 3, v0
    v_lshlrev_b32 v10, 3, v10
    v_and_b32 v11, 1, v3
    v_lshl_add_u32 v7, v9, 6, v10
    v_lshl_add_u32 v7, v11, 5, v7
    v_add_u32 v7, s14, v7
    v_xor_b32 v12, 32, v7
    v_lshrrev_b32 v8, 1, v8
    v_lshl_add_u32 v8, v11, 1, v8
    v_lshl_add_u32 v112, v9, 7, v10
    v_lshl_add_u32 v112, v8, 5, v112
    v_add_u32 v112, s6, v112
    v_xor_b32 v113, 32, v112
    v_xor_b32 v114, 64, v112
    v_xor_b32 v115, 96, v112
    s_and_b32 s60, s98, 3
    s_lshl_b32 s60, s60, 8
    s_add_u32 s60, s60, 98304
    v_lshlrev_b32 v14, 4, v3
    v_add_u32 v15, s60, v14
    s_lshl_b32 s60, s98, 7
    s_add_u32 s60, s60, 99328
    v_add_u32 v107, s60, v14
    v_lshl_add_u32 v111, v3, 5, v10
    v_add_u32 v111, 99328, v111
    s_mul_i32 s8, s3, 7168
    s_lshl_b32 s61, s58, 7
    s_add_u32 s8, s8, s61
    s_add_u32 s8, s8, 0x10000
    s_and_b32 s15, s95, 31
    s_lshl_b32 s15, s15, 11
    s_add_u32 s15, s15, 0x40000
    v_lshlrev_b32 v134, 3, v0
    v_lshlrev_b32 v133, 4, v0
    v_mov_b32 v104, s91
    v_mov_b32 v105, s92
    v_mov_b32 v106, 0x00010001
    v_lshlrev_b32 v118, 1, v0
    v_and_b32 v117, 2, v0
    v_cmp_eq_u32 vcc, 0, v117
    s_nop 1
    v_cndmask_b32 v117, v105, v104, vcc
    s_cmp_ge_u32 s98, 1
    s_cbranch_scc1 L_fd1
    s_waitcnt vmcnt(0)
    s_barrier
    s_waitcnt vmcnt(6)
    ds_read_b64_tr_b16 v[16:17], v7 offset:0
    ds_read_b64_tr_b16 v[18:19], v7 offset:256
    ds_read_b64_tr_b16 v[20:21], v12 offset:0
    ds_read_b64_tr_b16 v[22:23], v12 offset:256
    s_waitcnt vmcnt(4)
    ds_read_b64_tr_b16 v[24:25], v7 offset:2048
    ds_read_b64_tr_b16 v[26:27], v7 offset:2304
    ds_read_b64_tr_b16 v[28:29], v12 offset:2048
    ds_read_b64_tr_b16 v[30:31], v12 offset:2304
    s_waitcnt vmcnt(2)
    ds_read_b64_tr_b16 v[32:33], v7 offset:4096
    ds_read_b64_tr_b16 v[34:35], v7 offset:4352
    ds_read_b64_tr_b16 v[36:37], v12 offset:4096
    ds_read_b64_tr_b16 v[38:39], v12 offset:4352
    s_waitcnt vmcnt(0)
    ds_read_b64_tr_b16 v[40:41], v7 offset:6144
    ds_read_b64_tr_b16 v[42:43], v7 offset:6400
    ds_read_b64_tr_b16 v[44:45], v12 offset:6144
    ds_read_b64_tr_b16 v[46:47], v12 offset:6400
    s_barrier
    s_add_u32 m0, s6, 0
    s_nop 0
    buffer_load_dwordx4 v5, s[52:55], s13 offen lds
    s_add_u32 s13, s13, 8192
    s_add_u32 m0, s6, 1024
    s_nop 0
    buffer_load_dwordx4 v6, s[52:55], s13 offen lds
    s_add_u32 s13, s13, 8192
    s_add_u32 m0, s6, 2048
    s_nop 0
    buffer_load_dwordx4 v5, s[52:55], s13 offen lds
    s_add_u32 s13, s13, 8192
    s_add_u32 m0, s6, 3072
    s_nop 0
    buffer_load_dwordx4 v6, s[52:55], s13 offen lds
    s_branch L_f2
L_fd1:
    s_barrier
    s_cmp_lg_u32 s3, 2
    s_cbranch_scc1 L_f1
    s_add_u32 m0, s14, 0
    s_nop 0
    buffer_load_dwordx4 v4, s[44:47], s12 offen lds
    s_add_u32 s12, s12, 57344
    s_add_u32 m0, s14, 1024
    s_nop 0
    buffer_load_dwordx4 v4, s[44:47], s12 offen lds
    s_add_u32 s12, s12, 57344
    s_add_u32 m0, s14, 2048
    s_nop 0
    buffer_load_dwordx4 v4, s[44:47], s12 offen lds
    s_add_u32 s12, s12, 57344
    s_add_u32 m0, s14, 3072
    s_nop 0
    buffer_load_dwordx4 v4, s[44:47], s12 offen lds
    s_add_u32 s12, s12, 57344
    s_add_u32 m0, s14, 4096
    s_nop 0
    buffer_load_dwordx4 v4, s[44:47], s12 offen lds
    s_add_u32 s12, s12, 57344
    s_add_u32 m0, s14, 5120
    s_nop 0
    buffer_load_dwordx4 v4, s[44:47], s12 offen lds
    s_add_u32 s12, s12, 57344
    s_add_u32 m0, s14, 6144
    s_nop 0
    buffer_load_dwordx4 v4, s[44:47], s12 offen lds
    s_add_u32 s12, s12, 57344
    s_add_u32 m0, s14, 7168
    s_nop 0
    buffer_load_dwordx4 v4, s[44:47], s12 offen lds
    s_waitcnt vmcnt(0)
    buffer_load_dwordx4 v[128:131], v247, s[36:39], s15 offen sc1
    s_barrier
    s_waitcnt vmcnt(0)
    v_xor_b32 v129, s59, v129
    v_bitop3_b32 v129, v131, s59, v129 bitop3:0xbe
    v_cmp_ne_u32 vcc, 0, v129
    v_max_u32 v128, v128, v130
    s_nop 0
    s_cbranch_vccz L_f1a
L_pk3:
    buffer_load_dwordx4 v[128:131], v133, s[36:39], s15 offen sc1
L_pk3_w:
    s_waitcnt vmcnt(0)
    v_xor_b32 v129, s59, v129
    v_bitop3_b32 v129, v131, s59, v129 bitop3:0xbe
    v_cmp_ne_u32 vcc, 0, v129
    v_max_u32 v128, v128, v130
    s_nop 0
    s_cbranch_vccz L_pk3_ok
    s_sleep 1
    s_sub_u32 s90, s90, 1
    s_cbranch_scc0 L_pk3
    s_mov_b32 s90, 0
L_pk3_ok:
    v_max_u32_dpp v128, v128, v128 row_ror:8 row_mask:0xf bank_mask:0xf
    s_nop 1
    v_max_u32_dpp v128, v128, v128 row_ror:4 row_mask:0xf bank_mask:0xf
    s_nop 1
    v_max_u32_dpp v128, v128, v128 row_ror:2 row_mask:0xf bank_mask:0xf
    s_nop 1
    v_max_u32_dpp v128, v128, v128 row_ror:1 row_mask:0xf bank_mask:0xf
    s_nop 0
    v_readlane_b32 s97, v128, 0
    v_readlane_b32 s60, v128, 16
    v_readlane_b32 s61, v128, 32
    v_readlane_b32 s62, v128, 48
    s_max_u32 s97, s97, s60
    s_max_u32 s61, s61, s62
    s_max_u32 s97, s97, s61
    s_branch L_f1b
L_f1a:
    v_max_u32_dpp v128, v128, v128 row_ror:8 row_mask:0xf bank_mask:0xf
    s_nop 1
    v_max_u32_dpp v128, v128, v128 row_ror:4 row_mask:0xf bank_mask:0xf
    s_nop 1
    v_max_u32_dpp v128, v128, v128 row_ror:2 row_mask:0xf bank_mask:0xf
    s_nop 1
    v_max_u32_dpp v128, v128, v128 row_ror:1 row_mask:0xf bank_mask:0xf
    s_nop 0
    v_readlane_b32 s97, v128, 0
    v_readlane_b32 s60, v128, 16
    v_readlane_b32 s61, v128, 32
    v_readlane_b32 s62, v128, 48
    s_max_u32 s97, s97, s60
    s_max_u32 s61, s61, s62
    s_max_u32 s97, s97, s61
L_f1b:
    s_and_b32 s97, s97, 2047
    s_lshl_b32 s60, s97, 10
    s_mov_b32 m0, 98304
    s_nop 0
    buffer_load_dwordx4 v247, s[32:35], s60 offen lds
    s_add_u32 m0, s6, 0
    s_nop 0
    buffer_load_dwordx4 v5, s[52:55], s13 offen lds
    s_add_u32 s13, s13, 8192
    s_add_u32 m0, s6, 1024
    s_nop 0
    buffer_load_dwordx4 v6, s[52:55], s13 offen lds
    s_add_u32 s13, s13, 8192
    s_add_u32 m0, s6, 2048
    s_nop 0
    buffer_load_dwordx4 v5, s[52:55], s13 offen lds
    s_add_u32 s13, s13, 8192
    s_add_u32 m0, s6, 3072
    s_nop 0
    buffer_load_dwordx4 v6, s[52:55], s13 offen lds
    s_waitcnt vmcnt(14)
    ds_read_b64_tr_b16 v[16:17], v7 offset:0
    ds_read_b64_tr_b16 v[18:19], v7 offset:256
    ds_read_b64_tr_b16 v[20:21], v12 offset:0
    ds_read_b64_tr_b16 v[22:23], v12 offset:256
    s_waitcnt vmcnt(12)
    ds_read_b64_tr_b16 v[24:25], v7 offset:2048
    ds_read_b64_tr_b16 v[26:27], v7 offset:2304
    ds_read_b64_tr_b16 v[28:29], v12 offset:2048
    ds_read_b64_tr_b16 v[30:31], v12 offset:2304
    s_waitcnt vmcnt(10)
    ds_read_b64_tr_b16 v[32:33], v7 offset:4096
    ds_read_b64_tr_b16 v[34:35], v7 offset:4352
    ds_read_b64_tr_b16 v[36:37], v12 offset:4096
    ds_read_b64_tr_b16 v[38:39], v12 offset:4352
    s_waitcnt vmcnt(8)
    ds_read_b64_tr_b16 v[40:41], v7 offset:6144
    ds_read_b64_tr_b16 v[42:43], v7 offset:6400
    ds_read_b64_tr_b16 v[44:45], v12 offset:6144
    ds_read_b64_tr_b16 v[46:47], v12 offset:6400
    s_waitcnt vmcnt(4)
    s_branch L_f2
L_f1:
    s_add_u32 m0, s14, 0
    s_nop 0
    buffer_load_dwordx4 v4, s[44:47], s12 offen lds
    s_add_u32 s12, s12, 57344
    s_add_u32 m0, s14, 1024
    s_nop 0
    buffer_load_dwordx4 v4, s[44:47], s12 offen lds
    s_add_u32 s12, s12, 57344
    s_add_u32 m0, s14, 2048
    s_nop 0
    buffer_load_dwordx4 v4, s[44:47], s12 offen lds
    s_add_u32 s12, s12, 57344
    s_add_u32 m0, s14, 3072
    s_nop 0
    buffer_load_dwordx4 v4, s[44:47], s12 offen lds
    s_add_u32 s12, s12, 57344
    s_add_u32 m0, s14, 4096
    s_nop 0
    buffer_load_dwordx4 v4, s[44:47], s12 offen lds
    s_add_u32 s12, s12, 57344
    s_add_u32 m0, s14, 5120
    s_nop 0
    buffer_load_dwordx4 v4, s[44:47], s12 offen lds
    s_add_u32 s12, s12, 57344
    s_add_u32 m0, s14, 6144
    s_nop 0
    buffer_load_dwordx4 v4, s[44:47], s12 offen lds
    s_add_u32 s12, s12, 57344
    s_add_u32 m0, s14, 7168
    s_nop 0
    buffer_load_dwordx4 v4, s[44:47], s12 offen lds
    s_barrier
    s_add_u32 m0, s6, 0
    s_nop 0
    buffer_load_dwordx4 v5, s[52:55], s13 offen lds
    s_add_u32 s13, s13, 8192
    s_add_u32 m0, s6, 1024
    s_nop 0
    buffer_load_dwordx4 v6, s[52:55], s13 offen lds
    s_add_u32 s13, s13, 8192
    s_add_u32 m0, s6, 2048
    s_nop 0
    buffer_load_dwordx4 v5, s[52:55], s13 offen lds
    s_add_u32 s13, s13, 8192
    s_add_u32 m0, s6, 3072
    s_nop 0
    buffer_load_dwordx4 v6, s[52:55], s13 offen lds
    s_waitcnt vmcnt(10)
    ds_read_b64_tr_b16 v[16:17], v7 offset:0
    ds_read_b64_tr_b16 v[18:19], v7 offset:256
    ds_read_b64_tr_b16 v[20:21], v12 offset:0
    ds_read_b64_tr_b16 v[22:23], v12 offset:256
    s_waitcnt vmcnt(8)
    ds_read_b64_tr_b16 v[24:25], v7 offset:2048
    ds_read_b64_tr_b16 v[26:27], v7 offset:2304
    ds_read_b64_tr_b16 v[28:29], v12 offset:2048
    ds_read_b64_tr_b16 v[30:31], v12 offset:2304
    s_waitcnt vmcnt(6)
    ds_read_b64_tr_b16 v[32:33], v7 offset:4096
    ds_read_b64_tr_b16 v[34:35], v7 offset:4352
    ds_read_b64_tr_b16 v[36:37], v12 offset:4096
    ds_read_b64_tr_b16 v[38:39], v12 offset:4352
    s_waitcnt vmcnt(4)
    ds_read_b64_tr_b16 v[40:41], v7 offset:6144
    ds_read_b64_tr_b16 v[42:43], v7 offset:6400
    ds_read_b64_tr_b16 v[44:45], v12 offset:6144
    ds_read_b64_tr_b16 v[46:47], v12 offset:6400
L_f2:
    s_waitcnt lgkmcnt(0)
    s_barrier
    ds_read_b128 v[64:67], v15 offset:0
    ds_read_b128 v[68:71], v15 offset:64
    ds_read_b128 v[72:75], v15 offset:128
    ds_read_b128 v[76:79], v15 offset:192
    s_waitcnt lgkmcnt(3)
    v_mfma_f32_16x16x32_bf16 v[80:83], v[16:19], v[64:67], 0
    v_mfma_f32_16x16x32_bf16 v[84:87], v[20:23], v[64:67], 0
    s_waitcnt lgkmcnt(2)
    v_mfma_f32_16x16x32_bf16 v[80:83], v[24:27], v[68:71], v[80:83]
    v_mfma_f32_16x16x32_bf16 v[84:87], v[28:31], v[68:71], v[84:87]
    s_waitcnt lgkmcnt(1)
    v_mfma_f32_16x16x32_bf16 v[80:83], v[32:35], v[72:75], v[80:83]
    v_mfma_f32_16x16x32_bf16 v[84:87], v[36:39], v[72:75], v[84:87]
    s_waitcnt lgkmcnt(0)
    v_mfma_f32_16x16x32_bf16 v[80:83], v[40:43], v[76:79], v[80:83]
    v_mfma_f32_16x16x32_bf16 v[84:87], v[44:47], v[76:79], v[84:87]
    s_mov_b32 exec_lo, 0x10001
    s_mov_b32 exec_hi, 0x10001
    s_nop 4
    ds_write_b128 v107, v[80:83] offset:0
    ds_write_b128 v107, v[84:87] offset:64
    s_mov_b64 exec, -1
    s_waitcnt lgkmcnt(0)
    s_barrier
    ds_read_b64 v[64:65], v111 offset:0
    ds_read_b64 v[66:67], v111 offset:128
    ds_read_b64 v[68:69], v111 offset:256
    ds_read_b64 v[70:71], v111 offset:384
    ds_read_b64 v[72:73], v111 offset:512
    ds_read_b64 v[74:75], v111 offset:640
    ds_read_b64 v[76:77], v111 offset:768
    ds_read_b64 v[78:79], v111 offset:896
    s_waitcnt vmcnt(0)
    ds_read_b64_tr_b16 v[48:49], v112 offset:0
    ds_read_b64_tr_b16 v[50:51], v112 offset:512
    ds_read_b64_tr_b16 v[52:53], v113 offset:0
    ds_read_b64_tr_b16 v[54:55], v113 offset:512
    ds_read_b64_tr_b16 v[56:57], v114 offset:0
    ds_read_b64_tr_b16 v[58:59], v114 offset:512
    ds_read_b64_tr_b16 v[60:61], v115 offset:0
    ds_read_b64_tr_b16 v[62:63], v115 offset:512
    s_waitcnt lgkmcnt(12)
    v_pk_add_f32 v[64:65], v[64:65], v[66:67]
    v_pk_add_f32 v[68:69], v[68:69], v[70:71]
    v_pk_add_f32 v[64:65], v[64:65], v[68:69]
    v_mul_f32 v67, 0xbfb8aa3b, v65
    v_mul_f32 v66, 0xbfb8aa3b, v64
    v_exp_f32 v67, v67
    v_exp_f32 v66, v66
    v_add_f32 v67, 1.0, v67
    v_add_f32 v66, 1.0, v66
    v_rcp_f32 v67, v67
    v_rcp_f32 v66, v66
    s_nop 0
    v_pk_mul_f32 v[64:65], v[64:65], v[66:67]
    s_waitcnt lgkmcnt(8)
    v_pk_add_f32 v[72:73], v[72:73], v[74:75]
    v_pk_add_f32 v[76:77], v[76:77], v[78:79]
    v_pk_add_f32 v[72:73], v[72:73], v[76:77]
    v_pk_mul_f32 v[64:65], v[64:65], v[72:73]
    v_cvt_pk_bf16_f32 v64, v64, v65
    s_nop 1
    v_mov_b32_dpp v72, v64 quad_perm:[0,0,0,0] row_mask:0xf bank_mask:0xf
    v_mov_b32_dpp v73, v64 quad_perm:[1,1,1,1] row_mask:0xf bank_mask:0xf
    v_mov_b32_dpp v74, v64 quad_perm:[2,2,2,2] row_mask:0xf bank_mask:0xf
    v_mov_b32_dpp v75, v64 quad_perm:[3,3,3,3] row_mask:0xf bank_mask:0xf
    s_waitcnt lgkmcnt(6)
    s_nop 0
    v_mfma_f32_16x16x32_bf16 v[88:91], v[72:75], v[48:51], 0
    s_waitcnt lgkmcnt(4)
    v_mfma_f32_16x16x32_bf16 v[92:95], v[72:75], v[52:55], 0
    s_waitcnt lgkmcnt(2)
    v_mfma_f32_16x16x32_bf16 v[96:99], v[72:75], v[56:59], 0
    s_waitcnt lgkmcnt(0)
    v_mfma_f32_16x16x32_bf16 v[100:103], v[72:75], v[60:63], 0
    s_mov_b32 exec_lo, 0xffff0000
    s_mov_b32 exec_hi, 0
    s_nop 1
    v_mov_b32 v88, v92
    s_mov_b32 exec_lo, 0
    s_mov_b32 exec_hi, 0xffff
    v_mov_b32 v88, v96
    s_mov_b32 exec_hi, 0xffff0000
    v_mov_b32 v88, v100
    s_mov_b64 exec, -1
    s_nop 0
    v_mov_b32_dpp v89, v88 quad_perm:[1,1,3,3] row_mask:0xf bank_mask:0xf
    v_cvt_pk_bf16_f32 v120, v88, v89
    s_mov_b32 exec_lo, 0x55555555
    s_mov_b32 exec_hi, 0x55555555
    v_bitop3_b32 v120, v106, v117, v120 bitop3:0xca
    buffer_store_dword v120, v118, s[36:39], s8 offen sc1
    s_mov_b64 exec, -1
    s_endpgm
L_fin:
    v_lshlrev_b32 v4, 5, v2
    v_and_b32 v96, 1, v3
    v_lshl_add_u32 v4, v96, 9, v4
    v_lshrrev_b32 v96, 1, v3
    v_lshl_add_u32 v4, v96, 4, v4
    s_add_u32 s95, s56, 24
    s_lshr_b32 s99, s57, 1
    s_and_b32 s99, s99, 4
    s_add_u32 s99, s99, s56
    s_sub_u32 s99, s99, 4
    s_waitcnt lgkmcnt(0)
    s_load_dword s59, s[30:31], 0
    s_mov_b32 s32, s4
    s_mov_b32 s33, s5
    s_mov_b32 s34, 0x200000
    s_mov_b32 s35, 0x20000
    s_mov_b32 s36, s30
    s_mov_b32 s37, s31
    s_mov_b32 s38, 0x400000
    s_mov_b32 s39, 0x20000
    s_mov_b32 s48, s24
    s_mov_b32 s49, s25
    s_mov_b32 s50, 0x400
    s_mov_b32 s51, 0x20000
    buffer_load_dwordx4 v[28:31], v4, s[48:51], 0 offen
    s_lshl_b32 s60, s3, 10
    v_lshl_add_u32 v248, v0, 4, s60
    s_add_u32 m0, s60, 32768
    global_load_lds_dwordx4 v248, s[10:11] offset:0
    s_and_b32 s63, s3, 1
    s_add_u32 s63, s63, 8
    s_lshl_b32 s60, s63, 10
    v_lshl_add_u32 v248, v0, 4, s60
    s_add_u32 m0, s60, 32768
    global_load_lds_dwordx4 v248, s[10:11] offset:0
    s_mov_b32 s40, s26
    s_mov_b32 s41, s27
    s_mov_b32 s42, 0x200000
    s_mov_b32 s43, 0x20000
    v_mov_b32 v252, s4
    v_mov_b32 v253, s5
    v_writelane_b32 v252, s26, 1
    v_writelane_b32 v253, s27, 1
    s_add_u32 s63, s30, 0x3000
    v_writelane_b32 v252, s63, 2
    s_addc_u32 s63, s31, 0
    v_writelane_b32 v253, s63, 2
    s_add_u32 s63, s30, 0x203000
    v_writelane_b32 v252, s63, 3
    s_addc_u32 s63, s31, 0
    v_writelane_b32 v253, s63, 3
    s_mov_b64 exec, 0xf
    global_load_dword v254, v[252:253], off
    s_mov_b64 exec, -1
    v_lshlrev_b32 v5, 12, v3
    v_lshl_add_u32 v5, v2, 4, v5
    v_lshrrev_b32 v96, 2, v2
    v_xor_b32 v96, v96, v3
    v_and_b32 v96, 1, v96
    v_bfe_u32 v97, v2, 1, 1
    v_lshl_or_b32 v96, v96, 1, v97
    s_lshr_b32 s60, s3, 1
    v_xor_b32 v96, s60, v96
    v_lshlrev_b32 v96, 4, v96
    v_and_b32 v98, 7, v2
    v_lshl_add_u32 v96, v98, 6, v96
    v_lshl_add_u32 v96, v3, 12, v96
    v_lshrrev_b32 v98, 3, v2
    v_lshl_add_u32 v96, v98, 2, v96
    s_and_b32 s60, s3, 1
    s_lshl_b32 s60, s60, 3
    s_add_u32 s60, s60, 16384
    v_add_u32 v6, s60, v96
    v_xor_b32 v7, 48, v6
    v_bfe_u32 v96, v2, 2, 1
    v_xor_b32 v96, v96, v98
    v_lshl_or_b32 v96, v96, 1, v98
    v_xor_b32 v96, v96, v97
    v_xor_b32 v96, v96, v3
    v_lshlrev_b32 v96, 4, v96
    v_lshl_add_u32 v62, v2, 6, v96
    s_and_b32 s15, s95, 31
    s_lshl_b32 s15, s15, 11
    s_add_u32 s15, s15, 0x40000
    v_lshlrev_b32 v134, 3, v0
    v_lshlrev_b32 v133, 4, v0
    s_mul_i32 s7, s99, 7168
    s_lshl_b32 s61, s3, 10
    s_add_u32 s7, s7, s61
    s_add_u32 s7, s7, 0xfc00
    v_and_b32 v108, 1, v3
    v_lshrrev_b32 v111, 1, v3
    v_lshl_add_u32 v108, v108, 1, v111
    v_and_b32 v107, 7, v2
    v_lshl_add_u32 v108, v2, 2, v108
    s_lshl_b32 s60, s3, 8
    s_add_u32 s60, s60, 43008
    v_lshl_add_u32 v108, v108, 2, s60
    v_and_b32 v111, 3, v2
    v_lshlrev_b32 v111, 6, v111
    v_lshl_add_u32 v111, v3, 4, v111
    v_mov_b32 v109, 43016
    s_waitcnt lgkmcnt(0)
    s_add_u32 s59, s59, 0x9e3779b9
    s_bitcmp1_b32 s59, 0
    s_cselect_b32 s91, 1, 0x10000
    s_xor_b32 s92, s91, 0x10001
    s_cmp_lg_u32 s3, 0
    s_cbranch_scc1 L_fin0
    s_cmp_eq_u32 s99, 0
    s_cbranch_scc1 L_fin0
    s_lshl_b32 s60, s99, 7
    v_mov_b32 v96, 0x1000
    v_mov_b32 v97, s59
    s_mov_b64 exec, 1
    buffer_store_dword v97, v96, s[36:39], s60 offen sc1
    s_mov_b64 exec, -1
L_fin0:
    v_mov_b32 v104, s91
    v_mov_b32 v105, s92
    v_mov_b32 v106, 0x00010001
    s_waitcnt vmcnt(0)
    s_barrier
    s_lshr_b32 s60, s99, 2
    s_lshl_b32 s60, s60, 10
    v_add_u32 v110, s60, v247
    ds_read_b128 v[152:155], v247 offset:32768
    ds_read_b128 v[156:159], v247 offset:33792
    ds_read_b128 v[184:187], v247 offset:34816
    ds_read_b128 v[188:191], v247 offset:35840
    ds_read_b128 v[192:195], v247 offset:36864
    ds_read_b128 v[196:199], v247 offset:37888
    ds_read_b128 v[168:171], v110 offset:38912
    ds_read_b128 v[172:175], v110 offset:40960
    s_cmp_lg_u32 s3, 0
    s_cbranch_scc1 L_fin1a
    v_mov_b32 v80, 0
    v_mov_b32 v81, 0
    v_mov_b32 v82, 0
    v_mov_b32 v83, 0
    buffer_atomic_or_x2 v[80:81], v134, s[36:39], s15 offen sc0 sc1
    buffer_atomic_or_x2 v[82:83], v134, s[36:39], s15 offen offset:512 sc0 sc1
    s_sleep 4
    v_mov_b32 v84, 0
    v_mov_b32 v85, 0
    v_mov_b32 v86, 0
    v_mov_b32 v87, 0
    buffer_atomic_or_x2 v[84:85], v134, s[36:39], s15 offen sc0 sc1
    buffer_atomic_or_x2 v[86:87], v134, s[36:39], s15 offen offset:512 sc0 sc1
    s_sleep 4
    v_mov_b32 v88, 0
    v_mov_b32 v89, 0
    v_mov_b32 v90, 0
    v_mov_b32 v91, 0
    buffer_atomic_or_x2 v[88:89], v134, s[36:39], s15 offen sc0 sc1
    buffer_atomic_or_x2 v[90:91], v134, s[36:39], s15 offen offset:512 sc0 sc1
L_kp4:
    s_waitcnt vmcnt(4)
    v_xor_b32 v129, s59, v81
    v_bitop3_b32 v129, v83, s59, v129 bitop3:0xbe
    v_cmp_ne_u32 vcc, 0, v129
    s_nop 0
    s_cbranch_vccz L_kp4_d0
    v_mov_b32 v80, 0
    v_mov_b32 v81, 0
    v_mov_b32 v82, 0
    v_mov_b32 v83, 0
    buffer_atomic_or_x2 v[80:81], v134, s[36:39], s15 offen sc0 sc1
    buffer_atomic_or_x2 v[82:83], v134, s[36:39], s15 offen offset:512 sc0 sc1
    s_waitcnt vmcnt(4)
    v_xor_b32 v129, s59, v85
    v_bitop3_b32 v129, v87, s59, v129 bitop3:0xbe
    v_cmp_ne_u32 vcc, 0, v129
    s_nop 0
    s_cbranch_vccz L_kp4_d1
    v_mov_b32 v84, 0
    v_mov_b32 v85, 0
    v_mov_b32 v86, 0
    v_mov_b32 v87, 0
    buffer_atomic_or_x2 v[84:85], v134, s[36:39], s15 offen sc0 sc1
    buffer_atomic_or_x2 v[86:87], v134, s[36:39], s15 offen offset:512 sc0 sc1
    s_waitcnt vmcnt(4)
    v_xor_b32 v129, s59, v89
    v_bitop3_b32 v129, v91, s59, v129 bitop3:0xbe
    v_cmp_ne_u32 vcc, 0, v129
    s_nop 0
    s_cbranch_vccz L_kp4_d2
    v_mov_b32 v88, 0
    v_mov_b32 v89, 0
    v_mov_b32 v90, 0
    v_mov_b32 v91, 0
    buffer_atomic_or_x2 v[88:89], v134, s[36:39], s15 offen sc0 sc1
    buffer_atomic_or_x2 v[90:91], v134, s[36:39], s15 offen offset:512 sc0 sc1
    s_sub_u32 s90, s90, 1
    s_cbranch_scc0 L_kp4
    s_waitcnt vmcnt(0)
L_kp4_d0:
    v_max_u32 v128, v80, v82
    s_branch L_kp4_x
L_kp4_d1:
    v_max_u32 v128, v84, v86
    s_branch L_kp4_x
L_kp4_d2:
    v_max_u32 v128, v88, v90
L_kp4_x:
    s_nop 1
    v_max_u32_dpp v128, v128, v128 row_ror:8 row_mask:0xf bank_mask:0xf
    s_nop 1
    v_max_u32_dpp v128, v128, v128 row_ror:4 row_mask:0xf bank_mask:0xf
    s_nop 1
    v_max_u32_dpp v128, v128, v128 row_ror:2 row_mask:0xf bank_mask:0xf
    s_nop 1
    v_max_u32_dpp v128, v128, v128 row_ror:1 row_mask:0xf bank_mask:0xf
    s_nop 0
    v_readlane_b32 s97, v128, 0
    v_readlane_b32 s60, v128, 16
    v_readlane_b32 s61, v128, 32
    v_readlane_b32 s62, v128, 48
    s_max_u32 s97, s97, s60
    s_max_u32 s61, s61, s62
    s_max_u32 s97, s97, s61
    v_mov_b32 v110, s97
    ds_write_b32 v109, v110
    s_and_b32 s60, s97, 2047
    s_lshl_b32 s12, s60, 10
    buffer_load_dwordx4 v[40:43], v4, s[32:35], s12 offen
    s_branch L_fin1
L_fin1a:
    s_lshl3_add_u32 s60, s99, s3
    s_cmp_lg_u32 s60, 2
    s_cbranch_scc1 L_fin1
    v_lshlrev_b32 v128, 7, v0
    s_mov_b64 exec, 0xff
    s_movk_i32 s60, 0x1000
L_ack:
    buffer_load_dword v129, v128, s[36:39], s60 offen sc1
    s_waitcnt vmcnt(0)
    v_cmp_ne_u32 vcc, s59, v129
    s_nop 0
    s_cbranch_vccz L_ack_ok
    s_sleep 1
    s_sub_u32 s90, s90, 1
    s_cbranch_scc0 L_ack
    s_mov_b32 s90, 0
L_ack_ok:
    s_mov_b64 exec, -1
L_fin1:
    s_waitcnt lgkmcnt(0)
    s_barrier
    ds_read_b32 v110, v109
    s_waitcnt lgkmcnt(0)
    v_readfirstlane_b32 s8, v110
    s_nop 0
    s_and_b32 s97, s8, 2047
    s_and_b32 s60, s97, 255
    s_and_b32 s61, s97, 15
    s_and_b32 s62, s97, 7
    s_cselect_b32 s60, s61, s60
    s_cselect_b32 s61, 8, 128
    s_cmp_gt_u32 s60, s61
    s_cselect_b32 s96, 0x80000000, 0
    s_sub_u32 s61, 2048, s97
    s_cmp_lg_u32 s96, 0
    s_cselect_b32 s60, s61, s97
    s_and_b32 s58, s60, 255
    s_lshr_b32 s98, s60, 8
    s_lshr_b32 s60, s58, 4
    s_and_b32 s61, s58, 15
    s_lshl4_add_u32 s9, s61, s60
    s_add_u32 s62, s60, s61
    s_cmp_eq_u32 s61, 8
    s_cselect_b32 s9, s62, s9
    s_cmp_eq_u32 s58, 128
    s_cselect_b32 s9, 0, s9
    s_lshl_b32 s14, s9, 14
    s_lshl_b32 s60, s3, 8
    s_add_u32 s14, s14, s60
    s_add_u32 s14, s14, 0x200000
    v_lshrrev_b32 v96, 1, v2
    v_lshlrev_b32 v96, 8, v96
    v_add_u32 v96, s58, v96
    v_and_b32 v97, 1, v2
    v_lshlrev_b32 v98, 1, v3
    v_mul_u32_u24 v98, v98, v96
    v_cmp_eq_u32 vcc, 0, v97
    v_and_b32 v99, 2047, v98
    v_add_u32 v98, v98, v96
    v_cvt_f32_u32 v99, v99
    v_mul_f32 v99, 0x3a000000, v99
    v_cos_f32 v100, v99
    v_sin_f32 v101, v99
    v_mul_f32 v100, 0.5, v100
    v_mul_f32 v101, 0.5, v101
    v_cndmask_b32_e64 v102, -v101, v100, vcc
    v_cndmask_b32 v103, v100, v101, vcc
    v_cvt_pk_bf16_f32 v144, v102, v103
    v_cvt_pk_bf16_f32 v148, -v103, v102
    v_cndmask_b32 v102, v101, v100, vcc
    v_cndmask_b32_e64 v103, -v100, v101, vcc
    v_cvt_pk_bf16_f32 v145, v102, -v103
    v_cvt_pk_bf16_f32 v149, -v103, -v102
    s_and_b32 s60, s58, 127
    s_cbranch_scc1 L_fin_a10
    v_add_f32 v100, v100, v100
    v_add_f32 v101, v101, v101
    v_cndmask_b32 v102, 0, v100, vcc
    v_sub_f32 v103, v100, v102
    v_cvt_pk_bf16_f32 v100, v102, v103
    v_cndmask_b32 v102, 0, v101, vcc
    v_sub_f32 v103, v101, v102
    v_cvt_pk_bf16_f32 v101, -v102, -v103
    s_cmp_eq_u32 s58, 0
    s_cselect_b32 s60, -1, 0
    s_cselect_b32 s61, 0, -1
    v_and_b32 v144, s60, v100
    v_and_b32 v148, s60, v101
    v_and_b32 v145, s61, v100
    v_and_b32 v149, s61, v101
L_fin_a10:
    v_and_b32 v99, 2047, v98
    v_cvt_f32_u32 v99, v99
    v_mul_f32 v99, 0x3a000000, v99
    v_cos_f32 v100, v99
    v_sin_f32 v101, v99
    v_mul_f32 v100, 0.5, v100
    v_mul_f32 v101, 0.5, v101
    v_cndmask_b32_e64 v102, -v101, v100, vcc
    v_cndmask_b32 v103, v100, v101, vcc
    v_cvt_pk_bf16_f32 v146, v102, v103
    v_cvt_pk_bf16_f32 v150, -v103, v102
    v_cndmask_b32 v102, v101, v100, vcc
    v_cndmask_b32_e64 v103, -v100, v101, vcc
    v_cvt_pk_bf16_f32 v147, v102, -v103
    v_cvt_pk_bf16_f32 v151, -v103, -v102
    s_and_b32 s60, s58, 127
    s_cbranch_scc1 L_fin_a11
    v_add_f32 v100, v100, v100
    v_add_f32 v101, v101, v101
    v_cndmask_b32 v102, 0, v100, vcc
    v_sub_f32 v103, v100, v102
    v_cvt_pk_bf16_f32 v100, v102, v103
    v_cndmask_b32 v102, 0, v101, vcc
    v_sub_f32 v103, v101, v102
    v_cvt_pk_bf16_f32 v101, -v102, -v103
    s_cmp_eq_u32 s58, 0
    s_cselect_b32 s60, -1, 0
    s_cselect_b32 s61, 0, -1
    v_and_b32 v146, s60, v100
    v_and_b32 v150, s60, v101
    v_and_b32 v147, s61, v100
    v_and_b32 v151, s61, v101
L_fin_a11:
    s_cmp_lg_u32 s3, 0
    s_cbranch_scc1 L_fin3
    s_lshl_b32 s60, s98, 4
    s_and_b32 s60, s60, 32
    v_xor_b32 v62, s60, v62
    s_lshl_b32 s60, s98, 11
    s_add_u32 s60, s60, 16384
    v_add_u32 v62, s60, v62
    v_xor_b32 v152, s96, v152
    v_xor_b32 v156, s96, v156
    v_xor_b32 v153, s96, v153
    v_xor_b32 v157, s96, v157
    v_xor_b32 v154, s96, v154
    v_xor_b32 v158, s96, v158
    v_xor_b32 v155, s96, v155
    v_xor_b32 v159, s96, v159
    s_ashr_i32 s60, s8, 31
    s_orn2_b32 s60, 0x80000000, s60
    s_xor_b32 s8, s8, s60
    s_waitcnt vmcnt(0)
    v_dot2_f32_bf16 v32, v40, v28, 0
    v_dot2_f32_bf16 v32, v41, v29, v32
    v_dot2_f32_bf16 v32, v42, v30, v32
    v_dot2_f32_bf16 v32, v43, v31, v32
    s_nop 2
    v_add_f32_dpp v32, v32, v32 row_ror:8 row_mask:0xf bank_mask:0xf
    s_nop 1
    v_add_f32_dpp v32, v32, v32 row_ror:4 row_mask:0xf bank_mask:0xf
    s_nop 1
    v_add_f32_dpp v32, v32, v32 row_ror:2 row_mask:0xf bank_mask:0xf
    s_nop 1
    v_add_f32_dpp v32, v32, v32 row_ror:1 row_mask:0xf bank_mask:0xf
    v_mov_b32 v33, v32
    s_nop 1
    v_permlane32_swap_b32 v32, v33
    v_add_f32 v32, v32, v33
    v_mov_b32 v33, v32
    s_nop 1
    v_permlane16_swap_b32 v32, v33
    v_add_f32 v32, v32, v33
    v_mov_b32 v33, s8
    v_cvt_pk_bf16_f32 v33, v33, v33
    v_cvt_pk_bf16_f32 v32, v32, v32
    v_and_b32 v33, 0xffff0000, v33
    v_and_b32 v32, 0xffff0000, v32
    v_mul_f32 v35, 0xbfb8aa3b, v33
    v_mul_f32 v34, 0xbfb8aa3b, v32
    v_exp_f32 v35, v35
    v_exp_f32 v34, v34
    v_add_f32 v35, 1.0, v35
    v_add_f32 v34, 1.0, v34
    v_rcp_f32 v35, v35
    v_rcp_f32 v34, v34
    v_cvt_pk_bf16_f32 v35, v35, v35
    v_cvt_pk_bf16_f32 v34, v34, v34
    v_and_b32 v35, 0xffff0000, v35
    v_and_b32 v34, 0xffff0000, v34
    v_permlane16_swap_b32 v40, v42
    v_permlane16_swap_b32 v41, v43
    s_bitcmp1_b32 s99, 2
    s_cbranch_scc0 L_fint
    v_mov_b32 v40, v42
    v_mov_b32 v41, v43
L_fint:
    v_sub_f32 v36, 1.0, v34
    v_cvt_pk_bf16_f32 v36, v36, v36
    v_and_b32 v36, 0xffff0000, v36
    v_lshlrev_b32 v216, 16, v40
    v_and_b32 v217, 0xffff0000, v40
    v_pk_mul_f32 v[216:217], v[216:217], v[36:37] op_sel_hi:[1,0]
    v_lshlrev_b32 v218, 16, v41
    v_and_b32 v219, 0xffff0000, v41
    v_pk_mul_f32 v[218:219], v[218:219], v[36:37] op_sel_hi:[1,0]
    v_mul_f32 v38, v35, v36
    v_pk_mul_f32 v[184:185], v[184:185], v[34:35] op_sel_hi:[1,0]
    v_pk_mul_f32 v[186:187], v[186:187], v[34:35] op_sel_hi:[1,0]
    v_pk_mul_f32 v[188:189], v[188:189], v[34:35] op_sel_hi:[1,0]
    v_pk_mul_f32 v[190:191], v[190:191], v[34:35] op_sel_hi:[1,0]
    v_pk_mul_f32 v[192:193], v[192:193], v[34:35] op_sel_hi:[1,0]
    v_pk_mul_f32 v[194:195], v[194:195], v[34:35] op_sel_hi:[1,0]
    v_pk_mul_f32 v[196:197], v[196:197], v[34:35] op_sel_hi:[1,0]
    v_pk_mul_f32 v[198:199], v[198:199], v[34:35] op_sel_hi:[1,0]
L_fin3:
    buffer_load_dwordx4 v[8:11], v5, s[36:39], s14 offen offset:0 sc1
    buffer_load_dwordx4 v[12:15], v5, s[36:39], s14 offen offset:2048 sc1
    s_branch L_fin_pw
L_fin_pl:
    buffer_load_dwordx4 v[8:11], v5, s[36:39], s14 offen offset:0 sc1
    buffer_load_dwordx4 v[12:15], v5, s[36:39], s14 offen offset:2048 sc1
L_fin_pw:
    s_waitcnt vmcnt(0)
    v_swap_b32 v10, v12
    v_swap_b32 v11, v13
    v_xor_b32 v96, v104, v8
    v_xor_b32 v97, v105, v9
    v_mfma_f32_16x16x32_bf16 v[64:67], v[144:147], v[8:11], 0
    v_bitop3_b32 v96, v10, v104, v96 bitop3:0xbe
    v_bitop3_b32 v97, v11, v105, v97 bitop3:0xbe
    v_mfma_f32_16x16x32_bf16 v[68:71], v[148:151], v[8:11], 0
    v_bitop3_b32 v96, v12, v104, v96 bitop3:0xbe
    v_bitop3_b32 v97, v13, v105, v97 bitop3:0xbe
    v_mfma_f32_16x16x32_bf16 v[72:75], v[144:147], v[12:15], 0
    v_bitop3_b32 v96, v14, v104, v96 bitop3:0xbe
    v_bitop3_b32 v97, v15, v105, v97 bitop3:0xbe
    v_mfma_f32_16x16x32_bf16 v[76:79], v[148:151], v[12:15], 0
    v_bitop3_b32 v96, v96, v97, v106 bitop3:0xa8
    v_cmp_ne_u32 vcc, 0, v96
    s_nop 0
    s_cbranch_vccz L_fin_pl_ok
    s_sleep 1
    s_sub_u32 s90, s90, 1
    s_cbranch_scc0 L_fin_pl
    s_mov_b32 s90, 0
L_fin_pl_ok:
    v_cvt_pk_bf16_f32 v16, v64, v68
    v_cvt_pk_bf16_f32 v17, v65, v69
    ds_write2st64_b32 v6, v16, v17 offset0:0 offset1:4
    v_cvt_pk_bf16_f32 v18, v66, v70
    v_cvt_pk_bf16_f32 v19, v67, v71
    ds_write2st64_b32 v6, v18, v19 offset0:8 offset1:12
    v_cvt_pk_bf16_f32 v20, v72, v76
    v_cvt_pk_bf16_f32 v21, v73, v77
    ds_write2st64_b32 v7, v20, v21 offset0:2 offset1:6
    v_cvt_pk_bf16_f32 v22, v74, v78
    v_cvt_pk_bf16_f32 v23, v75, v79
    ds_write2st64_b32 v7, v22, v23 offset0:10 offset1:14
    s_waitcnt lgkmcnt(0)
    s_barrier
    s_cmp_lg_u32 s3, 0
    s_cbranch_scc1 L_pp0
    ds_read_b128 v[16:19], v62 offset:0
    ds_read_b128 v[20:23], v62 offset:1024
    s_waitcnt lgkmcnt(1)
    v_mfma_f32_16x16x32_bf16 v[64:67], v[16:19], v[152:155], 0
    v_mfma_f32_16x16x32_bf16 v[68:71], v[16:19], v[156:159], 0
    s_waitcnt lgkmcnt(0)
    v_mfma_f32_16x16x32_bf16 v[72:75], v[20:23], v[152:155], 0
    v_mfma_f32_16x16x32_bf16 v[76:79], v[20:23], v[156:159], 0
    s_nop 3
    v_pk_mul_f32 v[96:97], v[64:65], v[184:185]
    v_pk_mul_f32 v[100:101], v[68:69], v[184:185]
    v_pk_mul_f32 v[98:99], v[66:67], v[186:187]
    v_pk_mul_f32 v[102:103], v[70:71], v[186:187]
    v_pk_fma_f32 v[96:97], v[68:69], v[188:189], v[96:97]
    v_pk_fma_f32 v[100:101], v[64:65], v[188:189], v[100:101] neg_lo:[1,0,0] neg_hi:[1,0,0]
    v_pk_fma_f32 v[98:99], v[70:71], v[190:191], v[98:99]
    v_pk_fma_f32 v[102:103], v[66:67], v[190:191], v[102:103] neg_lo:[1,0,0] neg_hi:[1,0,0]
    v_cvt_pk_bf16_f32 v112, v96, v100
    v_cvt_pk_bf16_f32 v113, v97, v101
    v_cvt_pk_bf16_f32 v114, v98, v102
    v_cvt_pk_bf16_f32 v115, v99, v103
    s_nop 1
    v_mfma_f32_16x16x32_bf16 v[232:235], v[112:115], v[168:171], v[216:219]
    v_pk_mul_f32 v[96:97], v[72:73], v[192:193]
    v_pk_mul_f32 v[100:101], v[76:77], v[192:193]
    v_pk_mul_f32 v[98:99], v[74:75], v[194:195]
    v_pk_mul_f32 v[102:103], v[78:79], v[194:195]
    v_pk_fma_f32 v[96:97], v[76:77], v[196:197], v[96:97]
    v_pk_fma_f32 v[100:101], v[72:73], v[196:197], v[100:101] neg_lo:[1,0,0] neg_hi:[1,0,0]
    v_pk_fma_f32 v[98:99], v[78:79], v[198:199], v[98:99]
    v_pk_fma_f32 v[102:103], v[74:75], v[198:199], v[102:103] neg_lo:[1,0,0] neg_hi:[1,0,0]
    v_cvt_pk_bf16_f32 v116, v96, v100
    v_cvt_pk_bf16_f32 v117, v97, v101
    v_cvt_pk_bf16_f32 v118, v98, v102
    v_cvt_pk_bf16_f32 v119, v99, v103
    s_nop 1
    v_mfma_f32_16x16x32_bf16 v[232:235], v[116:119], v[172:175], v[232:235]
    s_and_b32 s61, s99, 3
    s_lshl_b32 s61, s61, 2
    s_lshl_b32 exec_lo, 0x000f000f, s61
    s_mov_b32 exec_hi, exec_lo
    s_nop 3
    ds_write_b128 v111, v[232:235] offset:45056
    s_mov_b64 exec, 0xffff
    s_waitcnt lgkmcnt(0)
    ds_read_b128 v[232:235], v247 offset:45056
    v_mov_b32 v111, v247
    v_mov_b32 v4, v246
    s_lshl_b32 s12, s97, 10
    s_lshl_b32 s61, s99, 7
    s_add_u32 s12, s12, s61
    s_waitcnt lgkmcnt(0)
    s_branch L_fin5
L_pp0:
    v_mov_b32 v8, 0
    v_mov_b32 v9, 0
    v_mov_b32 v10, 0
    v_mov_b32 v11, 0
    buffer_atomic_or_x2 v[8:9], v246, s[36:39], s7 offen offset:0 sc0 sc1
    buffer_atomic_or_x2 v[10:11], v246, s[36:39], s7 offen offset:512 sc0 sc1
    s_sleep 4
    v_mov_b32 v12, 0
    v_mov_b32 v13, 0
    v_mov_b32 v14, 0
    v_mov_b32 v15, 0
    buffer_atomic_or_x2 v[12:13], v246, s[36:39], s7 offen offset:0 sc0 sc1
    buffer_atomic_or_x2 v[14:15], v246, s[36:39], s7 offen offset:512 sc0 sc1
    s_sleep 4
    v_mov_b32 v16, 0
    v_mov_b32 v17, 0
    v_mov_b32 v18, 0
    v_mov_b32 v19, 0
    buffer_atomic_or_x2 v[16:17], v246, s[36:39], s7 offen offset:0 sc0 sc1
    buffer_atomic_or_x2 v[18:19], v246, s[36:39], s7 offen offset:512 sc0 sc1
L_pa:
    s_waitcnt vmcnt(4)
    v_xor_b32 v96, v104, v8
    v_xor_b32 v97, v105, v9
    v_bitop3_b32 v96, v10, v104, v96 bitop3:0xbe
    v_bitop3_b32 v97, v11, v105, v97 bitop3:0xbe
    v_bitop3_b32 v96, v96, v97, v106 bitop3:0xa8
    v_cmp_ne_u32 vcc, 0, v96
    s_nop 0
    s_cbranch_vccz L_pa_d0
    v_mov_b32 v8, 0
    v_mov_b32 v9, 0
    v_mov_b32 v10, 0
    v_mov_b32 v11, 0
    buffer_atomic_or_x2 v[8:9], v246, s[36:39], s7 offen offset:0 sc0 sc1
    buffer_atomic_or_x2 v[10:11], v246, s[36:39], s7 offen offset:512 sc0 sc1
    s_waitcnt vmcnt(4)
    v_xor_b32 v96, v104, v12
    v_xor_b32 v97, v105, v13
    v_bitop3_b32 v96, v14, v104, v96 bitop3:0xbe
    v_bitop3_b32 v97, v15, v105, v97 bitop3:0xbe
    v_bitop3_b32 v96, v96, v97, v106 bitop3:0xa8
    v_cmp_ne_u32 vcc, 0, v96
    s_nop 0
    s_cbranch_vccz L_pa_d1
    v_mov_b32 v12, 0
    v_mov_b32 v13, 0
    v_mov_b32 v14, 0
    v_mov_b32 v15, 0
    buffer_atomic_or_x2 v[12:13], v246, s[36:39], s7 offen offset:0 sc0 sc1
    buffer_atomic_or_x2 v[14:15], v246, s[36:39], s7 offen offset:512 sc0 sc1
    s_waitcnt vmcnt(4)
    v_xor_b32 v96, v104, v16
    v_xor_b32 v97, v105, v17
    v_bitop3_b32 v96, v18, v104, v96 bitop3:0xbe
    v_bitop3_b32 v97, v19, v105, v97 bitop3:0xbe
    v_bitop3_b32 v96, v96, v97, v106 bitop3:0xa8
    v_cmp_ne_u32 vcc, 0, v96
    s_nop 0
    s_cbranch_vccz L_pa_d2
    v_mov_b32 v16, 0
    v_mov_b32 v17, 0
    v_mov_b32 v18, 0
    v_mov_b32 v19, 0
    buffer_atomic_or_x2 v[16:17], v246, s[36:39], s7 offen offset:0 sc0 sc1
    buffer_atomic_or_x2 v[18:19], v246, s[36:39], s7 offen offset:512 sc0 sc1
    s_sub_u32 s90, s90, 1
    s_cbranch_scc0 L_pa
    s_waitcnt vmcnt(0)
L_pa_d0:
    v_lshlrev_b32 v32, 16, v8
    v_and_b32 v33, 0xffff0000, v8
    v_lshlrev_b32 v34, 16, v9
    v_and_b32 v35, 0xffff0000, v9
    v_lshlrev_b32 v36, 16, v10
    v_and_b32 v37, 0xffff0000, v10
    v_lshlrev_b32 v38, 16, v11
    v_and_b32 v39, 0xffff0000, v11
    s_branch L_pa_x
L_pa_d1:
    v_lshlrev_b32 v32, 16, v12
    v_and_b32 v33, 0xffff0000, v12
    v_lshlrev_b32 v34, 16, v13
    v_and_b32 v35, 0xffff0000, v13
    v_lshlrev_b32 v36, 16, v14
    v_and_b32 v37, 0xffff0000, v14
    v_lshlrev_b32 v38, 16, v15
    v_and_b32 v39, 0xffff0000, v15
    s_branch L_pa_x
L_pa_d2:
    v_lshlrev_b32 v32, 16, v16
    v_and_b32 v33, 0xffff0000, v16
    v_lshlrev_b32 v34, 16, v17
    v_and_b32 v35, 0xffff0000, v17
    v_lshlrev_b32 v36, 16, v18
    v_and_b32 v37, 0xffff0000, v18
    v_lshlrev_b32 v38, 16, v19
    v_and_b32 v39, 0xffff0000, v19
L_pa_x:
    v_pk_add_f32 v[32:33], v[32:33], v[36:37]
    v_pk_add_f32 v[34:35], v[34:35], v[38:39]
    s_nop 0
    v_permlane32_swap_b32 v32, v33
    v_permlane32_swap_b32 v34, v35
    v_add_f32 v32, v32, v33
    v_add_f32 v34, v34, v35
    s_nop 1
    v_permlane16_swap_b32 v32, v34
    v_add_f32 v32, v32, v34
    ds_write_b32 v108, v32
    s_waitcnt lgkmcnt(0)
L_fin5:
    s_barrier
    s_cmp_lg_u32 s3, 0
    s_cbranch_scc1 L_fin7
    ds_read_b128 v[64:67], v111 offset:43264
    ds_read_b128 v[68:71], v111 offset:43520
    ds_read_b128 v[72:75], v111 offset:43776
    ds_read_b128 v[76:79], v111 offset:44032
    ds_read_b128 v[80:83], v111 offset:44288
    ds_read_b128 v[84:87], v111 offset:44544
    ds_read_b128 v[88:91], v111 offset:44800
    s_waitcnt lgkmcnt(0)
    v_pk_add_f32 v[68:69], v[68:69], v[72:73]
    v_pk_add_f32 v[70:71], v[70:71], v[74:75]
    v_pk_add_f32 v[76:77], v[76:77], v[80:81]
    v_pk_add_f32 v[78:79], v[78:79], v[82:83]
    v_pk_add_f32 v[84:85], v[84:85], v[88:89]
    v_pk_add_f32 v[86:87], v[86:87], v[90:91]
    v_pk_add_f32 v[64:65], v[64:65], v[68:69]
    v_pk_add_f32 v[76:77], v[76:77], v[84:85]
    v_pk_add_f32 v[66:67], v[66:67], v[70:71]
    v_pk_add_f32 v[78:79], v[78:79], v[86:87]
    v_pk_add_f32 v[64:65], v[64:65], v[76:77]
    v_pk_add_f32 v[66:67], v[66:67], v[78:79]
    v_pk_fma_f32 v[64:65], v[64:65], v[38:39], v[232:233] op_sel_hi:[1,0,1]
    v_pk_fma_f32 v[66:67], v[66:67], v[38:39], v[234:235] op_sel_hi:[1,0,1]
    v_cvt_pk_bf16_f32 v16, v64, v65
    v_cvt_pk_bf16_f32 v17, v66, v67
    buffer_store_dwordx2 v[16:17], v4, s[40:43], s12 offen sc1
    s_cmp_lg_u32 s99, 0
    s_cbranch_scc1 L_fin7
    s_mov_b64 exec, 1
    v_mov_b32 v20, 0
    v_mov_b32 v21, s59
    buffer_store_dword v21, v20, s[36:39], 0 offen sc1
L_fin7:
    s_endpgm
L_end:
    s_endpgm
.p2align 7
.type L_tab,@object
L_tab:
.long 0x3f80, 0x3f80, 0x3f80, 0x3f80, 0x3f80, 0x3ec43f6d, 0x3f353f35, 0x3f6d3ec4
.long 0x3f80, 0x3f353f35, 0x3f800000, 0x3f35bf35, 0x3f80, 0x3f6d3ec4, 0x3f35bf35, 0xbec4bf6d
.long 0x3f80, 0x3f800000, 0xbf80, 0xbf800000, 0x3f80, 0x3f6dbec4, 0xbf35bf35, 0xbec43f6d
.long 0x3f80, 0x3f35bf35, 0xbf800000, 0x3f353f35, 0x3f80, 0x3ec4bf6d, 0xbf353f35, 0x3f6dbec4
.long 0x3f80, 0xbf80, 0x3f80, 0xbf80, 0x3f80, 0xbec4bf6d, 0x3f353f35, 0xbf6dbec4
.long 0x3f80, 0xbf35bf35, 0x3f800000, 0xbf353f35, 0x3f80, 0xbf6dbec4, 0x3f35bf35, 0x3ec43f6d
.long 0x3f80, 0xbf800000, 0xbf80, 0x3f800000, 0x3f80, 0xbf6d3ec4, 0xbf35bf35, 0x3ec4bf6d
.long 0x3f80, 0xbf353f35, 0xbf800000, 0xbf35bf35, 0x3f80, 0xbec43f6d, 0xbf353f35, 0xbf6d3ec4
.long 0x3f80, 0x3f80, 0x3f80, 0x3f80, 0x3f800000, 0x3f6dbec4, 0x3f35bf35, 0x3ec4bf6d
.long 0xbf80, 0xbf35bf35, 0xbf800000, 0xbf353f35, 0xbf800000, 0xbec43f6d, 0x3f353f35, 0x3f6dbec4
.long 0x3f80, 0x3f800000, 0xbf80, 0xbf800000, 0x3f800000, 0xbec4bf6d, 0xbf353f35, 0x3f6d3ec4
.long 0xbf80, 0xbf353f35, 0x3f800000, 0xbf35bf35, 0xbf800000, 0x3f6d3ec4, 0xbf35bf35, 0x3ec43f6d
.long 0x3f80, 0xbf80, 0x3f80, 0xbf80, 0x3f800000, 0xbf6d3ec4, 0x3f35bf35, 0xbec43f6d
.long 0xbf80, 0x3f353f35, 0xbf800000, 0x3f35bf35, 0xbf800000, 0x3ec4bf6d, 0x3f353f35, 0xbf6d3ec4
.long 0x3f80, 0xbf800000, 0xbf80, 0x3f800000, 0x3f800000, 0x3ec43f6d, 0xbf353f35, 0xbf6dbec4
.long 0xbf80, 0x3f35bf35, 0x3f800000, 0x3f353f35, 0xbf800000, 0xbf6dbec4, 0xbf35bf35, 0xbec4bf6d
.long 0x3f80, 0x3f80, 0x3f80, 0x3f80, 0xbf80, 0xbec4bf6d, 0xbf35bf35, 0xbf6dbec4
.long 0x3f80, 0x3f353f35, 0x3f800000, 0x3f35bf35, 0xbf80, 0xbf6dbec4, 0xbf353f35, 0x3ec43f6d
.long 0x3f80, 0x3f800000, 0xbf80, 0xbf800000, 0xbf80, 0xbf6d3ec4, 0x3f353f35, 0x3ec4bf6d
.long 0x3f80, 0x3f35bf35, 0xbf800000, 0x3f353f35, 0xbf80, 0xbec43f6d, 0x3f35bf35, 0xbf6d3ec4
.long 0x3f80, 0xbf80, 0x3f80, 0xbf80, 0xbf80, 0x3ec43f6d, 0xbf35bf35, 0x3f6d3ec4
.long 0x3f80, 0xbf35bf35, 0x3f800000, 0xbf353f35, 0xbf80, 0x3f6d3ec4, 0xbf353f35, 0xbec4bf6d
.long 0x3f80, 0xbf800000, 0xbf80, 0x3f800000, 0xbf80, 0x3f6dbec4, 0x3f353f35, 0xbec43f6d
.long 0x3f80, 0xbf353f35, 0xbf800000, 0xbf35bf35, 0xbf80, 0x3ec4bf6d, 0x3f35bf35, 0x3f6dbec4
.long 0x3f80, 0x3f80, 0x3f80, 0x3f80, 0xbf800000, 0xbf6d3ec4, 0xbf353f35, 0xbec43f6d
.long 0xbf80, 0xbf35bf35, 0xbf800000, 0xbf353f35, 0x3f800000, 0x3ec4bf6d, 0xbf35bf35, 0xbf6d3ec4
.long 0x3f80, 0x3f800000, 0xbf80, 0xbf800000, 0xbf800000, 0x3ec43f6d, 0x3f35bf35, 0xbf6dbec4
.long 0xbf80, 0xbf353f35, 0x3f800000, 0xbf35bf35, 0x3f800000, 0xbf6dbec4, 0x3f353f35, 0xbec4bf6d
.long 0x3f80, 0xbf80, 0x3f80, 0xbf80, 0xbf800000, 0x3f6dbec4, 0xbf353f35, 0x3ec4bf6d
.long 0xbf80, 0x3f353f35, 0xbf800000, 0x3f35bf35, 0x3f800000, 0xbec43f6d, 0xbf35bf35, 0x3f6dbec4
.long 0x3f80, 0xbf800000, 0xbf80, 0x3f800000, 0xbf800000, 0xbec4bf6d, 0x3f35bf35, 0x3f6d3ec4
.long 0xbf80, 0x3f35bf35, 0x3f800000, 0x3f353f35, 0x3f800000, 0x3f6d3ec4, 0x3f353f35, 0x3ec43f6d
.long 0x3f808000, 0x3f808000, 0x3f808000, 0x3f808000, 0x3f808000, 0x3f6dbec4, 0x3f35bf35, 0x3ec4bf6d
.long 0x3f808000, 0x3f35bf35, 0xbf80, 0xbf35bf35, 0x3f808000, 0x3ec4bf6d, 0xbf35bf35, 0xbf6d3ec4
.long 0x3f808000, 0xbf80, 0xbf808000, 0x3f80, 0x3f808000, 0xbec4bf6d, 0xbf353f35, 0x3f6d3ec4
.long 0x3f808000, 0xbf35bf35, 0x3f80, 0x3f35bf35, 0x3f808000, 0xbf6dbec4, 0x3f353f35, 0xbec4bf6d
.long 0x3f808000, 0xbf808000, 0x3f808000, 0xbf808000, 0x3f808000, 0xbf6d3ec4, 0x3f35bf35, 0xbec43f6d
.long 0x3f808000, 0xbf353f35, 0xbf80, 0x3f353f35, 0x3f808000, 0xbec43f6d, 0xbf35bf35, 0x3f6dbec4
.long 0x3f808000, 0x3f80, 0xbf808000, 0xbf80, 0x3f808000, 0x3ec43f6d, 0xbf353f35, 0xbf6dbec4
.long 0x3f808000, 0x3f353f35, 0x3f80, 0xbf353f35, 0x3f808000, 0x3f6d3ec4, 0x3f353f35, 0x3ec43f6d
.long 0x3f808000, 0x3f808000, 0x3f808000, 0x3f808000, 0xbf80, 0xbec4bf6d, 0xbf35bf35, 0xbf6dbec4
.long 0xbf808000, 0xbf353f35, 0x3f80, 0x3f353f35, 0x3f80, 0x3f6d3ec4, 0x3f35bf35, 0xbec4bf6d
.long 0x3f808000, 0xbf80, 0xbf808000, 0x3f80, 0xbf80, 0xbf6d3ec4, 0x3f353f35, 0x3ec4bf6d
.long 0xbf808000, 0x3f353f35, 0xbf80, 0xbf353f35, 0x3f80, 0x3ec4bf6d, 0xbf353f35, 0x3f6dbec4
.long 0x3f808000, 0xbf808000, 0x3f808000, 0xbf808000, 0xbf80, 0x3ec43f6d, 0xbf35bf35, 0x3f6d3ec4
.long 0xbf808000, 0x3f35bf35, 0x3f80, 0xbf35bf35, 0x3f80, 0xbf6dbec4, 0x3f35bf35, 0x3ec43f6d
.long 0x3f808000, 0x3f80, 0xbf808000, 0xbf80, 0xbf80, 0x3f6dbec4, 0x3f353f35, 0xbec43f6d
.long 0xbf808000, 0xbf35bf35, 0xbf80, 0x3f35bf35, 0x3f80, 0xbec43f6d, 0xbf353f35, 0xbf6d3ec4
.long 0x3f808000, 0x3f808000, 0x3f808000, 0x3f808000, 0xbf808000, 0xbf6d3ec4, 0xbf353f35, 0xbec43f6d
.long 0x3f808000, 0x3f35bf35, 0xbf80, 0xbf35bf35, 0xbf808000, 0xbec43f6d, 0x3f353f35, 0x3f6dbec4
.long 0x3f808000, 0xbf80, 0xbf808000, 0x3f80, 0xbf808000, 0x3ec43f6d, 0x3f35bf35, 0xbf6dbec4
.long 0x3f808000, 0xbf35bf35, 0x3f80, 0x3f35bf35, 0xbf808000, 0x3f6d3ec4, 0xbf35bf35, 0x3ec43f6d
.long 0x3f808000, 0xbf808000, 0x3f808000, 0xbf808000, 0xbf808000, 0x3f6dbec4, 0xbf353f35, 0x3ec4bf6d
.long 0x3f808000, 0xbf353f35, 0xbf80, 0x3f353f35, 0xbf808000, 0x3ec4bf6d, 0x3f353f35, 0xbf6d3ec4
.long 0x3f808000, 0x3f80, 0xbf808000, 0xbf80, 0xbf808000, 0xbec4bf6d, 0x3f35bf35, 0x3f6d3ec4
.long 0x3f808000, 0x3f353f35, 0x3f80, 0xbf353f35, 0xbf808000, 0xbf6dbec4, 0xbf35bf35, 0xbec4bf6d
.long 0x3f808000, 0x3f808000, 0x3f808000, 0x3f808000, 0x3f80, 0x3ec43f6d, 0x3f353f35, 0x3f6d3ec4
.long 0xbf808000, 0xbf353f35, 0x3f80, 0x3f353f35, 0xbf80, 0xbf6dbec4, 0xbf353f35, 0x3ec43f6d
.long 0x3f808000, 0xbf80, 0xbf808000, 0x3f80, 0x3f80, 0x3f6dbec4, 0xbf35bf35, 0xbec43f6d
.long 0xbf808000, 0x3f353f35, 0xbf80, 0xbf353f35, 0xbf80, 0xbec43f6d, 0x3f35bf35, 0xbf6d3ec4
.long 0x3f808000, 0xbf808000, 0x3f808000, 0xbf808000, 0x3f80, 0xbec4bf6d, 0x3f353f35, 0xbf6dbec4
.long 0xbf808000, 0x3f35bf35, 0x3f80, 0xbf35bf35, 0xbf80, 0x3f6d3ec4, 0xbf353f35, 0xbec4bf6d
.long 0x3f808000, 0x3f80, 0xbf808000, 0xbf80, 0x3f80, 0xbf6d3ec4, 0xbf35bf35, 0x3ec4bf6d
.long 0xbf808000, 0xbf35bf35, 0xbf80, 0x3f35bf35, 0xbf80, 0x3ec4bf6d, 0x3f35bf35, 0x3f6dbec4
.long 0x3f800000, 0x3f800000, 0x3f800000, 0x3f800000, 0x3f800000, 0x3f7fec43, 0x3f7fb10f, 0x3f7f4e6d
.long 0x3f800000, 0x3f7fb10f, 0x3f7ec46d, 0x3f7d3aac, 0x3f800000, 0x3f7f4e6d, 0x3f7d3aac, 0x3f79c79d
.long 0x3f800000, 0x3f7ec46d, 0x3f7b14be, 0x3f74fa0b, 0x3f800000, 0x3f7e1324, 0x3f7853f8, 0x3f6ed89e
.long 0x3f800000, 0x3f7d3aac, 0x3f74fa0b, 0x3f676bd8, 0x3f800000, 0x3f7c3b28, 0x3f710908, 0x3f5ebe05
.long 0x3f800000, 0x3f7b14be, 0x3f6c835e, 0x3f54db31, 0x3f800000, 0x3f79c79d, 0x3f676bd8, 0x3f49d112
.long 0x3f800000, 0x3f7853f8, 0x3f61c598, 0x3f3daef9, 0x3f800000, 0x3f76ba07, 0x3f5b941a, 0x3f3085bb
.long 0x3f800000, 0x3f74fa0b, 0x3f54db31, 0x3f226799, 0x3f800000, 0x3f731447, 0x3f4d9f02, 0x3f13682a
.long 0x3f800000, 0x3f710908, 0x3f45e403, 0x3f039c3d, 0x3f800000, 0x3f6ed89e, 0x3f3daef9, 0x3ee63375
.long 0x3f800000, 0x3f800000, 0x3f800000, 0x3f800000, 0x3f7ec46d, 0x3f7e1324, 0x3f7d3aac, 0x3f7c3b28
.long 0x3f7b14be, 0x3f7853f8, 0x3f74fa0b, 0x3f710908, 0x3f74fa0b, 0x3f6ed89e, 0x3f676bd8, 0x3f5ebe05
.long 0x3f6c835e, 0x3f61c598, 0x3f54db31, 0x3f45e403, 0x3f61c598, 0x3f514d3d, 0x3f3daef9, 0x3f273656
.long 0x3f54db31, 0x3f3daef9, 0x3f226799, 0x3f039c3d, 0x3f45e403, 0x3f273656, 0x3f039c3d, 0x3eb8442a
.long 0x3f3504f3, 0x3f0e39da, 0x3ec3ef15, 0x3e47c5c2, 0x3f226799, 0x3ee63375, 0x3e78cfcc, 0x3cc90ab0
.long 0x3f0e39da, 0x3eac7cd4, 0x3dc8bd36, 0xbe164083, 0x3ef15aea, 0x3e605c13, 0xbd48fb30, 0xbea09ae5
.long 0x3ec3ef15, 0x3dc8bd36, 0xbe47c5c2, 0xbef15aea, 0x3e94a031, 0xbcc90ab0, 0xbeac7cd4, 0xbf1d7fd1
.long 0x3e47c5c2, 0xbe164083, 0xbef15aea, 0xbf3daef9, 0x3dc8bd36, 0xbe888e93, 0xbf187fc0, 0xbf584853
.long 0x3f800000, 0x3f800000, 0x3f800000, 0x3f800000, 0x3f7b14be, 0x3f79c79d, 0x3f7853f8, 0x3f76ba07
.long 0x3f6c835e, 0x3f676bd8, 0x3f61c598, 0x3f5b941a, 0x3f54db31, 0x3f49d112, 0x3f3daef9, 0x3f3085bb
.long 0x3f3504f3, 0x3f226799, 0x3f0e39da, 0x3ef15aea, 0x3f0e39da, 0x3ee63375, 0x3eac7cd4, 0x3e605c13
.long 0x3ec3ef15, 0x3e78cfcc, 0x3dc8bd36, 0xbd48fb30, 0x3e47c5c2, 0x3cc90ab0, 0xbe164083, 0xbea09ae5
.long 0x0, 0xbe47c5c2, 0xbec3ef15, 0xbf0e39da, 0xbe47c5c2, 0xbecf7bca, 0xbf187fc0, 0xbf41d870
.long 0xbec3ef15, 0xbf187fc0, 0xbf45e403, 0xbf676bd8, 0xbf0e39da, 0xbf41d870, 0xbf676bd8, 0xbf7c3b28
.long 0xbf3504f3, 0xbf61c598, 0xbf7b14be, 0xbf7ec46d, 0xbf54db31, 0xbf76ba07, 0xbf7fb10f, 0xbf6ed89e
.long 0xbf6c835e, 0xbf7fb10f, 0xbf74fa0b, 0xbf4d9f02, 0xbf7b14be, 0xbf7c3b28, 0xbf5b941a, 0xbf1d7fd1
.long 0x3f800000, 0x3f800000, 0x3f800000, 0x3f800000, 0x3f74fa0b, 0x3f731447, 0x3f710908, 0x3f6ed89e
.long 0x3f54db31, 0x3f4d9f02, 0x3f45e403, 0x3f3daef9, 0x3f226799, 0x3f13682a, 0x3f039c3d, 0x3ee63375
.long 0x3ec3ef15, 0x3e94a031, 0x3e47c5c2, 0x3dc8bd36, 0x3dc8bd36, 0xbcc90ab0, 0xbe164083, 0xbe888e93
.long 0xbe47c5c2, 0xbeac7cd4, 0xbef15aea, 0xbf187fc0, 0xbef15aea, 0xbf1d7fd1, 0xbf3daef9, 0xbf584853
.long 0xbf3504f3, 0xbf54db31, 0xbf6c835e, 0xbf7b14be, 0xbf61c598, 0xbf76ba07, 0xbf7fb10f, 0xbf7c3b28
.long 0xbf7b14be, 0xbf7fb10f, 0xbf74fa0b, 0xbf5b941a, 0xbf7ec46d, 0xbf6ed89e, 0xbf4d9f02, 0xbf1d7fd1
.long 0xbf6c835e, 0xbf45e403, 0xbf0e39da, 0xbe94a031, 0xbf45e403, 0xbf08f59b, 0xbe78cfcc, 0x3d96a905
.long 0xbf0e39da, 0xbe78cfcc, 0x3dc8bd36, 0x3edae880, 0xbe94a031, 0x3d96a905, 0x3edae880, 0x3f396842
.long 0x0, 0x0, 0x0, 0x0, 0x0, 0x3cc90ab0, 0x3d48fb30, 0x3d96a905
.long 0x0, 0x3d48fb30, 0x3dc8bd36, 0x3e164083, 0x0, 0x3d96a905, 0x3e164083, 0x3e605c13
.long 0x0, 0x3dc8bd36, 0x3e47c5c2, 0x3e94a031, 0x0, 0x3dfab273, 0x3e78cfcc, 0x3eb8442a
.long 0x0, 0x3e164083, 0x3e94a031, 0x3edae880, 0x0, 0x3e2f10a2, 0x3eac7cd4, 0x3efc5d27
.long 0x0, 0x3e47c5c2, 0x3ec3ef15, 0x3f0e39da, 0x0, 0x3e605c13, 0x3edae880, 0x3f1d7fd1
.long 0x0, 0x3e78cfcc, 0x3ef15aea, 0x3f2beb4a, 0x0, 0x3e888e93, 0x3f039c3d, 0x3f396842
.long 0x0, 0x3e94a031, 0x3f0e39da, 0x3f45e403, 0x0, 0x3ea09ae5, 0x3f187fc0, 0x3f514d3d
.long 0x0, 0x3eac7cd4, 0x3f226799, 0x3f5b941a, 0x0, 0x3eb8442a, 0x3f2beb4a, 0x3f64aa59
.long 0x0, 0x0, 0x0, 0x0, 0x3dc8bd36, 0x3dfab273, 0x3e164083, 0x3e2f10a2
.long 0x3e47c5c2, 0x3e78cfcc, 0x3e94a031, 0x3eac7cd4, 0x3e94a031, 0x3eb8442a, 0x3edae880, 0x3efc5d27
.long 0x3ec3ef15, 0x3ef15aea, 0x3f0e39da, 0x3f226799, 0x3ef15aea, 0x3f13682a, 0x3f2beb4a, 0x3f41d870
.long 0x3f0e39da, 0x3f2beb4a, 0x3f45e403, 0x3f5b941a, 0x3f226799, 0x3f41d870, 0x3f5b941a, 0x3f6ed89e
.long 0x3f3504f3, 0x3f54db31, 0x3f6c835e, 0x3f7b14be, 0x3f45e403, 0x3f64aa59, 0x3f7853f8, 0x3f7fec43
.long 0x3f54db31, 0x3f710908, 0x3f7ec46d, 0x3f7d3aac, 0x3f61c598, 0x3f79c79d, 0x3f7fb10f, 0x3f731447
.long 0x3f6c835e, 0x3f7ec46d, 0x3f7b14be, 0x3f61c598, 0x3f74fa0b, 0x3f7fec43, 0x3f710908, 0x3f49d112
.long 0x3f7b14be, 0x3f7d3aac, 0x3f61c598, 0x3f2beb4a, 0x3f7ec46d, 0x3f76ba07, 0x3f4d9f02, 0x3f08f59b
.long 0x0, 0x0, 0x0, 0x0, 0x3e47c5c2, 0x3e605c13, 0x3e78cfcc, 0x3e888e93
.long 0x3ec3ef15, 0x3edae880, 0x3ef15aea, 0x3f039c3d, 0x3f0e39da, 0x3f1d7fd1, 0x3f2beb4a, 0x3f396842
.long 0x3f3504f3, 0x3f45e403, 0x3f54db31, 0x3f61c598, 0x3f54db31, 0x3f64aa59, 0x3f710908, 0x3f79c79d
.long 0x3f6c835e, 0x3f7853f8, 0x3f7ec46d, 0x3f7fb10f, 0x3f7b14be, 0x3f7fec43, 0x3f7d3aac, 0x3f731447
.long 0x3f800000, 0x3f7b14be, 0x3f6c835e, 0x3f54db31, 0x3f7b14be, 0x3f6a09a7, 0x3f4d9f02, 0x3f273656
.long 0x3f6c835e, 0x3f4d9f02, 0x3f226799, 0x3edae880, 0x3f54db31, 0x3f273656, 0x3edae880, 0x3e2f10a2
.long 0x3f3504f3, 0x3ef15aea, 0x3e47c5c2, 0xbdc8bd36, 0x3f0e39da, 0x3e888e93, 0xbd48fb30, 0xbeb8442a
.long 0x3ec3ef15, 0x3d48fb30, 0xbe94a031, 0xbf187fc0, 0x3e47c5c2, 0xbe2f10a2, 0xbf039c3d, 0xbf49d112
.long 0x0, 0x0, 0x0, 0x0, 0x3e94a031, 0x3ea09ae5, 0x3eac7cd4, 0x3eb8442a
.long 0x3f0e39da, 0x3f187fc0, 0x3f226799, 0x3f2beb4a, 0x3f45e403, 0x3f514d3d, 0x3f5b941a, 0x3f64aa59
.long 0x3f6c835e, 0x3f74fa0b, 0x3f7b14be, 0x3f7ec46d, 0x3f7ec46d, 0x3f7fec43, 0x3f7d3aac, 0x3f76ba07
.long 0x3f7b14be, 0x3f710908, 0x3f61c598, 0x3f4d9f02, 0x3f61c598, 0x3f49d112, 0x3f2beb4a, 0x3f08f59b
.long 0x3f3504f3, 0x3f0e39da, 0x3ec3ef15, 0x3e47c5c2, 0x3ef15aea, 0x3e888e93, 0x3d48fb30, 0xbe2f10a2
.long 0x3e47c5c2, 0xbd48fb30, 0xbe94a031, 0xbf039c3d, 0xbdc8bd36, 0xbeb8442a, 0xbf187fc0, 0xbf49d112
.long 0xbec3ef15, 0xbf226799, 0xbf54db31, 0xbf74fa0b, 0xbf226799, 0xbf584853, 0xbf7853f8, 0xbf7f4e6d
.long 0xbf54db31, 0xbf7853f8, 0xbf7ec46d, 0xbf676bd8, 0xbf74fa0b, 0xbf7f4e6d, 0xbf676bd8, 0xbf3085bb
.long 0x3f800000, 0x3f800000, 0x3f800000, 0x3f800000, 0x3f7ffb11, 0x3f7fd397, 0x3f7f84ab, 0x3f7f0e58
.long 0x3f7fec43, 0x3f7f4e6d, 0x3f7e1324, 0x3f7c3b28, 0x3f7fd397, 0x3f7e70b0, 0x3f7baccd, 0x3f778bc5
.long 0x3f7fb10f, 0x3f7d3aac, 0x3f7853f8, 0x3f710908, 0x3f7f84ab, 0x3f7baccd, 0x3f740bdd, 0x3f68bf3c
.long 0x3f7f4e6d, 0x3f79c79d, 0x3f6ed89e, 0x3f5ebe05, 0x3f7f0e58, 0x3f778bc5, 0x3f68bf3c, 0x3f531849
.long 0x3f7ec46d, 0x3f74fa0b, 0x3f61c598, 0x3f45e403, 0x3f7e70b0, 0x3f721352, 0x3f59f26a, 0x3f373a23
.long 0x3f7e1324, 0x3f6ed89e, 0x3f514d3d, 0x3f273656, 0x3f7dabcc, 0x3f6b4b0c, 0x3f47de65, 0x3f15f6d9
.long 0x3f7d3aac, 0x3f676bd8, 0x3f3daef9, 0x3f039c3d, 0x3f7cbfc9, 0x3f633c5a, 0x3f32c8c9, 0x3ee0924f
.long 0x3f7c3b28, 0x3f5ebe05, 0x3f273656, 0x3eb8442a, 0x3f7baccd, 0x3f59f26a, 0x3f1b02c6, 0x3e8e9a22
.long 0x3f800000, 0x3f800000, 0x3f800000, 0x3f800000, 0x3f7e70b0, 0x3f7dabcc, 0x3f7cbfc9, 0x3f7baccd
.long 0x3f79c79d, 0x3f76ba07, 0x3f731447, 0x3f6ed89e, 0x3f721352, 0x3f6b4b0c, 0x3f633c5a, 0x3f59f26a
.long 0x3f676bd8, 0x3f5b941a, 0x3f4d9f02, 0x3f3daef9, 0x3f59f26a, 0x3f47de65, 0x3f32c8c9, 0x3f1b02c6
.long 0x3f49d112, 0x3f3085bb, 0x3f13682a, 0x3ee63375, 0x3f373a23, 0x3f15f6d9, 0x3ee0924f, 0x3e8e9a22
.long 0x3f226799, 0x3ef15aea, 0x3e94a031, 0x3dc8bd36, 0x3f0b9a6b, 0x3eb263ef, 0x3e09cf86, 0xbdafb680
.long 0x3ee63375, 0x3e605c13, 0xbcc90ab0, 0xbe888e93, 0x3eb263ef, 0x3dafb680, 0xbe3b6ecf, 0xbee0924f
.long 0x3e78cfcc, 0xbd48fb30, 0xbeac7cd4, 0xbf187fc0, 0x3e09cf86, 0xbe3b6ecf, 0xbef6e0cb, 0xbf3b8f3b
.long 0x3cc90ab0, 0xbea09ae5, 0xbf1d7fd1, 0xbf584853, 0xbdafb680, 0xbee0924f, 0xbf3b8f3b, 0xbf6db293
.long 0x3f800000, 0x3f800000, 0x3f800000, 0x3f800000, 0x3f7a7302, 0x3f791298, 0x3f778bc5, 0x3f75dec6
.long 0x3f6a09a7, 0x3f64aa59, 0x3f5ebe05, 0x3f584853, 0x3f4f7a1f, 0x3f43e200, 0x3f373a23, 0x3f299415
.long 0x3f2beb4a, 0x3f187fc0, 0x3f039c3d, 0x3edae880, 0x3f00e7e4, 0x3ec9b953, 0x3e8e9a22, 0x3e22abb6
.long 0x3ea09ae5, 0x3e2f10a2, 0x3cc90ab0, 0xbdfab273, 0x3de1bc2e, 0xbd7b2b74, 0xbe6c9a7f, 0xbec9b953
.long 0xbdc8bd36, 0xbe94a031, 0xbef15aea, 0xbf226799, 0xbe9aa086, 0xbf00e7e4, 0xbf2e3bde, 0xbf531849
.long 0xbefc5d27, 0xbf3085bb, 0xbf584853, 0xbf731447, 0xbf299415, 0xbf5695e5, 0xbf740bdd, 0xbf7fd397
.long 0xbf4d9f02, 0xbf710908, 0xbf7fb10f, 0xbf7853f8, 0xbf68bf3c, 0xbf7e70b0, 0xbf7a7302, 0xbf5d2d53
.long 0xbf79c79d, 0xbf7e1324, 0xbf64aa59, 0xbf3085bb, 0xbf7ffb11, 0xbf6ff573, 0xbf3fc767, 0xbeebcbbb
.long 0x3f800000, 0x3f800000, 0x3f800000, 0x3f800000, 0x3f740bdd, 0x3f721352, 0x3f6ff573, 0x3f6db293
.long 0x3f514d3d, 0x3f49d112, 0x3f41d870, 0x3f396842, 0x3f1b02c6, 0x3f0b9a6b, 0x3ef6e0cb, 0x3ed53641
.long 0x3eac7cd4, 0x3e78cfcc, 0x3e164083, 0x3d48fb30, 0x3d16c32c, 0xbdafb680, 0xbe541501, 0xbea68f12
.long 0xbe888e93, 0xbecf7bca, 0xbf08f59b, 0xbf273656, 0xbf0b9a6b, 0xbf2e3bde, 0xbf4bbbf8, 0xbf633c5a
.long 0xbf45e403, 0xbf61c598, 0xbf74fa0b, 0xbf7ec46d, 0xbf6db293, 0xbf7cbfc9, 0xbf7f84ab, 0xbf75dec6
.long 0xbf7f4e6d, 0xbf7c3b28, 0xbf6a09a7, 0xbf49d112, 0xbf791298, 0xbf604621, 0xbf373a23, 0xbf00e7e4
.long 0xbf5b941a, 0xbf2beb4a, 0xbedae880, 0xbe164083, 0xbf299415, 0xbec9b953, 0xbdafb680, 0x3e6c9a7f
.long 0xbecf7bca, 0xbd96a905, 0x3e888e93, 0x3f13682a, 0xbde1bc2e, 0x3e827dc0, 0x3f15f6d9, 0x3f5695e5
.long 0x0, 0x0, 0x0, 0x0, 0x3c490e90, 0x3d16c32c, 0x3d7b2b74, 0x3dafb680
.long 0x3cc90ab0, 0x3d96a905, 0x3dfab273, 0x3e2f10a2, 0x3d16c32c, 0x3de1bc2e, 0x3e3b6ecf, 0x3e827dc0
.long 0x3d48fb30, 0x3e164083, 0x3e78cfcc, 0x3eac7cd4, 0x3d7b2b74, 0x3e3b6ecf, 0x3e9aa086, 0x3ed53641
.long 0x3d96a905, 0x3e605c13, 0x3eb8442a, 0x3efc5d27, 0x3dafb680, 0x3e827dc0, 0x3ed53641, 0x3f10d3cd
.long 0x3dc8bd36, 0x3e94a031, 0x3ef15aea, 0x3f226799, 0x3de1bc2e, 0x3ea68f12, 0x3f064b82, 0x3f32c8c9
.long 0x3dfab273, 0x3eb8442a, 0x3f13682a, 0x3f41d870, 0x3e09cf86, 0x3ec9b953, 0x3f1ff6cb, 0x3f4f7a1f
.long 0x3e164083, 0x3edae880, 0x3f2beb4a, 0x3f5b941a, 0x3e22abb6, 0x3eebcbbb, 0x3f373a23, 0x3f660f88
.long 0x3e2f10a2, 0x3efc5d27, 0x3f41d870, 0x3f6ed89e, 0x3e3b6ecf, 0x3f064b82, 0x3f4bbbf8, 0x3f75dec6
.long 0x0, 0x0, 0x0, 0x0, 0x3de1bc2e, 0x3e09cf86, 0x3e22abb6, 0x3e3b6ecf
.long 0x3e605c13, 0x3e888e93, 0x3ea09ae5, 0x3eb8442a, 0x3ea68f12, 0x3ec9b953, 0x3eebcbbb, 0x3f064b82
.long 0x3edae880, 0x3f039c3d, 0x3f187fc0, 0x3f2beb4a, 0x3f064b82, 0x3f1ff6cb, 0x3f373a23, 0x3f4bbbf8
.long 0x3f1d7fd1, 0x3f396842, 0x3f514d3d, 0x3f64aa59, 0x3f32c8c9, 0x3f4f7a1f, 0x3f660f88, 0x3f75dec6
.long 0x3f45e403, 0x3f61c598, 0x3f74fa0b, 0x3f7ec46d, 0x3f5695e5, 0x3f6ff573, 0x3f7dabcc, 0x3f7f0e58
.long 0x3f64aa59, 0x3f79c79d, 0x3f7fec43, 0x3f76ba07, 0x3f6ff573, 0x3f7f0e58, 0x3f7baccd, 0x3f660f88
.long 0x3f7853f8, 0x3f7fb10f, 0x3f710908, 0x3f4d9f02, 0x3f7dabcc, 0x3f7baccd, 0x3f604621, 0x3f2e3bde
.long 0x3f7fec43, 0x3f731447, 0x3f49d112, 0x3f08f59b, 0x3f7f0e58, 0x3f660f88, 0x3f2e3bde, 0x3ebe1d4a
.long 0x0, 0x0, 0x0, 0x0, 0x3e541501, 0x3e6c9a7f, 0x3e827dc0, 0x3e8e9a22
.long 0x3ecf7bca, 0x3ee63375, 0x3efc5d27, 0x3f08f59b, 0x3f15f6d9, 0x3f24d225, 0x3f32c8c9, 0x3f3fc767
.long 0x3f3daef9, 0x3f4d9f02, 0x3f5b941a, 0x3f676bd8, 0x3f5d2d53, 0x3f6b4b0c, 0x3f75dec6, 0x3f7cbfc9
.long 0x3f731447, 0x3f7c3b28, 0x3f7fec43, 0x3f7e1324, 0x3f7e70b0, 0x3f7f84ab, 0x3f791298, 0x3f6b4b0c
.long 0x3f7ec46d, 0x3f74fa0b, 0x3f61c598, 0x3f45e403, 0x3f740bdd, 0x3f5d2d53, 0x3f3b8f3b, 0x3f10d3cd
.long 0x3f5ebe05, 0x3f396842, 0x3f08f59b, 0x3ea09ae5, 0x3f3fc767, 0x3f0b9a6b, 0x3e9aa086, 0x3d16c32c
.long 0x3f187fc0, 0x3eac7cd4, 0x3d48fb30, 0xbe78cfcc, 0x3ed53641, 0x3de1bc2e, 0xbe541501, 0xbf00e7e4
.long 0x3e605c13, 0xbdfab273, 0xbee63375, 0xbf396842, 0x3c490e90, 0xbeb263ef, 0xbf299415, 0xbf633c5a
.long 0x0, 0x0, 0x0, 0x0, 0x3e9aa086, 0x3ea68f12, 0x3eb263ef, 0x3ebe1d4a
.long 0x3f13682a, 0x3f1d7fd1, 0x3f273656, 0x3f3085bb, 0x3f4bbbf8, 0x3f5695e5, 0x3f604621, 0x3f68bf3c
.long 0x3f710908, 0x3f7853f8, 0x3f7d3aac, 0x3f7fb10f, 0x3f7fd397, 0x3f7f0e58, 0x3f7a7302, 0x3f721352
.long 0x3f76ba07, 0x3f6a09a7, 0x3f584853, 0x3f41d870, 0x3f5695e5, 0x3f3b8f3b, 0x3f1b02c6, 0x3eebcbbb
.long 0x3f226799, 0x3ef15aea, 0x3e94a031, 0x3dc8bd36, 0x3ebe1d4a, 0x3e22abb6, 0xbd7b2b74, 0xbe8e9a22
.long 0x3d96a905, 0xbe2f10a2, 0xbecf7bca, 0xbf1d7fd1, 0xbe6c9a7f, 0xbef6e0cb, 0xbf32c8c9, 0xbf5d2d53
.long 0xbf039c3d, 0xbf3daef9, 0xbf676bd8, 0xbf7d3aac, 0xbf3fc767, 0xbf6b4b0c, 0xbf7f0e58, 0xbf791298
.long 0xbf6a09a7, 0xbf7f4e6d, 0xbf76ba07, 0xbf514d3d, 0xbf7e70b0, 0xbf778bc5, 0xbf4f7a1f, 0xbf0b9a6b
.long 0x3f80, 0x3f80, 0x3f80, 0x3f80, 0x3f80, 0x3ec43f6d, 0x3f353f35, 0x3f6d3ec4
.long 0x3f80, 0x3f353f35, 0x3f800000, 0x3f35bf35, 0x3f80, 0x3f6d3ec4, 0x3f35bf35, 0xbec4bf6d
.long 0x3f80, 0x3f800000, 0xbf80, 0xbf800000, 0x3f80, 0x3f6dbec4, 0xbf35bf35, 0xbec43f6d
.long 0x3f80, 0x3f35bf35, 0xbf800000, 0x3f353f35, 0x3f80, 0x3ec4bf6d, 0xbf353f35, 0x3f6dbec4
.long 0x3f80, 0xbf80, 0x3f80, 0xbf80, 0x3f80, 0xbec4bf6d, 0x3f353f35, 0xbf6dbec4
.long 0x3f80, 0xbf35bf35, 0x3f800000, 0xbf353f35, 0x3f80, 0xbf6dbec4, 0x3f35bf35, 0x3ec43f6d
.long 0x3f80, 0xbf800000, 0xbf80, 0x3f800000, 0x3f80, 0xbf6d3ec4, 0xbf35bf35, 0x3ec4bf6d
.long 0x3f80, 0xbf353f35, 0xbf800000, 0xbf35bf35, 0x3f80, 0xbec43f6d, 0xbf353f35, 0xbf6d3ec4
.long 0x3f80, 0x3f80, 0x3f80, 0x3f80, 0x3f800000, 0x3f6dbec4, 0x3f35bf35, 0x3ec4bf6d
.long 0xbf80, 0xbf35bf35, 0xbf800000, 0xbf353f35, 0xbf800000, 0xbec43f6d, 0x3f353f35, 0x3f6dbec4
.long 0x3f80, 0x3f800000, 0xbf80, 0xbf800000, 0x3f800000, 0xbec4bf6d, 0xbf353f35, 0x3f6d3ec4
.long 0xbf80, 0xbf353f35, 0x3f800000, 0xbf35bf35, 0xbf800000, 0x3f6d3ec4, 0xbf35bf35, 0x3ec43f6d
.long 0x3f80, 0xbf80, 0x3f80, 0xbf80, 0x3f800000, 0xbf6d3ec4, 0x3f35bf35, 0xbec43f6d
.long 0xbf80, 0x3f353f35, 0xbf800000, 0x3f35bf35, 0xbf800000, 0x3ec4bf6d, 0x3f353f35, 0xbf6d3ec4
.long 0x3f80, 0xbf800000, 0xbf80, 0x3f800000, 0x3f800000, 0x3ec43f6d, 0xbf353f35, 0xbf6dbec4
.long 0xbf80, 0x3f35bf35, 0x3f800000, 0x3f353f35, 0xbf800000, 0xbf6dbec4, 0xbf35bf35, 0xbec4bf6d
.long 0x3f80, 0x3f80, 0x3f80, 0x3f80, 0xbf80, 0xbec4bf6d, 0xbf35bf35, 0xbf6dbec4
.long 0x3f80, 0x3f353f35, 0x3f800000, 0x3f35bf35, 0xbf80, 0xbf6dbec4, 0xbf353f35, 0x3ec43f6d
.long 0x3f80, 0x3f800000, 0xbf80, 0xbf800000, 0xbf80, 0xbf6d3ec4, 0x3f353f35, 0x3ec4bf6d
.long 0x3f80, 0x3f35bf35, 0xbf800000, 0x3f353f35, 0xbf80, 0xbec43f6d, 0x3f35bf35, 0xbf6d3ec4
.long 0x3f80, 0xbf80, 0x3f80, 0xbf80, 0xbf80, 0x3ec43f6d, 0xbf35bf35, 0x3f6d3ec4
.long 0x3f80, 0xbf35bf35, 0x3f800000, 0xbf353f35, 0xbf80, 0x3f6d3ec4, 0xbf353f35, 0xbec4bf6d
.long 0x3f80, 0xbf800000, 0xbf80, 0x3f800000, 0xbf80, 0x3f6dbec4, 0x3f353f35, 0xbec43f6d
.long 0x3f80, 0xbf353f35, 0xbf800000, 0xbf35bf35, 0xbf80, 0x3ec4bf6d, 0x3f35bf35, 0x3f6dbec4
.long 0x3f80, 0x3f80, 0x3f80, 0x3f80, 0xbf800000, 0xbf6d3ec4, 0xbf353f35, 0xbec43f6d
.long 0xbf80, 0xbf35bf35, 0xbf800000, 0xbf353f35, 0x3f800000, 0x3ec4bf6d, 0xbf35bf35, 0xbf6d3ec4
.long 0x3f80, 0x3f800000, 0xbf80, 0xbf800000, 0xbf800000, 0x3ec43f6d, 0x3f35bf35, 0xbf6dbec4
.long 0xbf80, 0xbf353f35, 0x3f800000, 0xbf35bf35, 0x3f800000, 0xbf6dbec4, 0x3f353f35, 0xbec4bf6d
.long 0x3f80, 0xbf80, 0x3f80, 0xbf80, 0xbf800000, 0x3f6dbec4, 0xbf353f35, 0x3ec4bf6d
.long 0xbf80, 0x3f353f35, 0xbf800000, 0x3f35bf35, 0x3f800000, 0xbec43f6d, 0xbf35bf35, 0x3f6dbec4
.long 0x3f80, 0xbf800000, 0xbf80, 0x3f800000, 0xbf800000, 0xbec4bf6d, 0x3f35bf35, 0x3f6d3ec4
.long 0xbf80, 0x3f35bf35, 0x3f800000, 0x3f353f35, 0x3f800000, 0x3f6d3ec4, 0x3f353f35, 0x3ec43f6d
.long 0x3f80, 0x3f80, 0x3f80, 0x3f80, 0x3f80, 0x3ec43f6d, 0x3f353f35, 0x3f6d3ec4
.long 0x3f80, 0x3f353f35, 0x3f800000, 0x3f35bf35, 0x3f80, 0x3f6d3ec4, 0x3f35bf35, 0xbec4bf6d
.long 0x3f80, 0x3f800000, 0xbf80, 0xbf800000, 0x3f80, 0x3f6dbec4, 0xbf35bf35, 0xbec43f6d
.long 0x3f80, 0x3f35bf35, 0xbf800000, 0x3f353f35, 0x3f80, 0x3ec4bf6d, 0xbf353f35, 0x3f6dbec4
.long 0x3f80, 0xbf80, 0x3f80, 0xbf80, 0x3f80, 0xbec4bf6d, 0x3f353f35, 0xbf6dbec4
.long 0x3f80, 0xbf35bf35, 0x3f800000, 0xbf353f35, 0x3f80, 0xbf6dbec4, 0x3f35bf35, 0x3ec43f6d
.long 0x3f80, 0xbf800000, 0xbf80, 0x3f800000, 0x3f80, 0xbf6d3ec4, 0xbf35bf35, 0x3ec4bf6d
.long 0x3f80, 0xbf353f35, 0xbf800000, 0xbf35bf35, 0x3f80, 0xbec43f6d, 0xbf353f35, 0xbf6d3ec4
.long 0x3f80, 0x3f80, 0x3f80, 0x3f80, 0x3f800000, 0x3f6dbec4, 0x3f35bf35, 0x3ec4bf6d
.long 0xbf80, 0xbf35bf35, 0xbf800000, 0xbf353f35, 0xbf800000, 0xbec43f6d, 0x3f353f35, 0x3f6dbec4
.long 0x3f80, 0x3f800000, 0xbf80, 0xbf800000, 0x3f800000, 0xbec4bf6d, 0xbf353f35, 0x3f6d3ec4
.long 0xbf80, 0xbf353f35, 0x3f800000, 0xbf35bf35, 0xbf800000, 0x3f6d3ec4, 0xbf35bf35, 0x3ec43f6d
.long 0x3f80, 0xbf80, 0x3f80, 0xbf80, 0x3f800000, 0xbf6d3ec4, 0x3f35bf35, 0xbec43f6d
.long 0xbf80, 0x3f353f35, 0xbf800000, 0x3f35bf35, 0xbf800000, 0x3ec4bf6d, 0x3f353f35, 0xbf6d3ec4
.long 0x3f80, 0xbf800000, 0xbf80, 0x3f800000, 0x3f800000, 0x3ec43f6d, 0xbf353f35, 0xbf6dbec4
.long 0xbf80, 0x3f35bf35, 0x3f800000, 0x3f353f35, 0xbf800000, 0xbf6dbec4, 0xbf35bf35, 0xbec4bf6d
.long 0x3f80, 0x3f80, 0x3f80, 0x3f80, 0xbf80, 0xbec4bf6d, 0xbf35bf35, 0xbf6dbec4
.long 0x3f80, 0x3f353f35, 0x3f800000, 0x3f35bf35, 0xbf80, 0xbf6dbec4, 0xbf353f35, 0x3ec43f6d
.long 0x3f80, 0x3f800000, 0xbf80, 0xbf800000, 0xbf80, 0xbf6d3ec4, 0x3f353f35, 0x3ec4bf6d
.long 0x3f80, 0x3f35bf35, 0xbf800000, 0x3f353f35, 0xbf80, 0xbec43f6d, 0x3f35bf35, 0xbf6d3ec4
.long 0x3f80, 0xbf80, 0x3f80, 0xbf80, 0xbf80, 0x3ec43f6d, 0xbf35bf35, 0x3f6d3ec4
.long 0x3f80, 0xbf35bf35, 0x3f800000, 0xbf353f35, 0xbf80, 0x3f6d3ec4, 0xbf353f35, 0xbec4bf6d
.long 0x3f80, 0xbf800000, 0xbf80, 0x3f800000, 0xbf80, 0x3f6dbec4, 0x3f353f35, 0xbec43f6d
.long 0x3f80, 0xbf353f35, 0xbf800000, 0xbf35bf35, 0xbf80, 0x3ec4bf6d, 0x3f35bf35, 0x3f6dbec4
.long 0x3f80, 0x3f80, 0x3f80, 0x3f80, 0xbf800000, 0xbf6d3ec4, 0xbf353f35, 0xbec43f6d
.long 0xbf80, 0xbf35bf35, 0xbf800000, 0xbf353f35, 0x3f800000, 0x3ec4bf6d, 0xbf35bf35, 0xbf6d3ec4
.long 0x3f80, 0x3f800000, 0xbf80, 0xbf800000, 0xbf800000, 0x3ec43f6d, 0x3f35bf35, 0xbf6dbec4
.long 0xbf80, 0xbf353f35, 0x3f800000, 0xbf35bf35, 0x3f800000, 0xbf6dbec4, 0x3f353f35, 0xbec4bf6d
.long 0x3f80, 0xbf80, 0x3f80, 0xbf80, 0xbf800000, 0x3f6dbec4, 0xbf353f35, 0x3ec4bf6d
.long 0xbf80, 0x3f353f35, 0xbf800000, 0x3f35bf35, 0x3f800000, 0xbec43f6d, 0xbf35bf35, 0x3f6dbec4
.long 0x3f80, 0xbf800000, 0xbf80, 0x3f800000, 0xbf800000, 0xbec4bf6d, 0x3f35bf35, 0x3f6d3ec4
.long 0xbf80, 0x3f35bf35, 0x3f800000, 0x3f353f35, 0x3f800000, 0x3f6d3ec4, 0x3f353f35, 0x3ec43f6d
.long 0x3f80, 0x3f80, 0x3f80, 0x3f80, 0x3e483f7b, 0x3f0e3f55, 0x3f553f0e, 0x3f7b3e48
.long 0x3ec43f6d, 0x3f6d3ec4, 0x3f6dbec4, 0x3ec4bf6d, 0x3f0e3f55, 0x3f7bbe48, 0x3e48bf7b, 0xbf55bf0e
.long 0x3f353f35, 0x3f35bf35, 0xbf35bf35, 0xbf353f35, 0x3f553f0e, 0x3e48bf7b, 0xbf7b3e48, 0x3f0e3f55
.long 0x3f6d3ec4, 0xbec4bf6d, 0xbec43f6d, 0x3f6dbec4, 0x3f7b3e48, 0xbf55bf0e, 0x3f0e3f55, 0xbe48bf7b
.long 0x3f800000, 0xbf800000, 0x3f800000, 0xbf800000, 0x3f7bbe48, 0xbf553f0e, 0x3f0ebf55, 0xbe483f7b
.long 0x3f6dbec4, 0xbec43f6d, 0xbec4bf6d, 0x3f6d3ec4, 0x3f55bf0e, 0x3e483f7b, 0xbf7bbe48, 0x3f0ebf55
.long 0x3f35bf35, 0x3f353f35, 0xbf353f35, 0xbf35bf35, 0x3f0ebf55, 0x3f7b3e48, 0x3e483f7b, 0xbf553f0e
.long 0x3ec4bf6d, 0x3f6dbec4, 0x3f6d3ec4, 0x3ec43f6d, 0x3e48bf7b, 0x3f0ebf55, 0x3f55bf0e, 0x3f7bbe48
.long 0x3f80, 0x3f80, 0x3f80, 0x3f80, 0x3f7bbe48, 0x3f55bf0e, 0x3f0ebf55, 0x3e48bf7b
.long 0xbec4bf6d, 0xbf6dbec4, 0xbf6d3ec4, 0xbec43f6d, 0xbf553f0e, 0x3e483f7b, 0x3f7b3e48, 0x3f0ebf55
.long 0x3f353f35, 0x3f35bf35, 0xbf35bf35, 0xbf353f35, 0x3f0ebf55, 0xbf7bbe48, 0x3e483f7b, 0x3f55bf0e
.long 0xbf6dbec4, 0x3ec43f6d, 0x3ec4bf6d, 0xbf6d3ec4, 0xbe483f7b, 0x3f0ebf55, 0xbf553f0e, 0x3f7bbe48
.long 0x3f800000, 0xbf800000, 0x3f800000, 0xbf800000, 0xbe48bf7b, 0x3f0e3f55, 0xbf55bf0e, 0x3f7b3e48
.long 0xbf6d3ec4, 0x3ec4bf6d, 0x3ec43f6d, 0xbf6dbec4, 0x3f0e3f55, 0xbf7b3e48, 0x3e48bf7b, 0x3f553f0e
.long 0x3f35bf35, 0x3f353f35, 0xbf353f35, 0xbf35bf35, 0xbf55bf0e, 0x3e48bf7b, 0x3f7bbe48, 0x3f0e3f55
.long 0xbec43f6d, 0xbf6d3ec4, 0xbf6dbec4, 0xbec4bf6d, 0x3f7b3e48, 0x3f553f0e, 0x3f0e3f55, 0x3e483f7b
.long 0x3f80, 0x3f80, 0x3f80, 0x3f80, 0xbe48bf7b, 0xbf0ebf55, 0xbf55bf0e, 0xbf7bbe48
.long 0x3ec43f6d, 0x3f6d3ec4, 0x3f6dbec4, 0x3ec4bf6d, 0xbf0ebf55, 0xbf7b3e48, 0xbe483f7b, 0x3f553f0e
.long 0x3f353f35, 0x3f35bf35, 0xbf35bf35, 0xbf353f35, 0xbf55bf0e, 0xbe483f7b, 0x3f7bbe48, 0xbf0ebf55
.long 0x3f6d3ec4, 0xbec4bf6d, 0xbec43f6d, 0x3f6dbec4, 0xbf7bbe48, 0x3f553f0e, 0xbf0ebf55, 0x3e483f7b
.long 0x3f800000, 0xbf800000, 0x3f800000, 0xbf800000, 0xbf7b3e48, 0x3f55bf0e, 0xbf0e3f55, 0x3e48bf7b
.long 0x3f6dbec4, 0xbec43f6d, 0xbec4bf6d, 0x3f6d3ec4, 0xbf553f0e, 0xbe48bf7b, 0x3f7b3e48, 0xbf0e3f55
.long 0x3f35bf35, 0x3f353f35, 0xbf353f35, 0xbf35bf35, 0xbf0e3f55, 0xbf7bbe48, 0xbe48bf7b, 0x3f55bf0e
.long 0x3ec4bf6d, 0x3f6dbec4, 0x3f6d3ec4, 0x3ec43f6d, 0xbe483f7b, 0xbf0e3f55, 0xbf553f0e, 0xbf7b3e48
.long 0x3f80, 0x3f80, 0x3f80, 0x3f80, 0xbf7b3e48, 0xbf553f0e, 0xbf0e3f55, 0xbe483f7b
.long 0xbec4bf6d, 0xbf6dbec4, 0xbf6d3ec4, 0xbec43f6d, 0x3f55bf0e, 0xbe48bf7b, 0xbf7bbe48, 0xbf0e3f55
.long 0x3f353f35, 0x3f35bf35, 0xbf35bf35, 0xbf353f35, 0xbf0e3f55, 0x3f7b3e48, 0xbe48bf7b, 0xbf553f0e
.long 0xbf6dbec4, 0x3ec43f6d, 0x3ec4bf6d, 0xbf6d3ec4, 0x3e48bf7b, 0xbf0e3f55, 0x3f55bf0e, 0xbf7b3e48
.long 0x3f800000, 0xbf800000, 0x3f800000, 0xbf800000, 0x3e483f7b, 0xbf0ebf55, 0x3f553f0e, 0xbf7bbe48
.long 0xbf6d3ec4, 0x3ec4bf6d, 0x3ec43f6d, 0xbf6dbec4, 0xbf0ebf55, 0x3f7bbe48, 0xbe483f7b, 0xbf55bf0e
.long 0x3f35bf35, 0x3f353f35, 0xbf353f35, 0xbf35bf35, 0x3f553f0e, 0xbe483f7b, 0xbf7b3e48, 0xbf0ebf55
.long 0xbec43f6d, 0xbf6d3ec4, 0xbf6dbec4, 0xbec4bf6d, 0xbf7bbe48, 0xbf55bf0e, 0xbf0ebf55, 0xbe48bf7b
.long 0xbf80, 0xbf80, 0xbf80, 0xbf80, 0xbe48bf7b, 0xbf0ebf55, 0xbf55bf0e, 0xbf7bbe48
.long 0xbec4bf6d, 0xbf6dbec4, 0xbf6d3ec4, 0xbec43f6d, 0xbf0ebf55, 0xbf7b3e48, 0xbe483f7b, 0x3f553f0e
.long 0xbf35bf35, 0xbf353f35, 0x3f353f35, 0x3f35bf35, 0xbf55bf0e, 0xbe483f7b, 0x3f7bbe48, 0xbf0ebf55
.long 0xbf6dbec4, 0x3ec43f6d, 0x3ec4bf6d, 0xbf6d3ec4, 0xbf7bbe48, 0x3f553f0e, 0xbf0ebf55, 0x3e483f7b
.long 0xbf800000, 0x3f800000, 0xbf800000, 0x3f800000, 0xbf7b3e48, 0x3f55bf0e, 0xbf0e3f55, 0x3e48bf7b
.long 0xbf6d3ec4, 0x3ec4bf6d, 0x3ec43f6d, 0xbf6dbec4, 0xbf553f0e, 0xbe48bf7b, 0x3f7b3e48, 0xbf0e3f55
.long 0xbf353f35, 0xbf35bf35, 0x3f35bf35, 0x3f353f35, 0xbf0e3f55, 0xbf7bbe48, 0xbe48bf7b, 0x3f55bf0e
.long 0xbec43f6d, 0xbf6d3ec4, 0xbf6dbec4, 0xbec4bf6d, 0xbe483f7b, 0xbf0e3f55, 0xbf553f0e, 0xbf7b3e48
.long 0xbf80, 0xbf80, 0xbf80, 0xbf80, 0xbf7b3e48, 0xbf553f0e, 0xbf0e3f55, 0xbe483f7b
.long 0x3ec43f6d, 0x3f6d3ec4, 0x3f6dbec4, 0x3ec4bf6d, 0x3f55bf0e, 0xbe48bf7b, 0xbf7bbe48, 0xbf0e3f55
.long 0xbf35bf35, 0xbf353f35, 0x3f353f35, 0x3f35bf35, 0xbf0e3f55, 0x3f7b3e48, 0xbe48bf7b, 0xbf553f0e
.long 0x3f6d3ec4, 0xbec4bf6d, 0xbec43f6d, 0x3f6dbec4, 0x3e48bf7b, 0xbf0e3f55, 0x3f55bf0e, 0xbf7b3e48
.long 0xbf800000, 0x3f800000, 0xbf800000, 0x3f800000, 0x3e483f7b, 0xbf0ebf55, 0x3f553f0e, 0xbf7bbe48
.long 0x3f6dbec4, 0xbec43f6d, 0xbec4bf6d, 0x3f6d3ec4, 0xbf0ebf55, 0x3f7bbe48, 0xbe483f7b, 0xbf55bf0e
.long 0xbf353f35, 0xbf35bf35, 0x3f35bf35, 0x3f353f35, 0x3f553f0e, 0xbe483f7b, 0xbf7b3e48, 0xbf0ebf55
.long 0x3ec4bf6d, 0x3f6dbec4, 0x3f6d3ec4, 0x3ec43f6d, 0xbf7bbe48, 0xbf55bf0e, 0xbf0ebf55, 0xbe48bf7b
.long 0xbf80, 0xbf80, 0xbf80, 0xbf80, 0x3e483f7b, 0x3f0e3f55, 0x3f553f0e, 0x3f7b3e48
.long 0xbec4bf6d, 0xbf6dbec4, 0xbf6d3ec4, 0xbec43f6d, 0x3f0e3f55, 0x3f7bbe48, 0x3e48bf7b, 0xbf55bf0e
.long 0xbf35bf35, 0xbf353f35, 0x3f353f35, 0x3f35bf35, 0x3f553f0e, 0x3e48bf7b, 0xbf7b3e48, 0x3f0e3f55
.long 0xbf6dbec4, 0x3ec43f6d, 0x3ec4bf6d, 0xbf6d3ec4, 0x3f7b3e48, 0xbf55bf0e, 0x3f0e3f55, 0xbe48bf7b
.long 0xbf800000, 0x3f800000, 0xbf800000, 0x3f800000, 0x3f7bbe48, 0xbf553f0e, 0x3f0ebf55, 0xbe483f7b
.long 0xbf6d3ec4, 0x3ec4bf6d, 0x3ec43f6d, 0xbf6dbec4, 0x3f55bf0e, 0x3e483f7b, 0xbf7bbe48, 0x3f0ebf55
.long 0xbf353f35, 0xbf35bf35, 0x3f35bf35, 0x3f353f35, 0x3f0ebf55, 0x3f7b3e48, 0x3e483f7b, 0xbf553f0e
.long 0xbec43f6d, 0xbf6d3ec4, 0xbf6dbec4, 0xbec4bf6d, 0x3e48bf7b, 0x3f0ebf55, 0x3f55bf0e, 0x3f7bbe48
.long 0xbf80, 0xbf80, 0xbf80, 0xbf80, 0x3f7bbe48, 0x3f55bf0e, 0x3f0ebf55, 0x3e48bf7b
.long 0x3ec43f6d, 0x3f6d3ec4, 0x3f6dbec4, 0x3ec4bf6d, 0xbf553f0e, 0x3e483f7b, 0x3f7b3e48, 0x3f0ebf55
.long 0xbf35bf35, 0xbf353f35, 0x3f353f35, 0x3f35bf35, 0x3f0ebf55, 0xbf7bbe48, 0x3e483f7b, 0x3f55bf0e
.long 0x3f6d3ec4, 0xbec4bf6d, 0xbec43f6d, 0x3f6dbec4, 0xbe483f7b, 0x3f0ebf55, 0xbf553f0e, 0x3f7bbe48
.long 0xbf800000, 0x3f800000, 0xbf800000, 0x3f800000, 0xbe48bf7b, 0x3f0e3f55, 0xbf55bf0e, 0x3f7b3e48
.long 0x3f6dbec4, 0xbec43f6d, 0xbec4bf6d, 0x3f6d3ec4, 0x3f0e3f55, 0xbf7b3e48, 0x3e48bf7b, 0x3f553f0e
.long 0xbf353f35, 0xbf35bf35, 0x3f35bf35, 0x3f353f35, 0xbf55bf0e, 0x3e48bf7b, 0x3f7bbe48, 0x3f0e3f55
.long 0x3ec4bf6d, 0x3f6dbec4, 0x3f6d3ec4, 0x3ec43f6d, 0x3f7b3e48, 0x3f553f0e, 0x3f0e3f55, 0x3e483f7b
L_tabend:
.size L_tab, L_tabend - L_tab
.section .rodata,"a"
.p2align 6
.amdhsa_kernel gated_mix__spectral_fnet__moe_arch_mod__prompt_kernel
  .amdhsa_next_free_vgpr 256
  .amdhsa_next_free_sgpr 102
  .amdhsa_accum_offset 256
  .amdhsa_group_segment_fixed_size 0
  .amdhsa_kernarg_size 112
  .amdhsa_user_sgpr_count 2
  .amdhsa_user_sgpr_kernarg_segment_ptr 1
  .amdhsa_system_sgpr_workgroup_id_x 1
.end_amdhsa_kernel
```
